```python
import torch

def _softmax(x, axis=-1):
    return torch.softmax(x, dim=axis)

def _gelu(x):
    return torch.nn.functional.gelu(x, approximate='tanh')

def _silu(x):
    return torch.nn.functional.silu(x)

def _sigmoid(x):
    return torch.sigmoid(x)

def _layernorm(x, axis=-1, eps=1e-05):
    m = x.mean(dim=axis, keepdim=True)
    v = x.var(dim=axis, keepdim=True, unbiased=False)
    return (x - m) / torch.sqrt(v + eps)

def _scatter_add(tgt, idx, src, axis=0):
    return tgt.clone().index_add_(axis, idx, src)

def _segment_sum(src, seg, n):
    out = torch.zeros((n,) + src.shape[1:], dtype=src.dtype)
    return out.index_add_(0, seg, src)

def _pad(x, pw):
    flat = tuple((v for pair in reversed(pw) for v in pair))
    return torch.nn.functional.pad(x, flat)
kernel_name = 'sequential_preLN__memory_aug_recurrent_mem_tr__glu_gated_reglu__prompt'

def setup_inputs():

    _w = lambda a: (lambda t: t.to(torch.bfloat16) if t.is_floating_point() else t)(torch.as_tensor(a))

    def _A_setup():
        B, S, Dm = (1, 2048, 576)
        H, Dh = (32, 128)
        M, seg = (8, 32)
        seg = min(seg, S)
        S = S // seg * seg
        return {'x': _w((lambda *s: torch.randn(*s, dtype=torch.bfloat16) * 0.05)(B, S, Dm)), 'mem0': _w((lambda *s: torch.randn(*s, dtype=torch.bfloat16) * 0.2)(B, M, Dm)), 'Wq': _w((lambda *s: torch.randn(*s, dtype=torch.bfloat16) * 1.6)(Dm, H, Dh) * Dm ** (-0.5)), 'Wk': _w((lambda *s: torch.randn(*s, dtype=torch.bfloat16) * 1.6)(Dm, H, Dh) * Dm ** (-0.5)), 'Wv': _w((lambda *s: torch.randn(*s, dtype=torch.bfloat16) * 0.2)(Dm, H, Dh) * Dm ** (-0.5)), 'Wo': _w((lambda *s: torch.randn(*s, dtype=torch.bfloat16) * 0.2)(H, Dh, Dm) * (H * Dh) ** (-0.5)), 'seg_len': seg}
    _A_in = _A_setup()

    def _B_setup():
        B, S, D, F = (1, 2048, 576, 4608)
        return {'x': _w((lambda *s: torch.randn(*s, dtype=torch.bfloat16) * 0.05)(B, S, D)), 'W_gate': _w((lambda *s: torch.randn(*s, dtype=torch.bfloat16) * 0.2)(D, F) * (2.0 / D) ** 0.5), 'W_up': _w((lambda *s: torch.randn(*s, dtype=torch.bfloat16) * 0.2)(D, F) * (2.0 / D) ** 0.5), 'W_down': _w((lambda *s: torch.randn(*s, dtype=torch.bfloat16) * 0.2)(F, D) * (1.0 / F) ** 0.5)}
    _B_in = _B_setup()
    return {'A_x': _A_in['x'], 'A_mem0': _A_in['mem0'], 'A_Wq': _A_in['Wq'], 'A_Wk': _A_in['Wk'], 'A_Wv': _A_in['Wv'], 'A_Wo': _A_in['Wo'], 'A_seg_len': _A_in['seg_len'], 'B_x': _B_in['x'], 'B_W_gate': _B_in['W_gate'], 'B_W_up': _B_in['W_up'], 'B_W_down': _B_in['W_down']}

def reference(A_x, A_mem0, A_Wq, A_Wk, A_Wv, A_Wo, A_seg_len, B_x, B_W_gate, B_W_up, B_W_down):

    def _A_ref(x, mem0, Wq, Wk, Wv, Wo, seg_len):
        B, S, Dm = x.shape
        H, Dh = (Wq.shape[1], Wq.shape[2])
        M = mem0.shape[1]
        scale = Dh ** (-0.5)
        n_seg = S // seg_len
        L = M + seg_len
        idx = torch.arange(L)
        mask = (idx[:, None] < M) | (idx[:, None] >= idx[None, :])
        mem = mem0
        outs = []
        for s in range(n_seg):
            xs = x[:, s * seg_len:(s + 1) * seg_len, :].clone()
            h = torch.concatenate([mem, xs], axis=1)
            q = torch.einsum('btd,dhe->bhte', h, Wq)
            k = torch.einsum('btd,dhe->bhte', h, Wk)
            v = torch.einsum('btd,dhe->bhte', h, Wv)
            scores = torch.einsum('bhqe,bhke->bhqk', q, k) * scale
            scores = torch.where(mask[None, None], scores, -1000000000.0)
            p = _softmax(scores, axis=-1)
            o = torch.einsum('bhqk,bhke->bhqe', p, v)
            o = torch.einsum('bhte,hed->btd', o, Wo)
            mem = o[:, :M, :].clone()
            outs.append(o[:, M:, :])
        return torch.concatenate(outs, axis=1)

    def _B_ref(x, W_gate, W_up, W_down):
        gate = torch.einsum('bsd,df->bsf', x, W_gate)
        up = torch.einsum('bsd,df->bsf', x, W_up)
        gate = gate * (lambda x, dt: x.to(dt))(gate > 0, gate.dtype)
        h = gate * up
        return torch.einsum('bsf,fd->bsd', h, W_down)
    x = A_x
    h = x + _A_ref(_layernorm(x, axis=-1), A_mem0, A_Wq, A_Wk, A_Wv, A_Wo, A_seg_len)
    h2 = h + _B_ref(_layernorm(h, axis=-1), B_W_gate, B_W_up, B_W_down)
    return h2
```

```asm
; @launch grid=(256,1,1) block=(256,1,1) lds=163840
.amdgcn_target "amdgcn-amd-amdhsa--gfx950"
.text
.globl sequential_preLN__memory_aug_recurrent_mem_tr__glu_gated_reglu__prompt_kernel
.p2align 8
.type sequential_preLN__memory_aug_recurrent_mem_tr__glu_gated_reglu__prompt_kernel,@function
sequential_preLN__memory_aug_recurrent_mem_tr__glu_gated_reglu__prompt_kernel:
  s_cmp_ge_u32 s2, 256
  s_cbranch_scc1 L_exit
  s_load_dwordx4 s[8:11], s[0:1], 96
  s_load_dwordx2 s[28:29], s[0:1], 40
  s_getreg_b32 s34, hwreg(HW_REG_XCC_ID)
  v_readfirstlane_b32 s33, v0
  s_and_b32 s34, s34, 15
  s_lshr_b32 s33, s33, 6
  v_and_b32 v0, 63, v0
  s_waitcnt lgkmcnt(0)
  s_mov_b32 s4, s10
  s_and_b32 s5, s11, 0xffff
  s_mov_b32 s6, 268435456
  s_mov_b32 s7, 0x20000
  s_and_b32 s9, s9, 0xffff
  s_mov_b32 s10, 256
  s_mov_b32 s11, 0x20000
  s_cmp_eq_u32 s33, 0
  s_cbranch_scc1 L_nozero
  s_cmp_lg_u32 s34, 0
  s_cbranch_scc1 L_early_1
  s_getpc_b64 s[36:37]
L_early_1_pc:
  s_mov_b32 s38, L_chain-L_early_1_pc
  s_cmp_eq_u32 s33, 1
  s_cselect_b32 s38, L_chain_w1-L_early_1_pc, s38
  s_cmp_eq_u32 s33, 2
  s_cselect_b32 s38, L_chain_w2-L_early_1_pc, s38
  s_cmp_eq_u32 s33, 3
  s_cselect_b32 s38, L_chain_w3-L_early_1_pc, s38
  v_lshlrev_b32 v10, 6, v0
  v_add_u32 v10, s38, v10
  v_min_u32 v8, L_code_end-L_early_1_pc-4, v10
  v_mov_b32 v9, s37
  v_add_co_u32 v8, vcc, s36, v8
  s_nop 1
  v_addc_co_u32 v9, vcc, 0, v9, vcc
  global_load_dword v255, v[8:9], off
  v_add_u32 v10, 0x1000, v10
  v_min_u32 v8, L_code_end-L_early_1_pc-4, v10
  v_mov_b32 v9, s37
  v_add_co_u32 v8, vcc, s36, v8
  s_nop 1
  v_addc_co_u32 v9, vcc, 0, v9, vcc
  global_load_dword v255, v[8:9], off
  v_add_u32 v10, 0x1000, v10
  v_min_u32 v8, L_code_end-L_early_1_pc-4, v10
  v_mov_b32 v9, s37
  v_add_co_u32 v8, vcc, s36, v8
  s_nop 1
  v_addc_co_u32 v9, vcc, 0, v9, vcc
  global_load_dword v255, v[8:9], off
  s_cmp_lt_u32 s33, 2
  s_cbranch_scc1 L_early_1
  s_and_b32 s29, s29, 0xffff
  s_mov_b32 s30, 4718592
  s_mov_b32 s31, 0x20000
  s_bfe_u32 s36, s2, 0x50003
  s_mul_i32 s36, s36, 147456
  s_and_b32 s37, s33, 1
  s_lshl_b32 s37, s37, 12
  s_add_u32 s36, s36, s37
  v_lshlrev_b32 v8, 6, v0
  buffer_load_dword v255, v8, s[28:31], s36 offen
  s_add_u32 s36, s36, 8192
  buffer_load_dword v255, v8, s[28:31], s36 offen
  s_add_u32 s36, s36, 8192
  buffer_load_dword v255, v8, s[28:31], s36 offen
  s_add_u32 s36, s36, 8192
  buffer_load_dword v255, v8, s[28:31], s36 offen
  s_add_u32 s36, s36, 8192
  buffer_load_dword v255, v8, s[28:31], s36 offen
  s_add_u32 s36, s36, 8192
  buffer_load_dword v255, v8, s[28:31], s36 offen
  s_add_u32 s36, s36, 8192
  buffer_load_dword v255, v8, s[28:31], s36 offen
  s_add_u32 s36, s36, 8192
  buffer_load_dword v255, v8, s[28:31], s36 offen
  s_add_u32 s36, s36, 8192
  buffer_load_dword v255, v8, s[28:31], s36 offen
  s_add_u32 s36, s36, 8192
L_early_1:
  s_cmp_lg_u32 s33, 1
  s_cbranch_scc1 L_nozero
  s_cmp_lt_u32 s2, 236
  s_cbranch_scc1 L_noticket
  s_bitcmp0_b32 s2, 0
  s_cbranch_scc1 L_noticket
  v_mov_b64 v[4:5], 0
  v_mov_b64 v[6:7], 0
  v_lshlrev_b32 v3, 4, v0
  s_sub_u32 s36, s2, 237
  s_lshl_b32 s36, s36, 9
  buffer_store_dwordx4 v[4:7], v3, s[4:7], s36 offen sc1
  v_mov_b32 v1, 1
  s_waitcnt vmcnt(0)
  s_mov_b64 exec, 1
  buffer_atomic_add v1, off, s[8:11], 0 offset:4
  s_mov_b64 exec, -1
  s_branch L_noticket
L_nozero:
  s_cmp_lg_u32 s33, 0
  s_cbranch_scc1 L_noticket
  v_mov_b32 v2, 0
  s_mov_b64 exec, 1
  v_mov_b32 v1, 1
  s_and_b32 s34, s34, 7
  s_lshl_b32 s36, s34, 2
  s_add_u32 s36, s36, 88
  s_cmp_eq_u32 s34, 1
  s_cselect_b32 s36, 152, s36
  s_cmp_eq_u32 s34, 0
  s_cselect_b32 s36, 128, s36
  buffer_atomic_add v1, off, s[8:11], s36 sc0
  s_mov_b64 exec, -1
  s_cmp_lg_u32 s34, 0
  s_cbranch_scc1 L_early_2
  s_getpc_b64 s[36:37]
L_early_2_pc:
  s_mov_b32 s38, L_chain-L_early_2_pc
  s_cmp_eq_u32 s33, 1
  s_cselect_b32 s38, L_chain_w1-L_early_2_pc, s38
  s_cmp_eq_u32 s33, 2
  s_cselect_b32 s38, L_chain_w2-L_early_2_pc, s38
  s_cmp_eq_u32 s33, 3
  s_cselect_b32 s38, L_chain_w3-L_early_2_pc, s38
  v_lshlrev_b32 v10, 6, v0
  v_add_u32 v10, s38, v10
  v_min_u32 v8, L_code_end-L_early_2_pc-4, v10
  v_mov_b32 v9, s37
  v_add_co_u32 v8, vcc, s36, v8
  s_nop 1
  v_addc_co_u32 v9, vcc, 0, v9, vcc
  global_load_dword v255, v[8:9], off
  v_add_u32 v10, 0x1000, v10
  v_min_u32 v8, L_code_end-L_early_2_pc-4, v10
  v_mov_b32 v9, s37
  v_add_co_u32 v8, vcc, s36, v8
  s_nop 1
  v_addc_co_u32 v9, vcc, 0, v9, vcc
  global_load_dword v255, v[8:9], off
  v_add_u32 v10, 0x1000, v10
  v_min_u32 v8, L_code_end-L_early_2_pc-4, v10
  v_mov_b32 v9, s37
  v_add_co_u32 v8, vcc, s36, v8
  s_nop 1
  v_addc_co_u32 v9, vcc, 0, v9, vcc
  global_load_dword v255, v[8:9], off
L_early_2:
  s_mov_b64 exec, 1
  s_cmp_eq_u32 s34, 0
  s_cbranch_scc0 L_tk0
  s_waitcnt vmcnt(3)
  s_branch L_tk1
L_tk0:
  s_waitcnt vmcnt(0)
L_tk1:
  s_lshl_b32 s36, s34, 16
  v_readfirstlane_b32 s35, v1
  v_or_b32 v1, s36, v1
  s_cmp_lt_u32 s35, 32
  s_cbranch_scc1 L_ticket
  v_mov_b32 v1, 1
  buffer_atomic_add v1, off, s[8:11], 0 offset:0 sc0
  s_waitcnt vmcnt(0)
  v_or_b32 v1, 0x80000, v1
L_ticket:
  ds_write_b32 v2, v1
  s_waitcnt lgkmcnt(0)
  s_mov_b64 exec, -1
L_noticket:
  s_barrier
  v_mov_b32 v2, 0
  ds_read_b32 v1, v2
  s_waitcnt lgkmcnt(0)
  v_readfirstlane_b32 s35, v1
  s_barrier
  s_and_b32 s32, s35, 0xffff
  s_lshr_b32 s34, s35, 16
  s_cmp_lt_u32 s34, 8
  s_cbranch_scc1 L_drawn
  s_mov_b32 s37, 0
  v_lshlrev_b32 v2, 2, v0
  v_add_u32 v2, 88, v2
  v_mov_b32 v3, 128
  v_cmp_eq_u32 vcc, 0, v0
  s_nop 1
  v_cndmask_b32 v2, v2, v3, vcc
  v_mov_b32 v3, 152
  v_cmp_eq_u32 vcc, 1, v0
  s_nop 1
  v_cndmask_b32 v2, v2, v3, vcc
  v_mov_b32 v3, 0
  v_cmp_lt_u32 vcc, 7, v0
  s_nop 1
  v_cndmask_b32 v2, v2, v3, vcc
L_spare:
  buffer_load_dword v1, v2, s[8:11], 0 offen sc1
  s_add_u32 s37, s37, 1
  s_waitcnt vmcnt(0)
  v_readlane_b32 s35, v1, 8
  v_min_u32 v1, 32, v1
  s_cmp_ge_u32 s37, 262144
  s_cbranch_scc1 L_exit
  v_readlane_b32 s36, v1, 0
  s_nop 0
  s_add_u32 s35, s35, s36
  v_readlane_b32 s36, v1, 1
  s_nop 0
  s_add_u32 s35, s35, s36
  v_readlane_b32 s36, v1, 2
  s_nop 0
  s_add_u32 s35, s35, s36
  v_readlane_b32 s36, v1, 3
  s_nop 0
  s_add_u32 s35, s35, s36
  v_readlane_b32 s36, v1, 4
  s_nop 0
  s_add_u32 s35, s35, s36
  v_readlane_b32 s36, v1, 5
  s_nop 0
  s_add_u32 s35, s35, s36
  v_readlane_b32 s36, v1, 6
  s_nop 0
  s_add_u32 s35, s35, s36
  v_readlane_b32 s36, v1, 7
  s_nop 0
  s_add_u32 s35, s35, s36
  s_cmp_lt_u32 s35, 256
  s_cbranch_scc1 L_spare
  v_readlane_b32 s36, v1, 0
  s_mov_b32 s34, 0
  s_add_u32 s32, s32, s36
  s_cmp_lt_u32 s32, 32
  s_cbranch_scc1 L_drawn
  s_sub_u32 s32, s32, 32
  v_readlane_b32 s36, v1, 1
  s_mov_b32 s34, 1
  s_add_u32 s32, s32, s36
  s_cmp_lt_u32 s32, 32
  s_cbranch_scc1 L_drawn
  s_sub_u32 s32, s32, 32
  v_readlane_b32 s36, v1, 2
  s_mov_b32 s34, 2
  s_add_u32 s32, s32, s36
  s_cmp_lt_u32 s32, 32
  s_cbranch_scc1 L_drawn
  s_sub_u32 s32, s32, 32
  v_readlane_b32 s36, v1, 3
  s_mov_b32 s34, 3
  s_add_u32 s32, s32, s36
  s_cmp_lt_u32 s32, 32
  s_cbranch_scc1 L_drawn
  s_sub_u32 s32, s32, 32
  v_readlane_b32 s36, v1, 4
  s_mov_b32 s34, 4
  s_add_u32 s32, s32, s36
  s_cmp_lt_u32 s32, 32
  s_cbranch_scc1 L_drawn
  s_sub_u32 s32, s32, 32
  v_readlane_b32 s36, v1, 5
  s_mov_b32 s34, 5
  s_add_u32 s32, s32, s36
  s_cmp_lt_u32 s32, 32
  s_cbranch_scc1 L_drawn
  s_sub_u32 s32, s32, 32
  v_readlane_b32 s36, v1, 6
  s_mov_b32 s34, 6
  s_add_u32 s32, s32, s36
  s_cmp_lt_u32 s32, 32
  s_cbranch_scc1 L_drawn
  s_sub_u32 s32, s32, 32
  v_readlane_b32 s36, v1, 7
  s_mov_b32 s34, 7
  s_add_u32 s32, s32, s36
  s_cmp_lt_u32 s32, 32
  s_cbranch_scc1 L_drawn
  s_sub_u32 s32, s32, 32
  s_branch L_exit
L_drawn:
  s_cmp_eq_u32 s34, 0
  s_cbranch_scc1 L_chain
  s_cmp_eq_u32 s34, 1
  s_cbranch_scc1 L_tab1
  s_cmp_eq_u32 s34, 2
  s_cbranch_scc1 L_tab2
  s_cmp_eq_u32 s34, 3
  s_cbranch_scc1 L_tab3
  s_cmp_eq_u32 s34, 4
  s_cbranch_scc1 L_tab4
  s_cmp_eq_u32 s34, 5
  s_cbranch_scc1 L_tab5
  s_cmp_eq_u32 s34, 6
  s_cbranch_scc1 L_tab6
L_tab7:
  s_mov_b32 s64, 0x53525150
  s_mov_b32 s65, 0x57565554
  s_mov_b32 s66, 0x5b5a5958
  s_mov_b32 s67, 0x5f5e5d5c
  s_mov_b32 s68, 0x17110b05
  s_mov_b32 s69, 0x2f29231d
  s_mov_b32 s70, 0x87817b75
  s_mov_b32 s71, 0x9f99938d
  s_branch L_tabx
L_tab1:
  s_mov_b32 s64, 0x6c6d6e6f
  s_mov_b32 s65, 0x68696a6b
  s_mov_b32 s66, 0x64656667
  s_mov_b32 s67, 0x60616263
  s_mov_b32 s68, 0x3c3d3e3f
  s_mov_b32 s69, 0x38393a3b
  s_mov_b32 s70, 0x34353637
  s_mov_b32 s71, 0x30313233
  s_branch L_tabx
L_tab2:
  s_mov_b32 s64, 0x120c0600
  s_mov_b32 s65, 0x2a241e18
  s_mov_b32 s66, 0x827c7670
  s_mov_b32 s67, 0x9a948e88
  s_mov_b32 s68, 0xaca8a4a0
  s_mov_b32 s69, 0xbcb8b4b0
  s_mov_b32 s70, 0xccc8c4c0
  s_mov_b32 s71, 0xffd8d4d0
  s_branch L_tabx
L_tab3:
  s_mov_b32 s64, 0x130d0701
  s_mov_b32 s65, 0x2b251f19
  s_mov_b32 s66, 0x837d7771
  s_mov_b32 s67, 0x9b958f89
  s_mov_b32 s68, 0xada9a5a1
  s_mov_b32 s69, 0xbdb9b5b1
  s_mov_b32 s70, 0xcdc9c5c1
  s_mov_b32 s71, 0xffd9d5d1
  s_branch L_tabx
L_tab4:
  s_mov_b32 s64, 0x140e0802
  s_mov_b32 s65, 0x2c26201a
  s_mov_b32 s66, 0x847e7872
  s_mov_b32 s67, 0x9c96908a
  s_mov_b32 s68, 0xaeaaa6a2
  s_mov_b32 s69, 0xbebab6b2
  s_mov_b32 s70, 0xcecac6c2
  s_mov_b32 s71, 0xffdad6d2
  s_branch L_tabx
L_tab5:
  s_mov_b32 s64, 0x150f0903
  s_mov_b32 s65, 0x2d27211b
  s_mov_b32 s66, 0x857f7973
  s_mov_b32 s67, 0x9d97918b
  s_mov_b32 s68, 0xafaba7a3
  s_mov_b32 s69, 0xbfbbb7b3
  s_mov_b32 s70, 0xcfcbc7c3
  s_mov_b32 s71, 0xffdbd7d3
  s_branch L_tabx
L_tab6:
  s_mov_b32 s64, 0x43424140
  s_mov_b32 s65, 0x47464544
  s_mov_b32 s66, 0x4b4a4948
  s_mov_b32 s67, 0x4f4e4d4c
  s_mov_b32 s68, 0x16100a04
  s_mov_b32 s69, 0x2e28221c
  s_mov_b32 s70, 0x86807a74
  s_mov_b32 s71, 0x9e98928c
L_tabx:
  s_bitcmp1_b32 s32, 3
  s_cselect_b64 s[64:65], s[66:67], s[64:65]
  s_cselect_b64 s[68:69], s[70:71], s[68:69]
  s_bitcmp1_b32 s32, 4
  s_cselect_b64 s[64:65], s[68:69], s[64:65]
  s_and_b32 s32, s32, 7
  s_lshl_b32 s32, s32, 3
  s_lshr_b64 s[64:65], s[64:65], s32
  s_and_b32 s32, s64, 0xff
  s_cmp_ge_u32 s32, 220
  s_cbranch_scc1 L_exit
  s_branch L_roles
  s_mul_i32 s35, s32, 6
  s_add_u32 s35, s35, s34
  s_sub_u32 s35, s35, 2
  s_sub_u32 s32, 223, s32
  s_cmp_eq_u32 s34, 1
  s_cselect_b32 s32, s32, s35
L_list:
  s_cmp_lt_u32 s32, 48
  s_cbranch_scc1 L_roles
  s_cmp_lt_u32 s32, 80
  s_cselect_b32 s34, 16, 32
  s_cmp_lt_u32 s32, 192
  s_cselect_b32 s34, s34, -144
  s_cmp_lt_u32 s32, 208
  s_cselect_b32 s34, s34, -112
  s_add_u32 s32, s32, s34
  s_cmp_ge_u32 s32, 220
  s_cbranch_scc1 L_exit
  s_branch L_roles
L_exit:
  s_endpgm
L_roles:
  s_cmp_ge_u32 s32, 112
  s_cbranch_scc1 L_ffn
  s_cmp_ge_u32 s32, 48
  s_cbranch_scc1 L_att
L_proj:
  s_load_dwordx4 s[16:19], s[0:1], 16
  s_load_dwordx2 s[20:21], s[0:1], 32
  s_mov_b32 s50, 0
  s_waitcnt lgkmcnt(0)
  s_and_b32 s36, s33, 1
  s_cmp_lt_u32 s32, 32
  s_cbranch_scc1 L_proj_kv
  s_mov_b32 s12, s16
  s_mov_b32 s13, s17
  s_sub_u32 s34, s32, 32
  s_lshl_b32 s34, s34, 1
  s_lshr_b32 s35, s33, 1
  s_add_u32 s34, s34, s35
  s_mov_b32 s45, 18874368
  s_mov_b32 s44, 0
  s_branch L_proj_j
L_proj_kv:
  s_mov_b32 s34, s32
  s_cmp_ge_u32 s33, 2
  s_cbranch_scc1 L_proj_v
  s_mov_b32 s12, s18
  s_mov_b32 s13, s19
  s_mov_b32 s45, 35651584
  s_mov_b32 s44, 0
  s_branch L_proj_j
L_proj_v:
  s_mov_b32 s12, s20
  s_mov_b32 s13, s21
  s_mov_b32 s45, 52428800
  s_mov_b32 s44, 1
L_proj_j:
  s_and_b32 s13, s13, 0xffff
  s_mov_b32 s14, 4718592
  s_mov_b32 s15, 0x20000
  s_lshl_b32 s35, s34, 13
  s_add_u32 s45, s45, s35
  s_add_u32 s37, s44, 11
  s_lshl_b32 s35, s36, s37
  s_add_u32 s45, s45, s35
  s_lshl_b32 s34, s34, 8
  s_lshl_b32 s36, s36, 7
  s_add_u32 s34, s34, s36
  s_mul_i32 s42, s33, 32768
  v_lshrrev_b32 v64, 3, v0
  v_and_b32 v65, 7, v0
  v_lshlrev_b32 v64, 13, v64
  v_lshl_add_u32 v64, v65, 4, v64
  v_add_u32 v71, s34, v64
  s_add_u32 m0, s42, 0
  s_mov_b32 s51, 0
  buffer_load_dwordx4 v71, s[12:15], s51 offen lds
  s_add_u32 m0, s42, 1024
  s_mov_b32 s51, 65536
  buffer_load_dwordx4 v71, s[12:15], s51 offen lds
  s_add_u32 m0, s42, 2048
  s_mov_b32 s51, 131072
  buffer_load_dwordx4 v71, s[12:15], s51 offen lds
  s_add_u32 m0, s42, 3072
  s_mov_b32 s51, 196608
  buffer_load_dwordx4 v71, s[12:15], s51 offen lds
  s_add_u32 m0, s42, 4096
  s_mov_b32 s51, 262144
  buffer_load_dwordx4 v71, s[12:15], s51 offen lds
  s_add_u32 m0, s42, 5120
  s_mov_b32 s51, 327680
  buffer_load_dwordx4 v71, s[12:15], s51 offen lds
  s_add_u32 m0, s42, 6144
  s_mov_b32 s51, 393216
  buffer_load_dwordx4 v71, s[12:15], s51 offen lds
  s_add_u32 m0, s42, 7168
  s_mov_b32 s51, 458752
  buffer_load_dwordx4 v71, s[12:15], s51 offen lds
  s_add_u32 m0, s42, 8192
  s_mov_b32 s51, 524288
  buffer_load_dwordx4 v71, s[12:15], s51 offen lds
  s_add_u32 m0, s42, 9216
  s_mov_b32 s51, 589824
  buffer_load_dwordx4 v71, s[12:15], s51 offen lds
  s_add_u32 m0, s42, 10240
  s_mov_b32 s51, 655360
  buffer_load_dwordx4 v71, s[12:15], s51 offen lds
  s_add_u32 m0, s42, 11264
  s_mov_b32 s51, 720896
  buffer_load_dwordx4 v71, s[12:15], s51 offen lds
  s_add_u32 m0, s42, 12288
  s_mov_b32 s51, 786432
  buffer_load_dwordx4 v71, s[12:15], s51 offen lds
  s_add_u32 m0, s42, 13312
  s_mov_b32 s51, 851968
  buffer_load_dwordx4 v71, s[12:15], s51 offen lds
  s_add_u32 m0, s42, 14336
  s_mov_b32 s51, 917504
  buffer_load_dwordx4 v71, s[12:15], s51 offen lds
  s_add_u32 m0, s42, 15360
  s_mov_b32 s51, 983040
  buffer_load_dwordx4 v71, s[12:15], s51 offen lds
  s_add_u32 m0, s42, 16384
  s_mov_b32 s51, 1048576
  buffer_load_dwordx4 v71, s[12:15], s51 offen lds
  s_add_u32 m0, s42, 17408
  s_mov_b32 s51, 1114112
  buffer_load_dwordx4 v71, s[12:15], s51 offen lds
  s_add_u32 m0, s42, 18432
  s_mov_b32 s51, 1179648
  buffer_load_dwordx4 v71, s[12:15], s51 offen lds
  s_add_u32 m0, s42, 19456
  s_mov_b32 s51, 1245184
  buffer_load_dwordx4 v71, s[12:15], s51 offen lds
  s_add_u32 m0, s42, 20480
  s_mov_b32 s51, 1310720
  buffer_load_dwordx4 v71, s[12:15], s51 offen lds
  s_add_u32 m0, s42, 21504
  s_mov_b32 s51, 1376256
  buffer_load_dwordx4 v71, s[12:15], s51 offen lds
  s_add_u32 m0, s42, 22528
  s_mov_b32 s51, 1441792
  buffer_load_dwordx4 v71, s[12:15], s51 offen lds
  s_add_u32 m0, s42, 23552
  s_mov_b32 s51, 1507328
  buffer_load_dwordx4 v71, s[12:15], s51 offen lds
  s_add_u32 m0, s42, 24576
  s_mov_b32 s51, 1572864
  buffer_load_dwordx4 v71, s[12:15], s51 offen lds
  s_add_u32 m0, s42, 25600
  s_mov_b32 s51, 1638400
  buffer_load_dwordx4 v71, s[12:15], s51 offen lds
  s_add_u32 m0, s42, 26624
  s_mov_b32 s51, 1703936
  buffer_load_dwordx4 v71, s[12:15], s51 offen lds
  s_add_u32 m0, s42, 27648
  s_mov_b32 s51, 1769472
  buffer_load_dwordx4 v71, s[12:15], s51 offen lds
  s_add_u32 m0, s42, 28672
  s_mov_b32 s51, 1835008
  buffer_load_dwordx4 v71, s[12:15], s51 offen lds
  s_add_u32 m0, s42, 29696
  s_mov_b32 s51, 1900544
  buffer_load_dwordx4 v71, s[12:15], s51 offen lds
  s_add_u32 m0, s42, 30720
  s_mov_b32 s51, 1966080
  buffer_load_dwordx4 v71, s[12:15], s51 offen lds
  s_add_u32 m0, s42, 31744
  s_mov_b32 s51, 2031616
  buffer_load_dwordx4 v71, s[12:15], s51 offen lds
  v_lshrrev_b32 v64, 5, v0
  v_bfe_u32 v65, v0, 2, 2
  v_lshl_add_u32 v64, v64, 3, v65
  v_lshlrev_b32 v64, 7, v64
  v_bfe_u32 v65, v0, 4, 1
  v_lshl_add_u32 v64, v65, 5, v64
  v_and_b32 v65, 3, v0
  v_lshl_add_u32 v64, v65, 3, v64
  v_add_u32 v15, s42, v64
  s_mul_i32 s34, s33, 576
  s_mov_b32 s35, 58255
  v_add_u32 v64, s34, v0
  v_add_u32 v64, 0, v64
  v_mul_lo_u32 v65, v64, s35
  v_lshrrev_b32 v65, 22, v65
  v_mul_u32_u24 v66, 72, v65
  v_sub_u32 v66, v64, v66
  v_bfe_u32 v67, v65, 1, 3
  v_xor_b32 v66, v66, v67
  v_mul_u32_u24 v65, 1152, v65
  v_lshl_add_u32 v1, v66, 4, v65
  v_add_u32 v64, s34, v0
  v_add_u32 v64, 64, v64
  v_mul_lo_u32 v65, v64, s35
  v_lshrrev_b32 v65, 22, v65
  v_mul_u32_u24 v66, 72, v65
  v_sub_u32 v66, v64, v66
  v_bfe_u32 v67, v65, 1, 3
  v_xor_b32 v66, v66, v67
  v_mul_u32_u24 v65, 1152, v65
  v_lshl_add_u32 v2, v66, 4, v65
  v_add_u32 v64, s34, v0
  v_add_u32 v64, 128, v64
  v_mul_lo_u32 v65, v64, s35
  v_lshrrev_b32 v65, 22, v65
  v_mul_u32_u24 v66, 72, v65
  v_sub_u32 v66, v64, v66
  v_bfe_u32 v67, v65, 1, 3
  v_xor_b32 v66, v66, v67
  v_mul_u32_u24 v65, 1152, v65
  v_lshl_add_u32 v3, v66, 4, v65
  v_add_u32 v64, s34, v0
  v_add_u32 v64, 192, v64
  v_mul_lo_u32 v65, v64, s35
  v_lshrrev_b32 v65, 22, v65
  v_mul_u32_u24 v66, 72, v65
  v_sub_u32 v66, v64, v66
  v_bfe_u32 v67, v65, 1, 3
  v_xor_b32 v66, v66, v67
  v_mul_u32_u24 v65, 1152, v65
  v_lshl_add_u32 v4, v66, 4, v65
  v_add_u32 v64, s34, v0
  v_add_u32 v64, 256, v64
  v_mul_lo_u32 v65, v64, s35
  v_lshrrev_b32 v65, 22, v65
  v_mul_u32_u24 v66, 72, v65
  v_sub_u32 v66, v64, v66
  v_bfe_u32 v67, v65, 1, 3
  v_xor_b32 v66, v66, v67
  v_mul_u32_u24 v65, 1152, v65
  v_lshl_add_u32 v5, v66, 4, v65
  v_add_u32 v64, s34, v0
  v_add_u32 v64, 320, v64
  v_mul_lo_u32 v65, v64, s35
  v_lshrrev_b32 v65, 22, v65
  v_mul_u32_u24 v66, 72, v65
  v_sub_u32 v66, v64, v66
  v_bfe_u32 v67, v65, 1, 3
  v_xor_b32 v66, v66, v67
  v_mul_u32_u24 v65, 1152, v65
  v_lshl_add_u32 v6, v66, 4, v65
  v_add_u32 v64, s34, v0
  v_add_u32 v64, 384, v64
  v_mul_lo_u32 v65, v64, s35
  v_lshrrev_b32 v65, 22, v65
  v_mul_u32_u24 v66, 72, v65
  v_sub_u32 v66, v64, v66
  v_bfe_u32 v67, v65, 1, 3
  v_xor_b32 v66, v66, v67
  v_mul_u32_u24 v65, 1152, v65
  v_lshl_add_u32 v7, v66, 4, v65
  v_add_u32 v64, s34, v0
  v_add_u32 v64, 448, v64
  v_mul_lo_u32 v65, v64, s35
  v_lshrrev_b32 v65, 22, v65
  v_mul_u32_u24 v66, 72, v65
  v_sub_u32 v66, v64, v66
  v_bfe_u32 v67, v65, 1, 3
  v_xor_b32 v66, v66, v67
  v_mul_u32_u24 v65, 1152, v65
  v_lshl_add_u32 v8, v66, 4, v65
  v_add_u32 v64, s34, v0
  v_add_u32 v64, 512, v64
  v_mul_lo_u32 v65, v64, s35
  v_lshrrev_b32 v65, 22, v65
  v_mul_u32_u24 v66, 72, v65
  v_sub_u32 v66, v64, v66
  v_bfe_u32 v67, v65, 1, 3
  v_xor_b32 v66, v66, v67
  v_mul_u32_u24 v65, 1152, v65
  v_lshl_add_u32 v9, v66, 4, v65
  v_and_b32 v64, 31, v0
  v_lshrrev_b32 v65, 5, v0
  v_bfe_u32 v66, v64, 1, 3
  v_mul_u32_u24 v64, 1152, v64
  v_add_u32 v67, 0, v65
  v_xor_b32 v67, v67, v66
  v_lshl_add_u32 v10, v67, 4, v64
  v_add_u32 v67, 2, v65
  v_xor_b32 v67, v67, v66
  v_lshl_add_u32 v11, v67, 4, v64
  v_add_u32 v67, 4, v65
  v_xor_b32 v67, v67, v66
  v_lshl_add_u32 v12, v67, 4, v64
  v_add_u32 v67, 6, v65
  v_xor_b32 v67, v67, v66
  v_lshl_add_u32 v13, v67, 4, v64
  s_lshl_b32 s34, s44, 1
  s_sub_u32 s34, 12, s34
  v_bfe_u32 v64, v0, 4, 1
  v_lshlrev_b32 v64, s34, v64
  v_lshrrev_b32 v65, 5, v0
  v_lshl_add_u32 v64, v65, 8, v64
  v_and_b32 v65, 15, v0
  v_lshl_add_u32 v14, v65, 4, v64
  s_waitcnt vmcnt(30)
  ds_read_b64_tr_b16 v[224:225], v15 offset:0
  ds_read_b64_tr_b16 v[226:227], v15 offset:512
  ds_read_b64_tr_b16 v[228:229], v15 offset:64
  ds_read_b64_tr_b16 v[230:231], v15 offset:576
  s_waitcnt vmcnt(28)
  ds_read_b64_tr_b16 v[232:233], v15 offset:2048
  ds_read_b64_tr_b16 v[234:235], v15 offset:2560
  ds_read_b64_tr_b16 v[236:237], v15 offset:2112
  ds_read_b64_tr_b16 v[238:239], v15 offset:2624
  s_waitcnt lgkmcnt(4)
  s_add_u32 m0, s42, 0
  s_mov_b32 s51, 2097152
  buffer_load_dwordx4 v71, s[12:15], s51 offen lds
  s_add_u32 m0, s42, 1024
  s_mov_b32 s51, 2162688
  buffer_load_dwordx4 v71, s[12:15], s51 offen lds
  s_waitcnt vmcnt(28)
  ds_read_b64_tr_b16 v[240:241], v15 offset:4096
  ds_read_b64_tr_b16 v[242:243], v15 offset:4608
  ds_read_b64_tr_b16 v[244:245], v15 offset:4160
  ds_read_b64_tr_b16 v[246:247], v15 offset:4672
  s_waitcnt lgkmcnt(4)
  s_add_u32 m0, s42, 2048
  s_mov_b32 s51, 2228224
  buffer_load_dwordx4 v71, s[12:15], s51 offen lds
  s_add_u32 m0, s42, 3072
  s_mov_b32 s51, 2293760
  buffer_load_dwordx4 v71, s[12:15], s51 offen lds
  s_waitcnt vmcnt(28)
  ds_read_b64_tr_b16 v[248:249], v15 offset:6144
  ds_read_b64_tr_b16 v[250:251], v15 offset:6656
  ds_read_b64_tr_b16 v[252:253], v15 offset:6208
  ds_read_b64_tr_b16 v[254:255], v15 offset:6720
  s_waitcnt lgkmcnt(4)
  s_add_u32 m0, s42, 4096
  s_mov_b32 s51, 2359296
  buffer_load_dwordx4 v71, s[12:15], s51 offen lds
  s_add_u32 m0, s42, 5120
  s_mov_b32 s51, 2424832
  buffer_load_dwordx4 v71, s[12:15], s51 offen lds
  s_waitcnt vmcnt(28)
  ds_read_b64_tr_b16 a[0:1], v15 offset:8192
  ds_read_b64_tr_b16 a[2:3], v15 offset:8704
  ds_read_b64_tr_b16 a[4:5], v15 offset:8256
  ds_read_b64_tr_b16 a[6:7], v15 offset:8768
  s_waitcnt lgkmcnt(4)
  s_add_u32 m0, s42, 6144
  s_mov_b32 s51, 2490368
  buffer_load_dwordx4 v71, s[12:15], s51 offen lds
  s_add_u32 m0, s42, 7168
  s_mov_b32 s51, 2555904
  buffer_load_dwordx4 v71, s[12:15], s51 offen lds
  s_waitcnt vmcnt(28)
  ds_read_b64_tr_b16 a[8:9], v15 offset:10240
  ds_read_b64_tr_b16 a[10:11], v15 offset:10752
  ds_read_b64_tr_b16 a[12:13], v15 offset:10304
  ds_read_b64_tr_b16 a[14:15], v15 offset:10816
  s_waitcnt lgkmcnt(4)
  s_add_u32 m0, s42, 8192
  s_mov_b32 s51, 2621440
  buffer_load_dwordx4 v71, s[12:15], s51 offen lds
  s_add_u32 m0, s42, 9216
  s_mov_b32 s51, 2686976
  buffer_load_dwordx4 v71, s[12:15], s51 offen lds
  s_waitcnt vmcnt(28)
  ds_read_b64_tr_b16 a[16:17], v15 offset:12288
  ds_read_b64_tr_b16 a[18:19], v15 offset:12800
  ds_read_b64_tr_b16 a[20:21], v15 offset:12352
  ds_read_b64_tr_b16 a[22:23], v15 offset:12864
  s_waitcnt lgkmcnt(4)
  s_add_u32 m0, s42, 10240
  s_mov_b32 s51, 2752512
  buffer_load_dwordx4 v71, s[12:15], s51 offen lds
  s_add_u32 m0, s42, 11264
  s_mov_b32 s51, 2818048
  buffer_load_dwordx4 v71, s[12:15], s51 offen lds
  s_waitcnt vmcnt(28)
  ds_read_b64_tr_b16 a[24:25], v15 offset:14336
  ds_read_b64_tr_b16 a[26:27], v15 offset:14848
  ds_read_b64_tr_b16 a[28:29], v15 offset:14400
  ds_read_b64_tr_b16 a[30:31], v15 offset:14912
  s_waitcnt lgkmcnt(4)
  s_add_u32 m0, s42, 12288
  s_mov_b32 s51, 2883584
  buffer_load_dwordx4 v71, s[12:15], s51 offen lds
  s_add_u32 m0, s42, 13312
  s_mov_b32 s51, 2949120
  buffer_load_dwordx4 v71, s[12:15], s51 offen lds
  s_waitcnt vmcnt(28)
  ds_read_b64_tr_b16 a[32:33], v15 offset:16384
  ds_read_b64_tr_b16 a[34:35], v15 offset:16896
  ds_read_b64_tr_b16 a[36:37], v15 offset:16448
  ds_read_b64_tr_b16 a[38:39], v15 offset:16960
  s_waitcnt lgkmcnt(4)
  s_add_u32 m0, s42, 14336
  s_mov_b32 s51, 3014656
  buffer_load_dwordx4 v71, s[12:15], s51 offen lds
  s_add_u32 m0, s42, 15360
  s_mov_b32 s51, 3080192
  buffer_load_dwordx4 v71, s[12:15], s51 offen lds
  s_waitcnt vmcnt(28)
  ds_read_b64_tr_b16 a[40:41], v15 offset:18432
  ds_read_b64_tr_b16 a[42:43], v15 offset:18944
  ds_read_b64_tr_b16 a[44:45], v15 offset:18496
  ds_read_b64_tr_b16 a[46:47], v15 offset:19008
  s_waitcnt lgkmcnt(4)
  s_add_u32 m0, s42, 16384
  s_mov_b32 s51, 3145728
  buffer_load_dwordx4 v71, s[12:15], s51 offen lds
  s_add_u32 m0, s42, 17408
  s_mov_b32 s51, 3211264
  buffer_load_dwordx4 v71, s[12:15], s51 offen lds
  s_waitcnt vmcnt(28)
  ds_read_b64_tr_b16 a[48:49], v15 offset:20480
  ds_read_b64_tr_b16 a[50:51], v15 offset:20992
  ds_read_b64_tr_b16 a[52:53], v15 offset:20544
  ds_read_b64_tr_b16 a[54:55], v15 offset:21056
  s_waitcnt lgkmcnt(4)
  s_add_u32 m0, s42, 18432
  s_mov_b32 s51, 3276800
  buffer_load_dwordx4 v71, s[12:15], s51 offen lds
  s_add_u32 m0, s42, 19456
  s_mov_b32 s51, 3342336
  buffer_load_dwordx4 v71, s[12:15], s51 offen lds
  s_waitcnt vmcnt(28)
  ds_read_b64_tr_b16 a[56:57], v15 offset:22528
  ds_read_b64_tr_b16 a[58:59], v15 offset:23040
  ds_read_b64_tr_b16 a[60:61], v15 offset:22592
  ds_read_b64_tr_b16 a[62:63], v15 offset:23104
  s_waitcnt lgkmcnt(4)
  s_add_u32 m0, s42, 20480
  s_mov_b32 s51, 3407872
  buffer_load_dwordx4 v71, s[12:15], s51 offen lds
  s_add_u32 m0, s42, 21504
  s_mov_b32 s51, 3473408
  buffer_load_dwordx4 v71, s[12:15], s51 offen lds
  s_waitcnt vmcnt(28)
  ds_read_b64_tr_b16 a[64:65], v15 offset:24576
  ds_read_b64_tr_b16 a[66:67], v15 offset:25088
  ds_read_b64_tr_b16 a[68:69], v15 offset:24640
  ds_read_b64_tr_b16 a[70:71], v15 offset:25152
  s_waitcnt lgkmcnt(4)
  s_add_u32 m0, s42, 22528
  s_mov_b32 s51, 3538944
  buffer_load_dwordx4 v71, s[12:15], s51 offen lds
  s_add_u32 m0, s42, 23552
  s_mov_b32 s51, 3604480
  buffer_load_dwordx4 v71, s[12:15], s51 offen lds
  s_waitcnt vmcnt(28)
  ds_read_b64_tr_b16 a[72:73], v15 offset:26624
  ds_read_b64_tr_b16 a[74:75], v15 offset:27136
  ds_read_b64_tr_b16 a[76:77], v15 offset:26688
  ds_read_b64_tr_b16 a[78:79], v15 offset:27200
  s_waitcnt lgkmcnt(4)
  s_add_u32 m0, s42, 24576
  s_mov_b32 s51, 3670016
  buffer_load_dwordx4 v71, s[12:15], s51 offen lds
  s_add_u32 m0, s42, 25600
  s_mov_b32 s51, 3735552
  buffer_load_dwordx4 v71, s[12:15], s51 offen lds
  s_waitcnt vmcnt(28)
  ds_read_b64_tr_b16 a[80:81], v15 offset:28672
  ds_read_b64_tr_b16 a[82:83], v15 offset:29184
  ds_read_b64_tr_b16 a[84:85], v15 offset:28736
  ds_read_b64_tr_b16 a[86:87], v15 offset:29248
  s_waitcnt lgkmcnt(4)
  s_add_u32 m0, s42, 26624
  s_mov_b32 s51, 3801088
  buffer_load_dwordx4 v71, s[12:15], s51 offen lds
  s_add_u32 m0, s42, 27648
  s_mov_b32 s51, 3866624
  buffer_load_dwordx4 v71, s[12:15], s51 offen lds
  s_waitcnt vmcnt(28)
  ds_read_b64_tr_b16 a[88:89], v15 offset:30720
  ds_read_b64_tr_b16 a[90:91], v15 offset:31232
  ds_read_b64_tr_b16 a[92:93], v15 offset:30784
  ds_read_b64_tr_b16 a[94:95], v15 offset:31296
  s_waitcnt lgkmcnt(4)
  s_add_u32 m0, s42, 28672
  s_mov_b32 s51, 3932160
  buffer_load_dwordx4 v71, s[12:15], s51 offen lds
  s_add_u32 m0, s42, 29696
  s_mov_b32 s51, 3997696
  buffer_load_dwordx4 v71, s[12:15], s51 offen lds
  s_waitcnt vmcnt(28)
  ds_read_b64_tr_b16 a[96:97], v15 offset:0
  ds_read_b64_tr_b16 a[98:99], v15 offset:512
  ds_read_b64_tr_b16 a[100:101], v15 offset:64
  ds_read_b64_tr_b16 a[102:103], v15 offset:576
  s_waitcnt lgkmcnt(4)
  s_add_u32 m0, s42, 30720
  s_mov_b32 s51, 4063232
  buffer_load_dwordx4 v71, s[12:15], s51 offen lds
  s_add_u32 m0, s42, 31744
  s_mov_b32 s51, 4128768
  buffer_load_dwordx4 v71, s[12:15], s51 offen lds
  s_waitcnt vmcnt(28)
  ds_read_b64_tr_b16 a[104:105], v15 offset:2048
  ds_read_b64_tr_b16 a[106:107], v15 offset:2560
  ds_read_b64_tr_b16 a[108:109], v15 offset:2112
  ds_read_b64_tr_b16 a[110:111], v15 offset:2624
  s_waitcnt lgkmcnt(4)
  s_add_u32 m0, s42, 0
  s_mov_b32 s51, 4194304
  buffer_load_dwordx4 v71, s[12:15], s51 offen lds
  s_add_u32 m0, s42, 1024
  s_mov_b32 s51, 4259840
  buffer_load_dwordx4 v71, s[12:15], s51 offen lds
  s_waitcnt vmcnt(28)
  ds_read_b64_tr_b16 a[112:113], v15 offset:4096
  ds_read_b64_tr_b16 a[114:115], v15 offset:4608
  ds_read_b64_tr_b16 a[116:117], v15 offset:4160
  ds_read_b64_tr_b16 a[118:119], v15 offset:4672
  s_waitcnt lgkmcnt(4)
  s_add_u32 m0, s42, 2048
  s_mov_b32 s51, 4325376
  buffer_load_dwordx4 v71, s[12:15], s51 offen lds
  s_add_u32 m0, s42, 3072
  s_mov_b32 s51, 4390912
  buffer_load_dwordx4 v71, s[12:15], s51 offen lds
  s_waitcnt vmcnt(28)
  ds_read_b64_tr_b16 a[120:121], v15 offset:6144
  ds_read_b64_tr_b16 a[122:123], v15 offset:6656
  ds_read_b64_tr_b16 a[124:125], v15 offset:6208
  ds_read_b64_tr_b16 a[126:127], v15 offset:6720
  s_waitcnt lgkmcnt(4)
  s_add_u32 m0, s42, 4096
  s_mov_b32 s51, 4456448
  buffer_load_dwordx4 v71, s[12:15], s51 offen lds
  s_add_u32 m0, s42, 5120
  s_mov_b32 s51, 4521984
  buffer_load_dwordx4 v71, s[12:15], s51 offen lds
  s_waitcnt vmcnt(28)
  ds_read_b64_tr_b16 a[128:129], v15 offset:8192
  ds_read_b64_tr_b16 a[130:131], v15 offset:8704
  ds_read_b64_tr_b16 a[132:133], v15 offset:8256
  ds_read_b64_tr_b16 a[134:135], v15 offset:8768
  s_waitcnt lgkmcnt(4)
  s_add_u32 m0, s42, 6144
  s_mov_b32 s51, 4587520
  buffer_load_dwordx4 v71, s[12:15], s51 offen lds
  s_add_u32 m0, s42, 7168
  s_mov_b32 s51, 4653056
  buffer_load_dwordx4 v71, s[12:15], s51 offen lds
  s_waitcnt vmcnt(28)
  ds_read_b64_tr_b16 a[136:137], v15 offset:10240
  ds_read_b64_tr_b16 a[138:139], v15 offset:10752
  ds_read_b64_tr_b16 a[140:141], v15 offset:10304
  ds_read_b64_tr_b16 a[142:143], v15 offset:10816
  s_waitcnt vmcnt(26)
  ds_read_b64_tr_b16 a[144:145], v15 offset:12288
  ds_read_b64_tr_b16 a[146:147], v15 offset:12800
  ds_read_b64_tr_b16 a[148:149], v15 offset:12352
  ds_read_b64_tr_b16 a[150:151], v15 offset:12864
  s_waitcnt vmcnt(24)
  ds_read_b64_tr_b16 a[152:153], v15 offset:14336
  ds_read_b64_tr_b16 a[154:155], v15 offset:14848
  ds_read_b64_tr_b16 a[156:157], v15 offset:14400
  ds_read_b64_tr_b16 a[158:159], v15 offset:14912
  s_waitcnt vmcnt(22)
  ds_read_b64_tr_b16 a[160:161], v15 offset:16384
  ds_read_b64_tr_b16 a[162:163], v15 offset:16896
  ds_read_b64_tr_b16 a[164:165], v15 offset:16448
  ds_read_b64_tr_b16 a[166:167], v15 offset:16960
  s_waitcnt vmcnt(20)
  ds_read_b64_tr_b16 a[168:169], v15 offset:18432
  ds_read_b64_tr_b16 a[170:171], v15 offset:18944
  ds_read_b64_tr_b16 a[172:173], v15 offset:18496
  ds_read_b64_tr_b16 a[174:175], v15 offset:19008
  s_waitcnt vmcnt(18)
  ds_read_b64_tr_b16 a[176:177], v15 offset:20480
  ds_read_b64_tr_b16 a[178:179], v15 offset:20992
  ds_read_b64_tr_b16 a[180:181], v15 offset:20544
  ds_read_b64_tr_b16 a[182:183], v15 offset:21056
  s_waitcnt vmcnt(16)
  ds_read_b64_tr_b16 a[184:185], v15 offset:22528
  ds_read_b64_tr_b16 a[186:187], v15 offset:23040
  ds_read_b64_tr_b16 a[188:189], v15 offset:22592
  ds_read_b64_tr_b16 a[190:191], v15 offset:23104
  s_waitcnt vmcnt(14)
  ds_read_b64_tr_b16 a[192:193], v15 offset:24576
  ds_read_b64_tr_b16 a[194:195], v15 offset:25088
  ds_read_b64_tr_b16 a[196:197], v15 offset:24640
  ds_read_b64_tr_b16 a[198:199], v15 offset:25152
  s_waitcnt vmcnt(12)
  ds_read_b64_tr_b16 a[200:201], v15 offset:26624
  ds_read_b64_tr_b16 a[202:203], v15 offset:27136
  ds_read_b64_tr_b16 a[204:205], v15 offset:26688
  ds_read_b64_tr_b16 a[206:207], v15 offset:27200
  s_waitcnt vmcnt(10)
  ds_read_b64_tr_b16 a[208:209], v15 offset:28672
  ds_read_b64_tr_b16 a[210:211], v15 offset:29184
  ds_read_b64_tr_b16 a[212:213], v15 offset:28736
  ds_read_b64_tr_b16 a[214:215], v15 offset:29248
  s_waitcnt vmcnt(8)
  ds_read_b64_tr_b16 a[216:217], v15 offset:30720
  ds_read_b64_tr_b16 a[218:219], v15 offset:31232
  ds_read_b64_tr_b16 a[220:221], v15 offset:30784
  ds_read_b64_tr_b16 a[222:223], v15 offset:31296
  s_waitcnt vmcnt(6)
  ds_read_b64_tr_b16 a[224:225], v15 offset:0
  ds_read_b64_tr_b16 a[226:227], v15 offset:512
  ds_read_b64_tr_b16 a[228:229], v15 offset:64
  ds_read_b64_tr_b16 a[230:231], v15 offset:576
  s_waitcnt vmcnt(4)
  ds_read_b64_tr_b16 a[232:233], v15 offset:2048
  ds_read_b64_tr_b16 a[234:235], v15 offset:2560
  ds_read_b64_tr_b16 a[236:237], v15 offset:2112
  ds_read_b64_tr_b16 a[238:239], v15 offset:2624
  s_waitcnt vmcnt(2)
  ds_read_b64_tr_b16 a[240:241], v15 offset:4096
  ds_read_b64_tr_b16 a[242:243], v15 offset:4608
  ds_read_b64_tr_b16 a[244:245], v15 offset:4160
  ds_read_b64_tr_b16 a[246:247], v15 offset:4672
  s_waitcnt vmcnt(0)
  ds_read_b64_tr_b16 a[248:249], v15 offset:6144
  ds_read_b64_tr_b16 a[250:251], v15 offset:6656
  ds_read_b64_tr_b16 a[252:253], v15 offset:6208
  ds_read_b64_tr_b16 a[254:255], v15 offset:6720
  s_waitcnt lgkmcnt(0)
  s_waitcnt vmcnt(0)
  s_barrier
  s_cmp_lg_u32 s33, 0
  s_cbranch_scc1 L_meet_3
  v_mov_b32 v64, 1
  s_mov_b64 exec, 1
  buffer_atomic_add v64, off, s[8:11], 0 offset:16 sc0
  s_waitcnt vmcnt(0)
  v_readfirstlane_b32 s51, v64
  v_mov_b32 v64, 1
  s_cmp_lg_u32 s51, 47
  s_cbranch_scc1 L_cnt_4
  buffer_store_dword v64, off, s[8:11], 0 offset:136 sc1
L_cnt_4:
  s_mov_b64 exec, -1
L_pw_5:
  buffer_load_dword v64, off, s[8:11], 0 offset:4 sc1
  s_add_u32 s50, s50, 1
  s_cmp_ge_u32 s50, 262144
  s_waitcnt vmcnt(0)
  s_cbranch_scc1 L_pw_5_x
  v_cmp_ge_u32 vcc, 9, v64
  s_nop 0
  s_cbranch_vccnz L_pw_5
L_pw_5_x:
L_pw_6:
  buffer_load_dword v64, off, s[8:11], 0 offset:132 sc1
  s_add_u32 s50, s50, 1
  s_cmp_ge_u32 s50, 262144
  s_waitcnt vmcnt(0)
  s_cbranch_scc1 L_pw_6_x
  v_cmp_ge_u32 vcc, 0, v64
  s_nop 0
  s_cbranch_vccnz L_pw_6
L_pw_6_x:
L_meet_3:
  s_barrier
  s_mul_i32 s42, s33, 9216
  s_mov_b32 s41, 1048576
  s_mov_b32 m0, s42
  s_nop 0
  buffer_load_dwordx4 v1, s[4:7], s41 offen sc1 lds
  s_add_u32 m0, s42, 1024
  s_nop 0
  buffer_load_dwordx4 v2, s[4:7], s41 offen sc1 lds
  s_add_u32 m0, s42, 2048
  s_nop 0
  buffer_load_dwordx4 v3, s[4:7], s41 offen sc1 lds
  s_add_u32 m0, s42, 3072
  s_nop 0
  buffer_load_dwordx4 v4, s[4:7], s41 offen sc1 lds
  s_add_u32 m0, s42, 4096
  s_nop 0
  buffer_load_dwordx4 v5, s[4:7], s41 offen sc1 lds
  s_add_u32 m0, s42, 5120
  s_nop 0
  buffer_load_dwordx4 v6, s[4:7], s41 offen sc1 lds
  s_add_u32 m0, s42, 6144
  s_nop 0
  buffer_load_dwordx4 v7, s[4:7], s41 offen sc1 lds
  s_add_u32 m0, s42, 7168
  s_nop 0
  buffer_load_dwordx4 v8, s[4:7], s41 offen sc1 lds
  s_add_u32 m0, s42, 8192
  s_nop 0
  buffer_load_dwordx4 v9, s[4:7], s41 offen sc1 lds
  s_mov_b32 s40, 0
  s_lshl_b32 s43, s32, 7
  s_lshl_b32 s34, s33, 2
  s_add_u32 s43, s43, s34
  s_add_u32 s43, s43, 0
  v_mov_b32 v72, v14
  v_mov_b32 v14, 0x80000000
  s_sub_u32 s45, s45, 262144
  s_waitcnt vmcnt(0)
  s_cmp_eq_u32 s44, 1
  s_cbranch_scc1 L_proj_lv
L_proj_lk:
  s_waitcnt vmcnt(1)
  s_barrier
  ds_read_b128 v[48:51], v10 offset:0
  ds_read_b128 v[52:55], v11 offset:0
  ds_read_b128 v[56:59], v12 offset:0
  s_cmp_lt_u32 s40, 63
  s_cselect_b32 s34, 36864, 0
  s_add_u32 s41, s41, s34
  s_xor_b32 s42, s42, 0x10000
  s_waitcnt lgkmcnt(2)
  v_mfma_f32_32x32x16_bf16 v[16:31], v[224:227], v[48:51], 0
  ds_read_b128 v[60:63], v13 offset:0
  v_mfma_f32_32x32x16_bf16 v[32:47], v[228:231], v[48:51], 0
  s_waitcnt lgkmcnt(2)
  v_mfma_f32_32x32x16_bf16 v[16:31], v[232:235], v[52:55], v[16:31]
  ds_read_b128 v[48:51], v10 offset:128
  v_mfma_f32_32x32x16_bf16 v[32:47], v[236:239], v[52:55], v[32:47]
  v_cvt_pk_bf16_f32 v80, v80, v81
  v_cvt_pk_bf16_f32 v81, v82, v83
  v_cvt_pk_bf16_f32 v82, v84, v85
  v_cvt_pk_bf16_f32 v83, v86, v87
  buffer_store_dwordx4 v[80:83], v14, s[4:7], s45 offen offset:0 sc1
  s_waitcnt lgkmcnt(2)
  v_mfma_f32_32x32x16_bf16 v[16:31], v[240:243], v[56:59], v[16:31]
  ds_read_b128 v[52:55], v11 offset:128
  v_mfma_f32_32x32x16_bf16 v[32:47], v[244:247], v[56:59], v[32:47]
  v_cvt_pk_bf16_f32 v84, v88, v89
  v_cvt_pk_bf16_f32 v85, v90, v91
  v_cvt_pk_bf16_f32 v86, v92, v93
  v_cvt_pk_bf16_f32 v87, v94, v95
  buffer_store_dwordx4 v[84:87], v14, s[4:7], s45 offen offset:512 sc1
  s_waitcnt lgkmcnt(2)
  v_mfma_f32_32x32x16_bf16 v[16:31], v[248:251], v[60:63], v[16:31]
  ds_read_b128 v[56:59], v12 offset:128
  v_mfma_f32_32x32x16_bf16 v[32:47], v[252:255], v[60:63], v[32:47]
  v_cvt_pk_bf16_f32 v96, v96, v97
  v_cvt_pk_bf16_f32 v97, v98, v99
  v_cvt_pk_bf16_f32 v98, v100, v101
  v_cvt_pk_bf16_f32 v99, v102, v103
  buffer_store_dwordx4 v[96:99], v14, s[4:7], s45 offen offset:1024 sc1
  s_waitcnt lgkmcnt(2)
  v_mfma_f32_32x32x16_bf16 v[16:31], a[0:3], v[48:51], v[16:31]
  ds_read_b128 v[60:63], v13 offset:128
  v_mfma_f32_32x32x16_bf16 v[32:47], a[4:7], v[48:51], v[32:47]
  v_cvt_pk_bf16_f32 v100, v104, v105
  v_cvt_pk_bf16_f32 v101, v106, v107
  v_cvt_pk_bf16_f32 v102, v108, v109
  v_cvt_pk_bf16_f32 v103, v110, v111
  buffer_store_dwordx4 v[100:103], v14, s[4:7], s45 offen offset:1536 sc1
  s_waitcnt lgkmcnt(2)
  v_mfma_f32_32x32x16_bf16 v[16:31], a[8:11], v[52:55], v[16:31]
  ds_read_b128 v[48:51], v10 offset:256
  v_mfma_f32_32x32x16_bf16 v[32:47], a[12:15], v[52:55], v[32:47]
  s_add_u32 m0, s42, 0
  s_nop 0
  buffer_load_dwordx4 v1, s[4:7], s41 offen sc1 lds
  s_waitcnt lgkmcnt(2)
  v_mfma_f32_32x32x16_bf16 v[16:31], a[16:19], v[56:59], v[16:31]
  ds_read_b128 v[52:55], v11 offset:256
  v_mfma_f32_32x32x16_bf16 v[32:47], a[20:23], v[56:59], v[32:47]
  s_add_u32 m0, s42, 1024
  s_nop 0
  buffer_load_dwordx4 v2, s[4:7], s41 offen sc1 lds
  s_waitcnt lgkmcnt(2)
  v_mfma_f32_32x32x16_bf16 v[16:31], a[24:27], v[60:63], v[16:31]
  ds_read_b128 v[56:59], v12 offset:256
  v_mfma_f32_32x32x16_bf16 v[32:47], a[28:31], v[60:63], v[32:47]
  s_add_u32 m0, s42, 2048
  s_nop 0
  buffer_load_dwordx4 v3, s[4:7], s41 offen sc1 lds
  s_waitcnt lgkmcnt(2)
  v_mfma_f32_32x32x16_bf16 v[16:31], a[32:35], v[48:51], v[16:31]
  ds_read_b128 v[60:63], v13 offset:256
  v_mfma_f32_32x32x16_bf16 v[32:47], a[36:39], v[48:51], v[32:47]
  s_add_u32 m0, s42, 3072
  s_nop 0
  buffer_load_dwordx4 v4, s[4:7], s41 offen sc1 lds
  s_waitcnt lgkmcnt(2)
  v_mfma_f32_32x32x16_bf16 v[16:31], a[40:43], v[52:55], v[16:31]
  ds_read_b128 v[48:51], v10 offset:384
  v_mfma_f32_32x32x16_bf16 v[32:47], a[44:47], v[52:55], v[32:47]
  s_add_u32 m0, s42, 4096
  s_nop 0
  buffer_load_dwordx4 v5, s[4:7], s41 offen sc1 lds
  s_waitcnt lgkmcnt(2)
  v_mfma_f32_32x32x16_bf16 v[16:31], a[48:51], v[56:59], v[16:31]
  ds_read_b128 v[52:55], v11 offset:384
  v_mfma_f32_32x32x16_bf16 v[32:47], a[52:55], v[56:59], v[32:47]
  s_add_u32 m0, s42, 5120
  s_nop 0
  buffer_load_dwordx4 v6, s[4:7], s41 offen sc1 lds
  s_waitcnt lgkmcnt(2)
  v_mfma_f32_32x32x16_bf16 v[16:31], a[56:59], v[60:63], v[16:31]
  ds_read_b128 v[56:59], v12 offset:384
  v_mfma_f32_32x32x16_bf16 v[32:47], a[60:63], v[60:63], v[32:47]
  s_add_u32 m0, s42, 6144
  s_nop 0
  buffer_load_dwordx4 v7, s[4:7], s41 offen sc1 lds
  s_waitcnt lgkmcnt(2)
  v_mfma_f32_32x32x16_bf16 v[16:31], a[64:67], v[48:51], v[16:31]
  ds_read_b128 v[60:63], v13 offset:384
  v_mfma_f32_32x32x16_bf16 v[32:47], a[68:71], v[48:51], v[32:47]
  s_add_u32 m0, s42, 7168
  s_nop 0
  buffer_load_dwordx4 v8, s[4:7], s41 offen sc1 lds
  s_waitcnt lgkmcnt(2)
  v_mfma_f32_32x32x16_bf16 v[16:31], a[72:75], v[52:55], v[16:31]
  ds_read_b128 v[48:51], v10 offset:512
  v_mfma_f32_32x32x16_bf16 v[32:47], a[76:79], v[52:55], v[32:47]
  s_add_u32 m0, s42, 8192
  s_nop 0
  buffer_load_dwordx4 v9, s[4:7], s41 offen sc1 lds
  s_waitcnt lgkmcnt(2)
  v_mfma_f32_32x32x16_bf16 v[16:31], a[80:83], v[56:59], v[16:31]
  ds_read_b128 v[52:55], v11 offset:512
  v_mfma_f32_32x32x16_bf16 v[32:47], a[84:87], v[56:59], v[32:47]
  s_waitcnt lgkmcnt(2)
  v_mfma_f32_32x32x16_bf16 v[16:31], a[88:91], v[60:63], v[16:31]
  ds_read_b128 v[56:59], v12 offset:512
  v_mfma_f32_32x32x16_bf16 v[32:47], a[92:95], v[60:63], v[32:47]
  s_waitcnt lgkmcnt(2)
  v_mfma_f32_32x32x16_bf16 v[16:31], a[96:99], v[48:51], v[16:31]
  ds_read_b128 v[60:63], v13 offset:512
  v_mfma_f32_32x32x16_bf16 v[32:47], a[100:103], v[48:51], v[32:47]
  s_waitcnt lgkmcnt(2)
  v_mfma_f32_32x32x16_bf16 v[16:31], a[104:107], v[52:55], v[16:31]
  ds_read_b128 v[48:51], v10 offset:640
  v_mfma_f32_32x32x16_bf16 v[32:47], a[108:111], v[52:55], v[32:47]
  s_waitcnt lgkmcnt(2)
  v_mfma_f32_32x32x16_bf16 v[16:31], a[112:115], v[56:59], v[16:31]
  ds_read_b128 v[52:55], v11 offset:640
  v_mfma_f32_32x32x16_bf16 v[32:47], a[116:119], v[56:59], v[32:47]
  s_waitcnt lgkmcnt(2)
  v_mfma_f32_32x32x16_bf16 v[16:31], a[120:123], v[60:63], v[16:31]
  ds_read_b128 v[56:59], v12 offset:640
  v_mfma_f32_32x32x16_bf16 v[32:47], a[124:127], v[60:63], v[32:47]
  s_waitcnt lgkmcnt(2)
  v_mfma_f32_32x32x16_bf16 v[16:31], a[128:131], v[48:51], v[16:31]
  ds_read_b128 v[60:63], v13 offset:640
  v_mfma_f32_32x32x16_bf16 v[32:47], a[132:135], v[48:51], v[32:47]
  s_waitcnt lgkmcnt(2)
  v_mfma_f32_32x32x16_bf16 v[16:31], a[136:139], v[52:55], v[16:31]
  ds_read_b128 v[48:51], v10 offset:768
  v_mfma_f32_32x32x16_bf16 v[32:47], a[140:143], v[52:55], v[32:47]
  s_waitcnt lgkmcnt(2)
  v_mfma_f32_32x32x16_bf16 v[16:31], a[144:147], v[56:59], v[16:31]
  ds_read_b128 v[52:55], v11 offset:768
  v_mfma_f32_32x32x16_bf16 v[32:47], a[148:151], v[56:59], v[32:47]
  s_waitcnt vmcnt(9)
  v_mov_b32 v70, s40
  buffer_store_dword v70, off, s[4:7], s43 sc1
  s_waitcnt lgkmcnt(2)
  v_mfma_f32_32x32x16_bf16 v[16:31], a[152:155], v[60:63], v[16:31]
  ds_read_b128 v[56:59], v12 offset:768
  v_mfma_f32_32x32x16_bf16 v[32:47], a[156:159], v[60:63], v[32:47]
  s_waitcnt lgkmcnt(2)
  v_mfma_f32_32x32x16_bf16 v[16:31], a[160:163], v[48:51], v[16:31]
  ds_read_b128 v[60:63], v13 offset:768
  v_mfma_f32_32x32x16_bf16 v[32:47], a[164:167], v[48:51], v[32:47]
  s_waitcnt lgkmcnt(2)
  v_mfma_f32_32x32x16_bf16 v[16:31], a[168:171], v[52:55], v[16:31]
  ds_read_b128 v[48:51], v10 offset:896
  v_mfma_f32_32x32x16_bf16 v[32:47], a[172:175], v[52:55], v[32:47]
  s_waitcnt lgkmcnt(2)
  v_mfma_f32_32x32x16_bf16 v[16:31], a[176:179], v[56:59], v[16:31]
  ds_read_b128 v[52:55], v11 offset:896
  v_mfma_f32_32x32x16_bf16 v[32:47], a[180:183], v[56:59], v[32:47]
  s_waitcnt lgkmcnt(2)
  v_mfma_f32_32x32x16_bf16 v[16:31], a[184:187], v[60:63], v[16:31]
  ds_read_b128 v[56:59], v12 offset:896
  v_mfma_f32_32x32x16_bf16 v[32:47], a[188:191], v[60:63], v[32:47]
  s_waitcnt lgkmcnt(2)
  v_mfma_f32_32x32x16_bf16 v[16:31], a[192:195], v[48:51], v[16:31]
  ds_read_b128 v[60:63], v13 offset:896
  v_mfma_f32_32x32x16_bf16 v[32:47], a[196:199], v[48:51], v[32:47]
  s_waitcnt lgkmcnt(2)
  v_mfma_f32_32x32x16_bf16 v[16:31], a[200:203], v[52:55], v[16:31]
  ds_read_b128 v[48:51], v10 offset:1024
  v_mfma_f32_32x32x16_bf16 v[32:47], a[204:207], v[52:55], v[32:47]
  s_waitcnt lgkmcnt(2)
  v_mfma_f32_32x32x16_bf16 v[16:31], a[208:211], v[56:59], v[16:31]
  ds_read_b128 v[52:55], v11 offset:1024
  v_mfma_f32_32x32x16_bf16 v[32:47], a[212:215], v[56:59], v[32:47]
  s_waitcnt lgkmcnt(2)
  v_mfma_f32_32x32x16_bf16 v[16:31], a[216:219], v[60:63], v[16:31]
  ds_read_b128 v[56:59], v12 offset:1024
  v_mfma_f32_32x32x16_bf16 v[32:47], a[220:223], v[60:63], v[32:47]
  s_waitcnt lgkmcnt(2)
  v_mfma_f32_32x32x16_bf16 v[16:31], a[224:227], v[48:51], v[16:31]
  ds_read_b128 v[60:63], v13 offset:1024
  v_mfma_f32_32x32x16_bf16 v[32:47], a[228:231], v[48:51], v[32:47]
  s_waitcnt lgkmcnt(2)
  v_mfma_f32_32x32x16_bf16 v[16:31], a[232:235], v[52:55], v[16:31]
  v_mfma_f32_32x32x16_bf16 v[32:47], a[236:239], v[52:55], v[32:47]
  v_xor_b32 v10, 0x10000, v10
  v_xor_b32 v11, 0x10000, v11
  v_xor_b32 v12, 0x10000, v12
  v_xor_b32 v13, 0x10000, v13
  s_waitcnt lgkmcnt(1)
  v_mfma_f32_32x32x16_bf16 v[16:31], a[240:243], v[56:59], v[16:31]
  v_mfma_f32_32x32x16_bf16 v[32:47], a[244:247], v[56:59], v[32:47]
  v_mov_b32 v14, v72
  s_add_u32 s45, s45, 262144
  s_add_u32 s40, s40, 1
  s_waitcnt lgkmcnt(0)
  v_mfma_f32_32x32x16_bf16 v[16:31], a[248:251], v[60:63], v[16:31]
  v_mfma_f32_32x32x16_bf16 v[32:47], a[252:255], v[60:63], v[32:47]
  s_waitcnt vmcnt(1)
  s_barrier
  ds_read_b128 v[48:51], v10 offset:0
  ds_read_b128 v[52:55], v11 offset:0
  ds_read_b128 v[56:59], v12 offset:0
  s_cmp_lt_u32 s40, 63
  s_cselect_b32 s34, 36864, 0
  s_add_u32 s41, s41, s34
  s_xor_b32 s42, s42, 0x10000
  s_waitcnt lgkmcnt(2)
  v_mfma_f32_32x32x16_bf16 v[80:95], v[224:227], v[48:51], 0
  ds_read_b128 v[60:63], v13 offset:0
  v_mfma_f32_32x32x16_bf16 v[96:111], v[228:231], v[48:51], 0
  s_waitcnt lgkmcnt(2)
  v_mfma_f32_32x32x16_bf16 v[80:95], v[232:235], v[52:55], v[80:95]
  ds_read_b128 v[48:51], v10 offset:128
  v_mfma_f32_32x32x16_bf16 v[96:111], v[236:239], v[52:55], v[96:111]
  v_cvt_pk_bf16_f32 v16, v16, v17
  v_cvt_pk_bf16_f32 v17, v18, v19
  v_cvt_pk_bf16_f32 v18, v20, v21
  v_cvt_pk_bf16_f32 v19, v22, v23
  buffer_store_dwordx4 v[16:19], v14, s[4:7], s45 offen offset:0 sc1
  s_waitcnt lgkmcnt(2)
  v_mfma_f32_32x32x16_bf16 v[80:95], v[240:243], v[56:59], v[80:95]
  ds_read_b128 v[52:55], v11 offset:128
  v_mfma_f32_32x32x16_bf16 v[96:111], v[244:247], v[56:59], v[96:111]
  v_cvt_pk_bf16_f32 v20, v24, v25
  v_cvt_pk_bf16_f32 v21, v26, v27
  v_cvt_pk_bf16_f32 v22, v28, v29
  v_cvt_pk_bf16_f32 v23, v30, v31
  buffer_store_dwordx4 v[20:23], v14, s[4:7], s45 offen offset:512 sc1
  s_waitcnt lgkmcnt(2)
  v_mfma_f32_32x32x16_bf16 v[80:95], v[248:251], v[60:63], v[80:95]
  ds_read_b128 v[56:59], v12 offset:128
  v_mfma_f32_32x32x16_bf16 v[96:111], v[252:255], v[60:63], v[96:111]
  v_cvt_pk_bf16_f32 v32, v32, v33
  v_cvt_pk_bf16_f32 v33, v34, v35
  v_cvt_pk_bf16_f32 v34, v36, v37
  v_cvt_pk_bf16_f32 v35, v38, v39
  buffer_store_dwordx4 v[32:35], v14, s[4:7], s45 offen offset:1024 sc1
  s_waitcnt lgkmcnt(2)
  v_mfma_f32_32x32x16_bf16 v[80:95], a[0:3], v[48:51], v[80:95]
  ds_read_b128 v[60:63], v13 offset:128
  v_mfma_f32_32x32x16_bf16 v[96:111], a[4:7], v[48:51], v[96:111]
  v_cvt_pk_bf16_f32 v36, v40, v41
  v_cvt_pk_bf16_f32 v37, v42, v43
  v_cvt_pk_bf16_f32 v38, v44, v45
  v_cvt_pk_bf16_f32 v39, v46, v47
  buffer_store_dwordx4 v[36:39], v14, s[4:7], s45 offen offset:1536 sc1
  s_waitcnt lgkmcnt(2)
  v_mfma_f32_32x32x16_bf16 v[80:95], a[8:11], v[52:55], v[80:95]
  ds_read_b128 v[48:51], v10 offset:256
  v_mfma_f32_32x32x16_bf16 v[96:111], a[12:15], v[52:55], v[96:111]
  s_add_u32 m0, s42, 0
  s_nop 0
  buffer_load_dwordx4 v1, s[4:7], s41 offen sc1 lds
  s_waitcnt lgkmcnt(2)
  v_mfma_f32_32x32x16_bf16 v[80:95], a[16:19], v[56:59], v[80:95]
  ds_read_b128 v[52:55], v11 offset:256
  v_mfma_f32_32x32x16_bf16 v[96:111], a[20:23], v[56:59], v[96:111]
  s_add_u32 m0, s42, 1024
  s_nop 0
  buffer_load_dwordx4 v2, s[4:7], s41 offen sc1 lds
  s_waitcnt lgkmcnt(2)
  v_mfma_f32_32x32x16_bf16 v[80:95], a[24:27], v[60:63], v[80:95]
  ds_read_b128 v[56:59], v12 offset:256
  v_mfma_f32_32x32x16_bf16 v[96:111], a[28:31], v[60:63], v[96:111]
  s_add_u32 m0, s42, 2048
  s_nop 0
  buffer_load_dwordx4 v3, s[4:7], s41 offen sc1 lds
  s_waitcnt lgkmcnt(2)
  v_mfma_f32_32x32x16_bf16 v[80:95], a[32:35], v[48:51], v[80:95]
  ds_read_b128 v[60:63], v13 offset:256
  v_mfma_f32_32x32x16_bf16 v[96:111], a[36:39], v[48:51], v[96:111]
  s_add_u32 m0, s42, 3072
  s_nop 0
  buffer_load_dwordx4 v4, s[4:7], s41 offen sc1 lds
  s_waitcnt lgkmcnt(2)
  v_mfma_f32_32x32x16_bf16 v[80:95], a[40:43], v[52:55], v[80:95]
  ds_read_b128 v[48:51], v10 offset:384
  v_mfma_f32_32x32x16_bf16 v[96:111], a[44:47], v[52:55], v[96:111]
  s_add_u32 m0, s42, 4096
  s_nop 0
  buffer_load_dwordx4 v5, s[4:7], s41 offen sc1 lds
  s_waitcnt lgkmcnt(2)
  v_mfma_f32_32x32x16_bf16 v[80:95], a[48:51], v[56:59], v[80:95]
  ds_read_b128 v[52:55], v11 offset:384
  v_mfma_f32_32x32x16_bf16 v[96:111], a[52:55], v[56:59], v[96:111]
  s_add_u32 m0, s42, 5120
  s_nop 0
  buffer_load_dwordx4 v6, s[4:7], s41 offen sc1 lds
  s_waitcnt lgkmcnt(2)
  v_mfma_f32_32x32x16_bf16 v[80:95], a[56:59], v[60:63], v[80:95]
  ds_read_b128 v[56:59], v12 offset:384
  v_mfma_f32_32x32x16_bf16 v[96:111], a[60:63], v[60:63], v[96:111]
  s_add_u32 m0, s42, 6144
  s_nop 0
  buffer_load_dwordx4 v7, s[4:7], s41 offen sc1 lds
  s_waitcnt lgkmcnt(2)
  v_mfma_f32_32x32x16_bf16 v[80:95], a[64:67], v[48:51], v[80:95]
  ds_read_b128 v[60:63], v13 offset:384
  v_mfma_f32_32x32x16_bf16 v[96:111], a[68:71], v[48:51], v[96:111]
  s_add_u32 m0, s42, 7168
  s_nop 0
  buffer_load_dwordx4 v8, s[4:7], s41 offen sc1 lds
  s_waitcnt lgkmcnt(2)
  v_mfma_f32_32x32x16_bf16 v[80:95], a[72:75], v[52:55], v[80:95]
  ds_read_b128 v[48:51], v10 offset:512
  v_mfma_f32_32x32x16_bf16 v[96:111], a[76:79], v[52:55], v[96:111]
  s_add_u32 m0, s42, 8192
  s_nop 0
  buffer_load_dwordx4 v9, s[4:7], s41 offen sc1 lds
  s_waitcnt lgkmcnt(2)
  v_mfma_f32_32x32x16_bf16 v[80:95], a[80:83], v[56:59], v[80:95]
  ds_read_b128 v[52:55], v11 offset:512
  v_mfma_f32_32x32x16_bf16 v[96:111], a[84:87], v[56:59], v[96:111]
  s_waitcnt lgkmcnt(2)
  v_mfma_f32_32x32x16_bf16 v[80:95], a[88:91], v[60:63], v[80:95]
  ds_read_b128 v[56:59], v12 offset:512
  v_mfma_f32_32x32x16_bf16 v[96:111], a[92:95], v[60:63], v[96:111]
  s_waitcnt lgkmcnt(2)
  v_mfma_f32_32x32x16_bf16 v[80:95], a[96:99], v[48:51], v[80:95]
  ds_read_b128 v[60:63], v13 offset:512
  v_mfma_f32_32x32x16_bf16 v[96:111], a[100:103], v[48:51], v[96:111]
  s_waitcnt lgkmcnt(2)
  v_mfma_f32_32x32x16_bf16 v[80:95], a[104:107], v[52:55], v[80:95]
  ds_read_b128 v[48:51], v10 offset:640
  v_mfma_f32_32x32x16_bf16 v[96:111], a[108:111], v[52:55], v[96:111]
  s_waitcnt lgkmcnt(2)
  v_mfma_f32_32x32x16_bf16 v[80:95], a[112:115], v[56:59], v[80:95]
  ds_read_b128 v[52:55], v11 offset:640
  v_mfma_f32_32x32x16_bf16 v[96:111], a[116:119], v[56:59], v[96:111]
  s_waitcnt lgkmcnt(2)
  v_mfma_f32_32x32x16_bf16 v[80:95], a[120:123], v[60:63], v[80:95]
  ds_read_b128 v[56:59], v12 offset:640
  v_mfma_f32_32x32x16_bf16 v[96:111], a[124:127], v[60:63], v[96:111]
  s_waitcnt lgkmcnt(2)
  v_mfma_f32_32x32x16_bf16 v[80:95], a[128:131], v[48:51], v[80:95]
  ds_read_b128 v[60:63], v13 offset:640
  v_mfma_f32_32x32x16_bf16 v[96:111], a[132:135], v[48:51], v[96:111]
  s_waitcnt lgkmcnt(2)
  v_mfma_f32_32x32x16_bf16 v[80:95], a[136:139], v[52:55], v[80:95]
  ds_read_b128 v[48:51], v10 offset:768
  v_mfma_f32_32x32x16_bf16 v[96:111], a[140:143], v[52:55], v[96:111]
  s_waitcnt lgkmcnt(2)
  v_mfma_f32_32x32x16_bf16 v[80:95], a[144:147], v[56:59], v[80:95]
  ds_read_b128 v[52:55], v11 offset:768
  v_mfma_f32_32x32x16_bf16 v[96:111], a[148:151], v[56:59], v[96:111]
  s_waitcnt vmcnt(9)
  v_mov_b32 v70, s40
  buffer_store_dword v70, off, s[4:7], s43 sc1
  s_waitcnt lgkmcnt(2)
  v_mfma_f32_32x32x16_bf16 v[80:95], a[152:155], v[60:63], v[80:95]
  ds_read_b128 v[56:59], v12 offset:768
  v_mfma_f32_32x32x16_bf16 v[96:111], a[156:159], v[60:63], v[96:111]
  s_waitcnt lgkmcnt(2)
  v_mfma_f32_32x32x16_bf16 v[80:95], a[160:163], v[48:51], v[80:95]
  ds_read_b128 v[60:63], v13 offset:768
  v_mfma_f32_32x32x16_bf16 v[96:111], a[164:167], v[48:51], v[96:111]
  s_waitcnt lgkmcnt(2)
  v_mfma_f32_32x32x16_bf16 v[80:95], a[168:171], v[52:55], v[80:95]
  ds_read_b128 v[48:51], v10 offset:896
  v_mfma_f32_32x32x16_bf16 v[96:111], a[172:175], v[52:55], v[96:111]
  s_waitcnt lgkmcnt(2)
  v_mfma_f32_32x32x16_bf16 v[80:95], a[176:179], v[56:59], v[80:95]
  ds_read_b128 v[52:55], v11 offset:896
  v_mfma_f32_32x32x16_bf16 v[96:111], a[180:183], v[56:59], v[96:111]
  s_waitcnt lgkmcnt(2)
  v_mfma_f32_32x32x16_bf16 v[80:95], a[184:187], v[60:63], v[80:95]
  ds_read_b128 v[56:59], v12 offset:896
  v_mfma_f32_32x32x16_bf16 v[96:111], a[188:191], v[60:63], v[96:111]
  s_waitcnt lgkmcnt(2)
  v_mfma_f32_32x32x16_bf16 v[80:95], a[192:195], v[48:51], v[80:95]
  ds_read_b128 v[60:63], v13 offset:896
  v_mfma_f32_32x32x16_bf16 v[96:111], a[196:199], v[48:51], v[96:111]
  s_waitcnt lgkmcnt(2)
  v_mfma_f32_32x32x16_bf16 v[80:95], a[200:203], v[52:55], v[80:95]
  ds_read_b128 v[48:51], v10 offset:1024
  v_mfma_f32_32x32x16_bf16 v[96:111], a[204:207], v[52:55], v[96:111]
  s_waitcnt lgkmcnt(2)
  v_mfma_f32_32x32x16_bf16 v[80:95], a[208:211], v[56:59], v[80:95]
  ds_read_b128 v[52:55], v11 offset:1024
  v_mfma_f32_32x32x16_bf16 v[96:111], a[212:215], v[56:59], v[96:111]
  s_waitcnt lgkmcnt(2)
  v_mfma_f32_32x32x16_bf16 v[80:95], a[216:219], v[60:63], v[80:95]
  ds_read_b128 v[56:59], v12 offset:1024
  v_mfma_f32_32x32x16_bf16 v[96:111], a[220:223], v[60:63], v[96:111]
  s_waitcnt lgkmcnt(2)
  v_mfma_f32_32x32x16_bf16 v[80:95], a[224:227], v[48:51], v[80:95]
  ds_read_b128 v[60:63], v13 offset:1024
  v_mfma_f32_32x32x16_bf16 v[96:111], a[228:231], v[48:51], v[96:111]
  s_waitcnt lgkmcnt(2)
  v_mfma_f32_32x32x16_bf16 v[80:95], a[232:235], v[52:55], v[80:95]
  v_mfma_f32_32x32x16_bf16 v[96:111], a[236:239], v[52:55], v[96:111]
  v_xor_b32 v10, 0x10000, v10
  v_xor_b32 v11, 0x10000, v11
  v_xor_b32 v12, 0x10000, v12
  v_xor_b32 v13, 0x10000, v13
  s_waitcnt lgkmcnt(1)
  v_mfma_f32_32x32x16_bf16 v[80:95], a[240:243], v[56:59], v[80:95]
  v_mfma_f32_32x32x16_bf16 v[96:111], a[244:247], v[56:59], v[96:111]
  v_mov_b32 v14, v72
  s_add_u32 s45, s45, 262144
  s_add_u32 s40, s40, 1
  s_waitcnt lgkmcnt(0)
  v_mfma_f32_32x32x16_bf16 v[80:95], a[248:251], v[60:63], v[80:95]
  v_mfma_f32_32x32x16_bf16 v[96:111], a[252:255], v[60:63], v[96:111]
  s_cmp_lt_u32 s40, 64
  s_cbranch_scc1 L_proj_lk
  s_nop 2
  v_cvt_pk_bf16_f32 v80, v80, v81
  v_cvt_pk_bf16_f32 v81, v82, v83
  v_cvt_pk_bf16_f32 v82, v84, v85
  v_cvt_pk_bf16_f32 v83, v86, v87
  buffer_store_dwordx4 v[80:83], v14, s[4:7], s45 offen offset:0 sc1
  v_cvt_pk_bf16_f32 v84, v88, v89
  v_cvt_pk_bf16_f32 v85, v90, v91
  v_cvt_pk_bf16_f32 v86, v92, v93
  v_cvt_pk_bf16_f32 v87, v94, v95
  buffer_store_dwordx4 v[84:87], v14, s[4:7], s45 offen offset:512 sc1
  v_cvt_pk_bf16_f32 v96, v96, v97
  v_cvt_pk_bf16_f32 v97, v98, v99
  v_cvt_pk_bf16_f32 v98, v100, v101
  v_cvt_pk_bf16_f32 v99, v102, v103
  buffer_store_dwordx4 v[96:99], v14, s[4:7], s45 offen offset:1024 sc1
  v_cvt_pk_bf16_f32 v100, v104, v105
  v_cvt_pk_bf16_f32 v101, v106, v107
  v_cvt_pk_bf16_f32 v102, v108, v109
  v_cvt_pk_bf16_f32 v103, v110, v111
  buffer_store_dwordx4 v[100:103], v14, s[4:7], s45 offen offset:1536 sc1
  s_branch L_proj_end
L_proj_lv:
  s_waitcnt vmcnt(1)
  s_barrier
  ds_read_b128 v[48:51], v10 offset:0
  ds_read_b128 v[52:55], v11 offset:0
  ds_read_b128 v[56:59], v12 offset:0
  s_cmp_lt_u32 s40, 63
  s_cselect_b32 s34, 36864, 0
  s_add_u32 s41, s41, s34
  s_xor_b32 s42, s42, 0x10000
  s_waitcnt lgkmcnt(2)
  v_mfma_f32_32x32x16_bf16 v[16:31], v[48:51], v[224:227], 0
  ds_read_b128 v[60:63], v13 offset:0
  v_mfma_f32_32x32x16_bf16 v[32:47], v[48:51], v[228:231], 0
  s_waitcnt lgkmcnt(2)
  v_mfma_f32_32x32x16_bf16 v[16:31], v[52:55], v[232:235], v[16:31]
  ds_read_b128 v[48:51], v10 offset:128
  v_mfma_f32_32x32x16_bf16 v[32:47], v[52:55], v[236:239], v[32:47]
  v_cvt_pk_bf16_f32 v80, v80, v81
  v_cvt_pk_bf16_f32 v81, v82, v83
  v_cvt_pk_bf16_f32 v82, v88, v89
  v_cvt_pk_bf16_f32 v83, v90, v91
  buffer_store_dwordx4 v[80:83], v14, s[4:7], s45 offen offset:0 sc1
  s_waitcnt lgkmcnt(2)
  v_mfma_f32_32x32x16_bf16 v[16:31], v[56:59], v[240:243], v[16:31]
  ds_read_b128 v[52:55], v11 offset:128
  v_mfma_f32_32x32x16_bf16 v[32:47], v[56:59], v[244:247], v[32:47]
  v_cvt_pk_bf16_f32 v84, v84, v85
  v_cvt_pk_bf16_f32 v85, v86, v87
  v_cvt_pk_bf16_f32 v86, v92, v93
  v_cvt_pk_bf16_f32 v87, v94, v95
  buffer_store_dwordx4 v[84:87], v14, s[4:7], s45 offen offset:512 sc1
  s_waitcnt lgkmcnt(2)
  v_mfma_f32_32x32x16_bf16 v[16:31], v[60:63], v[248:251], v[16:31]
  ds_read_b128 v[56:59], v12 offset:128
  v_mfma_f32_32x32x16_bf16 v[32:47], v[60:63], v[252:255], v[32:47]
  v_cvt_pk_bf16_f32 v96, v96, v97
  v_cvt_pk_bf16_f32 v97, v98, v99
  v_cvt_pk_bf16_f32 v98, v104, v105
  v_cvt_pk_bf16_f32 v99, v106, v107
  buffer_store_dwordx4 v[96:99], v14, s[4:7], s45 offen offset:2048 sc1
  s_waitcnt lgkmcnt(2)
  v_mfma_f32_32x32x16_bf16 v[16:31], v[48:51], a[0:3], v[16:31]
  ds_read_b128 v[60:63], v13 offset:128
  v_mfma_f32_32x32x16_bf16 v[32:47], v[48:51], a[4:7], v[32:47]
  v_cvt_pk_bf16_f32 v100, v100, v101
  v_cvt_pk_bf16_f32 v101, v102, v103
  v_cvt_pk_bf16_f32 v102, v108, v109
  v_cvt_pk_bf16_f32 v103, v110, v111
  buffer_store_dwordx4 v[100:103], v14, s[4:7], s45 offen offset:2560 sc1
  s_waitcnt lgkmcnt(2)
  v_mfma_f32_32x32x16_bf16 v[16:31], v[52:55], a[8:11], v[16:31]
  ds_read_b128 v[48:51], v10 offset:256
  v_mfma_f32_32x32x16_bf16 v[32:47], v[52:55], a[12:15], v[32:47]
  s_add_u32 m0, s42, 0
  s_nop 0
  buffer_load_dwordx4 v1, s[4:7], s41 offen sc1 lds
  s_waitcnt lgkmcnt(2)
  v_mfma_f32_32x32x16_bf16 v[16:31], v[56:59], a[16:19], v[16:31]
  ds_read_b128 v[52:55], v11 offset:256
  v_mfma_f32_32x32x16_bf16 v[32:47], v[56:59], a[20:23], v[32:47]
  s_add_u32 m0, s42, 1024
  s_nop 0
  buffer_load_dwordx4 v2, s[4:7], s41 offen sc1 lds
  s_waitcnt lgkmcnt(2)
  v_mfma_f32_32x32x16_bf16 v[16:31], v[60:63], a[24:27], v[16:31]
  ds_read_b128 v[56:59], v12 offset:256
  v_mfma_f32_32x32x16_bf16 v[32:47], v[60:63], a[28:31], v[32:47]
  s_add_u32 m0, s42, 2048
  s_nop 0
  buffer_load_dwordx4 v3, s[4:7], s41 offen sc1 lds
  s_waitcnt lgkmcnt(2)
  v_mfma_f32_32x32x16_bf16 v[16:31], v[48:51], a[32:35], v[16:31]
  ds_read_b128 v[60:63], v13 offset:256
  v_mfma_f32_32x32x16_bf16 v[32:47], v[48:51], a[36:39], v[32:47]
  s_add_u32 m0, s42, 3072
  s_nop 0
  buffer_load_dwordx4 v4, s[4:7], s41 offen sc1 lds
  s_waitcnt lgkmcnt(2)
  v_mfma_f32_32x32x16_bf16 v[16:31], v[52:55], a[40:43], v[16:31]
  ds_read_b128 v[48:51], v10 offset:384
  v_mfma_f32_32x32x16_bf16 v[32:47], v[52:55], a[44:47], v[32:47]
  s_add_u32 m0, s42, 4096
  s_nop 0
  buffer_load_dwordx4 v5, s[4:7], s41 offen sc1 lds
  s_waitcnt lgkmcnt(2)
  v_mfma_f32_32x32x16_bf16 v[16:31], v[56:59], a[48:51], v[16:31]
  ds_read_b128 v[52:55], v11 offset:384
  v_mfma_f32_32x32x16_bf16 v[32:47], v[56:59], a[52:55], v[32:47]
  s_add_u32 m0, s42, 5120
  s_nop 0
  buffer_load_dwordx4 v6, s[4:7], s41 offen sc1 lds
  s_waitcnt lgkmcnt(2)
  v_mfma_f32_32x32x16_bf16 v[16:31], v[60:63], a[56:59], v[16:31]
  ds_read_b128 v[56:59], v12 offset:384
  v_mfma_f32_32x32x16_bf16 v[32:47], v[60:63], a[60:63], v[32:47]
  s_add_u32 m0, s42, 6144
  s_nop 0
  buffer_load_dwordx4 v7, s[4:7], s41 offen sc1 lds
  s_waitcnt lgkmcnt(2)
  v_mfma_f32_32x32x16_bf16 v[16:31], v[48:51], a[64:67], v[16:31]
  ds_read_b128 v[60:63], v13 offset:384
  v_mfma_f32_32x32x16_bf16 v[32:47], v[48:51], a[68:71], v[32:47]
  s_add_u32 m0, s42, 7168
  s_nop 0
  buffer_load_dwordx4 v8, s[4:7], s41 offen sc1 lds
  s_waitcnt lgkmcnt(2)
  v_mfma_f32_32x32x16_bf16 v[16:31], v[52:55], a[72:75], v[16:31]
  ds_read_b128 v[48:51], v10 offset:512
  v_mfma_f32_32x32x16_bf16 v[32:47], v[52:55], a[76:79], v[32:47]
  s_add_u32 m0, s42, 8192
  s_nop 0
  buffer_load_dwordx4 v9, s[4:7], s41 offen sc1 lds
  s_waitcnt lgkmcnt(2)
  v_mfma_f32_32x32x16_bf16 v[16:31], v[56:59], a[80:83], v[16:31]
  ds_read_b128 v[52:55], v11 offset:512
  v_mfma_f32_32x32x16_bf16 v[32:47], v[56:59], a[84:87], v[32:47]
  s_waitcnt lgkmcnt(2)
  v_mfma_f32_32x32x16_bf16 v[16:31], v[60:63], a[88:91], v[16:31]
  ds_read_b128 v[56:59], v12 offset:512
  v_mfma_f32_32x32x16_bf16 v[32:47], v[60:63], a[92:95], v[32:47]
  s_waitcnt lgkmcnt(2)
  v_mfma_f32_32x32x16_bf16 v[16:31], v[48:51], a[96:99], v[16:31]
  ds_read_b128 v[60:63], v13 offset:512
  v_mfma_f32_32x32x16_bf16 v[32:47], v[48:51], a[100:103], v[32:47]
  s_waitcnt lgkmcnt(2)
  v_mfma_f32_32x32x16_bf16 v[16:31], v[52:55], a[104:107], v[16:31]
  ds_read_b128 v[48:51], v10 offset:640
  v_mfma_f32_32x32x16_bf16 v[32:47], v[52:55], a[108:111], v[32:47]
  s_waitcnt lgkmcnt(2)
  v_mfma_f32_32x32x16_bf16 v[16:31], v[56:59], a[112:115], v[16:31]
  ds_read_b128 v[52:55], v11 offset:640
  v_mfma_f32_32x32x16_bf16 v[32:47], v[56:59], a[116:119], v[32:47]
  s_waitcnt lgkmcnt(2)
  v_mfma_f32_32x32x16_bf16 v[16:31], v[60:63], a[120:123], v[16:31]
  ds_read_b128 v[56:59], v12 offset:640
  v_mfma_f32_32x32x16_bf16 v[32:47], v[60:63], a[124:127], v[32:47]
  s_waitcnt lgkmcnt(2)
  v_mfma_f32_32x32x16_bf16 v[16:31], v[48:51], a[128:131], v[16:31]
  ds_read_b128 v[60:63], v13 offset:640
  v_mfma_f32_32x32x16_bf16 v[32:47], v[48:51], a[132:135], v[32:47]
  s_waitcnt lgkmcnt(2)
  v_mfma_f32_32x32x16_bf16 v[16:31], v[52:55], a[136:139], v[16:31]
  ds_read_b128 v[48:51], v10 offset:768
  v_mfma_f32_32x32x16_bf16 v[32:47], v[52:55], a[140:143], v[32:47]
  s_waitcnt lgkmcnt(2)
  v_mfma_f32_32x32x16_bf16 v[16:31], v[56:59], a[144:147], v[16:31]
  ds_read_b128 v[52:55], v11 offset:768
  v_mfma_f32_32x32x16_bf16 v[32:47], v[56:59], a[148:151], v[32:47]
  s_waitcnt vmcnt(9)
  v_mov_b32 v70, s40
  buffer_store_dword v70, off, s[4:7], s43 sc1
  s_waitcnt lgkmcnt(2)
  v_mfma_f32_32x32x16_bf16 v[16:31], v[60:63], a[152:155], v[16:31]
  ds_read_b128 v[56:59], v12 offset:768
  v_mfma_f32_32x32x16_bf16 v[32:47], v[60:63], a[156:159], v[32:47]
  s_waitcnt lgkmcnt(2)
  v_mfma_f32_32x32x16_bf16 v[16:31], v[48:51], a[160:163], v[16:31]
  ds_read_b128 v[60:63], v13 offset:768
  v_mfma_f32_32x32x16_bf16 v[32:47], v[48:51], a[164:167], v[32:47]
  s_waitcnt lgkmcnt(2)
  v_mfma_f32_32x32x16_bf16 v[16:31], v[52:55], a[168:171], v[16:31]
  ds_read_b128 v[48:51], v10 offset:896
  v_mfma_f32_32x32x16_bf16 v[32:47], v[52:55], a[172:175], v[32:47]
  s_waitcnt lgkmcnt(2)
  v_mfma_f32_32x32x16_bf16 v[16:31], v[56:59], a[176:179], v[16:31]
  ds_read_b128 v[52:55], v11 offset:896
  v_mfma_f32_32x32x16_bf16 v[32:47], v[56:59], a[180:183], v[32:47]
  s_waitcnt lgkmcnt(2)
  v_mfma_f32_32x32x16_bf16 v[16:31], v[60:63], a[184:187], v[16:31]
  ds_read_b128 v[56:59], v12 offset:896
  v_mfma_f32_32x32x16_bf16 v[32:47], v[60:63], a[188:191], v[32:47]
  s_waitcnt lgkmcnt(2)
  v_mfma_f32_32x32x16_bf16 v[16:31], v[48:51], a[192:195], v[16:31]
  ds_read_b128 v[60:63], v13 offset:896
  v_mfma_f32_32x32x16_bf16 v[32:47], v[48:51], a[196:199], v[32:47]
  s_waitcnt lgkmcnt(2)
  v_mfma_f32_32x32x16_bf16 v[16:31], v[52:55], a[200:203], v[16:31]
  ds_read_b128 v[48:51], v10 offset:1024
  v_mfma_f32_32x32x16_bf16 v[32:47], v[52:55], a[204:207], v[32:47]
  s_waitcnt lgkmcnt(2)
  v_mfma_f32_32x32x16_bf16 v[16:31], v[56:59], a[208:211], v[16:31]
  ds_read_b128 v[52:55], v11 offset:1024
  v_mfma_f32_32x32x16_bf16 v[32:47], v[56:59], a[212:215], v[32:47]
  s_waitcnt lgkmcnt(2)
  v_mfma_f32_32x32x16_bf16 v[16:31], v[60:63], a[216:219], v[16:31]
  ds_read_b128 v[56:59], v12 offset:1024
  v_mfma_f32_32x32x16_bf16 v[32:47], v[60:63], a[220:223], v[32:47]
  s_waitcnt lgkmcnt(2)
  v_mfma_f32_32x32x16_bf16 v[16:31], v[48:51], a[224:227], v[16:31]
  ds_read_b128 v[60:63], v13 offset:1024
  v_mfma_f32_32x32x16_bf16 v[32:47], v[48:51], a[228:231], v[32:47]
  s_waitcnt lgkmcnt(2)
  v_mfma_f32_32x32x16_bf16 v[16:31], v[52:55], a[232:235], v[16:31]
  v_mfma_f32_32x32x16_bf16 v[32:47], v[52:55], a[236:239], v[32:47]
  v_xor_b32 v10, 0x10000, v10
  v_xor_b32 v11, 0x10000, v11
  v_xor_b32 v12, 0x10000, v12
  v_xor_b32 v13, 0x10000, v13
  s_waitcnt lgkmcnt(1)
  v_mfma_f32_32x32x16_bf16 v[16:31], v[56:59], a[240:243], v[16:31]
  v_mfma_f32_32x32x16_bf16 v[32:47], v[56:59], a[244:247], v[32:47]
  v_mov_b32 v14, v72
  s_add_u32 s45, s45, 262144
  s_add_u32 s40, s40, 1
  s_waitcnt lgkmcnt(0)
  v_mfma_f32_32x32x16_bf16 v[16:31], v[60:63], a[248:251], v[16:31]
  v_mfma_f32_32x32x16_bf16 v[32:47], v[60:63], a[252:255], v[32:47]
  s_waitcnt vmcnt(1)
  s_barrier
  ds_read_b128 v[48:51], v10 offset:0
  ds_read_b128 v[52:55], v11 offset:0
  ds_read_b128 v[56:59], v12 offset:0
  s_cmp_lt_u32 s40, 63
  s_cselect_b32 s34, 36864, 0
  s_add_u32 s41, s41, s34
  s_xor_b32 s42, s42, 0x10000
  s_waitcnt lgkmcnt(2)
  v_mfma_f32_32x32x16_bf16 v[80:95], v[48:51], v[224:227], 0
  ds_read_b128 v[60:63], v13 offset:0
  v_mfma_f32_32x32x16_bf16 v[96:111], v[48:51], v[228:231], 0
  s_waitcnt lgkmcnt(2)
  v_mfma_f32_32x32x16_bf16 v[80:95], v[52:55], v[232:235], v[80:95]
  ds_read_b128 v[48:51], v10 offset:128
  v_mfma_f32_32x32x16_bf16 v[96:111], v[52:55], v[236:239], v[96:111]
  v_cvt_pk_bf16_f32 v16, v16, v17
  v_cvt_pk_bf16_f32 v17, v18, v19
  v_cvt_pk_bf16_f32 v18, v24, v25
  v_cvt_pk_bf16_f32 v19, v26, v27
  buffer_store_dwordx4 v[16:19], v14, s[4:7], s45 offen offset:0 sc1
  s_waitcnt lgkmcnt(2)
  v_mfma_f32_32x32x16_bf16 v[80:95], v[56:59], v[240:243], v[80:95]
  ds_read_b128 v[52:55], v11 offset:128
  v_mfma_f32_32x32x16_bf16 v[96:111], v[56:59], v[244:247], v[96:111]
  v_cvt_pk_bf16_f32 v20, v20, v21
  v_cvt_pk_bf16_f32 v21, v22, v23
  v_cvt_pk_bf16_f32 v22, v28, v29
  v_cvt_pk_bf16_f32 v23, v30, v31
  buffer_store_dwordx4 v[20:23], v14, s[4:7], s45 offen offset:512 sc1
  s_waitcnt lgkmcnt(2)
  v_mfma_f32_32x32x16_bf16 v[80:95], v[60:63], v[248:251], v[80:95]
  ds_read_b128 v[56:59], v12 offset:128
  v_mfma_f32_32x32x16_bf16 v[96:111], v[60:63], v[252:255], v[96:111]
  v_cvt_pk_bf16_f32 v32, v32, v33
  v_cvt_pk_bf16_f32 v33, v34, v35
  v_cvt_pk_bf16_f32 v34, v40, v41
  v_cvt_pk_bf16_f32 v35, v42, v43
  buffer_store_dwordx4 v[32:35], v14, s[4:7], s45 offen offset:2048 sc1
  s_waitcnt lgkmcnt(2)
  v_mfma_f32_32x32x16_bf16 v[80:95], v[48:51], a[0:3], v[80:95]
  ds_read_b128 v[60:63], v13 offset:128
  v_mfma_f32_32x32x16_bf16 v[96:111], v[48:51], a[4:7], v[96:111]
  v_cvt_pk_bf16_f32 v36, v36, v37
  v_cvt_pk_bf16_f32 v37, v38, v39
  v_cvt_pk_bf16_f32 v38, v44, v45
  v_cvt_pk_bf16_f32 v39, v46, v47
  buffer_store_dwordx4 v[36:39], v14, s[4:7], s45 offen offset:2560 sc1
  s_waitcnt lgkmcnt(2)
  v_mfma_f32_32x32x16_bf16 v[80:95], v[52:55], a[8:11], v[80:95]
  ds_read_b128 v[48:51], v10 offset:256
  v_mfma_f32_32x32x16_bf16 v[96:111], v[52:55], a[12:15], v[96:111]
  s_add_u32 m0, s42, 0
  s_nop 0
  buffer_load_dwordx4 v1, s[4:7], s41 offen sc1 lds
  s_waitcnt lgkmcnt(2)
  v_mfma_f32_32x32x16_bf16 v[80:95], v[56:59], a[16:19], v[80:95]
  ds_read_b128 v[52:55], v11 offset:256
  v_mfma_f32_32x32x16_bf16 v[96:111], v[56:59], a[20:23], v[96:111]
  s_add_u32 m0, s42, 1024
  s_nop 0
  buffer_load_dwordx4 v2, s[4:7], s41 offen sc1 lds
  s_waitcnt lgkmcnt(2)
  v_mfma_f32_32x32x16_bf16 v[80:95], v[60:63], a[24:27], v[80:95]
  ds_read_b128 v[56:59], v12 offset:256
  v_mfma_f32_32x32x16_bf16 v[96:111], v[60:63], a[28:31], v[96:111]
  s_add_u32 m0, s42, 2048
  s_nop 0
  buffer_load_dwordx4 v3, s[4:7], s41 offen sc1 lds
  s_waitcnt lgkmcnt(2)
  v_mfma_f32_32x32x16_bf16 v[80:95], v[48:51], a[32:35], v[80:95]
  ds_read_b128 v[60:63], v13 offset:256
  v_mfma_f32_32x32x16_bf16 v[96:111], v[48:51], a[36:39], v[96:111]
  s_add_u32 m0, s42, 3072
  s_nop 0
  buffer_load_dwordx4 v4, s[4:7], s41 offen sc1 lds
  s_waitcnt lgkmcnt(2)
  v_mfma_f32_32x32x16_bf16 v[80:95], v[52:55], a[40:43], v[80:95]
  ds_read_b128 v[48:51], v10 offset:384
  v_mfma_f32_32x32x16_bf16 v[96:111], v[52:55], a[44:47], v[96:111]
  s_add_u32 m0, s42, 4096
  s_nop 0
  buffer_load_dwordx4 v5, s[4:7], s41 offen sc1 lds
  s_waitcnt lgkmcnt(2)
  v_mfma_f32_32x32x16_bf16 v[80:95], v[56:59], a[48:51], v[80:95]
  ds_read_b128 v[52:55], v11 offset:384
  v_mfma_f32_32x32x16_bf16 v[96:111], v[56:59], a[52:55], v[96:111]
  s_add_u32 m0, s42, 5120
  s_nop 0
  buffer_load_dwordx4 v6, s[4:7], s41 offen sc1 lds
  s_waitcnt lgkmcnt(2)
  v_mfma_f32_32x32x16_bf16 v[80:95], v[60:63], a[56:59], v[80:95]
  ds_read_b128 v[56:59], v12 offset:384
  v_mfma_f32_32x32x16_bf16 v[96:111], v[60:63], a[60:63], v[96:111]
  s_add_u32 m0, s42, 6144
  s_nop 0
  buffer_load_dwordx4 v7, s[4:7], s41 offen sc1 lds
  s_waitcnt lgkmcnt(2)
  v_mfma_f32_32x32x16_bf16 v[80:95], v[48:51], a[64:67], v[80:95]
  ds_read_b128 v[60:63], v13 offset:384
  v_mfma_f32_32x32x16_bf16 v[96:111], v[48:51], a[68:71], v[96:111]
  s_add_u32 m0, s42, 7168
  s_nop 0
  buffer_load_dwordx4 v8, s[4:7], s41 offen sc1 lds
  s_waitcnt lgkmcnt(2)
  v_mfma_f32_32x32x16_bf16 v[80:95], v[52:55], a[72:75], v[80:95]
  ds_read_b128 v[48:51], v10 offset:512
  v_mfma_f32_32x32x16_bf16 v[96:111], v[52:55], a[76:79], v[96:111]
  s_add_u32 m0, s42, 8192
  s_nop 0
  buffer_load_dwordx4 v9, s[4:7], s41 offen sc1 lds
  s_waitcnt lgkmcnt(2)
  v_mfma_f32_32x32x16_bf16 v[80:95], v[56:59], a[80:83], v[80:95]
  ds_read_b128 v[52:55], v11 offset:512
  v_mfma_f32_32x32x16_bf16 v[96:111], v[56:59], a[84:87], v[96:111]
  s_waitcnt lgkmcnt(2)
  v_mfma_f32_32x32x16_bf16 v[80:95], v[60:63], a[88:91], v[80:95]
  ds_read_b128 v[56:59], v12 offset:512
  v_mfma_f32_32x32x16_bf16 v[96:111], v[60:63], a[92:95], v[96:111]
  s_waitcnt lgkmcnt(2)
  v_mfma_f32_32x32x16_bf16 v[80:95], v[48:51], a[96:99], v[80:95]
  ds_read_b128 v[60:63], v13 offset:512
  v_mfma_f32_32x32x16_bf16 v[96:111], v[48:51], a[100:103], v[96:111]
  s_waitcnt lgkmcnt(2)
  v_mfma_f32_32x32x16_bf16 v[80:95], v[52:55], a[104:107], v[80:95]
  ds_read_b128 v[48:51], v10 offset:640
  v_mfma_f32_32x32x16_bf16 v[96:111], v[52:55], a[108:111], v[96:111]
  s_waitcnt lgkmcnt(2)
  v_mfma_f32_32x32x16_bf16 v[80:95], v[56:59], a[112:115], v[80:95]
  ds_read_b128 v[52:55], v11 offset:640
  v_mfma_f32_32x32x16_bf16 v[96:111], v[56:59], a[116:119], v[96:111]
  s_waitcnt lgkmcnt(2)
  v_mfma_f32_32x32x16_bf16 v[80:95], v[60:63], a[120:123], v[80:95]
  ds_read_b128 v[56:59], v12 offset:640
  v_mfma_f32_32x32x16_bf16 v[96:111], v[60:63], a[124:127], v[96:111]
  s_waitcnt lgkmcnt(2)
  v_mfma_f32_32x32x16_bf16 v[80:95], v[48:51], a[128:131], v[80:95]
  ds_read_b128 v[60:63], v13 offset:640
  v_mfma_f32_32x32x16_bf16 v[96:111], v[48:51], a[132:135], v[96:111]
  s_waitcnt lgkmcnt(2)
  v_mfma_f32_32x32x16_bf16 v[80:95], v[52:55], a[136:139], v[80:95]
  ds_read_b128 v[48:51], v10 offset:768
  v_mfma_f32_32x32x16_bf16 v[96:111], v[52:55], a[140:143], v[96:111]
  s_waitcnt lgkmcnt(2)
  v_mfma_f32_32x32x16_bf16 v[80:95], v[56:59], a[144:147], v[80:95]
  ds_read_b128 v[52:55], v11 offset:768
  v_mfma_f32_32x32x16_bf16 v[96:111], v[56:59], a[148:151], v[96:111]
  s_waitcnt vmcnt(9)
  v_mov_b32 v70, s40
  buffer_store_dword v70, off, s[4:7], s43 sc1
  s_waitcnt lgkmcnt(2)
  v_mfma_f32_32x32x16_bf16 v[80:95], v[60:63], a[152:155], v[80:95]
  ds_read_b128 v[56:59], v12 offset:768
  v_mfma_f32_32x32x16_bf16 v[96:111], v[60:63], a[156:159], v[96:111]
  s_waitcnt lgkmcnt(2)
  v_mfma_f32_32x32x16_bf16 v[80:95], v[48:51], a[160:163], v[80:95]
  ds_read_b128 v[60:63], v13 offset:768
  v_mfma_f32_32x32x16_bf16 v[96:111], v[48:51], a[164:167], v[96:111]
  s_waitcnt lgkmcnt(2)
  v_mfma_f32_32x32x16_bf16 v[80:95], v[52:55], a[168:171], v[80:95]
  ds_read_b128 v[48:51], v10 offset:896
  v_mfma_f32_32x32x16_bf16 v[96:111], v[52:55], a[172:175], v[96:111]
  s_waitcnt lgkmcnt(2)
  v_mfma_f32_32x32x16_bf16 v[80:95], v[56:59], a[176:179], v[80:95]
  ds_read_b128 v[52:55], v11 offset:896
  v_mfma_f32_32x32x16_bf16 v[96:111], v[56:59], a[180:183], v[96:111]
  s_waitcnt lgkmcnt(2)
  v_mfma_f32_32x32x16_bf16 v[80:95], v[60:63], a[184:187], v[80:95]
  ds_read_b128 v[56:59], v12 offset:896
  v_mfma_f32_32x32x16_bf16 v[96:111], v[60:63], a[188:191], v[96:111]
  s_waitcnt lgkmcnt(2)
  v_mfma_f32_32x32x16_bf16 v[80:95], v[48:51], a[192:195], v[80:95]
  ds_read_b128 v[60:63], v13 offset:896
  v_mfma_f32_32x32x16_bf16 v[96:111], v[48:51], a[196:199], v[96:111]
  s_waitcnt lgkmcnt(2)
  v_mfma_f32_32x32x16_bf16 v[80:95], v[52:55], a[200:203], v[80:95]
  ds_read_b128 v[48:51], v10 offset:1024
  v_mfma_f32_32x32x16_bf16 v[96:111], v[52:55], a[204:207], v[96:111]
  s_waitcnt lgkmcnt(2)
  v_mfma_f32_32x32x16_bf16 v[80:95], v[56:59], a[208:211], v[80:95]
  ds_read_b128 v[52:55], v11 offset:1024
  v_mfma_f32_32x32x16_bf16 v[96:111], v[56:59], a[212:215], v[96:111]
  s_waitcnt lgkmcnt(2)
  v_mfma_f32_32x32x16_bf16 v[80:95], v[60:63], a[216:219], v[80:95]
  ds_read_b128 v[56:59], v12 offset:1024
  v_mfma_f32_32x32x16_bf16 v[96:111], v[60:63], a[220:223], v[96:111]
  s_waitcnt lgkmcnt(2)
  v_mfma_f32_32x32x16_bf16 v[80:95], v[48:51], a[224:227], v[80:95]
  ds_read_b128 v[60:63], v13 offset:1024
  v_mfma_f32_32x32x16_bf16 v[96:111], v[48:51], a[228:231], v[96:111]
  s_waitcnt lgkmcnt(2)
  v_mfma_f32_32x32x16_bf16 v[80:95], v[52:55], a[232:235], v[80:95]
  v_mfma_f32_32x32x16_bf16 v[96:111], v[52:55], a[236:239], v[96:111]
  v_xor_b32 v10, 0x10000, v10
  v_xor_b32 v11, 0x10000, v11
  v_xor_b32 v12, 0x10000, v12
  v_xor_b32 v13, 0x10000, v13
  s_waitcnt lgkmcnt(1)
  v_mfma_f32_32x32x16_bf16 v[80:95], v[56:59], a[240:243], v[80:95]
  v_mfma_f32_32x32x16_bf16 v[96:111], v[56:59], a[244:247], v[96:111]
  v_mov_b32 v14, v72
  s_add_u32 s45, s45, 262144
  s_add_u32 s40, s40, 1
  s_waitcnt lgkmcnt(0)
  v_mfma_f32_32x32x16_bf16 v[80:95], v[60:63], a[248:251], v[80:95]
  v_mfma_f32_32x32x16_bf16 v[96:111], v[60:63], a[252:255], v[96:111]
  s_cmp_lt_u32 s40, 64
  s_cbranch_scc1 L_proj_lv
  s_nop 2
  v_cvt_pk_bf16_f32 v80, v80, v81
  v_cvt_pk_bf16_f32 v81, v82, v83
  v_cvt_pk_bf16_f32 v82, v88, v89
  v_cvt_pk_bf16_f32 v83, v90, v91
  buffer_store_dwordx4 v[80:83], v14, s[4:7], s45 offen offset:0 sc1
  v_cvt_pk_bf16_f32 v84, v84, v85
  v_cvt_pk_bf16_f32 v85, v86, v87
  v_cvt_pk_bf16_f32 v86, v92, v93
  v_cvt_pk_bf16_f32 v87, v94, v95
  buffer_store_dwordx4 v[84:87], v14, s[4:7], s45 offen offset:512 sc1
  v_cvt_pk_bf16_f32 v96, v96, v97
  v_cvt_pk_bf16_f32 v97, v98, v99
  v_cvt_pk_bf16_f32 v98, v104, v105
  v_cvt_pk_bf16_f32 v99, v106, v107
  buffer_store_dwordx4 v[96:99], v14, s[4:7], s45 offen offset:2048 sc1
  v_cvt_pk_bf16_f32 v100, v100, v101
  v_cvt_pk_bf16_f32 v101, v102, v103
  v_cvt_pk_bf16_f32 v102, v108, v109
  v_cvt_pk_bf16_f32 v103, v110, v111
  buffer_store_dwordx4 v[100:103], v14, s[4:7], s45 offen offset:2560 sc1
L_proj_end:
  s_waitcnt vmcnt(0)
  v_mov_b32 v70, 64
  buffer_store_dword v70, off, s[4:7], s43 sc1
  s_barrier
  s_cmp_lt_u32 s32, 36
  s_cbranch_scc1 L_ffn
  s_endpgm
L_att:
  s_load_dwordx2 s[12:13], s[0:1], 0
  s_load_dwordx2 s[16:17], s[0:1], 40
  s_mov_b32 s50, 0
  s_sub_u32 s34, s32, 48
  s_and_b32 s43, s34, 15
  s_lshr_b32 s44, s34, 4
  v_lshlrev_b32 v1, 4, v0
  s_waitcnt lgkmcnt(0)
  s_and_b32 s13, s13, 0xffff
  s_mov_b32 s14, 2359296
  s_mov_b32 s15, 0x20000
  s_and_b32 s17, s17, 0xffff
  s_mov_b32 s18, 4718592
  s_mov_b32 s19, 0x20000
  s_mul_i32 s41, s34, 36864
  s_mul_i32 s42, s33, 9216
  s_add_u32 s41, s41, s42
  v_lshrrev_b32 v10, 3, v0
  v_mul_u32_u24 v10, 1152, v10
  v_and_b32 v11, 7, v0
  v_lshl_add_u32 v10, v11, 4, v10
  buffer_load_dwordx4 v[16:19], v10, s[12:15], s41 offen offset:0
  buffer_load_dwordx4 v[20:23], v10, s[12:15], s41 offen offset:128
  buffer_load_dwordx4 v[24:27], v10, s[12:15], s41 offen offset:256
  buffer_load_dwordx4 v[28:31], v10, s[12:15], s41 offen offset:384
  buffer_load_dwordx4 v[32:35], v10, s[12:15], s41 offen offset:512
  buffer_load_dwordx4 v[36:39], v10, s[12:15], s41 offen offset:640
  buffer_load_dwordx4 v[40:43], v10, s[12:15], s41 offen offset:768
  buffer_load_dwordx4 v[44:47], v10, s[12:15], s41 offen offset:896
  buffer_load_dwordx4 v[48:51], v10, s[12:15], s41 offen offset:1024
  s_mul_i32 s45, s43, 294912
  s_add_u32 s45, s45, s42
  s_lshl2_add_u32 s34, s34, s33
  v_mov_b64 v[64:65], -1
  v_mov_b64 v[66:67], -1
  s_mul_i32 s34, s34, 2048
  s_add_u32 s51, s34, 14155776
  buffer_store_dwordx4 v[64:67], v1, s[4:7], s51 offen offset:0 sc1
  buffer_store_dwordx4 v[64:67], v1, s[4:7], s51 offen offset:1024 sc1
  s_add_u32 s51, s34, 18350080
  buffer_store_dwordx4 v[64:67], v1, s[4:7], s51 offen offset:0 sc1
  buffer_store_dwordx4 v[64:67], v1, s[4:7], s51 offen offset:1024 sc1
  s_waitcnt vmcnt(4)
  s_nop 0
  v_lshlrev_b32 v64, 16, v16
  v_and_b32 v65, 0xffff0000, v16
  v_lshlrev_b32 v66, 16, v17
  v_and_b32 v67, 0xffff0000, v17
  v_lshlrev_b32 v68, 16, v18
  v_and_b32 v69, 0xffff0000, v18
  v_lshlrev_b32 v70, 16, v19
  v_and_b32 v71, 0xffff0000, v19
  v_lshlrev_b32 v72, 16, v20
  v_and_b32 v73, 0xffff0000, v20
  v_lshlrev_b32 v74, 16, v21
  v_and_b32 v75, 0xffff0000, v21
  v_lshlrev_b32 v76, 16, v22
  v_and_b32 v77, 0xffff0000, v22
  v_lshlrev_b32 v78, 16, v23
  v_and_b32 v79, 0xffff0000, v23
  v_lshlrev_b32 v80, 16, v24
  v_and_b32 v81, 0xffff0000, v24
  v_lshlrev_b32 v82, 16, v25
  v_and_b32 v83, 0xffff0000, v25
  v_lshlrev_b32 v84, 16, v26
  v_and_b32 v85, 0xffff0000, v26
  v_lshlrev_b32 v86, 16, v27
  v_and_b32 v87, 0xffff0000, v27
  v_lshlrev_b32 v88, 16, v28
  v_and_b32 v89, 0xffff0000, v28
  v_lshlrev_b32 v90, 16, v29
  v_and_b32 v91, 0xffff0000, v29
  v_lshlrev_b32 v92, 16, v30
  v_and_b32 v93, 0xffff0000, v30
  v_lshlrev_b32 v94, 16, v31
  v_and_b32 v95, 0xffff0000, v31
  v_lshlrev_b32 v96, 16, v32
  v_and_b32 v97, 0xffff0000, v32
  v_lshlrev_b32 v98, 16, v33
  v_and_b32 v99, 0xffff0000, v33
  v_lshlrev_b32 v100, 16, v34
  v_and_b32 v101, 0xffff0000, v34
  v_lshlrev_b32 v102, 16, v35
  v_and_b32 v103, 0xffff0000, v35
  v_lshlrev_b32 v104, 16, v36
  v_and_b32 v105, 0xffff0000, v36
  v_lshlrev_b32 v106, 16, v37
  v_and_b32 v107, 0xffff0000, v37
  v_lshlrev_b32 v108, 16, v38
  v_and_b32 v109, 0xffff0000, v38
  v_lshlrev_b32 v110, 16, v39
  v_and_b32 v111, 0xffff0000, v39
  v_lshlrev_b32 v112, 16, v40
  v_and_b32 v113, 0xffff0000, v40
  v_lshlrev_b32 v114, 16, v41
  v_and_b32 v115, 0xffff0000, v41
  v_lshlrev_b32 v116, 16, v42
  v_and_b32 v117, 0xffff0000, v42
  v_lshlrev_b32 v118, 16, v43
  v_and_b32 v119, 0xffff0000, v43
  v_lshlrev_b32 v120, 16, v44
  v_and_b32 v121, 0xffff0000, v44
  v_lshlrev_b32 v122, 16, v45
  v_and_b32 v123, 0xffff0000, v45
  v_lshlrev_b32 v124, 16, v46
  v_and_b32 v125, 0xffff0000, v46
  v_lshlrev_b32 v126, 16, v47
  v_and_b32 v127, 0xffff0000, v47
  v_lshlrev_b32 v128, 16, v48
  v_and_b32 v129, 0xffff0000, v48
  v_lshlrev_b32 v130, 16, v49
  v_and_b32 v131, 0xffff0000, v49
  v_lshlrev_b32 v132, 16, v50
  v_and_b32 v133, 0xffff0000, v50
  v_lshlrev_b32 v134, 16, v51
  v_and_b32 v135, 0xffff0000, v51
  v_add_f32 v12, v64, v68
  v_add_f32 v13, v65, v69
  v_add_f32 v14, v66, v70
  v_add_f32 v15, v67, v71
  v_add_f32 v12, v12, v72
  v_add_f32 v13, v13, v73
  v_add_f32 v14, v14, v74
  v_add_f32 v15, v15, v75
  v_add_f32 v12, v12, v76
  v_add_f32 v13, v13, v77
  v_add_f32 v14, v14, v78
  v_add_f32 v15, v15, v79
  v_add_f32 v12, v12, v80
  v_add_f32 v13, v13, v81
  v_add_f32 v14, v14, v82
  v_add_f32 v15, v15, v83
  v_add_f32 v12, v12, v84
  v_add_f32 v13, v13, v85
  v_add_f32 v14, v14, v86
  v_add_f32 v15, v15, v87
  v_add_f32 v12, v12, v88
  v_add_f32 v13, v13, v89
  v_add_f32 v14, v14, v90
  v_add_f32 v15, v15, v91
  v_add_f32 v12, v12, v92
  v_add_f32 v13, v13, v93
  v_add_f32 v14, v14, v94
  v_add_f32 v15, v15, v95
  v_add_f32 v12, v12, v96
  v_add_f32 v13, v13, v97
  v_add_f32 v14, v14, v98
  v_add_f32 v15, v15, v99
  v_add_f32 v12, v12, v100
  v_add_f32 v13, v13, v101
  v_add_f32 v14, v14, v102
  v_add_f32 v15, v15, v103
  v_add_f32 v12, v12, v104
  v_add_f32 v13, v13, v105
  v_add_f32 v14, v14, v106
  v_add_f32 v15, v15, v107
  v_add_f32 v12, v12, v108
  v_add_f32 v13, v13, v109
  v_add_f32 v14, v14, v110
  v_add_f32 v15, v15, v111
  v_add_f32 v12, v12, v112
  v_add_f32 v13, v13, v113
  v_add_f32 v14, v14, v114
  v_add_f32 v15, v15, v115
  v_add_f32 v12, v12, v116
  v_add_f32 v13, v13, v117
  v_add_f32 v14, v14, v118
  v_add_f32 v15, v15, v119
  v_add_f32 v12, v12, v120
  v_add_f32 v13, v13, v121
  v_add_f32 v14, v14, v122
  v_add_f32 v15, v15, v123
  v_add_f32 v12, v12, v124
  v_add_f32 v13, v13, v125
  v_add_f32 v14, v14, v126
  v_add_f32 v15, v15, v127
  v_add_f32 v12, v12, v128
  v_add_f32 v13, v13, v129
  v_add_f32 v14, v14, v130
  v_add_f32 v15, v15, v131
  v_add_f32 v12, v12, v132
  v_add_f32 v13, v13, v133
  v_add_f32 v14, v14, v134
  v_add_f32 v15, v15, v135
  v_add_f32 v12, v12, v13
  v_add_f32 v14, v14, v15
  v_add_f32 v12, v12, v14
  s_nop 1
  v_add_f32_dpp v12, v12, v12 quad_perm:[1,0,3,2] row_mask:0xf bank_mask:0xf
  s_nop 1
  v_add_f32_dpp v12, v12, v12 quad_perm:[2,3,0,1] row_mask:0xf bank_mask:0xf
  s_nop 1
  v_add_f32_dpp v12, v12, v12 row_half_mirror row_mask:0xf bank_mask:0xf
  v_mul_f32 v11, 0x3ae38e39, v12
  v_sub_f32 v64, v64, v11
  v_sub_f32 v65, v65, v11
  v_sub_f32 v66, v66, v11
  v_sub_f32 v67, v67, v11
  v_sub_f32 v68, v68, v11
  v_sub_f32 v69, v69, v11
  v_sub_f32 v70, v70, v11
  v_sub_f32 v71, v71, v11
  v_sub_f32 v72, v72, v11
  v_sub_f32 v73, v73, v11
  v_sub_f32 v74, v74, v11
  v_sub_f32 v75, v75, v11
  v_sub_f32 v76, v76, v11
  v_sub_f32 v77, v77, v11
  v_sub_f32 v78, v78, v11
  v_sub_f32 v79, v79, v11
  v_sub_f32 v80, v80, v11
  v_sub_f32 v81, v81, v11
  v_sub_f32 v82, v82, v11
  v_sub_f32 v83, v83, v11
  v_sub_f32 v84, v84, v11
  v_sub_f32 v85, v85, v11
  v_sub_f32 v86, v86, v11
  v_sub_f32 v87, v87, v11
  v_sub_f32 v88, v88, v11
  v_sub_f32 v89, v89, v11
  v_sub_f32 v90, v90, v11
  v_sub_f32 v91, v91, v11
  v_sub_f32 v92, v92, v11
  v_sub_f32 v93, v93, v11
  v_sub_f32 v94, v94, v11
  v_sub_f32 v95, v95, v11
  v_sub_f32 v96, v96, v11
  v_sub_f32 v97, v97, v11
  v_sub_f32 v98, v98, v11
  v_sub_f32 v99, v99, v11
  v_sub_f32 v100, v100, v11
  v_sub_f32 v101, v101, v11
  v_sub_f32 v102, v102, v11
  v_sub_f32 v103, v103, v11
  v_sub_f32 v104, v104, v11
  v_sub_f32 v105, v105, v11
  v_sub_f32 v106, v106, v11
  v_sub_f32 v107, v107, v11
  v_sub_f32 v108, v108, v11
  v_sub_f32 v109, v109, v11
  v_sub_f32 v110, v110, v11
  v_sub_f32 v111, v111, v11
  v_sub_f32 v112, v112, v11
  v_sub_f32 v113, v113, v11
  v_sub_f32 v114, v114, v11
  v_sub_f32 v115, v115, v11
  v_sub_f32 v116, v116, v11
  v_sub_f32 v117, v117, v11
  v_sub_f32 v118, v118, v11
  v_sub_f32 v119, v119, v11
  v_sub_f32 v120, v120, v11
  v_sub_f32 v121, v121, v11
  v_sub_f32 v122, v122, v11
  v_sub_f32 v123, v123, v11
  v_sub_f32 v124, v124, v11
  v_sub_f32 v125, v125, v11
  v_sub_f32 v126, v126, v11
  v_sub_f32 v127, v127, v11
  v_sub_f32 v128, v128, v11
  v_sub_f32 v129, v129, v11
  v_sub_f32 v130, v130, v11
  v_sub_f32 v131, v131, v11
  v_sub_f32 v132, v132, v11
  v_sub_f32 v133, v133, v11
  v_sub_f32 v134, v134, v11
  v_sub_f32 v135, v135, v11
  v_mul_f32 v12, v64, v64
  v_mul_f32 v13, v65, v65
  v_mul_f32 v14, v66, v66
  v_mul_f32 v15, v67, v67
  v_fmac_f32 v12, v68, v68
  v_fmac_f32 v13, v69, v69
  v_fmac_f32 v14, v70, v70
  v_fmac_f32 v15, v71, v71
  v_fmac_f32 v12, v72, v72
  v_fmac_f32 v13, v73, v73
  v_fmac_f32 v14, v74, v74
  v_fmac_f32 v15, v75, v75
  v_fmac_f32 v12, v76, v76
  v_fmac_f32 v13, v77, v77
  v_fmac_f32 v14, v78, v78
  v_fmac_f32 v15, v79, v79
  v_fmac_f32 v12, v80, v80
  v_fmac_f32 v13, v81, v81
  v_fmac_f32 v14, v82, v82
  v_fmac_f32 v15, v83, v83
  v_fmac_f32 v12, v84, v84
  v_fmac_f32 v13, v85, v85
  v_fmac_f32 v14, v86, v86
  v_fmac_f32 v15, v87, v87
  v_fmac_f32 v12, v88, v88
  v_fmac_f32 v13, v89, v89
  v_fmac_f32 v14, v90, v90
  v_fmac_f32 v15, v91, v91
  v_fmac_f32 v12, v92, v92
  v_fmac_f32 v13, v93, v93
  v_fmac_f32 v14, v94, v94
  v_fmac_f32 v15, v95, v95
  v_fmac_f32 v12, v96, v96
  v_fmac_f32 v13, v97, v97
  v_fmac_f32 v14, v98, v98
  v_fmac_f32 v15, v99, v99
  v_fmac_f32 v12, v100, v100
  v_fmac_f32 v13, v101, v101
  v_fmac_f32 v14, v102, v102
  v_fmac_f32 v15, v103, v103
  v_fmac_f32 v12, v104, v104
  v_fmac_f32 v13, v105, v105
  v_fmac_f32 v14, v106, v106
  v_fmac_f32 v15, v107, v107
  v_fmac_f32 v12, v108, v108
  v_fmac_f32 v13, v109, v109
  v_fmac_f32 v14, v110, v110
  v_fmac_f32 v15, v111, v111
  v_fmac_f32 v12, v112, v112
  v_fmac_f32 v13, v113, v113
  v_fmac_f32 v14, v114, v114
  v_fmac_f32 v15, v115, v115
  v_fmac_f32 v12, v116, v116
  v_fmac_f32 v13, v117, v117
  v_fmac_f32 v14, v118, v118
  v_fmac_f32 v15, v119, v119
  v_fmac_f32 v12, v120, v120
  v_fmac_f32 v13, v121, v121
  v_fmac_f32 v14, v122, v122
  v_fmac_f32 v15, v123, v123
  v_fmac_f32 v12, v124, v124
  v_fmac_f32 v13, v125, v125
  v_fmac_f32 v14, v126, v126
  v_fmac_f32 v15, v127, v127
  v_fmac_f32 v12, v128, v128
  v_fmac_f32 v13, v129, v129
  v_fmac_f32 v14, v130, v130
  v_fmac_f32 v15, v131, v131
  v_fmac_f32 v12, v132, v132
  v_fmac_f32 v13, v133, v133
  v_fmac_f32 v14, v134, v134
  v_fmac_f32 v15, v135, v135
  v_add_f32 v12, v12, v13
  v_add_f32 v14, v14, v15
  v_add_f32 v12, v12, v14
  s_nop 1
  v_add_f32_dpp v12, v12, v12 quad_perm:[1,0,3,2] row_mask:0xf bank_mask:0xf
  s_nop 1
  v_add_f32_dpp v12, v12, v12 quad_perm:[2,3,0,1] row_mask:0xf bank_mask:0xf
  s_nop 1
  v_add_f32_dpp v12, v12, v12 row_half_mirror row_mask:0xf bank_mask:0xf
  v_mov_b32 v11, 0x3727c5ac
  v_fmac_f32 v11, 0x3ae38e39, v12
  v_rsq_f32 v11, v11
  s_nop 0
  v_mul_f32 v64, v11, v64
  v_mul_f32 v65, v11, v65
  v_mul_f32 v66, v11, v66
  v_mul_f32 v67, v11, v67
  v_mul_f32 v68, v11, v68
  v_mul_f32 v69, v11, v69
  v_mul_f32 v70, v11, v70
  v_mul_f32 v71, v11, v71
  v_mul_f32 v72, v11, v72
  v_mul_f32 v73, v11, v73
  v_mul_f32 v74, v11, v74
  v_mul_f32 v75, v11, v75
  v_mul_f32 v76, v11, v76
  v_mul_f32 v77, v11, v77
  v_mul_f32 v78, v11, v78
  v_mul_f32 v79, v11, v79
  v_mul_f32 v80, v11, v80
  v_mul_f32 v81, v11, v81
  v_mul_f32 v82, v11, v82
  v_mul_f32 v83, v11, v83
  v_mul_f32 v84, v11, v84
  v_mul_f32 v85, v11, v85
  v_mul_f32 v86, v11, v86
  v_mul_f32 v87, v11, v87
  v_mul_f32 v88, v11, v88
  v_mul_f32 v89, v11, v89
  v_mul_f32 v90, v11, v90
  v_mul_f32 v91, v11, v91
  v_mul_f32 v92, v11, v92
  v_mul_f32 v93, v11, v93
  v_mul_f32 v94, v11, v94
  v_mul_f32 v95, v11, v95
  v_mul_f32 v96, v11, v96
  v_mul_f32 v97, v11, v97
  v_mul_f32 v98, v11, v98
  v_mul_f32 v99, v11, v99
  v_mul_f32 v100, v11, v100
  v_mul_f32 v101, v11, v101
  v_mul_f32 v102, v11, v102
  v_mul_f32 v103, v11, v103
  v_mul_f32 v104, v11, v104
  v_mul_f32 v105, v11, v105
  v_mul_f32 v106, v11, v106
  v_mul_f32 v107, v11, v107
  v_mul_f32 v108, v11, v108
  v_mul_f32 v109, v11, v109
  v_mul_f32 v110, v11, v110
  v_mul_f32 v111, v11, v111
  v_mul_f32 v112, v11, v112
  v_mul_f32 v113, v11, v113
  v_mul_f32 v114, v11, v114
  v_mul_f32 v115, v11, v115
  v_mul_f32 v116, v11, v116
  v_mul_f32 v117, v11, v117
  v_mul_f32 v118, v11, v118
  v_mul_f32 v119, v11, v119
  v_mul_f32 v120, v11, v120
  v_mul_f32 v121, v11, v121
  v_mul_f32 v122, v11, v122
  v_mul_f32 v123, v11, v123
  v_mul_f32 v124, v11, v124
  v_mul_f32 v125, v11, v125
  v_mul_f32 v126, v11, v126
  v_mul_f32 v127, v11, v127
  v_mul_f32 v128, v11, v128
  v_mul_f32 v129, v11, v129
  v_mul_f32 v130, v11, v130
  v_mul_f32 v131, v11, v131
  v_mul_f32 v132, v11, v132
  v_mul_f32 v133, v11, v133
  v_mul_f32 v134, v11, v134
  v_mul_f32 v135, v11, v135
  v_cvt_pk_bf16_f32 v16, v64, v65
  v_cvt_pk_bf16_f32 v17, v66, v67
  v_cvt_pk_bf16_f32 v18, v68, v69
  v_cvt_pk_bf16_f32 v19, v70, v71
  v_cvt_pk_bf16_f32 v20, v72, v73
  v_cvt_pk_bf16_f32 v21, v74, v75
  v_cvt_pk_bf16_f32 v22, v76, v77
  v_cvt_pk_bf16_f32 v23, v78, v79
  v_cvt_pk_bf16_f32 v24, v80, v81
  v_cvt_pk_bf16_f32 v25, v82, v83
  v_cvt_pk_bf16_f32 v26, v84, v85
  v_cvt_pk_bf16_f32 v27, v86, v87
  v_cvt_pk_bf16_f32 v28, v88, v89
  v_cvt_pk_bf16_f32 v29, v90, v91
  v_cvt_pk_bf16_f32 v30, v92, v93
  v_cvt_pk_bf16_f32 v31, v94, v95
  v_cvt_pk_bf16_f32 v32, v96, v97
  v_cvt_pk_bf16_f32 v33, v98, v99
  v_cvt_pk_bf16_f32 v34, v100, v101
  v_cvt_pk_bf16_f32 v35, v102, v103
  v_cvt_pk_bf16_f32 v36, v104, v105
  v_cvt_pk_bf16_f32 v37, v106, v107
  v_cvt_pk_bf16_f32 v38, v108, v109
  v_cvt_pk_bf16_f32 v39, v110, v111
  v_cvt_pk_bf16_f32 v40, v112, v113
  v_cvt_pk_bf16_f32 v41, v114, v115
  v_cvt_pk_bf16_f32 v42, v116, v117
  v_cvt_pk_bf16_f32 v43, v118, v119
  v_cvt_pk_bf16_f32 v44, v120, v121
  v_cvt_pk_bf16_f32 v45, v122, v123
  v_cvt_pk_bf16_f32 v46, v124, v125
  v_cvt_pk_bf16_f32 v47, v126, v127
  v_cvt_pk_bf16_f32 v48, v128, v129
  v_cvt_pk_bf16_f32 v49, v130, v131
  v_cvt_pk_bf16_f32 v50, v132, v133
  v_cvt_pk_bf16_f32 v51, v134, v135
  s_add_u32 s41, s41, 1048576
  buffer_store_dwordx4 v[16:19], v10, s[4:7], s41 offen offset:0 sc1
  buffer_store_dwordx4 v[20:23], v10, s[4:7], s41 offen offset:128 sc1
  buffer_store_dwordx4 v[24:27], v10, s[4:7], s41 offen offset:256 sc1
  buffer_store_dwordx4 v[28:31], v10, s[4:7], s41 offen offset:384 sc1
  buffer_store_dwordx4 v[32:35], v10, s[4:7], s41 offen offset:512 sc1
  buffer_store_dwordx4 v[36:39], v10, s[4:7], s41 offen offset:640 sc1
  buffer_store_dwordx4 v[40:43], v10, s[4:7], s41 offen offset:768 sc1
  buffer_store_dwordx4 v[44:47], v10, s[4:7], s41 offen offset:896 sc1
  buffer_store_dwordx4 v[48:51], v10, s[4:7], s41 offen offset:1024 sc1
  s_waitcnt vmcnt(0)
  s_barrier
  s_cmp_lg_u32 s33, 0
  s_cbranch_scc1 L_meet_7
  v_mov_b32 v14, 1
  s_mov_b64 exec, 1
  buffer_atomic_add v14, off, s[8:11], 0 offset:12 sc0
  s_waitcnt vmcnt(0)
  v_readfirstlane_b32 s51, v14
  v_mov_b32 v14, 1
  s_cmp_lg_u32 s51, 63
  s_cbranch_scc1 L_cnt_8
  buffer_store_dword v14, off, s[8:11], 0 offset:132 sc1
L_cnt_8:
  s_mov_b64 exec, -1
L_ga_9:
  buffer_load_dword v14, off, s[8:11], 0 offset:136 sc1
  s_add_u32 s50, s50, 1
  s_cmp_ge_u32 s50, 262144
  s_waitcnt vmcnt(0)
  s_cbranch_scc1 L_ga_9_x
  v_cmp_ge_u32 vcc, 0, v14
  s_nop 0
  s_cbranch_vccnz L_ga_9
L_ga_9_x:
L_meet_7:
  s_barrier
  s_add_u32 m0, s42, 0
  s_add_u32 s51, s45, 0
  buffer_load_dwordx4 v1, s[16:19], s51 offen offset:0 lds
  buffer_load_dwordx4 v1, s[16:19], s51 offen offset:1024 lds
  buffer_load_dwordx4 v1, s[16:19], s51 offen offset:2048 lds
  buffer_load_dwordx4 v1, s[16:19], s51 offen offset:3072 lds
  s_add_u32 m0, s42, 4096
  s_add_u32 s51, s45, 4096
  buffer_load_dwordx4 v1, s[16:19], s51 offen offset:0 lds
  buffer_load_dwordx4 v1, s[16:19], s51 offen offset:1024 lds
  buffer_load_dwordx4 v1, s[16:19], s51 offen offset:2048 lds
  buffer_load_dwordx4 v1, s[16:19], s51 offen offset:3072 lds
  s_add_u32 m0, s42, 8192
  s_add_u32 s51, s45, 8192
  buffer_load_dwordx4 v1, s[16:19], s51 offen offset:0 lds
  s_add_u32 m0, s42, 36864
  s_add_u32 s51, s45, 36864
  buffer_load_dwordx4 v1, s[16:19], s51 offen offset:0 lds
  buffer_load_dwordx4 v1, s[16:19], s51 offen offset:1024 lds
  buffer_load_dwordx4 v1, s[16:19], s51 offen offset:2048 lds
  buffer_load_dwordx4 v1, s[16:19], s51 offen offset:3072 lds
  s_add_u32 m0, s42, 40960
  s_add_u32 s51, s45, 40960
  buffer_load_dwordx4 v1, s[16:19], s51 offen offset:0 lds
  buffer_load_dwordx4 v1, s[16:19], s51 offen offset:1024 lds
  buffer_load_dwordx4 v1, s[16:19], s51 offen offset:2048 lds
  buffer_load_dwordx4 v1, s[16:19], s51 offen offset:3072 lds
  s_add_u32 m0, s42, 45056
  s_add_u32 s51, s45, 45056
  buffer_load_dwordx4 v1, s[16:19], s51 offen offset:0 lds
  s_add_u32 m0, s42, 73728
  s_add_u32 s51, s45, 73728
  buffer_load_dwordx4 v1, s[16:19], s51 offen offset:0 lds
  buffer_load_dwordx4 v1, s[16:19], s51 offen offset:1024 lds
  buffer_load_dwordx4 v1, s[16:19], s51 offen offset:2048 lds
  buffer_load_dwordx4 v1, s[16:19], s51 offen offset:3072 lds
  s_add_u32 m0, s42, 77824
  s_add_u32 s51, s45, 77824
  buffer_load_dwordx4 v1, s[16:19], s51 offen offset:0 lds
  buffer_load_dwordx4 v1, s[16:19], s51 offen offset:1024 lds
  buffer_load_dwordx4 v1, s[16:19], s51 offen offset:2048 lds
  buffer_load_dwordx4 v1, s[16:19], s51 offen offset:3072 lds
  s_add_u32 m0, s42, 81920
  s_add_u32 s51, s45, 81920
  buffer_load_dwordx4 v1, s[16:19], s51 offen offset:0 lds
  s_add_u32 m0, s42, 110592
  s_add_u32 s51, s45, 110592
  buffer_load_dwordx4 v1, s[16:19], s51 offen offset:0 lds
  buffer_load_dwordx4 v1, s[16:19], s51 offen offset:1024 lds
  buffer_load_dwordx4 v1, s[16:19], s51 offen offset:2048 lds
  buffer_load_dwordx4 v1, s[16:19], s51 offen offset:3072 lds
  s_add_u32 m0, s42, 114688
  s_add_u32 s51, s45, 114688
  buffer_load_dwordx4 v1, s[16:19], s51 offen offset:0 lds
  buffer_load_dwordx4 v1, s[16:19], s51 offen offset:1024 lds
  buffer_load_dwordx4 v1, s[16:19], s51 offen offset:2048 lds
  buffer_load_dwordx4 v1, s[16:19], s51 offen offset:3072 lds
  s_add_u32 m0, s42, 118784
  s_add_u32 s51, s45, 118784
  buffer_load_dwordx4 v1, s[16:19], s51 offen offset:0 lds
  s_cmp_eq_u32 s33, 1
  s_cbranch_scc1 L_att_w1
  s_cmp_eq_u32 s33, 2
  s_cbranch_scc1 L_att_w2
  s_cmp_eq_u32 s33, 3
  s_cbranch_scc1 L_att_w3
L_att_w0:
  v_lshrrev_b32 v12, 2, v0
  v_mul_u32_u24 v12, 1152, v12
  v_and_b32 v13, 3, v0
  v_lshl_add_u32 v12, v13, 4, v12
  v_add_u32 v13, 73728, v12
  s_waitcnt vmcnt(27)
  s_barrier
  ds_read_b64_tr_b16 v[224:225], v12 offset:0
  ds_read_b64_tr_b16 v[226:227], v12 offset:18432
  ds_read_b64_tr_b16 a[0:1], v12 offset:8
  ds_read_b64_tr_b16 a[2:3], v12 offset:18440
  ds_read_b64_tr_b16 a[32:33], v12 offset:64
  ds_read_b64_tr_b16 a[34:35], v12 offset:18496
  ds_read_b64_tr_b16 a[64:65], v12 offset:72
  ds_read_b64_tr_b16 a[66:67], v12 offset:18504
  ds_read_b64_tr_b16 a[96:97], v12 offset:128
  ds_read_b64_tr_b16 a[98:99], v12 offset:18560
  ds_read_b64_tr_b16 a[128:129], v12 offset:136
  ds_read_b64_tr_b16 a[130:131], v12 offset:18568
  ds_read_b64_tr_b16 a[160:161], v12 offset:192
  ds_read_b64_tr_b16 a[162:163], v12 offset:18624
  ds_read_b64_tr_b16 a[192:193], v12 offset:200
  ds_read_b64_tr_b16 a[194:195], v12 offset:18632
  ds_read_b64_tr_b16 a[224:225], v12 offset:256
  ds_read_b64_tr_b16 a[226:227], v12 offset:18688
  s_waitcnt lgkmcnt(0)
  s_barrier
  s_add_u32 m0, s42, 0
  s_add_u32 s51, s45, 147456
  buffer_load_dwordx4 v1, s[16:19], s51 offen offset:0 lds
  buffer_load_dwordx4 v1, s[16:19], s51 offen offset:1024 lds
  buffer_load_dwordx4 v1, s[16:19], s51 offen offset:2048 lds
  buffer_load_dwordx4 v1, s[16:19], s51 offen offset:3072 lds
  s_add_u32 m0, s42, 4096
  s_add_u32 s51, s45, 151552
  buffer_load_dwordx4 v1, s[16:19], s51 offen offset:0 lds
  buffer_load_dwordx4 v1, s[16:19], s51 offen offset:1024 lds
  buffer_load_dwordx4 v1, s[16:19], s51 offen offset:2048 lds
  buffer_load_dwordx4 v1, s[16:19], s51 offen offset:3072 lds
  s_add_u32 m0, s42, 8192
  s_add_u32 s51, s45, 155648
  buffer_load_dwordx4 v1, s[16:19], s51 offen offset:0 lds
  s_waitcnt vmcnt(27)
  s_barrier
  ds_read_b64_tr_b16 v[228:229], v12 offset:36864
  ds_read_b64_tr_b16 v[230:231], v12 offset:55296
  ds_read_b64_tr_b16 a[4:5], v12 offset:36872
  ds_read_b64_tr_b16 a[6:7], v12 offset:55304
  ds_read_b64_tr_b16 a[36:37], v12 offset:36928
  ds_read_b64_tr_b16 a[38:39], v12 offset:55360
  ds_read_b64_tr_b16 a[68:69], v12 offset:36936
  ds_read_b64_tr_b16 a[70:71], v12 offset:55368
  ds_read_b64_tr_b16 a[100:101], v12 offset:36992
  ds_read_b64_tr_b16 a[102:103], v12 offset:55424
  ds_read_b64_tr_b16 a[132:133], v12 offset:37000
  ds_read_b64_tr_b16 a[134:135], v12 offset:55432
  ds_read_b64_tr_b16 a[164:165], v12 offset:37056
  ds_read_b64_tr_b16 a[166:167], v12 offset:55488
  ds_read_b64_tr_b16 a[196:197], v12 offset:37064
  ds_read_b64_tr_b16 a[198:199], v12 offset:55496
  ds_read_b64_tr_b16 a[228:229], v12 offset:37120
  ds_read_b64_tr_b16 a[230:231], v12 offset:55552
  s_waitcnt lgkmcnt(0)
  s_barrier
  s_add_u32 m0, s42, 36864
  s_add_u32 s51, s45, 184320
  buffer_load_dwordx4 v1, s[16:19], s51 offen offset:0 lds
  buffer_load_dwordx4 v1, s[16:19], s51 offen offset:1024 lds
  buffer_load_dwordx4 v1, s[16:19], s51 offen offset:2048 lds
  buffer_load_dwordx4 v1, s[16:19], s51 offen offset:3072 lds
  s_add_u32 m0, s42, 40960
  s_add_u32 s51, s45, 188416
  buffer_load_dwordx4 v1, s[16:19], s51 offen offset:0 lds
  buffer_load_dwordx4 v1, s[16:19], s51 offen offset:1024 lds
  buffer_load_dwordx4 v1, s[16:19], s51 offen offset:2048 lds
  buffer_load_dwordx4 v1, s[16:19], s51 offen offset:3072 lds
  s_add_u32 m0, s42, 45056
  s_add_u32 s51, s45, 192512
  buffer_load_dwordx4 v1, s[16:19], s51 offen offset:0 lds
  s_waitcnt vmcnt(27)
  s_barrier
  ds_read_b64_tr_b16 v[232:233], v13 offset:0
  ds_read_b64_tr_b16 v[234:235], v13 offset:18432
  ds_read_b64_tr_b16 a[8:9], v13 offset:8
  ds_read_b64_tr_b16 a[10:11], v13 offset:18440
  ds_read_b64_tr_b16 a[40:41], v13 offset:64
  ds_read_b64_tr_b16 a[42:43], v13 offset:18496
  ds_read_b64_tr_b16 a[72:73], v13 offset:72
  ds_read_b64_tr_b16 a[74:75], v13 offset:18504
  ds_read_b64_tr_b16 a[104:105], v13 offset:128
  ds_read_b64_tr_b16 a[106:107], v13 offset:18560
  ds_read_b64_tr_b16 a[136:137], v13 offset:136
  ds_read_b64_tr_b16 a[138:139], v13 offset:18568
  ds_read_b64_tr_b16 a[168:169], v13 offset:192
  ds_read_b64_tr_b16 a[170:171], v13 offset:18624
  ds_read_b64_tr_b16 a[200:201], v13 offset:200
  ds_read_b64_tr_b16 a[202:203], v13 offset:18632
  ds_read_b64_tr_b16 a[232:233], v13 offset:256
  ds_read_b64_tr_b16 a[234:235], v13 offset:18688
  s_waitcnt lgkmcnt(0)
  s_barrier
  s_add_u32 m0, s42, 73728
  s_add_u32 s51, s45, 221184
  buffer_load_dwordx4 v1, s[16:19], s51 offen offset:0 lds
  buffer_load_dwordx4 v1, s[16:19], s51 offen offset:1024 lds
  buffer_load_dwordx4 v1, s[16:19], s51 offen offset:2048 lds
  buffer_load_dwordx4 v1, s[16:19], s51 offen offset:3072 lds
  s_add_u32 m0, s42, 77824
  s_add_u32 s51, s45, 225280
  buffer_load_dwordx4 v1, s[16:19], s51 offen offset:0 lds
  buffer_load_dwordx4 v1, s[16:19], s51 offen offset:1024 lds
  buffer_load_dwordx4 v1, s[16:19], s51 offen offset:2048 lds
  buffer_load_dwordx4 v1, s[16:19], s51 offen offset:3072 lds
  s_add_u32 m0, s42, 81920
  s_add_u32 s51, s45, 229376
  buffer_load_dwordx4 v1, s[16:19], s51 offen offset:0 lds
  s_waitcnt vmcnt(27)
  s_barrier
  ds_read_b64_tr_b16 v[236:237], v13 offset:36864
  ds_read_b64_tr_b16 v[238:239], v13 offset:55296
  ds_read_b64_tr_b16 a[12:13], v13 offset:36872
  ds_read_b64_tr_b16 a[14:15], v13 offset:55304
  ds_read_b64_tr_b16 a[44:45], v13 offset:36928
  ds_read_b64_tr_b16 a[46:47], v13 offset:55360
  ds_read_b64_tr_b16 a[76:77], v13 offset:36936
  ds_read_b64_tr_b16 a[78:79], v13 offset:55368
  ds_read_b64_tr_b16 a[108:109], v13 offset:36992
  ds_read_b64_tr_b16 a[110:111], v13 offset:55424
  ds_read_b64_tr_b16 a[140:141], v13 offset:37000
  ds_read_b64_tr_b16 a[142:143], v13 offset:55432
  ds_read_b64_tr_b16 a[172:173], v13 offset:37056
  ds_read_b64_tr_b16 a[174:175], v13 offset:55488
  ds_read_b64_tr_b16 a[204:205], v13 offset:37064
  ds_read_b64_tr_b16 a[206:207], v13 offset:55496
  ds_read_b64_tr_b16 a[236:237], v13 offset:37120
  ds_read_b64_tr_b16 a[238:239], v13 offset:55552
  s_waitcnt lgkmcnt(0)
  s_barrier
  s_add_u32 m0, s42, 110592
  s_add_u32 s51, s45, 258048
  buffer_load_dwordx4 v1, s[16:19], s51 offen offset:0 lds
  buffer_load_dwordx4 v1, s[16:19], s51 offen offset:1024 lds
  buffer_load_dwordx4 v1, s[16:19], s51 offen offset:2048 lds
  buffer_load_dwordx4 v1, s[16:19], s51 offen offset:3072 lds
  s_add_u32 m0, s42, 114688
  s_add_u32 s51, s45, 262144
  buffer_load_dwordx4 v1, s[16:19], s51 offen offset:0 lds
  buffer_load_dwordx4 v1, s[16:19], s51 offen offset:1024 lds
  buffer_load_dwordx4 v1, s[16:19], s51 offen offset:2048 lds
  buffer_load_dwordx4 v1, s[16:19], s51 offen offset:3072 lds
  s_add_u32 m0, s42, 118784
  s_add_u32 s51, s45, 266240
  buffer_load_dwordx4 v1, s[16:19], s51 offen offset:0 lds
  s_waitcnt vmcnt(27)
  s_barrier
  ds_read_b64_tr_b16 v[240:241], v12 offset:0
  ds_read_b64_tr_b16 v[242:243], v12 offset:18432
  ds_read_b64_tr_b16 a[16:17], v12 offset:8
  ds_read_b64_tr_b16 a[18:19], v12 offset:18440
  ds_read_b64_tr_b16 a[48:49], v12 offset:64
  ds_read_b64_tr_b16 a[50:51], v12 offset:18496
  ds_read_b64_tr_b16 a[80:81], v12 offset:72
  ds_read_b64_tr_b16 a[82:83], v12 offset:18504
  ds_read_b64_tr_b16 a[112:113], v12 offset:128
  ds_read_b64_tr_b16 a[114:115], v12 offset:18560
  ds_read_b64_tr_b16 a[144:145], v12 offset:136
  ds_read_b64_tr_b16 a[146:147], v12 offset:18568
  ds_read_b64_tr_b16 a[176:177], v12 offset:192
  ds_read_b64_tr_b16 a[178:179], v12 offset:18624
  ds_read_b64_tr_b16 a[208:209], v12 offset:200
  ds_read_b64_tr_b16 a[210:211], v12 offset:18632
  ds_read_b64_tr_b16 a[240:241], v12 offset:256
  ds_read_b64_tr_b16 a[242:243], v12 offset:18688
  s_waitcnt lgkmcnt(0)
  s_waitcnt vmcnt(18)
  s_barrier
  ds_read_b64_tr_b16 v[244:245], v12 offset:36864
  ds_read_b64_tr_b16 v[246:247], v12 offset:55296
  ds_read_b64_tr_b16 a[20:21], v12 offset:36872
  ds_read_b64_tr_b16 a[22:23], v12 offset:55304
  ds_read_b64_tr_b16 a[52:53], v12 offset:36928
  ds_read_b64_tr_b16 a[54:55], v12 offset:55360
  ds_read_b64_tr_b16 a[84:85], v12 offset:36936
  ds_read_b64_tr_b16 a[86:87], v12 offset:55368
  ds_read_b64_tr_b16 a[116:117], v12 offset:36992
  ds_read_b64_tr_b16 a[118:119], v12 offset:55424
  ds_read_b64_tr_b16 a[148:149], v12 offset:37000
  ds_read_b64_tr_b16 a[150:151], v12 offset:55432
  ds_read_b64_tr_b16 a[180:181], v12 offset:37056
  ds_read_b64_tr_b16 a[182:183], v12 offset:55488
  ds_read_b64_tr_b16 a[212:213], v12 offset:37064
  ds_read_b64_tr_b16 a[214:215], v12 offset:55496
  ds_read_b64_tr_b16 a[244:245], v12 offset:37120
  ds_read_b64_tr_b16 a[246:247], v12 offset:55552
  s_waitcnt lgkmcnt(0)
  s_waitcnt vmcnt(9)
  s_barrier
  ds_read_b64_tr_b16 v[248:249], v13 offset:0
  ds_read_b64_tr_b16 v[250:251], v13 offset:18432
  ds_read_b64_tr_b16 a[24:25], v13 offset:8
  ds_read_b64_tr_b16 a[26:27], v13 offset:18440
  ds_read_b64_tr_b16 a[56:57], v13 offset:64
  ds_read_b64_tr_b16 a[58:59], v13 offset:18496
  ds_read_b64_tr_b16 a[88:89], v13 offset:72
  ds_read_b64_tr_b16 a[90:91], v13 offset:18504
  ds_read_b64_tr_b16 a[120:121], v13 offset:128
  ds_read_b64_tr_b16 a[122:123], v13 offset:18560
  ds_read_b64_tr_b16 a[152:153], v13 offset:136
  ds_read_b64_tr_b16 a[154:155], v13 offset:18568
  ds_read_b64_tr_b16 a[184:185], v13 offset:192
  ds_read_b64_tr_b16 a[186:187], v13 offset:18624
  ds_read_b64_tr_b16 a[216:217], v13 offset:200
  ds_read_b64_tr_b16 a[218:219], v13 offset:18632
  ds_read_b64_tr_b16 a[248:249], v13 offset:256
  ds_read_b64_tr_b16 a[250:251], v13 offset:18688
  s_waitcnt lgkmcnt(0)
  s_waitcnt vmcnt(0)
  s_barrier
  ds_read_b64_tr_b16 v[252:253], v13 offset:36864
  ds_read_b64_tr_b16 v[254:255], v13 offset:55296
  ds_read_b64_tr_b16 a[28:29], v13 offset:36872
  ds_read_b64_tr_b16 a[30:31], v13 offset:55304
  ds_read_b64_tr_b16 a[60:61], v13 offset:36928
  ds_read_b64_tr_b16 a[62:63], v13 offset:55360
  ds_read_b64_tr_b16 a[92:93], v13 offset:36936
  ds_read_b64_tr_b16 a[94:95], v13 offset:55368
  ds_read_b64_tr_b16 a[124:125], v13 offset:36992
  ds_read_b64_tr_b16 a[126:127], v13 offset:55424
  ds_read_b64_tr_b16 a[156:157], v13 offset:37000
  ds_read_b64_tr_b16 a[158:159], v13 offset:55432
  ds_read_b64_tr_b16 a[188:189], v13 offset:37056
  ds_read_b64_tr_b16 a[190:191], v13 offset:55488
  ds_read_b64_tr_b16 a[220:221], v13 offset:37064
  ds_read_b64_tr_b16 a[222:223], v13 offset:55496
  ds_read_b64_tr_b16 a[252:253], v13 offset:37120
  ds_read_b64_tr_b16 a[254:255], v13 offset:55552
  s_waitcnt lgkmcnt(0)
  v_and_b32 v10, 15, v0
  v_lshrrev_b32 v11, 4, v0
  v_lshrrev_b32 v12, 2, v10
  v_and_b32 v13, 1, v0
  v_lshl_add_u32 v14, v12, 1, v13
  v_lshlrev_b32 v14, 4, v14
  v_lshl_add_u32 v2, v11, 7, v14
  v_lshlrev_b32 v3, 3, v0
  v_lshrrev_b32 v14, 1, v10
  v_mul_u32_u24 v14, 36864, v14
  v_lshl_add_u32 v14, v13, 6, v14
  v_lshl_add_u32 v14, v11, 4, v14
  s_mul_i32 s34, s43, 2304
  v_add_u32 v4, s34, v14
  v_mul_u32_u24 v14, 2304, v11
  v_and_b32 v15, 3, v0
  v_lshl_add_u32 v14, v15, 4, v14
  s_mul_i32 s34, s43, 36864
  s_add_u32 s34, s34, 0
  v_add_u32 v14, s34, v14
  v_lshl_add_u32 v5, v12, 7, v14
  v_and_b32 v8, 1, v12
  v_lshl_add_u32 v8, v8, 7, v14
  s_mul_i32 s34, s43, 2304
  s_add_u32 s34, s34, 0
  v_lshlrev_b32 v15, 4, v15
  v_add_u32 v15, s34, v15
  v_lshrrev_b32 v14, 1, v12
  v_mul_u32_u24 v14, 9, v14
  v_and_b32 v13, 1, v12
  v_mul_u32_u24 v10, 5, v13
  v_add_u32 v14, v14, v10
  v_lshrrev_b32 v10, 1, v11
  v_add_u32 v14, v14, v10
  v_lshl_add_u32 v14, v14, 6, v15
  v_and_b32 v11, 1, v11
  v_lshl_add_u32 v6, v11, 3, v14
  v_lshl_add_u32 v9, v11, 7, v14
  v_mul_u32_u24 v13, 576, v13
  v_add_u32 v13, 256, v13
  v_add_u32 v13, v13, v15
  v_lshl_add_u32 v13, v11, 3, v13
  s_mov_b32 s34, 0x00ff00ff
  s_mov_b32 s35, 0
  v_mov_b32 v14, 0x80000000
  v_cndmask_b32 v7, v14, v13, s[34:35]
  v_and_b32 v10, 15, v0
  v_and_b32 v11, 1, v10
  v_lshlrev_b32 v11, 4, v11
  v_mov_b32 v12, 0x3f80
  v_lshlrev_b32 v12, v11, v12
  v_lshrrev_b32 v10, 1, v10
  v_cmp_eq_u32 vcc, 0, v10
  s_nop 1
  v_cndmask_b32 v212, 0, v12, vcc
  v_cmp_eq_u32 vcc, 1, v10
  s_nop 1
  v_cndmask_b32 v213, 0, v12, vcc
  v_cmp_eq_u32 vcc, 2, v10
  s_nop 1
  v_cndmask_b32 v214, 0, v12, vcc
  v_cmp_eq_u32 vcc, 3, v10
  s_nop 1
  v_cndmask_b32 v215, 0, v12, vcc
  v_and_b32 v10, 15, v0
  v_xor_b32 v10, 8, v10
  v_and_b32 v11, 1, v10
  v_lshlrev_b32 v11, 4, v11
  v_mov_b32 v12, 0x3f80
  v_lshlrev_b32 v12, v11, v12
  v_lshrrev_b32 v10, 1, v10
  v_cmp_eq_u32 vcc, 0, v10
  s_nop 1
  v_cndmask_b32 v216, 0, v12, vcc
  v_cmp_eq_u32 vcc, 1, v10
  s_nop 1
  v_cndmask_b32 v217, 0, v12, vcc
  v_cmp_eq_u32 vcc, 2, v10
  s_nop 1
  v_cndmask_b32 v218, 0, v12, vcc
  v_cmp_eq_u32 vcc, 3, v10
  s_nop 1
  v_cndmask_b32 v219, 0, v12, vcc
  s_lshl_b32 s34, s43, 8
  s_add_u32 s92, s34, 0
  s_add_u32 s94, s34, 6144
  s_lshl_b32 s34, s43, 7
  s_add_u32 s93, s34, 4096
  s_mov_b32 s48, 0
  s_mov_b32 s49, 0
  s_mov_b32 s52, 0xfff0ffff
  s_mov_b32 s53, 0xf000ff00
  s_mov_b32 s54, 0xffe0fffe
  s_mov_b32 s55, 0xe000fe00
  s_mov_b32 s56, 0xffc0fffc
  s_mov_b32 s57, 0xc000fc00
  s_mov_b32 s58, 0xff80fff8
  s_mov_b32 s59, 0x8000f800
  s_mov_b32 s46, 0x3e0293ee
  s_mov_b32 s47, 0xbe0293ee
  s_mul_i32 s34, s44, 1179648
  s_mul_i32 s35, s43, 36864
  s_add_u32 s34, s34, s35
  s_sub_u32 s35, s32, 48
  s_mul_i32 s35, s35, 36864
  v_mov_b64 v[16:17], -1
  v_mov_b64 v[18:19], -1
  s_add_u32 s51, s34, 69206016
  buffer_store_dwordx4 v[16:19], v1, s[4:7], s51 offen offset:0 sc1
  buffer_store_dwordx4 v[16:19], v1, s[4:7], s51 offen offset:1024 sc1
  buffer_store_dwordx4 v[16:19], v1, s[4:7], s51 offen offset:2048 sc1
  buffer_store_dwordx4 v[16:19], v1, s[4:7], s51 offen offset:3072 sc1
  s_add_u32 s51, s34, 69210112
  buffer_store_dwordx4 v[16:19], v1, s[4:7], s51 offen offset:0 sc1
  buffer_store_dwordx4 v[16:19], v1, s[4:7], s51 offen offset:1024 sc1
  buffer_store_dwordx4 v[16:19], v1, s[4:7], s51 offen offset:2048 sc1
  buffer_store_dwordx4 v[16:19], v1, s[4:7], s51 offen offset:3072 sc1
  s_add_u32 s51, s34, 69214208
  buffer_store_dwordx4 v[16:19], v1, s[4:7], s51 offen offset:0 sc1
  s_add_u32 s51, s34, 69795840
  buffer_store_dwordx4 v[16:19], v1, s[4:7], s51 offen offset:0 sc1
  buffer_store_dwordx4 v[16:19], v1, s[4:7], s51 offen offset:1024 sc1
  buffer_store_dwordx4 v[16:19], v1, s[4:7], s51 offen offset:2048 sc1
  buffer_store_dwordx4 v[16:19], v1, s[4:7], s51 offen offset:3072 sc1
  s_add_u32 s51, s34, 69799936
  buffer_store_dwordx4 v[16:19], v1, s[4:7], s51 offen offset:0 sc1
  buffer_store_dwordx4 v[16:19], v1, s[4:7], s51 offen offset:1024 sc1
  buffer_store_dwordx4 v[16:19], v1, s[4:7], s51 offen offset:2048 sc1
  buffer_store_dwordx4 v[16:19], v1, s[4:7], s51 offen offset:3072 sc1
  s_add_u32 s51, s34, 69804032
  buffer_store_dwordx4 v[16:19], v1, s[4:7], s51 offen offset:0 sc1
  s_add_u32 s51, s35, 4194304
  buffer_store_dwordx4 v[16:19], v1, s[4:7], s51 offen offset:0 sc1
  buffer_store_dwordx4 v[16:19], v1, s[4:7], s51 offen offset:1024 sc1
  buffer_store_dwordx4 v[16:19], v1, s[4:7], s51 offen offset:2048 sc1
  buffer_store_dwordx4 v[16:19], v1, s[4:7], s51 offen offset:3072 sc1
  s_add_u32 s51, s35, 4198400
  buffer_store_dwordx4 v[16:19], v1, s[4:7], s51 offen offset:0 sc1
  buffer_store_dwordx4 v[16:19], v1, s[4:7], s51 offen offset:1024 sc1
  buffer_store_dwordx4 v[16:19], v1, s[4:7], s51 offen offset:2048 sc1
  buffer_store_dwordx4 v[16:19], v1, s[4:7], s51 offen offset:3072 sc1
  s_add_u32 s51, s35, 4202496
  buffer_store_dwordx4 v[16:19], v1, s[4:7], s51 offen offset:0 sc1
  s_add_u32 s51, s35, 7340032
  buffer_store_dwordx4 v[16:19], v1, s[4:7], s51 offen offset:0 sc1
  buffer_store_dwordx4 v[16:19], v1, s[4:7], s51 offen offset:1024 sc1
  buffer_store_dwordx4 v[16:19], v1, s[4:7], s51 offen offset:2048 sc1
  buffer_store_dwordx4 v[16:19], v1, s[4:7], s51 offen offset:3072 sc1
  s_add_u32 s51, s35, 7344128
  buffer_store_dwordx4 v[16:19], v1, s[4:7], s51 offen offset:0 sc1
  buffer_store_dwordx4 v[16:19], v1, s[4:7], s51 offen offset:1024 sc1
  buffer_store_dwordx4 v[16:19], v1, s[4:7], s51 offen offset:2048 sc1
  buffer_store_dwordx4 v[16:19], v1, s[4:7], s51 offen offset:3072 sc1
  s_add_u32 s51, s35, 7348224
  buffer_store_dwordx4 v[16:19], v1, s[4:7], s51 offen offset:0 sc1
  s_cmp_lt_u32 s32, 104
  s_cbranch_scc1 L_nof_10
  s_mul_i32 s34, s43, 36864
  v_mov_b64 v[16:17], -1
  v_mov_b64 v[18:19], -1
  s_add_u32 s51, s34, 73924608
  buffer_store_dwordx4 v[16:19], v1, s[4:7], s51 offen offset:0 sc1
  buffer_store_dwordx4 v[16:19], v1, s[4:7], s51 offen offset:1024 sc1
  buffer_store_dwordx4 v[16:19], v1, s[4:7], s51 offen offset:2048 sc1
  buffer_store_dwordx4 v[16:19], v1, s[4:7], s51 offen offset:3072 sc1
  s_add_u32 s51, s34, 73928704
  buffer_store_dwordx4 v[16:19], v1, s[4:7], s51 offen offset:0 sc1
  buffer_store_dwordx4 v[16:19], v1, s[4:7], s51 offen offset:1024 sc1
  buffer_store_dwordx4 v[16:19], v1, s[4:7], s51 offen offset:2048 sc1
  buffer_store_dwordx4 v[16:19], v1, s[4:7], s51 offen offset:3072 sc1
  s_add_u32 s51, s34, 73932800
  buffer_store_dwordx4 v[16:19], v1, s[4:7], s51 offen offset:0 sc1
L_nof_10:
  s_waitcnt vmcnt(0)
  s_barrier
  s_cmp_lg_u32 s33, 0
  s_cbranch_scc1 L_meet_11
  v_mov_b32 v10, 1
  s_mov_b64 exec, 1
  buffer_atomic_add v10, off, s[8:11], 0 offset:24 sc0
  s_waitcnt vmcnt(0)
  v_readfirstlane_b32 s51, v10
  v_mov_b32 v10, 1
  s_cmp_lg_u32 s51, 63
  s_cbranch_scc1 L_cnt_12
  buffer_store_dword v10, off, s[8:11], 0 offset:144 sc1
L_cnt_12:
  s_mov_b64 exec, -1
L_ai_13:
  buffer_load_dword v10, off, s[8:11], 0 offset:4 sc1
  s_add_u32 s50, s50, 1
  s_cmp_ge_u32 s50, 262144
  s_waitcnt vmcnt(0)
  s_cbranch_scc1 L_ai_13_x
  v_cmp_ge_u32 vcc, 9, v10
  s_nop 0
  s_cbranch_vccnz L_ai_13
L_ai_13_x:
L_ai_14:
  buffer_load_dword v10, off, s[8:11], 0 offset:144 sc1
  s_add_u32 s50, s50, 1
  s_cmp_ge_u32 s50, 262144
  s_waitcnt vmcnt(0)
  s_cbranch_scc1 L_ai_14_x
  v_cmp_ge_u32 vcc, 0, v10
  s_nop 0
  s_cbranch_vccnz L_ai_14
L_ai_14_x:
L_meet_11:
  s_barrier
  s_mov_b32 s34, 152
  s_cmp_eq_u32 s44, 0
  s_cselect_b32 s39, 32, 16
  s_cmp_eq_u32 s44, 1
  s_cselect_b32 s34, 112, s34
  s_cmp_eq_u32 s44, 2
  s_cselect_b32 s34, 116, s34
  buffer_load_dword v10, off, s[8:11], s34 sc1
  s_waitcnt vmcnt(0)
  v_readfirstlane_b32 s34, v10
  s_nop 0
  s_cmp_ge_u32 s34, s39
  s_cselect_b32 s39, 1, 0
  s_cmp_ge_u32 s34, 32
  s_cselect_b32 s38, s39, 0
  s_sub_u32 s34, s44, 1
  s_cmp_lt_u32 s34, 2
  s_cselect_b32 s38, 0, s38
  s_mov_b32 s40, s44
  s_mov_b32 s42, 0
  s_mov_b32 s61, 0
  s_add_u32 s95, s40, 1
  s_cmp_ge_u32 s48, s95
  s_cbranch_scc1 L_ap_15_x
L_ap_15:
  s_load_dwordx4 s[96:99], s[4:5], s92 glc
  s_load_dwordx2 s[100:101], s[4:5], s93 glc
  s_add_u32 s50, s50, 1
  s_cmp_ge_u32 s50, 262144
  s_cbranch_scc1 L_ap_15_y
  s_waitcnt lgkmcnt(0)
  s_min_u32 s48, s96, s97
  s_min_u32 s48, s48, s98
  s_min_u32 s48, s48, s99
  s_min_u32 s48, s48, s100
  s_min_u32 s48, s48, s101
  s_cmp_lt_u32 s48, s95
  s_cbranch_scc1 L_ap_15
L_ap_15_y:
  s_waitcnt lgkmcnt(0)
L_ap_15_x:
  s_lshl_b32 s34, s40, 5
  s_lshl1_add_u32 s34, s43, s34
  s_add_u32 s34, s34, 0
  s_lshl_b32 s34, s34, 13
  s_add_u32 s51, s34, 18874368
  buffer_load_dwordx4 v[16:19], v1, s[4:7], s51 offen offset:0 sc1
  buffer_load_dwordx4 v[20:23], v1, s[4:7], s51 offen offset:1024 sc1
  buffer_load_dwordx4 v[24:27], v1, s[4:7], s51 offen offset:2048 sc1
  buffer_load_dwordx4 v[28:31], v1, s[4:7], s51 offen offset:3072 sc1
  s_add_u32 s51, s34, 35651584
  buffer_load_dwordx4 v[32:35], v1, s[4:7], s51 offen offset:0 sc1
  buffer_load_dwordx4 v[36:39], v1, s[4:7], s51 offen offset:1024 sc1
  buffer_load_dwordx4 v[40:43], v1, s[4:7], s51 offen offset:2048 sc1
  buffer_load_dwordx4 v[44:47], v1, s[4:7], s51 offen offset:3072 sc1
  s_add_u32 s51, s34, 52428800
  buffer_load_dwordx4 v[64:67], v1, s[4:7], s51 offen offset:0 sc1
  buffer_load_dwordx4 v[68:71], v1, s[4:7], s51 offen offset:1024 sc1
  buffer_load_dwordx4 v[72:75], v1, s[4:7], s51 offen offset:2048 sc1
  buffer_load_dwordx4 v[76:79], v1, s[4:7], s51 offen offset:3072 sc1
  s_add_u32 s51, s34, 52432896
  buffer_load_dwordx4 v[80:83], v1, s[4:7], s51 offen offset:0 sc1
  buffer_load_dwordx4 v[84:87], v1, s[4:7], s51 offen offset:1024 sc1
  buffer_load_dwordx4 v[88:91], v1, s[4:7], s51 offen offset:2048 sc1
  buffer_load_dwordx4 v[92:95], v1, s[4:7], s51 offen offset:3072 sc1
.p2align 5
L_att_l0:
  s_lshl_b32 s41, s40, 5
  s_lshl1_add_u32 s41, s43, s41
  s_add_u32 s41, s41, 0
  s_lshl_b32 s41, s41, 11
  s_bfe_u32 s60, s61, 0x10001
  s_and_b32 s34, s61, 1
  s_add_u32 s61, s61, 1
  s_lshl1_add_u32 s34, s44, s34
  s_mul_i32 s45, s34, 589824
  s_add_u32 s45, s45, 69206016
  v_mov_b32 v140, 0x3f803f80
  v_mov_b32 v141, 0x3f803f80
  v_mov_b64 v[142:143], v[140:141]
  v_mov_b64_e64 v[136:137], 0
  v_mov_b64_e64 v[138:139], 0
  v_mov_b64_e64 v[134:135], 0
  s_waitcnt vmcnt(0)
  v_mfma_f32_16x16x32_bf16 v[124:127], v[32:35], v[16:19], 0
  v_mfma_f32_16x16x32_bf16 v[124:127], v[36:39], v[20:23], v[124:127]
  v_mfma_f32_16x16x32_bf16 v[124:127], v[40:43], v[24:27], v[124:127]
  v_mfma_f32_16x16x32_bf16 v[124:127], v[44:47], v[28:31], v[124:127]
  v_mov_b32 v10, 0xff800000
  s_nop 6
  v_cndmask_b32 v124, v10, v124, s[52:53]
  v_cndmask_b32 v125, v10, v125, s[54:55]
  v_cndmask_b32 v126, v10, v126, s[56:57]
  v_cndmask_b32 v127, v10, v127, s[58:59]
  v_max3_f32 v12, v124, v125, v126
  v_max_f32 v12, v12, v127
  s_cmp_lt_u32 s40, 63
  s_cbranch_scc1 L_att_l0_ncp
  s_getpc_b64 s[96:97]
L_att_l0_pc:
  s_add_u32 s96, s96, L_att_l0_w0-L_att_l0_pc
  s_addc_u32 s97, s97, 0
  v_lshlrev_b32 v148, 2, v1
  v_mov_b32_e64 v149, s97
  v_add_co_u32 v148, vcc, s96, v148
  s_nop 1
  v_addc_co_u32 v149, vcc, 0, v149, vcc
  global_load_dword v150, v[148:149], off
L_att_l0_ncp:
  s_cmp_lt_u32 s40, 56
  s_addc_u32 s95, s40, 0
  s_cmp_eq_u32 s40, 63
  s_cselect_b32 s95, 62, s95
  s_cmp_ge_u32 s49, s95
  s_cbranch_scc1 L_ac_16_x
L_ac_16:
  s_load_dword s96, s[4:5], s94 glc
  s_add_u32 s50, s50, 1
  s_cmp_ge_u32 s50, 262144
  s_cbranch_scc1 L_ac_16_y
  s_waitcnt lgkmcnt(0)
  s_mov_b32 s49, s96
  s_cmp_lt_u32 s49, s95
  s_cbranch_scc1 L_ac_16
L_ac_16_y:
  s_waitcnt lgkmcnt(0)
L_ac_16_x:
L_att_k0:
  s_add_u32 s51, s41, 10485760
  buffer_load_dwordx4 v[96:99], v2, s[4:7], s51 offen offset:0 sc1
  buffer_load_dwordx4 v[100:103], v2, s[4:7], s51 offen offset:512 sc1
  buffer_load_dwordx4 v[104:107], v2, s[4:7], s51 offen offset:1024 sc1
  buffer_load_dwordx4 v[108:111], v2, s[4:7], s51 offen offset:1536 sc1
  s_add_u32 s51, s41, 14680064
  buffer_load_dwordx2 v[112:113], v3, s[4:7], s51 offen offset:0 sc1
  buffer_load_dwordx2 v[114:115], v3, s[4:7], s51 offen offset:512 sc1
  buffer_load_dwordx2 v[116:117], v3, s[4:7], s51 offen offset:1024 sc1
  buffer_load_dwordx2 v[118:119], v3, s[4:7], s51 offen offset:1536 sc1
  s_waitcnt vmcnt(7)
  v_mfma_f32_16x16x32_bf16 v[120:123], v[96:99], v[16:19], 0
  s_waitcnt vmcnt(6)
  v_mfma_f32_16x16x32_bf16 v[120:123], v[100:103], v[20:23], v[120:123]
  s_waitcnt vmcnt(5)
  v_mfma_f32_16x16x32_bf16 v[120:123], v[104:107], v[24:27], v[120:123]
  s_waitcnt vmcnt(4)
  v_mfma_f32_16x16x32_bf16 v[120:123], v[108:111], v[28:31], v[120:123]
  v_max3_u32 v10, v96, v100, v104
  s_waitcnt vmcnt(0)
  v_max3_u32 v10, v10, v108, v112
  v_max3_u32 v10, v10, v114, v116
  v_max_u32_e64 v10, v10, v118
  v_cmp_eq_u32_e64 vcc, -1, v10
  s_nop 0
  s_cbranch_vccz L_att_k0_x
  s_add_u32 s50, s50, 1
  s_cmp_ge_u32 s50, 262144
  s_cbranch_scc1 L_att_k0_x
  s_branch L_att_k0
L_att_k0_x:
  v_max3_f32 v12, v12, v120, v121
  v_mov_b32 v13, v12
  s_nop 1
  v_permlane32_swap_b32 v12, v13
  v_max_f32 v12, v12, v13
  v_mov_b32 v13, v12
  s_nop 1
  v_permlane16_swap_b32 v12, v13
  v_max_f32 v12, v12, v13
  v_mul_f32 v12, s47, v12
  v_fma_f32 v120, v120, s46, v12
  v_fma_f32 v121, v121, s46, v12
  v_fma_f32 v124, v124, s46, v12
  v_fma_f32 v125, v125, s46, v12
  v_fma_f32 v126, v126, s46, v12
  v_fma_f32 v127, v127, s46, v12
  v_exp_f32 v120, v120
  v_exp_f32 v121, v121
  v_exp_f32 v124, v124
  v_exp_f32_e64 v125, v125
  v_exp_f32_e64 v126, v126
  v_exp_f32_e64 v127, v127
  v_cvt_pk_bf16_f32 v132, v124, v125
  v_cvt_pk_bf16_f32 v133, v126, v127
  v_cvt_pk_bf16_f32 v136, v120, v121
  v_cvt_pk_bf16_f32 v139, v120, v121
  v_mfma_f32_16x16x32_bf16 v[144:147], v[140:143], v[132:135], 0
  v_mfma_f32_16x16x32_bf16 v[148:151], v[64:67], v[132:135], 0
  v_mfma_f32_16x16x32_bf16 v[152:155], v[68:71], v[132:135], 0
  v_mfma_f32_16x16x32_bf16 v[156:159], v[72:75], v[132:135], 0
  v_mfma_f32_16x16x32_bf16 v[160:163], v[76:79], v[132:135], 0
  v_mfma_f32_16x16x16_bf16 v[144:147], v[140:141], v[136:137], v[144:147]
  v_mfma_f32_16x16x32_bf16 v[164:167], v[80:83], v[132:135], 0
  v_mfma_f32_16x16x32_bf16 v[168:171], v[84:87], v[132:135], 0
  v_mfma_f32_16x16x32_bf16 v[172:175], v[88:91], v[132:135], 0
  v_mfma_f32_16x16x32_bf16 v[176:179], v[92:95], v[132:135], 0
  v_add_u32 v11, s42, v1
  v_mfma_f32_16x16x16_bf16 v[148:151], v[112:113], v[136:137], v[148:151]
  v_rcp_f32 v12, v144
  v_mfma_f32_16x16x16_bf16 v[152:155], v[112:113], v[138:139], v[152:155]
  v_mfma_f32_16x16x16_bf16 v[156:159], v[114:115], v[136:137], v[156:159]
  v_mfma_f32_16x16x16_bf16 v[160:163], v[114:115], v[138:139], v[160:163]
  v_mfma_f32_16x16x16_bf16 v[164:167], v[116:117], v[136:137], v[164:167]
  v_mfma_f32_16x16x16_bf16 v[168:171], v[116:117], v[138:139], v[168:171]
  v_mfma_f32_16x16x16_bf16 v[172:175], v[118:119], v[136:137], v[172:175]
  v_mfma_f32_16x16x16_bf16 v[176:179], v[118:119], v[138:139], v[176:179]
  v_pk_mul_f32 v[148:149], v[148:149], v[12:13] op_sel_hi:[1,0]
  v_pk_mul_f32 v[150:151], v[150:151], v[12:13] op_sel_hi:[1,0]
  v_pk_mul_f32 v[152:153], v[152:153], v[12:13] op_sel_hi:[1,0]
  v_pk_mul_f32 v[154:155], v[154:155], v[12:13] op_sel_hi:[1,0]
  v_cvt_pk_bf16_f32 v148, v148, v149
  v_cvt_pk_bf16_f32 v149, v150, v151
  v_cvt_pk_bf16_f32 v150, v152, v153
  v_cvt_pk_bf16_f32 v151, v154, v155
  ds_write_b128 v11, v[148:151] offset:0
  v_pk_mul_f32 v[156:157], v[156:157], v[12:13] op_sel_hi:[1,0]
  v_pk_mul_f32 v[158:159], v[158:159], v[12:13] op_sel_hi:[1,0]
  v_pk_mul_f32 v[160:161], v[160:161], v[12:13] op_sel_hi:[1,0]
  v_pk_mul_f32 v[162:163], v[162:163], v[12:13] op_sel_hi:[1,0]
  v_cvt_pk_bf16_f32 v156, v156, v157
  v_cvt_pk_bf16_f32 v157, v158, v159
  v_cvt_pk_bf16_f32 v158, v160, v161
  v_cvt_pk_bf16_f32 v159, v162, v163
  ds_write_b128 v11, v[156:159] offset:1024
  v_pk_mul_f32 v[164:165], v[164:165], v[12:13] op_sel_hi:[1,0]
  v_pk_mul_f32 v[166:167], v[166:167], v[12:13] op_sel_hi:[1,0]
  v_pk_mul_f32 v[168:169], v[168:169], v[12:13] op_sel_hi:[1,0]
  v_pk_mul_f32 v[170:171], v[170:171], v[12:13] op_sel_hi:[1,0]
  v_cvt_pk_bf16_f32 v164, v164, v165
  v_cvt_pk_bf16_f32 v165, v166, v167
  v_cvt_pk_bf16_f32 v166, v168, v169
  v_cvt_pk_bf16_f32 v167, v170, v171
  ds_write_b128 v11, v[164:167] offset:2048
  v_pk_mul_f32 v[172:173], v[172:173], v[12:13] op_sel_hi:[1,0]
  v_pk_mul_f32 v[174:175], v[174:175], v[12:13] op_sel_hi:[1,0]
  v_pk_mul_f32 v[176:177], v[176:177], v[12:13] op_sel_hi:[1,0]
  v_pk_mul_f32 v[178:179], v[178:179], v[12:13] op_sel_hi:[1,0]
  v_cvt_pk_bf16_f32 v172, v172, v173
  v_cvt_pk_bf16_f32 v173, v174, v175
  v_cvt_pk_bf16_f32 v174, v176, v177
  v_cvt_pk_bf16_f32 v175, v178, v179
  ds_write_b128 v11, v[172:175] offset:3072
  s_waitcnt lgkmcnt(0)
  s_barrier
  s_cmp_eq_u32 s39, 0
  s_cbranch_scc1 L_att_l0_ws
  s_cmp_eq_u32 s40, 63
  s_cselect_b32 s34, s38, 0
  s_cmp_eq_u32 s34, 0
  s_cbranch_scc1 L_att_l0_wf
L_att_l0_w0:
  s_cmp_eq_u32 s44, 0
  s_cbranch_scc1 L_att_l0_wh
  ds_read_b128 v[148:151], v11 offset:0
  ds_read_b128 v[156:159], v11 offset:1024
  ds_read_b128 v[164:167], v11 offset:2048
  ds_read_b128 v[172:175], v11 offset:3072
  ds_read_b128 v[180:183], v11 offset:8192
  ds_read_b128 v[188:191], v11 offset:9216
  ds_read_b128 v[196:199], v11 offset:10240
  ds_read_b128 v[204:207], v11 offset:11264
  s_xor_b32 s42, s42, 0x4000
  s_add_u32 s51, s45, 294912
  s_mul_i32 s41, s40, 36864
  s_waitcnt lgkmcnt(7)
  v_mfma_f32_16x16x32_bf16 v[96:99], v[224:227], v[148:151], 0
  v_mfma_f32_16x16x32_bf16 v[100:103], a[0:3], v[148:151], 0
  s_waitcnt lgkmcnt(6)
  v_mfma_f32_16x16x32_bf16 v[96:99], v[228:231], v[156:159], v[96:99]
  v_mfma_f32_16x16x32_bf16 v[100:103], a[4:7], v[156:159], v[100:103]
  s_waitcnt lgkmcnt(5)
  v_mfma_f32_16x16x32_bf16 v[96:99], v[232:235], v[164:167], v[96:99]
  v_mfma_f32_16x16x32_bf16 v[100:103], a[8:11], v[164:167], v[100:103]
  buffer_load_dwordx2 v[48:49], v6, s[12:15], s41 offen offset:0
  s_waitcnt lgkmcnt(4)
  v_mfma_f32_16x16x32_bf16 v[96:99], v[236:239], v[172:175], v[96:99]
  v_mfma_f32_16x16x32_bf16 v[100:103], a[12:15], v[172:175], v[100:103]
  buffer_load_dwordx2 v[50:51], v6, s[12:15], s41 offen offset:128
  s_waitcnt lgkmcnt(3)
  v_mfma_f32_16x16x32_bf16 v[96:99], v[240:243], v[180:183], v[96:99]
  v_mfma_f32_16x16x32_bf16 v[100:103], a[16:19], v[180:183], v[100:103]
  buffer_load_dwordx2 v[52:53], v7, s[12:15], s41 offen offset:0
  s_waitcnt lgkmcnt(2)
  v_mfma_f32_16x16x32_bf16 v[96:99], v[244:247], v[188:191], v[96:99]
  v_mfma_f32_16x16x32_bf16 v[100:103], a[20:23], v[188:191], v[100:103]
  s_waitcnt lgkmcnt(1)
  v_mfma_f32_16x16x32_bf16 v[96:99], v[248:251], v[196:199], v[96:99]
  v_mfma_f32_16x16x32_bf16 v[100:103], a[24:27], v[196:199], v[100:103]
  s_waitcnt lgkmcnt(0)
  v_mfma_f32_16x16x32_bf16 v[96:99], v[252:255], v[204:207], v[96:99]
  v_mfma_f32_16x16x32_bf16 v[100:103], a[28:31], v[204:207], v[100:103]
  v_mfma_f32_16x16x32_bf16 v[112:115], a[32:35], v[148:151], 0
  v_mfma_f32_16x16x32_bf16 v[116:119], a[64:67], v[148:151], 0
  v_mfma_f32_16x16x32_bf16 v[112:115], a[36:39], v[156:159], v[112:115]
  v_cvt_pk_bf16_f32 v96, v96, v97
  v_cvt_pk_bf16_f32 v97, v98, v99
  v_mfma_f32_16x16x32_bf16 v[116:119], a[68:71], v[156:159], v[116:119]
  v_cvt_pk_bf16_f32 v98, v100, v101
  v_cvt_pk_bf16_f32 v99, v102, v103
  v_mfma_f32_16x16x32_bf16 v[112:115], a[40:43], v[164:167], v[112:115]
  v_bfi_b32 v96, 1, s60, v96
  v_bfi_b32 v98, 1, s60, v98
  buffer_store_dwordx4 v[96:99], v4, s[4:7], s45 offen offset:0
  v_mfma_f32_16x16x32_bf16 v[116:119], a[72:75], v[164:167], v[116:119]
  v_mfma_f32_16x16x32_bf16 v[112:115], a[44:47], v[172:175], v[112:115]
  v_mfma_f32_16x16x32_bf16 v[116:119], a[76:79], v[172:175], v[116:119]
  v_mfma_f32_16x16x32_bf16 v[112:115], a[48:51], v[180:183], v[112:115]
  v_mfma_f32_16x16x32_bf16 v[116:119], a[80:83], v[180:183], v[116:119]
  v_mfma_f32_16x16x32_bf16 v[112:115], a[52:55], v[188:191], v[112:115]
  v_mfma_f32_16x16x32_bf16 v[116:119], a[84:87], v[188:191], v[116:119]
  v_mfma_f32_16x16x32_bf16 v[112:115], a[56:59], v[196:199], v[112:115]
  v_mfma_f32_16x16x32_bf16 v[116:119], a[88:91], v[196:199], v[116:119]
  v_mfma_f32_16x16x32_bf16 v[112:115], a[60:63], v[204:207], v[112:115]
  v_mfma_f32_16x16x32_bf16 v[116:119], a[92:95], v[204:207], v[116:119]
  v_mfma_f32_16x16x32_bf16 v[96:99], a[96:99], v[148:151], 0
  v_mfma_f32_16x16x32_bf16 v[100:103], a[128:131], v[148:151], 0
  v_mfma_f32_16x16x32_bf16 v[96:99], a[100:103], v[156:159], v[96:99]
  v_cvt_pk_bf16_f32 v112, v112, v113
  v_cvt_pk_bf16_f32 v113, v114, v115
  v_mfma_f32_16x16x32_bf16 v[100:103], a[132:135], v[156:159], v[100:103]
  v_cvt_pk_bf16_f32 v114, v116, v117
  v_cvt_pk_bf16_f32 v115, v118, v119
  v_mfma_f32_16x16x32_bf16 v[96:99], a[104:107], v[164:167], v[96:99]
  v_bfi_b32 v112, 1, s60, v112
  v_bfi_b32 v114, 1, s60, v114
  buffer_store_dwordx4 v[112:115], v4, s[4:7], s45 offen offset:512
  v_mfma_f32_16x16x32_bf16 v[100:103], a[136:139], v[164:167], v[100:103]
  v_mfma_f32_16x16x32_bf16 v[96:99], a[108:111], v[172:175], v[96:99]
  v_mfma_f32_16x16x32_bf16 v[100:103], a[140:143], v[172:175], v[100:103]
  v_mfma_f32_16x16x32_bf16 v[96:99], a[112:115], v[180:183], v[96:99]
  v_mfma_f32_16x16x32_bf16 v[100:103], a[144:147], v[180:183], v[100:103]
  v_mfma_f32_16x16x32_bf16 v[96:99], a[116:119], v[188:191], v[96:99]
  v_mfma_f32_16x16x32_bf16 v[100:103], a[148:151], v[188:191], v[100:103]
  v_mfma_f32_16x16x32_bf16 v[96:99], a[120:123], v[196:199], v[96:99]
  v_mfma_f32_16x16x32_bf16 v[100:103], a[152:155], v[196:199], v[100:103]
  v_mfma_f32_16x16x32_bf16 v[96:99], a[124:127], v[204:207], v[96:99]
  v_mfma_f32_16x16x32_bf16 v[100:103], a[156:159], v[204:207], v[100:103]
  v_mfma_f32_16x16x32_bf16 v[112:115], a[160:163], v[148:151], 0
  v_mfma_f32_16x16x32_bf16 v[116:119], a[192:195], v[148:151], 0
  v_mfma_f32_16x16x32_bf16 v[112:115], a[164:167], v[156:159], v[112:115]
  v_cvt_pk_bf16_f32 v96, v96, v97
  v_cvt_pk_bf16_f32 v97, v98, v99
  v_mfma_f32_16x16x32_bf16 v[116:119], a[196:199], v[156:159], v[116:119]
  v_cvt_pk_bf16_f32 v98, v100, v101
  v_cvt_pk_bf16_f32 v99, v102, v103
  v_mfma_f32_16x16x32_bf16 v[112:115], a[168:171], v[164:167], v[112:115]
  v_bfi_b32 v96, 1, s60, v96
  v_bfi_b32 v98, 1, s60, v98
  buffer_store_dwordx4 v[96:99], v4, s[4:7], s45 offen offset:1024
  v_mfma_f32_16x16x32_bf16 v[116:119], a[200:203], v[164:167], v[116:119]
  v_mfma_f32_16x16x32_bf16 v[112:115], a[172:175], v[172:175], v[112:115]
  v_mfma_f32_16x16x32_bf16 v[116:119], a[204:207], v[172:175], v[116:119]
  v_mfma_f32_16x16x32_bf16 v[112:115], a[176:179], v[180:183], v[112:115]
  v_mfma_f32_16x16x32_bf16 v[116:119], a[208:211], v[180:183], v[116:119]
  v_mfma_f32_16x16x32_bf16 v[112:115], a[180:183], v[188:191], v[112:115]
  v_mfma_f32_16x16x32_bf16 v[116:119], a[212:215], v[188:191], v[116:119]
  v_mfma_f32_16x16x32_bf16 v[112:115], a[184:187], v[196:199], v[112:115]
  v_mfma_f32_16x16x32_bf16 v[116:119], a[216:219], v[196:199], v[116:119]
  v_mfma_f32_16x16x32_bf16 v[112:115], a[188:191], v[204:207], v[112:115]
  v_mfma_f32_16x16x32_bf16 v[116:119], a[220:223], v[204:207], v[116:119]
  v_mfma_f32_16x16x32_bf16 v[96:99], a[224:227], v[148:151], 0
  v_mfma_f32_16x16x32_bf16 v[96:99], a[228:231], v[156:159], v[96:99]
  v_mfma_f32_16x16x32_bf16 v[96:99], a[232:235], v[164:167], v[96:99]
  v_cvt_pk_bf16_f32 v112, v112, v113
  v_cvt_pk_bf16_f32 v113, v114, v115
  v_mfma_f32_16x16x32_bf16 v[96:99], a[236:239], v[172:175], v[96:99]
  v_cvt_pk_bf16_f32 v114, v116, v117
  v_cvt_pk_bf16_f32 v115, v118, v119
  v_mfma_f32_16x16x32_bf16 v[96:99], a[240:243], v[180:183], v[96:99]
  v_bfi_b32 v112, 1, s60, v112
  v_bfi_b32 v114, 1, s60, v114
  buffer_store_dwordx4 v[112:115], v4, s[4:7], s45 offen offset:1536
  v_mfma_f32_16x16x32_bf16 v[96:99], a[244:247], v[188:191], v[96:99]
  v_mfma_f32_16x16x32_bf16 v[96:99], a[248:251], v[196:199], v[96:99]
  v_mfma_f32_16x16x32_bf16 v[96:99], a[252:255], v[204:207], v[96:99]
  s_nop 7
  v_cvt_pk_bf16_f32 v96, v96, v97
  v_cvt_pk_bf16_f32 v97, v98, v99
  v_bfi_b32 v96, 1, s60, v96
  buffer_store_dwordx2 v[96:97], v4, s[4:7], s45 offen offset:2048
  s_cmp_ge_u32 s43, 8
  s_cselect_b32 s45, 73924608, s45
  s_cselect_b32 s60, 0, s60
  s_branch L_att_l0_wx
L_att_l0_wh:
  s_mov_b32 s45, 73924608
  s_mov_b32 s60, 0
  ds_read_b128 v[152:155], v11 offset:4096
  ds_read_b128 v[160:163], v11 offset:5120
  ds_read_b128 v[168:171], v11 offset:6144
  ds_read_b128 v[176:179], v11 offset:7168
  ds_read_b128 v[184:187], v11 offset:12288
  ds_read_b128 v[192:195], v11 offset:13312
  ds_read_b128 v[200:203], v11 offset:14336
  ds_read_b128 v[208:211], v11 offset:15360
  s_xor_b32 s42, s42, 0x4000
  s_add_u32 s51, s45, 294912
  s_mul_i32 s41, s40, 36864
  s_waitcnt lgkmcnt(7)
  v_mfma_f32_16x16x32_bf16 v[104:107], v[224:227], v[152:155], 0
  v_mfma_f32_16x16x32_bf16 v[108:111], a[0:3], v[152:155], 0
  s_waitcnt lgkmcnt(6)
  v_mfma_f32_16x16x32_bf16 v[104:107], v[228:231], v[160:163], v[104:107]
  v_mfma_f32_16x16x32_bf16 v[108:111], a[4:7], v[160:163], v[108:111]
  s_waitcnt lgkmcnt(5)
  v_mfma_f32_16x16x32_bf16 v[104:107], v[232:235], v[168:171], v[104:107]
  v_mfma_f32_16x16x32_bf16 v[108:111], a[8:11], v[168:171], v[108:111]
  s_waitcnt lgkmcnt(4)
  v_mfma_f32_16x16x32_bf16 v[104:107], v[236:239], v[176:179], v[104:107]
  v_mfma_f32_16x16x32_bf16 v[108:111], a[12:15], v[176:179], v[108:111]
  s_waitcnt lgkmcnt(3)
  v_mfma_f32_16x16x32_bf16 v[104:107], v[240:243], v[184:187], v[104:107]
  v_mfma_f32_16x16x32_bf16 v[108:111], a[16:19], v[184:187], v[108:111]
  s_waitcnt lgkmcnt(2)
  v_mfma_f32_16x16x32_bf16 v[104:107], v[244:247], v[192:195], v[104:107]
  v_mfma_f32_16x16x32_bf16 v[108:111], a[20:23], v[192:195], v[108:111]
  s_waitcnt lgkmcnt(1)
  v_mfma_f32_16x16x32_bf16 v[104:107], v[248:251], v[200:203], v[104:107]
  v_mfma_f32_16x16x32_bf16 v[108:111], a[24:27], v[200:203], v[108:111]
  s_waitcnt lgkmcnt(0)
  v_mfma_f32_16x16x32_bf16 v[104:107], v[252:255], v[208:211], v[104:107]
  v_mfma_f32_16x16x32_bf16 v[108:111], a[28:31], v[208:211], v[108:111]
  v_mfma_f32_16x16x32_bf16 v[120:123], a[32:35], v[152:155], 0
  v_mfma_f32_16x16x32_bf16 v[124:127], a[64:67], v[152:155], 0
  v_mfma_f32_16x16x32_bf16 v[120:123], a[36:39], v[160:163], v[120:123]
  v_cvt_pk_bf16_f32 v104, v104, v105
  v_cvt_pk_bf16_f32 v105, v106, v107
  v_mfma_f32_16x16x32_bf16 v[124:127], a[68:71], v[160:163], v[124:127]
  v_cvt_pk_bf16_f32 v106, v108, v109
  v_cvt_pk_bf16_f32 v107, v110, v111
  v_mfma_f32_16x16x32_bf16 v[120:123], a[40:43], v[168:171], v[120:123]
  v_bfi_b32 v104, 1, s60, v104
  v_bfi_b32 v106, 1, s60, v106
  buffer_store_dwordx4 v[104:107], v4, s[4:7], s51 offen offset:0
  v_mfma_f32_16x16x32_bf16 v[124:127], a[72:75], v[168:171], v[124:127]
  v_mfma_f32_16x16x32_bf16 v[120:123], a[44:47], v[176:179], v[120:123]
  v_mfma_f32_16x16x32_bf16 v[124:127], a[76:79], v[176:179], v[124:127]
  v_mfma_f32_16x16x32_bf16 v[120:123], a[48:51], v[184:187], v[120:123]
  v_mfma_f32_16x16x32_bf16 v[124:127], a[80:83], v[184:187], v[124:127]
  v_mfma_f32_16x16x32_bf16 v[120:123], a[52:55], v[192:195], v[120:123]
  v_mfma_f32_16x16x32_bf16 v[124:127], a[84:87], v[192:195], v[124:127]
  v_mfma_f32_16x16x32_bf16 v[120:123], a[56:59], v[200:203], v[120:123]
  v_mfma_f32_16x16x32_bf16 v[124:127], a[88:91], v[200:203], v[124:127]
  v_mfma_f32_16x16x32_bf16 v[120:123], a[60:63], v[208:211], v[120:123]
  v_mfma_f32_16x16x32_bf16 v[124:127], a[92:95], v[208:211], v[124:127]
  v_mfma_f32_16x16x32_bf16 v[104:107], a[96:99], v[152:155], 0
  v_mfma_f32_16x16x32_bf16 v[108:111], a[128:131], v[152:155], 0
  v_mfma_f32_16x16x32_bf16 v[104:107], a[100:103], v[160:163], v[104:107]
  v_cvt_pk_bf16_f32 v120, v120, v121
  v_cvt_pk_bf16_f32 v121, v122, v123
  v_mfma_f32_16x16x32_bf16 v[108:111], a[132:135], v[160:163], v[108:111]
  v_cvt_pk_bf16_f32 v122, v124, v125
  v_cvt_pk_bf16_f32 v123, v126, v127
  v_mfma_f32_16x16x32_bf16 v[104:107], a[104:107], v[168:171], v[104:107]
  v_bfi_b32 v120, 1, s60, v120
  v_bfi_b32 v122, 1, s60, v122
  buffer_store_dwordx4 v[120:123], v4, s[4:7], s51 offen offset:512
  v_mfma_f32_16x16x32_bf16 v[108:111], a[136:139], v[168:171], v[108:111]
  v_mfma_f32_16x16x32_bf16 v[104:107], a[108:111], v[176:179], v[104:107]
  v_mfma_f32_16x16x32_bf16 v[108:111], a[140:143], v[176:179], v[108:111]
  v_mfma_f32_16x16x32_bf16 v[104:107], a[112:115], v[184:187], v[104:107]
  v_mfma_f32_16x16x32_bf16 v[108:111], a[144:147], v[184:187], v[108:111]
  v_mfma_f32_16x16x32_bf16 v[104:107], a[116:119], v[192:195], v[104:107]
  v_mfma_f32_16x16x32_bf16 v[108:111], a[148:151], v[192:195], v[108:111]
  v_mfma_f32_16x16x32_bf16 v[104:107], a[120:123], v[200:203], v[104:107]
  v_mfma_f32_16x16x32_bf16 v[108:111], a[152:155], v[200:203], v[108:111]
  v_mfma_f32_16x16x32_bf16 v[104:107], a[124:127], v[208:211], v[104:107]
  v_mfma_f32_16x16x32_bf16 v[108:111], a[156:159], v[208:211], v[108:111]
  v_mfma_f32_16x16x32_bf16 v[120:123], a[160:163], v[152:155], 0
  v_mfma_f32_16x16x32_bf16 v[124:127], a[192:195], v[152:155], 0
  v_mfma_f32_16x16x32_bf16 v[120:123], a[164:167], v[160:163], v[120:123]
  v_cvt_pk_bf16_f32 v104, v104, v105
  v_cvt_pk_bf16_f32 v105, v106, v107
  v_mfma_f32_16x16x32_bf16 v[124:127], a[196:199], v[160:163], v[124:127]
  v_cvt_pk_bf16_f32 v106, v108, v109
  v_cvt_pk_bf16_f32 v107, v110, v111
  v_mfma_f32_16x16x32_bf16 v[120:123], a[168:171], v[168:171], v[120:123]
  v_bfi_b32 v104, 1, s60, v104
  v_bfi_b32 v106, 1, s60, v106
  buffer_store_dwordx4 v[104:107], v4, s[4:7], s51 offen offset:1024
  v_mfma_f32_16x16x32_bf16 v[124:127], a[200:203], v[168:171], v[124:127]
  v_mfma_f32_16x16x32_bf16 v[120:123], a[172:175], v[176:179], v[120:123]
  v_mfma_f32_16x16x32_bf16 v[124:127], a[204:207], v[176:179], v[124:127]
  v_mfma_f32_16x16x32_bf16 v[120:123], a[176:179], v[184:187], v[120:123]
  v_mfma_f32_16x16x32_bf16 v[124:127], a[208:211], v[184:187], v[124:127]
  v_mfma_f32_16x16x32_bf16 v[120:123], a[180:183], v[192:195], v[120:123]
  v_mfma_f32_16x16x32_bf16 v[124:127], a[212:215], v[192:195], v[124:127]
  v_mfma_f32_16x16x32_bf16 v[120:123], a[184:187], v[200:203], v[120:123]
  v_mfma_f32_16x16x32_bf16 v[124:127], a[216:219], v[200:203], v[124:127]
  v_mfma_f32_16x16x32_bf16 v[120:123], a[188:191], v[208:211], v[120:123]
  v_mfma_f32_16x16x32_bf16 v[124:127], a[220:223], v[208:211], v[124:127]
  v_mfma_f32_16x16x32_bf16 v[104:107], a[224:227], v[152:155], 0
  v_mfma_f32_16x16x32_bf16 v[104:107], a[228:231], v[160:163], v[104:107]
  v_mfma_f32_16x16x32_bf16 v[104:107], a[232:235], v[168:171], v[104:107]
  v_cvt_pk_bf16_f32 v120, v120, v121
  v_cvt_pk_bf16_f32 v121, v122, v123
  v_mfma_f32_16x16x32_bf16 v[104:107], a[236:239], v[176:179], v[104:107]
  v_cvt_pk_bf16_f32 v122, v124, v125
  v_cvt_pk_bf16_f32 v123, v126, v127
  v_mfma_f32_16x16x32_bf16 v[104:107], a[240:243], v[184:187], v[104:107]
  v_bfi_b32 v120, 1, s60, v120
  v_bfi_b32 v122, 1, s60, v122
  buffer_store_dwordx4 v[120:123], v4, s[4:7], s51 offen offset:1536
  v_mfma_f32_16x16x32_bf16 v[104:107], a[244:247], v[192:195], v[104:107]
  v_mfma_f32_16x16x32_bf16 v[104:107], a[248:251], v[200:203], v[104:107]
  v_mfma_f32_16x16x32_bf16 v[104:107], a[252:255], v[208:211], v[104:107]
  s_nop 7
  v_cvt_pk_bf16_f32 v104, v104, v105
  v_cvt_pk_bf16_f32 v105, v106, v107
  v_bfi_b32 v104, 1, s60, v104
  buffer_store_dwordx2 v[104:105], v4, s[4:7], s51 offen offset:2048
  s_branch L_att_l0_end
L_att_l0_wf:
  ds_read_b128 v[148:151], v11 offset:0
  ds_read_b128 v[152:155], v11 offset:4096
  ds_read_b128 v[156:159], v11 offset:1024
  ds_read_b128 v[160:163], v11 offset:5120
  ds_read_b128 v[164:167], v11 offset:2048
  ds_read_b128 v[168:171], v11 offset:6144
  ds_read_b128 v[172:175], v11 offset:3072
  ds_read_b128 v[176:179], v11 offset:7168
  ds_read_b128 v[180:183], v11 offset:8192
  ds_read_b128 v[184:187], v11 offset:12288
  ds_read_b128 v[188:191], v11 offset:9216
  ds_read_b128 v[192:195], v11 offset:13312
  ds_read_b128 v[196:199], v11 offset:10240
  ds_read_b128 v[200:203], v11 offset:14336
  ds_read_b128 v[204:207], v11 offset:11264
  ds_read_b128 v[208:211], v11 offset:15360
  s_xor_b32 s42, s42, 0x4000
  s_add_u32 s51, s45, 294912
  s_mul_i32 s41, s40, 36864
  s_waitcnt lgkmcnt(15)
  v_mfma_f32_16x16x32_bf16 v[96:99], v[224:227], v[148:151], 0
  v_mfma_f32_16x16x32_bf16 v[100:103], a[0:3], v[148:151], 0
  s_waitcnt lgkmcnt(14)
  v_mfma_f32_16x16x32_bf16 v[104:107], v[224:227], v[152:155], 0
  v_mfma_f32_16x16x32_bf16 v[108:111], a[0:3], v[152:155], 0
  s_waitcnt lgkmcnt(13)
  v_mfma_f32_16x16x32_bf16 v[96:99], v[228:231], v[156:159], v[96:99]
  v_mfma_f32_16x16x32_bf16 v[100:103], a[4:7], v[156:159], v[100:103]
  s_waitcnt lgkmcnt(12)
  v_mfma_f32_16x16x32_bf16 v[104:107], v[228:231], v[160:163], v[104:107]
  v_mfma_f32_16x16x32_bf16 v[108:111], a[4:7], v[160:163], v[108:111]
  s_waitcnt lgkmcnt(11)
  v_mfma_f32_16x16x32_bf16 v[96:99], v[232:235], v[164:167], v[96:99]
  v_mfma_f32_16x16x32_bf16 v[100:103], a[8:11], v[164:167], v[100:103]
  s_waitcnt lgkmcnt(10)
  v_mfma_f32_16x16x32_bf16 v[104:107], v[232:235], v[168:171], v[104:107]
  v_mfma_f32_16x16x32_bf16 v[108:111], a[8:11], v[168:171], v[108:111]
  buffer_load_dwordx2 v[48:49], v6, s[12:15], s41 offen offset:0
  s_waitcnt lgkmcnt(9)
  v_mfma_f32_16x16x32_bf16 v[96:99], v[236:239], v[172:175], v[96:99]
  v_mfma_f32_16x16x32_bf16 v[100:103], a[12:15], v[172:175], v[100:103]
  s_waitcnt lgkmcnt(8)
  v_mfma_f32_16x16x32_bf16 v[104:107], v[236:239], v[176:179], v[104:107]
  v_mfma_f32_16x16x32_bf16 v[108:111], a[12:15], v[176:179], v[108:111]
  buffer_load_dwordx2 v[50:51], v6, s[12:15], s41 offen offset:128
  s_waitcnt lgkmcnt(7)
  v_mfma_f32_16x16x32_bf16 v[96:99], v[240:243], v[180:183], v[96:99]
  v_mfma_f32_16x16x32_bf16 v[100:103], a[16:19], v[180:183], v[100:103]
  s_waitcnt lgkmcnt(6)
  v_mfma_f32_16x16x32_bf16 v[104:107], v[240:243], v[184:187], v[104:107]
  v_mfma_f32_16x16x32_bf16 v[108:111], a[16:19], v[184:187], v[108:111]
  buffer_load_dwordx2 v[52:53], v7, s[12:15], s41 offen offset:0
  s_waitcnt lgkmcnt(5)
  v_mfma_f32_16x16x32_bf16 v[96:99], v[244:247], v[188:191], v[96:99]
  v_mfma_f32_16x16x32_bf16 v[100:103], a[20:23], v[188:191], v[100:103]
  s_waitcnt lgkmcnt(4)
  v_mfma_f32_16x16x32_bf16 v[104:107], v[244:247], v[192:195], v[104:107]
  v_mfma_f32_16x16x32_bf16 v[108:111], a[20:23], v[192:195], v[108:111]
  s_waitcnt lgkmcnt(3)
  v_mfma_f32_16x16x32_bf16 v[96:99], v[248:251], v[196:199], v[96:99]
  v_mfma_f32_16x16x32_bf16 v[100:103], a[24:27], v[196:199], v[100:103]
  s_waitcnt lgkmcnt(2)
  v_mfma_f32_16x16x32_bf16 v[104:107], v[248:251], v[200:203], v[104:107]
  v_mfma_f32_16x16x32_bf16 v[108:111], a[24:27], v[200:203], v[108:111]
  s_waitcnt lgkmcnt(1)
  v_mfma_f32_16x16x32_bf16 v[96:99], v[252:255], v[204:207], v[96:99]
  v_mfma_f32_16x16x32_bf16 v[100:103], a[28:31], v[204:207], v[100:103]
  s_waitcnt lgkmcnt(0)
  v_mfma_f32_16x16x32_bf16 v[104:107], v[252:255], v[208:211], v[104:107]
  v_mfma_f32_16x16x32_bf16 v[108:111], a[28:31], v[208:211], v[108:111]
  v_mfma_f32_16x16x32_bf16 v[112:115], a[32:35], v[148:151], 0
  v_mfma_f32_16x16x32_bf16 v[116:119], a[64:67], v[148:151], 0
  v_mfma_f32_16x16x32_bf16 v[120:123], a[32:35], v[152:155], 0
  v_cvt_pk_bf16_f32 v96, v96, v97
  v_cvt_pk_bf16_f32 v97, v98, v99
  v_mfma_f32_16x16x32_bf16 v[124:127], a[64:67], v[152:155], 0
  v_cvt_pk_bf16_f32 v98, v100, v101
  v_cvt_pk_bf16_f32 v99, v102, v103
  v_mfma_f32_16x16x32_bf16 v[112:115], a[36:39], v[156:159], v[112:115]
  v_bfi_b32 v96, 1, s60, v96
  v_bfi_b32 v98, 1, s60, v98
  buffer_store_dwordx4 v[96:99], v4, s[4:7], s45 offen offset:0
  v_mfma_f32_16x16x32_bf16 v[116:119], a[68:71], v[156:159], v[116:119]
  v_cvt_pk_bf16_f32 v104, v104, v105
  v_cvt_pk_bf16_f32 v105, v106, v107
  v_mfma_f32_16x16x32_bf16 v[120:123], a[36:39], v[160:163], v[120:123]
  v_cvt_pk_bf16_f32 v106, v108, v109
  v_cvt_pk_bf16_f32 v107, v110, v111
  v_mfma_f32_16x16x32_bf16 v[124:127], a[68:71], v[160:163], v[124:127]
  v_bfi_b32 v104, 1, s60, v104
  v_bfi_b32 v106, 1, s60, v106
  buffer_store_dwordx4 v[104:107], v4, s[4:7], s51 offen offset:0
  v_mfma_f32_16x16x32_bf16 v[112:115], a[40:43], v[164:167], v[112:115]
  v_mfma_f32_16x16x32_bf16 v[116:119], a[72:75], v[164:167], v[116:119]
  v_mfma_f32_16x16x32_bf16 v[120:123], a[40:43], v[168:171], v[120:123]
  v_mfma_f32_16x16x32_bf16 v[124:127], a[72:75], v[168:171], v[124:127]
  v_mfma_f32_16x16x32_bf16 v[112:115], a[44:47], v[172:175], v[112:115]
  v_mfma_f32_16x16x32_bf16 v[116:119], a[76:79], v[172:175], v[116:119]
  v_mfma_f32_16x16x32_bf16 v[120:123], a[44:47], v[176:179], v[120:123]
  v_mfma_f32_16x16x32_bf16 v[124:127], a[76:79], v[176:179], v[124:127]
  v_mfma_f32_16x16x32_bf16 v[112:115], a[48:51], v[180:183], v[112:115]
  v_mfma_f32_16x16x32_bf16 v[116:119], a[80:83], v[180:183], v[116:119]
  v_mfma_f32_16x16x32_bf16 v[120:123], a[48:51], v[184:187], v[120:123]
  v_mfma_f32_16x16x32_bf16 v[124:127], a[80:83], v[184:187], v[124:127]
  v_mfma_f32_16x16x32_bf16 v[112:115], a[52:55], v[188:191], v[112:115]
  v_mfma_f32_16x16x32_bf16 v[116:119], a[84:87], v[188:191], v[116:119]
  v_mfma_f32_16x16x32_bf16 v[120:123], a[52:55], v[192:195], v[120:123]
  v_mfma_f32_16x16x32_bf16 v[124:127], a[84:87], v[192:195], v[124:127]
  v_mfma_f32_16x16x32_bf16 v[112:115], a[56:59], v[196:199], v[112:115]
  v_mfma_f32_16x16x32_bf16 v[116:119], a[88:91], v[196:199], v[116:119]
  v_mfma_f32_16x16x32_bf16 v[120:123], a[56:59], v[200:203], v[120:123]
  v_mfma_f32_16x16x32_bf16 v[124:127], a[88:91], v[200:203], v[124:127]
  v_mfma_f32_16x16x32_bf16 v[112:115], a[60:63], v[204:207], v[112:115]
  v_mfma_f32_16x16x32_bf16 v[116:119], a[92:95], v[204:207], v[116:119]
  v_mfma_f32_16x16x32_bf16 v[120:123], a[60:63], v[208:211], v[120:123]
  v_mfma_f32_16x16x32_bf16 v[124:127], a[92:95], v[208:211], v[124:127]
  v_mfma_f32_16x16x32_bf16 v[96:99], a[96:99], v[148:151], 0
  v_mfma_f32_16x16x32_bf16 v[100:103], a[128:131], v[148:151], 0
  v_mfma_f32_16x16x32_bf16 v[104:107], a[96:99], v[152:155], 0
  v_cvt_pk_bf16_f32 v112, v112, v113
  v_cvt_pk_bf16_f32 v113, v114, v115
  v_mfma_f32_16x16x32_bf16 v[108:111], a[128:131], v[152:155], 0
  v_cvt_pk_bf16_f32 v114, v116, v117
  v_cvt_pk_bf16_f32 v115, v118, v119
  v_mfma_f32_16x16x32_bf16 v[96:99], a[100:103], v[156:159], v[96:99]
  v_bfi_b32 v112, 1, s60, v112
  v_bfi_b32 v114, 1, s60, v114
  buffer_store_dwordx4 v[112:115], v4, s[4:7], s45 offen offset:512
  v_mfma_f32_16x16x32_bf16 v[100:103], a[132:135], v[156:159], v[100:103]
  v_cvt_pk_bf16_f32 v120, v120, v121
  v_cvt_pk_bf16_f32 v121, v122, v123
  v_mfma_f32_16x16x32_bf16 v[104:107], a[100:103], v[160:163], v[104:107]
  v_cvt_pk_bf16_f32 v122, v124, v125
  v_cvt_pk_bf16_f32 v123, v126, v127
  v_mfma_f32_16x16x32_bf16 v[108:111], a[132:135], v[160:163], v[108:111]
  v_bfi_b32 v120, 1, s60, v120
  v_bfi_b32 v122, 1, s60, v122
  buffer_store_dwordx4 v[120:123], v4, s[4:7], s51 offen offset:512
  v_mfma_f32_16x16x32_bf16 v[96:99], a[104:107], v[164:167], v[96:99]
  v_mfma_f32_16x16x32_bf16 v[100:103], a[136:139], v[164:167], v[100:103]
  v_mfma_f32_16x16x32_bf16 v[104:107], a[104:107], v[168:171], v[104:107]
  v_mfma_f32_16x16x32_bf16 v[108:111], a[136:139], v[168:171], v[108:111]
  v_mfma_f32_16x16x32_bf16 v[96:99], a[108:111], v[172:175], v[96:99]
  v_mfma_f32_16x16x32_bf16 v[100:103], a[140:143], v[172:175], v[100:103]
  v_mfma_f32_16x16x32_bf16 v[104:107], a[108:111], v[176:179], v[104:107]
  v_mfma_f32_16x16x32_bf16 v[108:111], a[140:143], v[176:179], v[108:111]
  v_mfma_f32_16x16x32_bf16 v[96:99], a[112:115], v[180:183], v[96:99]
  v_mfma_f32_16x16x32_bf16 v[100:103], a[144:147], v[180:183], v[100:103]
  v_mfma_f32_16x16x32_bf16 v[104:107], a[112:115], v[184:187], v[104:107]
  v_mfma_f32_16x16x32_bf16 v[108:111], a[144:147], v[184:187], v[108:111]
  v_mfma_f32_16x16x32_bf16 v[96:99], a[116:119], v[188:191], v[96:99]
  v_mfma_f32_16x16x32_bf16 v[100:103], a[148:151], v[188:191], v[100:103]
  v_mfma_f32_16x16x32_bf16 v[104:107], a[116:119], v[192:195], v[104:107]
  v_mfma_f32_16x16x32_bf16 v[108:111], a[148:151], v[192:195], v[108:111]
  v_mfma_f32_16x16x32_bf16 v[96:99], a[120:123], v[196:199], v[96:99]
  v_mfma_f32_16x16x32_bf16 v[100:103], a[152:155], v[196:199], v[100:103]
  v_mfma_f32_16x16x32_bf16 v[104:107], a[120:123], v[200:203], v[104:107]
  v_mfma_f32_16x16x32_bf16 v[108:111], a[152:155], v[200:203], v[108:111]
  v_mfma_f32_16x16x32_bf16 v[96:99], a[124:127], v[204:207], v[96:99]
  v_mfma_f32_16x16x32_bf16 v[100:103], a[156:159], v[204:207], v[100:103]
  v_mfma_f32_16x16x32_bf16 v[104:107], a[124:127], v[208:211], v[104:107]
  v_mfma_f32_16x16x32_bf16 v[108:111], a[156:159], v[208:211], v[108:111]
  v_mfma_f32_16x16x32_bf16 v[112:115], a[160:163], v[148:151], 0
  v_mfma_f32_16x16x32_bf16 v[116:119], a[192:195], v[148:151], 0
  v_mfma_f32_16x16x32_bf16 v[120:123], a[160:163], v[152:155], 0
  v_cvt_pk_bf16_f32 v96, v96, v97
  v_cvt_pk_bf16_f32 v97, v98, v99
  v_mfma_f32_16x16x32_bf16 v[124:127], a[192:195], v[152:155], 0
  v_cvt_pk_bf16_f32 v98, v100, v101
  v_cvt_pk_bf16_f32 v99, v102, v103
  v_mfma_f32_16x16x32_bf16 v[112:115], a[164:167], v[156:159], v[112:115]
  v_bfi_b32 v96, 1, s60, v96
  v_bfi_b32 v98, 1, s60, v98
  buffer_store_dwordx4 v[96:99], v4, s[4:7], s45 offen offset:1024
  v_mfma_f32_16x16x32_bf16 v[116:119], a[196:199], v[156:159], v[116:119]
  v_cvt_pk_bf16_f32 v104, v104, v105
  v_cvt_pk_bf16_f32 v105, v106, v107
  v_mfma_f32_16x16x32_bf16 v[120:123], a[164:167], v[160:163], v[120:123]
  v_cvt_pk_bf16_f32 v106, v108, v109
  v_cvt_pk_bf16_f32 v107, v110, v111
  v_mfma_f32_16x16x32_bf16 v[124:127], a[196:199], v[160:163], v[124:127]
  v_bfi_b32 v104, 1, s60, v104
  v_bfi_b32 v106, 1, s60, v106
  buffer_store_dwordx4 v[104:107], v4, s[4:7], s51 offen offset:1024
  v_mfma_f32_16x16x32_bf16 v[112:115], a[168:171], v[164:167], v[112:115]
  v_mfma_f32_16x16x32_bf16 v[116:119], a[200:203], v[164:167], v[116:119]
  v_mfma_f32_16x16x32_bf16 v[120:123], a[168:171], v[168:171], v[120:123]
  v_mfma_f32_16x16x32_bf16 v[124:127], a[200:203], v[168:171], v[124:127]
  v_mfma_f32_16x16x32_bf16 v[112:115], a[172:175], v[172:175], v[112:115]
  v_mfma_f32_16x16x32_bf16 v[116:119], a[204:207], v[172:175], v[116:119]
  v_mfma_f32_16x16x32_bf16 v[120:123], a[172:175], v[176:179], v[120:123]
  v_mfma_f32_16x16x32_bf16 v[124:127], a[204:207], v[176:179], v[124:127]
  v_mfma_f32_16x16x32_bf16 v[112:115], a[176:179], v[180:183], v[112:115]
  v_mfma_f32_16x16x32_bf16 v[116:119], a[208:211], v[180:183], v[116:119]
  v_mfma_f32_16x16x32_bf16 v[120:123], a[176:179], v[184:187], v[120:123]
  v_mfma_f32_16x16x32_bf16 v[124:127], a[208:211], v[184:187], v[124:127]
  v_mfma_f32_16x16x32_bf16 v[112:115], a[180:183], v[188:191], v[112:115]
  v_mfma_f32_16x16x32_bf16 v[116:119], a[212:215], v[188:191], v[116:119]
  v_mfma_f32_16x16x32_bf16 v[120:123], a[180:183], v[192:195], v[120:123]
  v_mfma_f32_16x16x32_bf16 v[124:127], a[212:215], v[192:195], v[124:127]
  v_mfma_f32_16x16x32_bf16 v[112:115], a[184:187], v[196:199], v[112:115]
  v_mfma_f32_16x16x32_bf16 v[116:119], a[216:219], v[196:199], v[116:119]
  v_mfma_f32_16x16x32_bf16 v[120:123], a[184:187], v[200:203], v[120:123]
  v_mfma_f32_16x16x32_bf16 v[124:127], a[216:219], v[200:203], v[124:127]
  v_mfma_f32_16x16x32_bf16 v[112:115], a[188:191], v[204:207], v[112:115]
  v_mfma_f32_16x16x32_bf16 v[116:119], a[220:223], v[204:207], v[116:119]
  v_mfma_f32_16x16x32_bf16 v[120:123], a[188:191], v[208:211], v[120:123]
  v_mfma_f32_16x16x32_bf16 v[124:127], a[220:223], v[208:211], v[124:127]
  v_mfma_f32_16x16x32_bf16 v[96:99], a[224:227], v[148:151], 0
  v_mfma_f32_16x16x32_bf16 v[104:107], a[224:227], v[152:155], 0
  v_mfma_f32_16x16x32_bf16 v[96:99], a[228:231], v[156:159], v[96:99]
  v_cvt_pk_bf16_f32 v112, v112, v113
  v_cvt_pk_bf16_f32 v113, v114, v115
  v_mfma_f32_16x16x32_bf16 v[104:107], a[228:231], v[160:163], v[104:107]
  v_cvt_pk_bf16_f32 v114, v116, v117
  v_cvt_pk_bf16_f32 v115, v118, v119
  v_mfma_f32_16x16x32_bf16 v[96:99], a[232:235], v[164:167], v[96:99]
  v_bfi_b32 v112, 1, s60, v112
  v_bfi_b32 v114, 1, s60, v114
  buffer_store_dwordx4 v[112:115], v4, s[4:7], s45 offen offset:1536
  v_mfma_f32_16x16x32_bf16 v[104:107], a[232:235], v[168:171], v[104:107]
  v_cvt_pk_bf16_f32 v120, v120, v121
  v_cvt_pk_bf16_f32 v121, v122, v123
  v_mfma_f32_16x16x32_bf16 v[96:99], a[236:239], v[172:175], v[96:99]
  v_cvt_pk_bf16_f32 v122, v124, v125
  v_cvt_pk_bf16_f32 v123, v126, v127
  v_mfma_f32_16x16x32_bf16 v[104:107], a[236:239], v[176:179], v[104:107]
  v_bfi_b32 v120, 1, s60, v120
  v_bfi_b32 v122, 1, s60, v122
  buffer_store_dwordx4 v[120:123], v4, s[4:7], s51 offen offset:1536
  v_mfma_f32_16x16x32_bf16 v[96:99], a[240:243], v[180:183], v[96:99]
  v_mfma_f32_16x16x32_bf16 v[104:107], a[240:243], v[184:187], v[104:107]
  v_mfma_f32_16x16x32_bf16 v[96:99], a[244:247], v[188:191], v[96:99]
  v_mfma_f32_16x16x32_bf16 v[104:107], a[244:247], v[192:195], v[104:107]
  v_mfma_f32_16x16x32_bf16 v[96:99], a[248:251], v[196:199], v[96:99]
  v_mfma_f32_16x16x32_bf16 v[104:107], a[248:251], v[200:203], v[104:107]
  v_mfma_f32_16x16x32_bf16 v[96:99], a[252:255], v[204:207], v[96:99]
  v_mfma_f32_16x16x32_bf16 v[104:107], a[252:255], v[208:211], v[104:107]
  s_nop 4
  v_cvt_pk_bf16_f32 v96, v96, v97
  v_cvt_pk_bf16_f32 v97, v98, v99
  v_bfi_b32 v96, 1, s60, v96
  buffer_store_dwordx2 v[96:97], v4, s[4:7], s45 offen offset:2048
  v_cvt_pk_bf16_f32 v104, v104, v105
  v_cvt_pk_bf16_f32 v105, v106, v107
  v_bfi_b32 v104, 1, s60, v104
  buffer_store_dwordx2 v[104:105], v4, s[4:7], s51 offen offset:2048
  s_branch L_att_l0_wx
L_att_l0_ws:
  ds_read_b128 v[148:151], v11 offset:0
  ds_read_b128 v[152:155], v11 offset:4096
  ds_read_b128 v[156:159], v11 offset:1024
  ds_read_b128 v[160:163], v11 offset:5120
  ds_read_b128 v[164:167], v11 offset:2048
  ds_read_b128 v[168:171], v11 offset:6144
  ds_read_b128 v[172:175], v11 offset:3072
  ds_read_b128 v[176:179], v11 offset:7168
  ds_read_b128 v[180:183], v11 offset:8192
  ds_read_b128 v[184:187], v11 offset:12288
  ds_read_b128 v[188:191], v11 offset:9216
  ds_read_b128 v[192:195], v11 offset:13312
  ds_read_b128 v[196:199], v11 offset:10240
  ds_read_b128 v[200:203], v11 offset:14336
  ds_read_b128 v[204:207], v11 offset:11264
  ds_read_b128 v[208:211], v11 offset:15360
  s_xor_b32 s42, s42, 0x4000
  s_add_u32 s51, s45, 294912
  s_mul_i32 s41, s40, 36864
  s_waitcnt lgkmcnt(15)
  v_mfma_f32_16x16x32_bf16 v[96:99], v[224:227], v[148:151], 0
  v_mfma_f32_16x16x32_bf16 v[100:103], a[0:3], v[148:151], 0
  s_waitcnt lgkmcnt(14)
  v_mfma_f32_16x16x32_bf16 v[104:107], v[224:227], v[152:155], 0
  v_mfma_f32_16x16x32_bf16 v[108:111], a[0:3], v[152:155], 0
  s_waitcnt lgkmcnt(13)
  v_mfma_f32_16x16x32_bf16 v[96:99], v[228:231], v[156:159], v[96:99]
  v_mfma_f32_16x16x32_bf16 v[100:103], a[4:7], v[156:159], v[100:103]
  s_waitcnt lgkmcnt(12)
  v_mfma_f32_16x16x32_bf16 v[104:107], v[228:231], v[160:163], v[104:107]
  v_mfma_f32_16x16x32_bf16 v[108:111], a[4:7], v[160:163], v[108:111]
  s_waitcnt lgkmcnt(11)
  v_mfma_f32_16x16x32_bf16 v[96:99], v[232:235], v[164:167], v[96:99]
  v_mfma_f32_16x16x32_bf16 v[100:103], a[8:11], v[164:167], v[100:103]
  s_waitcnt lgkmcnt(10)
  v_mfma_f32_16x16x32_bf16 v[104:107], v[232:235], v[168:171], v[104:107]
  v_mfma_f32_16x16x32_bf16 v[108:111], a[8:11], v[168:171], v[108:111]
  buffer_load_dwordx2 v[48:49], v6, s[12:15], s41 offen offset:0
  s_waitcnt lgkmcnt(9)
  v_mfma_f32_16x16x32_bf16 v[96:99], v[236:239], v[172:175], v[96:99]
  v_mfma_f32_16x16x32_bf16 v[100:103], a[12:15], v[172:175], v[100:103]
  s_waitcnt lgkmcnt(8)
  v_mfma_f32_16x16x32_bf16 v[104:107], v[236:239], v[176:179], v[104:107]
  v_mfma_f32_16x16x32_bf16 v[108:111], a[12:15], v[176:179], v[108:111]
  buffer_load_dwordx2 v[50:51], v6, s[12:15], s41 offen offset:128
  s_waitcnt lgkmcnt(7)
  v_mfma_f32_16x16x32_bf16 v[96:99], v[240:243], v[180:183], v[96:99]
  v_mfma_f32_16x16x32_bf16 v[100:103], a[16:19], v[180:183], v[100:103]
  s_waitcnt lgkmcnt(6)
  v_mfma_f32_16x16x32_bf16 v[104:107], v[240:243], v[184:187], v[104:107]
  v_mfma_f32_16x16x32_bf16 v[108:111], a[16:19], v[184:187], v[108:111]
  buffer_load_dwordx2 v[52:53], v7, s[12:15], s41 offen offset:0
  s_waitcnt lgkmcnt(5)
  v_mfma_f32_16x16x32_bf16 v[96:99], v[244:247], v[188:191], v[96:99]
  v_mfma_f32_16x16x32_bf16 v[100:103], a[20:23], v[188:191], v[100:103]
  s_waitcnt lgkmcnt(4)
  v_mfma_f32_16x16x32_bf16 v[104:107], v[244:247], v[192:195], v[104:107]
  v_mfma_f32_16x16x32_bf16 v[108:111], a[20:23], v[192:195], v[108:111]
  s_waitcnt lgkmcnt(3)
  v_mfma_f32_16x16x32_bf16 v[96:99], v[248:251], v[196:199], v[96:99]
  v_mfma_f32_16x16x32_bf16 v[100:103], a[24:27], v[196:199], v[100:103]
  s_waitcnt lgkmcnt(2)
  v_mfma_f32_16x16x32_bf16 v[104:107], v[248:251], v[200:203], v[104:107]
  v_mfma_f32_16x16x32_bf16 v[108:111], a[24:27], v[200:203], v[108:111]
  s_waitcnt lgkmcnt(1)
  v_mfma_f32_16x16x32_bf16 v[96:99], v[252:255], v[204:207], v[96:99]
  v_mfma_f32_16x16x32_bf16 v[100:103], a[28:31], v[204:207], v[100:103]
  s_waitcnt lgkmcnt(0)
  v_mfma_f32_16x16x32_bf16 v[104:107], v[252:255], v[208:211], v[104:107]
  v_mfma_f32_16x16x32_bf16 v[108:111], a[28:31], v[208:211], v[108:111]
  v_mfma_f32_16x16x32_bf16 v[112:115], a[32:35], v[148:151], 0
  v_mfma_f32_16x16x32_bf16 v[116:119], a[64:67], v[148:151], 0
  v_mfma_f32_16x16x32_bf16 v[120:123], a[32:35], v[152:155], 0
  v_cvt_pk_bf16_f32 v96, v96, v97
  v_cvt_pk_bf16_f32 v97, v98, v99
  v_mfma_f32_16x16x32_bf16 v[124:127], a[64:67], v[152:155], 0
  v_cvt_pk_bf16_f32 v98, v100, v101
  v_cvt_pk_bf16_f32 v99, v102, v103
  v_mfma_f32_16x16x32_bf16 v[112:115], a[36:39], v[156:159], v[112:115]
  v_bfi_b32 v96, 1, s60, v96
  v_bfi_b32 v98, 1, s60, v98
  buffer_store_dwordx4 v[96:99], v4, s[4:7], s45 offen offset:0 sc1
  v_mfma_f32_16x16x32_bf16 v[116:119], a[68:71], v[156:159], v[116:119]
  v_cvt_pk_bf16_f32 v104, v104, v105
  v_cvt_pk_bf16_f32 v105, v106, v107
  v_mfma_f32_16x16x32_bf16 v[120:123], a[36:39], v[160:163], v[120:123]
  v_cvt_pk_bf16_f32 v106, v108, v109
  v_cvt_pk_bf16_f32 v107, v110, v111
  v_mfma_f32_16x16x32_bf16 v[124:127], a[68:71], v[160:163], v[124:127]
  v_bfi_b32 v104, 1, s60, v104
  v_bfi_b32 v106, 1, s60, v106
  buffer_store_dwordx4 v[104:107], v4, s[4:7], s51 offen offset:0 sc1
  v_mfma_f32_16x16x32_bf16 v[112:115], a[40:43], v[164:167], v[112:115]
  v_mfma_f32_16x16x32_bf16 v[116:119], a[72:75], v[164:167], v[116:119]
  v_mfma_f32_16x16x32_bf16 v[120:123], a[40:43], v[168:171], v[120:123]
  v_mfma_f32_16x16x32_bf16 v[124:127], a[72:75], v[168:171], v[124:127]
  v_mfma_f32_16x16x32_bf16 v[112:115], a[44:47], v[172:175], v[112:115]
  v_mfma_f32_16x16x32_bf16 v[116:119], a[76:79], v[172:175], v[116:119]
  v_mfma_f32_16x16x32_bf16 v[120:123], a[44:47], v[176:179], v[120:123]
  v_mfma_f32_16x16x32_bf16 v[124:127], a[76:79], v[176:179], v[124:127]
  v_mfma_f32_16x16x32_bf16 v[112:115], a[48:51], v[180:183], v[112:115]
  v_mfma_f32_16x16x32_bf16 v[116:119], a[80:83], v[180:183], v[116:119]
  v_mfma_f32_16x16x32_bf16 v[120:123], a[48:51], v[184:187], v[120:123]
  v_mfma_f32_16x16x32_bf16 v[124:127], a[80:83], v[184:187], v[124:127]
  v_mfma_f32_16x16x32_bf16 v[112:115], a[52:55], v[188:191], v[112:115]
  v_mfma_f32_16x16x32_bf16 v[116:119], a[84:87], v[188:191], v[116:119]
  v_mfma_f32_16x16x32_bf16 v[120:123], a[52:55], v[192:195], v[120:123]
  v_mfma_f32_16x16x32_bf16 v[124:127], a[84:87], v[192:195], v[124:127]
  v_mfma_f32_16x16x32_bf16 v[112:115], a[56:59], v[196:199], v[112:115]
  v_mfma_f32_16x16x32_bf16 v[116:119], a[88:91], v[196:199], v[116:119]
  v_mfma_f32_16x16x32_bf16 v[120:123], a[56:59], v[200:203], v[120:123]
  v_mfma_f32_16x16x32_bf16 v[124:127], a[88:91], v[200:203], v[124:127]
  v_mfma_f32_16x16x32_bf16 v[112:115], a[60:63], v[204:207], v[112:115]
  v_mfma_f32_16x16x32_bf16 v[116:119], a[92:95], v[204:207], v[116:119]
  v_mfma_f32_16x16x32_bf16 v[120:123], a[60:63], v[208:211], v[120:123]
  v_mfma_f32_16x16x32_bf16 v[124:127], a[92:95], v[208:211], v[124:127]
  v_mfma_f32_16x16x32_bf16 v[96:99], a[96:99], v[148:151], 0
  v_mfma_f32_16x16x32_bf16 v[100:103], a[128:131], v[148:151], 0
  v_mfma_f32_16x16x32_bf16 v[104:107], a[96:99], v[152:155], 0
  v_cvt_pk_bf16_f32 v112, v112, v113
  v_cvt_pk_bf16_f32 v113, v114, v115
  v_mfma_f32_16x16x32_bf16 v[108:111], a[128:131], v[152:155], 0
  v_cvt_pk_bf16_f32 v114, v116, v117
  v_cvt_pk_bf16_f32 v115, v118, v119
  v_mfma_f32_16x16x32_bf16 v[96:99], a[100:103], v[156:159], v[96:99]
  v_bfi_b32 v112, 1, s60, v112
  v_bfi_b32 v114, 1, s60, v114
  buffer_store_dwordx4 v[112:115], v4, s[4:7], s45 offen offset:512 sc1
  v_mfma_f32_16x16x32_bf16 v[100:103], a[132:135], v[156:159], v[100:103]
  v_cvt_pk_bf16_f32 v120, v120, v121
  v_cvt_pk_bf16_f32 v121, v122, v123
  v_mfma_f32_16x16x32_bf16 v[104:107], a[100:103], v[160:163], v[104:107]
  v_cvt_pk_bf16_f32 v122, v124, v125
  v_cvt_pk_bf16_f32 v123, v126, v127
  v_mfma_f32_16x16x32_bf16 v[108:111], a[132:135], v[160:163], v[108:111]
  v_bfi_b32 v120, 1, s60, v120
  v_bfi_b32 v122, 1, s60, v122
  buffer_store_dwordx4 v[120:123], v4, s[4:7], s51 offen offset:512 sc1
  v_mfma_f32_16x16x32_bf16 v[96:99], a[104:107], v[164:167], v[96:99]
  v_mfma_f32_16x16x32_bf16 v[100:103], a[136:139], v[164:167], v[100:103]
  v_mfma_f32_16x16x32_bf16 v[104:107], a[104:107], v[168:171], v[104:107]
  v_mfma_f32_16x16x32_bf16 v[108:111], a[136:139], v[168:171], v[108:111]
  v_mfma_f32_16x16x32_bf16 v[96:99], a[108:111], v[172:175], v[96:99]
  v_mfma_f32_16x16x32_bf16 v[100:103], a[140:143], v[172:175], v[100:103]
  v_mfma_f32_16x16x32_bf16 v[104:107], a[108:111], v[176:179], v[104:107]
  v_mfma_f32_16x16x32_bf16 v[108:111], a[140:143], v[176:179], v[108:111]
  v_mfma_f32_16x16x32_bf16 v[96:99], a[112:115], v[180:183], v[96:99]
  v_mfma_f32_16x16x32_bf16 v[100:103], a[144:147], v[180:183], v[100:103]
  v_mfma_f32_16x16x32_bf16 v[104:107], a[112:115], v[184:187], v[104:107]
  v_mfma_f32_16x16x32_bf16 v[108:111], a[144:147], v[184:187], v[108:111]
  v_mfma_f32_16x16x32_bf16 v[96:99], a[116:119], v[188:191], v[96:99]
  v_mfma_f32_16x16x32_bf16 v[100:103], a[148:151], v[188:191], v[100:103]
  v_mfma_f32_16x16x32_bf16 v[104:107], a[116:119], v[192:195], v[104:107]
  v_mfma_f32_16x16x32_bf16 v[108:111], a[148:151], v[192:195], v[108:111]
  v_mfma_f32_16x16x32_bf16 v[96:99], a[120:123], v[196:199], v[96:99]
  v_mfma_f32_16x16x32_bf16 v[100:103], a[152:155], v[196:199], v[100:103]
  v_mfma_f32_16x16x32_bf16 v[104:107], a[120:123], v[200:203], v[104:107]
  v_mfma_f32_16x16x32_bf16 v[108:111], a[152:155], v[200:203], v[108:111]
  v_mfma_f32_16x16x32_bf16 v[96:99], a[124:127], v[204:207], v[96:99]
  v_mfma_f32_16x16x32_bf16 v[100:103], a[156:159], v[204:207], v[100:103]
  v_mfma_f32_16x16x32_bf16 v[104:107], a[124:127], v[208:211], v[104:107]
  v_mfma_f32_16x16x32_bf16 v[108:111], a[156:159], v[208:211], v[108:111]
  v_mfma_f32_16x16x32_bf16 v[112:115], a[160:163], v[148:151], 0
  v_mfma_f32_16x16x32_bf16 v[116:119], a[192:195], v[148:151], 0
  v_mfma_f32_16x16x32_bf16 v[120:123], a[160:163], v[152:155], 0
  v_cvt_pk_bf16_f32 v96, v96, v97
  v_cvt_pk_bf16_f32 v97, v98, v99
  v_mfma_f32_16x16x32_bf16 v[124:127], a[192:195], v[152:155], 0
  v_cvt_pk_bf16_f32 v98, v100, v101
  v_cvt_pk_bf16_f32 v99, v102, v103
  v_mfma_f32_16x16x32_bf16 v[112:115], a[164:167], v[156:159], v[112:115]
  v_bfi_b32 v96, 1, s60, v96
  v_bfi_b32 v98, 1, s60, v98
  buffer_store_dwordx4 v[96:99], v4, s[4:7], s45 offen offset:1024 sc1
  v_mfma_f32_16x16x32_bf16 v[116:119], a[196:199], v[156:159], v[116:119]
  v_cvt_pk_bf16_f32 v104, v104, v105
  v_cvt_pk_bf16_f32 v105, v106, v107
  v_mfma_f32_16x16x32_bf16 v[120:123], a[164:167], v[160:163], v[120:123]
  v_cvt_pk_bf16_f32 v106, v108, v109
  v_cvt_pk_bf16_f32 v107, v110, v111
  v_mfma_f32_16x16x32_bf16 v[124:127], a[196:199], v[160:163], v[124:127]
  v_bfi_b32 v104, 1, s60, v104
  v_bfi_b32 v106, 1, s60, v106
  buffer_store_dwordx4 v[104:107], v4, s[4:7], s51 offen offset:1024 sc1
  v_mfma_f32_16x16x32_bf16 v[112:115], a[168:171], v[164:167], v[112:115]
  v_mfma_f32_16x16x32_bf16 v[116:119], a[200:203], v[164:167], v[116:119]
  v_mfma_f32_16x16x32_bf16 v[120:123], a[168:171], v[168:171], v[120:123]
  v_mfma_f32_16x16x32_bf16 v[124:127], a[200:203], v[168:171], v[124:127]
  v_mfma_f32_16x16x32_bf16 v[112:115], a[172:175], v[172:175], v[112:115]
  v_mfma_f32_16x16x32_bf16 v[116:119], a[204:207], v[172:175], v[116:119]
  v_mfma_f32_16x16x32_bf16 v[120:123], a[172:175], v[176:179], v[120:123]
  v_mfma_f32_16x16x32_bf16 v[124:127], a[204:207], v[176:179], v[124:127]
  v_mfma_f32_16x16x32_bf16 v[112:115], a[176:179], v[180:183], v[112:115]
  v_mfma_f32_16x16x32_bf16 v[116:119], a[208:211], v[180:183], v[116:119]
  v_mfma_f32_16x16x32_bf16 v[120:123], a[176:179], v[184:187], v[120:123]
  v_mfma_f32_16x16x32_bf16 v[124:127], a[208:211], v[184:187], v[124:127]
  v_mfma_f32_16x16x32_bf16 v[112:115], a[180:183], v[188:191], v[112:115]
  v_mfma_f32_16x16x32_bf16 v[116:119], a[212:215], v[188:191], v[116:119]
  v_mfma_f32_16x16x32_bf16 v[120:123], a[180:183], v[192:195], v[120:123]
  v_mfma_f32_16x16x32_bf16 v[124:127], a[212:215], v[192:195], v[124:127]
  v_mfma_f32_16x16x32_bf16 v[112:115], a[184:187], v[196:199], v[112:115]
  v_mfma_f32_16x16x32_bf16 v[116:119], a[216:219], v[196:199], v[116:119]
  v_mfma_f32_16x16x32_bf16 v[120:123], a[184:187], v[200:203], v[120:123]
  v_mfma_f32_16x16x32_bf16 v[124:127], a[216:219], v[200:203], v[124:127]
  v_mfma_f32_16x16x32_bf16 v[112:115], a[188:191], v[204:207], v[112:115]
  v_mfma_f32_16x16x32_bf16 v[116:119], a[220:223], v[204:207], v[116:119]
  v_mfma_f32_16x16x32_bf16 v[120:123], a[188:191], v[208:211], v[120:123]
  v_mfma_f32_16x16x32_bf16 v[124:127], a[220:223], v[208:211], v[124:127]
  v_mfma_f32_16x16x32_bf16 v[96:99], a[224:227], v[148:151], 0
  v_mfma_f32_16x16x32_bf16 v[104:107], a[224:227], v[152:155], 0
  v_mfma_f32_16x16x32_bf16 v[96:99], a[228:231], v[156:159], v[96:99]
  v_cvt_pk_bf16_f32 v112, v112, v113
  v_cvt_pk_bf16_f32 v113, v114, v115
  v_mfma_f32_16x16x32_bf16 v[104:107], a[228:231], v[160:163], v[104:107]
  v_cvt_pk_bf16_f32 v114, v116, v117
  v_cvt_pk_bf16_f32 v115, v118, v119
  v_mfma_f32_16x16x32_bf16 v[96:99], a[232:235], v[164:167], v[96:99]
  v_bfi_b32 v112, 1, s60, v112
  v_bfi_b32 v114, 1, s60, v114
  buffer_store_dwordx4 v[112:115], v4, s[4:7], s45 offen offset:1536 sc1
  v_mfma_f32_16x16x32_bf16 v[104:107], a[232:235], v[168:171], v[104:107]
  v_cvt_pk_bf16_f32 v120, v120, v121
  v_cvt_pk_bf16_f32 v121, v122, v123
  v_mfma_f32_16x16x32_bf16 v[96:99], a[236:239], v[172:175], v[96:99]
  v_cvt_pk_bf16_f32 v122, v124, v125
  v_cvt_pk_bf16_f32 v123, v126, v127
  v_mfma_f32_16x16x32_bf16 v[104:107], a[236:239], v[176:179], v[104:107]
  v_bfi_b32 v120, 1, s60, v120
  v_bfi_b32 v122, 1, s60, v122
  buffer_store_dwordx4 v[120:123], v4, s[4:7], s51 offen offset:1536 sc1
  v_mfma_f32_16x16x32_bf16 v[96:99], a[240:243], v[180:183], v[96:99]
  v_mfma_f32_16x16x32_bf16 v[104:107], a[240:243], v[184:187], v[104:107]
  v_mfma_f32_16x16x32_bf16 v[96:99], a[244:247], v[188:191], v[96:99]
  v_mfma_f32_16x16x32_bf16 v[104:107], a[244:247], v[192:195], v[104:107]
  v_mfma_f32_16x16x32_bf16 v[96:99], a[248:251], v[196:199], v[96:99]
  v_mfma_f32_16x16x32_bf16 v[104:107], a[248:251], v[200:203], v[104:107]
  v_mfma_f32_16x16x32_bf16 v[96:99], a[252:255], v[204:207], v[96:99]
  v_mfma_f32_16x16x32_bf16 v[104:107], a[252:255], v[208:211], v[104:107]
  s_nop 4
  v_cvt_pk_bf16_f32 v96, v96, v97
  v_cvt_pk_bf16_f32 v97, v98, v99
  v_bfi_b32 v96, 1, s60, v96
  buffer_store_dwordx2 v[96:97], v4, s[4:7], s45 offen offset:2048 sc1
  v_cvt_pk_bf16_f32 v104, v104, v105
  v_cvt_pk_bf16_f32 v105, v106, v107
  v_bfi_b32 v104, 1, s60, v104
  buffer_store_dwordx2 v[104:105], v4, s[4:7], s51 offen offset:2048 sc1
L_att_l0_wx:
  s_add_u32 s51, s45, 0
  buffer_load_dwordx4 v[128:131], v5, s[4:7], s51 offen offset:0 sc1
  s_add_u32 s51, s45, 9216
  buffer_load_dwordx4 v[132:135], v5, s[4:7], s51 offen offset:0 sc1
  s_add_u32 s51, s45, 18432
  buffer_load_dwordx4 v[136:139], v5, s[4:7], s51 offen offset:0 sc1
  s_add_u32 s51, s45, 27648
  buffer_load_dwordx4 v[140:143], v5, s[4:7], s51 offen offset:0 sc1
  s_add_u32 s51, s45, 0
  buffer_load_dwordx4 v[144:147], v5, s[4:7], s51 offen offset:512 sc1
  s_add_u32 s51, s45, 9216
  buffer_load_dwordx4 v[148:151], v5, s[4:7], s51 offen offset:512 sc1
  s_add_u32 s51, s45, 18432
  buffer_load_dwordx4 v[152:155], v5, s[4:7], s51 offen offset:512 sc1
  s_add_u32 s51, s45, 27648
  buffer_load_dwordx4 v[156:159], v5, s[4:7], s51 offen offset:512 sc1
  s_add_u32 s51, s45, 0
  buffer_load_dwordx4 v[160:163], v5, s[4:7], s51 offen offset:1024 sc1
  s_add_u32 s51, s45, 9216
  buffer_load_dwordx4 v[164:167], v5, s[4:7], s51 offen offset:1024 sc1
  s_add_u32 s51, s45, 18432
  buffer_load_dwordx4 v[168:171], v5, s[4:7], s51 offen offset:1024 sc1
  s_add_u32 s51, s45, 27648
  buffer_load_dwordx4 v[172:175], v5, s[4:7], s51 offen offset:1024 sc1
  s_add_u32 s51, s45, 0
  buffer_load_dwordx4 v[176:179], v5, s[4:7], s51 offen offset:1536 sc1
  s_add_u32 s51, s45, 9216
  buffer_load_dwordx4 v[180:183], v5, s[4:7], s51 offen offset:1536 sc1
  s_add_u32 s51, s45, 18432
  buffer_load_dwordx4 v[184:187], v5, s[4:7], s51 offen offset:1536 sc1
  s_add_u32 s51, s45, 27648
  buffer_load_dwordx4 v[188:191], v5, s[4:7], s51 offen offset:1536 sc1
  s_add_u32 s51, s45, 0
  buffer_load_dwordx4 v[192:195], v8, s[4:7], s51 offen offset:2048 sc1
  s_add_u32 s51, s45, 9216
  buffer_load_dwordx4 v[196:199], v8, s[4:7], s51 offen offset:2048 sc1
  s_add_u32 s51, s45, 18432
  buffer_load_dwordx4 v[200:203], v8, s[4:7], s51 offen offset:2048 sc1
  s_add_u32 s51, s45, 27648
  buffer_load_dwordx4 v[204:207], v8, s[4:7], s51 offen offset:2048 sc1
L_att_r0_0:
  s_waitcnt vmcnt(16)
  v_bitop3_b32 v10, v128, v130, s60 bitop3:0x7e
  v_bitop3_b32 v11, v132, v134, s60 bitop3:0x7e
  v_bitop3_b32 v12, v136, v138, s60 bitop3:0x7e
  v_bitop3_b32 v13, v140, v142, s60 bitop3:0x7e
  v_or3_b32 v10, v10, v11, v12
  v_bitop3_b32 v10, v10, v13, 1 bitop3:0xa8
  v_cmp_eq_u32 vcc, 1, v10
  s_nop 0
  s_cbranch_vccz L_att_r0_0_x
  s_add_u32 s50, s50, 1
  s_cmp_ge_u32 s50, 262144
  s_cbranch_scc1 L_att_r0_0_x
  s_add_u32 s51, s45, 0
  buffer_load_dwordx4 v[128:131], v5, s[4:7], s51 offen offset:0 sc1
  s_add_u32 s51, s45, 9216
  buffer_load_dwordx4 v[132:135], v5, s[4:7], s51 offen offset:0 sc1
  s_add_u32 s51, s45, 18432
  buffer_load_dwordx4 v[136:139], v5, s[4:7], s51 offen offset:0 sc1
  s_add_u32 s51, s45, 27648
  buffer_load_dwordx4 v[140:143], v5, s[4:7], s51 offen offset:0 sc1
  s_add_u32 s51, s45, 0
  buffer_load_dwordx4 v[144:147], v5, s[4:7], s51 offen offset:512 sc1
  s_add_u32 s51, s45, 9216
  buffer_load_dwordx4 v[148:151], v5, s[4:7], s51 offen offset:512 sc1
  s_add_u32 s51, s45, 18432
  buffer_load_dwordx4 v[152:155], v5, s[4:7], s51 offen offset:512 sc1
  s_add_u32 s51, s45, 27648
  buffer_load_dwordx4 v[156:159], v5, s[4:7], s51 offen offset:512 sc1
  s_add_u32 s51, s45, 0
  buffer_load_dwordx4 v[160:163], v5, s[4:7], s51 offen offset:1024 sc1
  s_add_u32 s51, s45, 9216
  buffer_load_dwordx4 v[164:167], v5, s[4:7], s51 offen offset:1024 sc1
  s_add_u32 s51, s45, 18432
  buffer_load_dwordx4 v[168:171], v5, s[4:7], s51 offen offset:1024 sc1
  s_add_u32 s51, s45, 27648
  buffer_load_dwordx4 v[172:175], v5, s[4:7], s51 offen offset:1024 sc1
  s_add_u32 s51, s45, 0
  buffer_load_dwordx4 v[176:179], v5, s[4:7], s51 offen offset:1536 sc1
  s_add_u32 s51, s45, 9216
  buffer_load_dwordx4 v[180:183], v5, s[4:7], s51 offen offset:1536 sc1
  s_add_u32 s51, s45, 18432
  buffer_load_dwordx4 v[184:187], v5, s[4:7], s51 offen offset:1536 sc1
  s_add_u32 s51, s45, 27648
  buffer_load_dwordx4 v[188:191], v5, s[4:7], s51 offen offset:1536 sc1
  s_add_u32 s51, s45, 0
  buffer_load_dwordx4 v[192:195], v8, s[4:7], s51 offen offset:2048 sc1
  s_add_u32 s51, s45, 9216
  buffer_load_dwordx4 v[196:199], v8, s[4:7], s51 offen offset:2048 sc1
  s_add_u32 s51, s45, 18432
  buffer_load_dwordx4 v[200:203], v8, s[4:7], s51 offen offset:2048 sc1
  s_add_u32 s51, s45, 27648
  buffer_load_dwordx4 v[204:207], v8, s[4:7], s51 offen offset:2048 sc1
  s_branch L_att_r0_0
L_att_r0_0_x:
  v_lshlrev_b32 v96, 16, v48
  v_and_b32 v97, 0xffff0000, v48
  v_lshlrev_b32_e64 v98, 16, v49
  v_and_b32 v99, 0xffff0000, v49
  v_lshlrev_b32 v100, 16, v50
  v_and_b32 v101, 0xffff0000, v50
  v_lshlrev_b32 v102, 16, v51
  v_and_b32 v103, 0xffff0000, v51
  v_lshlrev_b32 v104, 16, v52
  v_and_b32 v105, 0xffff0000, v52
  v_lshlrev_b32_e64 v106, 16, v53
  v_and_b32 v107, 0xffff0000, v53
  v_mfma_f32_16x16x32_bf16 v[96:99], v[212:215], v[128:131], v[96:99]
  v_mfma_f32_16x16x32_bf16 v[96:99], v[212:215], v[132:135], v[96:99]
  v_mfma_f32_16x16x32_bf16 v[96:99], v[212:215], v[136:139], v[96:99]
  v_mfma_f32_16x16x32_bf16 v[96:99], v[212:215], v[140:143], v[96:99]
L_att_r0_1:
  s_waitcnt vmcnt(12)
  v_bitop3_b32 v10, v144, v146, s60 bitop3:0x7e
  v_bitop3_b32 v11, v148, v150, s60 bitop3:0x7e
  v_bitop3_b32 v12, v152, v154, s60 bitop3:0x7e
  v_bitop3_b32 v13, v156, v158, s60 bitop3:0x7e
  v_or3_b32 v10, v10, v11, v12
  v_bitop3_b32 v10, v10, v13, 1 bitop3:0xa8
  v_cmp_eq_u32 vcc, 1, v10
  s_nop 0
  s_cbranch_vccz L_att_r0_1_x
  s_add_u32 s50, s50, 1
  s_cmp_ge_u32 s50, 262144
  s_cbranch_scc1 L_att_r0_1_x
  s_add_u32 s51, s45, 0
  buffer_load_dwordx4 v[144:147], v5, s[4:7], s51 offen offset:512 sc1
  s_add_u32 s51, s45, 9216
  buffer_load_dwordx4 v[148:151], v5, s[4:7], s51 offen offset:512 sc1
  s_add_u32 s51, s45, 18432
  buffer_load_dwordx4 v[152:155], v5, s[4:7], s51 offen offset:512 sc1
  s_add_u32 s51, s45, 27648
  buffer_load_dwordx4 v[156:159], v5, s[4:7], s51 offen offset:512 sc1
  s_add_u32 s51, s45, 0
  buffer_load_dwordx4 v[160:163], v5, s[4:7], s51 offen offset:1024 sc1
  s_add_u32 s51, s45, 9216
  buffer_load_dwordx4 v[164:167], v5, s[4:7], s51 offen offset:1024 sc1
  s_add_u32 s51, s45, 18432
  buffer_load_dwordx4 v[168:171], v5, s[4:7], s51 offen offset:1024 sc1
  s_add_u32 s51, s45, 27648
  buffer_load_dwordx4 v[172:175], v5, s[4:7], s51 offen offset:1024 sc1
  s_add_u32 s51, s45, 0
  buffer_load_dwordx4 v[176:179], v5, s[4:7], s51 offen offset:1536 sc1
  s_add_u32 s51, s45, 9216
  buffer_load_dwordx4 v[180:183], v5, s[4:7], s51 offen offset:1536 sc1
  s_add_u32 s51, s45, 18432
  buffer_load_dwordx4 v[184:187], v5, s[4:7], s51 offen offset:1536 sc1
  s_add_u32 s51, s45, 27648
  buffer_load_dwordx4 v[188:191], v5, s[4:7], s51 offen offset:1536 sc1
  s_add_u32 s51, s45, 0
  buffer_load_dwordx4 v[192:195], v8, s[4:7], s51 offen offset:2048 sc1
  s_add_u32 s51, s45, 9216
  buffer_load_dwordx4 v[196:199], v8, s[4:7], s51 offen offset:2048 sc1
  s_add_u32 s51, s45, 18432
  buffer_load_dwordx4 v[200:203], v8, s[4:7], s51 offen offset:2048 sc1
  s_add_u32 s51, s45, 27648
  buffer_load_dwordx4 v[204:207], v8, s[4:7], s51 offen offset:2048 sc1
  s_branch L_att_r0_1
L_att_r0_1_x:
  v_mfma_f32_16x16x32_bf16 v[96:99], v[216:219], v[144:147], v[96:99]
  v_mfma_f32_16x16x32_bf16 v[96:99], v[216:219], v[148:151], v[96:99]
  v_mfma_f32_16x16x32_bf16 v[96:99], v[216:219], v[152:155], v[96:99]
  v_mfma_f32_16x16x32_bf16 v[96:99], v[216:219], v[156:159], v[96:99]
L_att_r0_2:
  s_waitcnt vmcnt(8)
  v_bitop3_b32 v10, v160, v162, s60 bitop3:0x7e
  v_bitop3_b32 v11, v164, v166, s60 bitop3:0x7e
  v_bitop3_b32 v12, v168, v170, s60 bitop3:0x7e
  v_bitop3_b32 v13, v172, v174, s60 bitop3:0x7e
  v_or3_b32 v10, v10, v11, v12
  v_bitop3_b32 v10, v10, v13, 1 bitop3:0xa8
  v_cmp_eq_u32 vcc, 1, v10
  s_nop 0
  s_cbranch_vccz L_att_r0_2_x
  s_add_u32 s50, s50, 1
  s_cmp_ge_u32 s50, 262144
  s_cbranch_scc1 L_att_r0_2_x
  s_add_u32 s51, s45, 0
  buffer_load_dwordx4 v[160:163], v5, s[4:7], s51 offen offset:1024 sc1
  s_add_u32 s51, s45, 9216
  buffer_load_dwordx4 v[164:167], v5, s[4:7], s51 offen offset:1024 sc1
  s_add_u32 s51, s45, 18432
  buffer_load_dwordx4 v[168:171], v5, s[4:7], s51 offen offset:1024 sc1
  s_add_u32 s51, s45, 27648
  buffer_load_dwordx4 v[172:175], v5, s[4:7], s51 offen offset:1024 sc1
  s_add_u32 s51, s45, 0
  buffer_load_dwordx4 v[176:179], v5, s[4:7], s51 offen offset:1536 sc1
  s_add_u32 s51, s45, 9216
  buffer_load_dwordx4 v[180:183], v5, s[4:7], s51 offen offset:1536 sc1
  s_add_u32 s51, s45, 18432
  buffer_load_dwordx4 v[184:187], v5, s[4:7], s51 offen offset:1536 sc1
  s_add_u32 s51, s45, 27648
  buffer_load_dwordx4 v[188:191], v5, s[4:7], s51 offen offset:1536 sc1
  s_add_u32 s51, s45, 0
  buffer_load_dwordx4 v[192:195], v8, s[4:7], s51 offen offset:2048 sc1
  s_add_u32 s51, s45, 9216
  buffer_load_dwordx4 v[196:199], v8, s[4:7], s51 offen offset:2048 sc1
  s_add_u32 s51, s45, 18432
  buffer_load_dwordx4 v[200:203], v8, s[4:7], s51 offen offset:2048 sc1
  s_add_u32 s51, s45, 27648
  buffer_load_dwordx4 v[204:207], v8, s[4:7], s51 offen offset:2048 sc1
  s_branch L_att_r0_2
L_att_r0_2_x:
  v_mfma_f32_16x16x32_bf16 v[100:103], v[212:215], v[160:163], v[100:103]
  v_mfma_f32_16x16x32_bf16 v[100:103], v[212:215], v[164:167], v[100:103]
  v_mfma_f32_16x16x32_bf16 v[100:103], v[212:215], v[168:171], v[100:103]
  v_mfma_f32_16x16x32_bf16 v[100:103], v[212:215], v[172:175], v[100:103]
L_att_r0_3:
  s_waitcnt vmcnt(4)
  v_bitop3_b32 v10, v176, v178, s60 bitop3:0x7e
  v_bitop3_b32 v11, v180, v182, s60 bitop3:0x7e
  v_bitop3_b32 v12, v184, v186, s60 bitop3:0x7e
  v_bitop3_b32 v13, v188, v190, s60 bitop3:0x7e
  v_or3_b32 v10, v10, v11, v12
  v_bitop3_b32 v10, v10, v13, 1 bitop3:0xa8
  v_cmp_eq_u32 vcc, 1, v10
  s_nop 0
  s_cbranch_vccz L_att_r0_3_x
  s_add_u32 s50, s50, 1
  s_cmp_ge_u32 s50, 262144
  s_cbranch_scc1 L_att_r0_3_x
  s_add_u32 s51, s45, 0
  buffer_load_dwordx4 v[176:179], v5, s[4:7], s51 offen offset:1536 sc1
  s_add_u32 s51, s45, 9216
  buffer_load_dwordx4 v[180:183], v5, s[4:7], s51 offen offset:1536 sc1
  s_add_u32 s51, s45, 18432
  buffer_load_dwordx4 v[184:187], v5, s[4:7], s51 offen offset:1536 sc1
  s_add_u32 s51, s45, 27648
  buffer_load_dwordx4 v[188:191], v5, s[4:7], s51 offen offset:1536 sc1
  s_add_u32 s51, s45, 0
  buffer_load_dwordx4 v[192:195], v8, s[4:7], s51 offen offset:2048 sc1
  s_add_u32 s51, s45, 9216
  buffer_load_dwordx4 v[196:199], v8, s[4:7], s51 offen offset:2048 sc1
  s_add_u32 s51, s45, 18432
  buffer_load_dwordx4 v[200:203], v8, s[4:7], s51 offen offset:2048 sc1
  s_add_u32 s51, s45, 27648
  buffer_load_dwordx4 v[204:207], v8, s[4:7], s51 offen offset:2048 sc1
  s_branch L_att_r0_3
L_att_r0_3_x:
  v_mfma_f32_16x16x32_bf16 v[100:103], v[216:219], v[176:179], v[100:103]
  v_mfma_f32_16x16x32_bf16 v[100:103], v[216:219], v[180:183], v[100:103]
  v_mfma_f32_16x16x32_bf16 v[100:103], v[216:219], v[184:187], v[100:103]
  v_mfma_f32_16x16x32_bf16 v[100:103], v[216:219], v[188:191], v[100:103]
L_att_r0_4:
  s_waitcnt vmcnt(0)
  v_bitop3_b32 v10, v192, v194, s60 bitop3:0x7e
  v_bitop3_b32 v11, v196, v198, s60 bitop3:0x7e
  v_bitop3_b32 v12, v200, v202, s60 bitop3:0x7e
  v_bitop3_b32 v13, v204, v206, s60 bitop3:0x7e
  v_or3_b32 v10, v10, v11, v12
  v_bitop3_b32 v10, v10, v13, 1 bitop3:0xa8
  v_cmp_eq_u32 vcc, 1, v10
  s_nop 0
  s_cbranch_vccz L_att_r0_4_x
  s_add_u32 s50, s50, 1
  s_cmp_ge_u32 s50, 262144
  s_cbranch_scc1 L_att_r0_4_x
  s_add_u32 s51, s45, 0
  buffer_load_dwordx4 v[192:195], v8, s[4:7], s51 offen offset:2048 sc1
  s_add_u32 s51, s45, 9216
  buffer_load_dwordx4 v[196:199], v8, s[4:7], s51 offen offset:2048 sc1
  s_add_u32 s51, s45, 18432
  buffer_load_dwordx4 v[200:203], v8, s[4:7], s51 offen offset:2048 sc1
  s_add_u32 s51, s45, 27648
  buffer_load_dwordx4 v[204:207], v8, s[4:7], s51 offen offset:2048 sc1
  s_branch L_att_r0_4
L_att_r0_4_x:
  v_mfma_f32_16x16x32_bf16 v[104:107], v[212:215], v[192:195], v[104:107]
  v_mfma_f32_16x16x32_bf16 v[104:107], v[212:215], v[196:199], v[104:107]
  v_mfma_f32_16x16x32_bf16 v[104:107], v[212:215], v[200:203], v[104:107]
  v_mfma_f32_16x16x32_bf16 v[104:107], v[212:215], v[204:207], v[104:107]
  s_mov_b32 s34, 0x00ff00ff
  s_mov_b32 s35, 0
  v_cvt_pk_bf16_f32 v108, v96, v97
  v_cvt_pk_bf16_f32 v109, v98, v99
  v_cvt_pk_bf16_f32 v110, v100, v101
  v_cvt_pk_bf16_f32 v111, v102, v103
  s_nop 1
  v_cvt_pk_bf16_f32 v112, v104, v105
  v_cvt_pk_bf16_f32 v113, v106, v107
  v_cndmask_b32 v112, 0, v112, s[34:35]
  v_cndmask_b32 v113, 0, v113, s[34:35]
  v_lshlrev_b32 v96, 16, v108
  v_and_b32 v97, 0xffff0000, v108
  v_lshlrev_b32 v98, 16, v109
  v_and_b32 v99, 0xffff0000, v109
  v_lshlrev_b32 v100, 16, v110
  v_and_b32 v101, 0xffff0000, v110
  v_lshlrev_b32 v102, 16, v111
  v_and_b32 v103, 0xffff0000, v111
  v_lshlrev_b32 v104, 16, v112
  v_and_b32 v105, 0xffff0000, v112
  v_lshlrev_b32 v106, 16, v113
  v_and_b32 v107, 0xffff0000, v113
  s_add_u32 s51, s41, 4194304
  v_permlane16_swap_b32 v108, v110
  v_permlane16_swap_b32 v109, v111
  buffer_store_dwordx4 v[108:111], v9, s[4:7], s51 offen sc1
  buffer_store_dwordx2 v[112:113], v7, s[4:7], s51 offen sc1
  v_add_f32 v10, v96, v97
  v_add_f32 v11, v98, v99
  v_add_f32 v10, v10, v100
  v_add_f32 v11, v11, v101
  v_add_f32 v10, v10, v102
  v_add_f32 v11, v11, v103
  v_add_f32 v10, v10, v104
  v_add_f32 v11, v11, v105
  v_add_f32 v10, v10, v106
  v_add_f32 v11, v11, v107
  v_add_f32 v10, v10, v11
  s_nop 1
  v_add_f32_dpp v10, v10, v10 quad_perm:[1,0,3,2] row_mask:0xf bank_mask:0xf
  s_nop 1
  v_add_f32_dpp v10, v10, v10 quad_perm:[2,3,0,1] row_mask:0xf bank_mask:0xf
  s_nop 1
  v_add_f32_dpp v10, v10, v10 row_half_mirror row_mask:0xf bank_mask:0xf
  s_nop 1
  v_add_f32_dpp v10, v10, v10 row_mirror row_mask:0xf bank_mask:0xf
  v_mov_b32 v11, v10
  s_nop 1
  v_permlane16_swap_b32 v10, v11
  v_add_f32 v10, v10, v11
  v_mov_b32 v11, v10
  s_nop 1
  v_permlane32_swap_b32 v10, v11
  v_add_f32 v10, v10, v11
  v_mul_f32 v10, 0x3ae38e39, v10
  v_sub_f32 v96, v96, v10
  v_sub_f32 v97, v97, v10
  v_sub_f32 v98, v98, v10
  v_sub_f32 v99, v99, v10
  v_sub_f32 v100, v100, v10
  v_sub_f32 v101, v101, v10
  v_sub_f32 v102, v102, v10
  v_sub_f32 v103, v103, v10
  v_sub_f32 v104, v104, v10
  v_sub_f32 v105, v105, v10
  v_sub_f32 v106, v106, v10
  v_sub_f32 v107, v107, v10
  v_cndmask_b32 v104, 0, v104, s[34:35]
  v_cndmask_b32 v105, 0, v105, s[34:35]
  v_cndmask_b32 v106, 0, v106, s[34:35]
  v_cndmask_b32 v107, 0, v107, s[34:35]
  v_mul_f32 v10, v96, v96
  v_mul_f32 v11, v97, v97
  v_fmac_f32 v10, v98, v98
  v_fmac_f32 v11, v99, v99
  v_fmac_f32 v10, v100, v100
  v_fmac_f32 v11, v101, v101
  v_fmac_f32 v10, v102, v102
  v_fmac_f32 v11, v103, v103
  v_fmac_f32 v10, v104, v104
  v_fmac_f32 v11, v105, v105
  v_fmac_f32 v10, v106, v106
  v_fmac_f32 v11, v107, v107
  v_add_f32 v10, v10, v11
  s_nop 1
  v_add_f32_dpp v10, v10, v10 quad_perm:[1,0,3,2] row_mask:0xf bank_mask:0xf
  s_nop 1
  v_add_f32_dpp v10, v10, v10 quad_perm:[2,3,0,1] row_mask:0xf bank_mask:0xf
  s_nop 1
  v_add_f32_dpp v10, v10, v10 row_half_mirror row_mask:0xf bank_mask:0xf
  s_nop 1
  v_add_f32_dpp v10, v10, v10 row_mirror row_mask:0xf bank_mask:0xf
  v_mov_b32 v11, v10
  s_nop 1
  v_permlane16_swap_b32 v10, v11
  v_add_f32 v10, v10, v11
  v_mov_b32 v11, v10
  s_nop 1
  v_permlane32_swap_b32 v10, v11
  v_add_f32 v10, v10, v11
  v_mov_b32 v11, 0x3727c5ac
  v_fmac_f32 v11, 0x3ae38e39, v10
  v_rsq_f32 v11, v11
  s_nop 0
  v_mul_f32 v96, v11, v96
  v_mul_f32 v97, v11, v97
  v_mul_f32 v98, v11, v98
  v_mul_f32 v99, v11, v99
  v_mul_f32 v100, v11, v100
  v_mul_f32 v101, v11, v101
  v_mul_f32 v102, v11, v102
  v_mul_f32 v103, v11, v103
  v_mul_f32 v104, v11, v104
  v_mul_f32 v105, v11, v105
  v_mul_f32 v106, v11, v106
  v_mul_f32_e64 v107, v11, v107
  v_cvt_pk_bf16_f32 v116, v96, v97
  v_cvt_pk_bf16_f32 v117, v98, v99
  v_cvt_pk_bf16_f32 v118, v100, v101
  v_cvt_pk_bf16_f32 v119, v102, v103
  v_cvt_pk_bf16_f32 v120, v104, v105
  v_cvt_pk_bf16_f32 v121, v106, v107
  s_add_u32 s51, s41, 7340032
  v_permlane16_swap_b32 v116, v118
  v_permlane16_swap_b32 v117, v119
  buffer_store_dwordx4 v[116:119], v9, s[4:7], s51 offen sc1
  buffer_store_dwordx2 v[120:121], v7, s[4:7], s51 offen sc1
  s_cmp_eq_u32 s40, 60
  s_cselect_b32 s34, s38, 0
  s_sub_u32 s40, s40, s34
  s_cmp_ge_u32 s40, 60
  s_cbranch_scc1 L_att_l0_end
  s_add_u32 s95, s40, 5
  s_cmp_ge_u32 s48, s95
  s_cbranch_scc1 L_ap_17_x
L_ap_17:
  s_load_dwordx4 s[96:99], s[4:5], s92 glc
  s_load_dwordx2 s[100:101], s[4:5], s93 glc
  s_add_u32 s50, s50, 1
  s_cmp_ge_u32 s50, 262144
  s_cbranch_scc1 L_ap_17_y
  s_waitcnt lgkmcnt(0)
  s_min_u32 s48, s96, s97
  s_min_u32 s48, s48, s98
  s_min_u32 s48, s48, s99
  s_min_u32 s48, s48, s100
  s_min_u32 s48, s48, s101
  s_cmp_lt_u32 s48, s95
  s_cbranch_scc1 L_ap_17
L_ap_17_y:
  s_waitcnt lgkmcnt(0)
L_ap_17_x:
  s_lshl_b32 s34, s40, 5
  s_lshl1_add_u32 s34, s43, s34
  s_add_u32 s34, s34, 128
  s_lshl_b32 s34, s34, 13
  s_add_u32 s51, s34, 18874368
  buffer_load_dwordx4 v[16:19], v1, s[4:7], s51 offen offset:0 sc1
  buffer_load_dwordx4 v[20:23], v1, s[4:7], s51 offen offset:1024 sc1
  buffer_load_dwordx4 v[24:27], v1, s[4:7], s51 offen offset:2048 sc1
  buffer_load_dwordx4 v[28:31], v1, s[4:7], s51 offen offset:3072 sc1
  s_add_u32 s51, s34, 35651584
  buffer_load_dwordx4 v[32:35], v1, s[4:7], s51 offen offset:0 sc1
  buffer_load_dwordx4 v[36:39], v1, s[4:7], s51 offen offset:1024 sc1
  buffer_load_dwordx4 v[40:43], v1, s[4:7], s51 offen offset:2048 sc1
  buffer_load_dwordx4 v[44:47], v1, s[4:7], s51 offen offset:3072 sc1
  s_add_u32 s51, s34, 52428800
  buffer_load_dwordx4 v[64:67], v1, s[4:7], s51 offen offset:0 sc1
  buffer_load_dwordx4 v[68:71], v1, s[4:7], s51 offen offset:1024 sc1
  buffer_load_dwordx4 v[72:75], v1, s[4:7], s51 offen offset:2048 sc1
  buffer_load_dwordx4 v[76:79], v1, s[4:7], s51 offen offset:3072 sc1
  s_add_u32 s51, s34, 52432896
  buffer_load_dwordx4 v[80:83], v1, s[4:7], s51 offen offset:0 sc1
  buffer_load_dwordx4 v[84:87], v1, s[4:7], s51 offen offset:1024 sc1
  buffer_load_dwordx4 v[88:91], v1, s[4:7], s51 offen offset:2048 sc1
  buffer_load_dwordx4 v[92:95], v1, s[4:7], s51 offen offset:3072 sc1
  s_add_u32 s40, s40, 4
  s_branch L_att_l0
L_att_l0_end:
  s_endpgm
L_att_w1:
  v_lshrrev_b32 v12, 2, v0
  v_mul_u32_u24 v12, 1152, v12
  v_and_b32 v13, 3, v0
  v_lshl_add_u32 v12, v13, 4, v12
  v_add_u32 v13, 73728, v12
  s_waitcnt vmcnt(27)
  s_barrier
  ds_read_b64_tr_b16 v[224:225], v12 offset:320
  ds_read_b64_tr_b16 v[226:227], v12 offset:18752
  ds_read_b64_tr_b16 a[0:1], v12 offset:328
  ds_read_b64_tr_b16 a[2:3], v12 offset:18760
  ds_read_b64_tr_b16 a[32:33], v12 offset:384
  ds_read_b64_tr_b16 a[34:35], v12 offset:18816
  ds_read_b64_tr_b16 a[64:65], v12 offset:392
  ds_read_b64_tr_b16 a[66:67], v12 offset:18824
  ds_read_b64_tr_b16 a[96:97], v12 offset:448
  ds_read_b64_tr_b16 a[98:99], v12 offset:18880
  ds_read_b64_tr_b16 a[128:129], v12 offset:456
  ds_read_b64_tr_b16 a[130:131], v12 offset:18888
  ds_read_b64_tr_b16 a[160:161], v12 offset:512
  ds_read_b64_tr_b16 a[162:163], v12 offset:18944
  ds_read_b64_tr_b16 a[192:193], v12 offset:520
  ds_read_b64_tr_b16 a[194:195], v12 offset:18952
  ds_read_b64_tr_b16 a[224:225], v12 offset:264
  ds_read_b64_tr_b16 a[226:227], v12 offset:18696
  s_waitcnt lgkmcnt(0)
  s_barrier
  s_add_u32 m0, s42, 0
  s_add_u32 s51, s45, 147456
  buffer_load_dwordx4 v1, s[16:19], s51 offen offset:0 lds
  buffer_load_dwordx4 v1, s[16:19], s51 offen offset:1024 lds
  buffer_load_dwordx4 v1, s[16:19], s51 offen offset:2048 lds
  buffer_load_dwordx4 v1, s[16:19], s51 offen offset:3072 lds
  s_add_u32 m0, s42, 4096
  s_add_u32 s51, s45, 151552
  buffer_load_dwordx4 v1, s[16:19], s51 offen offset:0 lds
  buffer_load_dwordx4 v1, s[16:19], s51 offen offset:1024 lds
  buffer_load_dwordx4 v1, s[16:19], s51 offen offset:2048 lds
  buffer_load_dwordx4 v1, s[16:19], s51 offen offset:3072 lds
  s_add_u32 m0, s42, 8192
  s_add_u32 s51, s45, 155648
  buffer_load_dwordx4 v1, s[16:19], s51 offen offset:0 lds
  s_waitcnt vmcnt(27)
  s_barrier
  ds_read_b64_tr_b16 v[228:229], v12 offset:37184
  ds_read_b64_tr_b16 v[230:231], v12 offset:55616
  ds_read_b64_tr_b16 a[4:5], v12 offset:37192
  ds_read_b64_tr_b16 a[6:7], v12 offset:55624
  ds_read_b64_tr_b16 a[36:37], v12 offset:37248
  ds_read_b64_tr_b16 a[38:39], v12 offset:55680
  ds_read_b64_tr_b16 a[68:69], v12 offset:37256
  ds_read_b64_tr_b16 a[70:71], v12 offset:55688
  ds_read_b64_tr_b16 a[100:101], v12 offset:37312
  ds_read_b64_tr_b16 a[102:103], v12 offset:55744
  ds_read_b64_tr_b16 a[132:133], v12 offset:37320
  ds_read_b64_tr_b16 a[134:135], v12 offset:55752
  ds_read_b64_tr_b16 a[164:165], v12 offset:37376
  ds_read_b64_tr_b16 a[166:167], v12 offset:55808
  ds_read_b64_tr_b16 a[196:197], v12 offset:37384
  ds_read_b64_tr_b16 a[198:199], v12 offset:55816
  ds_read_b64_tr_b16 a[228:229], v12 offset:37128
  ds_read_b64_tr_b16 a[230:231], v12 offset:55560
  s_waitcnt lgkmcnt(0)
  s_barrier
  s_add_u32 m0, s42, 36864
  s_add_u32 s51, s45, 184320
  buffer_load_dwordx4 v1, s[16:19], s51 offen offset:0 lds
  buffer_load_dwordx4 v1, s[16:19], s51 offen offset:1024 lds
  buffer_load_dwordx4 v1, s[16:19], s51 offen offset:2048 lds
  buffer_load_dwordx4 v1, s[16:19], s51 offen offset:3072 lds
  s_add_u32 m0, s42, 40960
  s_add_u32 s51, s45, 188416
  buffer_load_dwordx4 v1, s[16:19], s51 offen offset:0 lds
  buffer_load_dwordx4 v1, s[16:19], s51 offen offset:1024 lds
  buffer_load_dwordx4 v1, s[16:19], s51 offen offset:2048 lds
  buffer_load_dwordx4 v1, s[16:19], s51 offen offset:3072 lds
  s_add_u32 m0, s42, 45056
  s_add_u32 s51, s45, 192512
  buffer_load_dwordx4 v1, s[16:19], s51 offen offset:0 lds
  s_waitcnt vmcnt(27)
  s_barrier
  ds_read_b64_tr_b16 v[232:233], v13 offset:320
  ds_read_b64_tr_b16 v[234:235], v13 offset:18752
  ds_read_b64_tr_b16 a[8:9], v13 offset:328
  ds_read_b64_tr_b16 a[10:11], v13 offset:18760
  ds_read_b64_tr_b16 a[40:41], v13 offset:384
  ds_read_b64_tr_b16 a[42:43], v13 offset:18816
  ds_read_b64_tr_b16 a[72:73], v13 offset:392
  ds_read_b64_tr_b16 a[74:75], v13 offset:18824
  ds_read_b64_tr_b16 a[104:105], v13 offset:448
  ds_read_b64_tr_b16 a[106:107], v13 offset:18880
  ds_read_b64_tr_b16 a[136:137], v13 offset:456
  ds_read_b64_tr_b16 a[138:139], v13 offset:18888
  ds_read_b64_tr_b16 a[168:169], v13 offset:512
  ds_read_b64_tr_b16 a[170:171], v13 offset:18944
  ds_read_b64_tr_b16 a[200:201], v13 offset:520
  ds_read_b64_tr_b16 a[202:203], v13 offset:18952
  ds_read_b64_tr_b16 a[232:233], v13 offset:264
  ds_read_b64_tr_b16 a[234:235], v13 offset:18696
  s_waitcnt lgkmcnt(0)
  s_barrier
  s_add_u32 m0, s42, 73728
  s_add_u32 s51, s45, 221184
  buffer_load_dwordx4 v1, s[16:19], s51 offen offset:0 lds
  buffer_load_dwordx4 v1, s[16:19], s51 offen offset:1024 lds
  buffer_load_dwordx4 v1, s[16:19], s51 offen offset:2048 lds
  buffer_load_dwordx4 v1, s[16:19], s51 offen offset:3072 lds
  s_add_u32 m0, s42, 77824
  s_add_u32 s51, s45, 225280
  buffer_load_dwordx4 v1, s[16:19], s51 offen offset:0 lds
  buffer_load_dwordx4 v1, s[16:19], s51 offen offset:1024 lds
  buffer_load_dwordx4 v1, s[16:19], s51 offen offset:2048 lds
  buffer_load_dwordx4 v1, s[16:19], s51 offen offset:3072 lds
  s_add_u32 m0, s42, 81920
  s_add_u32 s51, s45, 229376
  buffer_load_dwordx4 v1, s[16:19], s51 offen offset:0 lds
  s_waitcnt vmcnt(27)
  s_barrier
  ds_read_b64_tr_b16 v[236:237], v13 offset:37184
  ds_read_b64_tr_b16 v[238:239], v13 offset:55616
  ds_read_b64_tr_b16 a[12:13], v13 offset:37192
  ds_read_b64_tr_b16 a[14:15], v13 offset:55624
  ds_read_b64_tr_b16 a[44:45], v13 offset:37248
  ds_read_b64_tr_b16 a[46:47], v13 offset:55680
  ds_read_b64_tr_b16 a[76:77], v13 offset:37256
  ds_read_b64_tr_b16 a[78:79], v13 offset:55688
  ds_read_b64_tr_b16 a[108:109], v13 offset:37312
  ds_read_b64_tr_b16 a[110:111], v13 offset:55744
  ds_read_b64_tr_b16 a[140:141], v13 offset:37320
  ds_read_b64_tr_b16 a[142:143], v13 offset:55752
  ds_read_b64_tr_b16 a[172:173], v13 offset:37376
  ds_read_b64_tr_b16 a[174:175], v13 offset:55808
  ds_read_b64_tr_b16 a[204:205], v13 offset:37384
  ds_read_b64_tr_b16 a[206:207], v13 offset:55816
  ds_read_b64_tr_b16 a[236:237], v13 offset:37128
  ds_read_b64_tr_b16 a[238:239], v13 offset:55560
  s_waitcnt lgkmcnt(0)
  s_barrier
  s_add_u32 m0, s42, 110592
  s_add_u32 s51, s45, 258048
  buffer_load_dwordx4 v1, s[16:19], s51 offen offset:0 lds
  buffer_load_dwordx4 v1, s[16:19], s51 offen offset:1024 lds
  buffer_load_dwordx4 v1, s[16:19], s51 offen offset:2048 lds
  buffer_load_dwordx4 v1, s[16:19], s51 offen offset:3072 lds
  s_add_u32 m0, s42, 114688
  s_add_u32 s51, s45, 262144
  buffer_load_dwordx4 v1, s[16:19], s51 offen offset:0 lds
  buffer_load_dwordx4 v1, s[16:19], s51 offen offset:1024 lds
  buffer_load_dwordx4 v1, s[16:19], s51 offen offset:2048 lds
  buffer_load_dwordx4 v1, s[16:19], s51 offen offset:3072 lds
  s_add_u32 m0, s42, 118784
  s_add_u32 s51, s45, 266240
  buffer_load_dwordx4 v1, s[16:19], s51 offen offset:0 lds
  s_waitcnt vmcnt(27)
  s_barrier
  ds_read_b64_tr_b16 v[240:241], v12 offset:320
  ds_read_b64_tr_b16 v[242:243], v12 offset:18752
  ds_read_b64_tr_b16 a[16:17], v12 offset:328
  ds_read_b64_tr_b16 a[18:19], v12 offset:18760
  ds_read_b64_tr_b16 a[48:49], v12 offset:384
  ds_read_b64_tr_b16 a[50:51], v12 offset:18816
  ds_read_b64_tr_b16 a[80:81], v12 offset:392
  ds_read_b64_tr_b16 a[82:83], v12 offset:18824
  ds_read_b64_tr_b16 a[112:113], v12 offset:448
  ds_read_b64_tr_b16 a[114:115], v12 offset:18880
  ds_read_b64_tr_b16 a[144:145], v12 offset:456
  ds_read_b64_tr_b16 a[146:147], v12 offset:18888
  ds_read_b64_tr_b16 a[176:177], v12 offset:512
  ds_read_b64_tr_b16 a[178:179], v12 offset:18944
  ds_read_b64_tr_b16 a[208:209], v12 offset:520
  ds_read_b64_tr_b16 a[210:211], v12 offset:18952
  ds_read_b64_tr_b16 a[240:241], v12 offset:264
  ds_read_b64_tr_b16 a[242:243], v12 offset:18696
  s_waitcnt lgkmcnt(0)
  s_waitcnt vmcnt(18)
  s_barrier
  ds_read_b64_tr_b16 v[244:245], v12 offset:37184
  ds_read_b64_tr_b16 v[246:247], v12 offset:55616
  ds_read_b64_tr_b16 a[20:21], v12 offset:37192
  ds_read_b64_tr_b16 a[22:23], v12 offset:55624
  ds_read_b64_tr_b16 a[52:53], v12 offset:37248
  ds_read_b64_tr_b16 a[54:55], v12 offset:55680
  ds_read_b64_tr_b16 a[84:85], v12 offset:37256
  ds_read_b64_tr_b16 a[86:87], v12 offset:55688
  ds_read_b64_tr_b16 a[116:117], v12 offset:37312
  ds_read_b64_tr_b16 a[118:119], v12 offset:55744
  ds_read_b64_tr_b16 a[148:149], v12 offset:37320
  ds_read_b64_tr_b16 a[150:151], v12 offset:55752
  ds_read_b64_tr_b16 a[180:181], v12 offset:37376
  ds_read_b64_tr_b16 a[182:183], v12 offset:55808
  ds_read_b64_tr_b16 a[212:213], v12 offset:37384
  ds_read_b64_tr_b16 a[214:215], v12 offset:55816
  ds_read_b64_tr_b16 a[244:245], v12 offset:37128
  ds_read_b64_tr_b16 a[246:247], v12 offset:55560
  s_waitcnt lgkmcnt(0)
  s_waitcnt vmcnt(9)
  s_barrier
  ds_read_b64_tr_b16 v[248:249], v13 offset:320
  ds_read_b64_tr_b16 v[250:251], v13 offset:18752
  ds_read_b64_tr_b16 a[24:25], v13 offset:328
  ds_read_b64_tr_b16 a[26:27], v13 offset:18760
  ds_read_b64_tr_b16 a[56:57], v13 offset:384
  ds_read_b64_tr_b16 a[58:59], v13 offset:18816
  ds_read_b64_tr_b16 a[88:89], v13 offset:392
  ds_read_b64_tr_b16 a[90:91], v13 offset:18824
  ds_read_b64_tr_b16 a[120:121], v13 offset:448
  ds_read_b64_tr_b16 a[122:123], v13 offset:18880
  ds_read_b64_tr_b16 a[152:153], v13 offset:456
  ds_read_b64_tr_b16 a[154:155], v13 offset:18888
  ds_read_b64_tr_b16 a[184:185], v13 offset:512
  ds_read_b64_tr_b16 a[186:187], v13 offset:18944
  ds_read_b64_tr_b16 a[216:217], v13 offset:520
  ds_read_b64_tr_b16 a[218:219], v13 offset:18952
  ds_read_b64_tr_b16 a[248:249], v13 offset:264
  ds_read_b64_tr_b16 a[250:251], v13 offset:18696
  s_waitcnt lgkmcnt(0)
  s_waitcnt vmcnt(0)
  s_barrier
  ds_read_b64_tr_b16 v[252:253], v13 offset:37184
  ds_read_b64_tr_b16 v[254:255], v13 offset:55616
  ds_read_b64_tr_b16 a[28:29], v13 offset:37192
  ds_read_b64_tr_b16 a[30:31], v13 offset:55624
  ds_read_b64_tr_b16 a[60:61], v13 offset:37248
  ds_read_b64_tr_b16 a[62:63], v13 offset:55680
  ds_read_b64_tr_b16 a[92:93], v13 offset:37256
  ds_read_b64_tr_b16 a[94:95], v13 offset:55688
  ds_read_b64_tr_b16 a[124:125], v13 offset:37312
  ds_read_b64_tr_b16 a[126:127], v13 offset:55744
  ds_read_b64_tr_b16 a[156:157], v13 offset:37320
  ds_read_b64_tr_b16 a[158:159], v13 offset:55752
  ds_read_b64_tr_b16 a[188:189], v13 offset:37376
  ds_read_b64_tr_b16 a[190:191], v13 offset:55808
  ds_read_b64_tr_b16 a[220:221], v13 offset:37384
  ds_read_b64_tr_b16 a[222:223], v13 offset:55816
  ds_read_b64_tr_b16 a[252:253], v13 offset:37128
  ds_read_b64_tr_b16 a[254:255], v13 offset:55560
  s_waitcnt lgkmcnt(0)
  v_and_b32 v10, 15, v0
  v_lshrrev_b32 v11, 4, v0
  v_lshrrev_b32 v12, 2, v10
  v_and_b32 v13, 1, v0
  v_lshl_add_u32 v14, v12, 1, v13
  v_lshlrev_b32 v14, 4, v14
  v_lshl_add_u32 v2, v11, 7, v14
  v_lshlrev_b32 v3, 3, v0
  v_lshrrev_b32 v14, 1, v10
  v_mul_u32_u24 v14, 36864, v14
  v_lshl_add_u32 v14, v13, 6, v14
  v_lshl_add_u32 v14, v11, 4, v14
  s_mul_i32 s34, s43, 2304
  v_add_u32 v4, s34, v14
  s_lshl_b32 s34, s43, 8
  s_add_u32 s92, s34, 0
  s_add_u32 s94, s34, 6144
  s_lshl_b32 s34, s43, 7
  s_add_u32 s93, s34, 4096
  s_mov_b32 s48, 0
  s_mov_b32 s49, 0
  s_mov_b32 s52, 0xfff0ffff
  s_mov_b32 s53, 0xf000ff00
  s_mov_b32 s54, 0xffe0fffe
  s_mov_b32 s55, 0xe000fe00
  s_mov_b32 s56, 0xffc0fffc
  s_mov_b32 s57, 0xc000fc00
  s_mov_b32 s58, 0xff80fff8
  s_mov_b32 s59, 0x8000f800
  s_mov_b32 s46, 0x3e0293ee
  s_mov_b32 s47, 0xbe0293ee
  s_mul_i32 s34, s44, 1179648
  s_mul_i32 s35, s43, 36864
  s_add_u32 s34, s34, s35
  s_sub_u32 s35, s32, 48
  s_mul_i32 s35, s35, 36864
  v_mov_b64 v[16:17], -1
  v_mov_b64 v[18:19], -1
  s_add_u32 s51, s34, 69215232
  buffer_store_dwordx4 v[16:19], v1, s[4:7], s51 offen offset:0 sc1
  buffer_store_dwordx4 v[16:19], v1, s[4:7], s51 offen offset:1024 sc1
  buffer_store_dwordx4 v[16:19], v1, s[4:7], s51 offen offset:2048 sc1
  buffer_store_dwordx4 v[16:19], v1, s[4:7], s51 offen offset:3072 sc1
  s_add_u32 s51, s34, 69219328
  buffer_store_dwordx4 v[16:19], v1, s[4:7], s51 offen offset:0 sc1
  buffer_store_dwordx4 v[16:19], v1, s[4:7], s51 offen offset:1024 sc1
  buffer_store_dwordx4 v[16:19], v1, s[4:7], s51 offen offset:2048 sc1
  buffer_store_dwordx4 v[16:19], v1, s[4:7], s51 offen offset:3072 sc1
  s_add_u32 s51, s34, 69223424
  buffer_store_dwordx4 v[16:19], v1, s[4:7], s51 offen offset:0 sc1
  s_add_u32 s51, s34, 69805056
  buffer_store_dwordx4 v[16:19], v1, s[4:7], s51 offen offset:0 sc1
  buffer_store_dwordx4 v[16:19], v1, s[4:7], s51 offen offset:1024 sc1
  buffer_store_dwordx4 v[16:19], v1, s[4:7], s51 offen offset:2048 sc1
  buffer_store_dwordx4 v[16:19], v1, s[4:7], s51 offen offset:3072 sc1
  s_add_u32 s51, s34, 69809152
  buffer_store_dwordx4 v[16:19], v1, s[4:7], s51 offen offset:0 sc1
  buffer_store_dwordx4 v[16:19], v1, s[4:7], s51 offen offset:1024 sc1
  buffer_store_dwordx4 v[16:19], v1, s[4:7], s51 offen offset:2048 sc1
  buffer_store_dwordx4 v[16:19], v1, s[4:7], s51 offen offset:3072 sc1
  s_add_u32 s51, s34, 69813248
  buffer_store_dwordx4 v[16:19], v1, s[4:7], s51 offen offset:0 sc1
  s_add_u32 s51, s35, 4203520
  buffer_store_dwordx4 v[16:19], v1, s[4:7], s51 offen offset:0 sc1
  buffer_store_dwordx4 v[16:19], v1, s[4:7], s51 offen offset:1024 sc1
  buffer_store_dwordx4 v[16:19], v1, s[4:7], s51 offen offset:2048 sc1
  buffer_store_dwordx4 v[16:19], v1, s[4:7], s51 offen offset:3072 sc1
  s_add_u32 s51, s35, 4207616
  buffer_store_dwordx4 v[16:19], v1, s[4:7], s51 offen offset:0 sc1
  buffer_store_dwordx4 v[16:19], v1, s[4:7], s51 offen offset:1024 sc1
  buffer_store_dwordx4 v[16:19], v1, s[4:7], s51 offen offset:2048 sc1
  buffer_store_dwordx4 v[16:19], v1, s[4:7], s51 offen offset:3072 sc1
  s_add_u32 s51, s35, 4211712
  buffer_store_dwordx4 v[16:19], v1, s[4:7], s51 offen offset:0 sc1
  s_add_u32 s51, s35, 7349248
  buffer_store_dwordx4 v[16:19], v1, s[4:7], s51 offen offset:0 sc1
  buffer_store_dwordx4 v[16:19], v1, s[4:7], s51 offen offset:1024 sc1
  buffer_store_dwordx4 v[16:19], v1, s[4:7], s51 offen offset:2048 sc1
  buffer_store_dwordx4 v[16:19], v1, s[4:7], s51 offen offset:3072 sc1
  s_add_u32 s51, s35, 7353344
  buffer_store_dwordx4 v[16:19], v1, s[4:7], s51 offen offset:0 sc1
  buffer_store_dwordx4 v[16:19], v1, s[4:7], s51 offen offset:1024 sc1
  buffer_store_dwordx4 v[16:19], v1, s[4:7], s51 offen offset:2048 sc1
  buffer_store_dwordx4 v[16:19], v1, s[4:7], s51 offen offset:3072 sc1
  s_add_u32 s51, s35, 7357440
  buffer_store_dwordx4 v[16:19], v1, s[4:7], s51 offen offset:0 sc1
  s_cmp_lt_u32 s32, 104
  s_cbranch_scc1 L_nof_18
  s_mul_i32 s34, s43, 36864
  v_mov_b64 v[16:17], -1
  v_mov_b64 v[18:19], -1
  s_add_u32 s51, s34, 73933824
  buffer_store_dwordx4 v[16:19], v1, s[4:7], s51 offen offset:0 sc1
  buffer_store_dwordx4 v[16:19], v1, s[4:7], s51 offen offset:1024 sc1
  buffer_store_dwordx4 v[16:19], v1, s[4:7], s51 offen offset:2048 sc1
  buffer_store_dwordx4 v[16:19], v1, s[4:7], s51 offen offset:3072 sc1
  s_add_u32 s51, s34, 73937920
  buffer_store_dwordx4 v[16:19], v1, s[4:7], s51 offen offset:0 sc1
  buffer_store_dwordx4 v[16:19], v1, s[4:7], s51 offen offset:1024 sc1
  buffer_store_dwordx4 v[16:19], v1, s[4:7], s51 offen offset:2048 sc1
  buffer_store_dwordx4 v[16:19], v1, s[4:7], s51 offen offset:3072 sc1
  s_add_u32 s51, s34, 73942016
  buffer_store_dwordx4 v[16:19], v1, s[4:7], s51 offen offset:0 sc1
L_nof_18:
  s_waitcnt vmcnt(0)
  s_barrier
  s_cmp_lg_u32 s33, 0
  s_cbranch_scc1 L_meet_19
  v_mov_b32 v10, 1
  s_mov_b64 exec, 1
  buffer_atomic_add v10, off, s[8:11], 0 offset:24 sc0
  s_waitcnt vmcnt(0)
  v_readfirstlane_b32 s51, v10
  v_mov_b32 v10, 1
  s_cmp_lg_u32 s51, 63
  s_cbranch_scc1 L_cnt_20
  buffer_store_dword v10, off, s[8:11], 0 offset:144 sc1
L_cnt_20:
  s_mov_b64 exec, -1
L_ai_21:
  buffer_load_dword v10, off, s[8:11], 0 offset:4 sc1
  s_add_u32 s50, s50, 1
  s_cmp_ge_u32 s50, 262144
  s_waitcnt vmcnt(0)
  s_cbranch_scc1 L_ai_21_x
  v_cmp_ge_u32 vcc, 9, v10
  s_nop 0
  s_cbranch_vccnz L_ai_21
L_ai_21_x:
L_ai_22:
  buffer_load_dword v10, off, s[8:11], 0 offset:144 sc1
  s_add_u32 s50, s50, 1
  s_cmp_ge_u32 s50, 262144
  s_waitcnt vmcnt(0)
  s_cbranch_scc1 L_ai_22_x
  v_cmp_ge_u32 vcc, 0, v10
  s_nop 0
  s_cbranch_vccnz L_ai_22
L_ai_22_x:
L_meet_19:
  s_barrier
  s_mov_b32 s34, 152
  s_cmp_eq_u32 s44, 0
  s_cselect_b32 s39, 32, 16
  s_cmp_eq_u32 s44, 1
  s_cselect_b32 s34, 112, s34
  s_cmp_eq_u32 s44, 2
  s_cselect_b32 s34, 116, s34
  buffer_load_dword v10, off, s[8:11], s34 sc1
  s_waitcnt vmcnt(0)
  v_readfirstlane_b32 s34, v10
  s_nop 0
  s_cmp_ge_u32 s34, s39
  s_cselect_b32 s39, 1, 0
  s_cmp_ge_u32 s34, 32
  s_cselect_b32 s38, s39, 0
  s_sub_u32 s34, s44, 1
  s_cmp_lt_u32 s34, 2
  s_cselect_b32 s38, 0, s38
  s_mov_b32 s40, s44
  s_mov_b32 s42, 0
  s_mov_b32 s61, 0
  s_add_u32 s95, s40, 1
  s_cmp_ge_u32 s48, s95
  s_cbranch_scc1 L_ap_23_x
L_ap_23:
  s_load_dwordx4 s[96:99], s[4:5], s92 glc
  s_load_dwordx2 s[100:101], s[4:5], s93 glc
  s_add_u32 s50, s50, 1
  s_cmp_ge_u32 s50, 262144
  s_cbranch_scc1 L_ap_23_y
  s_waitcnt lgkmcnt(0)
  s_min_u32 s48, s96, s97
  s_min_u32 s48, s48, s98
  s_min_u32 s48, s48, s99
  s_min_u32 s48, s48, s100
  s_min_u32 s48, s48, s101
  s_cmp_lt_u32 s48, s95
  s_cbranch_scc1 L_ap_23
L_ap_23_y:
  s_waitcnt lgkmcnt(0)
L_ap_23_x:
  s_lshl_b32 s34, s40, 5
  s_lshl1_add_u32 s34, s43, s34
  s_add_u32 s34, s34, 0
  s_lshl_b32 s34, s34, 13
  s_add_u32 s51, s34, 18878464
  buffer_load_dwordx4 v[16:19], v1, s[4:7], s51 offen offset:0 sc1
  buffer_load_dwordx4 v[20:23], v1, s[4:7], s51 offen offset:1024 sc1
  buffer_load_dwordx4 v[24:27], v1, s[4:7], s51 offen offset:2048 sc1
  buffer_load_dwordx4 v[28:31], v1, s[4:7], s51 offen offset:3072 sc1
  s_add_u32 s51, s34, 35651584
  buffer_load_dwordx4 v[32:35], v1, s[4:7], s51 offen offset:0 sc1
  buffer_load_dwordx4 v[36:39], v1, s[4:7], s51 offen offset:1024 sc1
  buffer_load_dwordx4 v[40:43], v1, s[4:7], s51 offen offset:2048 sc1
  buffer_load_dwordx4 v[44:47], v1, s[4:7], s51 offen offset:3072 sc1
  s_add_u32 s51, s34, 35655680
  buffer_load_dwordx4 v[48:51], v1, s[4:7], s51 offen offset:0 sc1
  buffer_load_dwordx4 v[52:55], v1, s[4:7], s51 offen offset:1024 sc1
  buffer_load_dwordx4 v[56:59], v1, s[4:7], s51 offen offset:2048 sc1
  buffer_load_dwordx4 v[60:63], v1, s[4:7], s51 offen offset:3072 sc1
  s_add_u32 s51, s34, 52428800
  buffer_load_dwordx4 v[64:67], v1, s[4:7], s51 offen offset:0 sc1
  buffer_load_dwordx4 v[68:71], v1, s[4:7], s51 offen offset:1024 sc1
  buffer_load_dwordx4 v[72:75], v1, s[4:7], s51 offen offset:2048 sc1
  buffer_load_dwordx4 v[76:79], v1, s[4:7], s51 offen offset:3072 sc1
  s_add_u32 s51, s34, 52432896
  buffer_load_dwordx4 v[80:83], v1, s[4:7], s51 offen offset:0 sc1
  buffer_load_dwordx4 v[84:87], v1, s[4:7], s51 offen offset:1024 sc1
  buffer_load_dwordx4 v[88:91], v1, s[4:7], s51 offen offset:2048 sc1
  buffer_load_dwordx4 v[92:95], v1, s[4:7], s51 offen offset:3072 sc1
.p2align 5
L_att_l1:
  s_lshl_b32 s41, s40, 5
  s_lshl1_add_u32 s41, s43, s41
  s_add_u32 s41, s41, 0
  s_lshl_b32 s41, s41, 11
  s_bfe_u32 s60, s61, 0x10001
  s_and_b32 s34, s61, 1
  s_add_u32 s61, s61, 1
  s_lshl1_add_u32 s34, s44, s34
  s_mul_i32 s45, s34, 589824
  s_add_u32 s45, s45, 69206016
  v_mov_b32 v140, 0x3f803f80
  v_mov_b32 v141, 0x3f803f80
  v_mov_b64 v[142:143], v[140:141]
  v_mov_b64 v[136:137], 0
  v_mov_b64 v[138:139], 0
  s_waitcnt vmcnt(0)
  v_mfma_f32_16x16x32_bf16 v[124:127], v[32:35], v[16:19], 0
  v_mfma_f32_16x16x32_bf16 v[128:131], v[48:51], v[16:19], 0
  v_mfma_f32_16x16x32_bf16 v[124:127], v[36:39], v[20:23], v[124:127]
  v_mfma_f32_16x16x32_bf16 v[128:131], v[52:55], v[20:23], v[128:131]
  v_mfma_f32_16x16x32_bf16 v[124:127], v[40:43], v[24:27], v[124:127]
  v_mfma_f32_16x16x32_bf16 v[128:131], v[56:59], v[24:27], v[128:131]
  v_mfma_f32_16x16x32_bf16 v[124:127], v[44:47], v[28:31], v[124:127]
  v_mfma_f32_16x16x32_bf16 v[128:131], v[60:63], v[28:31], v[128:131]
  v_mov_b32 v10, 0xff800000
  s_nop 6
  v_cndmask_b32 v128, v10, v128, s[52:53]
  v_cndmask_b32 v129, v10, v129, s[54:55]
  v_cndmask_b32 v130, v10, v130, s[56:57]
  v_cndmask_b32 v131, v10, v131, s[58:59]
  v_max3_f32 v12, v124, v125, v126
  v_max3_f32 v12, v12, v127, v128
  v_max3_f32 v12, v12, v129, v130
  v_max_f32 v12, v12, v131
  s_cmp_lt_u32 s40, 63
  s_cbranch_scc1 L_att_l1_ncp
  s_getpc_b64 s[96:97]
L_att_l1_pc:
  s_add_u32 s96, s96, L_att_l1_w0-L_att_l1_pc
  s_addc_u32 s97, s97, 0
  v_lshlrev_b32 v148, 2, v1
  v_mov_b32_e64 v149, s97
  v_add_co_u32 v148, vcc, s96, v148
  s_nop 1
  v_addc_co_u32 v149, vcc, 0, v149, vcc
  global_load_dword v150, v[148:149], off
L_att_l1_ncp:
  s_cmp_lt_u32 s40, 56
  s_addc_u32 s95, s40, 0
  s_cmp_eq_u32 s40, 63
  s_cselect_b32 s95, 62, s95
  s_cmp_ge_u32 s49, s95
  s_cbranch_scc1 L_ac_24_x
L_ac_24:
  s_load_dword s96, s[4:5], s94 glc
  s_add_u32 s50, s50, 1
  s_cmp_ge_u32 s50, 262144
  s_cbranch_scc1 L_ac_24_y
  s_waitcnt lgkmcnt(0)
  s_mov_b32 s49, s96
  s_cmp_lt_u32 s49, s95
  s_cbranch_scc1 L_ac_24
L_ac_24_y:
  s_waitcnt lgkmcnt(0)
L_ac_24_x:
L_att_k1:
  s_add_u32 s51, s41, 10485760
  buffer_load_dwordx4 v[96:99], v2, s[4:7], s51 offen offset:0 sc1
  buffer_load_dwordx4 v[100:103], v2, s[4:7], s51 offen offset:512 sc1
  buffer_load_dwordx4 v[104:107], v2, s[4:7], s51 offen offset:1024 sc1
  buffer_load_dwordx4 v[108:111], v2, s[4:7], s51 offen offset:1536 sc1
  s_add_u32 s51, s41, 14680064
  buffer_load_dwordx2 v[112:113], v3, s[4:7], s51 offen offset:0 sc1
  buffer_load_dwordx2 v[114:115], v3, s[4:7], s51 offen offset:512 sc1
  buffer_load_dwordx2 v[116:117], v3, s[4:7], s51 offen offset:1024 sc1
  buffer_load_dwordx2 v[118:119], v3, s[4:7], s51 offen offset:1536 sc1
  s_waitcnt vmcnt(7)
  v_mfma_f32_16x16x32_bf16 v[120:123], v[96:99], v[16:19], 0
  s_waitcnt vmcnt(6)
  v_mfma_f32_16x16x32_bf16 v[120:123], v[100:103], v[20:23], v[120:123]
  s_waitcnt vmcnt(5)
  v_mfma_f32_16x16x32_bf16 v[120:123], v[104:107], v[24:27], v[120:123]
  s_waitcnt vmcnt(4)
  v_mfma_f32_16x16x32_bf16 v[120:123], v[108:111], v[28:31], v[120:123]
  v_max3_u32 v10, v96, v100, v104
  s_waitcnt vmcnt(0)
  v_max3_u32 v10, v10, v108, v112
  v_max3_u32 v10, v10, v114, v116
  v_max_u32_e64 v10, v10, v118
  v_cmp_eq_u32_e64 vcc, -1, v10
  s_nop 0
  s_cbranch_vccz L_att_k1_x
  s_add_u32 s50, s50, 1
  s_cmp_ge_u32 s50, 262144
  s_cbranch_scc1 L_att_k1_x
  s_branch L_att_k1
L_att_k1_x:
  v_max3_f32 v12, v12, v120, v121
  v_mov_b32 v13, v12
  s_nop 1
  v_permlane32_swap_b32 v12, v13
  v_max_f32 v12, v12, v13
  v_mov_b32 v13, v12
  s_nop 1
  v_permlane16_swap_b32 v12, v13
  v_max_f32 v12, v12, v13
  v_mul_f32_e64 v12, s47, v12
  v_fma_f32 v120, v120, s46, v12
  v_fma_f32 v121, v121, s46, v12
  v_fma_f32 v124, v124, s46, v12
  v_fma_f32 v125, v125, s46, v12
  v_fma_f32 v126, v126, s46, v12
  v_fma_f32 v127, v127, s46, v12
  v_fma_f32 v128, v128, s46, v12
  v_fma_f32 v129, v129, s46, v12
  v_fma_f32 v130, v130, s46, v12
  v_fma_f32 v131, v131, s46, v12
  v_exp_f32 v120, v120
  v_exp_f32 v121, v121
  v_exp_f32 v124, v124
  v_exp_f32 v125, v125
  v_exp_f32 v126, v126
  v_exp_f32 v127, v127
  v_exp_f32_e64 v128, v128
  v_exp_f32 v129, v129
  v_exp_f32 v130, v130
  v_exp_f32_e64 v131, v131
  v_cvt_pk_bf16_f32 v132, v124, v125
  v_cvt_pk_bf16_f32 v133, v126, v127
  v_cvt_pk_bf16_f32 v134, v128, v129
  v_cvt_pk_bf16_f32 v135, v130, v131
  v_cvt_pk_bf16_f32 v136, v120, v121
  v_cvt_pk_bf16_f32 v139, v120, v121
  v_mfma_f32_16x16x32_bf16 v[144:147], v[140:143], v[132:135], 0
  v_mfma_f32_16x16x32_bf16 v[148:151], v[64:67], v[132:135], 0
  v_mfma_f32_16x16x32_bf16 v[152:155], v[68:71], v[132:135], 0
  v_mfma_f32_16x16x32_bf16 v[156:159], v[72:75], v[132:135], 0
  v_mfma_f32_16x16x32_bf16 v[160:163], v[76:79], v[132:135], 0
  v_mfma_f32_16x16x16_bf16 v[144:147], v[140:141], v[136:137], v[144:147]
  v_mfma_f32_16x16x32_bf16 v[164:167], v[80:83], v[132:135], 0
  v_mfma_f32_16x16x32_bf16 v[168:171], v[84:87], v[132:135], 0
  v_mfma_f32_16x16x32_bf16 v[172:175], v[88:91], v[132:135], 0
  v_mfma_f32_16x16x32_bf16 v[176:179], v[92:95], v[132:135], 0
  v_add_u32 v11, s42, v1
  v_mfma_f32_16x16x16_bf16 v[148:151], v[112:113], v[136:137], v[148:151]
  v_rcp_f32 v12, v144
  v_mfma_f32_16x16x16_bf16 v[152:155], v[112:113], v[138:139], v[152:155]
  v_mfma_f32_16x16x16_bf16 v[156:159], v[114:115], v[136:137], v[156:159]
  v_mfma_f32_16x16x16_bf16 v[160:163], v[114:115], v[138:139], v[160:163]
  v_mfma_f32_16x16x16_bf16 v[164:167], v[116:117], v[136:137], v[164:167]
  v_mfma_f32_16x16x16_bf16 v[168:171], v[116:117], v[138:139], v[168:171]
  v_mfma_f32_16x16x16_bf16 v[172:175], v[118:119], v[136:137], v[172:175]
  v_mfma_f32_16x16x16_bf16 v[176:179], v[118:119], v[138:139], v[176:179]
  v_pk_mul_f32 v[148:149], v[148:149], v[12:13] op_sel_hi:[1,0]
  v_pk_mul_f32 v[150:151], v[150:151], v[12:13] op_sel_hi:[1,0]
  v_pk_mul_f32 v[152:153], v[152:153], v[12:13] op_sel_hi:[1,0]
  v_pk_mul_f32 v[154:155], v[154:155], v[12:13] op_sel_hi:[1,0]
  v_cvt_pk_bf16_f32 v148, v148, v149
  v_cvt_pk_bf16_f32 v149, v150, v151
  v_cvt_pk_bf16_f32 v150, v152, v153
  v_cvt_pk_bf16_f32 v151, v154, v155
  ds_write_b128 v11, v[148:151] offset:4096
  v_pk_mul_f32 v[156:157], v[156:157], v[12:13] op_sel_hi:[1,0]
  v_pk_mul_f32 v[158:159], v[158:159], v[12:13] op_sel_hi:[1,0]
  v_pk_mul_f32 v[160:161], v[160:161], v[12:13] op_sel_hi:[1,0]
  v_pk_mul_f32 v[162:163], v[162:163], v[12:13] op_sel_hi:[1,0]
  v_cvt_pk_bf16_f32 v156, v156, v157
  v_cvt_pk_bf16_f32 v157, v158, v159
  v_cvt_pk_bf16_f32 v158, v160, v161
  v_cvt_pk_bf16_f32 v159, v162, v163
  ds_write_b128 v11, v[156:159] offset:5120
  v_pk_mul_f32 v[164:165], v[164:165], v[12:13] op_sel_hi:[1,0]
  v_pk_mul_f32 v[166:167], v[166:167], v[12:13] op_sel_hi:[1,0]
  v_pk_mul_f32 v[168:169], v[168:169], v[12:13] op_sel_hi:[1,0]
  v_pk_mul_f32 v[170:171], v[170:171], v[12:13] op_sel_hi:[1,0]
  v_cvt_pk_bf16_f32 v164, v164, v165
  v_cvt_pk_bf16_f32 v165, v166, v167
  v_cvt_pk_bf16_f32 v166, v168, v169
  v_cvt_pk_bf16_f32 v167, v170, v171
  ds_write_b128 v11, v[164:167] offset:6144
  v_pk_mul_f32 v[172:173], v[172:173], v[12:13] op_sel_hi:[1,0]
  v_pk_mul_f32 v[174:175], v[174:175], v[12:13] op_sel_hi:[1,0]
  v_pk_mul_f32 v[176:177], v[176:177], v[12:13] op_sel_hi:[1,0]
  v_pk_mul_f32 v[178:179], v[178:179], v[12:13] op_sel_hi:[1,0]
  v_cvt_pk_bf16_f32 v172, v172, v173
  v_cvt_pk_bf16_f32 v173, v174, v175
  v_cvt_pk_bf16_f32 v174, v176, v177
  v_cvt_pk_bf16_f32 v175, v178, v179
  ds_write_b128 v11, v[172:175] offset:7168
  s_waitcnt lgkmcnt(0)
  s_barrier
  s_cmp_eq_u32 s39, 0
  s_cbranch_scc1 L_att_l1_ws
  s_cmp_eq_u32 s40, 63
  s_cselect_b32 s34, s38, 0
  s_cmp_eq_u32 s34, 0
  s_cbranch_scc1 L_att_l1_wf
L_att_l1_w0:
  s_cmp_eq_u32 s44, 0
  s_cbranch_scc1 L_att_l1_wh
  ds_read_b128 v[148:151], v11 offset:0
  ds_read_b128 v[156:159], v11 offset:1024
  ds_read_b128 v[164:167], v11 offset:2048
  ds_read_b128 v[172:175], v11 offset:3072
  ds_read_b128 v[180:183], v11 offset:8192
  ds_read_b128 v[188:191], v11 offset:9216
  ds_read_b128 v[196:199], v11 offset:10240
  ds_read_b128 v[204:207], v11 offset:11264
  s_xor_b32 s42, s42, 0x4000
  s_add_u32 s51, s45, 294912
  s_waitcnt lgkmcnt(7)
  v_mfma_f32_16x16x32_bf16 v[96:99], v[224:227], v[148:151], 0
  v_mfma_f32_16x16x32_bf16 v[100:103], a[0:3], v[148:151], 0
  s_waitcnt lgkmcnt(6)
  v_mfma_f32_16x16x32_bf16 v[96:99], v[228:231], v[156:159], v[96:99]
  v_mfma_f32_16x16x32_bf16 v[100:103], a[4:7], v[156:159], v[100:103]
  s_waitcnt lgkmcnt(5)
  v_mfma_f32_16x16x32_bf16 v[96:99], v[232:235], v[164:167], v[96:99]
  v_mfma_f32_16x16x32_bf16 v[100:103], a[8:11], v[164:167], v[100:103]
  s_waitcnt lgkmcnt(4)
  v_mfma_f32_16x16x32_bf16 v[96:99], v[236:239], v[172:175], v[96:99]
  v_mfma_f32_16x16x32_bf16 v[100:103], a[12:15], v[172:175], v[100:103]
  s_waitcnt lgkmcnt(3)
  v_mfma_f32_16x16x32_bf16 v[96:99], v[240:243], v[180:183], v[96:99]
  v_mfma_f32_16x16x32_bf16 v[100:103], a[16:19], v[180:183], v[100:103]
  s_waitcnt lgkmcnt(2)
  v_mfma_f32_16x16x32_bf16 v[96:99], v[244:247], v[188:191], v[96:99]
  v_mfma_f32_16x16x32_bf16 v[100:103], a[20:23], v[188:191], v[100:103]
  s_waitcnt lgkmcnt(1)
  v_mfma_f32_16x16x32_bf16 v[96:99], v[248:251], v[196:199], v[96:99]
  v_mfma_f32_16x16x32_bf16 v[100:103], a[24:27], v[196:199], v[100:103]
  s_waitcnt lgkmcnt(0)
  v_mfma_f32_16x16x32_bf16 v[96:99], v[252:255], v[204:207], v[96:99]
  v_mfma_f32_16x16x32_bf16 v[100:103], a[28:31], v[204:207], v[100:103]
  v_mfma_f32_16x16x32_bf16 v[112:115], a[32:35], v[148:151], 0
  v_mfma_f32_16x16x32_bf16 v[116:119], a[64:67], v[148:151], 0
  v_mfma_f32_16x16x32_bf16 v[112:115], a[36:39], v[156:159], v[112:115]
  v_cvt_pk_bf16_f32 v96, v96, v97
  v_cvt_pk_bf16_f32 v97, v98, v99
  v_mfma_f32_16x16x32_bf16 v[116:119], a[68:71], v[156:159], v[116:119]
  v_cvt_pk_bf16_f32 v98, v100, v101
  v_cvt_pk_bf16_f32 v99, v102, v103
  v_mfma_f32_16x16x32_bf16 v[112:115], a[40:43], v[164:167], v[112:115]
  v_bfi_b32 v96, 1, s60, v96
  v_bfi_b32 v98, 1, s60, v98
  buffer_store_dwordx4 v[96:99], v4, s[4:7], s45 offen offset:128
  v_mfma_f32_16x16x32_bf16 v[116:119], a[72:75], v[164:167], v[116:119]
  v_mfma_f32_16x16x32_bf16 v[112:115], a[44:47], v[172:175], v[112:115]
  v_mfma_f32_16x16x32_bf16 v[116:119], a[76:79], v[172:175], v[116:119]
  v_mfma_f32_16x16x32_bf16 v[112:115], a[48:51], v[180:183], v[112:115]
  v_mfma_f32_16x16x32_bf16 v[116:119], a[80:83], v[180:183], v[116:119]
  v_mfma_f32_16x16x32_bf16 v[112:115], a[52:55], v[188:191], v[112:115]
  v_mfma_f32_16x16x32_bf16 v[116:119], a[84:87], v[188:191], v[116:119]
  v_mfma_f32_16x16x32_bf16 v[112:115], a[56:59], v[196:199], v[112:115]
  v_mfma_f32_16x16x32_bf16 v[116:119], a[88:91], v[196:199], v[116:119]
  v_mfma_f32_16x16x32_bf16 v[112:115], a[60:63], v[204:207], v[112:115]
  v_mfma_f32_16x16x32_bf16 v[116:119], a[92:95], v[204:207], v[116:119]
  v_mfma_f32_16x16x32_bf16 v[96:99], a[96:99], v[148:151], 0
  v_mfma_f32_16x16x32_bf16 v[100:103], a[128:131], v[148:151], 0
  v_mfma_f32_16x16x32_bf16 v[96:99], a[100:103], v[156:159], v[96:99]
  v_cvt_pk_bf16_f32 v112, v112, v113
  v_cvt_pk_bf16_f32 v113, v114, v115
  v_mfma_f32_16x16x32_bf16 v[100:103], a[132:135], v[156:159], v[100:103]
  v_cvt_pk_bf16_f32 v114, v116, v117
  v_cvt_pk_bf16_f32 v115, v118, v119
  v_mfma_f32_16x16x32_bf16 v[96:99], a[104:107], v[164:167], v[96:99]
  v_bfi_b32 v112, 1, s60, v112
  v_bfi_b32 v114, 1, s60, v114
  buffer_store_dwordx4 v[112:115], v4, s[4:7], s45 offen offset:640
  v_mfma_f32_16x16x32_bf16 v[100:103], a[136:139], v[164:167], v[100:103]
  v_mfma_f32_16x16x32_bf16 v[96:99], a[108:111], v[172:175], v[96:99]
  v_mfma_f32_16x16x32_bf16 v[100:103], a[140:143], v[172:175], v[100:103]
  v_mfma_f32_16x16x32_bf16 v[96:99], a[112:115], v[180:183], v[96:99]
  v_mfma_f32_16x16x32_bf16 v[100:103], a[144:147], v[180:183], v[100:103]
  v_mfma_f32_16x16x32_bf16 v[96:99], a[116:119], v[188:191], v[96:99]
  v_mfma_f32_16x16x32_bf16 v[100:103], a[148:151], v[188:191], v[100:103]
  v_mfma_f32_16x16x32_bf16 v[96:99], a[120:123], v[196:199], v[96:99]
  v_mfma_f32_16x16x32_bf16 v[100:103], a[152:155], v[196:199], v[100:103]
  v_mfma_f32_16x16x32_bf16 v[96:99], a[124:127], v[204:207], v[96:99]
  v_mfma_f32_16x16x32_bf16 v[100:103], a[156:159], v[204:207], v[100:103]
  v_mfma_f32_16x16x32_bf16 v[112:115], a[160:163], v[148:151], 0
  v_mfma_f32_16x16x32_bf16 v[116:119], a[192:195], v[148:151], 0
  v_mfma_f32_16x16x32_bf16 v[112:115], a[164:167], v[156:159], v[112:115]
  v_cvt_pk_bf16_f32 v96, v96, v97
  v_cvt_pk_bf16_f32 v97, v98, v99
  v_mfma_f32_16x16x32_bf16 v[116:119], a[196:199], v[156:159], v[116:119]
  v_cvt_pk_bf16_f32 v98, v100, v101
  v_cvt_pk_bf16_f32 v99, v102, v103
  v_mfma_f32_16x16x32_bf16 v[112:115], a[168:171], v[164:167], v[112:115]
  v_bfi_b32 v96, 1, s60, v96
  v_bfi_b32 v98, 1, s60, v98
  buffer_store_dwordx4 v[96:99], v4, s[4:7], s45 offen offset:1152
  v_mfma_f32_16x16x32_bf16 v[116:119], a[200:203], v[164:167], v[116:119]
  v_mfma_f32_16x16x32_bf16 v[112:115], a[172:175], v[172:175], v[112:115]
  v_mfma_f32_16x16x32_bf16 v[116:119], a[204:207], v[172:175], v[116:119]
  v_mfma_f32_16x16x32_bf16 v[112:115], a[176:179], v[180:183], v[112:115]
  v_mfma_f32_16x16x32_bf16 v[116:119], a[208:211], v[180:183], v[116:119]
  v_mfma_f32_16x16x32_bf16 v[112:115], a[180:183], v[188:191], v[112:115]
  v_mfma_f32_16x16x32_bf16 v[116:119], a[212:215], v[188:191], v[116:119]
  v_mfma_f32_16x16x32_bf16 v[112:115], a[184:187], v[196:199], v[112:115]
  v_mfma_f32_16x16x32_bf16 v[116:119], a[216:219], v[196:199], v[116:119]
  v_mfma_f32_16x16x32_bf16 v[112:115], a[188:191], v[204:207], v[112:115]
  v_mfma_f32_16x16x32_bf16 v[116:119], a[220:223], v[204:207], v[116:119]
  v_mfma_f32_16x16x32_bf16 v[96:99], a[224:227], v[148:151], 0
  v_mfma_f32_16x16x32_bf16 v[96:99], a[228:231], v[156:159], v[96:99]
  v_mfma_f32_16x16x32_bf16 v[96:99], a[232:235], v[164:167], v[96:99]
  v_cvt_pk_bf16_f32 v112, v112, v113
  v_cvt_pk_bf16_f32 v113, v114, v115
  v_mfma_f32_16x16x32_bf16 v[96:99], a[236:239], v[172:175], v[96:99]
  v_cvt_pk_bf16_f32 v114, v116, v117
  v_cvt_pk_bf16_f32 v115, v118, v119
  v_mfma_f32_16x16x32_bf16 v[96:99], a[240:243], v[180:183], v[96:99]
  v_bfi_b32 v112, 1, s60, v112
  v_bfi_b32 v114, 1, s60, v114
  buffer_store_dwordx4 v[112:115], v4, s[4:7], s45 offen offset:1664
  v_mfma_f32_16x16x32_bf16 v[96:99], a[244:247], v[188:191], v[96:99]
  v_mfma_f32_16x16x32_bf16 v[96:99], a[248:251], v[196:199], v[96:99]
  v_mfma_f32_16x16x32_bf16 v[96:99], a[252:255], v[204:207], v[96:99]
  s_nop 7
  v_cvt_pk_bf16_f32 v96, v96, v97
  v_cvt_pk_bf16_f32 v97, v98, v99
  v_bfi_b32 v96, 1, s60, v96
  buffer_store_dwordx2 v[96:97], v4, s[4:7], s45 offen offset:2056
  s_branch L_att_l1_wx
L_att_l1_wh:
  s_mov_b32 s45, 73924608
  s_mov_b32 s60, 0
  ds_read_b128 v[152:155], v11 offset:4096
  ds_read_b128 v[160:163], v11 offset:5120
  ds_read_b128 v[168:171], v11 offset:6144
  ds_read_b128 v[176:179], v11 offset:7168
  ds_read_b128 v[184:187], v11 offset:12288
  ds_read_b128 v[192:195], v11 offset:13312
  ds_read_b128 v[200:203], v11 offset:14336
  ds_read_b128 v[208:211], v11 offset:15360
  s_xor_b32 s42, s42, 0x4000
  s_add_u32 s51, s45, 294912
  s_waitcnt lgkmcnt(7)
  v_mfma_f32_16x16x32_bf16 v[104:107], v[224:227], v[152:155], 0
  v_mfma_f32_16x16x32_bf16 v[108:111], a[0:3], v[152:155], 0
  s_waitcnt lgkmcnt(6)
  v_mfma_f32_16x16x32_bf16 v[104:107], v[228:231], v[160:163], v[104:107]
  v_mfma_f32_16x16x32_bf16 v[108:111], a[4:7], v[160:163], v[108:111]
  s_waitcnt lgkmcnt(5)
  v_mfma_f32_16x16x32_bf16 v[104:107], v[232:235], v[168:171], v[104:107]
  v_mfma_f32_16x16x32_bf16 v[108:111], a[8:11], v[168:171], v[108:111]
  s_waitcnt lgkmcnt(4)
  v_mfma_f32_16x16x32_bf16 v[104:107], v[236:239], v[176:179], v[104:107]
  v_mfma_f32_16x16x32_bf16 v[108:111], a[12:15], v[176:179], v[108:111]
  s_waitcnt lgkmcnt(3)
  v_mfma_f32_16x16x32_bf16 v[104:107], v[240:243], v[184:187], v[104:107]
  v_mfma_f32_16x16x32_bf16 v[108:111], a[16:19], v[184:187], v[108:111]
  s_waitcnt lgkmcnt(2)
  v_mfma_f32_16x16x32_bf16 v[104:107], v[244:247], v[192:195], v[104:107]
  v_mfma_f32_16x16x32_bf16 v[108:111], a[20:23], v[192:195], v[108:111]
  s_waitcnt lgkmcnt(1)
  v_mfma_f32_16x16x32_bf16 v[104:107], v[248:251], v[200:203], v[104:107]
  v_mfma_f32_16x16x32_bf16 v[108:111], a[24:27], v[200:203], v[108:111]
  s_waitcnt lgkmcnt(0)
  v_mfma_f32_16x16x32_bf16 v[104:107], v[252:255], v[208:211], v[104:107]
  v_mfma_f32_16x16x32_bf16 v[108:111], a[28:31], v[208:211], v[108:111]
  v_mfma_f32_16x16x32_bf16 v[120:123], a[32:35], v[152:155], 0
  v_mfma_f32_16x16x32_bf16 v[124:127], a[64:67], v[152:155], 0
  v_mfma_f32_16x16x32_bf16 v[120:123], a[36:39], v[160:163], v[120:123]
  v_cvt_pk_bf16_f32 v104, v104, v105
  v_cvt_pk_bf16_f32 v105, v106, v107
  v_mfma_f32_16x16x32_bf16 v[124:127], a[68:71], v[160:163], v[124:127]
  v_cvt_pk_bf16_f32 v106, v108, v109
  v_cvt_pk_bf16_f32 v107, v110, v111
  v_mfma_f32_16x16x32_bf16 v[120:123], a[40:43], v[168:171], v[120:123]
  v_bfi_b32 v104, 1, s60, v104
  v_bfi_b32 v106, 1, s60, v106
  buffer_store_dwordx4 v[104:107], v4, s[4:7], s51 offen offset:128
  v_mfma_f32_16x16x32_bf16 v[124:127], a[72:75], v[168:171], v[124:127]
  v_mfma_f32_16x16x32_bf16 v[120:123], a[44:47], v[176:179], v[120:123]
  v_mfma_f32_16x16x32_bf16 v[124:127], a[76:79], v[176:179], v[124:127]
  v_mfma_f32_16x16x32_bf16 v[120:123], a[48:51], v[184:187], v[120:123]
  v_mfma_f32_16x16x32_bf16 v[124:127], a[80:83], v[184:187], v[124:127]
  v_mfma_f32_16x16x32_bf16 v[120:123], a[52:55], v[192:195], v[120:123]
  v_mfma_f32_16x16x32_bf16 v[124:127], a[84:87], v[192:195], v[124:127]
  v_mfma_f32_16x16x32_bf16 v[120:123], a[56:59], v[200:203], v[120:123]
  v_mfma_f32_16x16x32_bf16 v[124:127], a[88:91], v[200:203], v[124:127]
  v_mfma_f32_16x16x32_bf16 v[120:123], a[60:63], v[208:211], v[120:123]
  v_mfma_f32_16x16x32_bf16 v[124:127], a[92:95], v[208:211], v[124:127]
  v_mfma_f32_16x16x32_bf16 v[104:107], a[96:99], v[152:155], 0
  v_mfma_f32_16x16x32_bf16 v[108:111], a[128:131], v[152:155], 0
  v_mfma_f32_16x16x32_bf16 v[104:107], a[100:103], v[160:163], v[104:107]
  v_cvt_pk_bf16_f32 v120, v120, v121
  v_cvt_pk_bf16_f32 v121, v122, v123
  v_mfma_f32_16x16x32_bf16 v[108:111], a[132:135], v[160:163], v[108:111]
  v_cvt_pk_bf16_f32 v122, v124, v125
  v_cvt_pk_bf16_f32 v123, v126, v127
  v_mfma_f32_16x16x32_bf16 v[104:107], a[104:107], v[168:171], v[104:107]
  v_bfi_b32 v120, 1, s60, v120
  v_bfi_b32 v122, 1, s60, v122
  buffer_store_dwordx4 v[120:123], v4, s[4:7], s51 offen offset:640
  v_mfma_f32_16x16x32_bf16 v[108:111], a[136:139], v[168:171], v[108:111]
  v_mfma_f32_16x16x32_bf16 v[104:107], a[108:111], v[176:179], v[104:107]
  v_mfma_f32_16x16x32_bf16 v[108:111], a[140:143], v[176:179], v[108:111]
  v_mfma_f32_16x16x32_bf16 v[104:107], a[112:115], v[184:187], v[104:107]
  v_mfma_f32_16x16x32_bf16 v[108:111], a[144:147], v[184:187], v[108:111]
  v_mfma_f32_16x16x32_bf16 v[104:107], a[116:119], v[192:195], v[104:107]
  v_mfma_f32_16x16x32_bf16 v[108:111], a[148:151], v[192:195], v[108:111]
  v_mfma_f32_16x16x32_bf16 v[104:107], a[120:123], v[200:203], v[104:107]
  v_mfma_f32_16x16x32_bf16 v[108:111], a[152:155], v[200:203], v[108:111]
  v_mfma_f32_16x16x32_bf16 v[104:107], a[124:127], v[208:211], v[104:107]
  v_mfma_f32_16x16x32_bf16 v[108:111], a[156:159], v[208:211], v[108:111]
  v_mfma_f32_16x16x32_bf16 v[120:123], a[160:163], v[152:155], 0
  v_mfma_f32_16x16x32_bf16 v[124:127], a[192:195], v[152:155], 0
  v_mfma_f32_16x16x32_bf16 v[120:123], a[164:167], v[160:163], v[120:123]
  v_cvt_pk_bf16_f32 v104, v104, v105
  v_cvt_pk_bf16_f32 v105, v106, v107
  v_mfma_f32_16x16x32_bf16 v[124:127], a[196:199], v[160:163], v[124:127]
  v_cvt_pk_bf16_f32 v106, v108, v109
  v_cvt_pk_bf16_f32 v107, v110, v111
  v_mfma_f32_16x16x32_bf16 v[120:123], a[168:171], v[168:171], v[120:123]
  v_bfi_b32 v104, 1, s60, v104
  v_bfi_b32 v106, 1, s60, v106
  buffer_store_dwordx4 v[104:107], v4, s[4:7], s51 offen offset:1152
  v_mfma_f32_16x16x32_bf16 v[124:127], a[200:203], v[168:171], v[124:127]
  v_mfma_f32_16x16x32_bf16 v[120:123], a[172:175], v[176:179], v[120:123]
  v_mfma_f32_16x16x32_bf16 v[124:127], a[204:207], v[176:179], v[124:127]
  v_mfma_f32_16x16x32_bf16 v[120:123], a[176:179], v[184:187], v[120:123]
  v_mfma_f32_16x16x32_bf16 v[124:127], a[208:211], v[184:187], v[124:127]
  v_mfma_f32_16x16x32_bf16 v[120:123], a[180:183], v[192:195], v[120:123]
  v_mfma_f32_16x16x32_bf16 v[124:127], a[212:215], v[192:195], v[124:127]
  v_mfma_f32_16x16x32_bf16 v[120:123], a[184:187], v[200:203], v[120:123]
  v_mfma_f32_16x16x32_bf16 v[124:127], a[216:219], v[200:203], v[124:127]
  v_mfma_f32_16x16x32_bf16 v[120:123], a[188:191], v[208:211], v[120:123]
  v_mfma_f32_16x16x32_bf16 v[124:127], a[220:223], v[208:211], v[124:127]
  v_mfma_f32_16x16x32_bf16 v[104:107], a[224:227], v[152:155], 0
  v_mfma_f32_16x16x32_bf16 v[104:107], a[228:231], v[160:163], v[104:107]
  v_mfma_f32_16x16x32_bf16 v[104:107], a[232:235], v[168:171], v[104:107]
  v_cvt_pk_bf16_f32 v120, v120, v121
  v_cvt_pk_bf16_f32 v121, v122, v123
  v_mfma_f32_16x16x32_bf16 v[104:107], a[236:239], v[176:179], v[104:107]
  v_cvt_pk_bf16_f32 v122, v124, v125
  v_cvt_pk_bf16_f32 v123, v126, v127
  v_mfma_f32_16x16x32_bf16 v[104:107], a[240:243], v[184:187], v[104:107]
  v_bfi_b32 v120, 1, s60, v120
  v_bfi_b32 v122, 1, s60, v122
  buffer_store_dwordx4 v[120:123], v4, s[4:7], s51 offen offset:1664
  v_mfma_f32_16x16x32_bf16 v[104:107], a[244:247], v[192:195], v[104:107]
  v_mfma_f32_16x16x32_bf16 v[104:107], a[248:251], v[200:203], v[104:107]
  v_mfma_f32_16x16x32_bf16 v[104:107], a[252:255], v[208:211], v[104:107]
  s_nop 7
  v_cvt_pk_bf16_f32 v104, v104, v105
  v_cvt_pk_bf16_f32 v105, v106, v107
  v_bfi_b32 v104, 1, s60, v104
  buffer_store_dwordx2 v[104:105], v4, s[4:7], s51 offen offset:2056
  s_branch L_att_l1_end
L_att_l1_wf:
  ds_read_b128 v[148:151], v11 offset:0
  ds_read_b128 v[152:155], v11 offset:4096
  ds_read_b128 v[156:159], v11 offset:1024
  ds_read_b128 v[160:163], v11 offset:5120
  ds_read_b128 v[164:167], v11 offset:2048
  ds_read_b128 v[168:171], v11 offset:6144
  ds_read_b128 v[172:175], v11 offset:3072
  ds_read_b128 v[176:179], v11 offset:7168
  ds_read_b128 v[180:183], v11 offset:8192
  ds_read_b128 v[184:187], v11 offset:12288
  ds_read_b128 v[188:191], v11 offset:9216
  ds_read_b128 v[192:195], v11 offset:13312
  ds_read_b128 v[196:199], v11 offset:10240
  ds_read_b128 v[200:203], v11 offset:14336
  ds_read_b128 v[204:207], v11 offset:11264
  ds_read_b128 v[208:211], v11 offset:15360
  s_xor_b32 s42, s42, 0x4000
  s_add_u32 s51, s45, 294912
  s_waitcnt lgkmcnt(15)
  v_mfma_f32_16x16x32_bf16 v[96:99], v[224:227], v[148:151], 0
  v_mfma_f32_16x16x32_bf16 v[100:103], a[0:3], v[148:151], 0
  s_waitcnt lgkmcnt(14)
  v_mfma_f32_16x16x32_bf16 v[104:107], v[224:227], v[152:155], 0
  v_mfma_f32_16x16x32_bf16 v[108:111], a[0:3], v[152:155], 0
  s_waitcnt lgkmcnt(13)
  v_mfma_f32_16x16x32_bf16 v[96:99], v[228:231], v[156:159], v[96:99]
  v_mfma_f32_16x16x32_bf16 v[100:103], a[4:7], v[156:159], v[100:103]
  s_waitcnt lgkmcnt(12)
  v_mfma_f32_16x16x32_bf16 v[104:107], v[228:231], v[160:163], v[104:107]
  v_mfma_f32_16x16x32_bf16 v[108:111], a[4:7], v[160:163], v[108:111]
  s_waitcnt lgkmcnt(11)
  v_mfma_f32_16x16x32_bf16 v[96:99], v[232:235], v[164:167], v[96:99]
  v_mfma_f32_16x16x32_bf16 v[100:103], a[8:11], v[164:167], v[100:103]
  s_waitcnt lgkmcnt(10)
  v_mfma_f32_16x16x32_bf16 v[104:107], v[232:235], v[168:171], v[104:107]
  v_mfma_f32_16x16x32_bf16 v[108:111], a[8:11], v[168:171], v[108:111]
  s_waitcnt lgkmcnt(9)
  v_mfma_f32_16x16x32_bf16 v[96:99], v[236:239], v[172:175], v[96:99]
  v_mfma_f32_16x16x32_bf16 v[100:103], a[12:15], v[172:175], v[100:103]
  s_waitcnt lgkmcnt(8)
  v_mfma_f32_16x16x32_bf16 v[104:107], v[236:239], v[176:179], v[104:107]
  v_mfma_f32_16x16x32_bf16 v[108:111], a[12:15], v[176:179], v[108:111]
  s_waitcnt lgkmcnt(7)
  v_mfma_f32_16x16x32_bf16 v[96:99], v[240:243], v[180:183], v[96:99]
  v_mfma_f32_16x16x32_bf16 v[100:103], a[16:19], v[180:183], v[100:103]
  s_waitcnt lgkmcnt(6)
  v_mfma_f32_16x16x32_bf16 v[104:107], v[240:243], v[184:187], v[104:107]
  v_mfma_f32_16x16x32_bf16 v[108:111], a[16:19], v[184:187], v[108:111]
  s_waitcnt lgkmcnt(5)
  v_mfma_f32_16x16x32_bf16 v[96:99], v[244:247], v[188:191], v[96:99]
  v_mfma_f32_16x16x32_bf16 v[100:103], a[20:23], v[188:191], v[100:103]
  s_waitcnt lgkmcnt(4)
  v_mfma_f32_16x16x32_bf16 v[104:107], v[244:247], v[192:195], v[104:107]
  v_mfma_f32_16x16x32_bf16 v[108:111], a[20:23], v[192:195], v[108:111]
  s_waitcnt lgkmcnt(3)
  v_mfma_f32_16x16x32_bf16 v[96:99], v[248:251], v[196:199], v[96:99]
  v_mfma_f32_16x16x32_bf16 v[100:103], a[24:27], v[196:199], v[100:103]
  s_waitcnt lgkmcnt(2)
  v_mfma_f32_16x16x32_bf16 v[104:107], v[248:251], v[200:203], v[104:107]
  v_mfma_f32_16x16x32_bf16 v[108:111], a[24:27], v[200:203], v[108:111]
  s_waitcnt lgkmcnt(1)
  v_mfma_f32_16x16x32_bf16 v[96:99], v[252:255], v[204:207], v[96:99]
  v_mfma_f32_16x16x32_bf16 v[100:103], a[28:31], v[204:207], v[100:103]
  s_waitcnt lgkmcnt(0)
  v_mfma_f32_16x16x32_bf16 v[104:107], v[252:255], v[208:211], v[104:107]
  v_mfma_f32_16x16x32_bf16 v[108:111], a[28:31], v[208:211], v[108:111]
  v_mfma_f32_16x16x32_bf16 v[112:115], a[32:35], v[148:151], 0
  v_mfma_f32_16x16x32_bf16 v[116:119], a[64:67], v[148:151], 0
  v_mfma_f32_16x16x32_bf16 v[120:123], a[32:35], v[152:155], 0
  v_cvt_pk_bf16_f32 v96, v96, v97
  v_cvt_pk_bf16_f32 v97, v98, v99
  v_mfma_f32_16x16x32_bf16 v[124:127], a[64:67], v[152:155], 0
  v_cvt_pk_bf16_f32 v98, v100, v101
  v_cvt_pk_bf16_f32 v99, v102, v103
  v_mfma_f32_16x16x32_bf16 v[112:115], a[36:39], v[156:159], v[112:115]
  v_bfi_b32 v96, 1, s60, v96
  v_bfi_b32 v98, 1, s60, v98
  buffer_store_dwordx4 v[96:99], v4, s[4:7], s45 offen offset:128
  v_mfma_f32_16x16x32_bf16 v[116:119], a[68:71], v[156:159], v[116:119]
  v_cvt_pk_bf16_f32 v104, v104, v105
  v_cvt_pk_bf16_f32 v105, v106, v107
  v_mfma_f32_16x16x32_bf16 v[120:123], a[36:39], v[160:163], v[120:123]
  v_cvt_pk_bf16_f32 v106, v108, v109
  v_cvt_pk_bf16_f32 v107, v110, v111
  v_mfma_f32_16x16x32_bf16 v[124:127], a[68:71], v[160:163], v[124:127]
  v_bfi_b32 v104, 1, s60, v104
  v_bfi_b32 v106, 1, s60, v106
  buffer_store_dwordx4 v[104:107], v4, s[4:7], s51 offen offset:128
  v_mfma_f32_16x16x32_bf16 v[112:115], a[40:43], v[164:167], v[112:115]
  v_mfma_f32_16x16x32_bf16 v[116:119], a[72:75], v[164:167], v[116:119]
  v_mfma_f32_16x16x32_bf16 v[120:123], a[40:43], v[168:171], v[120:123]
  v_mfma_f32_16x16x32_bf16 v[124:127], a[72:75], v[168:171], v[124:127]
  v_mfma_f32_16x16x32_bf16 v[112:115], a[44:47], v[172:175], v[112:115]
  v_mfma_f32_16x16x32_bf16 v[116:119], a[76:79], v[172:175], v[116:119]
  v_mfma_f32_16x16x32_bf16 v[120:123], a[44:47], v[176:179], v[120:123]
  v_mfma_f32_16x16x32_bf16 v[124:127], a[76:79], v[176:179], v[124:127]
  v_mfma_f32_16x16x32_bf16 v[112:115], a[48:51], v[180:183], v[112:115]
  v_mfma_f32_16x16x32_bf16 v[116:119], a[80:83], v[180:183], v[116:119]
  v_mfma_f32_16x16x32_bf16 v[120:123], a[48:51], v[184:187], v[120:123]
  v_mfma_f32_16x16x32_bf16 v[124:127], a[80:83], v[184:187], v[124:127]
  v_mfma_f32_16x16x32_bf16 v[112:115], a[52:55], v[188:191], v[112:115]
  v_mfma_f32_16x16x32_bf16 v[116:119], a[84:87], v[188:191], v[116:119]
  v_mfma_f32_16x16x32_bf16 v[120:123], a[52:55], v[192:195], v[120:123]
  v_mfma_f32_16x16x32_bf16 v[124:127], a[84:87], v[192:195], v[124:127]
  v_mfma_f32_16x16x32_bf16 v[112:115], a[56:59], v[196:199], v[112:115]
  v_mfma_f32_16x16x32_bf16 v[116:119], a[88:91], v[196:199], v[116:119]
  v_mfma_f32_16x16x32_bf16 v[120:123], a[56:59], v[200:203], v[120:123]
  v_mfma_f32_16x16x32_bf16 v[124:127], a[88:91], v[200:203], v[124:127]
  v_mfma_f32_16x16x32_bf16 v[112:115], a[60:63], v[204:207], v[112:115]
  v_mfma_f32_16x16x32_bf16 v[116:119], a[92:95], v[204:207], v[116:119]
  v_mfma_f32_16x16x32_bf16 v[120:123], a[60:63], v[208:211], v[120:123]
  v_mfma_f32_16x16x32_bf16 v[124:127], a[92:95], v[208:211], v[124:127]
  v_mfma_f32_16x16x32_bf16 v[96:99], a[96:99], v[148:151], 0
  v_mfma_f32_16x16x32_bf16 v[100:103], a[128:131], v[148:151], 0
  v_mfma_f32_16x16x32_bf16 v[104:107], a[96:99], v[152:155], 0
  v_cvt_pk_bf16_f32 v112, v112, v113
  v_cvt_pk_bf16_f32 v113, v114, v115
  v_mfma_f32_16x16x32_bf16 v[108:111], a[128:131], v[152:155], 0
  v_cvt_pk_bf16_f32 v114, v116, v117
  v_cvt_pk_bf16_f32 v115, v118, v119
  v_mfma_f32_16x16x32_bf16 v[96:99], a[100:103], v[156:159], v[96:99]
  v_bfi_b32 v112, 1, s60, v112
  v_bfi_b32 v114, 1, s60, v114
  buffer_store_dwordx4 v[112:115], v4, s[4:7], s45 offen offset:640
  v_mfma_f32_16x16x32_bf16 v[100:103], a[132:135], v[156:159], v[100:103]
  v_cvt_pk_bf16_f32 v120, v120, v121
  v_cvt_pk_bf16_f32 v121, v122, v123
  v_mfma_f32_16x16x32_bf16 v[104:107], a[100:103], v[160:163], v[104:107]
  v_cvt_pk_bf16_f32 v122, v124, v125
  v_cvt_pk_bf16_f32 v123, v126, v127
  v_mfma_f32_16x16x32_bf16 v[108:111], a[132:135], v[160:163], v[108:111]
  v_bfi_b32 v120, 1, s60, v120
  v_bfi_b32 v122, 1, s60, v122
  buffer_store_dwordx4 v[120:123], v4, s[4:7], s51 offen offset:640
  v_mfma_f32_16x16x32_bf16 v[96:99], a[104:107], v[164:167], v[96:99]
  v_mfma_f32_16x16x32_bf16 v[100:103], a[136:139], v[164:167], v[100:103]
  v_mfma_f32_16x16x32_bf16 v[104:107], a[104:107], v[168:171], v[104:107]
  v_mfma_f32_16x16x32_bf16 v[108:111], a[136:139], v[168:171], v[108:111]
  v_mfma_f32_16x16x32_bf16 v[96:99], a[108:111], v[172:175], v[96:99]
  v_mfma_f32_16x16x32_bf16 v[100:103], a[140:143], v[172:175], v[100:103]
  v_mfma_f32_16x16x32_bf16 v[104:107], a[108:111], v[176:179], v[104:107]
  v_mfma_f32_16x16x32_bf16 v[108:111], a[140:143], v[176:179], v[108:111]
  v_mfma_f32_16x16x32_bf16 v[96:99], a[112:115], v[180:183], v[96:99]
  v_mfma_f32_16x16x32_bf16 v[100:103], a[144:147], v[180:183], v[100:103]
  v_mfma_f32_16x16x32_bf16 v[104:107], a[112:115], v[184:187], v[104:107]
  v_mfma_f32_16x16x32_bf16 v[108:111], a[144:147], v[184:187], v[108:111]
  v_mfma_f32_16x16x32_bf16 v[96:99], a[116:119], v[188:191], v[96:99]
  v_mfma_f32_16x16x32_bf16 v[100:103], a[148:151], v[188:191], v[100:103]
  v_mfma_f32_16x16x32_bf16 v[104:107], a[116:119], v[192:195], v[104:107]
  v_mfma_f32_16x16x32_bf16 v[108:111], a[148:151], v[192:195], v[108:111]
  v_mfma_f32_16x16x32_bf16 v[96:99], a[120:123], v[196:199], v[96:99]
  v_mfma_f32_16x16x32_bf16 v[100:103], a[152:155], v[196:199], v[100:103]
  v_mfma_f32_16x16x32_bf16 v[104:107], a[120:123], v[200:203], v[104:107]
  v_mfma_f32_16x16x32_bf16 v[108:111], a[152:155], v[200:203], v[108:111]
  v_mfma_f32_16x16x32_bf16 v[96:99], a[124:127], v[204:207], v[96:99]
  v_mfma_f32_16x16x32_bf16 v[100:103], a[156:159], v[204:207], v[100:103]
  v_mfma_f32_16x16x32_bf16 v[104:107], a[124:127], v[208:211], v[104:107]
  v_mfma_f32_16x16x32_bf16 v[108:111], a[156:159], v[208:211], v[108:111]
  v_mfma_f32_16x16x32_bf16 v[112:115], a[160:163], v[148:151], 0
  v_mfma_f32_16x16x32_bf16 v[116:119], a[192:195], v[148:151], 0
  v_mfma_f32_16x16x32_bf16 v[120:123], a[160:163], v[152:155], 0
  v_cvt_pk_bf16_f32 v96, v96, v97
  v_cvt_pk_bf16_f32 v97, v98, v99
  v_mfma_f32_16x16x32_bf16 v[124:127], a[192:195], v[152:155], 0
  v_cvt_pk_bf16_f32 v98, v100, v101
  v_cvt_pk_bf16_f32 v99, v102, v103
  v_mfma_f32_16x16x32_bf16 v[112:115], a[164:167], v[156:159], v[112:115]
  v_bfi_b32 v96, 1, s60, v96
  v_bfi_b32 v98, 1, s60, v98
  buffer_store_dwordx4 v[96:99], v4, s[4:7], s45 offen offset:1152
  v_mfma_f32_16x16x32_bf16 v[116:119], a[196:199], v[156:159], v[116:119]
  v_cvt_pk_bf16_f32 v104, v104, v105
  v_cvt_pk_bf16_f32 v105, v106, v107
  v_mfma_f32_16x16x32_bf16 v[120:123], a[164:167], v[160:163], v[120:123]
  v_cvt_pk_bf16_f32 v106, v108, v109
  v_cvt_pk_bf16_f32 v107, v110, v111
  v_mfma_f32_16x16x32_bf16 v[124:127], a[196:199], v[160:163], v[124:127]
  v_bfi_b32 v104, 1, s60, v104
  v_bfi_b32 v106, 1, s60, v106
  buffer_store_dwordx4 v[104:107], v4, s[4:7], s51 offen offset:1152
  v_mfma_f32_16x16x32_bf16 v[112:115], a[168:171], v[164:167], v[112:115]
  v_mfma_f32_16x16x32_bf16 v[116:119], a[200:203], v[164:167], v[116:119]
  v_mfma_f32_16x16x32_bf16 v[120:123], a[168:171], v[168:171], v[120:123]
  v_mfma_f32_16x16x32_bf16 v[124:127], a[200:203], v[168:171], v[124:127]
  v_mfma_f32_16x16x32_bf16 v[112:115], a[172:175], v[172:175], v[112:115]
  v_mfma_f32_16x16x32_bf16 v[116:119], a[204:207], v[172:175], v[116:119]
  v_mfma_f32_16x16x32_bf16 v[120:123], a[172:175], v[176:179], v[120:123]
  v_mfma_f32_16x16x32_bf16 v[124:127], a[204:207], v[176:179], v[124:127]
  v_mfma_f32_16x16x32_bf16 v[112:115], a[176:179], v[180:183], v[112:115]
  v_mfma_f32_16x16x32_bf16 v[116:119], a[208:211], v[180:183], v[116:119]
  v_mfma_f32_16x16x32_bf16 v[120:123], a[176:179], v[184:187], v[120:123]
  v_mfma_f32_16x16x32_bf16 v[124:127], a[208:211], v[184:187], v[124:127]
  v_mfma_f32_16x16x32_bf16 v[112:115], a[180:183], v[188:191], v[112:115]
  v_mfma_f32_16x16x32_bf16 v[116:119], a[212:215], v[188:191], v[116:119]
  v_mfma_f32_16x16x32_bf16 v[120:123], a[180:183], v[192:195], v[120:123]
  v_mfma_f32_16x16x32_bf16 v[124:127], a[212:215], v[192:195], v[124:127]
  v_mfma_f32_16x16x32_bf16 v[112:115], a[184:187], v[196:199], v[112:115]
  v_mfma_f32_16x16x32_bf16 v[116:119], a[216:219], v[196:199], v[116:119]
  v_mfma_f32_16x16x32_bf16 v[120:123], a[184:187], v[200:203], v[120:123]
  v_mfma_f32_16x16x32_bf16 v[124:127], a[216:219], v[200:203], v[124:127]
  v_mfma_f32_16x16x32_bf16 v[112:115], a[188:191], v[204:207], v[112:115]
  v_mfma_f32_16x16x32_bf16 v[116:119], a[220:223], v[204:207], v[116:119]
  v_mfma_f32_16x16x32_bf16 v[120:123], a[188:191], v[208:211], v[120:123]
  v_mfma_f32_16x16x32_bf16 v[124:127], a[220:223], v[208:211], v[124:127]
  v_mfma_f32_16x16x32_bf16 v[96:99], a[224:227], v[148:151], 0
  v_mfma_f32_16x16x32_bf16 v[104:107], a[224:227], v[152:155], 0
  v_mfma_f32_16x16x32_bf16 v[96:99], a[228:231], v[156:159], v[96:99]
  v_cvt_pk_bf16_f32 v112, v112, v113
  v_cvt_pk_bf16_f32 v113, v114, v115
  v_mfma_f32_16x16x32_bf16 v[104:107], a[228:231], v[160:163], v[104:107]
  v_cvt_pk_bf16_f32 v114, v116, v117
  v_cvt_pk_bf16_f32 v115, v118, v119
  v_mfma_f32_16x16x32_bf16 v[96:99], a[232:235], v[164:167], v[96:99]
  v_bfi_b32 v112, 1, s60, v112
  v_bfi_b32 v114, 1, s60, v114
  buffer_store_dwordx4 v[112:115], v4, s[4:7], s45 offen offset:1664
  v_mfma_f32_16x16x32_bf16 v[104:107], a[232:235], v[168:171], v[104:107]
  v_cvt_pk_bf16_f32 v120, v120, v121
  v_cvt_pk_bf16_f32 v121, v122, v123
  v_mfma_f32_16x16x32_bf16 v[96:99], a[236:239], v[172:175], v[96:99]
  v_cvt_pk_bf16_f32 v122, v124, v125
  v_cvt_pk_bf16_f32 v123, v126, v127
  v_mfma_f32_16x16x32_bf16 v[104:107], a[236:239], v[176:179], v[104:107]
  v_bfi_b32 v120, 1, s60, v120
  v_bfi_b32 v122, 1, s60, v122
  buffer_store_dwordx4 v[120:123], v4, s[4:7], s51 offen offset:1664
  v_mfma_f32_16x16x32_bf16 v[96:99], a[240:243], v[180:183], v[96:99]
  v_mfma_f32_16x16x32_bf16 v[104:107], a[240:243], v[184:187], v[104:107]
  v_mfma_f32_16x16x32_bf16 v[96:99], a[244:247], v[188:191], v[96:99]
  v_mfma_f32_16x16x32_bf16 v[104:107], a[244:247], v[192:195], v[104:107]
  v_mfma_f32_16x16x32_bf16 v[96:99], a[248:251], v[196:199], v[96:99]
  v_mfma_f32_16x16x32_bf16 v[104:107], a[248:251], v[200:203], v[104:107]
  v_mfma_f32_16x16x32_bf16 v[96:99], a[252:255], v[204:207], v[96:99]
  v_mfma_f32_16x16x32_bf16 v[104:107], a[252:255], v[208:211], v[104:107]
  s_nop 4
  v_cvt_pk_bf16_f32 v96, v96, v97
  v_cvt_pk_bf16_f32 v97, v98, v99
  v_bfi_b32 v96, 1, s60, v96
  buffer_store_dwordx2 v[96:97], v4, s[4:7], s45 offen offset:2056
  v_cvt_pk_bf16_f32 v104, v104, v105
  v_cvt_pk_bf16_f32 v105, v106, v107
  v_bfi_b32 v104, 1, s60, v104
  buffer_store_dwordx2 v[104:105], v4, s[4:7], s51 offen offset:2056
  s_branch L_att_l1_wx
L_att_l1_ws:
  ds_read_b128 v[148:151], v11 offset:0
  ds_read_b128 v[152:155], v11 offset:4096
  ds_read_b128 v[156:159], v11 offset:1024
  ds_read_b128 v[160:163], v11 offset:5120
  ds_read_b128 v[164:167], v11 offset:2048
  ds_read_b128 v[168:171], v11 offset:6144
  ds_read_b128 v[172:175], v11 offset:3072
  ds_read_b128 v[176:179], v11 offset:7168
  ds_read_b128 v[180:183], v11 offset:8192
  ds_read_b128 v[184:187], v11 offset:12288
  ds_read_b128 v[188:191], v11 offset:9216
  ds_read_b128 v[192:195], v11 offset:13312
  ds_read_b128 v[196:199], v11 offset:10240
  ds_read_b128 v[200:203], v11 offset:14336
  ds_read_b128 v[204:207], v11 offset:11264
  ds_read_b128 v[208:211], v11 offset:15360
  s_xor_b32 s42, s42, 0x4000
  s_add_u32 s51, s45, 294912
  s_waitcnt lgkmcnt(15)
  v_mfma_f32_16x16x32_bf16 v[96:99], v[224:227], v[148:151], 0
  v_mfma_f32_16x16x32_bf16 v[100:103], a[0:3], v[148:151], 0
  s_waitcnt lgkmcnt(14)
  v_mfma_f32_16x16x32_bf16 v[104:107], v[224:227], v[152:155], 0
  v_mfma_f32_16x16x32_bf16 v[108:111], a[0:3], v[152:155], 0
  s_waitcnt lgkmcnt(13)
  v_mfma_f32_16x16x32_bf16 v[96:99], v[228:231], v[156:159], v[96:99]
  v_mfma_f32_16x16x32_bf16 v[100:103], a[4:7], v[156:159], v[100:103]
  s_waitcnt lgkmcnt(12)
  v_mfma_f32_16x16x32_bf16 v[104:107], v[228:231], v[160:163], v[104:107]
  v_mfma_f32_16x16x32_bf16 v[108:111], a[4:7], v[160:163], v[108:111]
  s_waitcnt lgkmcnt(11)
  v_mfma_f32_16x16x32_bf16 v[96:99], v[232:235], v[164:167], v[96:99]
  v_mfma_f32_16x16x32_bf16 v[100:103], a[8:11], v[164:167], v[100:103]
  s_waitcnt lgkmcnt(10)
  v_mfma_f32_16x16x32_bf16 v[104:107], v[232:235], v[168:171], v[104:107]
  v_mfma_f32_16x16x32_bf16 v[108:111], a[8:11], v[168:171], v[108:111]
  s_waitcnt lgkmcnt(9)
  v_mfma_f32_16x16x32_bf16 v[96:99], v[236:239], v[172:175], v[96:99]
  v_mfma_f32_16x16x32_bf16 v[100:103], a[12:15], v[172:175], v[100:103]
  s_waitcnt lgkmcnt(8)
  v_mfma_f32_16x16x32_bf16 v[104:107], v[236:239], v[176:179], v[104:107]
  v_mfma_f32_16x16x32_bf16 v[108:111], a[12:15], v[176:179], v[108:111]
  s_waitcnt lgkmcnt(7)
  v_mfma_f32_16x16x32_bf16 v[96:99], v[240:243], v[180:183], v[96:99]
  v_mfma_f32_16x16x32_bf16 v[100:103], a[16:19], v[180:183], v[100:103]
  s_waitcnt lgkmcnt(6)
  v_mfma_f32_16x16x32_bf16 v[104:107], v[240:243], v[184:187], v[104:107]
  v_mfma_f32_16x16x32_bf16 v[108:111], a[16:19], v[184:187], v[108:111]
  s_waitcnt lgkmcnt(5)
  v_mfma_f32_16x16x32_bf16 v[96:99], v[244:247], v[188:191], v[96:99]
  v_mfma_f32_16x16x32_bf16 v[100:103], a[20:23], v[188:191], v[100:103]
  s_waitcnt lgkmcnt(4)
  v_mfma_f32_16x16x32_bf16 v[104:107], v[244:247], v[192:195], v[104:107]
  v_mfma_f32_16x16x32_bf16 v[108:111], a[20:23], v[192:195], v[108:111]
  s_waitcnt lgkmcnt(3)
  v_mfma_f32_16x16x32_bf16 v[96:99], v[248:251], v[196:199], v[96:99]
  v_mfma_f32_16x16x32_bf16 v[100:103], a[24:27], v[196:199], v[100:103]
  s_waitcnt lgkmcnt(2)
  v_mfma_f32_16x16x32_bf16 v[104:107], v[248:251], v[200:203], v[104:107]
  v_mfma_f32_16x16x32_bf16 v[108:111], a[24:27], v[200:203], v[108:111]
  s_waitcnt lgkmcnt(1)
  v_mfma_f32_16x16x32_bf16 v[96:99], v[252:255], v[204:207], v[96:99]
  v_mfma_f32_16x16x32_bf16 v[100:103], a[28:31], v[204:207], v[100:103]
  s_waitcnt lgkmcnt(0)
  v_mfma_f32_16x16x32_bf16 v[104:107], v[252:255], v[208:211], v[104:107]
  v_mfma_f32_16x16x32_bf16 v[108:111], a[28:31], v[208:211], v[108:111]
  v_mfma_f32_16x16x32_bf16 v[112:115], a[32:35], v[148:151], 0
  v_mfma_f32_16x16x32_bf16 v[116:119], a[64:67], v[148:151], 0
  v_mfma_f32_16x16x32_bf16 v[120:123], a[32:35], v[152:155], 0
  v_cvt_pk_bf16_f32 v96, v96, v97
  v_cvt_pk_bf16_f32 v97, v98, v99
  v_mfma_f32_16x16x32_bf16 v[124:127], a[64:67], v[152:155], 0
  v_cvt_pk_bf16_f32 v98, v100, v101
  v_cvt_pk_bf16_f32 v99, v102, v103
  v_mfma_f32_16x16x32_bf16 v[112:115], a[36:39], v[156:159], v[112:115]
  v_bfi_b32 v96, 1, s60, v96
  v_bfi_b32 v98, 1, s60, v98
  buffer_store_dwordx4 v[96:99], v4, s[4:7], s45 offen offset:128 sc1
  v_mfma_f32_16x16x32_bf16 v[116:119], a[68:71], v[156:159], v[116:119]
  v_cvt_pk_bf16_f32 v104, v104, v105
  v_cvt_pk_bf16_f32 v105, v106, v107
  v_mfma_f32_16x16x32_bf16 v[120:123], a[36:39], v[160:163], v[120:123]
  v_cvt_pk_bf16_f32 v106, v108, v109
  v_cvt_pk_bf16_f32 v107, v110, v111
  v_mfma_f32_16x16x32_bf16 v[124:127], a[68:71], v[160:163], v[124:127]
  v_bfi_b32 v104, 1, s60, v104
  v_bfi_b32 v106, 1, s60, v106
  buffer_store_dwordx4 v[104:107], v4, s[4:7], s51 offen offset:128 sc1
  v_mfma_f32_16x16x32_bf16 v[112:115], a[40:43], v[164:167], v[112:115]
  v_mfma_f32_16x16x32_bf16 v[116:119], a[72:75], v[164:167], v[116:119]
  v_mfma_f32_16x16x32_bf16 v[120:123], a[40:43], v[168:171], v[120:123]
  v_mfma_f32_16x16x32_bf16 v[124:127], a[72:75], v[168:171], v[124:127]
  v_mfma_f32_16x16x32_bf16 v[112:115], a[44:47], v[172:175], v[112:115]
  v_mfma_f32_16x16x32_bf16 v[116:119], a[76:79], v[172:175], v[116:119]
  v_mfma_f32_16x16x32_bf16 v[120:123], a[44:47], v[176:179], v[120:123]
  v_mfma_f32_16x16x32_bf16 v[124:127], a[76:79], v[176:179], v[124:127]
  v_mfma_f32_16x16x32_bf16 v[112:115], a[48:51], v[180:183], v[112:115]
  v_mfma_f32_16x16x32_bf16 v[116:119], a[80:83], v[180:183], v[116:119]
  v_mfma_f32_16x16x32_bf16 v[120:123], a[48:51], v[184:187], v[120:123]
  v_mfma_f32_16x16x32_bf16 v[124:127], a[80:83], v[184:187], v[124:127]
  v_mfma_f32_16x16x32_bf16 v[112:115], a[52:55], v[188:191], v[112:115]
  v_mfma_f32_16x16x32_bf16 v[116:119], a[84:87], v[188:191], v[116:119]
  v_mfma_f32_16x16x32_bf16 v[120:123], a[52:55], v[192:195], v[120:123]
  v_mfma_f32_16x16x32_bf16 v[124:127], a[84:87], v[192:195], v[124:127]
  v_mfma_f32_16x16x32_bf16 v[112:115], a[56:59], v[196:199], v[112:115]
  v_mfma_f32_16x16x32_bf16 v[116:119], a[88:91], v[196:199], v[116:119]
  v_mfma_f32_16x16x32_bf16 v[120:123], a[56:59], v[200:203], v[120:123]
  v_mfma_f32_16x16x32_bf16 v[124:127], a[88:91], v[200:203], v[124:127]
  v_mfma_f32_16x16x32_bf16 v[112:115], a[60:63], v[204:207], v[112:115]
  v_mfma_f32_16x16x32_bf16 v[116:119], a[92:95], v[204:207], v[116:119]
  v_mfma_f32_16x16x32_bf16 v[120:123], a[60:63], v[208:211], v[120:123]
  v_mfma_f32_16x16x32_bf16 v[124:127], a[92:95], v[208:211], v[124:127]
  v_mfma_f32_16x16x32_bf16 v[96:99], a[96:99], v[148:151], 0
  v_mfma_f32_16x16x32_bf16 v[100:103], a[128:131], v[148:151], 0
  v_mfma_f32_16x16x32_bf16 v[104:107], a[96:99], v[152:155], 0
  v_cvt_pk_bf16_f32 v112, v112, v113
  v_cvt_pk_bf16_f32 v113, v114, v115
  v_mfma_f32_16x16x32_bf16 v[108:111], a[128:131], v[152:155], 0
  v_cvt_pk_bf16_f32 v114, v116, v117
  v_cvt_pk_bf16_f32 v115, v118, v119
  v_mfma_f32_16x16x32_bf16 v[96:99], a[100:103], v[156:159], v[96:99]
  v_bfi_b32 v112, 1, s60, v112
  v_bfi_b32 v114, 1, s60, v114
  buffer_store_dwordx4 v[112:115], v4, s[4:7], s45 offen offset:640 sc1
  v_mfma_f32_16x16x32_bf16 v[100:103], a[132:135], v[156:159], v[100:103]
  v_cvt_pk_bf16_f32 v120, v120, v121
  v_cvt_pk_bf16_f32 v121, v122, v123
  v_mfma_f32_16x16x32_bf16 v[104:107], a[100:103], v[160:163], v[104:107]
  v_cvt_pk_bf16_f32 v122, v124, v125
  v_cvt_pk_bf16_f32 v123, v126, v127
  v_mfma_f32_16x16x32_bf16 v[108:111], a[132:135], v[160:163], v[108:111]
  v_bfi_b32 v120, 1, s60, v120
  v_bfi_b32 v122, 1, s60, v122
  buffer_store_dwordx4 v[120:123], v4, s[4:7], s51 offen offset:640 sc1
  v_mfma_f32_16x16x32_bf16 v[96:99], a[104:107], v[164:167], v[96:99]
  v_mfma_f32_16x16x32_bf16 v[100:103], a[136:139], v[164:167], v[100:103]
  v_mfma_f32_16x16x32_bf16 v[104:107], a[104:107], v[168:171], v[104:107]
  v_mfma_f32_16x16x32_bf16 v[108:111], a[136:139], v[168:171], v[108:111]
  v_mfma_f32_16x16x32_bf16 v[96:99], a[108:111], v[172:175], v[96:99]
  v_mfma_f32_16x16x32_bf16 v[100:103], a[140:143], v[172:175], v[100:103]
  v_mfma_f32_16x16x32_bf16 v[104:107], a[108:111], v[176:179], v[104:107]
  v_mfma_f32_16x16x32_bf16 v[108:111], a[140:143], v[176:179], v[108:111]
  v_mfma_f32_16x16x32_bf16 v[96:99], a[112:115], v[180:183], v[96:99]
  v_mfma_f32_16x16x32_bf16 v[100:103], a[144:147], v[180:183], v[100:103]
  v_mfma_f32_16x16x32_bf16 v[104:107], a[112:115], v[184:187], v[104:107]
  v_mfma_f32_16x16x32_bf16 v[108:111], a[144:147], v[184:187], v[108:111]
  v_mfma_f32_16x16x32_bf16 v[96:99], a[116:119], v[188:191], v[96:99]
  v_mfma_f32_16x16x32_bf16 v[100:103], a[148:151], v[188:191], v[100:103]
  v_mfma_f32_16x16x32_bf16 v[104:107], a[116:119], v[192:195], v[104:107]
  v_mfma_f32_16x16x32_bf16 v[108:111], a[148:151], v[192:195], v[108:111]
  v_mfma_f32_16x16x32_bf16 v[96:99], a[120:123], v[196:199], v[96:99]
  v_mfma_f32_16x16x32_bf16 v[100:103], a[152:155], v[196:199], v[100:103]
  v_mfma_f32_16x16x32_bf16 v[104:107], a[120:123], v[200:203], v[104:107]
  v_mfma_f32_16x16x32_bf16 v[108:111], a[152:155], v[200:203], v[108:111]
  v_mfma_f32_16x16x32_bf16 v[96:99], a[124:127], v[204:207], v[96:99]
  v_mfma_f32_16x16x32_bf16 v[100:103], a[156:159], v[204:207], v[100:103]
  v_mfma_f32_16x16x32_bf16 v[104:107], a[124:127], v[208:211], v[104:107]
  v_mfma_f32_16x16x32_bf16 v[108:111], a[156:159], v[208:211], v[108:111]
  v_mfma_f32_16x16x32_bf16 v[112:115], a[160:163], v[148:151], 0
  v_mfma_f32_16x16x32_bf16 v[116:119], a[192:195], v[148:151], 0
  v_mfma_f32_16x16x32_bf16 v[120:123], a[160:163], v[152:155], 0
  v_cvt_pk_bf16_f32 v96, v96, v97
  v_cvt_pk_bf16_f32 v97, v98, v99
  v_mfma_f32_16x16x32_bf16 v[124:127], a[192:195], v[152:155], 0
  v_cvt_pk_bf16_f32 v98, v100, v101
  v_cvt_pk_bf16_f32 v99, v102, v103
  v_mfma_f32_16x16x32_bf16 v[112:115], a[164:167], v[156:159], v[112:115]
  v_bfi_b32 v96, 1, s60, v96
  v_bfi_b32 v98, 1, s60, v98
  buffer_store_dwordx4 v[96:99], v4, s[4:7], s45 offen offset:1152 sc1
  v_mfma_f32_16x16x32_bf16 v[116:119], a[196:199], v[156:159], v[116:119]
  v_cvt_pk_bf16_f32 v104, v104, v105
  v_cvt_pk_bf16_f32 v105, v106, v107
  v_mfma_f32_16x16x32_bf16 v[120:123], a[164:167], v[160:163], v[120:123]
  v_cvt_pk_bf16_f32 v106, v108, v109
  v_cvt_pk_bf16_f32 v107, v110, v111
  v_mfma_f32_16x16x32_bf16 v[124:127], a[196:199], v[160:163], v[124:127]
  v_bfi_b32 v104, 1, s60, v104
  v_bfi_b32 v106, 1, s60, v106
  buffer_store_dwordx4 v[104:107], v4, s[4:7], s51 offen offset:1152 sc1
  v_mfma_f32_16x16x32_bf16 v[112:115], a[168:171], v[164:167], v[112:115]
  v_mfma_f32_16x16x32_bf16 v[116:119], a[200:203], v[164:167], v[116:119]
  v_mfma_f32_16x16x32_bf16 v[120:123], a[168:171], v[168:171], v[120:123]
  v_mfma_f32_16x16x32_bf16 v[124:127], a[200:203], v[168:171], v[124:127]
  v_mfma_f32_16x16x32_bf16 v[112:115], a[172:175], v[172:175], v[112:115]
  v_mfma_f32_16x16x32_bf16 v[116:119], a[204:207], v[172:175], v[116:119]
  v_mfma_f32_16x16x32_bf16 v[120:123], a[172:175], v[176:179], v[120:123]
  v_mfma_f32_16x16x32_bf16 v[124:127], a[204:207], v[176:179], v[124:127]
  v_mfma_f32_16x16x32_bf16 v[112:115], a[176:179], v[180:183], v[112:115]
  v_mfma_f32_16x16x32_bf16 v[116:119], a[208:211], v[180:183], v[116:119]
  v_mfma_f32_16x16x32_bf16 v[120:123], a[176:179], v[184:187], v[120:123]
  v_mfma_f32_16x16x32_bf16 v[124:127], a[208:211], v[184:187], v[124:127]
  v_mfma_f32_16x16x32_bf16 v[112:115], a[180:183], v[188:191], v[112:115]
  v_mfma_f32_16x16x32_bf16 v[116:119], a[212:215], v[188:191], v[116:119]
  v_mfma_f32_16x16x32_bf16 v[120:123], a[180:183], v[192:195], v[120:123]
  v_mfma_f32_16x16x32_bf16 v[124:127], a[212:215], v[192:195], v[124:127]
  v_mfma_f32_16x16x32_bf16 v[112:115], a[184:187], v[196:199], v[112:115]
  v_mfma_f32_16x16x32_bf16 v[116:119], a[216:219], v[196:199], v[116:119]
  v_mfma_f32_16x16x32_bf16 v[120:123], a[184:187], v[200:203], v[120:123]
  v_mfma_f32_16x16x32_bf16 v[124:127], a[216:219], v[200:203], v[124:127]
  v_mfma_f32_16x16x32_bf16 v[112:115], a[188:191], v[204:207], v[112:115]
  v_mfma_f32_16x16x32_bf16 v[116:119], a[220:223], v[204:207], v[116:119]
  v_mfma_f32_16x16x32_bf16 v[120:123], a[188:191], v[208:211], v[120:123]
  v_mfma_f32_16x16x32_bf16 v[124:127], a[220:223], v[208:211], v[124:127]
  v_mfma_f32_16x16x32_bf16 v[96:99], a[224:227], v[148:151], 0
  v_mfma_f32_16x16x32_bf16 v[104:107], a[224:227], v[152:155], 0
  v_mfma_f32_16x16x32_bf16 v[96:99], a[228:231], v[156:159], v[96:99]
  v_cvt_pk_bf16_f32 v112, v112, v113
  v_cvt_pk_bf16_f32 v113, v114, v115
  v_mfma_f32_16x16x32_bf16 v[104:107], a[228:231], v[160:163], v[104:107]
  v_cvt_pk_bf16_f32 v114, v116, v117
  v_cvt_pk_bf16_f32 v115, v118, v119
  v_mfma_f32_16x16x32_bf16 v[96:99], a[232:235], v[164:167], v[96:99]
  v_bfi_b32 v112, 1, s60, v112
  v_bfi_b32 v114, 1, s60, v114
  buffer_store_dwordx4 v[112:115], v4, s[4:7], s45 offen offset:1664 sc1
  v_mfma_f32_16x16x32_bf16 v[104:107], a[232:235], v[168:171], v[104:107]
  v_cvt_pk_bf16_f32 v120, v120, v121
  v_cvt_pk_bf16_f32 v121, v122, v123
  v_mfma_f32_16x16x32_bf16 v[96:99], a[236:239], v[172:175], v[96:99]
  v_cvt_pk_bf16_f32 v122, v124, v125
  v_cvt_pk_bf16_f32 v123, v126, v127
  v_mfma_f32_16x16x32_bf16 v[104:107], a[236:239], v[176:179], v[104:107]
  v_bfi_b32 v120, 1, s60, v120
  v_bfi_b32 v122, 1, s60, v122
  buffer_store_dwordx4 v[120:123], v4, s[4:7], s51 offen offset:1664 sc1
  v_mfma_f32_16x16x32_bf16 v[96:99], a[240:243], v[180:183], v[96:99]
  v_mfma_f32_16x16x32_bf16 v[104:107], a[240:243], v[184:187], v[104:107]
  v_mfma_f32_16x16x32_bf16 v[96:99], a[244:247], v[188:191], v[96:99]
  v_mfma_f32_16x16x32_bf16 v[104:107], a[244:247], v[192:195], v[104:107]
  v_mfma_f32_16x16x32_bf16 v[96:99], a[248:251], v[196:199], v[96:99]
  v_mfma_f32_16x16x32_bf16 v[104:107], a[248:251], v[200:203], v[104:107]
  v_mfma_f32_16x16x32_bf16 v[96:99], a[252:255], v[204:207], v[96:99]
  v_mfma_f32_16x16x32_bf16 v[104:107], a[252:255], v[208:211], v[104:107]
  s_nop 4
  v_cvt_pk_bf16_f32 v96, v96, v97
  v_cvt_pk_bf16_f32 v97, v98, v99
  v_bfi_b32 v96, 1, s60, v96
  buffer_store_dwordx2 v[96:97], v4, s[4:7], s45 offen offset:2056 sc1
  v_cvt_pk_bf16_f32 v104, v104, v105
  v_cvt_pk_bf16_f32 v105, v106, v107
  v_bfi_b32 v104, 1, s60, v104
  buffer_store_dwordx2 v[104:105], v4, s[4:7], s51 offen offset:2056 sc1
L_att_l1_wx:
  s_cmp_eq_u32 s40, 60
  s_cselect_b32 s34, s38, 0
  s_sub_u32 s40, s40, s34
  s_cmp_ge_u32 s40, 60
  s_cbranch_scc1 L_att_l1_end
  s_waitcnt vmcnt(0)
  s_add_u32 s95, s40, 5
  s_cmp_ge_u32 s48, s95
  s_cbranch_scc1 L_ap_25_x
L_ap_25:
  s_load_dwordx4 s[96:99], s[4:5], s92 glc
  s_load_dwordx2 s[100:101], s[4:5], s93 glc
  s_add_u32 s50, s50, 1
  s_cmp_ge_u32 s50, 262144
  s_cbranch_scc1 L_ap_25_y
  s_waitcnt lgkmcnt(0)
  s_min_u32 s48, s96, s97
  s_min_u32 s48, s48, s98
  s_min_u32 s48, s48, s99
  s_min_u32 s48, s48, s100
  s_min_u32 s48, s48, s101
  s_cmp_lt_u32 s48, s95
  s_cbranch_scc1 L_ap_25
L_ap_25_y:
  s_waitcnt lgkmcnt(0)
L_ap_25_x:
  s_lshl_b32 s34, s40, 5
  s_lshl1_add_u32 s34, s43, s34
  s_add_u32 s34, s34, 128
  s_lshl_b32 s34, s34, 13
  s_add_u32 s51, s34, 18878464
  buffer_load_dwordx4 v[16:19], v1, s[4:7], s51 offen offset:0 sc1
  buffer_load_dwordx4 v[20:23], v1, s[4:7], s51 offen offset:1024 sc1
  buffer_load_dwordx4 v[24:27], v1, s[4:7], s51 offen offset:2048 sc1
  buffer_load_dwordx4 v[28:31], v1, s[4:7], s51 offen offset:3072 sc1
  s_add_u32 s51, s34, 35651584
  buffer_load_dwordx4 v[32:35], v1, s[4:7], s51 offen offset:0 sc1
  buffer_load_dwordx4 v[36:39], v1, s[4:7], s51 offen offset:1024 sc1
  buffer_load_dwordx4 v[40:43], v1, s[4:7], s51 offen offset:2048 sc1
  buffer_load_dwordx4 v[44:47], v1, s[4:7], s51 offen offset:3072 sc1
  s_add_u32 s51, s34, 35655680
  buffer_load_dwordx4 v[48:51], v1, s[4:7], s51 offen offset:0 sc1
  buffer_load_dwordx4 v[52:55], v1, s[4:7], s51 offen offset:1024 sc1
  buffer_load_dwordx4 v[56:59], v1, s[4:7], s51 offen offset:2048 sc1
  buffer_load_dwordx4 v[60:63], v1, s[4:7], s51 offen offset:3072 sc1
  s_add_u32 s51, s34, 52428800
  buffer_load_dwordx4 v[64:67], v1, s[4:7], s51 offen offset:0 sc1
  buffer_load_dwordx4 v[68:71], v1, s[4:7], s51 offen offset:1024 sc1
  buffer_load_dwordx4 v[72:75], v1, s[4:7], s51 offen offset:2048 sc1
  buffer_load_dwordx4 v[76:79], v1, s[4:7], s51 offen offset:3072 sc1
  s_add_u32 s51, s34, 52432896
  buffer_load_dwordx4 v[80:83], v1, s[4:7], s51 offen offset:0 sc1
  buffer_load_dwordx4 v[84:87], v1, s[4:7], s51 offen offset:1024 sc1
  buffer_load_dwordx4 v[88:91], v1, s[4:7], s51 offen offset:2048 sc1
  buffer_load_dwordx4 v[92:95], v1, s[4:7], s51 offen offset:3072 sc1
  s_add_u32 s40, s40, 4
  s_branch L_att_l1
L_att_l1_end:
  s_endpgm
L_att_w2:
  v_lshrrev_b32 v12, 2, v0
  v_mul_u32_u24 v12, 1152, v12
  v_and_b32 v13, 3, v0
  v_lshl_add_u32 v12, v13, 4, v12
  v_add_u32 v13, 73728, v12
  s_waitcnt vmcnt(27)
  s_barrier
  ds_read_b64_tr_b16 v[224:225], v12 offset:576
  ds_read_b64_tr_b16 v[226:227], v12 offset:19008
  ds_read_b64_tr_b16 a[0:1], v12 offset:584
  ds_read_b64_tr_b16 a[2:3], v12 offset:19016
  ds_read_b64_tr_b16 a[32:33], v12 offset:640
  ds_read_b64_tr_b16 a[34:35], v12 offset:19072
  ds_read_b64_tr_b16 a[64:65], v12 offset:648
  ds_read_b64_tr_b16 a[66:67], v12 offset:19080
  ds_read_b64_tr_b16 a[96:97], v12 offset:704
  ds_read_b64_tr_b16 a[98:99], v12 offset:19136
  ds_read_b64_tr_b16 a[128:129], v12 offset:712
  ds_read_b64_tr_b16 a[130:131], v12 offset:19144
  ds_read_b64_tr_b16 a[160:161], v12 offset:768
  ds_read_b64_tr_b16 a[162:163], v12 offset:19200
  ds_read_b64_tr_b16 a[192:193], v12 offset:776
  ds_read_b64_tr_b16 a[194:195], v12 offset:19208
  ds_read_b64_tr_b16 a[224:225], v12 offset:832
  ds_read_b64_tr_b16 a[226:227], v12 offset:19264
  s_waitcnt lgkmcnt(0)
  s_barrier
  s_add_u32 m0, s42, 0
  s_add_u32 s51, s45, 147456
  buffer_load_dwordx4 v1, s[16:19], s51 offen offset:0 lds
  buffer_load_dwordx4 v1, s[16:19], s51 offen offset:1024 lds
  buffer_load_dwordx4 v1, s[16:19], s51 offen offset:2048 lds
  buffer_load_dwordx4 v1, s[16:19], s51 offen offset:3072 lds
  s_add_u32 m0, s42, 4096
  s_add_u32 s51, s45, 151552
  buffer_load_dwordx4 v1, s[16:19], s51 offen offset:0 lds
  buffer_load_dwordx4 v1, s[16:19], s51 offen offset:1024 lds
  buffer_load_dwordx4 v1, s[16:19], s51 offen offset:2048 lds
  buffer_load_dwordx4 v1, s[16:19], s51 offen offset:3072 lds
  s_add_u32 m0, s42, 8192
  s_add_u32 s51, s45, 155648
  buffer_load_dwordx4 v1, s[16:19], s51 offen offset:0 lds
  s_waitcnt vmcnt(27)
  s_barrier
  ds_read_b64_tr_b16 v[228:229], v12 offset:37440
  ds_read_b64_tr_b16 v[230:231], v12 offset:55872
  ds_read_b64_tr_b16 a[4:5], v12 offset:37448
  ds_read_b64_tr_b16 a[6:7], v12 offset:55880
  ds_read_b64_tr_b16 a[36:37], v12 offset:37504
  ds_read_b64_tr_b16 a[38:39], v12 offset:55936
  ds_read_b64_tr_b16 a[68:69], v12 offset:37512
  ds_read_b64_tr_b16 a[70:71], v12 offset:55944
  ds_read_b64_tr_b16 a[100:101], v12 offset:37568
  ds_read_b64_tr_b16 a[102:103], v12 offset:56000
  ds_read_b64_tr_b16 a[132:133], v12 offset:37576
  ds_read_b64_tr_b16 a[134:135], v12 offset:56008
  ds_read_b64_tr_b16 a[164:165], v12 offset:37632
  ds_read_b64_tr_b16 a[166:167], v12 offset:56064
  ds_read_b64_tr_b16 a[196:197], v12 offset:37640
  ds_read_b64_tr_b16 a[198:199], v12 offset:56072
  ds_read_b64_tr_b16 a[228:229], v12 offset:37696
  ds_read_b64_tr_b16 a[230:231], v12 offset:56128
  s_waitcnt lgkmcnt(0)
  s_barrier
  s_add_u32 m0, s42, 36864
  s_add_u32 s51, s45, 184320
  buffer_load_dwordx4 v1, s[16:19], s51 offen offset:0 lds
  buffer_load_dwordx4 v1, s[16:19], s51 offen offset:1024 lds
  buffer_load_dwordx4 v1, s[16:19], s51 offen offset:2048 lds
  buffer_load_dwordx4 v1, s[16:19], s51 offen offset:3072 lds
  s_add_u32 m0, s42, 40960
  s_add_u32 s51, s45, 188416
  buffer_load_dwordx4 v1, s[16:19], s51 offen offset:0 lds
  buffer_load_dwordx4 v1, s[16:19], s51 offen offset:1024 lds
  buffer_load_dwordx4 v1, s[16:19], s51 offen offset:2048 lds
  buffer_load_dwordx4 v1, s[16:19], s51 offen offset:3072 lds
  s_add_u32 m0, s42, 45056
  s_add_u32 s51, s45, 192512
  buffer_load_dwordx4 v1, s[16:19], s51 offen offset:0 lds
  s_waitcnt vmcnt(27)
  s_barrier
  ds_read_b64_tr_b16 v[232:233], v13 offset:576
  ds_read_b64_tr_b16 v[234:235], v13 offset:19008
  ds_read_b64_tr_b16 a[8:9], v13 offset:584
  ds_read_b64_tr_b16 a[10:11], v13 offset:19016
  ds_read_b64_tr_b16 a[40:41], v13 offset:640
  ds_read_b64_tr_b16 a[42:43], v13 offset:19072
  ds_read_b64_tr_b16 a[72:73], v13 offset:648
  ds_read_b64_tr_b16 a[74:75], v13 offset:19080
  ds_read_b64_tr_b16 a[104:105], v13 offset:704
  ds_read_b64_tr_b16 a[106:107], v13 offset:19136
  ds_read_b64_tr_b16 a[136:137], v13 offset:712
  ds_read_b64_tr_b16 a[138:139], v13 offset:19144
  ds_read_b64_tr_b16 a[168:169], v13 offset:768
  ds_read_b64_tr_b16 a[170:171], v13 offset:19200
  ds_read_b64_tr_b16 a[200:201], v13 offset:776
  ds_read_b64_tr_b16 a[202:203], v13 offset:19208
  ds_read_b64_tr_b16 a[232:233], v13 offset:832
  ds_read_b64_tr_b16 a[234:235], v13 offset:19264
  s_waitcnt lgkmcnt(0)
  s_barrier
  s_add_u32 m0, s42, 73728
  s_add_u32 s51, s45, 221184
  buffer_load_dwordx4 v1, s[16:19], s51 offen offset:0 lds
  buffer_load_dwordx4 v1, s[16:19], s51 offen offset:1024 lds
  buffer_load_dwordx4 v1, s[16:19], s51 offen offset:2048 lds
  buffer_load_dwordx4 v1, s[16:19], s51 offen offset:3072 lds
  s_add_u32 m0, s42, 77824
  s_add_u32 s51, s45, 225280
  buffer_load_dwordx4 v1, s[16:19], s51 offen offset:0 lds
  buffer_load_dwordx4 v1, s[16:19], s51 offen offset:1024 lds
  buffer_load_dwordx4 v1, s[16:19], s51 offen offset:2048 lds
  buffer_load_dwordx4 v1, s[16:19], s51 offen offset:3072 lds
  s_add_u32 m0, s42, 81920
  s_add_u32 s51, s45, 229376
  buffer_load_dwordx4 v1, s[16:19], s51 offen offset:0 lds
  s_waitcnt vmcnt(27)
  s_barrier
  ds_read_b64_tr_b16 v[236:237], v13 offset:37440
  ds_read_b64_tr_b16 v[238:239], v13 offset:55872
  ds_read_b64_tr_b16 a[12:13], v13 offset:37448
  ds_read_b64_tr_b16 a[14:15], v13 offset:55880
  ds_read_b64_tr_b16 a[44:45], v13 offset:37504
  ds_read_b64_tr_b16 a[46:47], v13 offset:55936
  ds_read_b64_tr_b16 a[76:77], v13 offset:37512
  ds_read_b64_tr_b16 a[78:79], v13 offset:55944
  ds_read_b64_tr_b16 a[108:109], v13 offset:37568
  ds_read_b64_tr_b16 a[110:111], v13 offset:56000
  ds_read_b64_tr_b16 a[140:141], v13 offset:37576
  ds_read_b64_tr_b16 a[142:143], v13 offset:56008
  ds_read_b64_tr_b16 a[172:173], v13 offset:37632
  ds_read_b64_tr_b16 a[174:175], v13 offset:56064
  ds_read_b64_tr_b16 a[204:205], v13 offset:37640
  ds_read_b64_tr_b16 a[206:207], v13 offset:56072
  ds_read_b64_tr_b16 a[236:237], v13 offset:37696
  ds_read_b64_tr_b16 a[238:239], v13 offset:56128
  s_waitcnt lgkmcnt(0)
  s_barrier
  s_add_u32 m0, s42, 110592
  s_add_u32 s51, s45, 258048
  buffer_load_dwordx4 v1, s[16:19], s51 offen offset:0 lds
  buffer_load_dwordx4 v1, s[16:19], s51 offen offset:1024 lds
  buffer_load_dwordx4 v1, s[16:19], s51 offen offset:2048 lds
  buffer_load_dwordx4 v1, s[16:19], s51 offen offset:3072 lds
  s_add_u32 m0, s42, 114688
  s_add_u32 s51, s45, 262144
  buffer_load_dwordx4 v1, s[16:19], s51 offen offset:0 lds
  buffer_load_dwordx4 v1, s[16:19], s51 offen offset:1024 lds
  buffer_load_dwordx4 v1, s[16:19], s51 offen offset:2048 lds
  buffer_load_dwordx4 v1, s[16:19], s51 offen offset:3072 lds
  s_add_u32 m0, s42, 118784
  s_add_u32 s51, s45, 266240
  buffer_load_dwordx4 v1, s[16:19], s51 offen offset:0 lds
  s_waitcnt vmcnt(27)
  s_barrier
  ds_read_b64_tr_b16 v[240:241], v12 offset:576
  ds_read_b64_tr_b16 v[242:243], v12 offset:19008
  ds_read_b64_tr_b16 a[16:17], v12 offset:584
  ds_read_b64_tr_b16 a[18:19], v12 offset:19016
  ds_read_b64_tr_b16 a[48:49], v12 offset:640
  ds_read_b64_tr_b16 a[50:51], v12 offset:19072
  ds_read_b64_tr_b16 a[80:81], v12 offset:648
  ds_read_b64_tr_b16 a[82:83], v12 offset:19080
  ds_read_b64_tr_b16 a[112:113], v12 offset:704
  ds_read_b64_tr_b16 a[114:115], v12 offset:19136
  ds_read_b64_tr_b16 a[144:145], v12 offset:712
  ds_read_b64_tr_b16 a[146:147], v12 offset:19144
  ds_read_b64_tr_b16 a[176:177], v12 offset:768
  ds_read_b64_tr_b16 a[178:179], v12 offset:19200
  ds_read_b64_tr_b16 a[208:209], v12 offset:776
  ds_read_b64_tr_b16 a[210:211], v12 offset:19208
  ds_read_b64_tr_b16 a[240:241], v12 offset:832
  ds_read_b64_tr_b16 a[242:243], v12 offset:19264
  s_waitcnt lgkmcnt(0)
  s_waitcnt vmcnt(18)
  s_barrier
  ds_read_b64_tr_b16 v[244:245], v12 offset:37440
  ds_read_b64_tr_b16 v[246:247], v12 offset:55872
  ds_read_b64_tr_b16 a[20:21], v12 offset:37448
  ds_read_b64_tr_b16 a[22:23], v12 offset:55880
  ds_read_b64_tr_b16 a[52:53], v12 offset:37504
  ds_read_b64_tr_b16 a[54:55], v12 offset:55936
  ds_read_b64_tr_b16 a[84:85], v12 offset:37512
  ds_read_b64_tr_b16 a[86:87], v12 offset:55944
  ds_read_b64_tr_b16 a[116:117], v12 offset:37568
  ds_read_b64_tr_b16 a[118:119], v12 offset:56000
  ds_read_b64_tr_b16 a[148:149], v12 offset:37576
  ds_read_b64_tr_b16 a[150:151], v12 offset:56008
  ds_read_b64_tr_b16 a[180:181], v12 offset:37632
  ds_read_b64_tr_b16 a[182:183], v12 offset:56064
  ds_read_b64_tr_b16 a[212:213], v12 offset:37640
  ds_read_b64_tr_b16 a[214:215], v12 offset:56072
  ds_read_b64_tr_b16 a[244:245], v12 offset:37696
  ds_read_b64_tr_b16 a[246:247], v12 offset:56128
  s_waitcnt lgkmcnt(0)
  s_waitcnt vmcnt(9)
  s_barrier
  ds_read_b64_tr_b16 v[248:249], v13 offset:576
  ds_read_b64_tr_b16 v[250:251], v13 offset:19008
  ds_read_b64_tr_b16 a[24:25], v13 offset:584
  ds_read_b64_tr_b16 a[26:27], v13 offset:19016
  ds_read_b64_tr_b16 a[56:57], v13 offset:640
  ds_read_b64_tr_b16 a[58:59], v13 offset:19072
  ds_read_b64_tr_b16 a[88:89], v13 offset:648
  ds_read_b64_tr_b16 a[90:91], v13 offset:19080
  ds_read_b64_tr_b16 a[120:121], v13 offset:704
  ds_read_b64_tr_b16 a[122:123], v13 offset:19136
  ds_read_b64_tr_b16 a[152:153], v13 offset:712
  ds_read_b64_tr_b16 a[154:155], v13 offset:19144
  ds_read_b64_tr_b16 a[184:185], v13 offset:768
  ds_read_b64_tr_b16 a[186:187], v13 offset:19200
  ds_read_b64_tr_b16 a[216:217], v13 offset:776
  ds_read_b64_tr_b16 a[218:219], v13 offset:19208
  ds_read_b64_tr_b16 a[248:249], v13 offset:832
  ds_read_b64_tr_b16 a[250:251], v13 offset:19264
  s_waitcnt lgkmcnt(0)
  s_waitcnt vmcnt(0)
  s_barrier
  ds_read_b64_tr_b16 v[252:253], v13 offset:37440
  ds_read_b64_tr_b16 v[254:255], v13 offset:55872
  ds_read_b64_tr_b16 a[28:29], v13 offset:37448
  ds_read_b64_tr_b16 a[30:31], v13 offset:55880
  ds_read_b64_tr_b16 a[60:61], v13 offset:37504
  ds_read_b64_tr_b16 a[62:63], v13 offset:55936
  ds_read_b64_tr_b16 a[92:93], v13 offset:37512
  ds_read_b64_tr_b16 a[94:95], v13 offset:55944
  ds_read_b64_tr_b16 a[124:125], v13 offset:37568
  ds_read_b64_tr_b16 a[126:127], v13 offset:56000
  ds_read_b64_tr_b16 a[156:157], v13 offset:37576
  ds_read_b64_tr_b16 a[158:159], v13 offset:56008
  ds_read_b64_tr_b16 a[188:189], v13 offset:37632
  ds_read_b64_tr_b16 a[190:191], v13 offset:56064
  ds_read_b64_tr_b16 a[220:221], v13 offset:37640
  ds_read_b64_tr_b16 a[222:223], v13 offset:56072
  ds_read_b64_tr_b16 a[252:253], v13 offset:37696
  ds_read_b64_tr_b16 a[254:255], v13 offset:56128
  s_waitcnt lgkmcnt(0)
  v_and_b32 v10, 15, v0
  v_lshrrev_b32 v11, 4, v0
  v_lshrrev_b32 v12, 2, v10
  v_and_b32 v13, 1, v0
  v_lshl_add_u32 v14, v12, 1, v13
  v_lshlrev_b32 v14, 4, v14
  v_lshl_add_u32 v2, v11, 7, v14
  v_lshlrev_b32 v3, 3, v0
  v_lshrrev_b32 v14, 1, v10
  v_mul_u32_u24 v14, 36864, v14
  v_lshl_add_u32 v14, v13, 6, v14
  v_lshl_add_u32 v14, v11, 4, v14
  s_mul_i32 s34, s43, 2304
  v_add_u32 v4, s34, v14
  v_mul_u32_u24 v14, 2304, v11
  v_and_b32 v15, 3, v0
  v_lshl_add_u32 v14, v15, 4, v14
  s_mul_i32 s34, s43, 36864
  s_add_u32 s34, s34, 64
  v_add_u32 v14, s34, v14
  v_lshl_add_u32 v5, v12, 7, v14
  v_and_b32 v8, 1, v12
  v_lshl_add_u32 v8, v8, 7, v14
  s_mul_i32 s34, s43, 2304
  s_add_u32 s34, s34, 1152
  v_lshlrev_b32 v15, 4, v15
  v_add_u32 v15, s34, v15
  v_lshrrev_b32 v14, 1, v12
  v_mul_u32_u24 v14, 9, v14
  v_and_b32 v13, 1, v12
  v_mul_u32_u24 v10, 5, v13
  v_add_u32 v14, v14, v10
  v_lshrrev_b32 v10, 1, v11
  v_add_u32 v14, v14, v10
  v_lshl_add_u32 v14, v14, 6, v15
  v_and_b32 v11, 1, v11
  v_lshl_add_u32 v6, v11, 3, v14
  v_lshl_add_u32 v9, v11, 7, v14
  v_mul_u32_u24 v13, 576, v13
  v_add_u32 v13, 256, v13
  v_add_u32 v13, v13, v15
  v_lshl_add_u32 v13, v11, 3, v13
  s_mov_b32 s34, 0x00ff00ff
  s_mov_b32 s35, 0
  v_mov_b32 v14, 0x80000000
  v_cndmask_b32 v7, v14, v13, s[34:35]
  v_and_b32 v10, 15, v0
  v_and_b32 v11, 1, v10
  v_lshlrev_b32 v11, 4, v11
  v_mov_b32 v12, 0x3f80
  v_lshlrev_b32 v12, v11, v12
  v_lshrrev_b32 v10, 1, v10
  v_cmp_eq_u32 vcc, 0, v10
  s_nop 1
  v_cndmask_b32 v212, 0, v12, vcc
  v_cmp_eq_u32 vcc, 1, v10
  s_nop 1
  v_cndmask_b32 v213, 0, v12, vcc
  v_cmp_eq_u32 vcc, 2, v10
  s_nop 1
  v_cndmask_b32 v214, 0, v12, vcc
  v_cmp_eq_u32 vcc, 3, v10
  s_nop 1
  v_cndmask_b32 v215, 0, v12, vcc
  v_and_b32 v10, 15, v0
  v_xor_b32 v10, 8, v10
  v_and_b32 v11, 1, v10
  v_lshlrev_b32 v11, 4, v11
  v_mov_b32 v12, 0x3f80
  v_lshlrev_b32 v12, v11, v12
  v_lshrrev_b32 v10, 1, v10
  v_cmp_eq_u32 vcc, 0, v10
  s_nop 1
  v_cndmask_b32 v216, 0, v12, vcc
  v_cmp_eq_u32 vcc, 1, v10
  s_nop 1
  v_cndmask_b32 v217, 0, v12, vcc
  v_cmp_eq_u32 vcc, 2, v10
  s_nop 1
  v_cndmask_b32 v218, 0, v12, vcc
  v_cmp_eq_u32 vcc, 3, v10
  s_nop 1
  v_cndmask_b32 v219, 0, v12, vcc
  s_lshl_b32 s34, s43, 8
  s_add_u32 s92, s34, 128
  s_add_u32 s94, s34, 6272
  s_lshl_b32 s34, s43, 7
  s_add_u32 s93, s34, 4104
  s_mov_b32 s48, 0
  s_mov_b32 s49, 0
  s_mov_b32 s52, 0xfff0ffff
  s_mov_b32 s53, 0xf000ff00
  s_mov_b32 s54, 0xffe0fffe
  s_mov_b32 s55, 0xe000fe00
  s_mov_b32 s56, 0xffc0fffc
  s_mov_b32 s57, 0xc000fc00
  s_mov_b32 s58, 0xff80fff8
  s_mov_b32 s59, 0x8000f800
  s_mov_b32 s46, 0x3e0293ee
  s_mov_b32 s47, 0xbe0293ee
  s_mul_i32 s34, s44, 1179648
  s_mul_i32 s35, s43, 36864
  s_add_u32 s34, s34, s35
  s_sub_u32 s35, s32, 48
  s_mul_i32 s35, s35, 36864
  v_mov_b64 v[16:17], -1
  v_mov_b64 v[18:19], -1
  s_add_u32 s51, s34, 69224448
  buffer_store_dwordx4 v[16:19], v1, s[4:7], s51 offen offset:0 sc1
  buffer_store_dwordx4 v[16:19], v1, s[4:7], s51 offen offset:1024 sc1
  buffer_store_dwordx4 v[16:19], v1, s[4:7], s51 offen offset:2048 sc1
  buffer_store_dwordx4 v[16:19], v1, s[4:7], s51 offen offset:3072 sc1
  s_add_u32 s51, s34, 69228544
  buffer_store_dwordx4 v[16:19], v1, s[4:7], s51 offen offset:0 sc1
  buffer_store_dwordx4 v[16:19], v1, s[4:7], s51 offen offset:1024 sc1
  buffer_store_dwordx4 v[16:19], v1, s[4:7], s51 offen offset:2048 sc1
  buffer_store_dwordx4 v[16:19], v1, s[4:7], s51 offen offset:3072 sc1
  s_add_u32 s51, s34, 69232640
  buffer_store_dwordx4 v[16:19], v1, s[4:7], s51 offen offset:0 sc1
  s_add_u32 s51, s34, 69814272
  buffer_store_dwordx4 v[16:19], v1, s[4:7], s51 offen offset:0 sc1
  buffer_store_dwordx4 v[16:19], v1, s[4:7], s51 offen offset:1024 sc1
  buffer_store_dwordx4 v[16:19], v1, s[4:7], s51 offen offset:2048 sc1
  buffer_store_dwordx4 v[16:19], v1, s[4:7], s51 offen offset:3072 sc1
  s_add_u32 s51, s34, 69818368
  buffer_store_dwordx4 v[16:19], v1, s[4:7], s51 offen offset:0 sc1
  buffer_store_dwordx4 v[16:19], v1, s[4:7], s51 offen offset:1024 sc1
  buffer_store_dwordx4 v[16:19], v1, s[4:7], s51 offen offset:2048 sc1
  buffer_store_dwordx4 v[16:19], v1, s[4:7], s51 offen offset:3072 sc1
  s_add_u32 s51, s34, 69822464
  buffer_store_dwordx4 v[16:19], v1, s[4:7], s51 offen offset:0 sc1
  s_add_u32 s51, s35, 4212736
  buffer_store_dwordx4 v[16:19], v1, s[4:7], s51 offen offset:0 sc1
  buffer_store_dwordx4 v[16:19], v1, s[4:7], s51 offen offset:1024 sc1
  buffer_store_dwordx4 v[16:19], v1, s[4:7], s51 offen offset:2048 sc1
  buffer_store_dwordx4 v[16:19], v1, s[4:7], s51 offen offset:3072 sc1
  s_add_u32 s51, s35, 4216832
  buffer_store_dwordx4 v[16:19], v1, s[4:7], s51 offen offset:0 sc1
  buffer_store_dwordx4 v[16:19], v1, s[4:7], s51 offen offset:1024 sc1
  buffer_store_dwordx4 v[16:19], v1, s[4:7], s51 offen offset:2048 sc1
  buffer_store_dwordx4 v[16:19], v1, s[4:7], s51 offen offset:3072 sc1
  s_add_u32 s51, s35, 4220928
  buffer_store_dwordx4 v[16:19], v1, s[4:7], s51 offen offset:0 sc1
  s_add_u32 s51, s35, 7358464
  buffer_store_dwordx4 v[16:19], v1, s[4:7], s51 offen offset:0 sc1
  buffer_store_dwordx4 v[16:19], v1, s[4:7], s51 offen offset:1024 sc1
  buffer_store_dwordx4 v[16:19], v1, s[4:7], s51 offen offset:2048 sc1
  buffer_store_dwordx4 v[16:19], v1, s[4:7], s51 offen offset:3072 sc1
  s_add_u32 s51, s35, 7362560
  buffer_store_dwordx4 v[16:19], v1, s[4:7], s51 offen offset:0 sc1
  buffer_store_dwordx4 v[16:19], v1, s[4:7], s51 offen offset:1024 sc1
  buffer_store_dwordx4 v[16:19], v1, s[4:7], s51 offen offset:2048 sc1
  buffer_store_dwordx4 v[16:19], v1, s[4:7], s51 offen offset:3072 sc1
  s_add_u32 s51, s35, 7366656
  buffer_store_dwordx4 v[16:19], v1, s[4:7], s51 offen offset:0 sc1
  s_cmp_lt_u32 s32, 104
  s_cbranch_scc1 L_nof_26
  s_mul_i32 s34, s43, 36864
  v_mov_b64 v[16:17], -1
  v_mov_b64 v[18:19], -1
  s_add_u32 s51, s34, 73943040
  buffer_store_dwordx4 v[16:19], v1, s[4:7], s51 offen offset:0 sc1
  buffer_store_dwordx4 v[16:19], v1, s[4:7], s51 offen offset:1024 sc1
  buffer_store_dwordx4 v[16:19], v1, s[4:7], s51 offen offset:2048 sc1
  buffer_store_dwordx4 v[16:19], v1, s[4:7], s51 offen offset:3072 sc1
  s_add_u32 s51, s34, 73947136
  buffer_store_dwordx4 v[16:19], v1, s[4:7], s51 offen offset:0 sc1
  buffer_store_dwordx4 v[16:19], v1, s[4:7], s51 offen offset:1024 sc1
  buffer_store_dwordx4 v[16:19], v1, s[4:7], s51 offen offset:2048 sc1
  buffer_store_dwordx4 v[16:19], v1, s[4:7], s51 offen offset:3072 sc1
  s_add_u32 s51, s34, 73951232
  buffer_store_dwordx4 v[16:19], v1, s[4:7], s51 offen offset:0 sc1
L_nof_26:
  s_waitcnt vmcnt(0)
  s_barrier
  s_cmp_lg_u32 s33, 0
  s_cbranch_scc1 L_meet_27
  v_mov_b32 v10, 1
  s_mov_b64 exec, 1
  buffer_atomic_add v10, off, s[8:11], 0 offset:24 sc0
  s_waitcnt vmcnt(0)
  v_readfirstlane_b32 s51, v10
  v_mov_b32 v10, 1
  s_cmp_lg_u32 s51, 63
  s_cbranch_scc1 L_cnt_28
  buffer_store_dword v10, off, s[8:11], 0 offset:144 sc1
L_cnt_28:
  s_mov_b64 exec, -1
L_ai_29:
  buffer_load_dword v10, off, s[8:11], 0 offset:4 sc1
  s_add_u32 s50, s50, 1
  s_cmp_ge_u32 s50, 262144
  s_waitcnt vmcnt(0)
  s_cbranch_scc1 L_ai_29_x
  v_cmp_ge_u32 vcc, 9, v10
  s_nop 0
  s_cbranch_vccnz L_ai_29
L_ai_29_x:
L_ai_30:
  buffer_load_dword v10, off, s[8:11], 0 offset:144 sc1
  s_add_u32 s50, s50, 1
  s_cmp_ge_u32 s50, 262144
  s_waitcnt vmcnt(0)
  s_cbranch_scc1 L_ai_30_x
  v_cmp_ge_u32 vcc, 0, v10
  s_nop 0
  s_cbranch_vccnz L_ai_30
L_ai_30_x:
L_meet_27:
  s_barrier
  s_mov_b32 s34, 152
  s_cmp_eq_u32 s44, 0
  s_cselect_b32 s39, 32, 16
  s_cmp_eq_u32 s44, 1
  s_cselect_b32 s34, 112, s34
  s_cmp_eq_u32 s44, 2
  s_cselect_b32 s34, 116, s34
  buffer_load_dword v10, off, s[8:11], s34 sc1
  s_waitcnt vmcnt(0)
  v_readfirstlane_b32 s34, v10
  s_nop 0
  s_cmp_ge_u32 s34, s39
  s_cselect_b32 s39, 1, 0
  s_cmp_ge_u32 s34, 32
  s_cselect_b32 s38, s39, 0
  s_sub_u32 s34, s44, 1
  s_cmp_lt_u32 s34, 2
  s_cselect_b32 s38, 0, s38
  s_mov_b32 s40, s44
  s_mov_b32 s42, 0
  s_mov_b32 s61, 0
  s_add_u32 s95, s40, 1
  s_cmp_ge_u32 s48, s95
  s_cbranch_scc1 L_ap_31_x
L_ap_31:
  s_load_dwordx4 s[96:99], s[4:5], s92 glc
  s_load_dwordx2 s[100:101], s[4:5], s93 glc
  s_add_u32 s50, s50, 1
  s_cmp_ge_u32 s50, 262144
  s_cbranch_scc1 L_ap_31_y
  s_waitcnt lgkmcnt(0)
  s_min_u32 s48, s96, s97
  s_min_u32 s48, s48, s98
  s_min_u32 s48, s48, s99
  s_min_u32 s48, s48, s100
  s_min_u32 s48, s48, s101
  s_cmp_lt_u32 s48, s95
  s_cbranch_scc1 L_ap_31
L_ap_31_y:
  s_waitcnt lgkmcnt(0)
L_ap_31_x:
  s_lshl_b32 s34, s40, 5
  s_lshl1_add_u32 s34, s43, s34
  s_add_u32 s34, s34, 1
  s_lshl_b32 s34, s34, 13
  s_add_u32 s51, s34, 18874368
  buffer_load_dwordx4 v[16:19], v1, s[4:7], s51 offen offset:0 sc1
  buffer_load_dwordx4 v[20:23], v1, s[4:7], s51 offen offset:1024 sc1
  buffer_load_dwordx4 v[24:27], v1, s[4:7], s51 offen offset:2048 sc1
  buffer_load_dwordx4 v[28:31], v1, s[4:7], s51 offen offset:3072 sc1
  s_add_u32 s51, s34, 35651584
  buffer_load_dwordx4 v[32:35], v1, s[4:7], s51 offen offset:0 sc1
  buffer_load_dwordx4 v[36:39], v1, s[4:7], s51 offen offset:1024 sc1
  buffer_load_dwordx4 v[40:43], v1, s[4:7], s51 offen offset:2048 sc1
  buffer_load_dwordx4 v[44:47], v1, s[4:7], s51 offen offset:3072 sc1
  s_add_u32 s51, s34, 52428800
  buffer_load_dwordx4 v[64:67], v1, s[4:7], s51 offen offset:0 sc1
  buffer_load_dwordx4 v[68:71], v1, s[4:7], s51 offen offset:1024 sc1
  buffer_load_dwordx4 v[72:75], v1, s[4:7], s51 offen offset:2048 sc1
  buffer_load_dwordx4 v[76:79], v1, s[4:7], s51 offen offset:3072 sc1
  s_add_u32 s51, s34, 52432896
  buffer_load_dwordx4 v[80:83], v1, s[4:7], s51 offen offset:0 sc1
  buffer_load_dwordx4 v[84:87], v1, s[4:7], s51 offen offset:1024 sc1
  buffer_load_dwordx4 v[88:91], v1, s[4:7], s51 offen offset:2048 sc1
  buffer_load_dwordx4 v[92:95], v1, s[4:7], s51 offen offset:3072 sc1
.p2align 5
L_att_l2:
  s_lshl_b32 s41, s40, 5
  s_lshl1_add_u32 s41, s43, s41
  s_add_u32 s41, s41, 1
  s_lshl_b32 s41, s41, 11
  s_bfe_u32 s60, s61, 0x10001
  s_and_b32 s34, s61, 1
  s_add_u32 s61, s61, 1
  s_lshl1_add_u32 s34, s44, s34
  s_mul_i32 s45, s34, 589824
  s_add_u32 s45, s45, 69206016
  v_mov_b32 v140, 0x3f803f80
  v_mov_b32 v141, 0x3f803f80
  v_mov_b64 v[142:143], v[140:141]
  v_mov_b64_e64 v[136:137], 0
  v_mov_b64_e64 v[138:139], 0
  v_mov_b64_e64 v[134:135], 0
  s_waitcnt vmcnt(0)
  v_mfma_f32_16x16x32_bf16 v[124:127], v[32:35], v[16:19], 0
  v_mfma_f32_16x16x32_bf16 v[124:127], v[36:39], v[20:23], v[124:127]
  v_mfma_f32_16x16x32_bf16 v[124:127], v[40:43], v[24:27], v[124:127]
  v_mfma_f32_16x16x32_bf16 v[124:127], v[44:47], v[28:31], v[124:127]
  v_mov_b32 v10, 0xff800000
  s_nop 6
  v_cndmask_b32 v124, v10, v124, s[52:53]
  v_cndmask_b32 v125, v10, v125, s[54:55]
  v_cndmask_b32 v126, v10, v126, s[56:57]
  v_cndmask_b32 v127, v10, v127, s[58:59]
  v_max3_f32 v12, v124, v125, v126
  v_max_f32 v12, v12, v127
  s_cmp_lt_u32 s40, 63
  s_cbranch_scc1 L_att_l2_ncp
  s_getpc_b64 s[96:97]
L_att_l2_pc:
  s_add_u32 s96, s96, L_att_l2_w0-L_att_l2_pc
  s_addc_u32 s97, s97, 0
  v_lshlrev_b32 v148, 2, v1
  v_mov_b32_e64 v149, s97
  v_add_co_u32 v148, vcc, s96, v148
  s_nop 1
  v_addc_co_u32 v149, vcc, 0, v149, vcc
  global_load_dword v150, v[148:149], off
L_att_l2_ncp:
  s_cmp_lt_u32 s40, 56
  s_addc_u32 s95, s40, 0
  s_cmp_eq_u32 s40, 63
  s_cselect_b32 s95, 62, s95
  s_cmp_ge_u32 s49, s95
  s_cbranch_scc1 L_ac_32_x
L_ac_32:
  s_load_dword s96, s[4:5], s94 glc
  s_add_u32 s50, s50, 1
  s_cmp_ge_u32 s50, 262144
  s_cbranch_scc1 L_ac_32_y
  s_waitcnt lgkmcnt(0)
  s_mov_b32 s49, s96
  s_cmp_lt_u32 s49, s95
  s_cbranch_scc1 L_ac_32
L_ac_32_y:
  s_waitcnt lgkmcnt(0)
L_ac_32_x:
L_att_k2:
  s_add_u32 s51, s41, 10485760
  buffer_load_dwordx4 v[96:99], v2, s[4:7], s51 offen offset:0 sc1
  buffer_load_dwordx4 v[100:103], v2, s[4:7], s51 offen offset:512 sc1
  buffer_load_dwordx4 v[104:107], v2, s[4:7], s51 offen offset:1024 sc1
  buffer_load_dwordx4 v[108:111], v2, s[4:7], s51 offen offset:1536 sc1
  s_add_u32 s51, s41, 14680064
  buffer_load_dwordx2 v[112:113], v3, s[4:7], s51 offen offset:0 sc1
  buffer_load_dwordx2 v[114:115], v3, s[4:7], s51 offen offset:512 sc1
  buffer_load_dwordx2 v[116:117], v3, s[4:7], s51 offen offset:1024 sc1
  buffer_load_dwordx2 v[118:119], v3, s[4:7], s51 offen offset:1536 sc1
  s_waitcnt vmcnt(7)
  v_mfma_f32_16x16x32_bf16 v[120:123], v[96:99], v[16:19], 0
  s_waitcnt vmcnt(6)
  v_mfma_f32_16x16x32_bf16 v[120:123], v[100:103], v[20:23], v[120:123]
  s_waitcnt vmcnt(5)
  v_mfma_f32_16x16x32_bf16 v[120:123], v[104:107], v[24:27], v[120:123]
  s_waitcnt vmcnt(4)
  v_mfma_f32_16x16x32_bf16 v[120:123], v[108:111], v[28:31], v[120:123]
  v_max3_u32 v10, v96, v100, v104
  s_waitcnt vmcnt(0)
  v_max3_u32 v10, v10, v108, v112
  v_max3_u32 v10, v10, v114, v116
  v_max_u32_e64 v10, v10, v118
  v_cmp_eq_u32_e64 vcc, -1, v10
  s_nop 0
  s_cbranch_vccz L_att_k2_x
  s_add_u32 s50, s50, 1
  s_cmp_ge_u32 s50, 262144
  s_cbranch_scc1 L_att_k2_x
  s_branch L_att_k2
L_att_k2_x:
  v_max3_f32 v12, v12, v120, v121
  v_mov_b32 v13, v12
  s_nop 1
  v_permlane32_swap_b32 v12, v13
  v_max_f32 v12, v12, v13
  v_mov_b32 v13, v12
  s_nop 1
  v_permlane16_swap_b32 v12, v13
  v_max_f32 v12, v12, v13
  v_mul_f32 v12, s47, v12
  v_fma_f32 v120, v120, s46, v12
  v_fma_f32 v121, v121, s46, v12
  v_fma_f32 v124, v124, s46, v12
  v_fma_f32 v125, v125, s46, v12
  v_fma_f32 v126, v126, s46, v12
  v_fma_f32 v127, v127, s46, v12
  v_exp_f32 v120, v120
  v_exp_f32 v121, v121
  v_exp_f32 v124, v124
  v_exp_f32_e64 v125, v125
  v_exp_f32_e64 v126, v126
  v_exp_f32_e64 v127, v127
  v_cvt_pk_bf16_f32 v132, v124, v125
  v_cvt_pk_bf16_f32 v133, v126, v127
  v_cvt_pk_bf16_f32 v136, v120, v121
  v_cvt_pk_bf16_f32 v139, v120, v121
  v_mfma_f32_16x16x32_bf16 v[144:147], v[140:143], v[132:135], 0
  v_mfma_f32_16x16x32_bf16 v[148:151], v[64:67], v[132:135], 0
  v_mfma_f32_16x16x32_bf16 v[152:155], v[68:71], v[132:135], 0
  v_mfma_f32_16x16x32_bf16 v[156:159], v[72:75], v[132:135], 0
  v_mfma_f32_16x16x32_bf16 v[160:163], v[76:79], v[132:135], 0
  v_mfma_f32_16x16x16_bf16 v[144:147], v[140:141], v[136:137], v[144:147]
  v_mfma_f32_16x16x32_bf16 v[164:167], v[80:83], v[132:135], 0
  v_mfma_f32_16x16x32_bf16 v[168:171], v[84:87], v[132:135], 0
  v_mfma_f32_16x16x32_bf16 v[172:175], v[88:91], v[132:135], 0
  v_mfma_f32_16x16x32_bf16 v[176:179], v[92:95], v[132:135], 0
  v_add_u32 v11, s42, v1
  v_mfma_f32_16x16x16_bf16 v[148:151], v[112:113], v[136:137], v[148:151]
  v_rcp_f32 v12, v144
  v_mfma_f32_16x16x16_bf16 v[152:155], v[112:113], v[138:139], v[152:155]
  v_mfma_f32_16x16x16_bf16 v[156:159], v[114:115], v[136:137], v[156:159]
  v_mfma_f32_16x16x16_bf16 v[160:163], v[114:115], v[138:139], v[160:163]
  v_mfma_f32_16x16x16_bf16 v[164:167], v[116:117], v[136:137], v[164:167]
  v_mfma_f32_16x16x16_bf16 v[168:171], v[116:117], v[138:139], v[168:171]
  v_mfma_f32_16x16x16_bf16 v[172:175], v[118:119], v[136:137], v[172:175]
  v_mfma_f32_16x16x16_bf16 v[176:179], v[118:119], v[138:139], v[176:179]
  v_pk_mul_f32 v[148:149], v[148:149], v[12:13] op_sel_hi:[1,0]
  v_pk_mul_f32 v[150:151], v[150:151], v[12:13] op_sel_hi:[1,0]
  v_pk_mul_f32 v[152:153], v[152:153], v[12:13] op_sel_hi:[1,0]
  v_pk_mul_f32 v[154:155], v[154:155], v[12:13] op_sel_hi:[1,0]
  v_cvt_pk_bf16_f32 v148, v148, v149
  v_cvt_pk_bf16_f32 v149, v150, v151
  v_cvt_pk_bf16_f32 v150, v152, v153
  v_cvt_pk_bf16_f32 v151, v154, v155
  ds_write_b128 v11, v[148:151] offset:8192
  v_pk_mul_f32 v[156:157], v[156:157], v[12:13] op_sel_hi:[1,0]
  v_pk_mul_f32 v[158:159], v[158:159], v[12:13] op_sel_hi:[1,0]
  v_pk_mul_f32 v[160:161], v[160:161], v[12:13] op_sel_hi:[1,0]
  v_pk_mul_f32 v[162:163], v[162:163], v[12:13] op_sel_hi:[1,0]
  v_cvt_pk_bf16_f32 v156, v156, v157
  v_cvt_pk_bf16_f32 v157, v158, v159
  v_cvt_pk_bf16_f32 v158, v160, v161
  v_cvt_pk_bf16_f32 v159, v162, v163
  ds_write_b128 v11, v[156:159] offset:9216
  v_pk_mul_f32 v[164:165], v[164:165], v[12:13] op_sel_hi:[1,0]
  v_pk_mul_f32 v[166:167], v[166:167], v[12:13] op_sel_hi:[1,0]
  v_pk_mul_f32 v[168:169], v[168:169], v[12:13] op_sel_hi:[1,0]
  v_pk_mul_f32 v[170:171], v[170:171], v[12:13] op_sel_hi:[1,0]
  v_cvt_pk_bf16_f32 v164, v164, v165
  v_cvt_pk_bf16_f32 v165, v166, v167
  v_cvt_pk_bf16_f32 v166, v168, v169
  v_cvt_pk_bf16_f32 v167, v170, v171
  ds_write_b128 v11, v[164:167] offset:10240
  v_pk_mul_f32 v[172:173], v[172:173], v[12:13] op_sel_hi:[1,0]
  v_pk_mul_f32 v[174:175], v[174:175], v[12:13] op_sel_hi:[1,0]
  v_pk_mul_f32 v[176:177], v[176:177], v[12:13] op_sel_hi:[1,0]
  v_pk_mul_f32 v[178:179], v[178:179], v[12:13] op_sel_hi:[1,0]
  v_cvt_pk_bf16_f32 v172, v172, v173
  v_cvt_pk_bf16_f32 v173, v174, v175
  v_cvt_pk_bf16_f32 v174, v176, v177
  v_cvt_pk_bf16_f32 v175, v178, v179
  ds_write_b128 v11, v[172:175] offset:11264
  s_waitcnt lgkmcnt(0)
  s_barrier
  s_cmp_eq_u32 s39, 0
  s_cbranch_scc1 L_att_l2_ws
  s_cmp_eq_u32 s40, 63
  s_cselect_b32 s34, s38, 0
  s_cmp_eq_u32 s34, 0
  s_cbranch_scc1 L_att_l2_wf
L_att_l2_w0:
  s_cmp_eq_u32 s44, 0
  s_cbranch_scc1 L_att_l2_wh
  ds_read_b128 v[148:151], v11 offset:0
  ds_read_b128 v[156:159], v11 offset:1024
  ds_read_b128 v[164:167], v11 offset:2048
  ds_read_b128 v[172:175], v11 offset:3072
  ds_read_b128 v[180:183], v11 offset:8192
  ds_read_b128 v[188:191], v11 offset:9216
  ds_read_b128 v[196:199], v11 offset:10240
  ds_read_b128 v[204:207], v11 offset:11264
  s_xor_b32 s42, s42, 0x4000
  s_add_u32 s51, s45, 294912
  s_mul_i32 s41, s40, 36864
  s_waitcnt lgkmcnt(7)
  v_mfma_f32_16x16x32_bf16 v[96:99], v[224:227], v[148:151], 0
  v_mfma_f32_16x16x32_bf16 v[100:103], a[0:3], v[148:151], 0
  s_waitcnt lgkmcnt(6)
  v_mfma_f32_16x16x32_bf16 v[96:99], v[228:231], v[156:159], v[96:99]
  v_mfma_f32_16x16x32_bf16 v[100:103], a[4:7], v[156:159], v[100:103]
  s_waitcnt lgkmcnt(5)
  v_mfma_f32_16x16x32_bf16 v[96:99], v[232:235], v[164:167], v[96:99]
  v_mfma_f32_16x16x32_bf16 v[100:103], a[8:11], v[164:167], v[100:103]
  buffer_load_dwordx2 v[48:49], v6, s[12:15], s41 offen offset:0
  s_waitcnt lgkmcnt(4)
  v_mfma_f32_16x16x32_bf16 v[96:99], v[236:239], v[172:175], v[96:99]
  v_mfma_f32_16x16x32_bf16 v[100:103], a[12:15], v[172:175], v[100:103]
  buffer_load_dwordx2 v[50:51], v6, s[12:15], s41 offen offset:128
  s_waitcnt lgkmcnt(3)
  v_mfma_f32_16x16x32_bf16 v[96:99], v[240:243], v[180:183], v[96:99]
  v_mfma_f32_16x16x32_bf16 v[100:103], a[16:19], v[180:183], v[100:103]
  buffer_load_dwordx2 v[52:53], v7, s[12:15], s41 offen offset:0
  s_waitcnt lgkmcnt(2)
  v_mfma_f32_16x16x32_bf16 v[96:99], v[244:247], v[188:191], v[96:99]
  v_mfma_f32_16x16x32_bf16 v[100:103], a[20:23], v[188:191], v[100:103]
  s_waitcnt lgkmcnt(1)
  v_mfma_f32_16x16x32_bf16 v[96:99], v[248:251], v[196:199], v[96:99]
  v_mfma_f32_16x16x32_bf16 v[100:103], a[24:27], v[196:199], v[100:103]
  s_waitcnt lgkmcnt(0)
  v_mfma_f32_16x16x32_bf16 v[96:99], v[252:255], v[204:207], v[96:99]
  v_mfma_f32_16x16x32_bf16 v[100:103], a[28:31], v[204:207], v[100:103]
  v_mfma_f32_16x16x32_bf16 v[112:115], a[32:35], v[148:151], 0
  v_mfma_f32_16x16x32_bf16 v[116:119], a[64:67], v[148:151], 0
  v_mfma_f32_16x16x32_bf16 v[112:115], a[36:39], v[156:159], v[112:115]
  v_cvt_pk_bf16_f32 v96, v96, v97
  v_cvt_pk_bf16_f32 v97, v98, v99
  v_mfma_f32_16x16x32_bf16 v[116:119], a[68:71], v[156:159], v[116:119]
  v_cvt_pk_bf16_f32 v98, v100, v101
  v_cvt_pk_bf16_f32 v99, v102, v103
  v_mfma_f32_16x16x32_bf16 v[112:115], a[40:43], v[164:167], v[112:115]
  v_bfi_b32 v96, 1, s60, v96
  v_bfi_b32 v98, 1, s60, v98
  buffer_store_dwordx4 v[96:99], v4, s[4:7], s45 offen offset:256
  v_mfma_f32_16x16x32_bf16 v[116:119], a[72:75], v[164:167], v[116:119]
  v_mfma_f32_16x16x32_bf16 v[112:115], a[44:47], v[172:175], v[112:115]
  v_mfma_f32_16x16x32_bf16 v[116:119], a[76:79], v[172:175], v[116:119]
  v_mfma_f32_16x16x32_bf16 v[112:115], a[48:51], v[180:183], v[112:115]
  v_mfma_f32_16x16x32_bf16 v[116:119], a[80:83], v[180:183], v[116:119]
  v_mfma_f32_16x16x32_bf16 v[112:115], a[52:55], v[188:191], v[112:115]
  v_mfma_f32_16x16x32_bf16 v[116:119], a[84:87], v[188:191], v[116:119]
  v_mfma_f32_16x16x32_bf16 v[112:115], a[56:59], v[196:199], v[112:115]
  v_mfma_f32_16x16x32_bf16 v[116:119], a[88:91], v[196:199], v[116:119]
  v_mfma_f32_16x16x32_bf16 v[112:115], a[60:63], v[204:207], v[112:115]
  v_mfma_f32_16x16x32_bf16 v[116:119], a[92:95], v[204:207], v[116:119]
  v_mfma_f32_16x16x32_bf16 v[96:99], a[96:99], v[148:151], 0
  v_mfma_f32_16x16x32_bf16 v[100:103], a[128:131], v[148:151], 0
  v_mfma_f32_16x16x32_bf16 v[96:99], a[100:103], v[156:159], v[96:99]
  v_cvt_pk_bf16_f32 v112, v112, v113
  v_cvt_pk_bf16_f32 v113, v114, v115
  v_mfma_f32_16x16x32_bf16 v[100:103], a[132:135], v[156:159], v[100:103]
  v_cvt_pk_bf16_f32 v114, v116, v117
  v_cvt_pk_bf16_f32 v115, v118, v119
  v_mfma_f32_16x16x32_bf16 v[96:99], a[104:107], v[164:167], v[96:99]
  v_bfi_b32 v112, 1, s60, v112
  v_bfi_b32 v114, 1, s60, v114
  buffer_store_dwordx4 v[112:115], v4, s[4:7], s45 offen offset:768
  v_mfma_f32_16x16x32_bf16 v[100:103], a[136:139], v[164:167], v[100:103]
  v_mfma_f32_16x16x32_bf16 v[96:99], a[108:111], v[172:175], v[96:99]
  v_mfma_f32_16x16x32_bf16 v[100:103], a[140:143], v[172:175], v[100:103]
  v_mfma_f32_16x16x32_bf16 v[96:99], a[112:115], v[180:183], v[96:99]
  v_mfma_f32_16x16x32_bf16 v[100:103], a[144:147], v[180:183], v[100:103]
  v_mfma_f32_16x16x32_bf16 v[96:99], a[116:119], v[188:191], v[96:99]
  v_mfma_f32_16x16x32_bf16 v[100:103], a[148:151], v[188:191], v[100:103]
  v_mfma_f32_16x16x32_bf16 v[96:99], a[120:123], v[196:199], v[96:99]
  v_mfma_f32_16x16x32_bf16 v[100:103], a[152:155], v[196:199], v[100:103]
  v_mfma_f32_16x16x32_bf16 v[96:99], a[124:127], v[204:207], v[96:99]
  v_mfma_f32_16x16x32_bf16 v[100:103], a[156:159], v[204:207], v[100:103]
  v_mfma_f32_16x16x32_bf16 v[112:115], a[160:163], v[148:151], 0
  v_mfma_f32_16x16x32_bf16 v[116:119], a[192:195], v[148:151], 0
  v_mfma_f32_16x16x32_bf16 v[112:115], a[164:167], v[156:159], v[112:115]
  v_cvt_pk_bf16_f32 v96, v96, v97
  v_cvt_pk_bf16_f32 v97, v98, v99
  v_mfma_f32_16x16x32_bf16 v[116:119], a[196:199], v[156:159], v[116:119]
  v_cvt_pk_bf16_f32 v98, v100, v101
  v_cvt_pk_bf16_f32 v99, v102, v103
  v_mfma_f32_16x16x32_bf16 v[112:115], a[168:171], v[164:167], v[112:115]
  v_bfi_b32 v96, 1, s60, v96
  v_bfi_b32 v98, 1, s60, v98
  buffer_store_dwordx4 v[96:99], v4, s[4:7], s45 offen offset:1280
  v_mfma_f32_16x16x32_bf16 v[116:119], a[200:203], v[164:167], v[116:119]
  v_mfma_f32_16x16x32_bf16 v[112:115], a[172:175], v[172:175], v[112:115]
  v_mfma_f32_16x16x32_bf16 v[116:119], a[204:207], v[172:175], v[116:119]
  v_mfma_f32_16x16x32_bf16 v[112:115], a[176:179], v[180:183], v[112:115]
  v_mfma_f32_16x16x32_bf16 v[116:119], a[208:211], v[180:183], v[116:119]
  v_mfma_f32_16x16x32_bf16 v[112:115], a[180:183], v[188:191], v[112:115]
  v_mfma_f32_16x16x32_bf16 v[116:119], a[212:215], v[188:191], v[116:119]
  v_mfma_f32_16x16x32_bf16 v[112:115], a[184:187], v[196:199], v[112:115]
  v_mfma_f32_16x16x32_bf16 v[116:119], a[216:219], v[196:199], v[116:119]
  v_mfma_f32_16x16x32_bf16 v[112:115], a[188:191], v[204:207], v[112:115]
  v_mfma_f32_16x16x32_bf16 v[116:119], a[220:223], v[204:207], v[116:119]
  v_mfma_f32_16x16x32_bf16 v[96:99], a[224:227], v[148:151], 0
  v_mfma_f32_16x16x32_bf16 v[96:99], a[228:231], v[156:159], v[96:99]
  v_mfma_f32_16x16x32_bf16 v[96:99], a[232:235], v[164:167], v[96:99]
  v_cvt_pk_bf16_f32 v112, v112, v113
  v_cvt_pk_bf16_f32 v113, v114, v115
  v_mfma_f32_16x16x32_bf16 v[96:99], a[236:239], v[172:175], v[96:99]
  v_cvt_pk_bf16_f32 v114, v116, v117
  v_cvt_pk_bf16_f32 v115, v118, v119
  v_mfma_f32_16x16x32_bf16 v[96:99], a[240:243], v[180:183], v[96:99]
  v_bfi_b32 v112, 1, s60, v112
  v_bfi_b32 v114, 1, s60, v114
  buffer_store_dwordx4 v[112:115], v4, s[4:7], s45 offen offset:1792
  v_mfma_f32_16x16x32_bf16 v[96:99], a[244:247], v[188:191], v[96:99]
  v_mfma_f32_16x16x32_bf16 v[96:99], a[248:251], v[196:199], v[96:99]
  v_mfma_f32_16x16x32_bf16 v[96:99], a[252:255], v[204:207], v[96:99]
  s_nop 7
  v_cvt_pk_bf16_f32 v96, v96, v97
  v_cvt_pk_bf16_f32 v97, v98, v99
  v_bfi_b32 v96, 1, s60, v96
  buffer_store_dwordx2 v[96:97], v4, s[4:7], s45 offen offset:2176
  s_cmp_ge_u32 s43, 8
  s_cselect_b32 s45, 73924608, s45
  s_cselect_b32 s60, 0, s60
  s_branch L_att_l2_wx
L_att_l2_wh:
  s_mov_b32 s45, 73924608
  s_mov_b32 s60, 0
  ds_read_b128 v[152:155], v11 offset:4096
  ds_read_b128 v[160:163], v11 offset:5120
  ds_read_b128 v[168:171], v11 offset:6144
  ds_read_b128 v[176:179], v11 offset:7168
  ds_read_b128 v[184:187], v11 offset:12288
  ds_read_b128 v[192:195], v11 offset:13312
  ds_read_b128 v[200:203], v11 offset:14336
  ds_read_b128 v[208:211], v11 offset:15360
  s_xor_b32 s42, s42, 0x4000
  s_add_u32 s51, s45, 294912
  s_mul_i32 s41, s40, 36864
  s_waitcnt lgkmcnt(7)
  v_mfma_f32_16x16x32_bf16 v[104:107], v[224:227], v[152:155], 0
  v_mfma_f32_16x16x32_bf16 v[108:111], a[0:3], v[152:155], 0
  s_waitcnt lgkmcnt(6)
  v_mfma_f32_16x16x32_bf16 v[104:107], v[228:231], v[160:163], v[104:107]
  v_mfma_f32_16x16x32_bf16 v[108:111], a[4:7], v[160:163], v[108:111]
  s_waitcnt lgkmcnt(5)
  v_mfma_f32_16x16x32_bf16 v[104:107], v[232:235], v[168:171], v[104:107]
  v_mfma_f32_16x16x32_bf16 v[108:111], a[8:11], v[168:171], v[108:111]
  s_waitcnt lgkmcnt(4)
  v_mfma_f32_16x16x32_bf16 v[104:107], v[236:239], v[176:179], v[104:107]
  v_mfma_f32_16x16x32_bf16 v[108:111], a[12:15], v[176:179], v[108:111]
  s_waitcnt lgkmcnt(3)
  v_mfma_f32_16x16x32_bf16 v[104:107], v[240:243], v[184:187], v[104:107]
  v_mfma_f32_16x16x32_bf16 v[108:111], a[16:19], v[184:187], v[108:111]
  s_waitcnt lgkmcnt(2)
  v_mfma_f32_16x16x32_bf16 v[104:107], v[244:247], v[192:195], v[104:107]
  v_mfma_f32_16x16x32_bf16 v[108:111], a[20:23], v[192:195], v[108:111]
  s_waitcnt lgkmcnt(1)
  v_mfma_f32_16x16x32_bf16 v[104:107], v[248:251], v[200:203], v[104:107]
  v_mfma_f32_16x16x32_bf16 v[108:111], a[24:27], v[200:203], v[108:111]
  s_waitcnt lgkmcnt(0)
  v_mfma_f32_16x16x32_bf16 v[104:107], v[252:255], v[208:211], v[104:107]
  v_mfma_f32_16x16x32_bf16 v[108:111], a[28:31], v[208:211], v[108:111]
  v_mfma_f32_16x16x32_bf16 v[120:123], a[32:35], v[152:155], 0
  v_mfma_f32_16x16x32_bf16 v[124:127], a[64:67], v[152:155], 0
  v_mfma_f32_16x16x32_bf16 v[120:123], a[36:39], v[160:163], v[120:123]
  v_cvt_pk_bf16_f32 v104, v104, v105
  v_cvt_pk_bf16_f32 v105, v106, v107
  v_mfma_f32_16x16x32_bf16 v[124:127], a[68:71], v[160:163], v[124:127]
  v_cvt_pk_bf16_f32 v106, v108, v109
  v_cvt_pk_bf16_f32 v107, v110, v111
  v_mfma_f32_16x16x32_bf16 v[120:123], a[40:43], v[168:171], v[120:123]
  v_bfi_b32 v104, 1, s60, v104
  v_bfi_b32 v106, 1, s60, v106
  buffer_store_dwordx4 v[104:107], v4, s[4:7], s51 offen offset:256
  v_mfma_f32_16x16x32_bf16 v[124:127], a[72:75], v[168:171], v[124:127]
  v_mfma_f32_16x16x32_bf16 v[120:123], a[44:47], v[176:179], v[120:123]
  v_mfma_f32_16x16x32_bf16 v[124:127], a[76:79], v[176:179], v[124:127]
  v_mfma_f32_16x16x32_bf16 v[120:123], a[48:51], v[184:187], v[120:123]
  v_mfma_f32_16x16x32_bf16 v[124:127], a[80:83], v[184:187], v[124:127]
  v_mfma_f32_16x16x32_bf16 v[120:123], a[52:55], v[192:195], v[120:123]
  v_mfma_f32_16x16x32_bf16 v[124:127], a[84:87], v[192:195], v[124:127]
  v_mfma_f32_16x16x32_bf16 v[120:123], a[56:59], v[200:203], v[120:123]
  v_mfma_f32_16x16x32_bf16 v[124:127], a[88:91], v[200:203], v[124:127]
  v_mfma_f32_16x16x32_bf16 v[120:123], a[60:63], v[208:211], v[120:123]
  v_mfma_f32_16x16x32_bf16 v[124:127], a[92:95], v[208:211], v[124:127]
  v_mfma_f32_16x16x32_bf16 v[104:107], a[96:99], v[152:155], 0
  v_mfma_f32_16x16x32_bf16 v[108:111], a[128:131], v[152:155], 0
  v_mfma_f32_16x16x32_bf16 v[104:107], a[100:103], v[160:163], v[104:107]
  v_cvt_pk_bf16_f32 v120, v120, v121
  v_cvt_pk_bf16_f32 v121, v122, v123
  v_mfma_f32_16x16x32_bf16 v[108:111], a[132:135], v[160:163], v[108:111]
  v_cvt_pk_bf16_f32 v122, v124, v125
  v_cvt_pk_bf16_f32 v123, v126, v127
  v_mfma_f32_16x16x32_bf16 v[104:107], a[104:107], v[168:171], v[104:107]
  v_bfi_b32 v120, 1, s60, v120
  v_bfi_b32 v122, 1, s60, v122
  buffer_store_dwordx4 v[120:123], v4, s[4:7], s51 offen offset:768
  v_mfma_f32_16x16x32_bf16 v[108:111], a[136:139], v[168:171], v[108:111]
  v_mfma_f32_16x16x32_bf16 v[104:107], a[108:111], v[176:179], v[104:107]
  v_mfma_f32_16x16x32_bf16 v[108:111], a[140:143], v[176:179], v[108:111]
  v_mfma_f32_16x16x32_bf16 v[104:107], a[112:115], v[184:187], v[104:107]
  v_mfma_f32_16x16x32_bf16 v[108:111], a[144:147], v[184:187], v[108:111]
  v_mfma_f32_16x16x32_bf16 v[104:107], a[116:119], v[192:195], v[104:107]
  v_mfma_f32_16x16x32_bf16 v[108:111], a[148:151], v[192:195], v[108:111]
  v_mfma_f32_16x16x32_bf16 v[104:107], a[120:123], v[200:203], v[104:107]
  v_mfma_f32_16x16x32_bf16 v[108:111], a[152:155], v[200:203], v[108:111]
  v_mfma_f32_16x16x32_bf16 v[104:107], a[124:127], v[208:211], v[104:107]
  v_mfma_f32_16x16x32_bf16 v[108:111], a[156:159], v[208:211], v[108:111]
  v_mfma_f32_16x16x32_bf16 v[120:123], a[160:163], v[152:155], 0
  v_mfma_f32_16x16x32_bf16 v[124:127], a[192:195], v[152:155], 0
  v_mfma_f32_16x16x32_bf16 v[120:123], a[164:167], v[160:163], v[120:123]
  v_cvt_pk_bf16_f32 v104, v104, v105
  v_cvt_pk_bf16_f32 v105, v106, v107
  v_mfma_f32_16x16x32_bf16 v[124:127], a[196:199], v[160:163], v[124:127]
  v_cvt_pk_bf16_f32 v106, v108, v109
  v_cvt_pk_bf16_f32 v107, v110, v111
  v_mfma_f32_16x16x32_bf16 v[120:123], a[168:171], v[168:171], v[120:123]
  v_bfi_b32 v104, 1, s60, v104
  v_bfi_b32 v106, 1, s60, v106
  buffer_store_dwordx4 v[104:107], v4, s[4:7], s51 offen offset:1280
  v_mfma_f32_16x16x32_bf16 v[124:127], a[200:203], v[168:171], v[124:127]
  v_mfma_f32_16x16x32_bf16 v[120:123], a[172:175], v[176:179], v[120:123]
  v_mfma_f32_16x16x32_bf16 v[124:127], a[204:207], v[176:179], v[124:127]
  v_mfma_f32_16x16x32_bf16 v[120:123], a[176:179], v[184:187], v[120:123]
  v_mfma_f32_16x16x32_bf16 v[124:127], a[208:211], v[184:187], v[124:127]
  v_mfma_f32_16x16x32_bf16 v[120:123], a[180:183], v[192:195], v[120:123]
  v_mfma_f32_16x16x32_bf16 v[124:127], a[212:215], v[192:195], v[124:127]
  v_mfma_f32_16x16x32_bf16 v[120:123], a[184:187], v[200:203], v[120:123]
  v_mfma_f32_16x16x32_bf16 v[124:127], a[216:219], v[200:203], v[124:127]
  v_mfma_f32_16x16x32_bf16 v[120:123], a[188:191], v[208:211], v[120:123]
  v_mfma_f32_16x16x32_bf16 v[124:127], a[220:223], v[208:211], v[124:127]
  v_mfma_f32_16x16x32_bf16 v[104:107], a[224:227], v[152:155], 0
  v_mfma_f32_16x16x32_bf16 v[104:107], a[228:231], v[160:163], v[104:107]
  v_mfma_f32_16x16x32_bf16 v[104:107], a[232:235], v[168:171], v[104:107]
  v_cvt_pk_bf16_f32 v120, v120, v121
  v_cvt_pk_bf16_f32 v121, v122, v123
  v_mfma_f32_16x16x32_bf16 v[104:107], a[236:239], v[176:179], v[104:107]
  v_cvt_pk_bf16_f32 v122, v124, v125
  v_cvt_pk_bf16_f32 v123, v126, v127
  v_mfma_f32_16x16x32_bf16 v[104:107], a[240:243], v[184:187], v[104:107]
  v_bfi_b32 v120, 1, s60, v120
  v_bfi_b32 v122, 1, s60, v122
  buffer_store_dwordx4 v[120:123], v4, s[4:7], s51 offen offset:1792
  v_mfma_f32_16x16x32_bf16 v[104:107], a[244:247], v[192:195], v[104:107]
  v_mfma_f32_16x16x32_bf16 v[104:107], a[248:251], v[200:203], v[104:107]
  v_mfma_f32_16x16x32_bf16 v[104:107], a[252:255], v[208:211], v[104:107]
  s_nop 7
  v_cvt_pk_bf16_f32 v104, v104, v105
  v_cvt_pk_bf16_f32 v105, v106, v107
  v_bfi_b32 v104, 1, s60, v104
  buffer_store_dwordx2 v[104:105], v4, s[4:7], s51 offen offset:2176
  s_branch L_att_l2_end
L_att_l2_wf:
  ds_read_b128 v[148:151], v11 offset:0
  ds_read_b128 v[152:155], v11 offset:4096
  ds_read_b128 v[156:159], v11 offset:1024
  ds_read_b128 v[160:163], v11 offset:5120
  ds_read_b128 v[164:167], v11 offset:2048
  ds_read_b128 v[168:171], v11 offset:6144
  ds_read_b128 v[172:175], v11 offset:3072
  ds_read_b128 v[176:179], v11 offset:7168
  ds_read_b128 v[180:183], v11 offset:8192
  ds_read_b128 v[184:187], v11 offset:12288
  ds_read_b128 v[188:191], v11 offset:9216
  ds_read_b128 v[192:195], v11 offset:13312
  ds_read_b128 v[196:199], v11 offset:10240
  ds_read_b128 v[200:203], v11 offset:14336
  ds_read_b128 v[204:207], v11 offset:11264
  ds_read_b128 v[208:211], v11 offset:15360
  s_xor_b32 s42, s42, 0x4000
  s_add_u32 s51, s45, 294912
  s_mul_i32 s41, s40, 36864
  s_waitcnt lgkmcnt(15)
  v_mfma_f32_16x16x32_bf16 v[96:99], v[224:227], v[148:151], 0
  v_mfma_f32_16x16x32_bf16 v[100:103], a[0:3], v[148:151], 0
  s_waitcnt lgkmcnt(14)
  v_mfma_f32_16x16x32_bf16 v[104:107], v[224:227], v[152:155], 0
  v_mfma_f32_16x16x32_bf16 v[108:111], a[0:3], v[152:155], 0
  s_waitcnt lgkmcnt(13)
  v_mfma_f32_16x16x32_bf16 v[96:99], v[228:231], v[156:159], v[96:99]
  v_mfma_f32_16x16x32_bf16 v[100:103], a[4:7], v[156:159], v[100:103]
  s_waitcnt lgkmcnt(12)
  v_mfma_f32_16x16x32_bf16 v[104:107], v[228:231], v[160:163], v[104:107]
  v_mfma_f32_16x16x32_bf16 v[108:111], a[4:7], v[160:163], v[108:111]
  s_waitcnt lgkmcnt(11)
  v_mfma_f32_16x16x32_bf16 v[96:99], v[232:235], v[164:167], v[96:99]
  v_mfma_f32_16x16x32_bf16 v[100:103], a[8:11], v[164:167], v[100:103]
  s_waitcnt lgkmcnt(10)
  v_mfma_f32_16x16x32_bf16 v[104:107], v[232:235], v[168:171], v[104:107]
  v_mfma_f32_16x16x32_bf16 v[108:111], a[8:11], v[168:171], v[108:111]
  buffer_load_dwordx2 v[48:49], v6, s[12:15], s41 offen offset:0
  s_waitcnt lgkmcnt(9)
  v_mfma_f32_16x16x32_bf16 v[96:99], v[236:239], v[172:175], v[96:99]
  v_mfma_f32_16x16x32_bf16 v[100:103], a[12:15], v[172:175], v[100:103]
  s_waitcnt lgkmcnt(8)
  v_mfma_f32_16x16x32_bf16 v[104:107], v[236:239], v[176:179], v[104:107]
  v_mfma_f32_16x16x32_bf16 v[108:111], a[12:15], v[176:179], v[108:111]
  buffer_load_dwordx2 v[50:51], v6, s[12:15], s41 offen offset:128
  s_waitcnt lgkmcnt(7)
  v_mfma_f32_16x16x32_bf16 v[96:99], v[240:243], v[180:183], v[96:99]
  v_mfma_f32_16x16x32_bf16 v[100:103], a[16:19], v[180:183], v[100:103]
  s_waitcnt lgkmcnt(6)
  v_mfma_f32_16x16x32_bf16 v[104:107], v[240:243], v[184:187], v[104:107]
  v_mfma_f32_16x16x32_bf16 v[108:111], a[16:19], v[184:187], v[108:111]
  buffer_load_dwordx2 v[52:53], v7, s[12:15], s41 offen offset:0
  s_waitcnt lgkmcnt(5)
  v_mfma_f32_16x16x32_bf16 v[96:99], v[244:247], v[188:191], v[96:99]
  v_mfma_f32_16x16x32_bf16 v[100:103], a[20:23], v[188:191], v[100:103]
  s_waitcnt lgkmcnt(4)
  v_mfma_f32_16x16x32_bf16 v[104:107], v[244:247], v[192:195], v[104:107]
  v_mfma_f32_16x16x32_bf16 v[108:111], a[20:23], v[192:195], v[108:111]
  s_waitcnt lgkmcnt(3)
  v_mfma_f32_16x16x32_bf16 v[96:99], v[248:251], v[196:199], v[96:99]
  v_mfma_f32_16x16x32_bf16 v[100:103], a[24:27], v[196:199], v[100:103]
  s_waitcnt lgkmcnt(2)
  v_mfma_f32_16x16x32_bf16 v[104:107], v[248:251], v[200:203], v[104:107]
  v_mfma_f32_16x16x32_bf16 v[108:111], a[24:27], v[200:203], v[108:111]
  s_waitcnt lgkmcnt(1)
  v_mfma_f32_16x16x32_bf16 v[96:99], v[252:255], v[204:207], v[96:99]
  v_mfma_f32_16x16x32_bf16 v[100:103], a[28:31], v[204:207], v[100:103]
  s_waitcnt lgkmcnt(0)
  v_mfma_f32_16x16x32_bf16 v[104:107], v[252:255], v[208:211], v[104:107]
  v_mfma_f32_16x16x32_bf16 v[108:111], a[28:31], v[208:211], v[108:111]
  v_mfma_f32_16x16x32_bf16 v[112:115], a[32:35], v[148:151], 0
  v_mfma_f32_16x16x32_bf16 v[116:119], a[64:67], v[148:151], 0
  v_mfma_f32_16x16x32_bf16 v[120:123], a[32:35], v[152:155], 0
  v_cvt_pk_bf16_f32 v96, v96, v97
  v_cvt_pk_bf16_f32 v97, v98, v99
  v_mfma_f32_16x16x32_bf16 v[124:127], a[64:67], v[152:155], 0
  v_cvt_pk_bf16_f32 v98, v100, v101
  v_cvt_pk_bf16_f32 v99, v102, v103
  v_mfma_f32_16x16x32_bf16 v[112:115], a[36:39], v[156:159], v[112:115]
  v_bfi_b32 v96, 1, s60, v96
  v_bfi_b32 v98, 1, s60, v98
  buffer_store_dwordx4 v[96:99], v4, s[4:7], s45 offen offset:256
  v_mfma_f32_16x16x32_bf16 v[116:119], a[68:71], v[156:159], v[116:119]
  v_cvt_pk_bf16_f32 v104, v104, v105
  v_cvt_pk_bf16_f32 v105, v106, v107
  v_mfma_f32_16x16x32_bf16 v[120:123], a[36:39], v[160:163], v[120:123]
  v_cvt_pk_bf16_f32 v106, v108, v109
  v_cvt_pk_bf16_f32 v107, v110, v111
  v_mfma_f32_16x16x32_bf16 v[124:127], a[68:71], v[160:163], v[124:127]
  v_bfi_b32 v104, 1, s60, v104
  v_bfi_b32 v106, 1, s60, v106
  buffer_store_dwordx4 v[104:107], v4, s[4:7], s51 offen offset:256
  v_mfma_f32_16x16x32_bf16 v[112:115], a[40:43], v[164:167], v[112:115]
  v_mfma_f32_16x16x32_bf16 v[116:119], a[72:75], v[164:167], v[116:119]
  v_mfma_f32_16x16x32_bf16 v[120:123], a[40:43], v[168:171], v[120:123]
  v_mfma_f32_16x16x32_bf16 v[124:127], a[72:75], v[168:171], v[124:127]
  v_mfma_f32_16x16x32_bf16 v[112:115], a[44:47], v[172:175], v[112:115]
  v_mfma_f32_16x16x32_bf16 v[116:119], a[76:79], v[172:175], v[116:119]
  v_mfma_f32_16x16x32_bf16 v[120:123], a[44:47], v[176:179], v[120:123]
  v_mfma_f32_16x16x32_bf16 v[124:127], a[76:79], v[176:179], v[124:127]
  v_mfma_f32_16x16x32_bf16 v[112:115], a[48:51], v[180:183], v[112:115]
  v_mfma_f32_16x16x32_bf16 v[116:119], a[80:83], v[180:183], v[116:119]
  v_mfma_f32_16x16x32_bf16 v[120:123], a[48:51], v[184:187], v[120:123]
  v_mfma_f32_16x16x32_bf16 v[124:127], a[80:83], v[184:187], v[124:127]
  v_mfma_f32_16x16x32_bf16 v[112:115], a[52:55], v[188:191], v[112:115]
  v_mfma_f32_16x16x32_bf16 v[116:119], a[84:87], v[188:191], v[116:119]
  v_mfma_f32_16x16x32_bf16 v[120:123], a[52:55], v[192:195], v[120:123]
  v_mfma_f32_16x16x32_bf16 v[124:127], a[84:87], v[192:195], v[124:127]
  v_mfma_f32_16x16x32_bf16 v[112:115], a[56:59], v[196:199], v[112:115]
  v_mfma_f32_16x16x32_bf16 v[116:119], a[88:91], v[196:199], v[116:119]
  v_mfma_f32_16x16x32_bf16 v[120:123], a[56:59], v[200:203], v[120:123]
  v_mfma_f32_16x16x32_bf16 v[124:127], a[88:91], v[200:203], v[124:127]
  v_mfma_f32_16x16x32_bf16 v[112:115], a[60:63], v[204:207], v[112:115]
  v_mfma_f32_16x16x32_bf16 v[116:119], a[92:95], v[204:207], v[116:119]
  v_mfma_f32_16x16x32_bf16 v[120:123], a[60:63], v[208:211], v[120:123]
  v_mfma_f32_16x16x32_bf16 v[124:127], a[92:95], v[208:211], v[124:127]
  v_mfma_f32_16x16x32_bf16 v[96:99], a[96:99], v[148:151], 0
  v_mfma_f32_16x16x32_bf16 v[100:103], a[128:131], v[148:151], 0
  v_mfma_f32_16x16x32_bf16 v[104:107], a[96:99], v[152:155], 0
  v_cvt_pk_bf16_f32 v112, v112, v113
  v_cvt_pk_bf16_f32 v113, v114, v115
  v_mfma_f32_16x16x32_bf16 v[108:111], a[128:131], v[152:155], 0
  v_cvt_pk_bf16_f32 v114, v116, v117
  v_cvt_pk_bf16_f32 v115, v118, v119
  v_mfma_f32_16x16x32_bf16 v[96:99], a[100:103], v[156:159], v[96:99]
  v_bfi_b32 v112, 1, s60, v112
  v_bfi_b32 v114, 1, s60, v114
  buffer_store_dwordx4 v[112:115], v4, s[4:7], s45 offen offset:768
  v_mfma_f32_16x16x32_bf16 v[100:103], a[132:135], v[156:159], v[100:103]
  v_cvt_pk_bf16_f32 v120, v120, v121
  v_cvt_pk_bf16_f32 v121, v122, v123
  v_mfma_f32_16x16x32_bf16 v[104:107], a[100:103], v[160:163], v[104:107]
  v_cvt_pk_bf16_f32 v122, v124, v125
  v_cvt_pk_bf16_f32 v123, v126, v127
  v_mfma_f32_16x16x32_bf16 v[108:111], a[132:135], v[160:163], v[108:111]
  v_bfi_b32 v120, 1, s60, v120
  v_bfi_b32 v122, 1, s60, v122
  buffer_store_dwordx4 v[120:123], v4, s[4:7], s51 offen offset:768
  v_mfma_f32_16x16x32_bf16 v[96:99], a[104:107], v[164:167], v[96:99]
  v_mfma_f32_16x16x32_bf16 v[100:103], a[136:139], v[164:167], v[100:103]
  v_mfma_f32_16x16x32_bf16 v[104:107], a[104:107], v[168:171], v[104:107]
  v_mfma_f32_16x16x32_bf16 v[108:111], a[136:139], v[168:171], v[108:111]
  v_mfma_f32_16x16x32_bf16 v[96:99], a[108:111], v[172:175], v[96:99]
  v_mfma_f32_16x16x32_bf16 v[100:103], a[140:143], v[172:175], v[100:103]
  v_mfma_f32_16x16x32_bf16 v[104:107], a[108:111], v[176:179], v[104:107]
  v_mfma_f32_16x16x32_bf16 v[108:111], a[140:143], v[176:179], v[108:111]
  v_mfma_f32_16x16x32_bf16 v[96:99], a[112:115], v[180:183], v[96:99]
  v_mfma_f32_16x16x32_bf16 v[100:103], a[144:147], v[180:183], v[100:103]
  v_mfma_f32_16x16x32_bf16 v[104:107], a[112:115], v[184:187], v[104:107]
  v_mfma_f32_16x16x32_bf16 v[108:111], a[144:147], v[184:187], v[108:111]
  v_mfma_f32_16x16x32_bf16 v[96:99], a[116:119], v[188:191], v[96:99]
  v_mfma_f32_16x16x32_bf16 v[100:103], a[148:151], v[188:191], v[100:103]
  v_mfma_f32_16x16x32_bf16 v[104:107], a[116:119], v[192:195], v[104:107]
  v_mfma_f32_16x16x32_bf16 v[108:111], a[148:151], v[192:195], v[108:111]
  v_mfma_f32_16x16x32_bf16 v[96:99], a[120:123], v[196:199], v[96:99]
  v_mfma_f32_16x16x32_bf16 v[100:103], a[152:155], v[196:199], v[100:103]
  v_mfma_f32_16x16x32_bf16 v[104:107], a[120:123], v[200:203], v[104:107]
  v_mfma_f32_16x16x32_bf16 v[108:111], a[152:155], v[200:203], v[108:111]
  v_mfma_f32_16x16x32_bf16 v[96:99], a[124:127], v[204:207], v[96:99]
  v_mfma_f32_16x16x32_bf16 v[100:103], a[156:159], v[204:207], v[100:103]
  v_mfma_f32_16x16x32_bf16 v[104:107], a[124:127], v[208:211], v[104:107]
  v_mfma_f32_16x16x32_bf16 v[108:111], a[156:159], v[208:211], v[108:111]
  v_mfma_f32_16x16x32_bf16 v[112:115], a[160:163], v[148:151], 0
  v_mfma_f32_16x16x32_bf16 v[116:119], a[192:195], v[148:151], 0
  v_mfma_f32_16x16x32_bf16 v[120:123], a[160:163], v[152:155], 0
  v_cvt_pk_bf16_f32 v96, v96, v97
  v_cvt_pk_bf16_f32 v97, v98, v99
  v_mfma_f32_16x16x32_bf16 v[124:127], a[192:195], v[152:155], 0
  v_cvt_pk_bf16_f32 v98, v100, v101
  v_cvt_pk_bf16_f32 v99, v102, v103
  v_mfma_f32_16x16x32_bf16 v[112:115], a[164:167], v[156:159], v[112:115]
  v_bfi_b32 v96, 1, s60, v96
  v_bfi_b32 v98, 1, s60, v98
  buffer_store_dwordx4 v[96:99], v4, s[4:7], s45 offen offset:1280
  v_mfma_f32_16x16x32_bf16 v[116:119], a[196:199], v[156:159], v[116:119]
  v_cvt_pk_bf16_f32 v104, v104, v105
  v_cvt_pk_bf16_f32 v105, v106, v107
  v_mfma_f32_16x16x32_bf16 v[120:123], a[164:167], v[160:163], v[120:123]
  v_cvt_pk_bf16_f32 v106, v108, v109
  v_cvt_pk_bf16_f32 v107, v110, v111
  v_mfma_f32_16x16x32_bf16 v[124:127], a[196:199], v[160:163], v[124:127]
  v_bfi_b32 v104, 1, s60, v104
  v_bfi_b32 v106, 1, s60, v106
  buffer_store_dwordx4 v[104:107], v4, s[4:7], s51 offen offset:1280
  v_mfma_f32_16x16x32_bf16 v[112:115], a[168:171], v[164:167], v[112:115]
  v_mfma_f32_16x16x32_bf16 v[116:119], a[200:203], v[164:167], v[116:119]
  v_mfma_f32_16x16x32_bf16 v[120:123], a[168:171], v[168:171], v[120:123]
  v_mfma_f32_16x16x32_bf16 v[124:127], a[200:203], v[168:171], v[124:127]
  v_mfma_f32_16x16x32_bf16 v[112:115], a[172:175], v[172:175], v[112:115]
  v_mfma_f32_16x16x32_bf16 v[116:119], a[204:207], v[172:175], v[116:119]
  v_mfma_f32_16x16x32_bf16 v[120:123], a[172:175], v[176:179], v[120:123]
  v_mfma_f32_16x16x32_bf16 v[124:127], a[204:207], v[176:179], v[124:127]
  v_mfma_f32_16x16x32_bf16 v[112:115], a[176:179], v[180:183], v[112:115]
  v_mfma_f32_16x16x32_bf16 v[116:119], a[208:211], v[180:183], v[116:119]
  v_mfma_f32_16x16x32_bf16 v[120:123], a[176:179], v[184:187], v[120:123]
  v_mfma_f32_16x16x32_bf16 v[124:127], a[208:211], v[184:187], v[124:127]
  v_mfma_f32_16x16x32_bf16 v[112:115], a[180:183], v[188:191], v[112:115]
  v_mfma_f32_16x16x32_bf16 v[116:119], a[212:215], v[188:191], v[116:119]
  v_mfma_f32_16x16x32_bf16 v[120:123], a[180:183], v[192:195], v[120:123]
  v_mfma_f32_16x16x32_bf16 v[124:127], a[212:215], v[192:195], v[124:127]
  v_mfma_f32_16x16x32_bf16 v[112:115], a[184:187], v[196:199], v[112:115]
  v_mfma_f32_16x16x32_bf16 v[116:119], a[216:219], v[196:199], v[116:119]
  v_mfma_f32_16x16x32_bf16 v[120:123], a[184:187], v[200:203], v[120:123]
  v_mfma_f32_16x16x32_bf16 v[124:127], a[216:219], v[200:203], v[124:127]
  v_mfma_f32_16x16x32_bf16 v[112:115], a[188:191], v[204:207], v[112:115]
  v_mfma_f32_16x16x32_bf16 v[116:119], a[220:223], v[204:207], v[116:119]
  v_mfma_f32_16x16x32_bf16 v[120:123], a[188:191], v[208:211], v[120:123]
  v_mfma_f32_16x16x32_bf16 v[124:127], a[220:223], v[208:211], v[124:127]
  v_mfma_f32_16x16x32_bf16 v[96:99], a[224:227], v[148:151], 0
  v_mfma_f32_16x16x32_bf16 v[104:107], a[224:227], v[152:155], 0
  v_mfma_f32_16x16x32_bf16 v[96:99], a[228:231], v[156:159], v[96:99]
  v_cvt_pk_bf16_f32 v112, v112, v113
  v_cvt_pk_bf16_f32 v113, v114, v115
  v_mfma_f32_16x16x32_bf16 v[104:107], a[228:231], v[160:163], v[104:107]
  v_cvt_pk_bf16_f32 v114, v116, v117
  v_cvt_pk_bf16_f32 v115, v118, v119
  v_mfma_f32_16x16x32_bf16 v[96:99], a[232:235], v[164:167], v[96:99]
  v_bfi_b32 v112, 1, s60, v112
  v_bfi_b32 v114, 1, s60, v114
  buffer_store_dwordx4 v[112:115], v4, s[4:7], s45 offen offset:1792
  v_mfma_f32_16x16x32_bf16 v[104:107], a[232:235], v[168:171], v[104:107]
  v_cvt_pk_bf16_f32 v120, v120, v121
  v_cvt_pk_bf16_f32 v121, v122, v123
  v_mfma_f32_16x16x32_bf16 v[96:99], a[236:239], v[172:175], v[96:99]
  v_cvt_pk_bf16_f32 v122, v124, v125
  v_cvt_pk_bf16_f32 v123, v126, v127
  v_mfma_f32_16x16x32_bf16 v[104:107], a[236:239], v[176:179], v[104:107]
  v_bfi_b32 v120, 1, s60, v120
  v_bfi_b32 v122, 1, s60, v122
  buffer_store_dwordx4 v[120:123], v4, s[4:7], s51 offen offset:1792
  v_mfma_f32_16x16x32_bf16 v[96:99], a[240:243], v[180:183], v[96:99]
  v_mfma_f32_16x16x32_bf16 v[104:107], a[240:243], v[184:187], v[104:107]
  v_mfma_f32_16x16x32_bf16 v[96:99], a[244:247], v[188:191], v[96:99]
  v_mfma_f32_16x16x32_bf16 v[104:107], a[244:247], v[192:195], v[104:107]
  v_mfma_f32_16x16x32_bf16 v[96:99], a[248:251], v[196:199], v[96:99]
  v_mfma_f32_16x16x32_bf16 v[104:107], a[248:251], v[200:203], v[104:107]
  v_mfma_f32_16x16x32_bf16 v[96:99], a[252:255], v[204:207], v[96:99]
  v_mfma_f32_16x16x32_bf16 v[104:107], a[252:255], v[208:211], v[104:107]
  s_nop 4
  v_cvt_pk_bf16_f32 v96, v96, v97
  v_cvt_pk_bf16_f32 v97, v98, v99
  v_bfi_b32 v96, 1, s60, v96
  buffer_store_dwordx2 v[96:97], v4, s[4:7], s45 offen offset:2176
  v_cvt_pk_bf16_f32 v104, v104, v105
  v_cvt_pk_bf16_f32 v105, v106, v107
  v_bfi_b32 v104, 1, s60, v104
  buffer_store_dwordx2 v[104:105], v4, s[4:7], s51 offen offset:2176
  s_branch L_att_l2_wx
L_att_l2_ws:
  ds_read_b128 v[148:151], v11 offset:0
  ds_read_b128 v[152:155], v11 offset:4096
  ds_read_b128 v[156:159], v11 offset:1024
  ds_read_b128 v[160:163], v11 offset:5120
  ds_read_b128 v[164:167], v11 offset:2048
  ds_read_b128 v[168:171], v11 offset:6144
  ds_read_b128 v[172:175], v11 offset:3072
  ds_read_b128 v[176:179], v11 offset:7168
  ds_read_b128 v[180:183], v11 offset:8192
  ds_read_b128 v[184:187], v11 offset:12288
  ds_read_b128 v[188:191], v11 offset:9216
  ds_read_b128 v[192:195], v11 offset:13312
  ds_read_b128 v[196:199], v11 offset:10240
  ds_read_b128 v[200:203], v11 offset:14336
  ds_read_b128 v[204:207], v11 offset:11264
  ds_read_b128 v[208:211], v11 offset:15360
  s_xor_b32 s42, s42, 0x4000
  s_add_u32 s51, s45, 294912
  s_mul_i32 s41, s40, 36864
  s_waitcnt lgkmcnt(15)
  v_mfma_f32_16x16x32_bf16 v[96:99], v[224:227], v[148:151], 0
  v_mfma_f32_16x16x32_bf16 v[100:103], a[0:3], v[148:151], 0
  s_waitcnt lgkmcnt(14)
  v_mfma_f32_16x16x32_bf16 v[104:107], v[224:227], v[152:155], 0
  v_mfma_f32_16x16x32_bf16 v[108:111], a[0:3], v[152:155], 0
  s_waitcnt lgkmcnt(13)
  v_mfma_f32_16x16x32_bf16 v[96:99], v[228:231], v[156:159], v[96:99]
  v_mfma_f32_16x16x32_bf16 v[100:103], a[4:7], v[156:159], v[100:103]
  s_waitcnt lgkmcnt(12)
  v_mfma_f32_16x16x32_bf16 v[104:107], v[228:231], v[160:163], v[104:107]
  v_mfma_f32_16x16x32_bf16 v[108:111], a[4:7], v[160:163], v[108:111]
  s_waitcnt lgkmcnt(11)
  v_mfma_f32_16x16x32_bf16 v[96:99], v[232:235], v[164:167], v[96:99]
  v_mfma_f32_16x16x32_bf16 v[100:103], a[8:11], v[164:167], v[100:103]
  s_waitcnt lgkmcnt(10)
  v_mfma_f32_16x16x32_bf16 v[104:107], v[232:235], v[168:171], v[104:107]
  v_mfma_f32_16x16x32_bf16 v[108:111], a[8:11], v[168:171], v[108:111]
  buffer_load_dwordx2 v[48:49], v6, s[12:15], s41 offen offset:0
  s_waitcnt lgkmcnt(9)
  v_mfma_f32_16x16x32_bf16 v[96:99], v[236:239], v[172:175], v[96:99]
  v_mfma_f32_16x16x32_bf16 v[100:103], a[12:15], v[172:175], v[100:103]
  s_waitcnt lgkmcnt(8)
  v_mfma_f32_16x16x32_bf16 v[104:107], v[236:239], v[176:179], v[104:107]
  v_mfma_f32_16x16x32_bf16 v[108:111], a[12:15], v[176:179], v[108:111]
  buffer_load_dwordx2 v[50:51], v6, s[12:15], s41 offen offset:128
  s_waitcnt lgkmcnt(7)
  v_mfma_f32_16x16x32_bf16 v[96:99], v[240:243], v[180:183], v[96:99]
  v_mfma_f32_16x16x32_bf16 v[100:103], a[16:19], v[180:183], v[100:103]
  s_waitcnt lgkmcnt(6)
  v_mfma_f32_16x16x32_bf16 v[104:107], v[240:243], v[184:187], v[104:107]
  v_mfma_f32_16x16x32_bf16 v[108:111], a[16:19], v[184:187], v[108:111]
  buffer_load_dwordx2 v[52:53], v7, s[12:15], s41 offen offset:0
  s_waitcnt lgkmcnt(5)
  v_mfma_f32_16x16x32_bf16 v[96:99], v[244:247], v[188:191], v[96:99]
  v_mfma_f32_16x16x32_bf16 v[100:103], a[20:23], v[188:191], v[100:103]
  s_waitcnt lgkmcnt(4)
  v_mfma_f32_16x16x32_bf16 v[104:107], v[244:247], v[192:195], v[104:107]
  v_mfma_f32_16x16x32_bf16 v[108:111], a[20:23], v[192:195], v[108:111]
  s_waitcnt lgkmcnt(3)
  v_mfma_f32_16x16x32_bf16 v[96:99], v[248:251], v[196:199], v[96:99]
  v_mfma_f32_16x16x32_bf16 v[100:103], a[24:27], v[196:199], v[100:103]
  s_waitcnt lgkmcnt(2)
  v_mfma_f32_16x16x32_bf16 v[104:107], v[248:251], v[200:203], v[104:107]
  v_mfma_f32_16x16x32_bf16 v[108:111], a[24:27], v[200:203], v[108:111]
  s_waitcnt lgkmcnt(1)
  v_mfma_f32_16x16x32_bf16 v[96:99], v[252:255], v[204:207], v[96:99]
  v_mfma_f32_16x16x32_bf16 v[100:103], a[28:31], v[204:207], v[100:103]
  s_waitcnt lgkmcnt(0)
  v_mfma_f32_16x16x32_bf16 v[104:107], v[252:255], v[208:211], v[104:107]
  v_mfma_f32_16x16x32_bf16 v[108:111], a[28:31], v[208:211], v[108:111]
  v_mfma_f32_16x16x32_bf16 v[112:115], a[32:35], v[148:151], 0
  v_mfma_f32_16x16x32_bf16 v[116:119], a[64:67], v[148:151], 0
  v_mfma_f32_16x16x32_bf16 v[120:123], a[32:35], v[152:155], 0
  v_cvt_pk_bf16_f32 v96, v96, v97
  v_cvt_pk_bf16_f32 v97, v98, v99
  v_mfma_f32_16x16x32_bf16 v[124:127], a[64:67], v[152:155], 0
  v_cvt_pk_bf16_f32 v98, v100, v101
  v_cvt_pk_bf16_f32 v99, v102, v103
  v_mfma_f32_16x16x32_bf16 v[112:115], a[36:39], v[156:159], v[112:115]
  v_bfi_b32 v96, 1, s60, v96
  v_bfi_b32 v98, 1, s60, v98
  buffer_store_dwordx4 v[96:99], v4, s[4:7], s45 offen offset:256 sc1
  v_mfma_f32_16x16x32_bf16 v[116:119], a[68:71], v[156:159], v[116:119]
  v_cvt_pk_bf16_f32 v104, v104, v105
  v_cvt_pk_bf16_f32 v105, v106, v107
  v_mfma_f32_16x16x32_bf16 v[120:123], a[36:39], v[160:163], v[120:123]
  v_cvt_pk_bf16_f32 v106, v108, v109
  v_cvt_pk_bf16_f32 v107, v110, v111
  v_mfma_f32_16x16x32_bf16 v[124:127], a[68:71], v[160:163], v[124:127]
  v_bfi_b32 v104, 1, s60, v104
  v_bfi_b32 v106, 1, s60, v106
  buffer_store_dwordx4 v[104:107], v4, s[4:7], s51 offen offset:256 sc1
  v_mfma_f32_16x16x32_bf16 v[112:115], a[40:43], v[164:167], v[112:115]
  v_mfma_f32_16x16x32_bf16 v[116:119], a[72:75], v[164:167], v[116:119]
  v_mfma_f32_16x16x32_bf16 v[120:123], a[40:43], v[168:171], v[120:123]
  v_mfma_f32_16x16x32_bf16 v[124:127], a[72:75], v[168:171], v[124:127]
  v_mfma_f32_16x16x32_bf16 v[112:115], a[44:47], v[172:175], v[112:115]
  v_mfma_f32_16x16x32_bf16 v[116:119], a[76:79], v[172:175], v[116:119]
  v_mfma_f32_16x16x32_bf16 v[120:123], a[44:47], v[176:179], v[120:123]
  v_mfma_f32_16x16x32_bf16 v[124:127], a[76:79], v[176:179], v[124:127]
  v_mfma_f32_16x16x32_bf16 v[112:115], a[48:51], v[180:183], v[112:115]
  v_mfma_f32_16x16x32_bf16 v[116:119], a[80:83], v[180:183], v[116:119]
  v_mfma_f32_16x16x32_bf16 v[120:123], a[48:51], v[184:187], v[120:123]
  v_mfma_f32_16x16x32_bf16 v[124:127], a[80:83], v[184:187], v[124:127]
  v_mfma_f32_16x16x32_bf16 v[112:115], a[52:55], v[188:191], v[112:115]
  v_mfma_f32_16x16x32_bf16 v[116:119], a[84:87], v[188:191], v[116:119]
  v_mfma_f32_16x16x32_bf16 v[120:123], a[52:55], v[192:195], v[120:123]
  v_mfma_f32_16x16x32_bf16 v[124:127], a[84:87], v[192:195], v[124:127]
  v_mfma_f32_16x16x32_bf16 v[112:115], a[56:59], v[196:199], v[112:115]
  v_mfma_f32_16x16x32_bf16 v[116:119], a[88:91], v[196:199], v[116:119]
  v_mfma_f32_16x16x32_bf16 v[120:123], a[56:59], v[200:203], v[120:123]
  v_mfma_f32_16x16x32_bf16 v[124:127], a[88:91], v[200:203], v[124:127]
  v_mfma_f32_16x16x32_bf16 v[112:115], a[60:63], v[204:207], v[112:115]
  v_mfma_f32_16x16x32_bf16 v[116:119], a[92:95], v[204:207], v[116:119]
  v_mfma_f32_16x16x32_bf16 v[120:123], a[60:63], v[208:211], v[120:123]
  v_mfma_f32_16x16x32_bf16 v[124:127], a[92:95], v[208:211], v[124:127]
  v_mfma_f32_16x16x32_bf16 v[96:99], a[96:99], v[148:151], 0
  v_mfma_f32_16x16x32_bf16 v[100:103], a[128:131], v[148:151], 0
  v_mfma_f32_16x16x32_bf16 v[104:107], a[96:99], v[152:155], 0
  v_cvt_pk_bf16_f32 v112, v112, v113
  v_cvt_pk_bf16_f32 v113, v114, v115
  v_mfma_f32_16x16x32_bf16 v[108:111], a[128:131], v[152:155], 0
  v_cvt_pk_bf16_f32 v114, v116, v117
  v_cvt_pk_bf16_f32 v115, v118, v119
  v_mfma_f32_16x16x32_bf16 v[96:99], a[100:103], v[156:159], v[96:99]
  v_bfi_b32 v112, 1, s60, v112
  v_bfi_b32 v114, 1, s60, v114
  buffer_store_dwordx4 v[112:115], v4, s[4:7], s45 offen offset:768 sc1
  v_mfma_f32_16x16x32_bf16 v[100:103], a[132:135], v[156:159], v[100:103]
  v_cvt_pk_bf16_f32 v120, v120, v121
  v_cvt_pk_bf16_f32 v121, v122, v123
  v_mfma_f32_16x16x32_bf16 v[104:107], a[100:103], v[160:163], v[104:107]
  v_cvt_pk_bf16_f32 v122, v124, v125
  v_cvt_pk_bf16_f32 v123, v126, v127
  v_mfma_f32_16x16x32_bf16 v[108:111], a[132:135], v[160:163], v[108:111]
  v_bfi_b32 v120, 1, s60, v120
  v_bfi_b32 v122, 1, s60, v122
  buffer_store_dwordx4 v[120:123], v4, s[4:7], s51 offen offset:768 sc1
  v_mfma_f32_16x16x32_bf16 v[96:99], a[104:107], v[164:167], v[96:99]
  v_mfma_f32_16x16x32_bf16 v[100:103], a[136:139], v[164:167], v[100:103]
  v_mfma_f32_16x16x32_bf16 v[104:107], a[104:107], v[168:171], v[104:107]
  v_mfma_f32_16x16x32_bf16 v[108:111], a[136:139], v[168:171], v[108:111]
  v_mfma_f32_16x16x32_bf16 v[96:99], a[108:111], v[172:175], v[96:99]
  v_mfma_f32_16x16x32_bf16 v[100:103], a[140:143], v[172:175], v[100:103]
  v_mfma_f32_16x16x32_bf16 v[104:107], a[108:111], v[176:179], v[104:107]
  v_mfma_f32_16x16x32_bf16 v[108:111], a[140:143], v[176:179], v[108:111]
  v_mfma_f32_16x16x32_bf16 v[96:99], a[112:115], v[180:183], v[96:99]
  v_mfma_f32_16x16x32_bf16 v[100:103], a[144:147], v[180:183], v[100:103]
  v_mfma_f32_16x16x32_bf16 v[104:107], a[112:115], v[184:187], v[104:107]
  v_mfma_f32_16x16x32_bf16 v[108:111], a[144:147], v[184:187], v[108:111]
  v_mfma_f32_16x16x32_bf16 v[96:99], a[116:119], v[188:191], v[96:99]
  v_mfma_f32_16x16x32_bf16 v[100:103], a[148:151], v[188:191], v[100:103]
  v_mfma_f32_16x16x32_bf16 v[104:107], a[116:119], v[192:195], v[104:107]
  v_mfma_f32_16x16x32_bf16 v[108:111], a[148:151], v[192:195], v[108:111]
  v_mfma_f32_16x16x32_bf16 v[96:99], a[120:123], v[196:199], v[96:99]
  v_mfma_f32_16x16x32_bf16 v[100:103], a[152:155], v[196:199], v[100:103]
  v_mfma_f32_16x16x32_bf16 v[104:107], a[120:123], v[200:203], v[104:107]
  v_mfma_f32_16x16x32_bf16 v[108:111], a[152:155], v[200:203], v[108:111]
  v_mfma_f32_16x16x32_bf16 v[96:99], a[124:127], v[204:207], v[96:99]
  v_mfma_f32_16x16x32_bf16 v[100:103], a[156:159], v[204:207], v[100:103]
  v_mfma_f32_16x16x32_bf16 v[104:107], a[124:127], v[208:211], v[104:107]
  v_mfma_f32_16x16x32_bf16 v[108:111], a[156:159], v[208:211], v[108:111]
  v_mfma_f32_16x16x32_bf16 v[112:115], a[160:163], v[148:151], 0
  v_mfma_f32_16x16x32_bf16 v[116:119], a[192:195], v[148:151], 0
  v_mfma_f32_16x16x32_bf16 v[120:123], a[160:163], v[152:155], 0
  v_cvt_pk_bf16_f32 v96, v96, v97
  v_cvt_pk_bf16_f32 v97, v98, v99
  v_mfma_f32_16x16x32_bf16 v[124:127], a[192:195], v[152:155], 0
  v_cvt_pk_bf16_f32 v98, v100, v101
  v_cvt_pk_bf16_f32 v99, v102, v103
  v_mfma_f32_16x16x32_bf16 v[112:115], a[164:167], v[156:159], v[112:115]
  v_bfi_b32 v96, 1, s60, v96
  v_bfi_b32 v98, 1, s60, v98
  buffer_store_dwordx4 v[96:99], v4, s[4:7], s45 offen offset:1280 sc1
  v_mfma_f32_16x16x32_bf16 v[116:119], a[196:199], v[156:159], v[116:119]
  v_cvt_pk_bf16_f32 v104, v104, v105
  v_cvt_pk_bf16_f32 v105, v106, v107
  v_mfma_f32_16x16x32_bf16 v[120:123], a[164:167], v[160:163], v[120:123]
  v_cvt_pk_bf16_f32 v106, v108, v109
  v_cvt_pk_bf16_f32 v107, v110, v111
  v_mfma_f32_16x16x32_bf16 v[124:127], a[196:199], v[160:163], v[124:127]
  v_bfi_b32 v104, 1, s60, v104
  v_bfi_b32 v106, 1, s60, v106
  buffer_store_dwordx4 v[104:107], v4, s[4:7], s51 offen offset:1280 sc1
  v_mfma_f32_16x16x32_bf16 v[112:115], a[168:171], v[164:167], v[112:115]
  v_mfma_f32_16x16x32_bf16 v[116:119], a[200:203], v[164:167], v[116:119]
  v_mfma_f32_16x16x32_bf16 v[120:123], a[168:171], v[168:171], v[120:123]
  v_mfma_f32_16x16x32_bf16 v[124:127], a[200:203], v[168:171], v[124:127]
  v_mfma_f32_16x16x32_bf16 v[112:115], a[172:175], v[172:175], v[112:115]
  v_mfma_f32_16x16x32_bf16 v[116:119], a[204:207], v[172:175], v[116:119]
  v_mfma_f32_16x16x32_bf16 v[120:123], a[172:175], v[176:179], v[120:123]
  v_mfma_f32_16x16x32_bf16 v[124:127], a[204:207], v[176:179], v[124:127]
  v_mfma_f32_16x16x32_bf16 v[112:115], a[176:179], v[180:183], v[112:115]
  v_mfma_f32_16x16x32_bf16 v[116:119], a[208:211], v[180:183], v[116:119]
  v_mfma_f32_16x16x32_bf16 v[120:123], a[176:179], v[184:187], v[120:123]
  v_mfma_f32_16x16x32_bf16 v[124:127], a[208:211], v[184:187], v[124:127]
  v_mfma_f32_16x16x32_bf16 v[112:115], a[180:183], v[188:191], v[112:115]
  v_mfma_f32_16x16x32_bf16 v[116:119], a[212:215], v[188:191], v[116:119]
  v_mfma_f32_16x16x32_bf16 v[120:123], a[180:183], v[192:195], v[120:123]
  v_mfma_f32_16x16x32_bf16 v[124:127], a[212:215], v[192:195], v[124:127]
  v_mfma_f32_16x16x32_bf16 v[112:115], a[184:187], v[196:199], v[112:115]
  v_mfma_f32_16x16x32_bf16 v[116:119], a[216:219], v[196:199], v[116:119]
  v_mfma_f32_16x16x32_bf16 v[120:123], a[184:187], v[200:203], v[120:123]
  v_mfma_f32_16x16x32_bf16 v[124:127], a[216:219], v[200:203], v[124:127]
  v_mfma_f32_16x16x32_bf16 v[112:115], a[188:191], v[204:207], v[112:115]
  v_mfma_f32_16x16x32_bf16 v[116:119], a[220:223], v[204:207], v[116:119]
  v_mfma_f32_16x16x32_bf16 v[120:123], a[188:191], v[208:211], v[120:123]
  v_mfma_f32_16x16x32_bf16 v[124:127], a[220:223], v[208:211], v[124:127]
  v_mfma_f32_16x16x32_bf16 v[96:99], a[224:227], v[148:151], 0
  v_mfma_f32_16x16x32_bf16 v[104:107], a[224:227], v[152:155], 0
  v_mfma_f32_16x16x32_bf16 v[96:99], a[228:231], v[156:159], v[96:99]
  v_cvt_pk_bf16_f32 v112, v112, v113
  v_cvt_pk_bf16_f32 v113, v114, v115
  v_mfma_f32_16x16x32_bf16 v[104:107], a[228:231], v[160:163], v[104:107]
  v_cvt_pk_bf16_f32 v114, v116, v117
  v_cvt_pk_bf16_f32 v115, v118, v119
  v_mfma_f32_16x16x32_bf16 v[96:99], a[232:235], v[164:167], v[96:99]
  v_bfi_b32 v112, 1, s60, v112
  v_bfi_b32 v114, 1, s60, v114
  buffer_store_dwordx4 v[112:115], v4, s[4:7], s45 offen offset:1792 sc1
  v_mfma_f32_16x16x32_bf16 v[104:107], a[232:235], v[168:171], v[104:107]
  v_cvt_pk_bf16_f32 v120, v120, v121
  v_cvt_pk_bf16_f32 v121, v122, v123
  v_mfma_f32_16x16x32_bf16 v[96:99], a[236:239], v[172:175], v[96:99]
  v_cvt_pk_bf16_f32 v122, v124, v125
  v_cvt_pk_bf16_f32 v123, v126, v127
  v_mfma_f32_16x16x32_bf16 v[104:107], a[236:239], v[176:179], v[104:107]
  v_bfi_b32 v120, 1, s60, v120
  v_bfi_b32 v122, 1, s60, v122
  buffer_store_dwordx4 v[120:123], v4, s[4:7], s51 offen offset:1792 sc1
  v_mfma_f32_16x16x32_bf16 v[96:99], a[240:243], v[180:183], v[96:99]
  v_mfma_f32_16x16x32_bf16 v[104:107], a[240:243], v[184:187], v[104:107]
  v_mfma_f32_16x16x32_bf16 v[96:99], a[244:247], v[188:191], v[96:99]
  v_mfma_f32_16x16x32_bf16 v[104:107], a[244:247], v[192:195], v[104:107]
  v_mfma_f32_16x16x32_bf16 v[96:99], a[248:251], v[196:199], v[96:99]
  v_mfma_f32_16x16x32_bf16 v[104:107], a[248:251], v[200:203], v[104:107]
  v_mfma_f32_16x16x32_bf16 v[96:99], a[252:255], v[204:207], v[96:99]
  v_mfma_f32_16x16x32_bf16 v[104:107], a[252:255], v[208:211], v[104:107]
  s_nop 4
  v_cvt_pk_bf16_f32 v96, v96, v97
  v_cvt_pk_bf16_f32 v97, v98, v99
  v_bfi_b32 v96, 1, s60, v96
  buffer_store_dwordx2 v[96:97], v4, s[4:7], s45 offen offset:2176 sc1
  v_cvt_pk_bf16_f32 v104, v104, v105
  v_cvt_pk_bf16_f32 v105, v106, v107
  v_bfi_b32 v104, 1, s60, v104
  buffer_store_dwordx2 v[104:105], v4, s[4:7], s51 offen offset:2176 sc1
L_att_l2_wx:
  s_add_u32 s51, s45, 0
  buffer_load_dwordx4 v[128:131], v5, s[4:7], s51 offen offset:0 sc1
  s_add_u32 s51, s45, 9216
  buffer_load_dwordx4 v[132:135], v5, s[4:7], s51 offen offset:0 sc1
  s_add_u32 s51, s45, 18432
  buffer_load_dwordx4 v[136:139], v5, s[4:7], s51 offen offset:0 sc1
  s_add_u32 s51, s45, 27648
  buffer_load_dwordx4 v[140:143], v5, s[4:7], s51 offen offset:0 sc1
  s_add_u32 s51, s45, 0
  buffer_load_dwordx4 v[144:147], v5, s[4:7], s51 offen offset:512 sc1
  s_add_u32 s51, s45, 9216
  buffer_load_dwordx4 v[148:151], v5, s[4:7], s51 offen offset:512 sc1
  s_add_u32 s51, s45, 18432
  buffer_load_dwordx4 v[152:155], v5, s[4:7], s51 offen offset:512 sc1
  s_add_u32 s51, s45, 27648
  buffer_load_dwordx4 v[156:159], v5, s[4:7], s51 offen offset:512 sc1
  s_add_u32 s51, s45, 0
  buffer_load_dwordx4 v[160:163], v5, s[4:7], s51 offen offset:1024 sc1
  s_add_u32 s51, s45, 9216
  buffer_load_dwordx4 v[164:167], v5, s[4:7], s51 offen offset:1024 sc1
  s_add_u32 s51, s45, 18432
  buffer_load_dwordx4 v[168:171], v5, s[4:7], s51 offen offset:1024 sc1
  s_add_u32 s51, s45, 27648
  buffer_load_dwordx4 v[172:175], v5, s[4:7], s51 offen offset:1024 sc1
  s_add_u32 s51, s45, 0
  buffer_load_dwordx4 v[176:179], v5, s[4:7], s51 offen offset:1536 sc1
  s_add_u32 s51, s45, 9216
  buffer_load_dwordx4 v[180:183], v5, s[4:7], s51 offen offset:1536 sc1
  s_add_u32 s51, s45, 18432
  buffer_load_dwordx4 v[184:187], v5, s[4:7], s51 offen offset:1536 sc1
  s_add_u32 s51, s45, 27648
  buffer_load_dwordx4 v[188:191], v5, s[4:7], s51 offen offset:1536 sc1
  s_add_u32 s51, s45, 0
  buffer_load_dwordx4 v[192:195], v8, s[4:7], s51 offen offset:2048 sc1
  s_add_u32 s51, s45, 9216
  buffer_load_dwordx4 v[196:199], v8, s[4:7], s51 offen offset:2048 sc1
  s_add_u32 s51, s45, 18432
  buffer_load_dwordx4 v[200:203], v8, s[4:7], s51 offen offset:2048 sc1
  s_add_u32 s51, s45, 27648
  buffer_load_dwordx4 v[204:207], v8, s[4:7], s51 offen offset:2048 sc1
L_att_r2_0:
  s_waitcnt vmcnt(16)
  v_bitop3_b32 v10, v128, v130, s60 bitop3:0x7e
  v_bitop3_b32 v11, v132, v134, s60 bitop3:0x7e
  v_bitop3_b32 v12, v136, v138, s60 bitop3:0x7e
  v_bitop3_b32 v13, v140, v142, s60 bitop3:0x7e
  v_or3_b32 v10, v10, v11, v12
  v_bitop3_b32 v10, v10, v13, 1 bitop3:0xa8
  v_cmp_eq_u32 vcc, 1, v10
  s_nop 0
  s_cbranch_vccz L_att_r2_0_x
  s_add_u32 s50, s50, 1
  s_cmp_ge_u32 s50, 262144
  s_cbranch_scc1 L_att_r2_0_x
  s_add_u32 s51, s45, 0
  buffer_load_dwordx4 v[128:131], v5, s[4:7], s51 offen offset:0 sc1
  s_add_u32 s51, s45, 9216
  buffer_load_dwordx4 v[132:135], v5, s[4:7], s51 offen offset:0 sc1
  s_add_u32 s51, s45, 18432
  buffer_load_dwordx4 v[136:139], v5, s[4:7], s51 offen offset:0 sc1
  s_add_u32 s51, s45, 27648
  buffer_load_dwordx4 v[140:143], v5, s[4:7], s51 offen offset:0 sc1
  s_add_u32 s51, s45, 0
  buffer_load_dwordx4 v[144:147], v5, s[4:7], s51 offen offset:512 sc1
  s_add_u32 s51, s45, 9216
  buffer_load_dwordx4 v[148:151], v5, s[4:7], s51 offen offset:512 sc1
  s_add_u32 s51, s45, 18432
  buffer_load_dwordx4 v[152:155], v5, s[4:7], s51 offen offset:512 sc1
  s_add_u32 s51, s45, 27648
  buffer_load_dwordx4 v[156:159], v5, s[4:7], s51 offen offset:512 sc1
  s_add_u32 s51, s45, 0
  buffer_load_dwordx4 v[160:163], v5, s[4:7], s51 offen offset:1024 sc1
  s_add_u32 s51, s45, 9216
  buffer_load_dwordx4 v[164:167], v5, s[4:7], s51 offen offset:1024 sc1
  s_add_u32 s51, s45, 18432
  buffer_load_dwordx4 v[168:171], v5, s[4:7], s51 offen offset:1024 sc1
  s_add_u32 s51, s45, 27648
  buffer_load_dwordx4 v[172:175], v5, s[4:7], s51 offen offset:1024 sc1
  s_add_u32 s51, s45, 0
  buffer_load_dwordx4 v[176:179], v5, s[4:7], s51 offen offset:1536 sc1
  s_add_u32 s51, s45, 9216
  buffer_load_dwordx4 v[180:183], v5, s[4:7], s51 offen offset:1536 sc1
  s_add_u32 s51, s45, 18432
  buffer_load_dwordx4 v[184:187], v5, s[4:7], s51 offen offset:1536 sc1
  s_add_u32 s51, s45, 27648
  buffer_load_dwordx4 v[188:191], v5, s[4:7], s51 offen offset:1536 sc1
  s_add_u32 s51, s45, 0
  buffer_load_dwordx4 v[192:195], v8, s[4:7], s51 offen offset:2048 sc1
  s_add_u32 s51, s45, 9216
  buffer_load_dwordx4 v[196:199], v8, s[4:7], s51 offen offset:2048 sc1
  s_add_u32 s51, s45, 18432
  buffer_load_dwordx4 v[200:203], v8, s[4:7], s51 offen offset:2048 sc1
  s_add_u32 s51, s45, 27648
  buffer_load_dwordx4 v[204:207], v8, s[4:7], s51 offen offset:2048 sc1
  s_branch L_att_r2_0
L_att_r2_0_x:
  v_lshlrev_b32 v96, 16, v48
  v_and_b32 v97, 0xffff0000, v48
  v_lshlrev_b32_e64 v98, 16, v49
  v_and_b32 v99, 0xffff0000, v49
  v_lshlrev_b32 v100, 16, v50
  v_and_b32 v101, 0xffff0000, v50
  v_lshlrev_b32 v102, 16, v51
  v_and_b32 v103, 0xffff0000, v51
  v_lshlrev_b32 v104, 16, v52
  v_and_b32 v105, 0xffff0000, v52
  v_lshlrev_b32_e64 v106, 16, v53
  v_and_b32 v107, 0xffff0000, v53
  v_mfma_f32_16x16x32_bf16 v[96:99], v[212:215], v[128:131], v[96:99]
  v_mfma_f32_16x16x32_bf16 v[96:99], v[212:215], v[132:135], v[96:99]
  v_mfma_f32_16x16x32_bf16 v[96:99], v[212:215], v[136:139], v[96:99]
  v_mfma_f32_16x16x32_bf16 v[96:99], v[212:215], v[140:143], v[96:99]
L_att_r2_1:
  s_waitcnt vmcnt(12)
  v_bitop3_b32 v10, v144, v146, s60 bitop3:0x7e
  v_bitop3_b32 v11, v148, v150, s60 bitop3:0x7e
  v_bitop3_b32 v12, v152, v154, s60 bitop3:0x7e
  v_bitop3_b32 v13, v156, v158, s60 bitop3:0x7e
  v_or3_b32 v10, v10, v11, v12
  v_bitop3_b32 v10, v10, v13, 1 bitop3:0xa8
  v_cmp_eq_u32 vcc, 1, v10
  s_nop 0
  s_cbranch_vccz L_att_r2_1_x
  s_add_u32 s50, s50, 1
  s_cmp_ge_u32 s50, 262144
  s_cbranch_scc1 L_att_r2_1_x
  s_add_u32 s51, s45, 0
  buffer_load_dwordx4 v[144:147], v5, s[4:7], s51 offen offset:512 sc1
  s_add_u32 s51, s45, 9216
  buffer_load_dwordx4 v[148:151], v5, s[4:7], s51 offen offset:512 sc1
  s_add_u32 s51, s45, 18432
  buffer_load_dwordx4 v[152:155], v5, s[4:7], s51 offen offset:512 sc1
  s_add_u32 s51, s45, 27648
  buffer_load_dwordx4 v[156:159], v5, s[4:7], s51 offen offset:512 sc1
  s_add_u32 s51, s45, 0
  buffer_load_dwordx4 v[160:163], v5, s[4:7], s51 offen offset:1024 sc1
  s_add_u32 s51, s45, 9216
  buffer_load_dwordx4 v[164:167], v5, s[4:7], s51 offen offset:1024 sc1
  s_add_u32 s51, s45, 18432
  buffer_load_dwordx4 v[168:171], v5, s[4:7], s51 offen offset:1024 sc1
  s_add_u32 s51, s45, 27648
  buffer_load_dwordx4 v[172:175], v5, s[4:7], s51 offen offset:1024 sc1
  s_add_u32 s51, s45, 0
  buffer_load_dwordx4 v[176:179], v5, s[4:7], s51 offen offset:1536 sc1
  s_add_u32 s51, s45, 9216
  buffer_load_dwordx4 v[180:183], v5, s[4:7], s51 offen offset:1536 sc1
  s_add_u32 s51, s45, 18432
  buffer_load_dwordx4 v[184:187], v5, s[4:7], s51 offen offset:1536 sc1
  s_add_u32 s51, s45, 27648
  buffer_load_dwordx4 v[188:191], v5, s[4:7], s51 offen offset:1536 sc1
  s_add_u32 s51, s45, 0
  buffer_load_dwordx4 v[192:195], v8, s[4:7], s51 offen offset:2048 sc1
  s_add_u32 s51, s45, 9216
  buffer_load_dwordx4 v[196:199], v8, s[4:7], s51 offen offset:2048 sc1
  s_add_u32 s51, s45, 18432
  buffer_load_dwordx4 v[200:203], v8, s[4:7], s51 offen offset:2048 sc1
  s_add_u32 s51, s45, 27648
  buffer_load_dwordx4 v[204:207], v8, s[4:7], s51 offen offset:2048 sc1
  s_branch L_att_r2_1
L_att_r2_1_x:
  v_mfma_f32_16x16x32_bf16 v[96:99], v[216:219], v[144:147], v[96:99]
  v_mfma_f32_16x16x32_bf16 v[96:99], v[216:219], v[148:151], v[96:99]
  v_mfma_f32_16x16x32_bf16 v[96:99], v[216:219], v[152:155], v[96:99]
  v_mfma_f32_16x16x32_bf16 v[96:99], v[216:219], v[156:159], v[96:99]
L_att_r2_2:
  s_waitcnt vmcnt(8)
  v_bitop3_b32 v10, v160, v162, s60 bitop3:0x7e
  v_bitop3_b32 v11, v164, v166, s60 bitop3:0x7e
  v_bitop3_b32 v12, v168, v170, s60 bitop3:0x7e
  v_bitop3_b32 v13, v172, v174, s60 bitop3:0x7e
  v_or3_b32 v10, v10, v11, v12
  v_bitop3_b32 v10, v10, v13, 1 bitop3:0xa8
  v_cmp_eq_u32 vcc, 1, v10
  s_nop 0
  s_cbranch_vccz L_att_r2_2_x
  s_add_u32 s50, s50, 1
  s_cmp_ge_u32 s50, 262144
  s_cbranch_scc1 L_att_r2_2_x
  s_add_u32 s51, s45, 0
  buffer_load_dwordx4 v[160:163], v5, s[4:7], s51 offen offset:1024 sc1
  s_add_u32 s51, s45, 9216
  buffer_load_dwordx4 v[164:167], v5, s[4:7], s51 offen offset:1024 sc1
  s_add_u32 s51, s45, 18432
  buffer_load_dwordx4 v[168:171], v5, s[4:7], s51 offen offset:1024 sc1
  s_add_u32 s51, s45, 27648
  buffer_load_dwordx4 v[172:175], v5, s[4:7], s51 offen offset:1024 sc1
  s_add_u32 s51, s45, 0
  buffer_load_dwordx4 v[176:179], v5, s[4:7], s51 offen offset:1536 sc1
  s_add_u32 s51, s45, 9216
  buffer_load_dwordx4 v[180:183], v5, s[4:7], s51 offen offset:1536 sc1
  s_add_u32 s51, s45, 18432
  buffer_load_dwordx4 v[184:187], v5, s[4:7], s51 offen offset:1536 sc1
  s_add_u32 s51, s45, 27648
  buffer_load_dwordx4 v[188:191], v5, s[4:7], s51 offen offset:1536 sc1
  s_add_u32 s51, s45, 0
  buffer_load_dwordx4 v[192:195], v8, s[4:7], s51 offen offset:2048 sc1
  s_add_u32 s51, s45, 9216
  buffer_load_dwordx4 v[196:199], v8, s[4:7], s51 offen offset:2048 sc1
  s_add_u32 s51, s45, 18432
  buffer_load_dwordx4 v[200:203], v8, s[4:7], s51 offen offset:2048 sc1
  s_add_u32 s51, s45, 27648
  buffer_load_dwordx4 v[204:207], v8, s[4:7], s51 offen offset:2048 sc1
  s_branch L_att_r2_2
L_att_r2_2_x:
  v_mfma_f32_16x16x32_bf16 v[100:103], v[212:215], v[160:163], v[100:103]
  v_mfma_f32_16x16x32_bf16 v[100:103], v[212:215], v[164:167], v[100:103]
  v_mfma_f32_16x16x32_bf16 v[100:103], v[212:215], v[168:171], v[100:103]
  v_mfma_f32_16x16x32_bf16 v[100:103], v[212:215], v[172:175], v[100:103]
L_att_r2_3:
  s_waitcnt vmcnt(4)
  v_bitop3_b32 v10, v176, v178, s60 bitop3:0x7e
  v_bitop3_b32 v11, v180, v182, s60 bitop3:0x7e
  v_bitop3_b32 v12, v184, v186, s60 bitop3:0x7e
  v_bitop3_b32 v13, v188, v190, s60 bitop3:0x7e
  v_or3_b32 v10, v10, v11, v12
  v_bitop3_b32 v10, v10, v13, 1 bitop3:0xa8
  v_cmp_eq_u32 vcc, 1, v10
  s_nop 0
  s_cbranch_vccz L_att_r2_3_x
  s_add_u32 s50, s50, 1
  s_cmp_ge_u32 s50, 262144
  s_cbranch_scc1 L_att_r2_3_x
  s_add_u32 s51, s45, 0
  buffer_load_dwordx4 v[176:179], v5, s[4:7], s51 offen offset:1536 sc1
  s_add_u32 s51, s45, 9216
  buffer_load_dwordx4 v[180:183], v5, s[4:7], s51 offen offset:1536 sc1
  s_add_u32 s51, s45, 18432
  buffer_load_dwordx4 v[184:187], v5, s[4:7], s51 offen offset:1536 sc1
  s_add_u32 s51, s45, 27648
  buffer_load_dwordx4 v[188:191], v5, s[4:7], s51 offen offset:1536 sc1
  s_add_u32 s51, s45, 0
  buffer_load_dwordx4 v[192:195], v8, s[4:7], s51 offen offset:2048 sc1
  s_add_u32 s51, s45, 9216
  buffer_load_dwordx4 v[196:199], v8, s[4:7], s51 offen offset:2048 sc1
  s_add_u32 s51, s45, 18432
  buffer_load_dwordx4 v[200:203], v8, s[4:7], s51 offen offset:2048 sc1
  s_add_u32 s51, s45, 27648
  buffer_load_dwordx4 v[204:207], v8, s[4:7], s51 offen offset:2048 sc1
  s_branch L_att_r2_3
L_att_r2_3_x:
  v_mfma_f32_16x16x32_bf16 v[100:103], v[216:219], v[176:179], v[100:103]
  v_mfma_f32_16x16x32_bf16 v[100:103], v[216:219], v[180:183], v[100:103]
  v_mfma_f32_16x16x32_bf16 v[100:103], v[216:219], v[184:187], v[100:103]
  v_mfma_f32_16x16x32_bf16 v[100:103], v[216:219], v[188:191], v[100:103]
L_att_r2_4:
  s_waitcnt vmcnt(0)
  v_bitop3_b32 v10, v192, v194, s60 bitop3:0x7e
  v_bitop3_b32 v11, v196, v198, s60 bitop3:0x7e
  v_bitop3_b32 v12, v200, v202, s60 bitop3:0x7e
  v_bitop3_b32 v13, v204, v206, s60 bitop3:0x7e
  v_or3_b32 v10, v10, v11, v12
  v_bitop3_b32 v10, v10, v13, 1 bitop3:0xa8
  v_cmp_eq_u32 vcc, 1, v10
  s_nop 0
  s_cbranch_vccz L_att_r2_4_x
  s_add_u32 s50, s50, 1
  s_cmp_ge_u32 s50, 262144
  s_cbranch_scc1 L_att_r2_4_x
  s_add_u32 s51, s45, 0
  buffer_load_dwordx4 v[192:195], v8, s[4:7], s51 offen offset:2048 sc1
  s_add_u32 s51, s45, 9216
  buffer_load_dwordx4 v[196:199], v8, s[4:7], s51 offen offset:2048 sc1
  s_add_u32 s51, s45, 18432
  buffer_load_dwordx4 v[200:203], v8, s[4:7], s51 offen offset:2048 sc1
  s_add_u32 s51, s45, 27648
  buffer_load_dwordx4 v[204:207], v8, s[4:7], s51 offen offset:2048 sc1
  s_branch L_att_r2_4
L_att_r2_4_x:
  v_mfma_f32_16x16x32_bf16 v[104:107], v[212:215], v[192:195], v[104:107]
  v_mfma_f32_16x16x32_bf16 v[104:107], v[212:215], v[196:199], v[104:107]
  v_mfma_f32_16x16x32_bf16 v[104:107], v[212:215], v[200:203], v[104:107]
  v_mfma_f32_16x16x32_bf16 v[104:107], v[212:215], v[204:207], v[104:107]
  s_mov_b32 s34, 0x00ff00ff
  s_mov_b32 s35, 0
  v_cvt_pk_bf16_f32 v108, v96, v97
  v_cvt_pk_bf16_f32 v109, v98, v99
  v_cvt_pk_bf16_f32 v110, v100, v101
  v_cvt_pk_bf16_f32 v111, v102, v103
  s_nop 1
  v_cvt_pk_bf16_f32 v112, v104, v105
  v_cvt_pk_bf16_f32 v113, v106, v107
  v_cndmask_b32 v112, 0, v112, s[34:35]
  v_cndmask_b32 v113, 0, v113, s[34:35]
  v_lshlrev_b32 v96, 16, v108
  v_and_b32 v97, 0xffff0000, v108
  v_lshlrev_b32 v98, 16, v109
  v_and_b32 v99, 0xffff0000, v109
  v_lshlrev_b32 v100, 16, v110
  v_and_b32 v101, 0xffff0000, v110
  v_lshlrev_b32 v102, 16, v111
  v_and_b32 v103, 0xffff0000, v111
  v_lshlrev_b32 v104, 16, v112
  v_and_b32 v105, 0xffff0000, v112
  v_lshlrev_b32 v106, 16, v113
  v_and_b32 v107, 0xffff0000, v113
  s_add_u32 s51, s41, 4194304
  v_permlane16_swap_b32 v108, v110
  v_permlane16_swap_b32 v109, v111
  buffer_store_dwordx4 v[108:111], v9, s[4:7], s51 offen sc1
  buffer_store_dwordx2 v[112:113], v7, s[4:7], s51 offen sc1
  v_add_f32 v10, v96, v97
  v_add_f32 v11, v98, v99
  v_add_f32 v10, v10, v100
  v_add_f32 v11, v11, v101
  v_add_f32 v10, v10, v102
  v_add_f32 v11, v11, v103
  v_add_f32 v10, v10, v104
  v_add_f32 v11, v11, v105
  v_add_f32 v10, v10, v106
  v_add_f32 v11, v11, v107
  v_add_f32 v10, v10, v11
  s_nop 1
  v_add_f32_dpp v10, v10, v10 quad_perm:[1,0,3,2] row_mask:0xf bank_mask:0xf
  s_nop 1
  v_add_f32_dpp v10, v10, v10 quad_perm:[2,3,0,1] row_mask:0xf bank_mask:0xf
  s_nop 1
  v_add_f32_dpp v10, v10, v10 row_half_mirror row_mask:0xf bank_mask:0xf
  s_nop 1
  v_add_f32_dpp v10, v10, v10 row_mirror row_mask:0xf bank_mask:0xf
  v_mov_b32 v11, v10
  s_nop 1
  v_permlane16_swap_b32 v10, v11
  v_add_f32 v10, v10, v11
  v_mov_b32 v11, v10
  s_nop 1
  v_permlane32_swap_b32 v10, v11
  v_add_f32 v10, v10, v11
  v_mul_f32 v10, 0x3ae38e39, v10
  v_sub_f32 v96, v96, v10
  v_sub_f32 v97, v97, v10
  v_sub_f32 v98, v98, v10
  v_sub_f32 v99, v99, v10
  v_sub_f32 v100, v100, v10
  v_sub_f32 v101, v101, v10
  v_sub_f32 v102, v102, v10
  v_sub_f32 v103, v103, v10
  v_sub_f32 v104, v104, v10
  v_sub_f32 v105, v105, v10
  v_sub_f32 v106, v106, v10
  v_sub_f32 v107, v107, v10
  v_cndmask_b32 v104, 0, v104, s[34:35]
  v_cndmask_b32 v105, 0, v105, s[34:35]
  v_cndmask_b32 v106, 0, v106, s[34:35]
  v_cndmask_b32 v107, 0, v107, s[34:35]
  v_mul_f32 v10, v96, v96
  v_mul_f32 v11, v97, v97
  v_fmac_f32 v10, v98, v98
  v_fmac_f32 v11, v99, v99
  v_fmac_f32 v10, v100, v100
  v_fmac_f32 v11, v101, v101
  v_fmac_f32 v10, v102, v102
  v_fmac_f32 v11, v103, v103
  v_fmac_f32 v10, v104, v104
  v_fmac_f32 v11, v105, v105
  v_fmac_f32 v10, v106, v106
  v_fmac_f32 v11, v107, v107
  v_add_f32 v10, v10, v11
  s_nop 1
  v_add_f32_dpp v10, v10, v10 quad_perm:[1,0,3,2] row_mask:0xf bank_mask:0xf
  s_nop 1
  v_add_f32_dpp v10, v10, v10 quad_perm:[2,3,0,1] row_mask:0xf bank_mask:0xf
  s_nop 1
  v_add_f32_dpp v10, v10, v10 row_half_mirror row_mask:0xf bank_mask:0xf
  s_nop 1
  v_add_f32_dpp v10, v10, v10 row_mirror row_mask:0xf bank_mask:0xf
  v_mov_b32 v11, v10
  s_nop 1
  v_permlane16_swap_b32 v10, v11
  v_add_f32 v10, v10, v11
  v_mov_b32 v11, v10
  s_nop 1
  v_permlane32_swap_b32 v10, v11
  v_add_f32 v10, v10, v11
  v_mov_b32 v11, 0x3727c5ac
  v_fmac_f32 v11, 0x3ae38e39, v10
  v_rsq_f32 v11, v11
  s_nop 0
  v_mul_f32 v96, v11, v96
  v_mul_f32 v97, v11, v97
  v_mul_f32 v98, v11, v98
  v_mul_f32 v99, v11, v99
  v_mul_f32 v100, v11, v100
  v_mul_f32 v101, v11, v101
  v_mul_f32 v102, v11, v102
  v_mul_f32 v103, v11, v103
  v_mul_f32 v104, v11, v104
  v_mul_f32 v105, v11, v105
  v_mul_f32 v106, v11, v106
  v_mul_f32_e64 v107, v11, v107
  v_cvt_pk_bf16_f32 v116, v96, v97
  v_cvt_pk_bf16_f32 v117, v98, v99
  v_cvt_pk_bf16_f32 v118, v100, v101
  v_cvt_pk_bf16_f32 v119, v102, v103
  v_cvt_pk_bf16_f32 v120, v104, v105
  v_cvt_pk_bf16_f32 v121, v106, v107
  s_add_u32 s51, s41, 7340032
  v_permlane16_swap_b32 v116, v118
  v_permlane16_swap_b32 v117, v119
  buffer_store_dwordx4 v[116:119], v9, s[4:7], s51 offen sc1
  buffer_store_dwordx2 v[120:121], v7, s[4:7], s51 offen sc1
  s_cmp_eq_u32 s40, 60
  s_cselect_b32 s34, s38, 0
  s_sub_u32 s40, s40, s34
  s_cmp_ge_u32 s40, 60
  s_cbranch_scc1 L_att_l2_end
  s_add_u32 s95, s40, 5
  s_cmp_ge_u32 s48, s95
  s_cbranch_scc1 L_ap_33_x
L_ap_33:
  s_load_dwordx4 s[96:99], s[4:5], s92 glc
  s_load_dwordx2 s[100:101], s[4:5], s93 glc
  s_add_u32 s50, s50, 1
  s_cmp_ge_u32 s50, 262144
  s_cbranch_scc1 L_ap_33_y
  s_waitcnt lgkmcnt(0)
  s_min_u32 s48, s96, s97
  s_min_u32 s48, s48, s98
  s_min_u32 s48, s48, s99
  s_min_u32 s48, s48, s100
  s_min_u32 s48, s48, s101
  s_cmp_lt_u32 s48, s95
  s_cbranch_scc1 L_ap_33
L_ap_33_y:
  s_waitcnt lgkmcnt(0)
L_ap_33_x:
  s_lshl_b32 s34, s40, 5
  s_lshl1_add_u32 s34, s43, s34
  s_add_u32 s34, s34, 129
  s_lshl_b32 s34, s34, 13
  s_add_u32 s51, s34, 18874368
  buffer_load_dwordx4 v[16:19], v1, s[4:7], s51 offen offset:0 sc1
  buffer_load_dwordx4 v[20:23], v1, s[4:7], s51 offen offset:1024 sc1
  buffer_load_dwordx4 v[24:27], v1, s[4:7], s51 offen offset:2048 sc1
  buffer_load_dwordx4 v[28:31], v1, s[4:7], s51 offen offset:3072 sc1
  s_add_u32 s51, s34, 35651584
  buffer_load_dwordx4 v[32:35], v1, s[4:7], s51 offen offset:0 sc1
  buffer_load_dwordx4 v[36:39], v1, s[4:7], s51 offen offset:1024 sc1
  buffer_load_dwordx4 v[40:43], v1, s[4:7], s51 offen offset:2048 sc1
  buffer_load_dwordx4 v[44:47], v1, s[4:7], s51 offen offset:3072 sc1
  s_add_u32 s51, s34, 52428800
  buffer_load_dwordx4 v[64:67], v1, s[4:7], s51 offen offset:0 sc1
  buffer_load_dwordx4 v[68:71], v1, s[4:7], s51 offen offset:1024 sc1
  buffer_load_dwordx4 v[72:75], v1, s[4:7], s51 offen offset:2048 sc1
  buffer_load_dwordx4 v[76:79], v1, s[4:7], s51 offen offset:3072 sc1
  s_add_u32 s51, s34, 52432896
  buffer_load_dwordx4 v[80:83], v1, s[4:7], s51 offen offset:0 sc1
  buffer_load_dwordx4 v[84:87], v1, s[4:7], s51 offen offset:1024 sc1
  buffer_load_dwordx4 v[88:91], v1, s[4:7], s51 offen offset:2048 sc1
  buffer_load_dwordx4 v[92:95], v1, s[4:7], s51 offen offset:3072 sc1
  s_add_u32 s40, s40, 4
  s_branch L_att_l2
L_att_l2_end:
  s_endpgm
L_att_w3:
  v_lshrrev_b32 v12, 2, v0
  v_mul_u32_u24 v12, 1152, v12
  v_and_b32 v13, 3, v0
  v_lshl_add_u32 v12, v13, 4, v12
  v_add_u32 v13, 73728, v12
  s_waitcnt vmcnt(27)
  s_barrier
  ds_read_b64_tr_b16 v[224:225], v12 offset:896
  ds_read_b64_tr_b16 v[226:227], v12 offset:19328
  ds_read_b64_tr_b16 a[0:1], v12 offset:904
  ds_read_b64_tr_b16 a[2:3], v12 offset:19336
  ds_read_b64_tr_b16 a[32:33], v12 offset:960
  ds_read_b64_tr_b16 a[34:35], v12 offset:19392
  ds_read_b64_tr_b16 a[64:65], v12 offset:968
  ds_read_b64_tr_b16 a[66:67], v12 offset:19400
  ds_read_b64_tr_b16 a[96:97], v12 offset:1024
  ds_read_b64_tr_b16 a[98:99], v12 offset:19456
  ds_read_b64_tr_b16 a[128:129], v12 offset:1032
  ds_read_b64_tr_b16 a[130:131], v12 offset:19464
  ds_read_b64_tr_b16 a[160:161], v12 offset:1088
  ds_read_b64_tr_b16 a[162:163], v12 offset:19520
  ds_read_b64_tr_b16 a[192:193], v12 offset:1096
  ds_read_b64_tr_b16 a[194:195], v12 offset:19528
  ds_read_b64_tr_b16 a[224:225], v12 offset:840
  ds_read_b64_tr_b16 a[226:227], v12 offset:19272
  s_waitcnt lgkmcnt(0)
  s_barrier
  s_add_u32 m0, s42, 0
  s_add_u32 s51, s45, 147456
  buffer_load_dwordx4 v1, s[16:19], s51 offen offset:0 lds
  buffer_load_dwordx4 v1, s[16:19], s51 offen offset:1024 lds
  buffer_load_dwordx4 v1, s[16:19], s51 offen offset:2048 lds
  buffer_load_dwordx4 v1, s[16:19], s51 offen offset:3072 lds
  s_add_u32 m0, s42, 4096
  s_add_u32 s51, s45, 151552
  buffer_load_dwordx4 v1, s[16:19], s51 offen offset:0 lds
  buffer_load_dwordx4 v1, s[16:19], s51 offen offset:1024 lds
  buffer_load_dwordx4 v1, s[16:19], s51 offen offset:2048 lds
  buffer_load_dwordx4 v1, s[16:19], s51 offen offset:3072 lds
  s_add_u32 m0, s42, 8192
  s_add_u32 s51, s45, 155648
  buffer_load_dwordx4 v1, s[16:19], s51 offen offset:0 lds
  s_waitcnt vmcnt(27)
  s_barrier
  ds_read_b64_tr_b16 v[228:229], v12 offset:37760
  ds_read_b64_tr_b16 v[230:231], v12 offset:56192
  ds_read_b64_tr_b16 a[4:5], v12 offset:37768
  ds_read_b64_tr_b16 a[6:7], v12 offset:56200
  ds_read_b64_tr_b16 a[36:37], v12 offset:37824
  ds_read_b64_tr_b16 a[38:39], v12 offset:56256
  ds_read_b64_tr_b16 a[68:69], v12 offset:37832
  ds_read_b64_tr_b16 a[70:71], v12 offset:56264
  ds_read_b64_tr_b16 a[100:101], v12 offset:37888
  ds_read_b64_tr_b16 a[102:103], v12 offset:56320
  ds_read_b64_tr_b16 a[132:133], v12 offset:37896
  ds_read_b64_tr_b16 a[134:135], v12 offset:56328
  ds_read_b64_tr_b16 a[164:165], v12 offset:37952
  ds_read_b64_tr_b16 a[166:167], v12 offset:56384
  ds_read_b64_tr_b16 a[196:197], v12 offset:37960
  ds_read_b64_tr_b16 a[198:199], v12 offset:56392
  ds_read_b64_tr_b16 a[228:229], v12 offset:37704
  ds_read_b64_tr_b16 a[230:231], v12 offset:56136
  s_waitcnt lgkmcnt(0)
  s_barrier
  s_add_u32 m0, s42, 36864
  s_add_u32 s51, s45, 184320
  buffer_load_dwordx4 v1, s[16:19], s51 offen offset:0 lds
  buffer_load_dwordx4 v1, s[16:19], s51 offen offset:1024 lds
  buffer_load_dwordx4 v1, s[16:19], s51 offen offset:2048 lds
  buffer_load_dwordx4 v1, s[16:19], s51 offen offset:3072 lds
  s_add_u32 m0, s42, 40960
  s_add_u32 s51, s45, 188416
  buffer_load_dwordx4 v1, s[16:19], s51 offen offset:0 lds
  buffer_load_dwordx4 v1, s[16:19], s51 offen offset:1024 lds
  buffer_load_dwordx4 v1, s[16:19], s51 offen offset:2048 lds
  buffer_load_dwordx4 v1, s[16:19], s51 offen offset:3072 lds
  s_add_u32 m0, s42, 45056
  s_add_u32 s51, s45, 192512
  buffer_load_dwordx4 v1, s[16:19], s51 offen offset:0 lds
  s_waitcnt vmcnt(27)
  s_barrier
  ds_read_b64_tr_b16 v[232:233], v13 offset:896
  ds_read_b64_tr_b16 v[234:235], v13 offset:19328
  ds_read_b64_tr_b16 a[8:9], v13 offset:904
  ds_read_b64_tr_b16 a[10:11], v13 offset:19336
  ds_read_b64_tr_b16 a[40:41], v13 offset:960
  ds_read_b64_tr_b16 a[42:43], v13 offset:19392
  ds_read_b64_tr_b16 a[72:73], v13 offset:968
  ds_read_b64_tr_b16 a[74:75], v13 offset:19400
  ds_read_b64_tr_b16 a[104:105], v13 offset:1024
  ds_read_b64_tr_b16 a[106:107], v13 offset:19456
  ds_read_b64_tr_b16 a[136:137], v13 offset:1032
  ds_read_b64_tr_b16 a[138:139], v13 offset:19464
  ds_read_b64_tr_b16 a[168:169], v13 offset:1088
  ds_read_b64_tr_b16 a[170:171], v13 offset:19520
  ds_read_b64_tr_b16 a[200:201], v13 offset:1096
  ds_read_b64_tr_b16 a[202:203], v13 offset:19528
  ds_read_b64_tr_b16 a[232:233], v13 offset:840
  ds_read_b64_tr_b16 a[234:235], v13 offset:19272
  s_waitcnt lgkmcnt(0)
  s_barrier
  s_add_u32 m0, s42, 73728
  s_add_u32 s51, s45, 221184
  buffer_load_dwordx4 v1, s[16:19], s51 offen offset:0 lds
  buffer_load_dwordx4 v1, s[16:19], s51 offen offset:1024 lds
  buffer_load_dwordx4 v1, s[16:19], s51 offen offset:2048 lds
  buffer_load_dwordx4 v1, s[16:19], s51 offen offset:3072 lds
  s_add_u32 m0, s42, 77824
  s_add_u32 s51, s45, 225280
  buffer_load_dwordx4 v1, s[16:19], s51 offen offset:0 lds
  buffer_load_dwordx4 v1, s[16:19], s51 offen offset:1024 lds
  buffer_load_dwordx4 v1, s[16:19], s51 offen offset:2048 lds
  buffer_load_dwordx4 v1, s[16:19], s51 offen offset:3072 lds
  s_add_u32 m0, s42, 81920
  s_add_u32 s51, s45, 229376
  buffer_load_dwordx4 v1, s[16:19], s51 offen offset:0 lds
  s_waitcnt vmcnt(27)
  s_barrier
  ds_read_b64_tr_b16 v[236:237], v13 offset:37760
  ds_read_b64_tr_b16 v[238:239], v13 offset:56192
  ds_read_b64_tr_b16 a[12:13], v13 offset:37768
  ds_read_b64_tr_b16 a[14:15], v13 offset:56200
  ds_read_b64_tr_b16 a[44:45], v13 offset:37824
  ds_read_b64_tr_b16 a[46:47], v13 offset:56256
  ds_read_b64_tr_b16 a[76:77], v13 offset:37832
  ds_read_b64_tr_b16 a[78:79], v13 offset:56264
  ds_read_b64_tr_b16 a[108:109], v13 offset:37888
  ds_read_b64_tr_b16 a[110:111], v13 offset:56320
  ds_read_b64_tr_b16 a[140:141], v13 offset:37896
  ds_read_b64_tr_b16 a[142:143], v13 offset:56328
  ds_read_b64_tr_b16 a[172:173], v13 offset:37952
  ds_read_b64_tr_b16 a[174:175], v13 offset:56384
  ds_read_b64_tr_b16 a[204:205], v13 offset:37960
  ds_read_b64_tr_b16 a[206:207], v13 offset:56392
  ds_read_b64_tr_b16 a[236:237], v13 offset:37704
  ds_read_b64_tr_b16 a[238:239], v13 offset:56136
  s_waitcnt lgkmcnt(0)
  s_barrier
  s_add_u32 m0, s42, 110592
  s_add_u32 s51, s45, 258048
  buffer_load_dwordx4 v1, s[16:19], s51 offen offset:0 lds
  buffer_load_dwordx4 v1, s[16:19], s51 offen offset:1024 lds
  buffer_load_dwordx4 v1, s[16:19], s51 offen offset:2048 lds
  buffer_load_dwordx4 v1, s[16:19], s51 offen offset:3072 lds
  s_add_u32 m0, s42, 114688
  s_add_u32 s51, s45, 262144
  buffer_load_dwordx4 v1, s[16:19], s51 offen offset:0 lds
  buffer_load_dwordx4 v1, s[16:19], s51 offen offset:1024 lds
  buffer_load_dwordx4 v1, s[16:19], s51 offen offset:2048 lds
  buffer_load_dwordx4 v1, s[16:19], s51 offen offset:3072 lds
  s_add_u32 m0, s42, 118784
  s_add_u32 s51, s45, 266240
  buffer_load_dwordx4 v1, s[16:19], s51 offen offset:0 lds
  s_waitcnt vmcnt(27)
  s_barrier
  ds_read_b64_tr_b16 v[240:241], v12 offset:896
  ds_read_b64_tr_b16 v[242:243], v12 offset:19328
  ds_read_b64_tr_b16 a[16:17], v12 offset:904
  ds_read_b64_tr_b16 a[18:19], v12 offset:19336
  ds_read_b64_tr_b16 a[48:49], v12 offset:960
  ds_read_b64_tr_b16 a[50:51], v12 offset:19392
  ds_read_b64_tr_b16 a[80:81], v12 offset:968
  ds_read_b64_tr_b16 a[82:83], v12 offset:19400
  ds_read_b64_tr_b16 a[112:113], v12 offset:1024
  ds_read_b64_tr_b16 a[114:115], v12 offset:19456
  ds_read_b64_tr_b16 a[144:145], v12 offset:1032
  ds_read_b64_tr_b16 a[146:147], v12 offset:19464
  ds_read_b64_tr_b16 a[176:177], v12 offset:1088
  ds_read_b64_tr_b16 a[178:179], v12 offset:19520
  ds_read_b64_tr_b16 a[208:209], v12 offset:1096
  ds_read_b64_tr_b16 a[210:211], v12 offset:19528
  ds_read_b64_tr_b16 a[240:241], v12 offset:840
  ds_read_b64_tr_b16 a[242:243], v12 offset:19272
  s_waitcnt lgkmcnt(0)
  s_waitcnt vmcnt(18)
  s_barrier
  ds_read_b64_tr_b16 v[244:245], v12 offset:37760
  ds_read_b64_tr_b16 v[246:247], v12 offset:56192
  ds_read_b64_tr_b16 a[20:21], v12 offset:37768
  ds_read_b64_tr_b16 a[22:23], v12 offset:56200
  ds_read_b64_tr_b16 a[52:53], v12 offset:37824
  ds_read_b64_tr_b16 a[54:55], v12 offset:56256
  ds_read_b64_tr_b16 a[84:85], v12 offset:37832
  ds_read_b64_tr_b16 a[86:87], v12 offset:56264
  ds_read_b64_tr_b16 a[116:117], v12 offset:37888
  ds_read_b64_tr_b16 a[118:119], v12 offset:56320
  ds_read_b64_tr_b16 a[148:149], v12 offset:37896
  ds_read_b64_tr_b16 a[150:151], v12 offset:56328
  ds_read_b64_tr_b16 a[180:181], v12 offset:37952
  ds_read_b64_tr_b16 a[182:183], v12 offset:56384
  ds_read_b64_tr_b16 a[212:213], v12 offset:37960
  ds_read_b64_tr_b16 a[214:215], v12 offset:56392
  ds_read_b64_tr_b16 a[244:245], v12 offset:37704
  ds_read_b64_tr_b16 a[246:247], v12 offset:56136
  s_waitcnt lgkmcnt(0)
  s_waitcnt vmcnt(9)
  s_barrier
  ds_read_b64_tr_b16 v[248:249], v13 offset:896
  ds_read_b64_tr_b16 v[250:251], v13 offset:19328
  ds_read_b64_tr_b16 a[24:25], v13 offset:904
  ds_read_b64_tr_b16 a[26:27], v13 offset:19336
  ds_read_b64_tr_b16 a[56:57], v13 offset:960
  ds_read_b64_tr_b16 a[58:59], v13 offset:19392
  ds_read_b64_tr_b16 a[88:89], v13 offset:968
  ds_read_b64_tr_b16 a[90:91], v13 offset:19400
  ds_read_b64_tr_b16 a[120:121], v13 offset:1024
  ds_read_b64_tr_b16 a[122:123], v13 offset:19456
  ds_read_b64_tr_b16 a[152:153], v13 offset:1032
  ds_read_b64_tr_b16 a[154:155], v13 offset:19464
  ds_read_b64_tr_b16 a[184:185], v13 offset:1088
  ds_read_b64_tr_b16 a[186:187], v13 offset:19520
  ds_read_b64_tr_b16 a[216:217], v13 offset:1096
  ds_read_b64_tr_b16 a[218:219], v13 offset:19528
  ds_read_b64_tr_b16 a[248:249], v13 offset:840
  ds_read_b64_tr_b16 a[250:251], v13 offset:19272
  s_waitcnt lgkmcnt(0)
  s_waitcnt vmcnt(0)
  s_barrier
  ds_read_b64_tr_b16 v[252:253], v13 offset:37760
  ds_read_b64_tr_b16 v[254:255], v13 offset:56192
  ds_read_b64_tr_b16 a[28:29], v13 offset:37768
  ds_read_b64_tr_b16 a[30:31], v13 offset:56200
  ds_read_b64_tr_b16 a[60:61], v13 offset:37824
  ds_read_b64_tr_b16 a[62:63], v13 offset:56256
  ds_read_b64_tr_b16 a[92:93], v13 offset:37832
  ds_read_b64_tr_b16 a[94:95], v13 offset:56264
  ds_read_b64_tr_b16 a[124:125], v13 offset:37888
  ds_read_b64_tr_b16 a[126:127], v13 offset:56320
  ds_read_b64_tr_b16 a[156:157], v13 offset:37896
  ds_read_b64_tr_b16 a[158:159], v13 offset:56328
  ds_read_b64_tr_b16 a[188:189], v13 offset:37952
  ds_read_b64_tr_b16 a[190:191], v13 offset:56384
  ds_read_b64_tr_b16 a[220:221], v13 offset:37960
  ds_read_b64_tr_b16 a[222:223], v13 offset:56392
  ds_read_b64_tr_b16 a[252:253], v13 offset:37704
  ds_read_b64_tr_b16 a[254:255], v13 offset:56136
  s_waitcnt lgkmcnt(0)
  v_and_b32 v10, 15, v0
  v_lshrrev_b32 v11, 4, v0
  v_lshrrev_b32 v12, 2, v10
  v_and_b32 v13, 1, v0
  v_lshl_add_u32 v14, v12, 1, v13
  v_lshlrev_b32 v14, 4, v14
  v_lshl_add_u32 v2, v11, 7, v14
  v_lshlrev_b32 v3, 3, v0
  v_lshrrev_b32 v14, 1, v10
  v_mul_u32_u24 v14, 36864, v14
  v_lshl_add_u32 v14, v13, 6, v14
  v_lshl_add_u32 v14, v11, 4, v14
  s_mul_i32 s34, s43, 2304
  v_add_u32 v4, s34, v14
  s_lshl_b32 s34, s43, 8
  s_add_u32 s92, s34, 128
  s_add_u32 s94, s34, 6272
  s_lshl_b32 s34, s43, 7
  s_add_u32 s93, s34, 4104
  s_mov_b32 s48, 0
  s_mov_b32 s49, 0
  s_mov_b32 s52, 0xfff0ffff
  s_mov_b32 s53, 0xf000ff00
  s_mov_b32 s54, 0xffe0fffe
  s_mov_b32 s55, 0xe000fe00
  s_mov_b32 s56, 0xffc0fffc
  s_mov_b32 s57, 0xc000fc00
  s_mov_b32 s58, 0xff80fff8
  s_mov_b32 s59, 0x8000f800
  s_mov_b32 s46, 0x3e0293ee
  s_mov_b32 s47, 0xbe0293ee
  s_mul_i32 s34, s44, 1179648
  s_mul_i32 s35, s43, 36864
  s_add_u32 s34, s34, s35
  s_sub_u32 s35, s32, 48
  s_mul_i32 s35, s35, 36864
  v_mov_b64 v[16:17], -1
  v_mov_b64 v[18:19], -1
  s_add_u32 s51, s34, 69233664
  buffer_store_dwordx4 v[16:19], v1, s[4:7], s51 offen offset:0 sc1
  buffer_store_dwordx4 v[16:19], v1, s[4:7], s51 offen offset:1024 sc1
  buffer_store_dwordx4 v[16:19], v1, s[4:7], s51 offen offset:2048 sc1
  buffer_store_dwordx4 v[16:19], v1, s[4:7], s51 offen offset:3072 sc1
  s_add_u32 s51, s34, 69237760
  buffer_store_dwordx4 v[16:19], v1, s[4:7], s51 offen offset:0 sc1
  buffer_store_dwordx4 v[16:19], v1, s[4:7], s51 offen offset:1024 sc1
  buffer_store_dwordx4 v[16:19], v1, s[4:7], s51 offen offset:2048 sc1
  buffer_store_dwordx4 v[16:19], v1, s[4:7], s51 offen offset:3072 sc1
  s_add_u32 s51, s34, 69241856
  buffer_store_dwordx4 v[16:19], v1, s[4:7], s51 offen offset:0 sc1
  s_add_u32 s51, s34, 69823488
  buffer_store_dwordx4 v[16:19], v1, s[4:7], s51 offen offset:0 sc1
  buffer_store_dwordx4 v[16:19], v1, s[4:7], s51 offen offset:1024 sc1
  buffer_store_dwordx4 v[16:19], v1, s[4:7], s51 offen offset:2048 sc1
  buffer_store_dwordx4 v[16:19], v1, s[4:7], s51 offen offset:3072 sc1
  s_add_u32 s51, s34, 69827584
  buffer_store_dwordx4 v[16:19], v1, s[4:7], s51 offen offset:0 sc1
  buffer_store_dwordx4 v[16:19], v1, s[4:7], s51 offen offset:1024 sc1
  buffer_store_dwordx4 v[16:19], v1, s[4:7], s51 offen offset:2048 sc1
  buffer_store_dwordx4 v[16:19], v1, s[4:7], s51 offen offset:3072 sc1
  s_add_u32 s51, s34, 69831680
  buffer_store_dwordx4 v[16:19], v1, s[4:7], s51 offen offset:0 sc1
  s_add_u32 s51, s35, 4221952
  buffer_store_dwordx4 v[16:19], v1, s[4:7], s51 offen offset:0 sc1
  buffer_store_dwordx4 v[16:19], v1, s[4:7], s51 offen offset:1024 sc1
  buffer_store_dwordx4 v[16:19], v1, s[4:7], s51 offen offset:2048 sc1
  buffer_store_dwordx4 v[16:19], v1, s[4:7], s51 offen offset:3072 sc1
  s_add_u32 s51, s35, 4226048
  buffer_store_dwordx4 v[16:19], v1, s[4:7], s51 offen offset:0 sc1
  buffer_store_dwordx4 v[16:19], v1, s[4:7], s51 offen offset:1024 sc1
  buffer_store_dwordx4 v[16:19], v1, s[4:7], s51 offen offset:2048 sc1
  buffer_store_dwordx4 v[16:19], v1, s[4:7], s51 offen offset:3072 sc1
  s_add_u32 s51, s35, 4230144
  buffer_store_dwordx4 v[16:19], v1, s[4:7], s51 offen offset:0 sc1
  s_add_u32 s51, s35, 7367680
  buffer_store_dwordx4 v[16:19], v1, s[4:7], s51 offen offset:0 sc1
  buffer_store_dwordx4 v[16:19], v1, s[4:7], s51 offen offset:1024 sc1
  buffer_store_dwordx4 v[16:19], v1, s[4:7], s51 offen offset:2048 sc1
  buffer_store_dwordx4 v[16:19], v1, s[4:7], s51 offen offset:3072 sc1
  s_add_u32 s51, s35, 7371776
  buffer_store_dwordx4 v[16:19], v1, s[4:7], s51 offen offset:0 sc1
  buffer_store_dwordx4 v[16:19], v1, s[4:7], s51 offen offset:1024 sc1
  buffer_store_dwordx4 v[16:19], v1, s[4:7], s51 offen offset:2048 sc1
  buffer_store_dwordx4 v[16:19], v1, s[4:7], s51 offen offset:3072 sc1
  s_add_u32 s51, s35, 7375872
  buffer_store_dwordx4 v[16:19], v1, s[4:7], s51 offen offset:0 sc1
  s_cmp_lt_u32 s32, 104
  s_cbranch_scc1 L_nof_34
  s_mul_i32 s34, s43, 36864
  v_mov_b64 v[16:17], -1
  v_mov_b64 v[18:19], -1
  s_add_u32 s51, s34, 73952256
  buffer_store_dwordx4 v[16:19], v1, s[4:7], s51 offen offset:0 sc1
  buffer_store_dwordx4 v[16:19], v1, s[4:7], s51 offen offset:1024 sc1
  buffer_store_dwordx4 v[16:19], v1, s[4:7], s51 offen offset:2048 sc1
  buffer_store_dwordx4 v[16:19], v1, s[4:7], s51 offen offset:3072 sc1
  s_add_u32 s51, s34, 73956352
  buffer_store_dwordx4 v[16:19], v1, s[4:7], s51 offen offset:0 sc1
  buffer_store_dwordx4 v[16:19], v1, s[4:7], s51 offen offset:1024 sc1
  buffer_store_dwordx4 v[16:19], v1, s[4:7], s51 offen offset:2048 sc1
  buffer_store_dwordx4 v[16:19], v1, s[4:7], s51 offen offset:3072 sc1
  s_add_u32 s51, s34, 73960448
  buffer_store_dwordx4 v[16:19], v1, s[4:7], s51 offen offset:0 sc1
L_nof_34:
  s_waitcnt vmcnt(0)
  s_barrier
  s_cmp_lg_u32 s33, 0
  s_cbranch_scc1 L_meet_35
  v_mov_b32 v10, 1
  s_mov_b64 exec, 1
  buffer_atomic_add v10, off, s[8:11], 0 offset:24 sc0
  s_waitcnt vmcnt(0)
  v_readfirstlane_b32 s51, v10
  v_mov_b32 v10, 1
  s_cmp_lg_u32 s51, 63
  s_cbranch_scc1 L_cnt_36
  buffer_store_dword v10, off, s[8:11], 0 offset:144 sc1
L_cnt_36:
  s_mov_b64 exec, -1
L_ai_37:
  buffer_load_dword v10, off, s[8:11], 0 offset:4 sc1
  s_add_u32 s50, s50, 1
  s_cmp_ge_u32 s50, 262144
  s_waitcnt vmcnt(0)
  s_cbranch_scc1 L_ai_37_x
  v_cmp_ge_u32 vcc, 9, v10
  s_nop 0
  s_cbranch_vccnz L_ai_37
L_ai_37_x:
L_ai_38:
  buffer_load_dword v10, off, s[8:11], 0 offset:144 sc1
  s_add_u32 s50, s50, 1
  s_cmp_ge_u32 s50, 262144
  s_waitcnt vmcnt(0)
  s_cbranch_scc1 L_ai_38_x
  v_cmp_ge_u32 vcc, 0, v10
  s_nop 0
  s_cbranch_vccnz L_ai_38
L_ai_38_x:
L_meet_35:
  s_barrier
  s_mov_b32 s34, 152
  s_cmp_eq_u32 s44, 0
  s_cselect_b32 s39, 32, 16
  s_cmp_eq_u32 s44, 1
  s_cselect_b32 s34, 112, s34
  s_cmp_eq_u32 s44, 2
  s_cselect_b32 s34, 116, s34
  buffer_load_dword v10, off, s[8:11], s34 sc1
  s_waitcnt vmcnt(0)
  v_readfirstlane_b32 s34, v10
  s_nop 0
  s_cmp_ge_u32 s34, s39
  s_cselect_b32 s39, 1, 0
  s_cmp_ge_u32 s34, 32
  s_cselect_b32 s38, s39, 0
  s_sub_u32 s34, s44, 1
  s_cmp_lt_u32 s34, 2
  s_cselect_b32 s38, 0, s38
  s_mov_b32 s40, s44
  s_mov_b32 s42, 0
  s_mov_b32 s61, 0
  s_add_u32 s95, s40, 1
  s_cmp_ge_u32 s48, s95
  s_cbranch_scc1 L_ap_39_x
L_ap_39:
  s_load_dwordx4 s[96:99], s[4:5], s92 glc
  s_load_dwordx2 s[100:101], s[4:5], s93 glc
  s_add_u32 s50, s50, 1
  s_cmp_ge_u32 s50, 262144
  s_cbranch_scc1 L_ap_39_y
  s_waitcnt lgkmcnt(0)
  s_min_u32 s48, s96, s97
  s_min_u32 s48, s48, s98
  s_min_u32 s48, s48, s99
  s_min_u32 s48, s48, s100
  s_min_u32 s48, s48, s101
  s_cmp_lt_u32 s48, s95
  s_cbranch_scc1 L_ap_39
L_ap_39_y:
  s_waitcnt lgkmcnt(0)
L_ap_39_x:
  s_lshl_b32 s34, s40, 5
  s_lshl1_add_u32 s34, s43, s34
  s_add_u32 s34, s34, 1
  s_lshl_b32 s34, s34, 13
  s_add_u32 s51, s34, 18878464
  buffer_load_dwordx4 v[16:19], v1, s[4:7], s51 offen offset:0 sc1
  buffer_load_dwordx4 v[20:23], v1, s[4:7], s51 offen offset:1024 sc1
  buffer_load_dwordx4 v[24:27], v1, s[4:7], s51 offen offset:2048 sc1
  buffer_load_dwordx4 v[28:31], v1, s[4:7], s51 offen offset:3072 sc1
  s_add_u32 s51, s34, 35651584
  buffer_load_dwordx4 v[32:35], v1, s[4:7], s51 offen offset:0 sc1
  buffer_load_dwordx4 v[36:39], v1, s[4:7], s51 offen offset:1024 sc1
  buffer_load_dwordx4 v[40:43], v1, s[4:7], s51 offen offset:2048 sc1
  buffer_load_dwordx4 v[44:47], v1, s[4:7], s51 offen offset:3072 sc1
  s_add_u32 s51, s34, 35655680
  buffer_load_dwordx4 v[48:51], v1, s[4:7], s51 offen offset:0 sc1
  buffer_load_dwordx4 v[52:55], v1, s[4:7], s51 offen offset:1024 sc1
  buffer_load_dwordx4 v[56:59], v1, s[4:7], s51 offen offset:2048 sc1
  buffer_load_dwordx4 v[60:63], v1, s[4:7], s51 offen offset:3072 sc1
  s_add_u32 s51, s34, 52428800
  buffer_load_dwordx4 v[64:67], v1, s[4:7], s51 offen offset:0 sc1
  buffer_load_dwordx4 v[68:71], v1, s[4:7], s51 offen offset:1024 sc1
  buffer_load_dwordx4 v[72:75], v1, s[4:7], s51 offen offset:2048 sc1
  buffer_load_dwordx4 v[76:79], v1, s[4:7], s51 offen offset:3072 sc1
  s_add_u32 s51, s34, 52432896
  buffer_load_dwordx4 v[80:83], v1, s[4:7], s51 offen offset:0 sc1
  buffer_load_dwordx4 v[84:87], v1, s[4:7], s51 offen offset:1024 sc1
  buffer_load_dwordx4 v[88:91], v1, s[4:7], s51 offen offset:2048 sc1
  buffer_load_dwordx4 v[92:95], v1, s[4:7], s51 offen offset:3072 sc1
.p2align 5
L_att_l3:
  s_lshl_b32 s41, s40, 5
  s_lshl1_add_u32 s41, s43, s41
  s_add_u32 s41, s41, 1
  s_lshl_b32 s41, s41, 11
  s_bfe_u32 s60, s61, 0x10001
  s_and_b32 s34, s61, 1
  s_add_u32 s61, s61, 1
  s_lshl1_add_u32 s34, s44, s34
  s_mul_i32 s45, s34, 589824
  s_add_u32 s45, s45, 69206016
  v_mov_b32 v140, 0x3f803f80
  v_mov_b32 v141, 0x3f803f80
  v_mov_b64 v[142:143], v[140:141]
  v_mov_b64 v[136:137], 0
  v_mov_b64 v[138:139], 0
  s_waitcnt vmcnt(0)
  v_mfma_f32_16x16x32_bf16 v[124:127], v[32:35], v[16:19], 0
  v_mfma_f32_16x16x32_bf16 v[128:131], v[48:51], v[16:19], 0
  v_mfma_f32_16x16x32_bf16 v[124:127], v[36:39], v[20:23], v[124:127]
  v_mfma_f32_16x16x32_bf16 v[128:131], v[52:55], v[20:23], v[128:131]
  v_mfma_f32_16x16x32_bf16 v[124:127], v[40:43], v[24:27], v[124:127]
  v_mfma_f32_16x16x32_bf16 v[128:131], v[56:59], v[24:27], v[128:131]
  v_mfma_f32_16x16x32_bf16 v[124:127], v[44:47], v[28:31], v[124:127]
  v_mfma_f32_16x16x32_bf16 v[128:131], v[60:63], v[28:31], v[128:131]
  v_mov_b32 v10, 0xff800000
  s_nop 6
  v_cndmask_b32 v128, v10, v128, s[52:53]
  v_cndmask_b32 v129, v10, v129, s[54:55]
  v_cndmask_b32 v130, v10, v130, s[56:57]
  v_cndmask_b32 v131, v10, v131, s[58:59]
  v_max3_f32 v12, v124, v125, v126
  v_max3_f32 v12, v12, v127, v128
  v_max3_f32 v12, v12, v129, v130
  v_max_f32 v12, v12, v131
  s_cmp_lt_u32 s40, 63
  s_cbranch_scc1 L_att_l3_ncp
  s_getpc_b64 s[96:97]
L_att_l3_pc:
  s_add_u32 s96, s96, L_att_l3_w0-L_att_l3_pc
  s_addc_u32 s97, s97, 0
  v_lshlrev_b32 v148, 2, v1
  v_mov_b32_e64 v149, s97
  v_add_co_u32 v148, vcc, s96, v148
  s_nop 1
  v_addc_co_u32 v149, vcc, 0, v149, vcc
  global_load_dword v150, v[148:149], off
L_att_l3_ncp:
  s_cmp_lt_u32 s40, 56
  s_addc_u32 s95, s40, 0
  s_cmp_eq_u32 s40, 63
  s_cselect_b32 s95, 62, s95
  s_cmp_ge_u32 s49, s95
  s_cbranch_scc1 L_ac_40_x
L_ac_40:
  s_load_dword s96, s[4:5], s94 glc
  s_add_u32 s50, s50, 1
  s_cmp_ge_u32 s50, 262144
  s_cbranch_scc1 L_ac_40_y
  s_waitcnt lgkmcnt(0)
  s_mov_b32 s49, s96
  s_cmp_lt_u32 s49, s95
  s_cbranch_scc1 L_ac_40
L_ac_40_y:
  s_waitcnt lgkmcnt(0)
L_ac_40_x:
L_att_k3:
  s_add_u32 s51, s41, 10485760
  buffer_load_dwordx4 v[96:99], v2, s[4:7], s51 offen offset:0 sc1
  buffer_load_dwordx4 v[100:103], v2, s[4:7], s51 offen offset:512 sc1
  buffer_load_dwordx4 v[104:107], v2, s[4:7], s51 offen offset:1024 sc1
  buffer_load_dwordx4 v[108:111], v2, s[4:7], s51 offen offset:1536 sc1
  s_add_u32 s51, s41, 14680064
  buffer_load_dwordx2 v[112:113], v3, s[4:7], s51 offen offset:0 sc1
  buffer_load_dwordx2 v[114:115], v3, s[4:7], s51 offen offset:512 sc1
  buffer_load_dwordx2 v[116:117], v3, s[4:7], s51 offen offset:1024 sc1
  buffer_load_dwordx2 v[118:119], v3, s[4:7], s51 offen offset:1536 sc1
  s_waitcnt vmcnt(7)
  v_mfma_f32_16x16x32_bf16 v[120:123], v[96:99], v[16:19], 0
  s_waitcnt vmcnt(6)
  v_mfma_f32_16x16x32_bf16 v[120:123], v[100:103], v[20:23], v[120:123]
  s_waitcnt vmcnt(5)
  v_mfma_f32_16x16x32_bf16 v[120:123], v[104:107], v[24:27], v[120:123]
  s_waitcnt vmcnt(4)
  v_mfma_f32_16x16x32_bf16 v[120:123], v[108:111], v[28:31], v[120:123]
  v_max3_u32 v10, v96, v100, v104
  s_waitcnt vmcnt(0)
  v_max3_u32 v10, v10, v108, v112
  v_max3_u32 v10, v10, v114, v116
  v_max_u32_e64 v10, v10, v118
  v_cmp_eq_u32_e64 vcc, -1, v10
  s_nop 0
  s_cbranch_vccz L_att_k3_x
  s_add_u32 s50, s50, 1
  s_cmp_ge_u32 s50, 262144
  s_cbranch_scc1 L_att_k3_x
  s_branch L_att_k3
L_att_k3_x:
  v_max3_f32 v12, v12, v120, v121
  v_mov_b32 v13, v12
  s_nop 1
  v_permlane32_swap_b32 v12, v13
  v_max_f32 v12, v12, v13
  v_mov_b32 v13, v12
  s_nop 1
  v_permlane16_swap_b32 v12, v13
  v_max_f32 v12, v12, v13
  v_mul_f32_e64 v12, s47, v12
  v_fma_f32 v120, v120, s46, v12
  v_fma_f32 v121, v121, s46, v12
  v_fma_f32 v124, v124, s46, v12
  v_fma_f32 v125, v125, s46, v12
  v_fma_f32 v126, v126, s46, v12
  v_fma_f32 v127, v127, s46, v12
  v_fma_f32 v128, v128, s46, v12
  v_fma_f32 v129, v129, s46, v12
  v_fma_f32 v130, v130, s46, v12
  v_fma_f32 v131, v131, s46, v12
  v_exp_f32 v120, v120
  v_exp_f32 v121, v121
  v_exp_f32 v124, v124
  v_exp_f32 v125, v125
  v_exp_f32 v126, v126
  v_exp_f32 v127, v127
  v_exp_f32_e64 v128, v128
  v_exp_f32 v129, v129
  v_exp_f32 v130, v130
  v_exp_f32_e64 v131, v131
  v_cvt_pk_bf16_f32 v132, v124, v125
  v_cvt_pk_bf16_f32 v133, v126, v127
  v_cvt_pk_bf16_f32 v134, v128, v129
  v_cvt_pk_bf16_f32 v135, v130, v131
  v_cvt_pk_bf16_f32 v136, v120, v121
  v_cvt_pk_bf16_f32 v139, v120, v121
  v_mfma_f32_16x16x32_bf16 v[144:147], v[140:143], v[132:135], 0
  v_mfma_f32_16x16x32_bf16 v[148:151], v[64:67], v[132:135], 0
  v_mfma_f32_16x16x32_bf16 v[152:155], v[68:71], v[132:135], 0
  v_mfma_f32_16x16x32_bf16 v[156:159], v[72:75], v[132:135], 0
  v_mfma_f32_16x16x32_bf16 v[160:163], v[76:79], v[132:135], 0
  v_mfma_f32_16x16x16_bf16 v[144:147], v[140:141], v[136:137], v[144:147]
  v_mfma_f32_16x16x32_bf16 v[164:167], v[80:83], v[132:135], 0
  v_mfma_f32_16x16x32_bf16 v[168:171], v[84:87], v[132:135], 0
  v_mfma_f32_16x16x32_bf16 v[172:175], v[88:91], v[132:135], 0
  v_mfma_f32_16x16x32_bf16 v[176:179], v[92:95], v[132:135], 0
  v_add_u32 v11, s42, v1
  v_mfma_f32_16x16x16_bf16 v[148:151], v[112:113], v[136:137], v[148:151]
  v_rcp_f32 v12, v144
  v_mfma_f32_16x16x16_bf16 v[152:155], v[112:113], v[138:139], v[152:155]
  v_mfma_f32_16x16x16_bf16 v[156:159], v[114:115], v[136:137], v[156:159]
  v_mfma_f32_16x16x16_bf16 v[160:163], v[114:115], v[138:139], v[160:163]
  v_mfma_f32_16x16x16_bf16 v[164:167], v[116:117], v[136:137], v[164:167]
  v_mfma_f32_16x16x16_bf16 v[168:171], v[116:117], v[138:139], v[168:171]
  v_mfma_f32_16x16x16_bf16 v[172:175], v[118:119], v[136:137], v[172:175]
  v_mfma_f32_16x16x16_bf16 v[176:179], v[118:119], v[138:139], v[176:179]
  v_pk_mul_f32 v[148:149], v[148:149], v[12:13] op_sel_hi:[1,0]
  v_pk_mul_f32 v[150:151], v[150:151], v[12:13] op_sel_hi:[1,0]
  v_pk_mul_f32 v[152:153], v[152:153], v[12:13] op_sel_hi:[1,0]
  v_pk_mul_f32 v[154:155], v[154:155], v[12:13] op_sel_hi:[1,0]
  v_cvt_pk_bf16_f32 v148, v148, v149
  v_cvt_pk_bf16_f32 v149, v150, v151
  v_cvt_pk_bf16_f32 v150, v152, v153
  v_cvt_pk_bf16_f32 v151, v154, v155
  ds_write_b128 v11, v[148:151] offset:12288
  v_pk_mul_f32 v[156:157], v[156:157], v[12:13] op_sel_hi:[1,0]
  v_pk_mul_f32 v[158:159], v[158:159], v[12:13] op_sel_hi:[1,0]
  v_pk_mul_f32 v[160:161], v[160:161], v[12:13] op_sel_hi:[1,0]
  v_pk_mul_f32 v[162:163], v[162:163], v[12:13] op_sel_hi:[1,0]
  v_cvt_pk_bf16_f32 v156, v156, v157
  v_cvt_pk_bf16_f32 v157, v158, v159
  v_cvt_pk_bf16_f32 v158, v160, v161
  v_cvt_pk_bf16_f32 v159, v162, v163
  ds_write_b128 v11, v[156:159] offset:13312
  v_pk_mul_f32 v[164:165], v[164:165], v[12:13] op_sel_hi:[1,0]
  v_pk_mul_f32 v[166:167], v[166:167], v[12:13] op_sel_hi:[1,0]
  v_pk_mul_f32 v[168:169], v[168:169], v[12:13] op_sel_hi:[1,0]
  v_pk_mul_f32 v[170:171], v[170:171], v[12:13] op_sel_hi:[1,0]
  v_cvt_pk_bf16_f32 v164, v164, v165
  v_cvt_pk_bf16_f32 v165, v166, v167
  v_cvt_pk_bf16_f32 v166, v168, v169
  v_cvt_pk_bf16_f32 v167, v170, v171
  ds_write_b128 v11, v[164:167] offset:14336
  v_pk_mul_f32 v[172:173], v[172:173], v[12:13] op_sel_hi:[1,0]
  v_pk_mul_f32 v[174:175], v[174:175], v[12:13] op_sel_hi:[1,0]
  v_pk_mul_f32 v[176:177], v[176:177], v[12:13] op_sel_hi:[1,0]
  v_pk_mul_f32 v[178:179], v[178:179], v[12:13] op_sel_hi:[1,0]
  v_cvt_pk_bf16_f32 v172, v172, v173
  v_cvt_pk_bf16_f32 v173, v174, v175
  v_cvt_pk_bf16_f32 v174, v176, v177
  v_cvt_pk_bf16_f32 v175, v178, v179
  ds_write_b128 v11, v[172:175] offset:15360
  s_waitcnt lgkmcnt(0)
  s_barrier
  s_cmp_eq_u32 s39, 0
  s_cbranch_scc1 L_att_l3_ws
  s_cmp_eq_u32 s40, 63
  s_cselect_b32 s34, s38, 0
  s_cmp_eq_u32 s34, 0
  s_cbranch_scc1 L_att_l3_wf
L_att_l3_w0:
  s_cmp_eq_u32 s44, 0
  s_cbranch_scc1 L_att_l3_wh
  ds_read_b128 v[148:151], v11 offset:0
  ds_read_b128 v[156:159], v11 offset:1024
  ds_read_b128 v[164:167], v11 offset:2048
  ds_read_b128 v[172:175], v11 offset:3072
  ds_read_b128 v[180:183], v11 offset:8192
  ds_read_b128 v[188:191], v11 offset:9216
  ds_read_b128 v[196:199], v11 offset:10240
  ds_read_b128 v[204:207], v11 offset:11264
  s_xor_b32 s42, s42, 0x4000
  s_add_u32 s51, s45, 294912
  s_waitcnt lgkmcnt(7)
  v_mfma_f32_16x16x32_bf16 v[96:99], v[224:227], v[148:151], 0
  v_mfma_f32_16x16x32_bf16 v[100:103], a[0:3], v[148:151], 0
  s_waitcnt lgkmcnt(6)
  v_mfma_f32_16x16x32_bf16 v[96:99], v[228:231], v[156:159], v[96:99]
  v_mfma_f32_16x16x32_bf16 v[100:103], a[4:7], v[156:159], v[100:103]
  s_waitcnt lgkmcnt(5)
  v_mfma_f32_16x16x32_bf16 v[96:99], v[232:235], v[164:167], v[96:99]
  v_mfma_f32_16x16x32_bf16 v[100:103], a[8:11], v[164:167], v[100:103]
  s_waitcnt lgkmcnt(4)
  v_mfma_f32_16x16x32_bf16 v[96:99], v[236:239], v[172:175], v[96:99]
  v_mfma_f32_16x16x32_bf16 v[100:103], a[12:15], v[172:175], v[100:103]
  s_waitcnt lgkmcnt(3)
  v_mfma_f32_16x16x32_bf16 v[96:99], v[240:243], v[180:183], v[96:99]
  v_mfma_f32_16x16x32_bf16 v[100:103], a[16:19], v[180:183], v[100:103]
  s_waitcnt lgkmcnt(2)
  v_mfma_f32_16x16x32_bf16 v[96:99], v[244:247], v[188:191], v[96:99]
  v_mfma_f32_16x16x32_bf16 v[100:103], a[20:23], v[188:191], v[100:103]
  s_waitcnt lgkmcnt(1)
  v_mfma_f32_16x16x32_bf16 v[96:99], v[248:251], v[196:199], v[96:99]
  v_mfma_f32_16x16x32_bf16 v[100:103], a[24:27], v[196:199], v[100:103]
  s_waitcnt lgkmcnt(0)
  v_mfma_f32_16x16x32_bf16 v[96:99], v[252:255], v[204:207], v[96:99]
  v_mfma_f32_16x16x32_bf16 v[100:103], a[28:31], v[204:207], v[100:103]
  v_mfma_f32_16x16x32_bf16 v[112:115], a[32:35], v[148:151], 0
  v_mfma_f32_16x16x32_bf16 v[116:119], a[64:67], v[148:151], 0
  v_mfma_f32_16x16x32_bf16 v[112:115], a[36:39], v[156:159], v[112:115]
  v_cvt_pk_bf16_f32 v96, v96, v97
  v_cvt_pk_bf16_f32 v97, v98, v99
  v_mfma_f32_16x16x32_bf16 v[116:119], a[68:71], v[156:159], v[116:119]
  v_cvt_pk_bf16_f32 v98, v100, v101
  v_cvt_pk_bf16_f32 v99, v102, v103
  v_mfma_f32_16x16x32_bf16 v[112:115], a[40:43], v[164:167], v[112:115]
  v_bfi_b32 v96, 1, s60, v96
  v_bfi_b32 v98, 1, s60, v98
  buffer_store_dwordx4 v[96:99], v4, s[4:7], s45 offen offset:384
  v_mfma_f32_16x16x32_bf16 v[116:119], a[72:75], v[164:167], v[116:119]
  v_mfma_f32_16x16x32_bf16 v[112:115], a[44:47], v[172:175], v[112:115]
  v_mfma_f32_16x16x32_bf16 v[116:119], a[76:79], v[172:175], v[116:119]
  v_mfma_f32_16x16x32_bf16 v[112:115], a[48:51], v[180:183], v[112:115]
  v_mfma_f32_16x16x32_bf16 v[116:119], a[80:83], v[180:183], v[116:119]
  v_mfma_f32_16x16x32_bf16 v[112:115], a[52:55], v[188:191], v[112:115]
  v_mfma_f32_16x16x32_bf16 v[116:119], a[84:87], v[188:191], v[116:119]
  v_mfma_f32_16x16x32_bf16 v[112:115], a[56:59], v[196:199], v[112:115]
  v_mfma_f32_16x16x32_bf16 v[116:119], a[88:91], v[196:199], v[116:119]
  v_mfma_f32_16x16x32_bf16 v[112:115], a[60:63], v[204:207], v[112:115]
  v_mfma_f32_16x16x32_bf16 v[116:119], a[92:95], v[204:207], v[116:119]
  v_mfma_f32_16x16x32_bf16 v[96:99], a[96:99], v[148:151], 0
  v_mfma_f32_16x16x32_bf16 v[100:103], a[128:131], v[148:151], 0
  v_mfma_f32_16x16x32_bf16 v[96:99], a[100:103], v[156:159], v[96:99]
  v_cvt_pk_bf16_f32 v112, v112, v113
  v_cvt_pk_bf16_f32 v113, v114, v115
  v_mfma_f32_16x16x32_bf16 v[100:103], a[132:135], v[156:159], v[100:103]
  v_cvt_pk_bf16_f32 v114, v116, v117
  v_cvt_pk_bf16_f32 v115, v118, v119
  v_mfma_f32_16x16x32_bf16 v[96:99], a[104:107], v[164:167], v[96:99]
  v_bfi_b32 v112, 1, s60, v112
  v_bfi_b32 v114, 1, s60, v114
  buffer_store_dwordx4 v[112:115], v4, s[4:7], s45 offen offset:896
  v_mfma_f32_16x16x32_bf16 v[100:103], a[136:139], v[164:167], v[100:103]
  v_mfma_f32_16x16x32_bf16 v[96:99], a[108:111], v[172:175], v[96:99]
  v_mfma_f32_16x16x32_bf16 v[100:103], a[140:143], v[172:175], v[100:103]
  v_mfma_f32_16x16x32_bf16 v[96:99], a[112:115], v[180:183], v[96:99]
  v_mfma_f32_16x16x32_bf16 v[100:103], a[144:147], v[180:183], v[100:103]
  v_mfma_f32_16x16x32_bf16 v[96:99], a[116:119], v[188:191], v[96:99]
  v_mfma_f32_16x16x32_bf16 v[100:103], a[148:151], v[188:191], v[100:103]
  v_mfma_f32_16x16x32_bf16 v[96:99], a[120:123], v[196:199], v[96:99]
  v_mfma_f32_16x16x32_bf16 v[100:103], a[152:155], v[196:199], v[100:103]
  v_mfma_f32_16x16x32_bf16 v[96:99], a[124:127], v[204:207], v[96:99]
  v_mfma_f32_16x16x32_bf16 v[100:103], a[156:159], v[204:207], v[100:103]
  v_mfma_f32_16x16x32_bf16 v[112:115], a[160:163], v[148:151], 0
  v_mfma_f32_16x16x32_bf16 v[116:119], a[192:195], v[148:151], 0
  v_mfma_f32_16x16x32_bf16 v[112:115], a[164:167], v[156:159], v[112:115]
  v_cvt_pk_bf16_f32 v96, v96, v97
  v_cvt_pk_bf16_f32 v97, v98, v99
  v_mfma_f32_16x16x32_bf16 v[116:119], a[196:199], v[156:159], v[116:119]
  v_cvt_pk_bf16_f32 v98, v100, v101
  v_cvt_pk_bf16_f32 v99, v102, v103
  v_mfma_f32_16x16x32_bf16 v[112:115], a[168:171], v[164:167], v[112:115]
  v_bfi_b32 v96, 1, s60, v96
  v_bfi_b32 v98, 1, s60, v98
  buffer_store_dwordx4 v[96:99], v4, s[4:7], s45 offen offset:1408
  v_mfma_f32_16x16x32_bf16 v[116:119], a[200:203], v[164:167], v[116:119]
  v_mfma_f32_16x16x32_bf16 v[112:115], a[172:175], v[172:175], v[112:115]
  v_mfma_f32_16x16x32_bf16 v[116:119], a[204:207], v[172:175], v[116:119]
  v_mfma_f32_16x16x32_bf16 v[112:115], a[176:179], v[180:183], v[112:115]
  v_mfma_f32_16x16x32_bf16 v[116:119], a[208:211], v[180:183], v[116:119]
  v_mfma_f32_16x16x32_bf16 v[112:115], a[180:183], v[188:191], v[112:115]
  v_mfma_f32_16x16x32_bf16 v[116:119], a[212:215], v[188:191], v[116:119]
  v_mfma_f32_16x16x32_bf16 v[112:115], a[184:187], v[196:199], v[112:115]
  v_mfma_f32_16x16x32_bf16 v[116:119], a[216:219], v[196:199], v[116:119]
  v_mfma_f32_16x16x32_bf16 v[112:115], a[188:191], v[204:207], v[112:115]
  v_mfma_f32_16x16x32_bf16 v[116:119], a[220:223], v[204:207], v[116:119]
  v_mfma_f32_16x16x32_bf16 v[96:99], a[224:227], v[148:151], 0
  v_mfma_f32_16x16x32_bf16 v[96:99], a[228:231], v[156:159], v[96:99]
  v_mfma_f32_16x16x32_bf16 v[96:99], a[232:235], v[164:167], v[96:99]
  v_cvt_pk_bf16_f32 v112, v112, v113
  v_cvt_pk_bf16_f32 v113, v114, v115
  v_mfma_f32_16x16x32_bf16 v[96:99], a[236:239], v[172:175], v[96:99]
  v_cvt_pk_bf16_f32 v114, v116, v117
  v_cvt_pk_bf16_f32 v115, v118, v119
  v_mfma_f32_16x16x32_bf16 v[96:99], a[240:243], v[180:183], v[96:99]
  v_bfi_b32 v112, 1, s60, v112
  v_bfi_b32 v114, 1, s60, v114
  buffer_store_dwordx4 v[112:115], v4, s[4:7], s45 offen offset:1920
  v_mfma_f32_16x16x32_bf16 v[96:99], a[244:247], v[188:191], v[96:99]
  v_mfma_f32_16x16x32_bf16 v[96:99], a[248:251], v[196:199], v[96:99]
  v_mfma_f32_16x16x32_bf16 v[96:99], a[252:255], v[204:207], v[96:99]
  s_nop 7
  v_cvt_pk_bf16_f32 v96, v96, v97
  v_cvt_pk_bf16_f32 v97, v98, v99
  v_bfi_b32 v96, 1, s60, v96
  buffer_store_dwordx2 v[96:97], v4, s[4:7], s45 offen offset:2184
  s_branch L_att_l3_wx
L_att_l3_wh:
  s_mov_b32 s45, 73924608
  s_mov_b32 s60, 0
  ds_read_b128 v[152:155], v11 offset:4096
  ds_read_b128 v[160:163], v11 offset:5120
  ds_read_b128 v[168:171], v11 offset:6144
  ds_read_b128 v[176:179], v11 offset:7168
  ds_read_b128 v[184:187], v11 offset:12288
  ds_read_b128 v[192:195], v11 offset:13312
  ds_read_b128 v[200:203], v11 offset:14336
  ds_read_b128 v[208:211], v11 offset:15360
  s_xor_b32 s42, s42, 0x4000
  s_add_u32 s51, s45, 294912
  s_waitcnt lgkmcnt(7)
  v_mfma_f32_16x16x32_bf16 v[104:107], v[224:227], v[152:155], 0
  v_mfma_f32_16x16x32_bf16 v[108:111], a[0:3], v[152:155], 0
  s_waitcnt lgkmcnt(6)
  v_mfma_f32_16x16x32_bf16 v[104:107], v[228:231], v[160:163], v[104:107]
  v_mfma_f32_16x16x32_bf16 v[108:111], a[4:7], v[160:163], v[108:111]
  s_waitcnt lgkmcnt(5)
  v_mfma_f32_16x16x32_bf16 v[104:107], v[232:235], v[168:171], v[104:107]
  v_mfma_f32_16x16x32_bf16 v[108:111], a[8:11], v[168:171], v[108:111]
  s_waitcnt lgkmcnt(4)
  v_mfma_f32_16x16x32_bf16 v[104:107], v[236:239], v[176:179], v[104:107]
  v_mfma_f32_16x16x32_bf16 v[108:111], a[12:15], v[176:179], v[108:111]
  s_waitcnt lgkmcnt(3)
  v_mfma_f32_16x16x32_bf16 v[104:107], v[240:243], v[184:187], v[104:107]
  v_mfma_f32_16x16x32_bf16 v[108:111], a[16:19], v[184:187], v[108:111]
  s_waitcnt lgkmcnt(2)
  v_mfma_f32_16x16x32_bf16 v[104:107], v[244:247], v[192:195], v[104:107]
  v_mfma_f32_16x16x32_bf16 v[108:111], a[20:23], v[192:195], v[108:111]
  s_waitcnt lgkmcnt(1)
  v_mfma_f32_16x16x32_bf16 v[104:107], v[248:251], v[200:203], v[104:107]
  v_mfma_f32_16x16x32_bf16 v[108:111], a[24:27], v[200:203], v[108:111]
  s_waitcnt lgkmcnt(0)
  v_mfma_f32_16x16x32_bf16 v[104:107], v[252:255], v[208:211], v[104:107]
  v_mfma_f32_16x16x32_bf16 v[108:111], a[28:31], v[208:211], v[108:111]
  v_mfma_f32_16x16x32_bf16 v[120:123], a[32:35], v[152:155], 0
  v_mfma_f32_16x16x32_bf16 v[124:127], a[64:67], v[152:155], 0
  v_mfma_f32_16x16x32_bf16 v[120:123], a[36:39], v[160:163], v[120:123]
  v_cvt_pk_bf16_f32 v104, v104, v105
  v_cvt_pk_bf16_f32 v105, v106, v107
  v_mfma_f32_16x16x32_bf16 v[124:127], a[68:71], v[160:163], v[124:127]
  v_cvt_pk_bf16_f32 v106, v108, v109
  v_cvt_pk_bf16_f32 v107, v110, v111
  v_mfma_f32_16x16x32_bf16 v[120:123], a[40:43], v[168:171], v[120:123]
  v_bfi_b32 v104, 1, s60, v104
  v_bfi_b32 v106, 1, s60, v106
  buffer_store_dwordx4 v[104:107], v4, s[4:7], s51 offen offset:384
  v_mfma_f32_16x16x32_bf16 v[124:127], a[72:75], v[168:171], v[124:127]
  v_mfma_f32_16x16x32_bf16 v[120:123], a[44:47], v[176:179], v[120:123]
  v_mfma_f32_16x16x32_bf16 v[124:127], a[76:79], v[176:179], v[124:127]
  v_mfma_f32_16x16x32_bf16 v[120:123], a[48:51], v[184:187], v[120:123]
  v_mfma_f32_16x16x32_bf16 v[124:127], a[80:83], v[184:187], v[124:127]
  v_mfma_f32_16x16x32_bf16 v[120:123], a[52:55], v[192:195], v[120:123]
  v_mfma_f32_16x16x32_bf16 v[124:127], a[84:87], v[192:195], v[124:127]
  v_mfma_f32_16x16x32_bf16 v[120:123], a[56:59], v[200:203], v[120:123]
  v_mfma_f32_16x16x32_bf16 v[124:127], a[88:91], v[200:203], v[124:127]
  v_mfma_f32_16x16x32_bf16 v[120:123], a[60:63], v[208:211], v[120:123]
  v_mfma_f32_16x16x32_bf16 v[124:127], a[92:95], v[208:211], v[124:127]
  v_mfma_f32_16x16x32_bf16 v[104:107], a[96:99], v[152:155], 0
  v_mfma_f32_16x16x32_bf16 v[108:111], a[128:131], v[152:155], 0
  v_mfma_f32_16x16x32_bf16 v[104:107], a[100:103], v[160:163], v[104:107]
  v_cvt_pk_bf16_f32 v120, v120, v121
  v_cvt_pk_bf16_f32 v121, v122, v123
  v_mfma_f32_16x16x32_bf16 v[108:111], a[132:135], v[160:163], v[108:111]
  v_cvt_pk_bf16_f32 v122, v124, v125
  v_cvt_pk_bf16_f32 v123, v126, v127
  v_mfma_f32_16x16x32_bf16 v[104:107], a[104:107], v[168:171], v[104:107]
  v_bfi_b32 v120, 1, s60, v120
  v_bfi_b32 v122, 1, s60, v122
  buffer_store_dwordx4 v[120:123], v4, s[4:7], s51 offen offset:896
  v_mfma_f32_16x16x32_bf16 v[108:111], a[136:139], v[168:171], v[108:111]
  v_mfma_f32_16x16x32_bf16 v[104:107], a[108:111], v[176:179], v[104:107]
  v_mfma_f32_16x16x32_bf16 v[108:111], a[140:143], v[176:179], v[108:111]
  v_mfma_f32_16x16x32_bf16 v[104:107], a[112:115], v[184:187], v[104:107]
  v_mfma_f32_16x16x32_bf16 v[108:111], a[144:147], v[184:187], v[108:111]
  v_mfma_f32_16x16x32_bf16 v[104:107], a[116:119], v[192:195], v[104:107]
  v_mfma_f32_16x16x32_bf16 v[108:111], a[148:151], v[192:195], v[108:111]
  v_mfma_f32_16x16x32_bf16 v[104:107], a[120:123], v[200:203], v[104:107]
  v_mfma_f32_16x16x32_bf16 v[108:111], a[152:155], v[200:203], v[108:111]
  v_mfma_f32_16x16x32_bf16 v[104:107], a[124:127], v[208:211], v[104:107]
  v_mfma_f32_16x16x32_bf16 v[108:111], a[156:159], v[208:211], v[108:111]
  v_mfma_f32_16x16x32_bf16 v[120:123], a[160:163], v[152:155], 0
  v_mfma_f32_16x16x32_bf16 v[124:127], a[192:195], v[152:155], 0
  v_mfma_f32_16x16x32_bf16 v[120:123], a[164:167], v[160:163], v[120:123]
  v_cvt_pk_bf16_f32 v104, v104, v105
  v_cvt_pk_bf16_f32 v105, v106, v107
  v_mfma_f32_16x16x32_bf16 v[124:127], a[196:199], v[160:163], v[124:127]
  v_cvt_pk_bf16_f32 v106, v108, v109
  v_cvt_pk_bf16_f32 v107, v110, v111
  v_mfma_f32_16x16x32_bf16 v[120:123], a[168:171], v[168:171], v[120:123]
  v_bfi_b32 v104, 1, s60, v104
  v_bfi_b32 v106, 1, s60, v106
  buffer_store_dwordx4 v[104:107], v4, s[4:7], s51 offen offset:1408
  v_mfma_f32_16x16x32_bf16 v[124:127], a[200:203], v[168:171], v[124:127]
  v_mfma_f32_16x16x32_bf16 v[120:123], a[172:175], v[176:179], v[120:123]
  v_mfma_f32_16x16x32_bf16 v[124:127], a[204:207], v[176:179], v[124:127]
  v_mfma_f32_16x16x32_bf16 v[120:123], a[176:179], v[184:187], v[120:123]
  v_mfma_f32_16x16x32_bf16 v[124:127], a[208:211], v[184:187], v[124:127]
  v_mfma_f32_16x16x32_bf16 v[120:123], a[180:183], v[192:195], v[120:123]
  v_mfma_f32_16x16x32_bf16 v[124:127], a[212:215], v[192:195], v[124:127]
  v_mfma_f32_16x16x32_bf16 v[120:123], a[184:187], v[200:203], v[120:123]
  v_mfma_f32_16x16x32_bf16 v[124:127], a[216:219], v[200:203], v[124:127]
  v_mfma_f32_16x16x32_bf16 v[120:123], a[188:191], v[208:211], v[120:123]
  v_mfma_f32_16x16x32_bf16 v[124:127], a[220:223], v[208:211], v[124:127]
  v_mfma_f32_16x16x32_bf16 v[104:107], a[224:227], v[152:155], 0
  v_mfma_f32_16x16x32_bf16 v[104:107], a[228:231], v[160:163], v[104:107]
  v_mfma_f32_16x16x32_bf16 v[104:107], a[232:235], v[168:171], v[104:107]
  v_cvt_pk_bf16_f32 v120, v120, v121
  v_cvt_pk_bf16_f32 v121, v122, v123
  v_mfma_f32_16x16x32_bf16 v[104:107], a[236:239], v[176:179], v[104:107]
  v_cvt_pk_bf16_f32 v122, v124, v125
  v_cvt_pk_bf16_f32 v123, v126, v127
  v_mfma_f32_16x16x32_bf16 v[104:107], a[240:243], v[184:187], v[104:107]
  v_bfi_b32 v120, 1, s60, v120
  v_bfi_b32 v122, 1, s60, v122
  buffer_store_dwordx4 v[120:123], v4, s[4:7], s51 offen offset:1920
  v_mfma_f32_16x16x32_bf16 v[104:107], a[244:247], v[192:195], v[104:107]
  v_mfma_f32_16x16x32_bf16 v[104:107], a[248:251], v[200:203], v[104:107]
  v_mfma_f32_16x16x32_bf16 v[104:107], a[252:255], v[208:211], v[104:107]
  s_nop 7
  v_cvt_pk_bf16_f32 v104, v104, v105
  v_cvt_pk_bf16_f32 v105, v106, v107
  v_bfi_b32 v104, 1, s60, v104
  buffer_store_dwordx2 v[104:105], v4, s[4:7], s51 offen offset:2184
  s_branch L_att_l3_end
L_att_l3_wf:
  ds_read_b128 v[148:151], v11 offset:0
  ds_read_b128 v[152:155], v11 offset:4096
  ds_read_b128 v[156:159], v11 offset:1024
  ds_read_b128 v[160:163], v11 offset:5120
  ds_read_b128 v[164:167], v11 offset:2048
  ds_read_b128 v[168:171], v11 offset:6144
  ds_read_b128 v[172:175], v11 offset:3072
  ds_read_b128 v[176:179], v11 offset:7168
  ds_read_b128 v[180:183], v11 offset:8192
  ds_read_b128 v[184:187], v11 offset:12288
  ds_read_b128 v[188:191], v11 offset:9216
  ds_read_b128 v[192:195], v11 offset:13312
  ds_read_b128 v[196:199], v11 offset:10240
  ds_read_b128 v[200:203], v11 offset:14336
  ds_read_b128 v[204:207], v11 offset:11264
  ds_read_b128 v[208:211], v11 offset:15360
  s_xor_b32 s42, s42, 0x4000
  s_add_u32 s51, s45, 294912
  s_waitcnt lgkmcnt(15)
  v_mfma_f32_16x16x32_bf16 v[96:99], v[224:227], v[148:151], 0
  v_mfma_f32_16x16x32_bf16 v[100:103], a[0:3], v[148:151], 0
  s_waitcnt lgkmcnt(14)
  v_mfma_f32_16x16x32_bf16 v[104:107], v[224:227], v[152:155], 0
  v_mfma_f32_16x16x32_bf16 v[108:111], a[0:3], v[152:155], 0
  s_waitcnt lgkmcnt(13)
  v_mfma_f32_16x16x32_bf16 v[96:99], v[228:231], v[156:159], v[96:99]
  v_mfma_f32_16x16x32_bf16 v[100:103], a[4:7], v[156:159], v[100:103]
  s_waitcnt lgkmcnt(12)
  v_mfma_f32_16x16x32_bf16 v[104:107], v[228:231], v[160:163], v[104:107]
  v_mfma_f32_16x16x32_bf16 v[108:111], a[4:7], v[160:163], v[108:111]
  s_waitcnt lgkmcnt(11)
  v_mfma_f32_16x16x32_bf16 v[96:99], v[232:235], v[164:167], v[96:99]
  v_mfma_f32_16x16x32_bf16 v[100:103], a[8:11], v[164:167], v[100:103]
  s_waitcnt lgkmcnt(10)
  v_mfma_f32_16x16x32_bf16 v[104:107], v[232:235], v[168:171], v[104:107]
  v_mfma_f32_16x16x32_bf16 v[108:111], a[8:11], v[168:171], v[108:111]
  s_waitcnt lgkmcnt(9)
  v_mfma_f32_16x16x32_bf16 v[96:99], v[236:239], v[172:175], v[96:99]
  v_mfma_f32_16x16x32_bf16 v[100:103], a[12:15], v[172:175], v[100:103]
  s_waitcnt lgkmcnt(8)
  v_mfma_f32_16x16x32_bf16 v[104:107], v[236:239], v[176:179], v[104:107]
  v_mfma_f32_16x16x32_bf16 v[108:111], a[12:15], v[176:179], v[108:111]
  s_waitcnt lgkmcnt(7)
  v_mfma_f32_16x16x32_bf16 v[96:99], v[240:243], v[180:183], v[96:99]
  v_mfma_f32_16x16x32_bf16 v[100:103], a[16:19], v[180:183], v[100:103]
  s_waitcnt lgkmcnt(6)
  v_mfma_f32_16x16x32_bf16 v[104:107], v[240:243], v[184:187], v[104:107]
  v_mfma_f32_16x16x32_bf16 v[108:111], a[16:19], v[184:187], v[108:111]
  s_waitcnt lgkmcnt(5)
  v_mfma_f32_16x16x32_bf16 v[96:99], v[244:247], v[188:191], v[96:99]
  v_mfma_f32_16x16x32_bf16 v[100:103], a[20:23], v[188:191], v[100:103]
  s_waitcnt lgkmcnt(4)
  v_mfma_f32_16x16x32_bf16 v[104:107], v[244:247], v[192:195], v[104:107]
  v_mfma_f32_16x16x32_bf16 v[108:111], a[20:23], v[192:195], v[108:111]
  s_waitcnt lgkmcnt(3)
  v_mfma_f32_16x16x32_bf16 v[96:99], v[248:251], v[196:199], v[96:99]
  v_mfma_f32_16x16x32_bf16 v[100:103], a[24:27], v[196:199], v[100:103]
  s_waitcnt lgkmcnt(2)
  v_mfma_f32_16x16x32_bf16 v[104:107], v[248:251], v[200:203], v[104:107]
  v_mfma_f32_16x16x32_bf16 v[108:111], a[24:27], v[200:203], v[108:111]
  s_waitcnt lgkmcnt(1)
  v_mfma_f32_16x16x32_bf16 v[96:99], v[252:255], v[204:207], v[96:99]
  v_mfma_f32_16x16x32_bf16 v[100:103], a[28:31], v[204:207], v[100:103]
  s_waitcnt lgkmcnt(0)
  v_mfma_f32_16x16x32_bf16 v[104:107], v[252:255], v[208:211], v[104:107]
  v_mfma_f32_16x16x32_bf16 v[108:111], a[28:31], v[208:211], v[108:111]
  v_mfma_f32_16x16x32_bf16 v[112:115], a[32:35], v[148:151], 0
  v_mfma_f32_16x16x32_bf16 v[116:119], a[64:67], v[148:151], 0
  v_mfma_f32_16x16x32_bf16 v[120:123], a[32:35], v[152:155], 0
  v_cvt_pk_bf16_f32 v96, v96, v97
  v_cvt_pk_bf16_f32 v97, v98, v99
  v_mfma_f32_16x16x32_bf16 v[124:127], a[64:67], v[152:155], 0
  v_cvt_pk_bf16_f32 v98, v100, v101
  v_cvt_pk_bf16_f32 v99, v102, v103
  v_mfma_f32_16x16x32_bf16 v[112:115], a[36:39], v[156:159], v[112:115]
  v_bfi_b32 v96, 1, s60, v96
  v_bfi_b32 v98, 1, s60, v98
  buffer_store_dwordx4 v[96:99], v4, s[4:7], s45 offen offset:384
  v_mfma_f32_16x16x32_bf16 v[116:119], a[68:71], v[156:159], v[116:119]
  v_cvt_pk_bf16_f32 v104, v104, v105
  v_cvt_pk_bf16_f32 v105, v106, v107
  v_mfma_f32_16x16x32_bf16 v[120:123], a[36:39], v[160:163], v[120:123]
  v_cvt_pk_bf16_f32 v106, v108, v109
  v_cvt_pk_bf16_f32 v107, v110, v111
  v_mfma_f32_16x16x32_bf16 v[124:127], a[68:71], v[160:163], v[124:127]
  v_bfi_b32 v104, 1, s60, v104
  v_bfi_b32 v106, 1, s60, v106
  buffer_store_dwordx4 v[104:107], v4, s[4:7], s51 offen offset:384
  v_mfma_f32_16x16x32_bf16 v[112:115], a[40:43], v[164:167], v[112:115]
  v_mfma_f32_16x16x32_bf16 v[116:119], a[72:75], v[164:167], v[116:119]
  v_mfma_f32_16x16x32_bf16 v[120:123], a[40:43], v[168:171], v[120:123]
  v_mfma_f32_16x16x32_bf16 v[124:127], a[72:75], v[168:171], v[124:127]
  v_mfma_f32_16x16x32_bf16 v[112:115], a[44:47], v[172:175], v[112:115]
  v_mfma_f32_16x16x32_bf16 v[116:119], a[76:79], v[172:175], v[116:119]
  v_mfma_f32_16x16x32_bf16 v[120:123], a[44:47], v[176:179], v[120:123]
  v_mfma_f32_16x16x32_bf16 v[124:127], a[76:79], v[176:179], v[124:127]
  v_mfma_f32_16x16x32_bf16 v[112:115], a[48:51], v[180:183], v[112:115]
  v_mfma_f32_16x16x32_bf16 v[116:119], a[80:83], v[180:183], v[116:119]
  v_mfma_f32_16x16x32_bf16 v[120:123], a[48:51], v[184:187], v[120:123]
  v_mfma_f32_16x16x32_bf16 v[124:127], a[80:83], v[184:187], v[124:127]
  v_mfma_f32_16x16x32_bf16 v[112:115], a[52:55], v[188:191], v[112:115]
  v_mfma_f32_16x16x32_bf16 v[116:119], a[84:87], v[188:191], v[116:119]
  v_mfma_f32_16x16x32_bf16 v[120:123], a[52:55], v[192:195], v[120:123]
  v_mfma_f32_16x16x32_bf16 v[124:127], a[84:87], v[192:195], v[124:127]
  v_mfma_f32_16x16x32_bf16 v[112:115], a[56:59], v[196:199], v[112:115]
  v_mfma_f32_16x16x32_bf16 v[116:119], a[88:91], v[196:199], v[116:119]
  v_mfma_f32_16x16x32_bf16 v[120:123], a[56:59], v[200:203], v[120:123]
  v_mfma_f32_16x16x32_bf16 v[124:127], a[88:91], v[200:203], v[124:127]
  v_mfma_f32_16x16x32_bf16 v[112:115], a[60:63], v[204:207], v[112:115]
  v_mfma_f32_16x16x32_bf16 v[116:119], a[92:95], v[204:207], v[116:119]
  v_mfma_f32_16x16x32_bf16 v[120:123], a[60:63], v[208:211], v[120:123]
  v_mfma_f32_16x16x32_bf16 v[124:127], a[92:95], v[208:211], v[124:127]
  v_mfma_f32_16x16x32_bf16 v[96:99], a[96:99], v[148:151], 0
  v_mfma_f32_16x16x32_bf16 v[100:103], a[128:131], v[148:151], 0
  v_mfma_f32_16x16x32_bf16 v[104:107], a[96:99], v[152:155], 0
  v_cvt_pk_bf16_f32 v112, v112, v113
  v_cvt_pk_bf16_f32 v113, v114, v115
  v_mfma_f32_16x16x32_bf16 v[108:111], a[128:131], v[152:155], 0
  v_cvt_pk_bf16_f32 v114, v116, v117
  v_cvt_pk_bf16_f32 v115, v118, v119
  v_mfma_f32_16x16x32_bf16 v[96:99], a[100:103], v[156:159], v[96:99]
  v_bfi_b32 v112, 1, s60, v112
  v_bfi_b32 v114, 1, s60, v114
  buffer_store_dwordx4 v[112:115], v4, s[4:7], s45 offen offset:896
  v_mfma_f32_16x16x32_bf16 v[100:103], a[132:135], v[156:159], v[100:103]
  v_cvt_pk_bf16_f32 v120, v120, v121
  v_cvt_pk_bf16_f32 v121, v122, v123
  v_mfma_f32_16x16x32_bf16 v[104:107], a[100:103], v[160:163], v[104:107]
  v_cvt_pk_bf16_f32 v122, v124, v125
  v_cvt_pk_bf16_f32 v123, v126, v127
  v_mfma_f32_16x16x32_bf16 v[108:111], a[132:135], v[160:163], v[108:111]
  v_bfi_b32 v120, 1, s60, v120
  v_bfi_b32 v122, 1, s60, v122
  buffer_store_dwordx4 v[120:123], v4, s[4:7], s51 offen offset:896
  v_mfma_f32_16x16x32_bf16 v[96:99], a[104:107], v[164:167], v[96:99]
  v_mfma_f32_16x16x32_bf16 v[100:103], a[136:139], v[164:167], v[100:103]
  v_mfma_f32_16x16x32_bf16 v[104:107], a[104:107], v[168:171], v[104:107]
  v_mfma_f32_16x16x32_bf16 v[108:111], a[136:139], v[168:171], v[108:111]
  v_mfma_f32_16x16x32_bf16 v[96:99], a[108:111], v[172:175], v[96:99]
  v_mfma_f32_16x16x32_bf16 v[100:103], a[140:143], v[172:175], v[100:103]
  v_mfma_f32_16x16x32_bf16 v[104:107], a[108:111], v[176:179], v[104:107]
  v_mfma_f32_16x16x32_bf16 v[108:111], a[140:143], v[176:179], v[108:111]
  v_mfma_f32_16x16x32_bf16 v[96:99], a[112:115], v[180:183], v[96:99]
  v_mfma_f32_16x16x32_bf16 v[100:103], a[144:147], v[180:183], v[100:103]
  v_mfma_f32_16x16x32_bf16 v[104:107], a[112:115], v[184:187], v[104:107]
  v_mfma_f32_16x16x32_bf16 v[108:111], a[144:147], v[184:187], v[108:111]
  v_mfma_f32_16x16x32_bf16 v[96:99], a[116:119], v[188:191], v[96:99]
  v_mfma_f32_16x16x32_bf16 v[100:103], a[148:151], v[188:191], v[100:103]
  v_mfma_f32_16x16x32_bf16 v[104:107], a[116:119], v[192:195], v[104:107]
  v_mfma_f32_16x16x32_bf16 v[108:111], a[148:151], v[192:195], v[108:111]
  v_mfma_f32_16x16x32_bf16 v[96:99], a[120:123], v[196:199], v[96:99]
  v_mfma_f32_16x16x32_bf16 v[100:103], a[152:155], v[196:199], v[100:103]
  v_mfma_f32_16x16x32_bf16 v[104:107], a[120:123], v[200:203], v[104:107]
  v_mfma_f32_16x16x32_bf16 v[108:111], a[152:155], v[200:203], v[108:111]
  v_mfma_f32_16x16x32_bf16 v[96:99], a[124:127], v[204:207], v[96:99]
  v_mfma_f32_16x16x32_bf16 v[100:103], a[156:159], v[204:207], v[100:103]
  v_mfma_f32_16x16x32_bf16 v[104:107], a[124:127], v[208:211], v[104:107]
  v_mfma_f32_16x16x32_bf16 v[108:111], a[156:159], v[208:211], v[108:111]
  v_mfma_f32_16x16x32_bf16 v[112:115], a[160:163], v[148:151], 0
  v_mfma_f32_16x16x32_bf16 v[116:119], a[192:195], v[148:151], 0
  v_mfma_f32_16x16x32_bf16 v[120:123], a[160:163], v[152:155], 0
  v_cvt_pk_bf16_f32 v96, v96, v97
  v_cvt_pk_bf16_f32 v97, v98, v99
  v_mfma_f32_16x16x32_bf16 v[124:127], a[192:195], v[152:155], 0
  v_cvt_pk_bf16_f32 v98, v100, v101
  v_cvt_pk_bf16_f32 v99, v102, v103
  v_mfma_f32_16x16x32_bf16 v[112:115], a[164:167], v[156:159], v[112:115]
  v_bfi_b32 v96, 1, s60, v96
  v_bfi_b32 v98, 1, s60, v98
  buffer_store_dwordx4 v[96:99], v4, s[4:7], s45 offen offset:1408
  v_mfma_f32_16x16x32_bf16 v[116:119], a[196:199], v[156:159], v[116:119]
  v_cvt_pk_bf16_f32 v104, v104, v105
  v_cvt_pk_bf16_f32 v105, v106, v107
  v_mfma_f32_16x16x32_bf16 v[120:123], a[164:167], v[160:163], v[120:123]
  v_cvt_pk_bf16_f32 v106, v108, v109
  v_cvt_pk_bf16_f32 v107, v110, v111
  v_mfma_f32_16x16x32_bf16 v[124:127], a[196:199], v[160:163], v[124:127]
  v_bfi_b32 v104, 1, s60, v104
  v_bfi_b32 v106, 1, s60, v106
  buffer_store_dwordx4 v[104:107], v4, s[4:7], s51 offen offset:1408
  v_mfma_f32_16x16x32_bf16 v[112:115], a[168:171], v[164:167], v[112:115]
  v_mfma_f32_16x16x32_bf16 v[116:119], a[200:203], v[164:167], v[116:119]
  v_mfma_f32_16x16x32_bf16 v[120:123], a[168:171], v[168:171], v[120:123]
  v_mfma_f32_16x16x32_bf16 v[124:127], a[200:203], v[168:171], v[124:127]
  v_mfma_f32_16x16x32_bf16 v[112:115], a[172:175], v[172:175], v[112:115]
  v_mfma_f32_16x16x32_bf16 v[116:119], a[204:207], v[172:175], v[116:119]
  v_mfma_f32_16x16x32_bf16 v[120:123], a[172:175], v[176:179], v[120:123]
  v_mfma_f32_16x16x32_bf16 v[124:127], a[204:207], v[176:179], v[124:127]
  v_mfma_f32_16x16x32_bf16 v[112:115], a[176:179], v[180:183], v[112:115]
  v_mfma_f32_16x16x32_bf16 v[116:119], a[208:211], v[180:183], v[116:119]
  v_mfma_f32_16x16x32_bf16 v[120:123], a[176:179], v[184:187], v[120:123]
  v_mfma_f32_16x16x32_bf16 v[124:127], a[208:211], v[184:187], v[124:127]
  v_mfma_f32_16x16x32_bf16 v[112:115], a[180:183], v[188:191], v[112:115]
  v_mfma_f32_16x16x32_bf16 v[116:119], a[212:215], v[188:191], v[116:119]
  v_mfma_f32_16x16x32_bf16 v[120:123], a[180:183], v[192:195], v[120:123]
  v_mfma_f32_16x16x32_bf16 v[124:127], a[212:215], v[192:195], v[124:127]
  v_mfma_f32_16x16x32_bf16 v[112:115], a[184:187], v[196:199], v[112:115]
  v_mfma_f32_16x16x32_bf16 v[116:119], a[216:219], v[196:199], v[116:119]
  v_mfma_f32_16x16x32_bf16 v[120:123], a[184:187], v[200:203], v[120:123]
  v_mfma_f32_16x16x32_bf16 v[124:127], a[216:219], v[200:203], v[124:127]
  v_mfma_f32_16x16x32_bf16 v[112:115], a[188:191], v[204:207], v[112:115]
  v_mfma_f32_16x16x32_bf16 v[116:119], a[220:223], v[204:207], v[116:119]
  v_mfma_f32_16x16x32_bf16 v[120:123], a[188:191], v[208:211], v[120:123]
  v_mfma_f32_16x16x32_bf16 v[124:127], a[220:223], v[208:211], v[124:127]
  v_mfma_f32_16x16x32_bf16 v[96:99], a[224:227], v[148:151], 0
  v_mfma_f32_16x16x32_bf16 v[104:107], a[224:227], v[152:155], 0
  v_mfma_f32_16x16x32_bf16 v[96:99], a[228:231], v[156:159], v[96:99]
  v_cvt_pk_bf16_f32 v112, v112, v113
  v_cvt_pk_bf16_f32 v113, v114, v115
  v_mfma_f32_16x16x32_bf16 v[104:107], a[228:231], v[160:163], v[104:107]
  v_cvt_pk_bf16_f32 v114, v116, v117
  v_cvt_pk_bf16_f32 v115, v118, v119
  v_mfma_f32_16x16x32_bf16 v[96:99], a[232:235], v[164:167], v[96:99]
  v_bfi_b32 v112, 1, s60, v112
  v_bfi_b32 v114, 1, s60, v114
  buffer_store_dwordx4 v[112:115], v4, s[4:7], s45 offen offset:1920
  v_mfma_f32_16x16x32_bf16 v[104:107], a[232:235], v[168:171], v[104:107]
  v_cvt_pk_bf16_f32 v120, v120, v121
  v_cvt_pk_bf16_f32 v121, v122, v123
  v_mfma_f32_16x16x32_bf16 v[96:99], a[236:239], v[172:175], v[96:99]
  v_cvt_pk_bf16_f32 v122, v124, v125
  v_cvt_pk_bf16_f32 v123, v126, v127
  v_mfma_f32_16x16x32_bf16 v[104:107], a[236:239], v[176:179], v[104:107]
  v_bfi_b32 v120, 1, s60, v120
  v_bfi_b32 v122, 1, s60, v122
  buffer_store_dwordx4 v[120:123], v4, s[4:7], s51 offen offset:1920
  v_mfma_f32_16x16x32_bf16 v[96:99], a[240:243], v[180:183], v[96:99]
  v_mfma_f32_16x16x32_bf16 v[104:107], a[240:243], v[184:187], v[104:107]
  v_mfma_f32_16x16x32_bf16 v[96:99], a[244:247], v[188:191], v[96:99]
  v_mfma_f32_16x16x32_bf16 v[104:107], a[244:247], v[192:195], v[104:107]
  v_mfma_f32_16x16x32_bf16 v[96:99], a[248:251], v[196:199], v[96:99]
  v_mfma_f32_16x16x32_bf16 v[104:107], a[248:251], v[200:203], v[104:107]
  v_mfma_f32_16x16x32_bf16 v[96:99], a[252:255], v[204:207], v[96:99]
  v_mfma_f32_16x16x32_bf16 v[104:107], a[252:255], v[208:211], v[104:107]
  s_nop 4
  v_cvt_pk_bf16_f32 v96, v96, v97
  v_cvt_pk_bf16_f32 v97, v98, v99
  v_bfi_b32 v96, 1, s60, v96
  buffer_store_dwordx2 v[96:97], v4, s[4:7], s45 offen offset:2184
  v_cvt_pk_bf16_f32 v104, v104, v105
  v_cvt_pk_bf16_f32 v105, v106, v107
  v_bfi_b32 v104, 1, s60, v104
  buffer_store_dwordx2 v[104:105], v4, s[4:7], s51 offen offset:2184
  s_branch L_att_l3_wx
L_att_l3_ws:
  ds_read_b128 v[148:151], v11 offset:0
  ds_read_b128 v[152:155], v11 offset:4096
  ds_read_b128 v[156:159], v11 offset:1024
  ds_read_b128 v[160:163], v11 offset:5120
  ds_read_b128 v[164:167], v11 offset:2048
  ds_read_b128 v[168:171], v11 offset:6144
  ds_read_b128 v[172:175], v11 offset:3072
  ds_read_b128 v[176:179], v11 offset:7168
  ds_read_b128 v[180:183], v11 offset:8192
  ds_read_b128 v[184:187], v11 offset:12288
  ds_read_b128 v[188:191], v11 offset:9216
  ds_read_b128 v[192:195], v11 offset:13312
  ds_read_b128 v[196:199], v11 offset:10240
  ds_read_b128 v[200:203], v11 offset:14336
  ds_read_b128 v[204:207], v11 offset:11264
  ds_read_b128 v[208:211], v11 offset:15360
  s_xor_b32 s42, s42, 0x4000
  s_add_u32 s51, s45, 294912
  s_waitcnt lgkmcnt(15)
  v_mfma_f32_16x16x32_bf16 v[96:99], v[224:227], v[148:151], 0
  v_mfma_f32_16x16x32_bf16 v[100:103], a[0:3], v[148:151], 0
  s_waitcnt lgkmcnt(14)
  v_mfma_f32_16x16x32_bf16 v[104:107], v[224:227], v[152:155], 0
  v_mfma_f32_16x16x32_bf16 v[108:111], a[0:3], v[152:155], 0
  s_waitcnt lgkmcnt(13)
  v_mfma_f32_16x16x32_bf16 v[96:99], v[228:231], v[156:159], v[96:99]
  v_mfma_f32_16x16x32_bf16 v[100:103], a[4:7], v[156:159], v[100:103]
  s_waitcnt lgkmcnt(12)
  v_mfma_f32_16x16x32_bf16 v[104:107], v[228:231], v[160:163], v[104:107]
  v_mfma_f32_16x16x32_bf16 v[108:111], a[4:7], v[160:163], v[108:111]
  s_waitcnt lgkmcnt(11)
  v_mfma_f32_16x16x32_bf16 v[96:99], v[232:235], v[164:167], v[96:99]
  v_mfma_f32_16x16x32_bf16 v[100:103], a[8:11], v[164:167], v[100:103]
  s_waitcnt lgkmcnt(10)
  v_mfma_f32_16x16x32_bf16 v[104:107], v[232:235], v[168:171], v[104:107]
  v_mfma_f32_16x16x32_bf16 v[108:111], a[8:11], v[168:171], v[108:111]
  s_waitcnt lgkmcnt(9)
  v_mfma_f32_16x16x32_bf16 v[96:99], v[236:239], v[172:175], v[96:99]
  v_mfma_f32_16x16x32_bf16 v[100:103], a[12:15], v[172:175], v[100:103]
  s_waitcnt lgkmcnt(8)
  v_mfma_f32_16x16x32_bf16 v[104:107], v[236:239], v[176:179], v[104:107]
  v_mfma_f32_16x16x32_bf16 v[108:111], a[12:15], v[176:179], v[108:111]
  s_waitcnt lgkmcnt(7)
  v_mfma_f32_16x16x32_bf16 v[96:99], v[240:243], v[180:183], v[96:99]
  v_mfma_f32_16x16x32_bf16 v[100:103], a[16:19], v[180:183], v[100:103]
  s_waitcnt lgkmcnt(6)
  v_mfma_f32_16x16x32_bf16 v[104:107], v[240:243], v[184:187], v[104:107]
  v_mfma_f32_16x16x32_bf16 v[108:111], a[16:19], v[184:187], v[108:111]
  s_waitcnt lgkmcnt(5)
  v_mfma_f32_16x16x32_bf16 v[96:99], v[244:247], v[188:191], v[96:99]
  v_mfma_f32_16x16x32_bf16 v[100:103], a[20:23], v[188:191], v[100:103]
  s_waitcnt lgkmcnt(4)
  v_mfma_f32_16x16x32_bf16 v[104:107], v[244:247], v[192:195], v[104:107]
  v_mfma_f32_16x16x32_bf16 v[108:111], a[20:23], v[192:195], v[108:111]
  s_waitcnt lgkmcnt(3)
  v_mfma_f32_16x16x32_bf16 v[96:99], v[248:251], v[196:199], v[96:99]
  v_mfma_f32_16x16x32_bf16 v[100:103], a[24:27], v[196:199], v[100:103]
  s_waitcnt lgkmcnt(2)
  v_mfma_f32_16x16x32_bf16 v[104:107], v[248:251], v[200:203], v[104:107]
  v_mfma_f32_16x16x32_bf16 v[108:111], a[24:27], v[200:203], v[108:111]
  s_waitcnt lgkmcnt(1)
  v_mfma_f32_16x16x32_bf16 v[96:99], v[252:255], v[204:207], v[96:99]
  v_mfma_f32_16x16x32_bf16 v[100:103], a[28:31], v[204:207], v[100:103]
  s_waitcnt lgkmcnt(0)
  v_mfma_f32_16x16x32_bf16 v[104:107], v[252:255], v[208:211], v[104:107]
  v_mfma_f32_16x16x32_bf16 v[108:111], a[28:31], v[208:211], v[108:111]
  v_mfma_f32_16x16x32_bf16 v[112:115], a[32:35], v[148:151], 0
  v_mfma_f32_16x16x32_bf16 v[116:119], a[64:67], v[148:151], 0
  v_mfma_f32_16x16x32_bf16 v[120:123], a[32:35], v[152:155], 0
  v_cvt_pk_bf16_f32 v96, v96, v97
  v_cvt_pk_bf16_f32 v97, v98, v99
  v_mfma_f32_16x16x32_bf16 v[124:127], a[64:67], v[152:155], 0
  v_cvt_pk_bf16_f32 v98, v100, v101
  v_cvt_pk_bf16_f32 v99, v102, v103
  v_mfma_f32_16x16x32_bf16 v[112:115], a[36:39], v[156:159], v[112:115]
  v_bfi_b32 v96, 1, s60, v96
  v_bfi_b32 v98, 1, s60, v98
  buffer_store_dwordx4 v[96:99], v4, s[4:7], s45 offen offset:384 sc1
  v_mfma_f32_16x16x32_bf16 v[116:119], a[68:71], v[156:159], v[116:119]
  v_cvt_pk_bf16_f32 v104, v104, v105
  v_cvt_pk_bf16_f32 v105, v106, v107
  v_mfma_f32_16x16x32_bf16 v[120:123], a[36:39], v[160:163], v[120:123]
  v_cvt_pk_bf16_f32 v106, v108, v109
  v_cvt_pk_bf16_f32 v107, v110, v111
  v_mfma_f32_16x16x32_bf16 v[124:127], a[68:71], v[160:163], v[124:127]
  v_bfi_b32 v104, 1, s60, v104
  v_bfi_b32 v106, 1, s60, v106
  buffer_store_dwordx4 v[104:107], v4, s[4:7], s51 offen offset:384 sc1
  v_mfma_f32_16x16x32_bf16 v[112:115], a[40:43], v[164:167], v[112:115]
  v_mfma_f32_16x16x32_bf16 v[116:119], a[72:75], v[164:167], v[116:119]
  v_mfma_f32_16x16x32_bf16 v[120:123], a[40:43], v[168:171], v[120:123]
  v_mfma_f32_16x16x32_bf16 v[124:127], a[72:75], v[168:171], v[124:127]
  v_mfma_f32_16x16x32_bf16 v[112:115], a[44:47], v[172:175], v[112:115]
  v_mfma_f32_16x16x32_bf16 v[116:119], a[76:79], v[172:175], v[116:119]
  v_mfma_f32_16x16x32_bf16 v[120:123], a[44:47], v[176:179], v[120:123]
  v_mfma_f32_16x16x32_bf16 v[124:127], a[76:79], v[176:179], v[124:127]
  v_mfma_f32_16x16x32_bf16 v[112:115], a[48:51], v[180:183], v[112:115]
  v_mfma_f32_16x16x32_bf16 v[116:119], a[80:83], v[180:183], v[116:119]
  v_mfma_f32_16x16x32_bf16 v[120:123], a[48:51], v[184:187], v[120:123]
  v_mfma_f32_16x16x32_bf16 v[124:127], a[80:83], v[184:187], v[124:127]
  v_mfma_f32_16x16x32_bf16 v[112:115], a[52:55], v[188:191], v[112:115]
  v_mfma_f32_16x16x32_bf16 v[116:119], a[84:87], v[188:191], v[116:119]
  v_mfma_f32_16x16x32_bf16 v[120:123], a[52:55], v[192:195], v[120:123]
  v_mfma_f32_16x16x32_bf16 v[124:127], a[84:87], v[192:195], v[124:127]
  v_mfma_f32_16x16x32_bf16 v[112:115], a[56:59], v[196:199], v[112:115]
  v_mfma_f32_16x16x32_bf16 v[116:119], a[88:91], v[196:199], v[116:119]
  v_mfma_f32_16x16x32_bf16 v[120:123], a[56:59], v[200:203], v[120:123]
  v_mfma_f32_16x16x32_bf16 v[124:127], a[88:91], v[200:203], v[124:127]
  v_mfma_f32_16x16x32_bf16 v[112:115], a[60:63], v[204:207], v[112:115]
  v_mfma_f32_16x16x32_bf16 v[116:119], a[92:95], v[204:207], v[116:119]
  v_mfma_f32_16x16x32_bf16 v[120:123], a[60:63], v[208:211], v[120:123]
  v_mfma_f32_16x16x32_bf16 v[124:127], a[92:95], v[208:211], v[124:127]
  v_mfma_f32_16x16x32_bf16 v[96:99], a[96:99], v[148:151], 0
  v_mfma_f32_16x16x32_bf16 v[100:103], a[128:131], v[148:151], 0
  v_mfma_f32_16x16x32_bf16 v[104:107], a[96:99], v[152:155], 0
  v_cvt_pk_bf16_f32 v112, v112, v113
  v_cvt_pk_bf16_f32 v113, v114, v115
  v_mfma_f32_16x16x32_bf16 v[108:111], a[128:131], v[152:155], 0
  v_cvt_pk_bf16_f32 v114, v116, v117
  v_cvt_pk_bf16_f32 v115, v118, v119
  v_mfma_f32_16x16x32_bf16 v[96:99], a[100:103], v[156:159], v[96:99]
  v_bfi_b32 v112, 1, s60, v112
  v_bfi_b32 v114, 1, s60, v114
  buffer_store_dwordx4 v[112:115], v4, s[4:7], s45 offen offset:896 sc1
  v_mfma_f32_16x16x32_bf16 v[100:103], a[132:135], v[156:159], v[100:103]
  v_cvt_pk_bf16_f32 v120, v120, v121
  v_cvt_pk_bf16_f32 v121, v122, v123
  v_mfma_f32_16x16x32_bf16 v[104:107], a[100:103], v[160:163], v[104:107]
  v_cvt_pk_bf16_f32 v122, v124, v125
  v_cvt_pk_bf16_f32 v123, v126, v127
  v_mfma_f32_16x16x32_bf16 v[108:111], a[132:135], v[160:163], v[108:111]
  v_bfi_b32 v120, 1, s60, v120
  v_bfi_b32 v122, 1, s60, v122
  buffer_store_dwordx4 v[120:123], v4, s[4:7], s51 offen offset:896 sc1
  v_mfma_f32_16x16x32_bf16 v[96:99], a[104:107], v[164:167], v[96:99]
  v_mfma_f32_16x16x32_bf16 v[100:103], a[136:139], v[164:167], v[100:103]
  v_mfma_f32_16x16x32_bf16 v[104:107], a[104:107], v[168:171], v[104:107]
  v_mfma_f32_16x16x32_bf16 v[108:111], a[136:139], v[168:171], v[108:111]
  v_mfma_f32_16x16x32_bf16 v[96:99], a[108:111], v[172:175], v[96:99]
  v_mfma_f32_16x16x32_bf16 v[100:103], a[140:143], v[172:175], v[100:103]
  v_mfma_f32_16x16x32_bf16 v[104:107], a[108:111], v[176:179], v[104:107]
  v_mfma_f32_16x16x32_bf16 v[108:111], a[140:143], v[176:179], v[108:111]
  v_mfma_f32_16x16x32_bf16 v[96:99], a[112:115], v[180:183], v[96:99]
  v_mfma_f32_16x16x32_bf16 v[100:103], a[144:147], v[180:183], v[100:103]
  v_mfma_f32_16x16x32_bf16 v[104:107], a[112:115], v[184:187], v[104:107]
  v_mfma_f32_16x16x32_bf16 v[108:111], a[144:147], v[184:187], v[108:111]
  v_mfma_f32_16x16x32_bf16 v[96:99], a[116:119], v[188:191], v[96:99]
  v_mfma_f32_16x16x32_bf16 v[100:103], a[148:151], v[188:191], v[100:103]
  v_mfma_f32_16x16x32_bf16 v[104:107], a[116:119], v[192:195], v[104:107]
  v_mfma_f32_16x16x32_bf16 v[108:111], a[148:151], v[192:195], v[108:111]
  v_mfma_f32_16x16x32_bf16 v[96:99], a[120:123], v[196:199], v[96:99]
  v_mfma_f32_16x16x32_bf16 v[100:103], a[152:155], v[196:199], v[100:103]
  v_mfma_f32_16x16x32_bf16 v[104:107], a[120:123], v[200:203], v[104:107]
  v_mfma_f32_16x16x32_bf16 v[108:111], a[152:155], v[200:203], v[108:111]
  v_mfma_f32_16x16x32_bf16 v[96:99], a[124:127], v[204:207], v[96:99]
  v_mfma_f32_16x16x32_bf16 v[100:103], a[156:159], v[204:207], v[100:103]
  v_mfma_f32_16x16x32_bf16 v[104:107], a[124:127], v[208:211], v[104:107]
  v_mfma_f32_16x16x32_bf16 v[108:111], a[156:159], v[208:211], v[108:111]
  v_mfma_f32_16x16x32_bf16 v[112:115], a[160:163], v[148:151], 0
  v_mfma_f32_16x16x32_bf16 v[116:119], a[192:195], v[148:151], 0
  v_mfma_f32_16x16x32_bf16 v[120:123], a[160:163], v[152:155], 0
  v_cvt_pk_bf16_f32 v96, v96, v97
  v_cvt_pk_bf16_f32 v97, v98, v99
  v_mfma_f32_16x16x32_bf16 v[124:127], a[192:195], v[152:155], 0
  v_cvt_pk_bf16_f32 v98, v100, v101
  v_cvt_pk_bf16_f32 v99, v102, v103
  v_mfma_f32_16x16x32_bf16 v[112:115], a[164:167], v[156:159], v[112:115]
  v_bfi_b32 v96, 1, s60, v96
  v_bfi_b32 v98, 1, s60, v98
  buffer_store_dwordx4 v[96:99], v4, s[4:7], s45 offen offset:1408 sc1
  v_mfma_f32_16x16x32_bf16 v[116:119], a[196:199], v[156:159], v[116:119]
  v_cvt_pk_bf16_f32 v104, v104, v105
  v_cvt_pk_bf16_f32 v105, v106, v107
  v_mfma_f32_16x16x32_bf16 v[120:123], a[164:167], v[160:163], v[120:123]
  v_cvt_pk_bf16_f32 v106, v108, v109
  v_cvt_pk_bf16_f32 v107, v110, v111
  v_mfma_f32_16x16x32_bf16 v[124:127], a[196:199], v[160:163], v[124:127]
  v_bfi_b32 v104, 1, s60, v104
  v_bfi_b32 v106, 1, s60, v106
  buffer_store_dwordx4 v[104:107], v4, s[4:7], s51 offen offset:1408 sc1
  v_mfma_f32_16x16x32_bf16 v[112:115], a[168:171], v[164:167], v[112:115]
  v_mfma_f32_16x16x32_bf16 v[116:119], a[200:203], v[164:167], v[116:119]
  v_mfma_f32_16x16x32_bf16 v[120:123], a[168:171], v[168:171], v[120:123]
  v_mfma_f32_16x16x32_bf16 v[124:127], a[200:203], v[168:171], v[124:127]
  v_mfma_f32_16x16x32_bf16 v[112:115], a[172:175], v[172:175], v[112:115]
  v_mfma_f32_16x16x32_bf16 v[116:119], a[204:207], v[172:175], v[116:119]
  v_mfma_f32_16x16x32_bf16 v[120:123], a[172:175], v[176:179], v[120:123]
  v_mfma_f32_16x16x32_bf16 v[124:127], a[204:207], v[176:179], v[124:127]
  v_mfma_f32_16x16x32_bf16 v[112:115], a[176:179], v[180:183], v[112:115]
  v_mfma_f32_16x16x32_bf16 v[116:119], a[208:211], v[180:183], v[116:119]
  v_mfma_f32_16x16x32_bf16 v[120:123], a[176:179], v[184:187], v[120:123]
  v_mfma_f32_16x16x32_bf16 v[124:127], a[208:211], v[184:187], v[124:127]
  v_mfma_f32_16x16x32_bf16 v[112:115], a[180:183], v[188:191], v[112:115]
  v_mfma_f32_16x16x32_bf16 v[116:119], a[212:215], v[188:191], v[116:119]
  v_mfma_f32_16x16x32_bf16 v[120:123], a[180:183], v[192:195], v[120:123]
  v_mfma_f32_16x16x32_bf16 v[124:127], a[212:215], v[192:195], v[124:127]
  v_mfma_f32_16x16x32_bf16 v[112:115], a[184:187], v[196:199], v[112:115]
  v_mfma_f32_16x16x32_bf16 v[116:119], a[216:219], v[196:199], v[116:119]
  v_mfma_f32_16x16x32_bf16 v[120:123], a[184:187], v[200:203], v[120:123]
  v_mfma_f32_16x16x32_bf16 v[124:127], a[216:219], v[200:203], v[124:127]
  v_mfma_f32_16x16x32_bf16 v[112:115], a[188:191], v[204:207], v[112:115]
  v_mfma_f32_16x16x32_bf16 v[116:119], a[220:223], v[204:207], v[116:119]
  v_mfma_f32_16x16x32_bf16 v[120:123], a[188:191], v[208:211], v[120:123]
  v_mfma_f32_16x16x32_bf16 v[124:127], a[220:223], v[208:211], v[124:127]
  v_mfma_f32_16x16x32_bf16 v[96:99], a[224:227], v[148:151], 0
  v_mfma_f32_16x16x32_bf16 v[104:107], a[224:227], v[152:155], 0
  v_mfma_f32_16x16x32_bf16 v[96:99], a[228:231], v[156:159], v[96:99]
  v_cvt_pk_bf16_f32 v112, v112, v113
  v_cvt_pk_bf16_f32 v113, v114, v115
  v_mfma_f32_16x16x32_bf16 v[104:107], a[228:231], v[160:163], v[104:107]
  v_cvt_pk_bf16_f32 v114, v116, v117
  v_cvt_pk_bf16_f32 v115, v118, v119
  v_mfma_f32_16x16x32_bf16 v[96:99], a[232:235], v[164:167], v[96:99]
  v_bfi_b32 v112, 1, s60, v112
  v_bfi_b32 v114, 1, s60, v114
  buffer_store_dwordx4 v[112:115], v4, s[4:7], s45 offen offset:1920 sc1
  v_mfma_f32_16x16x32_bf16 v[104:107], a[232:235], v[168:171], v[104:107]
  v_cvt_pk_bf16_f32 v120, v120, v121
  v_cvt_pk_bf16_f32 v121, v122, v123
  v_mfma_f32_16x16x32_bf16 v[96:99], a[236:239], v[172:175], v[96:99]
  v_cvt_pk_bf16_f32 v122, v124, v125
  v_cvt_pk_bf16_f32 v123, v126, v127
  v_mfma_f32_16x16x32_bf16 v[104:107], a[236:239], v[176:179], v[104:107]
  v_bfi_b32 v120, 1, s60, v120
  v_bfi_b32 v122, 1, s60, v122
  buffer_store_dwordx4 v[120:123], v4, s[4:7], s51 offen offset:1920 sc1
  v_mfma_f32_16x16x32_bf16 v[96:99], a[240:243], v[180:183], v[96:99]
  v_mfma_f32_16x16x32_bf16 v[104:107], a[240:243], v[184:187], v[104:107]
  v_mfma_f32_16x16x32_bf16 v[96:99], a[244:247], v[188:191], v[96:99]
  v_mfma_f32_16x16x32_bf16 v[104:107], a[244:247], v[192:195], v[104:107]
  v_mfma_f32_16x16x32_bf16 v[96:99], a[248:251], v[196:199], v[96:99]
  v_mfma_f32_16x16x32_bf16 v[104:107], a[248:251], v[200:203], v[104:107]
  v_mfma_f32_16x16x32_bf16 v[96:99], a[252:255], v[204:207], v[96:99]
  v_mfma_f32_16x16x32_bf16 v[104:107], a[252:255], v[208:211], v[104:107]
  s_nop 4
  v_cvt_pk_bf16_f32 v96, v96, v97
  v_cvt_pk_bf16_f32 v97, v98, v99
  v_bfi_b32 v96, 1, s60, v96
  buffer_store_dwordx2 v[96:97], v4, s[4:7], s45 offen offset:2184 sc1
  v_cvt_pk_bf16_f32 v104, v104, v105
  v_cvt_pk_bf16_f32 v105, v106, v107
  v_bfi_b32 v104, 1, s60, v104
  buffer_store_dwordx2 v[104:105], v4, s[4:7], s51 offen offset:2184 sc1
L_att_l3_wx:
  s_cmp_eq_u32 s40, 60
  s_cselect_b32 s34, s38, 0
  s_sub_u32 s40, s40, s34
  s_cmp_ge_u32 s40, 60
  s_cbranch_scc1 L_att_l3_end
  s_waitcnt vmcnt(0)
  s_add_u32 s95, s40, 5
  s_cmp_ge_u32 s48, s95
  s_cbranch_scc1 L_ap_41_x
L_ap_41:
  s_load_dwordx4 s[96:99], s[4:5], s92 glc
  s_load_dwordx2 s[100:101], s[4:5], s93 glc
  s_add_u32 s50, s50, 1
  s_cmp_ge_u32 s50, 262144
  s_cbranch_scc1 L_ap_41_y
  s_waitcnt lgkmcnt(0)
  s_min_u32 s48, s96, s97
  s_min_u32 s48, s48, s98
  s_min_u32 s48, s48, s99
  s_min_u32 s48, s48, s100
  s_min_u32 s48, s48, s101
  s_cmp_lt_u32 s48, s95
  s_cbranch_scc1 L_ap_41
L_ap_41_y:
  s_waitcnt lgkmcnt(0)
L_ap_41_x:
  s_lshl_b32 s34, s40, 5
  s_lshl1_add_u32 s34, s43, s34
  s_add_u32 s34, s34, 129
  s_lshl_b32 s34, s34, 13
  s_add_u32 s51, s34, 18878464
  buffer_load_dwordx4 v[16:19], v1, s[4:7], s51 offen offset:0 sc1
  buffer_load_dwordx4 v[20:23], v1, s[4:7], s51 offen offset:1024 sc1
  buffer_load_dwordx4 v[24:27], v1, s[4:7], s51 offen offset:2048 sc1
  buffer_load_dwordx4 v[28:31], v1, s[4:7], s51 offen offset:3072 sc1
  s_add_u32 s51, s34, 35651584
  buffer_load_dwordx4 v[32:35], v1, s[4:7], s51 offen offset:0 sc1
  buffer_load_dwordx4 v[36:39], v1, s[4:7], s51 offen offset:1024 sc1
  buffer_load_dwordx4 v[40:43], v1, s[4:7], s51 offen offset:2048 sc1
  buffer_load_dwordx4 v[44:47], v1, s[4:7], s51 offen offset:3072 sc1
  s_add_u32 s51, s34, 35655680
  buffer_load_dwordx4 v[48:51], v1, s[4:7], s51 offen offset:0 sc1
  buffer_load_dwordx4 v[52:55], v1, s[4:7], s51 offen offset:1024 sc1
  buffer_load_dwordx4 v[56:59], v1, s[4:7], s51 offen offset:2048 sc1
  buffer_load_dwordx4 v[60:63], v1, s[4:7], s51 offen offset:3072 sc1
  s_add_u32 s51, s34, 52428800
  buffer_load_dwordx4 v[64:67], v1, s[4:7], s51 offen offset:0 sc1
  buffer_load_dwordx4 v[68:71], v1, s[4:7], s51 offen offset:1024 sc1
  buffer_load_dwordx4 v[72:75], v1, s[4:7], s51 offen offset:2048 sc1
  buffer_load_dwordx4 v[76:79], v1, s[4:7], s51 offen offset:3072 sc1
  s_add_u32 s51, s34, 52432896
  buffer_load_dwordx4 v[80:83], v1, s[4:7], s51 offen offset:0 sc1
  buffer_load_dwordx4 v[84:87], v1, s[4:7], s51 offen offset:1024 sc1
  buffer_load_dwordx4 v[88:91], v1, s[4:7], s51 offen offset:2048 sc1
  buffer_load_dwordx4 v[92:95], v1, s[4:7], s51 offen offset:3072 sc1
  s_add_u32 s40, s40, 4
  s_branch L_att_l3
L_att_l3_end:
  s_endpgm
L_ffn:
  s_load_dwordx4 s[12:15], s[0:1], 64
  s_load_dwordx4 s[20:23], s[0:1], 80
  s_mov_b32 s50, 0
  s_sub_u32 s43, s32, 112
  s_mov_b32 s44, 0
  s_cmp_ge_u32 s43, 36
  s_cselect_b32 s34, 36, 0
  s_cselect_b32 s35, 1, 0
  s_sub_u32 s43, s43, s34
  s_add_u32 s44, s44, s35
  s_cmp_ge_u32 s43, 36
  s_cselect_b32 s34, 36, 0
  s_cselect_b32 s35, 1, 0
  s_sub_u32 s43, s43, s34
  s_add_u32 s44, s44, s35
  s_cmp_lt_u32 s32, 36
  s_cselect_b32 s43, s32, s43
  s_cselect_b32 s44, 3, s44
  v_lshlrev_b32 v14, 4, v0
  s_waitcnt lgkmcnt(0)
  s_mov_b32 s16, s14
  s_mov_b32 s17, s15
  s_mov_b32 s24, s22
  s_mov_b32 s25, s23
  s_and_b32 s13, s13, 0xffff
  s_mov_b32 s14, 5308416
  s_mov_b32 s15, 0x20000
  s_and_b32 s17, s17, 0xffff
  s_mov_b32 s18, 5308416
  s_mov_b32 s19, 0x20000
  s_and_b32 s21, s21, 0xffff
  s_mov_b32 s22, 5308416
  s_mov_b32 s23, 0x20000
  s_and_b32 s25, s25, 0xffff
  s_mov_b32 s26, 2359296
  s_mov_b32 s27, 0x20000
  s_mul_i32 s34, s33, 147456
  s_lshl_b32 s35, s43, 8
  s_add_u32 s34, s34, s35
  v_lshrrev_b32 v20, 4, v0
  v_mul_u32_u24 v20, 9216, v20
  v_and_b32 v21, 15, v0
  v_lshl_add_u32 v20, v21, 4, v20
  v_add_u32 v24, s34, v20
  s_lshl_b32 s42, s33, 12
  s_cmp_lg_u32 s33, 0
  s_cbranch_scc1 L_meet_42
L_gf_43:
  buffer_load_dword v20, off, s[8:11], 0 offset:136 sc1
  s_add_u32 s50, s50, 1
  s_cmp_ge_u32 s50, 262144
  s_waitcnt vmcnt(0)
  s_cbranch_scc1 L_gf_43_x
  v_cmp_ge_u32 vcc, 0, v20
  s_nop 0
  s_cbranch_vccnz L_gf_43
L_gf_43_x:
L_meet_42:
  s_barrier
  s_add_u32 m0, s42, 0
  s_mov_b32 s51, 0
  buffer_load_dwordx4 v24, s[12:15], s51 offen nt lds
  s_add_u32 m0, s42, 1024
  s_mov_b32 s51, 36864
  buffer_load_dwordx4 v24, s[12:15], s51 offen nt lds
  s_add_u32 m0, s42, 2048
  s_mov_b32 s51, 73728
  buffer_load_dwordx4 v24, s[12:15], s51 offen nt lds
  s_add_u32 m0, s42, 3072
  s_mov_b32 s51, 110592
  buffer_load_dwordx4 v24, s[12:15], s51 offen nt lds
  s_add_u32 m0, s42, 16384
  s_mov_b32 s51, 0
  buffer_load_dwordx4 v24, s[16:19], s51 offen nt lds
  s_add_u32 m0, s42, 17408
  s_mov_b32 s51, 36864
  buffer_load_dwordx4 v24, s[16:19], s51 offen nt lds
  s_add_u32 m0, s42, 18432
  s_mov_b32 s51, 73728
  buffer_load_dwordx4 v24, s[16:19], s51 offen nt lds
  s_add_u32 m0, s42, 19456
  s_mov_b32 s51, 110592
  buffer_load_dwordx4 v24, s[16:19], s51 offen nt lds
  s_add_u32 m0, s42, 32768
  s_mov_b32 s51, 589824
  buffer_load_dwordx4 v24, s[12:15], s51 offen nt lds
  s_add_u32 m0, s42, 33792
  s_mov_b32 s51, 626688
  buffer_load_dwordx4 v24, s[12:15], s51 offen nt lds
  s_add_u32 m0, s42, 34816
  s_mov_b32 s51, 663552
  buffer_load_dwordx4 v24, s[12:15], s51 offen nt lds
  s_add_u32 m0, s42, 35840
  s_mov_b32 s51, 700416
  buffer_load_dwordx4 v24, s[12:15], s51 offen nt lds
  s_add_u32 m0, s42, 49152
  s_mov_b32 s51, 589824
  buffer_load_dwordx4 v24, s[16:19], s51 offen nt lds
  s_add_u32 m0, s42, 50176
  s_mov_b32 s51, 626688
  buffer_load_dwordx4 v24, s[16:19], s51 offen nt lds
  s_add_u32 m0, s42, 51200
  s_mov_b32 s51, 663552
  buffer_load_dwordx4 v24, s[16:19], s51 offen nt lds
  s_add_u32 m0, s42, 52224
  s_mov_b32 s51, 700416
  buffer_load_dwordx4 v24, s[16:19], s51 offen nt lds
  s_add_u32 m0, s42, 65536
  s_mov_b32 s51, 1179648
  buffer_load_dwordx4 v24, s[12:15], s51 offen nt lds
  s_add_u32 m0, s42, 66560
  s_mov_b32 s51, 1216512
  buffer_load_dwordx4 v24, s[12:15], s51 offen nt lds
  s_add_u32 m0, s42, 67584
  s_mov_b32 s51, 1253376
  buffer_load_dwordx4 v24, s[12:15], s51 offen nt lds
  s_add_u32 m0, s42, 68608
  s_mov_b32 s51, 1290240
  buffer_load_dwordx4 v24, s[12:15], s51 offen nt lds
  s_add_u32 m0, s42, 81920
  s_mov_b32 s51, 1179648
  buffer_load_dwordx4 v24, s[16:19], s51 offen nt lds
  s_add_u32 m0, s42, 82944
  s_mov_b32 s51, 1216512
  buffer_load_dwordx4 v24, s[16:19], s51 offen nt lds
  s_add_u32 m0, s42, 83968
  s_mov_b32 s51, 1253376
  buffer_load_dwordx4 v24, s[16:19], s51 offen nt lds
  s_add_u32 m0, s42, 84992
  s_mov_b32 s51, 1290240
  buffer_load_dwordx4 v24, s[16:19], s51 offen nt lds
  s_add_u32 m0, s42, 98304
  s_mov_b32 s51, 1769472
  buffer_load_dwordx4 v24, s[12:15], s51 offen nt lds
  s_add_u32 m0, s42, 99328
  s_mov_b32 s51, 1806336
  buffer_load_dwordx4 v24, s[12:15], s51 offen nt lds
  s_add_u32 m0, s42, 100352
  s_mov_b32 s51, 1843200
  buffer_load_dwordx4 v24, s[12:15], s51 offen nt lds
  s_add_u32 m0, s42, 101376
  s_mov_b32 s51, 1880064
  buffer_load_dwordx4 v24, s[12:15], s51 offen nt lds
  s_add_u32 m0, s42, 114688
  s_mov_b32 s51, 1769472
  buffer_load_dwordx4 v24, s[16:19], s51 offen nt lds
  s_add_u32 m0, s42, 115712
  s_mov_b32 s51, 1806336
  buffer_load_dwordx4 v24, s[16:19], s51 offen nt lds
  s_add_u32 m0, s42, 116736
  s_mov_b32 s51, 1843200
  buffer_load_dwordx4 v24, s[16:19], s51 offen nt lds
  s_add_u32 m0, s42, 117760
  s_mov_b32 s51, 1880064
  buffer_load_dwordx4 v24, s[16:19], s51 offen nt lds
  s_lshl_b32 s34, s33, 6
  v_lshrrev_b32 v20, 5, v0
  v_bfe_u32 v21, v0, 2, 2
  v_lshl_add_u32 v20, v20, 3, v21
  v_lshlrev_b32 v20, 8, v20
  v_bfe_u32 v21, v0, 4, 1
  v_lshl_add_u32 v20, v21, 5, v20
  v_and_b32 v21, 3, v0
  v_lshl_add_u32 v20, v21, 3, v20
  v_add_u32 v25, s34, v20
  v_add_u32 v26, 65536, v25
  s_mul_i32 s34, s33, 576
  s_mov_b32 s35, 58255
  v_add_u32 v20, s34, v0
  v_add_u32 v20, 0, v20
  v_mul_lo_u32 v21, v20, s35
  v_lshrrev_b32 v21, 22, v21
  v_mul_u32_u24 v22, 72, v21
  v_sub_u32 v22, v20, v22
  v_bfe_u32 v23, v21, 1, 3
  v_xor_b32 v22, v22, v23
  v_mul_u32_u24 v21, 1152, v21
  v_lshl_add_u32 v1, v22, 4, v21
  v_add_u32 v20, s34, v0
  v_add_u32 v20, 64, v20
  v_mul_lo_u32 v21, v20, s35
  v_lshrrev_b32 v21, 22, v21
  v_mul_u32_u24 v22, 72, v21
  v_sub_u32 v22, v20, v22
  v_bfe_u32 v23, v21, 1, 3
  v_xor_b32 v22, v22, v23
  v_mul_u32_u24 v21, 1152, v21
  v_lshl_add_u32 v2, v22, 4, v21
  v_add_u32 v20, s34, v0
  v_add_u32 v20, 128, v20
  v_mul_lo_u32 v21, v20, s35
  v_lshrrev_b32 v21, 22, v21
  v_mul_u32_u24 v22, 72, v21
  v_sub_u32 v22, v20, v22
  v_bfe_u32 v23, v21, 1, 3
  v_xor_b32 v22, v22, v23
  v_mul_u32_u24 v21, 1152, v21
  v_lshl_add_u32 v3, v22, 4, v21
  v_add_u32 v20, s34, v0
  v_add_u32 v20, 192, v20
  v_mul_lo_u32 v21, v20, s35
  v_lshrrev_b32 v21, 22, v21
  v_mul_u32_u24 v22, 72, v21
  v_sub_u32 v22, v20, v22
  v_bfe_u32 v23, v21, 1, 3
  v_xor_b32 v22, v22, v23
  v_mul_u32_u24 v21, 1152, v21
  v_lshl_add_u32 v4, v22, 4, v21
  v_add_u32 v20, s34, v0
  v_add_u32 v20, 256, v20
  v_mul_lo_u32 v21, v20, s35
  v_lshrrev_b32 v21, 22, v21
  v_mul_u32_u24 v22, 72, v21
  v_sub_u32 v22, v20, v22
  v_bfe_u32 v23, v21, 1, 3
  v_xor_b32 v22, v22, v23
  v_mul_u32_u24 v21, 1152, v21
  v_lshl_add_u32 v5, v22, 4, v21
  v_add_u32 v20, s34, v0
  v_add_u32 v20, 320, v20
  v_mul_lo_u32 v21, v20, s35
  v_lshrrev_b32 v21, 22, v21
  v_mul_u32_u24 v22, 72, v21
  v_sub_u32 v22, v20, v22
  v_bfe_u32 v23, v21, 1, 3
  v_xor_b32 v22, v22, v23
  v_mul_u32_u24 v21, 1152, v21
  v_lshl_add_u32 v6, v22, 4, v21
  v_add_u32 v20, s34, v0
  v_add_u32 v20, 384, v20
  v_mul_lo_u32 v21, v20, s35
  v_lshrrev_b32 v21, 22, v21
  v_mul_u32_u24 v22, 72, v21
  v_sub_u32 v22, v20, v22
  v_bfe_u32 v23, v21, 1, 3
  v_xor_b32 v22, v22, v23
  v_mul_u32_u24 v21, 1152, v21
  v_lshl_add_u32 v7, v22, 4, v21
  v_add_u32 v20, s34, v0
  v_add_u32 v20, 448, v20
  v_mul_lo_u32 v21, v20, s35
  v_lshrrev_b32 v21, 22, v21
  v_mul_u32_u24 v22, 72, v21
  v_sub_u32 v22, v20, v22
  v_bfe_u32 v23, v21, 1, 3
  v_xor_b32 v22, v22, v23
  v_mul_u32_u24 v21, 1152, v21
  v_lshl_add_u32 v8, v22, 4, v21
  v_add_u32 v20, s34, v0
  v_add_u32 v20, 512, v20
  v_mul_lo_u32 v21, v20, s35
  v_lshrrev_b32 v21, 22, v21
  v_mul_u32_u24 v22, 72, v21
  v_sub_u32 v22, v20, v22
  v_bfe_u32 v23, v21, 1, 3
  v_xor_b32 v22, v22, v23
  v_mul_u32_u24 v21, 1152, v21
  v_lshl_add_u32 v9, v22, 4, v21
  v_and_b32 v20, 31, v0
  v_lshrrev_b32 v21, 5, v0
  v_bfe_u32 v22, v20, 1, 3
  v_mul_u32_u24 v20, 1152, v20
  v_add_u32 v23, 0, v21
  v_xor_b32 v23, v23, v22
  v_lshl_add_u32 v10, v23, 4, v20
  v_add_u32 v23, 2, v21
  v_xor_b32 v23, v23, v22
  v_lshl_add_u32 v11, v23, 4, v20
  v_add_u32 v23, 4, v21
  v_xor_b32 v23, v23, v22
  v_lshl_add_u32 v12, v23, 4, v20
  v_add_u32 v23, 6, v21
  v_xor_b32 v23, v23, v22
  v_lshl_add_u32 v13, v23, 4, v20
  s_waitcnt vmcnt(24)
  s_barrier
  ds_read_b64_tr_b16 v[80:81], v25 offset:0
  ds_read_b64_tr_b16 v[82:83], v25 offset:1024
  ds_read_b64_tr_b16 v[84:85], v25 offset:16384
  ds_read_b64_tr_b16 v[86:87], v25 offset:17408
  ds_read_b64_tr_b16 v[88:89], v25 offset:4096
  ds_read_b64_tr_b16 v[90:91], v25 offset:5120
  ds_read_b64_tr_b16 v[92:93], v25 offset:20480
  ds_read_b64_tr_b16 v[94:95], v25 offset:21504
  ds_read_b64_tr_b16 v[96:97], v25 offset:8192
  ds_read_b64_tr_b16 v[98:99], v25 offset:9216
  ds_read_b64_tr_b16 v[100:101], v25 offset:24576
  ds_read_b64_tr_b16 v[102:103], v25 offset:25600
  ds_read_b64_tr_b16 v[104:105], v25 offset:12288
  ds_read_b64_tr_b16 v[106:107], v25 offset:13312
  ds_read_b64_tr_b16 v[108:109], v25 offset:28672
  ds_read_b64_tr_b16 v[110:111], v25 offset:29696
  s_waitcnt lgkmcnt(0)
  s_barrier
  s_add_u32 m0, s42, 0
  s_mov_b32 s51, 2359296
  buffer_load_dwordx4 v24, s[12:15], s51 offen nt lds
  s_add_u32 m0, s42, 1024
  s_mov_b32 s51, 2396160
  buffer_load_dwordx4 v24, s[12:15], s51 offen nt lds
  s_add_u32 m0, s42, 2048
  s_mov_b32 s51, 2433024
  buffer_load_dwordx4 v24, s[12:15], s51 offen nt lds
  s_add_u32 m0, s42, 3072
  s_mov_b32 s51, 2469888
  buffer_load_dwordx4 v24, s[12:15], s51 offen nt lds
  s_add_u32 m0, s42, 16384
  s_mov_b32 s51, 2359296
  buffer_load_dwordx4 v24, s[16:19], s51 offen nt lds
  s_add_u32 m0, s42, 17408
  s_mov_b32 s51, 2396160
  buffer_load_dwordx4 v24, s[16:19], s51 offen nt lds
  s_add_u32 m0, s42, 18432
  s_mov_b32 s51, 2433024
  buffer_load_dwordx4 v24, s[16:19], s51 offen nt lds
  s_add_u32 m0, s42, 19456
  s_mov_b32 s51, 2469888
  buffer_load_dwordx4 v24, s[16:19], s51 offen nt lds
  s_waitcnt vmcnt(24)
  s_barrier
  ds_read_b64_tr_b16 v[112:113], v25 offset:32768
  ds_read_b64_tr_b16 v[114:115], v25 offset:33792
  ds_read_b64_tr_b16 v[116:117], v25 offset:49152
  ds_read_b64_tr_b16 v[118:119], v25 offset:50176
  ds_read_b64_tr_b16 v[120:121], v25 offset:36864
  ds_read_b64_tr_b16 v[122:123], v25 offset:37888
  ds_read_b64_tr_b16 v[124:125], v25 offset:53248
  ds_read_b64_tr_b16 v[126:127], v25 offset:54272
  ds_read_b64_tr_b16 v[128:129], v25 offset:40960
  ds_read_b64_tr_b16 v[130:131], v25 offset:41984
  ds_read_b64_tr_b16 v[132:133], v25 offset:57344
  ds_read_b64_tr_b16 v[134:135], v25 offset:58368
  ds_read_b64_tr_b16 v[136:137], v25 offset:45056
  ds_read_b64_tr_b16 v[138:139], v25 offset:46080
  ds_read_b64_tr_b16 v[140:141], v25 offset:61440
  ds_read_b64_tr_b16 v[142:143], v25 offset:62464
  s_waitcnt lgkmcnt(0)
  s_barrier
  s_add_u32 m0, s42, 32768
  s_mov_b32 s51, 2949120
  buffer_load_dwordx4 v24, s[12:15], s51 offen nt lds
  s_add_u32 m0, s42, 33792
  s_mov_b32 s51, 2985984
  buffer_load_dwordx4 v24, s[12:15], s51 offen nt lds
  s_add_u32 m0, s42, 34816
  s_mov_b32 s51, 3022848
  buffer_load_dwordx4 v24, s[12:15], s51 offen nt lds
  s_add_u32 m0, s42, 35840
  s_mov_b32 s51, 3059712
  buffer_load_dwordx4 v24, s[12:15], s51 offen nt lds
  s_add_u32 m0, s42, 49152
  s_mov_b32 s51, 2949120
  buffer_load_dwordx4 v24, s[16:19], s51 offen nt lds
  s_add_u32 m0, s42, 50176
  s_mov_b32 s51, 2985984
  buffer_load_dwordx4 v24, s[16:19], s51 offen nt lds
  s_add_u32 m0, s42, 51200
  s_mov_b32 s51, 3022848
  buffer_load_dwordx4 v24, s[16:19], s51 offen nt lds
  s_add_u32 m0, s42, 52224
  s_mov_b32 s51, 3059712
  buffer_load_dwordx4 v24, s[16:19], s51 offen nt lds
  s_waitcnt vmcnt(24)
  s_barrier
  ds_read_b64_tr_b16 v[144:145], v26 offset:0
  ds_read_b64_tr_b16 v[146:147], v26 offset:1024
  ds_read_b64_tr_b16 v[148:149], v26 offset:16384
  ds_read_b64_tr_b16 v[150:151], v26 offset:17408
  ds_read_b64_tr_b16 v[152:153], v26 offset:4096
  ds_read_b64_tr_b16 v[154:155], v26 offset:5120
  ds_read_b64_tr_b16 v[156:157], v26 offset:20480
  ds_read_b64_tr_b16 v[158:159], v26 offset:21504
  ds_read_b64_tr_b16 v[160:161], v26 offset:8192
  ds_read_b64_tr_b16 v[162:163], v26 offset:9216
  ds_read_b64_tr_b16 v[164:165], v26 offset:24576
  ds_read_b64_tr_b16 v[166:167], v26 offset:25600
  ds_read_b64_tr_b16 v[168:169], v26 offset:12288
  ds_read_b64_tr_b16 v[170:171], v26 offset:13312
  ds_read_b64_tr_b16 v[172:173], v26 offset:28672
  ds_read_b64_tr_b16 v[174:175], v26 offset:29696
  s_waitcnt lgkmcnt(0)
  s_barrier
  s_add_u32 m0, s42, 65536
  s_mov_b32 s51, 3538944
  buffer_load_dwordx4 v24, s[12:15], s51 offen nt lds
  s_add_u32 m0, s42, 66560
  s_mov_b32 s51, 3575808
  buffer_load_dwordx4 v24, s[12:15], s51 offen nt lds
  s_add_u32 m0, s42, 67584
  s_mov_b32 s51, 3612672
  buffer_load_dwordx4 v24, s[12:15], s51 offen nt lds
  s_add_u32 m0, s42, 68608
  s_mov_b32 s51, 3649536
  buffer_load_dwordx4 v24, s[12:15], s51 offen nt lds
  s_add_u32 m0, s42, 81920
  s_mov_b32 s51, 3538944
  buffer_load_dwordx4 v24, s[16:19], s51 offen nt lds
  s_add_u32 m0, s42, 82944
  s_mov_b32 s51, 3575808
  buffer_load_dwordx4 v24, s[16:19], s51 offen nt lds
  s_add_u32 m0, s42, 83968
  s_mov_b32 s51, 3612672
  buffer_load_dwordx4 v24, s[16:19], s51 offen nt lds
  s_add_u32 m0, s42, 84992
  s_mov_b32 s51, 3649536
  buffer_load_dwordx4 v24, s[16:19], s51 offen nt lds
  s_waitcnt vmcnt(24)
  s_barrier
  ds_read_b64_tr_b16 v[176:177], v26 offset:32768
  ds_read_b64_tr_b16 v[178:179], v26 offset:33792
  ds_read_b64_tr_b16 v[180:181], v26 offset:49152
  ds_read_b64_tr_b16 v[182:183], v26 offset:50176
  ds_read_b64_tr_b16 v[184:185], v26 offset:36864
  ds_read_b64_tr_b16 v[186:187], v26 offset:37888
  ds_read_b64_tr_b16 v[188:189], v26 offset:53248
  ds_read_b64_tr_b16 v[190:191], v26 offset:54272
  ds_read_b64_tr_b16 v[192:193], v26 offset:40960
  ds_read_b64_tr_b16 v[194:195], v26 offset:41984
  ds_read_b64_tr_b16 v[196:197], v26 offset:57344
  ds_read_b64_tr_b16 v[198:199], v26 offset:58368
  ds_read_b64_tr_b16 v[200:201], v26 offset:45056
  ds_read_b64_tr_b16 v[202:203], v26 offset:46080
  ds_read_b64_tr_b16 v[204:205], v26 offset:61440
  ds_read_b64_tr_b16 v[206:207], v26 offset:62464
  s_waitcnt lgkmcnt(0)
  s_barrier
  s_add_u32 m0, s42, 98304
  s_mov_b32 s51, 4128768
  buffer_load_dwordx4 v24, s[12:15], s51 offen nt lds
  s_add_u32 m0, s42, 99328
  s_mov_b32 s51, 4165632
  buffer_load_dwordx4 v24, s[12:15], s51 offen nt lds
  s_add_u32 m0, s42, 100352
  s_mov_b32 s51, 4202496
  buffer_load_dwordx4 v24, s[12:15], s51 offen nt lds
  s_add_u32 m0, s42, 101376
  s_mov_b32 s51, 4239360
  buffer_load_dwordx4 v24, s[12:15], s51 offen nt lds
  s_add_u32 m0, s42, 114688
  s_mov_b32 s51, 4128768
  buffer_load_dwordx4 v24, s[16:19], s51 offen nt lds
  s_add_u32 m0, s42, 115712
  s_mov_b32 s51, 4165632
  buffer_load_dwordx4 v24, s[16:19], s51 offen nt lds
  s_add_u32 m0, s42, 116736
  s_mov_b32 s51, 4202496
  buffer_load_dwordx4 v24, s[16:19], s51 offen nt lds
  s_add_u32 m0, s42, 117760
  s_mov_b32 s51, 4239360
  buffer_load_dwordx4 v24, s[16:19], s51 offen nt lds
  s_waitcnt vmcnt(24)
  s_barrier
  ds_read_b64_tr_b16 v[208:209], v25 offset:0
  ds_read_b64_tr_b16 v[210:211], v25 offset:1024
  ds_read_b64_tr_b16 v[212:213], v25 offset:16384
  ds_read_b64_tr_b16 v[214:215], v25 offset:17408
  ds_read_b64_tr_b16 v[216:217], v25 offset:4096
  ds_read_b64_tr_b16 v[218:219], v25 offset:5120
  ds_read_b64_tr_b16 v[220:221], v25 offset:20480
  ds_read_b64_tr_b16 v[222:223], v25 offset:21504
  ds_read_b64_tr_b16 v[224:225], v25 offset:8192
  ds_read_b64_tr_b16 v[226:227], v25 offset:9216
  ds_read_b64_tr_b16 v[228:229], v25 offset:24576
  ds_read_b64_tr_b16 v[230:231], v25 offset:25600
  ds_read_b64_tr_b16 v[232:233], v25 offset:12288
  ds_read_b64_tr_b16 v[234:235], v25 offset:13312
  ds_read_b64_tr_b16 v[236:237], v25 offset:28672
  ds_read_b64_tr_b16 v[238:239], v25 offset:29696
  s_waitcnt lgkmcnt(0)
  s_barrier
  s_add_u32 m0, s42, 0
  s_mov_b32 s51, 4718592
  buffer_load_dwordx4 v24, s[12:15], s51 offen nt lds
  s_add_u32 m0, s42, 1024
  s_mov_b32 s51, 4755456
  buffer_load_dwordx4 v24, s[12:15], s51 offen nt lds
  s_add_u32 m0, s42, 2048
  s_mov_b32 s51, 4792320
  buffer_load_dwordx4 v24, s[12:15], s51 offen nt lds
  s_add_u32 m0, s42, 3072
  s_mov_b32 s51, 4829184
  buffer_load_dwordx4 v24, s[12:15], s51 offen nt lds
  s_add_u32 m0, s42, 16384
  s_mov_b32 s51, 4718592
  buffer_load_dwordx4 v24, s[16:19], s51 offen nt lds
  s_add_u32 m0, s42, 17408
  s_mov_b32 s51, 4755456
  buffer_load_dwordx4 v24, s[16:19], s51 offen nt lds
  s_add_u32 m0, s42, 18432
  s_mov_b32 s51, 4792320
  buffer_load_dwordx4 v24, s[16:19], s51 offen nt lds
  s_add_u32 m0, s42, 19456
  s_mov_b32 s51, 4829184
  buffer_load_dwordx4 v24, s[16:19], s51 offen nt lds
  s_waitcnt vmcnt(24)
  s_barrier
  ds_read_b64_tr_b16 v[240:241], v25 offset:32768
  ds_read_b64_tr_b16 v[242:243], v25 offset:33792
  ds_read_b64_tr_b16 v[244:245], v25 offset:49152
  ds_read_b64_tr_b16 v[246:247], v25 offset:50176
  ds_read_b64_tr_b16 v[248:249], v25 offset:36864
  ds_read_b64_tr_b16 v[250:251], v25 offset:37888
  ds_read_b64_tr_b16 v[252:253], v25 offset:53248
  ds_read_b64_tr_b16 v[254:255], v25 offset:54272
  ds_read_b64_tr_b16 a[0:1], v25 offset:40960
  ds_read_b64_tr_b16 a[2:3], v25 offset:41984
  ds_read_b64_tr_b16 a[4:5], v25 offset:57344
  ds_read_b64_tr_b16 a[6:7], v25 offset:58368
  ds_read_b64_tr_b16 a[8:9], v25 offset:45056
  ds_read_b64_tr_b16 a[10:11], v25 offset:46080
  ds_read_b64_tr_b16 a[12:13], v25 offset:61440
  ds_read_b64_tr_b16 a[14:15], v25 offset:62464
  s_waitcnt lgkmcnt(0)
  s_waitcnt vmcnt(16)
  s_barrier
  ds_read_b64_tr_b16 a[16:17], v26 offset:0
  ds_read_b64_tr_b16 a[18:19], v26 offset:1024
  ds_read_b64_tr_b16 a[20:21], v26 offset:16384
  ds_read_b64_tr_b16 a[22:23], v26 offset:17408
  ds_read_b64_tr_b16 a[24:25], v26 offset:4096
  ds_read_b64_tr_b16 a[26:27], v26 offset:5120
  ds_read_b64_tr_b16 a[28:29], v26 offset:20480
  ds_read_b64_tr_b16 a[30:31], v26 offset:21504
  ds_read_b64_tr_b16 a[32:33], v26 offset:8192
  ds_read_b64_tr_b16 a[34:35], v26 offset:9216
  ds_read_b64_tr_b16 a[36:37], v26 offset:24576
  ds_read_b64_tr_b16 a[38:39], v26 offset:25600
  ds_read_b64_tr_b16 a[40:41], v26 offset:12288
  ds_read_b64_tr_b16 a[42:43], v26 offset:13312
  ds_read_b64_tr_b16 a[44:45], v26 offset:28672
  ds_read_b64_tr_b16 a[46:47], v26 offset:29696
  s_waitcnt lgkmcnt(0)
  s_waitcnt vmcnt(8)
  s_barrier
  ds_read_b64_tr_b16 a[48:49], v26 offset:32768
  ds_read_b64_tr_b16 a[50:51], v26 offset:33792
  ds_read_b64_tr_b16 a[52:53], v26 offset:49152
  ds_read_b64_tr_b16 a[54:55], v26 offset:50176
  ds_read_b64_tr_b16 a[56:57], v26 offset:36864
  ds_read_b64_tr_b16 a[58:59], v26 offset:37888
  ds_read_b64_tr_b16 a[60:61], v26 offset:53248
  ds_read_b64_tr_b16 a[62:63], v26 offset:54272
  ds_read_b64_tr_b16 a[64:65], v26 offset:40960
  ds_read_b64_tr_b16 a[66:67], v26 offset:41984
  ds_read_b64_tr_b16 a[68:69], v26 offset:57344
  ds_read_b64_tr_b16 a[70:71], v26 offset:58368
  ds_read_b64_tr_b16 a[72:73], v26 offset:45056
  ds_read_b64_tr_b16 a[74:75], v26 offset:46080
  ds_read_b64_tr_b16 a[76:77], v26 offset:61440
  ds_read_b64_tr_b16 a[78:79], v26 offset:62464
  s_waitcnt lgkmcnt(0)
  s_waitcnt vmcnt(0)
  s_barrier
  ds_read_b64_tr_b16 a[80:81], v25 offset:0
  ds_read_b64_tr_b16 a[82:83], v25 offset:1024
  ds_read_b64_tr_b16 a[84:85], v25 offset:16384
  ds_read_b64_tr_b16 a[86:87], v25 offset:17408
  ds_read_b64_tr_b16 a[88:89], v25 offset:4096
  ds_read_b64_tr_b16 a[90:91], v25 offset:5120
  ds_read_b64_tr_b16 a[92:93], v25 offset:20480
  ds_read_b64_tr_b16 a[94:95], v25 offset:21504
  ds_read_b64_tr_b16 a[96:97], v25 offset:8192
  ds_read_b64_tr_b16 a[98:99], v25 offset:9216
  ds_read_b64_tr_b16 a[100:101], v25 offset:24576
  ds_read_b64_tr_b16 a[102:103], v25 offset:25600
  ds_read_b64_tr_b16 a[104:105], v25 offset:12288
  ds_read_b64_tr_b16 a[106:107], v25 offset:13312
  ds_read_b64_tr_b16 a[108:109], v25 offset:28672
  ds_read_b64_tr_b16 a[110:111], v25 offset:29696
  s_waitcnt lgkmcnt(0)
  s_barrier
  s_mul_i32 s42, s33, 9216
  s_mul_i32 s45, s43, 147456
  s_add_u32 s45, s45, s42
  s_add_u32 m0, s42, 0
  s_add_u32 s51, s45, 0
  buffer_load_dwordx4 v14, s[20:23], s51 offen offset:0 nt lds
  buffer_load_dwordx4 v14, s[20:23], s51 offen offset:1024 nt lds
  buffer_load_dwordx4 v14, s[20:23], s51 offen offset:2048 nt lds
  buffer_load_dwordx4 v14, s[20:23], s51 offen offset:3072 nt lds
  s_add_u32 m0, s42, 4096
  s_add_u32 s51, s45, 4096
  buffer_load_dwordx4 v14, s[20:23], s51 offen offset:0 nt lds
  buffer_load_dwordx4 v14, s[20:23], s51 offen offset:1024 nt lds
  buffer_load_dwordx4 v14, s[20:23], s51 offen offset:2048 nt lds
  buffer_load_dwordx4 v14, s[20:23], s51 offen offset:3072 nt lds
  s_add_u32 m0, s42, 8192
  s_add_u32 s51, s45, 8192
  buffer_load_dwordx4 v14, s[20:23], s51 offen offset:0 nt lds
  s_add_u32 m0, s42, 36864
  s_add_u32 s51, s45, 36864
  buffer_load_dwordx4 v14, s[20:23], s51 offen offset:0 nt lds
  buffer_load_dwordx4 v14, s[20:23], s51 offen offset:1024 nt lds
  buffer_load_dwordx4 v14, s[20:23], s51 offen offset:2048 nt lds
  buffer_load_dwordx4 v14, s[20:23], s51 offen offset:3072 nt lds
  s_add_u32 m0, s42, 40960
  s_add_u32 s51, s45, 40960
  buffer_load_dwordx4 v14, s[20:23], s51 offen offset:0 nt lds
  buffer_load_dwordx4 v14, s[20:23], s51 offen offset:1024 nt lds
  buffer_load_dwordx4 v14, s[20:23], s51 offen offset:2048 nt lds
  buffer_load_dwordx4 v14, s[20:23], s51 offen offset:3072 nt lds
  s_add_u32 m0, s42, 45056
  s_add_u32 s51, s45, 45056
  buffer_load_dwordx4 v14, s[20:23], s51 offen offset:0 nt lds
  s_add_u32 m0, s42, 73728
  s_add_u32 s51, s45, 73728
  buffer_load_dwordx4 v14, s[20:23], s51 offen offset:0 nt lds
  buffer_load_dwordx4 v14, s[20:23], s51 offen offset:1024 nt lds
  buffer_load_dwordx4 v14, s[20:23], s51 offen offset:2048 nt lds
  buffer_load_dwordx4 v14, s[20:23], s51 offen offset:3072 nt lds
  s_add_u32 m0, s42, 77824
  s_add_u32 s51, s45, 77824
  buffer_load_dwordx4 v14, s[20:23], s51 offen offset:0 nt lds
  buffer_load_dwordx4 v14, s[20:23], s51 offen offset:1024 nt lds
  buffer_load_dwordx4 v14, s[20:23], s51 offen offset:2048 nt lds
  buffer_load_dwordx4 v14, s[20:23], s51 offen offset:3072 nt lds
  s_add_u32 m0, s42, 81920
  s_add_u32 s51, s45, 81920
  buffer_load_dwordx4 v14, s[20:23], s51 offen offset:0 nt lds
  s_add_u32 m0, s42, 110592
  s_add_u32 s51, s45, 110592
  buffer_load_dwordx4 v14, s[20:23], s51 offen offset:0 nt lds
  buffer_load_dwordx4 v14, s[20:23], s51 offen offset:1024 nt lds
  buffer_load_dwordx4 v14, s[20:23], s51 offen offset:2048 nt lds
  buffer_load_dwordx4 v14, s[20:23], s51 offen offset:3072 nt lds
  s_add_u32 m0, s42, 114688
  s_add_u32 s51, s45, 114688
  buffer_load_dwordx4 v14, s[20:23], s51 offen offset:0 nt lds
  buffer_load_dwordx4 v14, s[20:23], s51 offen offset:1024 nt lds
  buffer_load_dwordx4 v14, s[20:23], s51 offen offset:2048 nt lds
  buffer_load_dwordx4 v14, s[20:23], s51 offen offset:3072 nt lds
  s_add_u32 m0, s42, 118784
  s_add_u32 s51, s45, 118784
  buffer_load_dwordx4 v14, s[20:23], s51 offen offset:0 nt lds
  v_and_b32 v20, 15, v0
  v_and_b32 v20, 7, v20
  v_and_b32 v21, 1, v20
  v_lshlrev_b32 v21, 4, v21
  v_mov_b32 v22, 0x3f80
  v_lshlrev_b32 v22, v21, v22
  v_lshrrev_b32 v20, 1, v20
  v_cmp_eq_u32 vcc, 0, v20
  s_nop 1
  v_cndmask_b32 v28, 0, v22, vcc
  v_cmp_eq_u32 vcc, 1, v20
  s_nop 1
  v_cndmask_b32 v29, 0, v22, vcc
  v_cmp_eq_u32 vcc, 2, v20
  s_nop 1
  v_cndmask_b32 v30, 0, v22, vcc
  v_cmp_eq_u32 vcc, 3, v20
  s_nop 1
  v_cndmask_b32 v31, 0, v22, vcc
  v_and_b32 v20, 15, v0
  v_lshrrev_b32 v21, 4, v0
  v_lshlrev_b32 v22, 6, v20
  v_lshl_add_u32 v22, v21, 4, v22
  s_lshl_b32 s34, s43, 10
  v_add_u32 v15, s34, v22
  v_lshlrev_b32 v22, 4, v20
  v_lshl_add_u32 v22, v21, 10, v22
  s_mul_i32 s34, s43, 36864
  s_lshl_b32 s35, s33, 8
  s_add_u32 s34, s34, s35
  v_add_u32 v16, s34, v22
  s_cmp_ge_u32 s43, 18
  s_cselect_b32 s34, 17280, 0
  s_lshl_b32 s35, s43, 6
  s_add_u32 s34, s34, s35
  s_mul_i32 s35, s33, 4608
  s_add_u32 s34, s34, s35
  v_lshrrev_b32 v22, 2, v20
  v_mul_u32_u24 v22, 1152, v22
  v_and_b32 v23, 3, v0
  v_lshl_add_u32 v22, v23, 4, v22
  v_lshl_add_u32 v22, v21, 3, v22
  v_add_u32 v22, s34, v22
  v_mov_b32 v23, 0x80000000
  v_cmp_gt_u32 vcc, 32, v0
  s_nop 1
  v_cndmask_b32 v17, v23, v22, vcc
  v_add_u32 v18, s42, v14
  v_lshrrev_b32 v20, 5, v0
  v_bfe_u32 v21, v0, 2, 3
  v_lshl_add_u32 v20, v20, 4, v21
  v_mul_u32_u24 v20, 1152, v20
  v_and_b32 v21, 3, v0
  v_lshl_add_u32 v25, v21, 4, v20
  v_add_u32 v26, 73728, v25
  s_cmp_eq_u32 s33, 1
  s_cbranch_scc1 L_ffn_w1
  s_cmp_eq_u32 s33, 2
  s_cbranch_scc1 L_ffn_w2
  s_cmp_eq_u32 s33, 3
  s_cbranch_scc1 L_ffn_w3
L_ffn_w0:
  s_waitcnt vmcnt(27)
  s_barrier
  ds_read_b64_tr_b16 a[112:113], v25 offset:0
  ds_read_b64_tr_b16 a[114:115], v25 offset:9216
  ds_read_b64_tr_b16 a[128:129], v25 offset:8
  ds_read_b64_tr_b16 a[130:131], v25 offset:9224
  ds_read_b64_tr_b16 a[144:145], v25 offset:64
  ds_read_b64_tr_b16 a[146:147], v25 offset:9280
  ds_read_b64_tr_b16 a[160:161], v25 offset:72
  ds_read_b64_tr_b16 a[162:163], v25 offset:9288
  ds_read_b64_tr_b16 a[176:177], v25 offset:128
  ds_read_b64_tr_b16 a[178:179], v25 offset:9344
  ds_read_b64_tr_b16 a[192:193], v25 offset:136
  ds_read_b64_tr_b16 a[194:195], v25 offset:9352
  ds_read_b64_tr_b16 a[208:209], v25 offset:192
  ds_read_b64_tr_b16 a[210:211], v25 offset:9408
  ds_read_b64_tr_b16 a[224:225], v25 offset:200
  ds_read_b64_tr_b16 a[226:227], v25 offset:9416
  ds_read_b64_tr_b16 a[240:241], v25 offset:256
  ds_read_b64_tr_b16 a[242:243], v25 offset:9472
  s_waitcnt vmcnt(18)
  s_barrier
  ds_read_b64_tr_b16 a[116:117], v25 offset:36864
  ds_read_b64_tr_b16 a[118:119], v25 offset:46080
  ds_read_b64_tr_b16 a[132:133], v25 offset:36872
  ds_read_b64_tr_b16 a[134:135], v25 offset:46088
  ds_read_b64_tr_b16 a[148:149], v25 offset:36928
  ds_read_b64_tr_b16 a[150:151], v25 offset:46144
  ds_read_b64_tr_b16 a[164:165], v25 offset:36936
  ds_read_b64_tr_b16 a[166:167], v25 offset:46152
  ds_read_b64_tr_b16 a[180:181], v25 offset:36992
  ds_read_b64_tr_b16 a[182:183], v25 offset:46208
  ds_read_b64_tr_b16 a[196:197], v25 offset:37000
  ds_read_b64_tr_b16 a[198:199], v25 offset:46216
  ds_read_b64_tr_b16 a[212:213], v25 offset:37056
  ds_read_b64_tr_b16 a[214:215], v25 offset:46272
  ds_read_b64_tr_b16 a[228:229], v25 offset:37064
  ds_read_b64_tr_b16 a[230:231], v25 offset:46280
  ds_read_b64_tr_b16 a[244:245], v25 offset:37120
  ds_read_b64_tr_b16 a[246:247], v25 offset:46336
  s_waitcnt vmcnt(9)
  s_barrier
  ds_read_b64_tr_b16 a[120:121], v26 offset:0
  ds_read_b64_tr_b16 a[122:123], v26 offset:9216
  ds_read_b64_tr_b16 a[136:137], v26 offset:8
  ds_read_b64_tr_b16 a[138:139], v26 offset:9224
  ds_read_b64_tr_b16 a[152:153], v26 offset:64
  ds_read_b64_tr_b16 a[154:155], v26 offset:9280
  ds_read_b64_tr_b16 a[168:169], v26 offset:72
  ds_read_b64_tr_b16 a[170:171], v26 offset:9288
  ds_read_b64_tr_b16 a[184:185], v26 offset:128
  ds_read_b64_tr_b16 a[186:187], v26 offset:9344
  ds_read_b64_tr_b16 a[200:201], v26 offset:136
  ds_read_b64_tr_b16 a[202:203], v26 offset:9352
  ds_read_b64_tr_b16 a[216:217], v26 offset:192
  ds_read_b64_tr_b16 a[218:219], v26 offset:9408
  ds_read_b64_tr_b16 a[232:233], v26 offset:200
  ds_read_b64_tr_b16 a[234:235], v26 offset:9416
  ds_read_b64_tr_b16 a[248:249], v26 offset:256
  ds_read_b64_tr_b16 a[250:251], v26 offset:9472
  s_waitcnt vmcnt(0)
  s_barrier
  ds_read_b64_tr_b16 a[124:125], v26 offset:36864
  ds_read_b64_tr_b16 a[126:127], v26 offset:46080
  ds_read_b64_tr_b16 a[140:141], v26 offset:36872
  ds_read_b64_tr_b16 a[142:143], v26 offset:46088
  ds_read_b64_tr_b16 a[156:157], v26 offset:36928
  ds_read_b64_tr_b16 a[158:159], v26 offset:46144
  ds_read_b64_tr_b16 a[172:173], v26 offset:36936
  ds_read_b64_tr_b16 a[174:175], v26 offset:46152
  ds_read_b64_tr_b16 a[188:189], v26 offset:36992
  ds_read_b64_tr_b16 a[190:191], v26 offset:46208
  ds_read_b64_tr_b16 a[204:205], v26 offset:37000
  ds_read_b64_tr_b16 a[206:207], v26 offset:46216
  ds_read_b64_tr_b16 a[220:221], v26 offset:37056
  ds_read_b64_tr_b16 a[222:223], v26 offset:46272
  ds_read_b64_tr_b16 a[236:237], v26 offset:37064
  ds_read_b64_tr_b16 a[238:239], v26 offset:46280
  ds_read_b64_tr_b16 a[252:253], v26 offset:37120
  ds_read_b64_tr_b16 a[254:255], v26 offset:46336
  s_waitcnt lgkmcnt(0)
  s_mul_i32 s34, s44, 2654208
  s_mul_i32 s35, s43, 36864
  s_add_u32 s34, s34, s35
  v_mov_b64 v[32:33], -1
  v_mov_b64 v[34:35], -1
  s_add_u32 s51, s34, 75497472
  buffer_store_dwordx4 v[32:35], v14, s[4:7], s51 offen offset:0 sc1
  buffer_store_dwordx4 v[32:35], v14, s[4:7], s51 offen offset:1024 sc1
  buffer_store_dwordx4 v[32:35], v14, s[4:7], s51 offen offset:2048 sc1
  buffer_store_dwordx4 v[32:35], v14, s[4:7], s51 offen offset:3072 sc1
  s_add_u32 s51, s34, 75501568
  buffer_store_dwordx4 v[32:35], v14, s[4:7], s51 offen offset:0 sc1
  buffer_store_dwordx4 v[32:35], v14, s[4:7], s51 offen offset:1024 sc1
  buffer_store_dwordx4 v[32:35], v14, s[4:7], s51 offen offset:2048 sc1
  buffer_store_dwordx4 v[32:35], v14, s[4:7], s51 offen offset:3072 sc1
  s_add_u32 s51, s34, 75505664
  buffer_store_dwordx4 v[32:35], v14, s[4:7], s51 offen offset:0 sc1
  s_add_u32 s51, s34, 76824576
  buffer_store_dwordx4 v[32:35], v14, s[4:7], s51 offen offset:0 sc1
  buffer_store_dwordx4 v[32:35], v14, s[4:7], s51 offen offset:1024 sc1
  buffer_store_dwordx4 v[32:35], v14, s[4:7], s51 offen offset:2048 sc1
  buffer_store_dwordx4 v[32:35], v14, s[4:7], s51 offen offset:3072 sc1
  s_add_u32 s51, s34, 76828672
  buffer_store_dwordx4 v[32:35], v14, s[4:7], s51 offen offset:0 sc1
  buffer_store_dwordx4 v[32:35], v14, s[4:7], s51 offen offset:1024 sc1
  buffer_store_dwordx4 v[32:35], v14, s[4:7], s51 offen offset:2048 sc1
  buffer_store_dwordx4 v[32:35], v14, s[4:7], s51 offen offset:3072 sc1
  s_add_u32 s51, s34, 76832768
  buffer_store_dwordx4 v[32:35], v14, s[4:7], s51 offen offset:0 sc1
  s_cmp_lg_u32 s44, 3
  s_cbranch_scc1 L_f4_44
  s_waitcnt vmcnt(0)
  s_barrier
  s_cmp_lg_u32 s33, 0
  s_cbranch_scc1 L_meet_45
  v_mov_b32 v20, 1
  s_mov_b64 exec, 1
  buffer_atomic_add v20, off, s[8:11], 0 offset:64 sc0
  s_waitcnt vmcnt(0)
  v_readfirstlane_b32 s51, v20
  v_mov_b32 v20, 1
  s_cmp_lg_u32 s51, 35
  s_cbranch_scc1 L_cnt_46
  buffer_store_dword v20, off, s[8:11], 0 offset:156 sc1
L_cnt_46:
  s_mov_b64 exec, -1
L_f4_47:
  buffer_load_dword v20, off, s[8:11], 0 offset:156 sc1
  s_add_u32 s50, s50, 1
  s_cmp_ge_u32 s50, 262144
  s_waitcnt vmcnt(0)
  s_cbranch_scc1 L_f4_47_x
  v_cmp_ge_u32 vcc, 0, v20
  s_nop 0
  s_cbranch_vccnz L_f4_47
L_f4_47_x:
L_f4_48:
  buffer_load_dword v20, off, s[8:11], 0 offset:144 sc1
  s_add_u32 s50, s50, 1
  s_cmp_ge_u32 s50, 262144
  s_waitcnt vmcnt(0)
  s_cbranch_scc1 L_f4_48_x
  v_cmp_ge_u32 vcc, 0, v20
  s_nop 0
  s_cbranch_vccnz L_f4_48
L_f4_48_x:
L_meet_45:
  s_barrier
  s_mov_b32 s40, 57
  s_branch L_f4_44_x
L_f4_44:
  s_waitcnt vmcnt(0)
  s_barrier
  s_cmp_lg_u32 s33, 0
  s_cbranch_scc1 L_meet_49
  v_mov_b32 v20, 1
  s_mov_b64 exec, 1
  buffer_atomic_add v20, off, s[8:11], 0 offset:28 sc0
  s_waitcnt vmcnt(0)
  v_readfirstlane_b32 s51, v20
  v_mov_b32 v20, 1
  s_cmp_lg_u32 s51, 107
  s_cbranch_scc1 L_cnt_50
  buffer_store_dword v20, off, s[8:11], 0 offset:148 sc1
L_cnt_50:
  s_mov_b64 exec, -1
L_fi_51:
  buffer_load_dword v20, off, s[8:11], 0 offset:148 sc1
  s_add_u32 s50, s50, 1
  s_cmp_ge_u32 s50, 262144
  s_waitcnt vmcnt(0)
  s_cbranch_scc1 L_fi_51_x
  v_cmp_ge_u32 vcc, 0, v20
  s_nop 0
  s_cbranch_vccnz L_fi_51
L_fi_51_x:
L_fi_52:
  buffer_load_dword v20, off, s[8:11], 0 offset:144 sc1
  s_add_u32 s50, s50, 1
  s_cmp_ge_u32 s50, 262144
  s_waitcnt vmcnt(0)
  s_cbranch_scc1 L_fi_52_x
  v_cmp_ge_u32 vcc, 0, v20
  s_nop 0
  s_cbranch_vccnz L_fi_52
L_fi_52_x:
L_meet_49:
  s_barrier
  s_mov_b32 s40, s44
L_f4_44_x:
  s_mov_b32 s95, 0
  s_mov_b32 s48, 0
  v_min_u32 v19, 7, v0
  v_mul_u32_u24 v19, 1152, v19
  v_bfe_u32 v20, v0, 4, 1
  v_lshlrev_b32 v20, 10, v20
  v_lshrrev_b32 v21, 5, v0
  v_lshl_add_u32 v20, v21, 8, v20
  v_and_b32 v21, 15, v0
  v_lshl_add_u32 v24, v21, 4, v20
.p2align 5
L_ffn_l0:
  s_mul_i32 s45, s40, 36864
  s_add_u32 s35, s45, 7340032
  s_add_u32 s34, s45, 4194304
  s_bfe_u32 s60, s95, 0x10001
  s_and_b32 s41, s95, 1
  s_lshl1_add_u32 s41, s44, s41
  s_mul_i32 s41, s41, 1327104
  s_add_u32 s41, s41, 75497472
  s_cmp_ge_u32 s40, 54
  s_addc_u32 s49, s40, 3
  s_cmp_eq_u32 s48, 0
  s_cbranch_scc1 L_ffn_l0_reg
  s_waitcnt vmcnt(1)
  ds_read_b128 v[32:35], v18 offset:0
  ds_read_b128 v[36:39], v18 offset:1024
  ds_read_b128 v[40:43], v18 offset:2048
  ds_read_b128 v[44:47], v18 offset:3072
  ds_read_b128 v[48:51], v18 offset:4096
  ds_read_b128 v[52:55], v18 offset:5120
  ds_read_b128 v[56:59], v18 offset:6144
  ds_read_b128 v[60:63], v18 offset:7168
  ds_read_b128 v[64:67], v18 offset:8192
  s_waitcnt lgkmcnt(8)
  v_max_u32 v20, v32, v34
  s_waitcnt lgkmcnt(7)
  v_max3_u32 v20, v20, v36, v38
  s_waitcnt lgkmcnt(6)
  v_max3_u32 v20, v20, v40, v42
  s_waitcnt lgkmcnt(5)
  v_max3_u32 v20, v20, v44, v46
  s_waitcnt lgkmcnt(4)
  v_max3_u32 v20, v20, v48, v50
  s_waitcnt lgkmcnt(3)
  v_max3_u32 v20, v20, v52, v54
  s_waitcnt lgkmcnt(2)
  v_max3_u32 v20, v20, v56, v58
  s_waitcnt lgkmcnt(1)
  v_max3_u32 v20, v20, v60, v62
  s_waitcnt lgkmcnt(0)
  v_max3_u32 v20, v20, v64, v66
  v_cmp_eq_u32 vcc, -1, v20
  s_nop 0
  s_cbranch_vccz L_ffn_l0_xok
L_ffn_l0_reg:
  s_cmp_ge_u32 s40, 63
  s_cbranch_scc1 L_ffn_l0_p_x
L_ffn_l0_p:
  buffer_load_dword v20, v19, s[4:7], s34 offen sc1
  s_add_u32 s50, s50, 1
  s_cmp_ge_u32 s50, 262144
  s_waitcnt vmcnt(0)
  s_cbranch_scc1 L_ffn_l0_p_x
  v_cmp_eq_u32 vcc, -1, v20
  s_nop 0
  s_cbranch_vccnz L_ffn_l0_p
L_ffn_l0_p_x:
  buffer_load_dwordx4 v[32:35], v1, s[4:7], s35 offen sc1
  buffer_load_dwordx4 v[36:39], v2, s[4:7], s35 offen sc1
  buffer_load_dwordx4 v[40:43], v3, s[4:7], s35 offen sc1
  buffer_load_dwordx4 v[44:47], v4, s[4:7], s35 offen sc1
  buffer_load_dwordx4 v[48:51], v5, s[4:7], s35 offen sc1
  buffer_load_dwordx4 v[52:55], v6, s[4:7], s35 offen sc1
  buffer_load_dwordx4 v[56:59], v7, s[4:7], s35 offen sc1
  buffer_load_dwordx4 v[60:63], v8, s[4:7], s35 offen sc1
  buffer_load_dwordx4 v[64:67], v9, s[4:7], s35 offen sc1
L_ffn_x0_0:
  s_waitcnt vmcnt(8)
  ds_write_b128 v18, v[32:35] offset:0
  v_max_u32 v20, v32, v34
  s_waitcnt vmcnt(7)
  ds_write_b128 v18, v[36:39] offset:1024
  v_max3_u32 v20, v20, v36, v38
  s_waitcnt vmcnt(6)
  ds_write_b128 v18, v[40:43] offset:2048
  v_max3_u32 v20, v20, v40, v42
  v_cmp_eq_u32 vcc, -1, v20
  s_nop 0
  s_cbranch_vccz L_ffn_x0_0_x
  s_add_u32 s50, s50, 1
  s_cmp_ge_u32 s50, 262144
  s_cbranch_scc1 L_ffn_x0_0_x
  s_waitcnt lgkmcnt(0)
  buffer_load_dwordx4 v[32:35], v1, s[4:7], s35 offen sc1
  buffer_load_dwordx4 v[36:39], v2, s[4:7], s35 offen sc1
  buffer_load_dwordx4 v[40:43], v3, s[4:7], s35 offen sc1
  buffer_load_dwordx4 v[44:47], v4, s[4:7], s35 offen sc1
  buffer_load_dwordx4 v[48:51], v5, s[4:7], s35 offen sc1
  buffer_load_dwordx4 v[52:55], v6, s[4:7], s35 offen sc1
  buffer_load_dwordx4 v[56:59], v7, s[4:7], s35 offen sc1
  buffer_load_dwordx4 v[60:63], v8, s[4:7], s35 offen sc1
  buffer_load_dwordx4 v[64:67], v9, s[4:7], s35 offen sc1
  s_branch L_ffn_x0_0
L_ffn_x0_0_x:
L_ffn_x0_1:
  s_waitcnt vmcnt(5)
  ds_write_b128 v18, v[44:47] offset:3072
  v_max_u32 v20, v44, v46
  s_waitcnt vmcnt(4)
  ds_write_b128 v18, v[48:51] offset:4096
  v_max3_u32 v20, v20, v48, v50
  s_waitcnt vmcnt(3)
  ds_write_b128 v18, v[52:55] offset:5120
  v_max3_u32 v20, v20, v52, v54
  v_cmp_eq_u32 vcc, -1, v20
  s_nop 0
  s_cbranch_vccz L_ffn_x0_1_x
  s_add_u32 s50, s50, 1
  s_cmp_ge_u32 s50, 262144
  s_cbranch_scc1 L_ffn_x0_1_x
  s_waitcnt lgkmcnt(0)
  buffer_load_dwordx4 v[44:47], v4, s[4:7], s35 offen sc1
  buffer_load_dwordx4 v[48:51], v5, s[4:7], s35 offen sc1
  buffer_load_dwordx4 v[52:55], v6, s[4:7], s35 offen sc1
  buffer_load_dwordx4 v[56:59], v7, s[4:7], s35 offen sc1
  buffer_load_dwordx4 v[60:63], v8, s[4:7], s35 offen sc1
  buffer_load_dwordx4 v[64:67], v9, s[4:7], s35 offen sc1
  s_branch L_ffn_x0_1
L_ffn_x0_1_x:
L_ffn_x0_2:
  s_waitcnt vmcnt(2)
  ds_write_b128 v18, v[56:59] offset:6144
  v_max_u32 v20, v56, v58
  s_waitcnt vmcnt(1)
  ds_write_b128 v18, v[60:63] offset:7168
  v_max3_u32 v20, v20, v60, v62
  s_waitcnt vmcnt(0)
  ds_write_b128 v18, v[64:67] offset:8192
  v_max3_u32 v20, v20, v64, v66
  v_cmp_eq_u32 vcc, -1, v20
  s_nop 0
  s_cbranch_vccz L_ffn_x0_2_x
  s_add_u32 s50, s50, 1
  s_cmp_ge_u32 s50, 262144
  s_cbranch_scc1 L_ffn_x0_2_x
  s_waitcnt lgkmcnt(0)
  buffer_load_dwordx4 v[56:59], v7, s[4:7], s35 offen sc1
  buffer_load_dwordx4 v[60:63], v8, s[4:7], s35 offen sc1
  buffer_load_dwordx4 v[64:67], v9, s[4:7], s35 offen sc1
  s_branch L_ffn_x0_2
L_ffn_x0_2_x:
  s_waitcnt lgkmcnt(0)
L_ffn_l0_xok:
  s_barrier
  ds_read_b128 v[64:67], v10 offset:0
  ds_read_b128 v[68:71], v11 offset:0
  ds_read_b128 v[72:75], v12 offset:0
  s_add_u32 s34, s45, 4194304
  s_waitcnt lgkmcnt(2)
  v_mfma_f32_32x32x16_bf16 v[32:47], v[80:83], v[64:67], 0
  ds_read_b128 v[76:79], v13 offset:0
  v_mfma_f32_32x32x16_bf16 v[48:63], v[84:87], v[64:67], 0
  s_waitcnt lgkmcnt(2)
  v_mfma_f32_32x32x16_bf16 v[32:47], v[88:91], v[68:71], v[32:47]
  ds_read_b128 v[64:67], v10 offset:128
  v_mfma_f32_32x32x16_bf16 v[48:63], v[92:95], v[68:71], v[48:63]
  s_waitcnt lgkmcnt(2)
  v_mfma_f32_32x32x16_bf16 v[32:47], v[96:99], v[72:75], v[32:47]
  ds_read_b128 v[68:71], v11 offset:128
  v_mfma_f32_32x32x16_bf16 v[48:63], v[100:103], v[72:75], v[48:63]
  s_waitcnt lgkmcnt(2)
  v_mfma_f32_32x32x16_bf16 v[32:47], v[104:107], v[76:79], v[32:47]
  ds_read_b128 v[72:75], v12 offset:128
  v_mfma_f32_32x32x16_bf16 v[48:63], v[108:111], v[76:79], v[48:63]
  s_waitcnt lgkmcnt(2)
  v_mfma_f32_32x32x16_bf16 v[32:47], v[112:115], v[64:67], v[32:47]
  ds_read_b128 v[76:79], v13 offset:128
  v_mfma_f32_32x32x16_bf16 v[48:63], v[116:119], v[64:67], v[48:63]
  s_waitcnt lgkmcnt(2)
  v_mfma_f32_32x32x16_bf16 v[32:47], v[120:123], v[68:71], v[32:47]
  ds_read_b128 v[64:67], v10 offset:256
  v_mfma_f32_32x32x16_bf16 v[48:63], v[124:127], v[68:71], v[48:63]
  s_waitcnt lgkmcnt(2)
  v_mfma_f32_32x32x16_bf16 v[32:47], v[128:131], v[72:75], v[32:47]
  ds_read_b128 v[68:71], v11 offset:256
  v_mfma_f32_32x32x16_bf16 v[48:63], v[132:135], v[72:75], v[48:63]
  s_waitcnt lgkmcnt(2)
  v_mfma_f32_32x32x16_bf16 v[32:47], v[136:139], v[76:79], v[32:47]
  ds_read_b128 v[72:75], v12 offset:256
  v_mfma_f32_32x32x16_bf16 v[48:63], v[140:143], v[76:79], v[48:63]
  s_waitcnt lgkmcnt(2)
  v_mfma_f32_32x32x16_bf16 v[32:47], v[144:147], v[64:67], v[32:47]
  ds_read_b128 v[76:79], v13 offset:256
  v_mfma_f32_32x32x16_bf16 v[48:63], v[148:151], v[64:67], v[48:63]
  buffer_load_dwordx2 v[26:27], v17, s[4:7], s34 offen sc1
  s_waitcnt lgkmcnt(2)
  v_mfma_f32_32x32x16_bf16 v[32:47], v[152:155], v[68:71], v[32:47]
  ds_read_b128 v[64:67], v10 offset:384
  v_mfma_f32_32x32x16_bf16 v[48:63], v[156:159], v[68:71], v[48:63]
  s_waitcnt lgkmcnt(2)
  v_mfma_f32_32x32x16_bf16 v[32:47], v[160:163], v[72:75], v[32:47]
  ds_read_b128 v[68:71], v11 offset:384
  v_mfma_f32_32x32x16_bf16 v[48:63], v[164:167], v[72:75], v[48:63]
  s_waitcnt lgkmcnt(2)
  v_mfma_f32_32x32x16_bf16 v[32:47], v[168:171], v[76:79], v[32:47]
  ds_read_b128 v[72:75], v12 offset:384
  v_mfma_f32_32x32x16_bf16 v[48:63], v[172:175], v[76:79], v[48:63]
  s_waitcnt lgkmcnt(2)
  v_mfma_f32_32x32x16_bf16 v[32:47], v[176:179], v[64:67], v[32:47]
  ds_read_b128 v[76:79], v13 offset:384
  v_mfma_f32_32x32x16_bf16 v[48:63], v[180:183], v[64:67], v[48:63]
  s_waitcnt lgkmcnt(2)
  v_mfma_f32_32x32x16_bf16 v[32:47], v[184:187], v[68:71], v[32:47]
  ds_read_b128 v[64:67], v10 offset:512
  v_mfma_f32_32x32x16_bf16 v[48:63], v[188:191], v[68:71], v[48:63]
  s_waitcnt lgkmcnt(2)
  v_mfma_f32_32x32x16_bf16 v[32:47], v[192:195], v[72:75], v[32:47]
  ds_read_b128 v[68:71], v11 offset:512
  v_mfma_f32_32x32x16_bf16 v[48:63], v[196:199], v[72:75], v[48:63]
  s_waitcnt lgkmcnt(2)
  v_mfma_f32_32x32x16_bf16 v[32:47], v[200:203], v[76:79], v[32:47]
  ds_read_b128 v[72:75], v12 offset:512
  v_mfma_f32_32x32x16_bf16 v[48:63], v[204:207], v[76:79], v[48:63]
  s_waitcnt lgkmcnt(2)
  v_mfma_f32_32x32x16_bf16 v[32:47], v[208:211], v[64:67], v[32:47]
  ds_read_b128 v[76:79], v13 offset:512
  v_mfma_f32_32x32x16_bf16 v[48:63], v[212:215], v[64:67], v[48:63]
  s_waitcnt lgkmcnt(2)
  v_mfma_f32_32x32x16_bf16 v[32:47], v[216:219], v[68:71], v[32:47]
  ds_read_b128 v[64:67], v10 offset:640
  v_mfma_f32_32x32x16_bf16 v[48:63], v[220:223], v[68:71], v[48:63]
  s_waitcnt lgkmcnt(2)
  v_mfma_f32_32x32x16_bf16 v[32:47], v[224:227], v[72:75], v[32:47]
  ds_read_b128 v[68:71], v11 offset:640
  v_mfma_f32_32x32x16_bf16 v[48:63], v[228:231], v[72:75], v[48:63]
  s_waitcnt lgkmcnt(2)
  v_mfma_f32_32x32x16_bf16 v[32:47], v[232:235], v[76:79], v[32:47]
  ds_read_b128 v[72:75], v12 offset:640
  v_mfma_f32_32x32x16_bf16 v[48:63], v[236:239], v[76:79], v[48:63]
  s_waitcnt lgkmcnt(2)
  v_mfma_f32_32x32x16_bf16 v[32:47], v[240:243], v[64:67], v[32:47]
  ds_read_b128 v[76:79], v13 offset:640
  v_mfma_f32_32x32x16_bf16 v[48:63], v[244:247], v[64:67], v[48:63]
  s_waitcnt lgkmcnt(2)
  v_mfma_f32_32x32x16_bf16 v[32:47], v[248:251], v[68:71], v[32:47]
  ds_read_b128 v[64:67], v10 offset:768
  v_mfma_f32_32x32x16_bf16 v[48:63], v[252:255], v[68:71], v[48:63]
  s_waitcnt lgkmcnt(2)
  v_mfma_f32_32x32x16_bf16 v[32:47], a[0:3], v[72:75], v[32:47]
  ds_read_b128 v[68:71], v11 offset:768
  v_mfma_f32_32x32x16_bf16 v[48:63], a[4:7], v[72:75], v[48:63]
  s_waitcnt lgkmcnt(2)
  v_mfma_f32_32x32x16_bf16 v[32:47], a[8:11], v[76:79], v[32:47]
  ds_read_b128 v[72:75], v12 offset:768
  v_mfma_f32_32x32x16_bf16 v[48:63], a[12:15], v[76:79], v[48:63]
  s_waitcnt lgkmcnt(2)
  v_mfma_f32_32x32x16_bf16 v[32:47], a[16:19], v[64:67], v[32:47]
  ds_read_b128 v[76:79], v13 offset:768
  v_mfma_f32_32x32x16_bf16 v[48:63], a[20:23], v[64:67], v[48:63]
  s_waitcnt lgkmcnt(2)
  v_mfma_f32_32x32x16_bf16 v[32:47], a[24:27], v[68:71], v[32:47]
  ds_read_b128 v[64:67], v10 offset:896
  v_mfma_f32_32x32x16_bf16 v[48:63], a[28:31], v[68:71], v[48:63]
  s_waitcnt lgkmcnt(2)
  v_mfma_f32_32x32x16_bf16 v[32:47], a[32:35], v[72:75], v[32:47]
  ds_read_b128 v[68:71], v11 offset:896
  v_mfma_f32_32x32x16_bf16 v[48:63], a[36:39], v[72:75], v[48:63]
  s_waitcnt lgkmcnt(2)
  v_mfma_f32_32x32x16_bf16 v[32:47], a[40:43], v[76:79], v[32:47]
  ds_read_b128 v[72:75], v12 offset:896
  v_mfma_f32_32x32x16_bf16 v[48:63], a[44:47], v[76:79], v[48:63]
  s_waitcnt lgkmcnt(2)
  v_mfma_f32_32x32x16_bf16 v[32:47], a[48:51], v[64:67], v[32:47]
  ds_read_b128 v[76:79], v13 offset:896
  v_mfma_f32_32x32x16_bf16 v[48:63], a[52:55], v[64:67], v[48:63]
  s_waitcnt lgkmcnt(2)
  v_mfma_f32_32x32x16_bf16 v[32:47], a[56:59], v[68:71], v[32:47]
  ds_read_b128 v[64:67], v10 offset:1024
  v_mfma_f32_32x32x16_bf16 v[48:63], a[60:63], v[68:71], v[48:63]
  s_waitcnt lgkmcnt(2)
  v_mfma_f32_32x32x16_bf16 v[32:47], a[64:67], v[72:75], v[32:47]
  ds_read_b128 v[68:71], v11 offset:1024
  v_mfma_f32_32x32x16_bf16 v[48:63], a[68:71], v[72:75], v[48:63]
  s_waitcnt lgkmcnt(2)
  v_mfma_f32_32x32x16_bf16 v[32:47], a[72:75], v[76:79], v[32:47]
  ds_read_b128 v[72:75], v12 offset:1024
  v_mfma_f32_32x32x16_bf16 v[48:63], a[76:79], v[76:79], v[48:63]
  s_waitcnt lgkmcnt(2)
  v_mfma_f32_32x32x16_bf16 v[32:47], a[80:83], v[64:67], v[32:47]
  ds_read_b128 v[76:79], v13 offset:1024
  v_mfma_f32_32x32x16_bf16 v[48:63], a[84:87], v[64:67], v[48:63]
  s_waitcnt lgkmcnt(2)
  v_mfma_f32_32x32x16_bf16 v[32:47], a[88:91], v[68:71], v[32:47]
  v_mfma_f32_32x32x16_bf16 v[48:63], a[92:95], v[68:71], v[48:63]
  s_waitcnt lgkmcnt(1)
  v_mfma_f32_32x32x16_bf16 v[32:47], a[96:99], v[72:75], v[32:47]
  v_mfma_f32_32x32x16_bf16 v[48:63], a[100:103], v[72:75], v[48:63]
  s_waitcnt lgkmcnt(0)
  v_mfma_f32_32x32x16_bf16 v[32:47], a[104:107], v[76:79], v[32:47]
  v_mfma_f32_32x32x16_bf16 v[48:63], a[108:111], v[76:79], v[48:63]
  s_nop 4
  v_max_f32 v32, 0, v32
  v_max_f32 v33, 0, v33
  v_max_f32 v34, 0, v34
  v_max_f32 v35, 0, v35
  v_max_f32 v36, 0, v36
  v_max_f32 v37, 0, v37
  v_max_f32 v38, 0, v38
  v_max_f32 v39, 0, v39
  v_max_f32 v40, 0, v40
  v_max_f32 v41, 0, v41
  v_max_f32 v42, 0, v42
  v_max_f32 v43, 0, v43
  v_max_f32 v44, 0, v44
  v_max_f32 v45, 0, v45
  v_max_f32 v46, 0, v46
  v_max_f32 v47, 0, v47
  v_pk_mul_f32 v[32:33], v[32:33], v[48:49]
  v_pk_mul_f32 v[34:35], v[34:35], v[50:51]
  v_pk_mul_f32 v[36:37], v[36:37], v[52:53]
  v_pk_mul_f32 v[38:39], v[38:39], v[54:55]
  v_cvt_pk_bf16_f32 v32, v32, v33
  v_cvt_pk_bf16_f32 v33, v34, v35
  v_cvt_pk_bf16_f32 v34, v36, v37
  v_cvt_pk_bf16_f32 v35, v38, v39
  ds_write_b128 v24, v[32:35] offset:40960
  v_pk_mul_f32 v[40:41], v[40:41], v[56:57]
  v_pk_mul_f32 v[42:43], v[42:43], v[58:59]
  v_pk_mul_f32 v[44:45], v[44:45], v[60:61]
  v_pk_mul_f32 v[46:47], v[46:47], v[62:63]
  v_cvt_pk_bf16_f32 v40, v40, v41
  v_cvt_pk_bf16_f32 v41, v42, v43
  v_cvt_pk_bf16_f32 v42, v44, v45
  v_cvt_pk_bf16_f32 v43, v46, v47
  ds_write_b128 v24, v[40:43] offset:41472
  s_waitcnt lgkmcnt(0)
  s_barrier
  ds_read_b128 v[32:35], v14 offset:40960
  ds_read_b128 v[36:39], v14 offset:41984
  ds_read_b128 v[40:43], v14 offset:43008
  ds_read_b128 v[44:47], v14 offset:44032
  ds_read_b128 v[48:51], v14 offset:45056
  ds_read_b128 v[52:55], v14 offset:46080
  ds_read_b128 v[56:59], v14 offset:47104
  ds_read_b128 v[60:63], v14 offset:48128
  s_waitcnt lgkmcnt(7)
  v_mfma_f32_16x16x32_bf16 v[64:67], a[112:115], v[32:35], 0
  v_mfma_f32_16x16x32_bf16 v[68:71], a[128:131], v[32:35], 0
  s_waitcnt lgkmcnt(5)
  v_mfma_f32_16x16x32_bf16 v[64:67], a[116:119], v[40:43], v[64:67]
  v_mfma_f32_16x16x32_bf16 v[68:71], a[132:135], v[40:43], v[68:71]
  s_waitcnt lgkmcnt(3)
  v_mfma_f32_16x16x32_bf16 v[64:67], a[120:123], v[48:51], v[64:67]
  v_mfma_f32_16x16x32_bf16 v[68:71], a[136:139], v[48:51], v[68:71]
  s_waitcnt lgkmcnt(1)
  v_mfma_f32_16x16x32_bf16 v[64:67], a[124:127], v[56:59], v[64:67]
  v_mfma_f32_16x16x32_bf16 v[68:71], a[140:143], v[56:59], v[68:71]
  v_mfma_f32_16x16x32_bf16 v[72:75], a[112:115], v[36:39], 0
  v_mfma_f32_16x16x32_bf16 v[76:79], a[128:131], v[36:39], 0
  v_mfma_f32_16x16x32_bf16 v[72:75], a[116:119], v[44:47], v[72:75]
  v_mfma_f32_16x16x32_bf16 v[76:79], a[132:135], v[44:47], v[76:79]
  s_add_u32 s51, s41, 0
  v_cvt_pk_bf16_f32 v64, v64, v65
  v_cvt_pk_bf16_f32 v65, v66, v67
  v_cvt_pk_bf16_f32 v66, v68, v69
  v_cvt_pk_bf16_f32 v67, v70, v71
  v_bfi_b32 v64, 1, s60, v64
  v_bfi_b32 v66, 1, s60, v66
  buffer_store_dwordx4 v[64:67], v15, s[4:7], s51 offen sc1
  v_mfma_f32_16x16x32_bf16 v[72:75], a[120:123], v[52:55], v[72:75]
  v_mfma_f32_16x16x32_bf16 v[76:79], a[136:139], v[52:55], v[76:79]
  s_waitcnt lgkmcnt(0)
  v_mfma_f32_16x16x32_bf16 v[72:75], a[124:127], v[60:63], v[72:75]
  v_mfma_f32_16x16x32_bf16 v[76:79], a[140:143], v[60:63], v[76:79]
  v_mfma_f32_16x16x32_bf16 v[64:67], a[144:147], v[32:35], 0
  v_mfma_f32_16x16x32_bf16 v[68:71], a[160:163], v[32:35], 0
  v_mfma_f32_16x16x32_bf16 v[64:67], a[148:151], v[40:43], v[64:67]
  v_mfma_f32_16x16x32_bf16 v[68:71], a[164:167], v[40:43], v[68:71]
  s_add_u32 s51, s41, 663552
  v_cvt_pk_bf16_f32 v72, v72, v73
  v_cvt_pk_bf16_f32 v73, v74, v75
  v_cvt_pk_bf16_f32 v74, v76, v77
  v_cvt_pk_bf16_f32 v75, v78, v79
  v_bfi_b32 v72, 1, s60, v72
  v_bfi_b32 v74, 1, s60, v74
  buffer_store_dwordx4 v[72:75], v15, s[4:7], s51 offen sc1
  v_mfma_f32_16x16x32_bf16 v[64:67], a[152:155], v[48:51], v[64:67]
  v_mfma_f32_16x16x32_bf16 v[68:71], a[168:171], v[48:51], v[68:71]
  v_mfma_f32_16x16x32_bf16 v[64:67], a[156:159], v[56:59], v[64:67]
  v_mfma_f32_16x16x32_bf16 v[68:71], a[172:175], v[56:59], v[68:71]
  v_mfma_f32_16x16x32_bf16 v[72:75], a[144:147], v[36:39], 0
  v_mfma_f32_16x16x32_bf16 v[76:79], a[160:163], v[36:39], 0
  v_mfma_f32_16x16x32_bf16 v[72:75], a[148:151], v[44:47], v[72:75]
  v_mfma_f32_16x16x32_bf16 v[76:79], a[164:167], v[44:47], v[76:79]
  s_add_u32 s51, s41, 36864
  v_cvt_pk_bf16_f32 v64, v64, v65
  v_cvt_pk_bf16_f32 v65, v66, v67
  v_cvt_pk_bf16_f32 v66, v68, v69
  v_cvt_pk_bf16_f32 v67, v70, v71
  v_bfi_b32 v64, 1, s60, v64
  v_bfi_b32 v66, 1, s60, v66
  buffer_store_dwordx4 v[64:67], v15, s[4:7], s51 offen sc1
  v_mfma_f32_16x16x32_bf16 v[72:75], a[152:155], v[52:55], v[72:75]
  v_mfma_f32_16x16x32_bf16 v[76:79], a[168:171], v[52:55], v[76:79]
  v_mfma_f32_16x16x32_bf16 v[72:75], a[156:159], v[60:63], v[72:75]
  v_mfma_f32_16x16x32_bf16 v[76:79], a[172:175], v[60:63], v[76:79]
  v_mfma_f32_16x16x32_bf16 v[64:67], a[176:179], v[32:35], 0
  v_mfma_f32_16x16x32_bf16 v[68:71], a[192:195], v[32:35], 0
  v_mfma_f32_16x16x32_bf16 v[64:67], a[180:183], v[40:43], v[64:67]
  v_mfma_f32_16x16x32_bf16 v[68:71], a[196:199], v[40:43], v[68:71]
  s_add_u32 s51, s41, 700416
  v_cvt_pk_bf16_f32 v72, v72, v73
  v_cvt_pk_bf16_f32 v73, v74, v75
  v_cvt_pk_bf16_f32 v74, v76, v77
  v_cvt_pk_bf16_f32 v75, v78, v79
  v_bfi_b32 v72, 1, s60, v72
  v_bfi_b32 v74, 1, s60, v74
  buffer_store_dwordx4 v[72:75], v15, s[4:7], s51 offen sc1
  v_mfma_f32_16x16x32_bf16 v[64:67], a[184:187], v[48:51], v[64:67]
  v_mfma_f32_16x16x32_bf16 v[68:71], a[200:203], v[48:51], v[68:71]
  v_mfma_f32_16x16x32_bf16 v[64:67], a[188:191], v[56:59], v[64:67]
  v_mfma_f32_16x16x32_bf16 v[68:71], a[204:207], v[56:59], v[68:71]
  v_mfma_f32_16x16x32_bf16 v[72:75], a[176:179], v[36:39], 0
  v_mfma_f32_16x16x32_bf16 v[76:79], a[192:195], v[36:39], 0
  v_mfma_f32_16x16x32_bf16 v[72:75], a[180:183], v[44:47], v[72:75]
  v_mfma_f32_16x16x32_bf16 v[76:79], a[196:199], v[44:47], v[76:79]
  s_add_u32 s51, s41, 73728
  v_cvt_pk_bf16_f32 v64, v64, v65
  v_cvt_pk_bf16_f32 v65, v66, v67
  v_cvt_pk_bf16_f32 v66, v68, v69
  v_cvt_pk_bf16_f32 v67, v70, v71
  v_bfi_b32 v64, 1, s60, v64
  v_bfi_b32 v66, 1, s60, v66
  buffer_store_dwordx4 v[64:67], v15, s[4:7], s51 offen sc1
  v_mfma_f32_16x16x32_bf16 v[72:75], a[184:187], v[52:55], v[72:75]
  v_mfma_f32_16x16x32_bf16 v[76:79], a[200:203], v[52:55], v[76:79]
  v_mfma_f32_16x16x32_bf16 v[72:75], a[188:191], v[60:63], v[72:75]
  v_mfma_f32_16x16x32_bf16 v[76:79], a[204:207], v[60:63], v[76:79]
  v_mfma_f32_16x16x32_bf16 v[64:67], a[208:211], v[32:35], 0
  v_mfma_f32_16x16x32_bf16 v[68:71], a[224:227], v[32:35], 0
  v_mfma_f32_16x16x32_bf16 v[64:67], a[212:215], v[40:43], v[64:67]
  v_mfma_f32_16x16x32_bf16 v[68:71], a[228:231], v[40:43], v[68:71]
  s_add_u32 s51, s41, 737280
  v_cvt_pk_bf16_f32 v72, v72, v73
  v_cvt_pk_bf16_f32 v73, v74, v75
  v_cvt_pk_bf16_f32 v74, v76, v77
  v_cvt_pk_bf16_f32 v75, v78, v79
  v_bfi_b32 v72, 1, s60, v72
  v_bfi_b32 v74, 1, s60, v74
  buffer_store_dwordx4 v[72:75], v15, s[4:7], s51 offen sc1
  v_mfma_f32_16x16x32_bf16 v[64:67], a[216:219], v[48:51], v[64:67]
  v_mfma_f32_16x16x32_bf16 v[68:71], a[232:235], v[48:51], v[68:71]
  v_mfma_f32_16x16x32_bf16 v[64:67], a[220:223], v[56:59], v[64:67]
  v_mfma_f32_16x16x32_bf16 v[68:71], a[236:239], v[56:59], v[68:71]
  v_mfma_f32_16x16x32_bf16 v[72:75], a[208:211], v[36:39], 0
  v_mfma_f32_16x16x32_bf16 v[76:79], a[224:227], v[36:39], 0
  v_mfma_f32_16x16x32_bf16 v[72:75], a[212:215], v[44:47], v[72:75]
  v_mfma_f32_16x16x32_bf16 v[76:79], a[228:231], v[44:47], v[76:79]
  s_add_u32 s51, s41, 110592
  v_cvt_pk_bf16_f32 v64, v64, v65
  v_cvt_pk_bf16_f32 v65, v66, v67
  v_cvt_pk_bf16_f32 v66, v68, v69
  v_cvt_pk_bf16_f32 v67, v70, v71
  v_bfi_b32 v64, 1, s60, v64
  v_bfi_b32 v66, 1, s60, v66
  buffer_store_dwordx4 v[64:67], v15, s[4:7], s51 offen sc1
  v_mfma_f32_16x16x32_bf16 v[72:75], a[216:219], v[52:55], v[72:75]
  v_mfma_f32_16x16x32_bf16 v[76:79], a[232:235], v[52:55], v[76:79]
  v_mfma_f32_16x16x32_bf16 v[72:75], a[220:223], v[60:63], v[72:75]
  v_mfma_f32_16x16x32_bf16 v[76:79], a[236:239], v[60:63], v[76:79]
  s_mul_i32 s35, s49, 36864
  s_add_u32 s35, s35, 7340032
  s_load_dword s52, s[4:5], s35 offset:0 glc
  s_load_dword s53, s[4:5], s35 offset:1152 glc
  s_load_dword s54, s[4:5], s35 offset:2304 glc
  s_load_dword s55, s[4:5], s35 offset:3456 glc
  s_load_dword s56, s[4:5], s35 offset:4608 glc
  s_load_dword s57, s[4:5], s35 offset:5760 glc
  s_load_dword s58, s[4:5], s35 offset:6912 glc
  s_load_dword s59, s[4:5], s35 offset:8064 glc
  v_mfma_f32_16x16x32_bf16 v[64:67], a[240:243], v[32:35], 0
  v_mfma_f32_16x16x32_bf16 v[64:67], a[244:247], v[40:43], v[64:67]
  s_add_u32 s51, s41, 774144
  v_cvt_pk_bf16_f32 v72, v72, v73
  v_cvt_pk_bf16_f32 v73, v74, v75
  v_cvt_pk_bf16_f32 v74, v76, v77
  v_cvt_pk_bf16_f32 v75, v78, v79
  v_bfi_b32 v72, 1, s60, v72
  v_bfi_b32 v74, 1, s60, v74
  buffer_store_dwordx4 v[72:75], v15, s[4:7], s51 offen sc1
  v_mfma_f32_16x16x32_bf16 v[64:67], a[248:251], v[48:51], v[64:67]
  v_mfma_f32_16x16x32_bf16 v[64:67], a[252:255], v[56:59], v[64:67]
  v_mfma_f32_16x16x32_bf16 v[72:75], a[240:243], v[36:39], 0
  v_mfma_f32_16x16x32_bf16 v[72:75], a[244:247], v[44:47], v[72:75]
  s_add_u32 s51, s41, 147456
  v_cvt_pk_bf16_f32 v64, v64, v65
  v_cvt_pk_bf16_f32 v65, v66, v67
  v_bfi_b32 v64, 1, s60, v64
  buffer_store_dwordx2 v[64:65], v15, s[4:7], s51 offen offset:0 sc1
  v_mfma_f32_16x16x32_bf16 v[72:75], a[248:251], v[52:55], v[72:75]
  v_mfma_f32_16x16x32_bf16 v[72:75], a[252:255], v[60:63], v[72:75]
  s_add_u32 s51, s41, 811008
  s_nop 6
  v_cvt_pk_bf16_f32 v72, v72, v73
  v_cvt_pk_bf16_f32 v73, v74, v75
  v_bfi_b32 v72, 1, s60, v72
  buffer_store_dwordx2 v[72:73], v15, s[4:7], s51 offen offset:0 sc1
  s_waitcnt vmcnt(2)
  s_add_u32 s51, s41, 0
  buffer_load_dwordx4 v[32:35], v16, s[4:7], s51 offen sc1
  s_add_u32 s51, s41, 4096
  buffer_load_dwordx4 v[36:39], v16, s[4:7], s51 offen sc1
  s_add_u32 s51, s41, 8192
  buffer_load_dwordx4 v[40:43], v16, s[4:7], s51 offen sc1
  s_add_u32 s51, s41, 12288
  buffer_load_dwordx4 v[44:47], v16, s[4:7], s51 offen sc1
  s_add_u32 s51, s41, 16384
  buffer_load_dwordx4 v[48:51], v16, s[4:7], s51 offen sc1
  s_add_u32 s51, s41, 20480
  buffer_load_dwordx4 v[52:55], v16, s[4:7], s51 offen sc1
  s_add_u32 s51, s41, 24576
  buffer_load_dwordx4 v[56:59], v16, s[4:7], s51 offen sc1
  s_add_u32 s51, s41, 28672
  buffer_load_dwordx4 v[60:63], v16, s[4:7], s51 offen sc1
  s_add_u32 s51, s41, 32768
  buffer_load_dwordx4 v[64:67], v16, s[4:7], s51 offen sc1
  s_waitcnt lgkmcnt(0)
  s_max_u32 s52, s52, s53
  s_max_u32 s52, s52, s54
  s_max_u32 s52, s52, s55
  s_max_u32 s52, s52, s56
  s_max_u32 s52, s52, s57
  s_max_u32 s52, s52, s58
  s_max_u32 s52, s52, s59
  s_cmp_lt_u32 s49, 64
  s_cselect_b32 s52, s52, -1
  s_cmp_lg_u32 s52, -1
  s_cselect_b32 s48, 1, 0
  s_cbranch_scc0 L_ffn_f0_0
  s_mov_b32 m0, s42
  s_nop 0
  buffer_load_dwordx4 v1, s[4:7], s35 offen sc1 lds
  s_add_u32 m0, s42, 1024
  s_nop 0
  buffer_load_dwordx4 v2, s[4:7], s35 offen sc1 lds
  s_add_u32 m0, s42, 2048
  s_nop 0
  buffer_load_dwordx4 v3, s[4:7], s35 offen sc1 lds
  s_add_u32 m0, s42, 3072
  s_nop 0
  buffer_load_dwordx4 v4, s[4:7], s35 offen sc1 lds
  s_add_u32 m0, s42, 4096
  s_nop 0
  buffer_load_dwordx4 v5, s[4:7], s35 offen sc1 lds
  s_add_u32 m0, s42, 5120
  s_nop 0
  buffer_load_dwordx4 v6, s[4:7], s35 offen sc1 lds
  s_add_u32 m0, s42, 6144
  s_nop 0
  buffer_load_dwordx4 v7, s[4:7], s35 offen sc1 lds
  s_add_u32 m0, s42, 7168
  s_nop 0
  buffer_load_dwordx4 v8, s[4:7], s35 offen sc1 lds
  s_add_u32 m0, s42, 8192
  s_nop 0
  buffer_load_dwordx4 v9, s[4:7], s35 offen sc1 lds
  s_waitcnt vmcnt(15)
  v_bitop3_b32 v20, v32, v34, s60 bitop3:0x7e
  v_bitop3_b32 v21, v36, v38, s60 bitop3:0x7e
  v_bitop3_b32 v22, v40, v42, s60 bitop3:0x7e
  v_or3_b32 v20, v20, v21, v22
  v_and_b32 v20, 1, v20
  v_cmp_eq_u32 vcc, -1, v26
  s_nop 1
  v_cndmask_b32 v20, v20, 1, vcc
  v_cmp_eq_u32 vcc, 1, v20
  s_nop 0
  s_cbranch_vccnz L_ffn_f0_0_r
  v_lshlrev_b32 v68, 16, v26
  v_and_b32 v69, 0xffff0000, v26
  v_lshlrev_b32 v70, 16, v27
  v_and_b32 v71, 0xffff0000, v27
  s_nop 1
  v_mfma_f32_16x16x32_bf16 v[68:71], v[28:31], v[32:35], v[68:71]
  v_mfma_f32_16x16x32_bf16 v[68:71], v[28:31], v[36:39], v[68:71]
  v_mfma_f32_16x16x32_bf16 v[68:71], v[28:31], v[40:43], v[68:71]
  s_waitcnt vmcnt(12)
  v_bitop3_b32 v20, v44, v46, s60 bitop3:0x7e
  v_bitop3_b32 v21, v48, v50, s60 bitop3:0x7e
  v_bitop3_b32 v22, v52, v54, s60 bitop3:0x7e
  v_or3_b32 v20, v20, v21, v22
  v_and_b32 v20, 1, v20
  v_cmp_eq_u32 vcc, 1, v20
  s_nop 0
  s_cbranch_vccnz L_ffn_f0_1_r
  v_mfma_f32_16x16x32_bf16 v[68:71], v[28:31], v[44:47], v[68:71]
  v_mfma_f32_16x16x32_bf16 v[68:71], v[28:31], v[48:51], v[68:71]
  v_mfma_f32_16x16x32_bf16 v[68:71], v[28:31], v[52:55], v[68:71]
  s_waitcnt vmcnt(9)
  v_bitop3_b32 v20, v56, v58, s60 bitop3:0x7e
  v_bitop3_b32 v21, v60, v62, s60 bitop3:0x7e
  v_bitop3_b32 v22, v64, v66, s60 bitop3:0x7e
  v_or3_b32 v20, v20, v21, v22
  v_and_b32 v20, 1, v20
  v_cmp_eq_u32 vcc, 1, v20
  s_nop 0
  s_cbranch_vccnz L_ffn_f0_2_r
  v_mfma_f32_16x16x32_bf16 v[68:71], v[28:31], v[56:59], v[68:71]
  v_mfma_f32_16x16x32_bf16 v[68:71], v[28:31], v[60:63], v[68:71]
  v_mfma_f32_16x16x32_bf16 v[68:71], v[28:31], v[64:67], v[68:71]
  s_branch L_ffn_l0_out
L_ffn_f0_0:
  s_waitcnt vmcnt(6)
  v_bitop3_b32 v20, v32, v34, s60 bitop3:0x7e
  v_bitop3_b32 v21, v36, v38, s60 bitop3:0x7e
  v_bitop3_b32 v22, v40, v42, s60 bitop3:0x7e
  v_or3_b32 v20, v20, v21, v22
  v_and_b32 v20, 1, v20
  v_cmp_eq_u32 vcc, -1, v26
  s_nop 1
  v_cndmask_b32 v20, v20, 1, vcc
  v_cmp_eq_u32 vcc, 1, v20
  s_nop 0
  s_cbranch_vccz L_ffn_f0_0_x
L_ffn_f0_0_r:
  s_add_u32 s50, s50, 1
  s_cmp_ge_u32 s50, 262144
  s_cbranch_scc1 L_ffn_f0_0_x
  buffer_load_dwordx2 v[26:27], v17, s[4:7], s34 offen sc1
  s_add_u32 s51, s41, 0
  buffer_load_dwordx4 v[32:35], v16, s[4:7], s51 offen sc1
  s_add_u32 s51, s41, 4096
  buffer_load_dwordx4 v[36:39], v16, s[4:7], s51 offen sc1
  s_add_u32 s51, s41, 8192
  buffer_load_dwordx4 v[40:43], v16, s[4:7], s51 offen sc1
  s_add_u32 s51, s41, 12288
  buffer_load_dwordx4 v[44:47], v16, s[4:7], s51 offen sc1
  s_add_u32 s51, s41, 16384
  buffer_load_dwordx4 v[48:51], v16, s[4:7], s51 offen sc1
  s_add_u32 s51, s41, 20480
  buffer_load_dwordx4 v[52:55], v16, s[4:7], s51 offen sc1
  s_add_u32 s51, s41, 24576
  buffer_load_dwordx4 v[56:59], v16, s[4:7], s51 offen sc1
  s_add_u32 s51, s41, 28672
  buffer_load_dwordx4 v[60:63], v16, s[4:7], s51 offen sc1
  s_add_u32 s51, s41, 32768
  buffer_load_dwordx4 v[64:67], v16, s[4:7], s51 offen sc1
  s_branch L_ffn_f0_0
L_ffn_f0_0_x:
  v_lshlrev_b32 v68, 16, v26
  v_and_b32 v69, 0xffff0000, v26
  v_lshlrev_b32 v70, 16, v27
  v_and_b32 v71, 0xffff0000, v27
  s_nop 1
  v_mfma_f32_16x16x32_bf16 v[68:71], v[28:31], v[32:35], v[68:71]
  v_mfma_f32_16x16x32_bf16 v[68:71], v[28:31], v[36:39], v[68:71]
  v_mfma_f32_16x16x32_bf16 v[68:71], v[28:31], v[40:43], v[68:71]
L_ffn_f0_1:
  s_waitcnt vmcnt(3)
  v_bitop3_b32 v20, v44, v46, s60 bitop3:0x7e
  v_bitop3_b32 v21, v48, v50, s60 bitop3:0x7e
  v_bitop3_b32 v22, v52, v54, s60 bitop3:0x7e
  v_or3_b32 v20, v20, v21, v22
  v_and_b32 v20, 1, v20
  v_cmp_eq_u32 vcc, 1, v20
  s_nop 0
  s_cbranch_vccz L_ffn_f0_1_x
L_ffn_f0_1_r:
  s_add_u32 s50, s50, 1
  s_cmp_ge_u32 s50, 262144
  s_cbranch_scc1 L_ffn_f0_1_x
  s_add_u32 s51, s41, 12288
  buffer_load_dwordx4 v[44:47], v16, s[4:7], s51 offen sc1
  s_add_u32 s51, s41, 16384
  buffer_load_dwordx4 v[48:51], v16, s[4:7], s51 offen sc1
  s_add_u32 s51, s41, 20480
  buffer_load_dwordx4 v[52:55], v16, s[4:7], s51 offen sc1
  s_add_u32 s51, s41, 24576
  buffer_load_dwordx4 v[56:59], v16, s[4:7], s51 offen sc1
  s_add_u32 s51, s41, 28672
  buffer_load_dwordx4 v[60:63], v16, s[4:7], s51 offen sc1
  s_add_u32 s51, s41, 32768
  buffer_load_dwordx4 v[64:67], v16, s[4:7], s51 offen sc1
  s_branch L_ffn_f0_1
L_ffn_f0_1_x:
  v_mfma_f32_16x16x32_bf16 v[68:71], v[28:31], v[44:47], v[68:71]
  v_mfma_f32_16x16x32_bf16 v[68:71], v[28:31], v[48:51], v[68:71]
  v_mfma_f32_16x16x32_bf16 v[68:71], v[28:31], v[52:55], v[68:71]
L_ffn_f0_2:
  s_waitcnt vmcnt(0)
  v_bitop3_b32 v20, v56, v58, s60 bitop3:0x7e
  v_bitop3_b32 v21, v60, v62, s60 bitop3:0x7e
  v_bitop3_b32 v22, v64, v66, s60 bitop3:0x7e
  v_or3_b32 v20, v20, v21, v22
  v_and_b32 v20, 1, v20
  v_cmp_eq_u32_e64 vcc, 1, v20
  s_nop 0
  s_cbranch_vccz L_ffn_f0_2_x
L_ffn_f0_2_r:
  s_add_u32 s50, s50, 1
  s_cmp_ge_u32 s50, 262144
  s_cbranch_scc1 L_ffn_f0_2_x
  s_add_u32 s51, s41, 24576
  buffer_load_dwordx4 v[56:59], v16, s[4:7], s51 offen sc1
  s_add_u32 s51, s41, 28672
  buffer_load_dwordx4 v[60:63], v16, s[4:7], s51 offen sc1
  s_add_u32 s51, s41, 32768
  buffer_load_dwordx4 v[64:67], v16, s[4:7], s51 offen sc1
  s_branch L_ffn_f0_2
L_ffn_f0_2_x:
  v_mfma_f32_16x16x32_bf16 v[68:71], v[28:31], v[56:59], v[68:71]
  v_mfma_f32_16x16x32_bf16 v[68:71], v[28:31], v[60:63], v[68:71]
  v_mfma_f32_16x16x32_bf16 v[68:71], v[28:31], v[64:67], v[68:71]
L_ffn_l0_out:
  s_nop 7
  v_cvt_pk_bf16_f32 v68, v68, v69
  v_cvt_pk_bf16_f32 v69, v70, v71
  buffer_store_dwordx2 v[68:69], v17, s[24:27], s45 offen
  s_mov_b32 s40, s49
  s_add_u32 s95, s95, 1
  s_cmp_lt_u32 s40, 64
  s_cbranch_scc1 L_ffn_l0
  s_endpgm
L_ffn_w1:
  s_waitcnt vmcnt(27)
  s_barrier
  ds_read_b64_tr_b16 a[112:113], v25 offset:320
  ds_read_b64_tr_b16 a[114:115], v25 offset:9536
  ds_read_b64_tr_b16 a[128:129], v25 offset:328
  ds_read_b64_tr_b16 a[130:131], v25 offset:9544
  ds_read_b64_tr_b16 a[144:145], v25 offset:384
  ds_read_b64_tr_b16 a[146:147], v25 offset:9600
  ds_read_b64_tr_b16 a[160:161], v25 offset:392
  ds_read_b64_tr_b16 a[162:163], v25 offset:9608
  ds_read_b64_tr_b16 a[176:177], v25 offset:448
  ds_read_b64_tr_b16 a[178:179], v25 offset:9664
  ds_read_b64_tr_b16 a[192:193], v25 offset:456
  ds_read_b64_tr_b16 a[194:195], v25 offset:9672
  ds_read_b64_tr_b16 a[208:209], v25 offset:512
  ds_read_b64_tr_b16 a[210:211], v25 offset:9728
  ds_read_b64_tr_b16 a[224:225], v25 offset:520
  ds_read_b64_tr_b16 a[226:227], v25 offset:9736
  ds_read_b64_tr_b16 a[240:241], v25 offset:264
  ds_read_b64_tr_b16 a[242:243], v25 offset:9480
  s_waitcnt vmcnt(18)
  s_barrier
  ds_read_b64_tr_b16 a[116:117], v25 offset:37184
  ds_read_b64_tr_b16 a[118:119], v25 offset:46400
  ds_read_b64_tr_b16 a[132:133], v25 offset:37192
  ds_read_b64_tr_b16 a[134:135], v25 offset:46408
  ds_read_b64_tr_b16 a[148:149], v25 offset:37248
  ds_read_b64_tr_b16 a[150:151], v25 offset:46464
  ds_read_b64_tr_b16 a[164:165], v25 offset:37256
  ds_read_b64_tr_b16 a[166:167], v25 offset:46472
  ds_read_b64_tr_b16 a[180:181], v25 offset:37312
  ds_read_b64_tr_b16 a[182:183], v25 offset:46528
  ds_read_b64_tr_b16 a[196:197], v25 offset:37320
  ds_read_b64_tr_b16 a[198:199], v25 offset:46536
  ds_read_b64_tr_b16 a[212:213], v25 offset:37376
  ds_read_b64_tr_b16 a[214:215], v25 offset:46592
  ds_read_b64_tr_b16 a[228:229], v25 offset:37384
  ds_read_b64_tr_b16 a[230:231], v25 offset:46600
  ds_read_b64_tr_b16 a[244:245], v25 offset:37128
  ds_read_b64_tr_b16 a[246:247], v25 offset:46344
  s_waitcnt vmcnt(9)
  s_barrier
  ds_read_b64_tr_b16 a[120:121], v26 offset:320
  ds_read_b64_tr_b16 a[122:123], v26 offset:9536
  ds_read_b64_tr_b16 a[136:137], v26 offset:328
  ds_read_b64_tr_b16 a[138:139], v26 offset:9544
  ds_read_b64_tr_b16 a[152:153], v26 offset:384
  ds_read_b64_tr_b16 a[154:155], v26 offset:9600
  ds_read_b64_tr_b16 a[168:169], v26 offset:392
  ds_read_b64_tr_b16 a[170:171], v26 offset:9608
  ds_read_b64_tr_b16 a[184:185], v26 offset:448
  ds_read_b64_tr_b16 a[186:187], v26 offset:9664
  ds_read_b64_tr_b16 a[200:201], v26 offset:456
  ds_read_b64_tr_b16 a[202:203], v26 offset:9672
  ds_read_b64_tr_b16 a[216:217], v26 offset:512
  ds_read_b64_tr_b16 a[218:219], v26 offset:9728
  ds_read_b64_tr_b16 a[232:233], v26 offset:520
  ds_read_b64_tr_b16 a[234:235], v26 offset:9736
  ds_read_b64_tr_b16 a[248:249], v26 offset:264
  ds_read_b64_tr_b16 a[250:251], v26 offset:9480
  s_waitcnt vmcnt(0)
  s_barrier
  ds_read_b64_tr_b16 a[124:125], v26 offset:37184
  ds_read_b64_tr_b16 a[126:127], v26 offset:46400
  ds_read_b64_tr_b16 a[140:141], v26 offset:37192
  ds_read_b64_tr_b16 a[142:143], v26 offset:46408
  ds_read_b64_tr_b16 a[156:157], v26 offset:37248
  ds_read_b64_tr_b16 a[158:159], v26 offset:46464
  ds_read_b64_tr_b16 a[172:173], v26 offset:37256
  ds_read_b64_tr_b16 a[174:175], v26 offset:46472
  ds_read_b64_tr_b16 a[188:189], v26 offset:37312
  ds_read_b64_tr_b16 a[190:191], v26 offset:46528
  ds_read_b64_tr_b16 a[204:205], v26 offset:37320
  ds_read_b64_tr_b16 a[206:207], v26 offset:46536
  ds_read_b64_tr_b16 a[220:221], v26 offset:37376
  ds_read_b64_tr_b16 a[222:223], v26 offset:46592
  ds_read_b64_tr_b16 a[236:237], v26 offset:37384
  ds_read_b64_tr_b16 a[238:239], v26 offset:46600
  ds_read_b64_tr_b16 a[252:253], v26 offset:37128
  ds_read_b64_tr_b16 a[254:255], v26 offset:46344
  s_waitcnt lgkmcnt(0)
  s_mul_i32 s34, s44, 2654208
  s_mul_i32 s35, s43, 36864
  s_add_u32 s34, s34, s35
  v_mov_b64 v[32:33], -1
  v_mov_b64 v[34:35], -1
  s_add_u32 s51, s34, 75506688
  buffer_store_dwordx4 v[32:35], v14, s[4:7], s51 offen offset:0 sc1
  buffer_store_dwordx4 v[32:35], v14, s[4:7], s51 offen offset:1024 sc1
  buffer_store_dwordx4 v[32:35], v14, s[4:7], s51 offen offset:2048 sc1
  buffer_store_dwordx4 v[32:35], v14, s[4:7], s51 offen offset:3072 sc1
  s_add_u32 s51, s34, 75510784
  buffer_store_dwordx4 v[32:35], v14, s[4:7], s51 offen offset:0 sc1
  buffer_store_dwordx4 v[32:35], v14, s[4:7], s51 offen offset:1024 sc1
  buffer_store_dwordx4 v[32:35], v14, s[4:7], s51 offen offset:2048 sc1
  buffer_store_dwordx4 v[32:35], v14, s[4:7], s51 offen offset:3072 sc1
  s_add_u32 s51, s34, 75514880
  buffer_store_dwordx4 v[32:35], v14, s[4:7], s51 offen offset:0 sc1
  s_add_u32 s51, s34, 76833792
  buffer_store_dwordx4 v[32:35], v14, s[4:7], s51 offen offset:0 sc1
  buffer_store_dwordx4 v[32:35], v14, s[4:7], s51 offen offset:1024 sc1
  buffer_store_dwordx4 v[32:35], v14, s[4:7], s51 offen offset:2048 sc1
  buffer_store_dwordx4 v[32:35], v14, s[4:7], s51 offen offset:3072 sc1
  s_add_u32 s51, s34, 76837888
  buffer_store_dwordx4 v[32:35], v14, s[4:7], s51 offen offset:0 sc1
  buffer_store_dwordx4 v[32:35], v14, s[4:7], s51 offen offset:1024 sc1
  buffer_store_dwordx4 v[32:35], v14, s[4:7], s51 offen offset:2048 sc1
  buffer_store_dwordx4 v[32:35], v14, s[4:7], s51 offen offset:3072 sc1
  s_add_u32 s51, s34, 76841984
  buffer_store_dwordx4 v[32:35], v14, s[4:7], s51 offen offset:0 sc1
  s_cmp_lg_u32 s44, 3
  s_cbranch_scc1 L_f4_53
  s_waitcnt vmcnt(0)
  s_barrier
  s_cmp_lg_u32 s33, 0
  s_cbranch_scc1 L_meet_54
  v_mov_b32 v20, 1
  s_mov_b64 exec, 1
  buffer_atomic_add v20, off, s[8:11], 0 offset:64 sc0
  s_waitcnt vmcnt(0)
  v_readfirstlane_b32 s51, v20
  v_mov_b32 v20, 1
  s_cmp_lg_u32 s51, 35
  s_cbranch_scc1 L_cnt_55
  buffer_store_dword v20, off, s[8:11], 0 offset:156 sc1
L_cnt_55:
  s_mov_b64 exec, -1
L_f4_56:
  buffer_load_dword v20, off, s[8:11], 0 offset:156 sc1
  s_add_u32 s50, s50, 1
  s_cmp_ge_u32 s50, 262144
  s_waitcnt vmcnt(0)
  s_cbranch_scc1 L_f4_56_x
  v_cmp_ge_u32 vcc, 0, v20
  s_nop 0
  s_cbranch_vccnz L_f4_56
L_f4_56_x:
L_f4_57:
  buffer_load_dword v20, off, s[8:11], 0 offset:144 sc1
  s_add_u32 s50, s50, 1
  s_cmp_ge_u32 s50, 262144
  s_waitcnt vmcnt(0)
  s_cbranch_scc1 L_f4_57_x
  v_cmp_ge_u32 vcc, 0, v20
  s_nop 0
  s_cbranch_vccnz L_f4_57
L_f4_57_x:
L_meet_54:
  s_barrier
  s_mov_b32 s40, 57
  s_branch L_f4_53_x
L_f4_53:
  s_waitcnt vmcnt(0)
  s_barrier
  s_cmp_lg_u32 s33, 0
  s_cbranch_scc1 L_meet_58
  v_mov_b32 v20, 1
  s_mov_b64 exec, 1
  buffer_atomic_add v20, off, s[8:11], 0 offset:28 sc0
  s_waitcnt vmcnt(0)
  v_readfirstlane_b32 s51, v20
  v_mov_b32 v20, 1
  s_cmp_lg_u32 s51, 107
  s_cbranch_scc1 L_cnt_59
  buffer_store_dword v20, off, s[8:11], 0 offset:148 sc1
L_cnt_59:
  s_mov_b64 exec, -1
L_fi_60:
  buffer_load_dword v20, off, s[8:11], 0 offset:148 sc1
  s_add_u32 s50, s50, 1
  s_cmp_ge_u32 s50, 262144
  s_waitcnt vmcnt(0)
  s_cbranch_scc1 L_fi_60_x
  v_cmp_ge_u32 vcc, 0, v20
  s_nop 0
  s_cbranch_vccnz L_fi_60
L_fi_60_x:
L_fi_61:
  buffer_load_dword v20, off, s[8:11], 0 offset:144 sc1
  s_add_u32 s50, s50, 1
  s_cmp_ge_u32 s50, 262144
  s_waitcnt vmcnt(0)
  s_cbranch_scc1 L_fi_61_x
  v_cmp_ge_u32 vcc, 0, v20
  s_nop 0
  s_cbranch_vccnz L_fi_61
L_fi_61_x:
L_meet_58:
  s_barrier
  s_mov_b32 s40, s44
L_f4_53_x:
  s_mov_b32 s95, 0
  s_mov_b32 s48, 0
  v_min_u32 v19, 7, v0
  v_mul_u32_u24 v19, 1152, v19
  v_bfe_u32 v20, v0, 4, 1
  v_lshlrev_b32 v20, 10, v20
  v_lshrrev_b32 v21, 5, v0
  v_lshl_add_u32 v20, v21, 8, v20
  v_and_b32 v21, 15, v0
  v_lshl_add_u32 v24, v21, 4, v20
.p2align 5
L_ffn_l1:
  s_mul_i32 s45, s40, 36864
  s_add_u32 s35, s45, 7340032
  s_add_u32 s34, s45, 4203520
  s_bfe_u32 s60, s95, 0x10001
  s_and_b32 s41, s95, 1
  s_lshl1_add_u32 s41, s44, s41
  s_mul_i32 s41, s41, 1327104
  s_add_u32 s41, s41, 75497472
  s_cmp_ge_u32 s40, 54
  s_addc_u32 s49, s40, 3
  s_cmp_eq_u32 s48, 0
  s_cbranch_scc1 L_ffn_l1_reg
  s_waitcnt vmcnt(1)
  ds_read_b128 v[32:35], v18 offset:0
  ds_read_b128 v[36:39], v18 offset:1024
  ds_read_b128 v[40:43], v18 offset:2048
  ds_read_b128 v[44:47], v18 offset:3072
  ds_read_b128 v[48:51], v18 offset:4096
  ds_read_b128 v[52:55], v18 offset:5120
  ds_read_b128 v[56:59], v18 offset:6144
  ds_read_b128 v[60:63], v18 offset:7168
  ds_read_b128 v[64:67], v18 offset:8192
  s_waitcnt lgkmcnt(8)
  v_max_u32 v20, v32, v34
  s_waitcnt lgkmcnt(7)
  v_max3_u32 v20, v20, v36, v38
  s_waitcnt lgkmcnt(6)
  v_max3_u32 v20, v20, v40, v42
  s_waitcnt lgkmcnt(5)
  v_max3_u32 v20, v20, v44, v46
  s_waitcnt lgkmcnt(4)
  v_max3_u32 v20, v20, v48, v50
  s_waitcnt lgkmcnt(3)
  v_max3_u32 v20, v20, v52, v54
  s_waitcnt lgkmcnt(2)
  v_max3_u32 v20, v20, v56, v58
  s_waitcnt lgkmcnt(1)
  v_max3_u32 v20, v20, v60, v62
  s_waitcnt lgkmcnt(0)
  v_max3_u32 v20, v20, v64, v66
  v_cmp_eq_u32 vcc, -1, v20
  s_nop 0
  s_cbranch_vccz L_ffn_l1_xok
L_ffn_l1_reg:
  s_cmp_ge_u32 s40, 63
  s_cbranch_scc1 L_ffn_l1_p_x
L_ffn_l1_p:
  buffer_load_dword v20, v19, s[4:7], s34 offen sc1
  s_add_u32 s50, s50, 1
  s_cmp_ge_u32 s50, 262144
  s_waitcnt vmcnt(0)
  s_cbranch_scc1 L_ffn_l1_p_x
  v_cmp_eq_u32 vcc, -1, v20
  s_nop 0
  s_cbranch_vccnz L_ffn_l1_p
L_ffn_l1_p_x:
  buffer_load_dwordx4 v[32:35], v1, s[4:7], s35 offen sc1
  buffer_load_dwordx4 v[36:39], v2, s[4:7], s35 offen sc1
  buffer_load_dwordx4 v[40:43], v3, s[4:7], s35 offen sc1
  buffer_load_dwordx4 v[44:47], v4, s[4:7], s35 offen sc1
  buffer_load_dwordx4 v[48:51], v5, s[4:7], s35 offen sc1
  buffer_load_dwordx4 v[52:55], v6, s[4:7], s35 offen sc1
  buffer_load_dwordx4 v[56:59], v7, s[4:7], s35 offen sc1
  buffer_load_dwordx4 v[60:63], v8, s[4:7], s35 offen sc1
  buffer_load_dwordx4 v[64:67], v9, s[4:7], s35 offen sc1
L_ffn_x1_0:
  s_waitcnt vmcnt(8)
  ds_write_b128 v18, v[32:35] offset:0
  v_max_u32 v20, v32, v34
  s_waitcnt vmcnt(7)
  ds_write_b128 v18, v[36:39] offset:1024
  v_max3_u32 v20, v20, v36, v38
  s_waitcnt vmcnt(6)
  ds_write_b128 v18, v[40:43] offset:2048
  v_max3_u32 v20, v20, v40, v42
  v_cmp_eq_u32 vcc, -1, v20
  s_nop 0
  s_cbranch_vccz L_ffn_x1_0_x
  s_add_u32 s50, s50, 1
  s_cmp_ge_u32 s50, 262144
  s_cbranch_scc1 L_ffn_x1_0_x
  s_waitcnt lgkmcnt(0)
  buffer_load_dwordx4 v[32:35], v1, s[4:7], s35 offen sc1
  buffer_load_dwordx4 v[36:39], v2, s[4:7], s35 offen sc1
  buffer_load_dwordx4 v[40:43], v3, s[4:7], s35 offen sc1
  buffer_load_dwordx4 v[44:47], v4, s[4:7], s35 offen sc1
  buffer_load_dwordx4 v[48:51], v5, s[4:7], s35 offen sc1
  buffer_load_dwordx4 v[52:55], v6, s[4:7], s35 offen sc1
  buffer_load_dwordx4 v[56:59], v7, s[4:7], s35 offen sc1
  buffer_load_dwordx4 v[60:63], v8, s[4:7], s35 offen sc1
  buffer_load_dwordx4 v[64:67], v9, s[4:7], s35 offen sc1
  s_branch L_ffn_x1_0
L_ffn_x1_0_x:
L_ffn_x1_1:
  s_waitcnt vmcnt(5)
  ds_write_b128 v18, v[44:47] offset:3072
  v_max_u32 v20, v44, v46
  s_waitcnt vmcnt(4)
  ds_write_b128 v18, v[48:51] offset:4096
  v_max3_u32 v20, v20, v48, v50
  s_waitcnt vmcnt(3)
  ds_write_b128 v18, v[52:55] offset:5120
  v_max3_u32 v20, v20, v52, v54
  v_cmp_eq_u32 vcc, -1, v20
  s_nop 0
  s_cbranch_vccz L_ffn_x1_1_x
  s_add_u32 s50, s50, 1
  s_cmp_ge_u32 s50, 262144
  s_cbranch_scc1 L_ffn_x1_1_x
  s_waitcnt lgkmcnt(0)
  buffer_load_dwordx4 v[44:47], v4, s[4:7], s35 offen sc1
  buffer_load_dwordx4 v[48:51], v5, s[4:7], s35 offen sc1
  buffer_load_dwordx4 v[52:55], v6, s[4:7], s35 offen sc1
  buffer_load_dwordx4 v[56:59], v7, s[4:7], s35 offen sc1
  buffer_load_dwordx4 v[60:63], v8, s[4:7], s35 offen sc1
  buffer_load_dwordx4 v[64:67], v9, s[4:7], s35 offen sc1
  s_branch L_ffn_x1_1
L_ffn_x1_1_x:
L_ffn_x1_2:
  s_waitcnt vmcnt(2)
  ds_write_b128 v18, v[56:59] offset:6144
  v_max_u32 v20, v56, v58
  s_waitcnt vmcnt(1)
  ds_write_b128 v18, v[60:63] offset:7168
  v_max3_u32 v20, v20, v60, v62
  s_waitcnt vmcnt(0)
  ds_write_b128 v18, v[64:67] offset:8192
  v_max3_u32 v20, v20, v64, v66
  v_cmp_eq_u32 vcc, -1, v20
  s_nop 0
  s_cbranch_vccz L_ffn_x1_2_x
  s_add_u32 s50, s50, 1
  s_cmp_ge_u32 s50, 262144
  s_cbranch_scc1 L_ffn_x1_2_x
  s_waitcnt lgkmcnt(0)
  buffer_load_dwordx4 v[56:59], v7, s[4:7], s35 offen sc1
  buffer_load_dwordx4 v[60:63], v8, s[4:7], s35 offen sc1
  buffer_load_dwordx4 v[64:67], v9, s[4:7], s35 offen sc1
  s_branch L_ffn_x1_2
L_ffn_x1_2_x:
  s_waitcnt lgkmcnt(0)
L_ffn_l1_xok:
  s_barrier
  ds_read_b128 v[64:67], v10 offset:0
  ds_read_b128 v[68:71], v11 offset:0
  ds_read_b128 v[72:75], v12 offset:0
  s_add_u32 s34, s45, 4194304
  s_waitcnt lgkmcnt(2)
  v_mfma_f32_32x32x16_bf16 v[32:47], v[80:83], v[64:67], 0
  ds_read_b128 v[76:79], v13 offset:0
  v_mfma_f32_32x32x16_bf16 v[48:63], v[84:87], v[64:67], 0
  s_waitcnt lgkmcnt(2)
  v_mfma_f32_32x32x16_bf16 v[32:47], v[88:91], v[68:71], v[32:47]
  ds_read_b128 v[64:67], v10 offset:128
  v_mfma_f32_32x32x16_bf16 v[48:63], v[92:95], v[68:71], v[48:63]
  s_waitcnt lgkmcnt(2)
  v_mfma_f32_32x32x16_bf16 v[32:47], v[96:99], v[72:75], v[32:47]
  ds_read_b128 v[68:71], v11 offset:128
  v_mfma_f32_32x32x16_bf16 v[48:63], v[100:103], v[72:75], v[48:63]
  s_waitcnt lgkmcnt(2)
  v_mfma_f32_32x32x16_bf16 v[32:47], v[104:107], v[76:79], v[32:47]
  ds_read_b128 v[72:75], v12 offset:128
  v_mfma_f32_32x32x16_bf16 v[48:63], v[108:111], v[76:79], v[48:63]
  s_waitcnt lgkmcnt(2)
  v_mfma_f32_32x32x16_bf16 v[32:47], v[112:115], v[64:67], v[32:47]
  ds_read_b128 v[76:79], v13 offset:128
  v_mfma_f32_32x32x16_bf16 v[48:63], v[116:119], v[64:67], v[48:63]
  s_waitcnt lgkmcnt(2)
  v_mfma_f32_32x32x16_bf16 v[32:47], v[120:123], v[68:71], v[32:47]
  ds_read_b128 v[64:67], v10 offset:256
  v_mfma_f32_32x32x16_bf16 v[48:63], v[124:127], v[68:71], v[48:63]
  s_waitcnt lgkmcnt(2)
  v_mfma_f32_32x32x16_bf16 v[32:47], v[128:131], v[72:75], v[32:47]
  ds_read_b128 v[68:71], v11 offset:256
  v_mfma_f32_32x32x16_bf16 v[48:63], v[132:135], v[72:75], v[48:63]
  s_waitcnt lgkmcnt(2)
  v_mfma_f32_32x32x16_bf16 v[32:47], v[136:139], v[76:79], v[32:47]
  ds_read_b128 v[72:75], v12 offset:256
  v_mfma_f32_32x32x16_bf16 v[48:63], v[140:143], v[76:79], v[48:63]
  s_waitcnt lgkmcnt(2)
  v_mfma_f32_32x32x16_bf16 v[32:47], v[144:147], v[64:67], v[32:47]
  ds_read_b128 v[76:79], v13 offset:256
  v_mfma_f32_32x32x16_bf16 v[48:63], v[148:151], v[64:67], v[48:63]
  buffer_load_dwordx2 v[26:27], v17, s[4:7], s34 offen sc1
  s_waitcnt lgkmcnt(2)
  v_mfma_f32_32x32x16_bf16 v[32:47], v[152:155], v[68:71], v[32:47]
  ds_read_b128 v[64:67], v10 offset:384
  v_mfma_f32_32x32x16_bf16 v[48:63], v[156:159], v[68:71], v[48:63]
  s_waitcnt lgkmcnt(2)
  v_mfma_f32_32x32x16_bf16 v[32:47], v[160:163], v[72:75], v[32:47]
  ds_read_b128 v[68:71], v11 offset:384
  v_mfma_f32_32x32x16_bf16 v[48:63], v[164:167], v[72:75], v[48:63]
  s_waitcnt lgkmcnt(2)
  v_mfma_f32_32x32x16_bf16 v[32:47], v[168:171], v[76:79], v[32:47]
  ds_read_b128 v[72:75], v12 offset:384
  v_mfma_f32_32x32x16_bf16 v[48:63], v[172:175], v[76:79], v[48:63]
  s_waitcnt lgkmcnt(2)
  v_mfma_f32_32x32x16_bf16 v[32:47], v[176:179], v[64:67], v[32:47]
  ds_read_b128 v[76:79], v13 offset:384
  v_mfma_f32_32x32x16_bf16 v[48:63], v[180:183], v[64:67], v[48:63]
  s_waitcnt lgkmcnt(2)
  v_mfma_f32_32x32x16_bf16 v[32:47], v[184:187], v[68:71], v[32:47]
  ds_read_b128 v[64:67], v10 offset:512
  v_mfma_f32_32x32x16_bf16 v[48:63], v[188:191], v[68:71], v[48:63]
  s_waitcnt lgkmcnt(2)
  v_mfma_f32_32x32x16_bf16 v[32:47], v[192:195], v[72:75], v[32:47]
  ds_read_b128 v[68:71], v11 offset:512
  v_mfma_f32_32x32x16_bf16 v[48:63], v[196:199], v[72:75], v[48:63]
  s_waitcnt lgkmcnt(2)
  v_mfma_f32_32x32x16_bf16 v[32:47], v[200:203], v[76:79], v[32:47]
  ds_read_b128 v[72:75], v12 offset:512
  v_mfma_f32_32x32x16_bf16 v[48:63], v[204:207], v[76:79], v[48:63]
  s_waitcnt lgkmcnt(2)
  v_mfma_f32_32x32x16_bf16 v[32:47], v[208:211], v[64:67], v[32:47]
  ds_read_b128 v[76:79], v13 offset:512
  v_mfma_f32_32x32x16_bf16 v[48:63], v[212:215], v[64:67], v[48:63]
  s_waitcnt lgkmcnt(2)
  v_mfma_f32_32x32x16_bf16 v[32:47], v[216:219], v[68:71], v[32:47]
  ds_read_b128 v[64:67], v10 offset:640
  v_mfma_f32_32x32x16_bf16 v[48:63], v[220:223], v[68:71], v[48:63]
  s_waitcnt lgkmcnt(2)
  v_mfma_f32_32x32x16_bf16 v[32:47], v[224:227], v[72:75], v[32:47]
  ds_read_b128 v[68:71], v11 offset:640
  v_mfma_f32_32x32x16_bf16 v[48:63], v[228:231], v[72:75], v[48:63]
  s_waitcnt lgkmcnt(2)
  v_mfma_f32_32x32x16_bf16 v[32:47], v[232:235], v[76:79], v[32:47]
  ds_read_b128 v[72:75], v12 offset:640
  v_mfma_f32_32x32x16_bf16 v[48:63], v[236:239], v[76:79], v[48:63]
  s_waitcnt lgkmcnt(2)
  v_mfma_f32_32x32x16_bf16 v[32:47], v[240:243], v[64:67], v[32:47]
  ds_read_b128 v[76:79], v13 offset:640
  v_mfma_f32_32x32x16_bf16 v[48:63], v[244:247], v[64:67], v[48:63]
  s_waitcnt lgkmcnt(2)
  v_mfma_f32_32x32x16_bf16 v[32:47], v[248:251], v[68:71], v[32:47]
  ds_read_b128 v[64:67], v10 offset:768
  v_mfma_f32_32x32x16_bf16 v[48:63], v[252:255], v[68:71], v[48:63]
  s_waitcnt lgkmcnt(2)
  v_mfma_f32_32x32x16_bf16 v[32:47], a[0:3], v[72:75], v[32:47]
  ds_read_b128 v[68:71], v11 offset:768
  v_mfma_f32_32x32x16_bf16 v[48:63], a[4:7], v[72:75], v[48:63]
  s_waitcnt lgkmcnt(2)
  v_mfma_f32_32x32x16_bf16 v[32:47], a[8:11], v[76:79], v[32:47]
  ds_read_b128 v[72:75], v12 offset:768
  v_mfma_f32_32x32x16_bf16 v[48:63], a[12:15], v[76:79], v[48:63]
  s_waitcnt lgkmcnt(2)
  v_mfma_f32_32x32x16_bf16 v[32:47], a[16:19], v[64:67], v[32:47]
  ds_read_b128 v[76:79], v13 offset:768
  v_mfma_f32_32x32x16_bf16 v[48:63], a[20:23], v[64:67], v[48:63]
  s_waitcnt lgkmcnt(2)
  v_mfma_f32_32x32x16_bf16 v[32:47], a[24:27], v[68:71], v[32:47]
  ds_read_b128 v[64:67], v10 offset:896
  v_mfma_f32_32x32x16_bf16 v[48:63], a[28:31], v[68:71], v[48:63]
  s_waitcnt lgkmcnt(2)
  v_mfma_f32_32x32x16_bf16 v[32:47], a[32:35], v[72:75], v[32:47]
  ds_read_b128 v[68:71], v11 offset:896
  v_mfma_f32_32x32x16_bf16 v[48:63], a[36:39], v[72:75], v[48:63]
  s_waitcnt lgkmcnt(2)
  v_mfma_f32_32x32x16_bf16 v[32:47], a[40:43], v[76:79], v[32:47]
  ds_read_b128 v[72:75], v12 offset:896
  v_mfma_f32_32x32x16_bf16 v[48:63], a[44:47], v[76:79], v[48:63]
  s_waitcnt lgkmcnt(2)
  v_mfma_f32_32x32x16_bf16 v[32:47], a[48:51], v[64:67], v[32:47]
  ds_read_b128 v[76:79], v13 offset:896
  v_mfma_f32_32x32x16_bf16 v[48:63], a[52:55], v[64:67], v[48:63]
  s_waitcnt lgkmcnt(2)
  v_mfma_f32_32x32x16_bf16 v[32:47], a[56:59], v[68:71], v[32:47]
  ds_read_b128 v[64:67], v10 offset:1024
  v_mfma_f32_32x32x16_bf16 v[48:63], a[60:63], v[68:71], v[48:63]
  s_waitcnt lgkmcnt(2)
  v_mfma_f32_32x32x16_bf16 v[32:47], a[64:67], v[72:75], v[32:47]
  ds_read_b128 v[68:71], v11 offset:1024
  v_mfma_f32_32x32x16_bf16 v[48:63], a[68:71], v[72:75], v[48:63]
  s_waitcnt lgkmcnt(2)
  v_mfma_f32_32x32x16_bf16 v[32:47], a[72:75], v[76:79], v[32:47]
  ds_read_b128 v[72:75], v12 offset:1024
  v_mfma_f32_32x32x16_bf16 v[48:63], a[76:79], v[76:79], v[48:63]
  s_waitcnt lgkmcnt(2)
  v_mfma_f32_32x32x16_bf16 v[32:47], a[80:83], v[64:67], v[32:47]
  ds_read_b128 v[76:79], v13 offset:1024
  v_mfma_f32_32x32x16_bf16 v[48:63], a[84:87], v[64:67], v[48:63]
  s_waitcnt lgkmcnt(2)
  v_mfma_f32_32x32x16_bf16 v[32:47], a[88:91], v[68:71], v[32:47]
  v_mfma_f32_32x32x16_bf16 v[48:63], a[92:95], v[68:71], v[48:63]
  s_waitcnt lgkmcnt(1)
  v_mfma_f32_32x32x16_bf16 v[32:47], a[96:99], v[72:75], v[32:47]
  v_mfma_f32_32x32x16_bf16 v[48:63], a[100:103], v[72:75], v[48:63]
  s_waitcnt lgkmcnt(0)
  v_mfma_f32_32x32x16_bf16 v[32:47], a[104:107], v[76:79], v[32:47]
  v_mfma_f32_32x32x16_bf16 v[48:63], a[108:111], v[76:79], v[48:63]
  s_nop 4
  v_max_f32_e64 v32, 0, v32
  v_max_f32_e64 v33, 0, v33
  v_max_f32 v34, 0, v34
  v_max_f32 v35, 0, v35
  v_max_f32_e64 v36, 0, v36
  v_max_f32_e64 v37, 0, v37
  v_max_f32_e64 v38, 0, v38
  v_max_f32 v39, 0, v39
  v_max_f32 v40, 0, v40
  v_max_f32 v41, 0, v41
  v_max_f32 v42, 0, v42
  v_max_f32_e64 v43, 0, v43
  v_max_f32_e64 v44, 0, v44
  v_max_f32 v45, 0, v45
  v_max_f32 v46, 0, v46
  v_max_f32 v47, 0, v47
  v_pk_mul_f32 v[32:33], v[32:33], v[48:49]
  v_pk_mul_f32 v[34:35], v[34:35], v[50:51]
  v_pk_mul_f32 v[36:37], v[36:37], v[52:53]
  v_pk_mul_f32 v[38:39], v[38:39], v[54:55]
  v_cvt_pk_bf16_f32 v32, v32, v33
  v_cvt_pk_bf16_f32 v33, v34, v35
  v_cvt_pk_bf16_f32 v34, v36, v37
  v_cvt_pk_bf16_f32 v35, v38, v39
  ds_write_b128 v24, v[32:35] offset:43008
  v_pk_mul_f32 v[40:41], v[40:41], v[56:57]
  v_pk_mul_f32 v[42:43], v[42:43], v[58:59]
  v_pk_mul_f32 v[44:45], v[44:45], v[60:61]
  v_pk_mul_f32 v[46:47], v[46:47], v[62:63]
  v_cvt_pk_bf16_f32 v40, v40, v41
  v_cvt_pk_bf16_f32 v41, v42, v43
  v_cvt_pk_bf16_f32 v42, v44, v45
  v_cvt_pk_bf16_f32 v43, v46, v47
  ds_write_b128 v24, v[40:43] offset:43520
  s_waitcnt lgkmcnt(0)
  s_barrier
  ds_read_b128 v[32:35], v14 offset:40960
  ds_read_b128 v[36:39], v14 offset:41984
  ds_read_b128 v[40:43], v14 offset:43008
  ds_read_b128 v[44:47], v14 offset:44032
  ds_read_b128 v[48:51], v14 offset:45056
  ds_read_b128 v[52:55], v14 offset:46080
  ds_read_b128 v[56:59], v14 offset:47104
  ds_read_b128 v[60:63], v14 offset:48128
  s_waitcnt lgkmcnt(7)
  v_mfma_f32_16x16x32_bf16 v[64:67], a[112:115], v[32:35], 0
  v_mfma_f32_16x16x32_bf16 v[68:71], a[128:131], v[32:35], 0
  s_waitcnt lgkmcnt(5)
  v_mfma_f32_16x16x32_bf16 v[64:67], a[116:119], v[40:43], v[64:67]
  v_mfma_f32_16x16x32_bf16 v[68:71], a[132:135], v[40:43], v[68:71]
  s_waitcnt lgkmcnt(3)
  v_mfma_f32_16x16x32_bf16 v[64:67], a[120:123], v[48:51], v[64:67]
  v_mfma_f32_16x16x32_bf16 v[68:71], a[136:139], v[48:51], v[68:71]
  s_waitcnt lgkmcnt(1)
  v_mfma_f32_16x16x32_bf16 v[64:67], a[124:127], v[56:59], v[64:67]
  v_mfma_f32_16x16x32_bf16 v[68:71], a[140:143], v[56:59], v[68:71]
  v_mfma_f32_16x16x32_bf16 v[72:75], a[112:115], v[36:39], 0
  v_mfma_f32_16x16x32_bf16 v[76:79], a[128:131], v[36:39], 0
  v_mfma_f32_16x16x32_bf16 v[72:75], a[116:119], v[44:47], v[72:75]
  v_mfma_f32_16x16x32_bf16 v[76:79], a[132:135], v[44:47], v[76:79]
  s_add_u32 s51, s41, 184320
  v_cvt_pk_bf16_f32 v64, v64, v65
  v_cvt_pk_bf16_f32 v65, v66, v67
  v_cvt_pk_bf16_f32 v66, v68, v69
  v_cvt_pk_bf16_f32 v67, v70, v71
  v_bfi_b32 v64, 1, s60, v64
  v_bfi_b32 v66, 1, s60, v66
  buffer_store_dwordx4 v[64:67], v15, s[4:7], s51 offen sc1
  v_mfma_f32_16x16x32_bf16 v[72:75], a[120:123], v[52:55], v[72:75]
  v_mfma_f32_16x16x32_bf16 v[76:79], a[136:139], v[52:55], v[76:79]
  s_waitcnt lgkmcnt(0)
  v_mfma_f32_16x16x32_bf16 v[72:75], a[124:127], v[60:63], v[72:75]
  v_mfma_f32_16x16x32_bf16 v[76:79], a[140:143], v[60:63], v[76:79]
  v_mfma_f32_16x16x32_bf16 v[64:67], a[144:147], v[32:35], 0
  v_mfma_f32_16x16x32_bf16 v[68:71], a[160:163], v[32:35], 0
  v_mfma_f32_16x16x32_bf16 v[64:67], a[148:151], v[40:43], v[64:67]
  v_mfma_f32_16x16x32_bf16 v[68:71], a[164:167], v[40:43], v[68:71]
  s_add_u32 s51, s41, 847872
  v_cvt_pk_bf16_f32 v72, v72, v73
  v_cvt_pk_bf16_f32 v73, v74, v75
  v_cvt_pk_bf16_f32 v74, v76, v77
  v_cvt_pk_bf16_f32 v75, v78, v79
  v_bfi_b32 v72, 1, s60, v72
  v_bfi_b32 v74, 1, s60, v74
  buffer_store_dwordx4 v[72:75], v15, s[4:7], s51 offen sc1
  v_mfma_f32_16x16x32_bf16 v[64:67], a[152:155], v[48:51], v[64:67]
  v_mfma_f32_16x16x32_bf16 v[68:71], a[168:171], v[48:51], v[68:71]
  v_mfma_f32_16x16x32_bf16 v[64:67], a[156:159], v[56:59], v[64:67]
  v_mfma_f32_16x16x32_bf16 v[68:71], a[172:175], v[56:59], v[68:71]
  v_mfma_f32_16x16x32_bf16 v[72:75], a[144:147], v[36:39], 0
  v_mfma_f32_16x16x32_bf16 v[76:79], a[160:163], v[36:39], 0
  v_mfma_f32_16x16x32_bf16 v[72:75], a[148:151], v[44:47], v[72:75]
  v_mfma_f32_16x16x32_bf16 v[76:79], a[164:167], v[44:47], v[76:79]
  s_add_u32 s51, s41, 221184
  v_cvt_pk_bf16_f32 v64, v64, v65
  v_cvt_pk_bf16_f32 v65, v66, v67
  v_cvt_pk_bf16_f32 v66, v68, v69
  v_cvt_pk_bf16_f32 v67, v70, v71
  v_bfi_b32 v64, 1, s60, v64
  v_bfi_b32 v66, 1, s60, v66
  buffer_store_dwordx4 v[64:67], v15, s[4:7], s51 offen sc1
  v_mfma_f32_16x16x32_bf16 v[72:75], a[152:155], v[52:55], v[72:75]
  v_mfma_f32_16x16x32_bf16 v[76:79], a[168:171], v[52:55], v[76:79]
  v_mfma_f32_16x16x32_bf16 v[72:75], a[156:159], v[60:63], v[72:75]
  v_mfma_f32_16x16x32_bf16 v[76:79], a[172:175], v[60:63], v[76:79]
  v_mfma_f32_16x16x32_bf16 v[64:67], a[176:179], v[32:35], 0
  v_mfma_f32_16x16x32_bf16 v[68:71], a[192:195], v[32:35], 0
  v_mfma_f32_16x16x32_bf16 v[64:67], a[180:183], v[40:43], v[64:67]
  v_mfma_f32_16x16x32_bf16 v[68:71], a[196:199], v[40:43], v[68:71]
  s_add_u32 s51, s41, 884736
  v_cvt_pk_bf16_f32 v72, v72, v73
  v_cvt_pk_bf16_f32 v73, v74, v75
  v_cvt_pk_bf16_f32 v74, v76, v77
  v_cvt_pk_bf16_f32 v75, v78, v79
  v_bfi_b32 v72, 1, s60, v72
  v_bfi_b32 v74, 1, s60, v74
  buffer_store_dwordx4 v[72:75], v15, s[4:7], s51 offen sc1
  v_mfma_f32_16x16x32_bf16 v[64:67], a[184:187], v[48:51], v[64:67]
  v_mfma_f32_16x16x32_bf16 v[68:71], a[200:203], v[48:51], v[68:71]
  v_mfma_f32_16x16x32_bf16 v[64:67], a[188:191], v[56:59], v[64:67]
  v_mfma_f32_16x16x32_bf16 v[68:71], a[204:207], v[56:59], v[68:71]
  v_mfma_f32_16x16x32_bf16 v[72:75], a[176:179], v[36:39], 0
  v_mfma_f32_16x16x32_bf16 v[76:79], a[192:195], v[36:39], 0
  v_mfma_f32_16x16x32_bf16 v[72:75], a[180:183], v[44:47], v[72:75]
  v_mfma_f32_16x16x32_bf16 v[76:79], a[196:199], v[44:47], v[76:79]
  s_add_u32 s51, s41, 258048
  v_cvt_pk_bf16_f32 v64, v64, v65
  v_cvt_pk_bf16_f32 v65, v66, v67
  v_cvt_pk_bf16_f32 v66, v68, v69
  v_cvt_pk_bf16_f32 v67, v70, v71
  v_bfi_b32 v64, 1, s60, v64
  v_bfi_b32 v66, 1, s60, v66
  buffer_store_dwordx4 v[64:67], v15, s[4:7], s51 offen sc1
  v_mfma_f32_16x16x32_bf16 v[72:75], a[184:187], v[52:55], v[72:75]
  v_mfma_f32_16x16x32_bf16 v[76:79], a[200:203], v[52:55], v[76:79]
  v_mfma_f32_16x16x32_bf16 v[72:75], a[188:191], v[60:63], v[72:75]
  v_mfma_f32_16x16x32_bf16 v[76:79], a[204:207], v[60:63], v[76:79]
  v_mfma_f32_16x16x32_bf16 v[64:67], a[208:211], v[32:35], 0
  v_mfma_f32_16x16x32_bf16 v[68:71], a[224:227], v[32:35], 0
  v_mfma_f32_16x16x32_bf16 v[64:67], a[212:215], v[40:43], v[64:67]
  v_mfma_f32_16x16x32_bf16 v[68:71], a[228:231], v[40:43], v[68:71]
  s_add_u32 s51, s41, 921600
  v_cvt_pk_bf16_f32 v72, v72, v73
  v_cvt_pk_bf16_f32 v73, v74, v75
  v_cvt_pk_bf16_f32 v74, v76, v77
  v_cvt_pk_bf16_f32 v75, v78, v79
  v_bfi_b32 v72, 1, s60, v72
  v_bfi_b32 v74, 1, s60, v74
  buffer_store_dwordx4 v[72:75], v15, s[4:7], s51 offen sc1
  v_mfma_f32_16x16x32_bf16 v[64:67], a[216:219], v[48:51], v[64:67]
  v_mfma_f32_16x16x32_bf16 v[68:71], a[232:235], v[48:51], v[68:71]
  v_mfma_f32_16x16x32_bf16 v[64:67], a[220:223], v[56:59], v[64:67]
  v_mfma_f32_16x16x32_bf16 v[68:71], a[236:239], v[56:59], v[68:71]
  v_mfma_f32_16x16x32_bf16 v[72:75], a[208:211], v[36:39], 0
  v_mfma_f32_16x16x32_bf16 v[76:79], a[224:227], v[36:39], 0
  v_mfma_f32_16x16x32_bf16 v[72:75], a[212:215], v[44:47], v[72:75]
  v_mfma_f32_16x16x32_bf16 v[76:79], a[228:231], v[44:47], v[76:79]
  s_add_u32 s51, s41, 294912
  v_cvt_pk_bf16_f32 v64, v64, v65
  v_cvt_pk_bf16_f32 v65, v66, v67
  v_cvt_pk_bf16_f32 v66, v68, v69
  v_cvt_pk_bf16_f32 v67, v70, v71
  v_bfi_b32 v64, 1, s60, v64
  v_bfi_b32 v66, 1, s60, v66
  buffer_store_dwordx4 v[64:67], v15, s[4:7], s51 offen sc1
  v_mfma_f32_16x16x32_bf16 v[72:75], a[216:219], v[52:55], v[72:75]
  v_mfma_f32_16x16x32_bf16 v[76:79], a[232:235], v[52:55], v[76:79]
  v_mfma_f32_16x16x32_bf16 v[72:75], a[220:223], v[60:63], v[72:75]
  v_mfma_f32_16x16x32_bf16 v[76:79], a[236:239], v[60:63], v[76:79]
  s_mul_i32 s35, s49, 36864
  s_add_u32 s35, s35, 7340032
  s_load_dword s52, s[4:5], s35 offset:9216 glc
  s_load_dword s53, s[4:5], s35 offset:10368 glc
  s_load_dword s54, s[4:5], s35 offset:11520 glc
  s_load_dword s55, s[4:5], s35 offset:12672 glc
  s_load_dword s56, s[4:5], s35 offset:13824 glc
  s_load_dword s57, s[4:5], s35 offset:14976 glc
  s_load_dword s58, s[4:5], s35 offset:16128 glc
  s_load_dword s59, s[4:5], s35 offset:17280 glc
  v_mfma_f32_16x16x32_bf16 v[64:67], a[240:243], v[32:35], 0
  v_mfma_f32_16x16x32_bf16 v[64:67], a[244:247], v[40:43], v[64:67]
  s_add_u32 s51, s41, 958464
  v_cvt_pk_bf16_f32 v72, v72, v73
  v_cvt_pk_bf16_f32 v73, v74, v75
  v_cvt_pk_bf16_f32 v74, v76, v77
  v_cvt_pk_bf16_f32 v75, v78, v79
  v_bfi_b32 v72, 1, s60, v72
  v_bfi_b32 v74, 1, s60, v74
  buffer_store_dwordx4 v[72:75], v15, s[4:7], s51 offen sc1
  v_mfma_f32_16x16x32_bf16 v[64:67], a[248:251], v[48:51], v[64:67]
  v_mfma_f32_16x16x32_bf16 v[64:67], a[252:255], v[56:59], v[64:67]
  v_mfma_f32_16x16x32_bf16 v[72:75], a[240:243], v[36:39], 0
  v_mfma_f32_16x16x32_bf16 v[72:75], a[244:247], v[44:47], v[72:75]
  s_add_u32 s51, s41, 147456
  v_cvt_pk_bf16_f32 v64, v64, v65
  v_cvt_pk_bf16_f32 v65, v66, v67
  v_bfi_b32 v64, 1, s60, v64
  buffer_store_dwordx2 v[64:65], v15, s[4:7], s51 offen offset:8 sc1
  v_mfma_f32_16x16x32_bf16 v[72:75], a[248:251], v[52:55], v[72:75]
  v_mfma_f32_16x16x32_bf16 v[72:75], a[252:255], v[60:63], v[72:75]
  s_add_u32 s51, s41, 811008
  s_nop 6
  v_cvt_pk_bf16_f32 v72, v72, v73
  v_cvt_pk_bf16_f32 v73, v74, v75
  v_bfi_b32 v72, 1, s60, v72
  buffer_store_dwordx2 v[72:73], v15, s[4:7], s51 offen offset:8 sc1
  s_waitcnt vmcnt(2)
  s_add_u32 s51, s41, 0
  buffer_load_dwordx4 v[32:35], v16, s[4:7], s51 offen sc1
  s_add_u32 s51, s41, 4096
  buffer_load_dwordx4 v[36:39], v16, s[4:7], s51 offen sc1
  s_add_u32 s51, s41, 8192
  buffer_load_dwordx4 v[40:43], v16, s[4:7], s51 offen sc1
  s_add_u32 s51, s41, 12288
  buffer_load_dwordx4 v[44:47], v16, s[4:7], s51 offen sc1
  s_add_u32 s51, s41, 16384
  buffer_load_dwordx4 v[48:51], v16, s[4:7], s51 offen sc1
  s_add_u32 s51, s41, 20480
  buffer_load_dwordx4 v[52:55], v16, s[4:7], s51 offen sc1
  s_add_u32 s51, s41, 24576
  buffer_load_dwordx4 v[56:59], v16, s[4:7], s51 offen sc1
  s_add_u32 s51, s41, 28672
  buffer_load_dwordx4 v[60:63], v16, s[4:7], s51 offen sc1
  s_add_u32 s51, s41, 32768
  buffer_load_dwordx4 v[64:67], v16, s[4:7], s51 offen sc1
  s_waitcnt lgkmcnt(0)
  s_max_u32 s52, s52, s53
  s_max_u32 s52, s52, s54
  s_max_u32 s52, s52, s55
  s_max_u32 s52, s52, s56
  s_max_u32 s52, s52, s57
  s_max_u32 s52, s52, s58
  s_max_u32 s52, s52, s59
  s_cmp_lt_u32 s49, 64
  s_cselect_b32 s52, s52, -1
  s_cmp_lg_u32 s52, -1
  s_cselect_b32 s48, 1, 0
  s_cbranch_scc0 L_ffn_f1_0
  s_mov_b32 m0, s42
  s_nop 0
  buffer_load_dwordx4 v1, s[4:7], s35 offen sc1 lds
  s_add_u32 m0, s42, 1024
  s_nop 0
  buffer_load_dwordx4 v2, s[4:7], s35 offen sc1 lds
  s_add_u32 m0, s42, 2048
  s_nop 0
  buffer_load_dwordx4 v3, s[4:7], s35 offen sc1 lds
  s_add_u32 m0, s42, 3072
  s_nop 0
  buffer_load_dwordx4 v4, s[4:7], s35 offen sc1 lds
  s_add_u32 m0, s42, 4096
  s_nop 0
  buffer_load_dwordx4 v5, s[4:7], s35 offen sc1 lds
  s_add_u32 m0, s42, 5120
  s_nop 0
  buffer_load_dwordx4 v6, s[4:7], s35 offen sc1 lds
  s_add_u32 m0, s42, 6144
  s_nop 0
  buffer_load_dwordx4 v7, s[4:7], s35 offen sc1 lds
  s_add_u32 m0, s42, 7168
  s_nop 0
  buffer_load_dwordx4 v8, s[4:7], s35 offen sc1 lds
  s_add_u32 m0, s42, 8192
  s_nop 0
  buffer_load_dwordx4 v9, s[4:7], s35 offen sc1 lds
  s_waitcnt vmcnt(15)
  v_bitop3_b32 v20, v32, v34, s60 bitop3:0x7e
  v_bitop3_b32 v21, v36, v38, s60 bitop3:0x7e
  v_bitop3_b32 v22, v40, v42, s60 bitop3:0x7e
  v_or3_b32 v20, v20, v21, v22
  v_and_b32 v20, 1, v20
  v_cmp_eq_u32 vcc, -1, v26
  s_nop 1
  v_cndmask_b32 v20, v20, 1, vcc
  v_cmp_eq_u32 vcc, 1, v20
  s_nop 0
  s_cbranch_vccnz L_ffn_f1_0_r
  v_lshlrev_b32 v68, 16, v26
  v_and_b32 v69, 0xffff0000, v26
  v_lshlrev_b32 v70, 16, v27
  v_and_b32 v71, 0xffff0000, v27
  s_nop 1
  v_mfma_f32_16x16x32_bf16 v[68:71], v[28:31], v[32:35], v[68:71]
  v_mfma_f32_16x16x32_bf16 v[68:71], v[28:31], v[36:39], v[68:71]
  v_mfma_f32_16x16x32_bf16 v[68:71], v[28:31], v[40:43], v[68:71]
  s_waitcnt vmcnt(12)
  v_bitop3_b32 v20, v44, v46, s60 bitop3:0x7e
  v_bitop3_b32 v21, v48, v50, s60 bitop3:0x7e
  v_bitop3_b32 v22, v52, v54, s60 bitop3:0x7e
  v_or3_b32 v20, v20, v21, v22
  v_and_b32 v20, 1, v20
  v_cmp_eq_u32 vcc, 1, v20
  s_nop 0
  s_cbranch_vccnz L_ffn_f1_1_r
  v_mfma_f32_16x16x32_bf16 v[68:71], v[28:31], v[44:47], v[68:71]
  v_mfma_f32_16x16x32_bf16 v[68:71], v[28:31], v[48:51], v[68:71]
  v_mfma_f32_16x16x32_bf16 v[68:71], v[28:31], v[52:55], v[68:71]
  s_waitcnt vmcnt(9)
  v_bitop3_b32 v20, v56, v58, s60 bitop3:0x7e
  v_bitop3_b32 v21, v60, v62, s60 bitop3:0x7e
  v_bitop3_b32 v22, v64, v66, s60 bitop3:0x7e
  v_or3_b32 v20, v20, v21, v22
  v_and_b32 v20, 1, v20
  v_cmp_eq_u32 vcc, 1, v20
  s_nop 0
  s_cbranch_vccnz L_ffn_f1_2_r
  v_mfma_f32_16x16x32_bf16 v[68:71], v[28:31], v[56:59], v[68:71]
  v_mfma_f32_16x16x32_bf16 v[68:71], v[28:31], v[60:63], v[68:71]
  v_mfma_f32_16x16x32_bf16 v[68:71], v[28:31], v[64:67], v[68:71]
  s_branch L_ffn_l1_out
L_ffn_f1_0:
  s_waitcnt vmcnt(6)
  v_bitop3_b32 v20, v32, v34, s60 bitop3:0x7e
  v_bitop3_b32 v21, v36, v38, s60 bitop3:0x7e
  v_bitop3_b32 v22, v40, v42, s60 bitop3:0x7e
  v_or3_b32 v20, v20, v21, v22
  v_and_b32 v20, 1, v20
  v_cmp_eq_u32 vcc, -1, v26
  s_nop 1
  v_cndmask_b32 v20, v20, 1, vcc
  v_cmp_eq_u32 vcc, 1, v20
  s_nop 0
  s_cbranch_vccz L_ffn_f1_0_x
L_ffn_f1_0_r:
  s_add_u32 s50, s50, 1
  s_cmp_ge_u32 s50, 262144
  s_cbranch_scc1 L_ffn_f1_0_x
  buffer_load_dwordx2 v[26:27], v17, s[4:7], s34 offen sc1
  s_add_u32 s51, s41, 0
  buffer_load_dwordx4 v[32:35], v16, s[4:7], s51 offen sc1
  s_add_u32 s51, s41, 4096
  buffer_load_dwordx4 v[36:39], v16, s[4:7], s51 offen sc1
  s_add_u32 s51, s41, 8192
  buffer_load_dwordx4 v[40:43], v16, s[4:7], s51 offen sc1
  s_add_u32 s51, s41, 12288
  buffer_load_dwordx4 v[44:47], v16, s[4:7], s51 offen sc1
  s_add_u32 s51, s41, 16384
  buffer_load_dwordx4 v[48:51], v16, s[4:7], s51 offen sc1
  s_add_u32 s51, s41, 20480
  buffer_load_dwordx4 v[52:55], v16, s[4:7], s51 offen sc1
  s_add_u32 s51, s41, 24576
  buffer_load_dwordx4 v[56:59], v16, s[4:7], s51 offen sc1
  s_add_u32 s51, s41, 28672
  buffer_load_dwordx4 v[60:63], v16, s[4:7], s51 offen sc1
  s_add_u32 s51, s41, 32768
  buffer_load_dwordx4 v[64:67], v16, s[4:7], s51 offen sc1
  s_branch L_ffn_f1_0
L_ffn_f1_0_x:
  v_lshlrev_b32 v68, 16, v26
  v_and_b32 v69, 0xffff0000, v26
  v_lshlrev_b32 v70, 16, v27
  v_and_b32 v71, 0xffff0000, v27
  s_nop 1
  v_mfma_f32_16x16x32_bf16 v[68:71], v[28:31], v[32:35], v[68:71]
  v_mfma_f32_16x16x32_bf16 v[68:71], v[28:31], v[36:39], v[68:71]
  v_mfma_f32_16x16x32_bf16 v[68:71], v[28:31], v[40:43], v[68:71]
L_ffn_f1_1:
  s_waitcnt vmcnt(3)
  v_bitop3_b32 v20, v44, v46, s60 bitop3:0x7e
  v_bitop3_b32 v21, v48, v50, s60 bitop3:0x7e
  v_bitop3_b32 v22, v52, v54, s60 bitop3:0x7e
  v_or3_b32 v20, v20, v21, v22
  v_and_b32 v20, 1, v20
  v_cmp_eq_u32 vcc, 1, v20
  s_nop 0
  s_cbranch_vccz L_ffn_f1_1_x
L_ffn_f1_1_r:
  s_add_u32 s50, s50, 1
  s_cmp_ge_u32 s50, 262144
  s_cbranch_scc1 L_ffn_f1_1_x
  s_add_u32 s51, s41, 12288
  buffer_load_dwordx4 v[44:47], v16, s[4:7], s51 offen sc1
  s_add_u32 s51, s41, 16384
  buffer_load_dwordx4 v[48:51], v16, s[4:7], s51 offen sc1
  s_add_u32 s51, s41, 20480
  buffer_load_dwordx4 v[52:55], v16, s[4:7], s51 offen sc1
  s_add_u32 s51, s41, 24576
  buffer_load_dwordx4 v[56:59], v16, s[4:7], s51 offen sc1
  s_add_u32 s51, s41, 28672
  buffer_load_dwordx4 v[60:63], v16, s[4:7], s51 offen sc1
  s_add_u32 s51, s41, 32768
  buffer_load_dwordx4 v[64:67], v16, s[4:7], s51 offen sc1
  s_branch L_ffn_f1_1
L_ffn_f1_1_x:
  v_mfma_f32_16x16x32_bf16 v[68:71], v[28:31], v[44:47], v[68:71]
  v_mfma_f32_16x16x32_bf16 v[68:71], v[28:31], v[48:51], v[68:71]
  v_mfma_f32_16x16x32_bf16 v[68:71], v[28:31], v[52:55], v[68:71]
L_ffn_f1_2:
  s_waitcnt vmcnt(0)
  v_bitop3_b32 v20, v56, v58, s60 bitop3:0x7e
  v_bitop3_b32 v21, v60, v62, s60 bitop3:0x7e
  v_bitop3_b32 v22, v64, v66, s60 bitop3:0x7e
  v_or3_b32 v20, v20, v21, v22
  v_and_b32 v20, 1, v20
  v_cmp_eq_u32_e64 vcc, 1, v20
  s_nop 0
  s_cbranch_vccz L_ffn_f1_2_x
L_ffn_f1_2_r:
  s_add_u32 s50, s50, 1
  s_cmp_ge_u32 s50, 262144
  s_cbranch_scc1 L_ffn_f1_2_x
  s_add_u32 s51, s41, 24576
  buffer_load_dwordx4 v[56:59], v16, s[4:7], s51 offen sc1
  s_add_u32 s51, s41, 28672
  buffer_load_dwordx4 v[60:63], v16, s[4:7], s51 offen sc1
  s_add_u32 s51, s41, 32768
  buffer_load_dwordx4 v[64:67], v16, s[4:7], s51 offen sc1
  s_branch L_ffn_f1_2
L_ffn_f1_2_x:
  v_mfma_f32_16x16x32_bf16 v[68:71], v[28:31], v[56:59], v[68:71]
  v_mfma_f32_16x16x32_bf16 v[68:71], v[28:31], v[60:63], v[68:71]
  v_mfma_f32_16x16x32_bf16 v[68:71], v[28:31], v[64:67], v[68:71]
L_ffn_l1_out:
  s_nop 7
  v_cvt_pk_bf16_f32 v68, v68, v69
  v_cvt_pk_bf16_f32 v69, v70, v71
  buffer_store_dwordx2 v[68:69], v17, s[24:27], s45 offen
  s_mov_b32 s40, s49
  s_add_u32 s95, s95, 1
  s_cmp_lt_u32 s40, 64
  s_cbranch_scc1 L_ffn_l1
  s_endpgm
L_ffn_w2:
  s_waitcnt vmcnt(27)
  s_barrier
  ds_read_b64_tr_b16 a[112:113], v25 offset:576
  ds_read_b64_tr_b16 a[114:115], v25 offset:9792
  ds_read_b64_tr_b16 a[128:129], v25 offset:584
  ds_read_b64_tr_b16 a[130:131], v25 offset:9800
  ds_read_b64_tr_b16 a[144:145], v25 offset:640
  ds_read_b64_tr_b16 a[146:147], v25 offset:9856
  ds_read_b64_tr_b16 a[160:161], v25 offset:648
  ds_read_b64_tr_b16 a[162:163], v25 offset:9864
  ds_read_b64_tr_b16 a[176:177], v25 offset:704
  ds_read_b64_tr_b16 a[178:179], v25 offset:9920
  ds_read_b64_tr_b16 a[192:193], v25 offset:712
  ds_read_b64_tr_b16 a[194:195], v25 offset:9928
  ds_read_b64_tr_b16 a[208:209], v25 offset:768
  ds_read_b64_tr_b16 a[210:211], v25 offset:9984
  ds_read_b64_tr_b16 a[224:225], v25 offset:776
  ds_read_b64_tr_b16 a[226:227], v25 offset:9992
  ds_read_b64_tr_b16 a[240:241], v25 offset:832
  ds_read_b64_tr_b16 a[242:243], v25 offset:10048
  s_waitcnt vmcnt(18)
  s_barrier
  ds_read_b64_tr_b16 a[116:117], v25 offset:37440
  ds_read_b64_tr_b16 a[118:119], v25 offset:46656
  ds_read_b64_tr_b16 a[132:133], v25 offset:37448
  ds_read_b64_tr_b16 a[134:135], v25 offset:46664
  ds_read_b64_tr_b16 a[148:149], v25 offset:37504
  ds_read_b64_tr_b16 a[150:151], v25 offset:46720
  ds_read_b64_tr_b16 a[164:165], v25 offset:37512
  ds_read_b64_tr_b16 a[166:167], v25 offset:46728
  ds_read_b64_tr_b16 a[180:181], v25 offset:37568
  ds_read_b64_tr_b16 a[182:183], v25 offset:46784
  ds_read_b64_tr_b16 a[196:197], v25 offset:37576
  ds_read_b64_tr_b16 a[198:199], v25 offset:46792
  ds_read_b64_tr_b16 a[212:213], v25 offset:37632
  ds_read_b64_tr_b16 a[214:215], v25 offset:46848
  ds_read_b64_tr_b16 a[228:229], v25 offset:37640
  ds_read_b64_tr_b16 a[230:231], v25 offset:46856
  ds_read_b64_tr_b16 a[244:245], v25 offset:37696
  ds_read_b64_tr_b16 a[246:247], v25 offset:46912
  s_waitcnt vmcnt(9)
  s_barrier
  ds_read_b64_tr_b16 a[120:121], v26 offset:576
  ds_read_b64_tr_b16 a[122:123], v26 offset:9792
  ds_read_b64_tr_b16 a[136:137], v26 offset:584
  ds_read_b64_tr_b16 a[138:139], v26 offset:9800
  ds_read_b64_tr_b16 a[152:153], v26 offset:640
  ds_read_b64_tr_b16 a[154:155], v26 offset:9856
  ds_read_b64_tr_b16 a[168:169], v26 offset:648
  ds_read_b64_tr_b16 a[170:171], v26 offset:9864
  ds_read_b64_tr_b16 a[184:185], v26 offset:704
  ds_read_b64_tr_b16 a[186:187], v26 offset:9920
  ds_read_b64_tr_b16 a[200:201], v26 offset:712
  ds_read_b64_tr_b16 a[202:203], v26 offset:9928
  ds_read_b64_tr_b16 a[216:217], v26 offset:768
  ds_read_b64_tr_b16 a[218:219], v26 offset:9984
  ds_read_b64_tr_b16 a[232:233], v26 offset:776
  ds_read_b64_tr_b16 a[234:235], v26 offset:9992
  ds_read_b64_tr_b16 a[248:249], v26 offset:832
  ds_read_b64_tr_b16 a[250:251], v26 offset:10048
  s_waitcnt vmcnt(0)
  s_barrier
  ds_read_b64_tr_b16 a[124:125], v26 offset:37440
  ds_read_b64_tr_b16 a[126:127], v26 offset:46656
  ds_read_b64_tr_b16 a[140:141], v26 offset:37448
  ds_read_b64_tr_b16 a[142:143], v26 offset:46664
  ds_read_b64_tr_b16 a[156:157], v26 offset:37504
  ds_read_b64_tr_b16 a[158:159], v26 offset:46720
  ds_read_b64_tr_b16 a[172:173], v26 offset:37512
  ds_read_b64_tr_b16 a[174:175], v26 offset:46728
  ds_read_b64_tr_b16 a[188:189], v26 offset:37568
  ds_read_b64_tr_b16 a[190:191], v26 offset:46784
  ds_read_b64_tr_b16 a[204:205], v26 offset:37576
  ds_read_b64_tr_b16 a[206:207], v26 offset:46792
  ds_read_b64_tr_b16 a[220:221], v26 offset:37632
  ds_read_b64_tr_b16 a[222:223], v26 offset:46848
  ds_read_b64_tr_b16 a[236:237], v26 offset:37640
  ds_read_b64_tr_b16 a[238:239], v26 offset:46856
  ds_read_b64_tr_b16 a[252:253], v26 offset:37696
  ds_read_b64_tr_b16 a[254:255], v26 offset:46912
  s_waitcnt lgkmcnt(0)
  s_mul_i32 s34, s44, 2654208
  s_mul_i32 s35, s43, 36864
  s_add_u32 s34, s34, s35
  v_mov_b64 v[32:33], -1
  v_mov_b64 v[34:35], -1
  s_add_u32 s51, s34, 75515904
  buffer_store_dwordx4 v[32:35], v14, s[4:7], s51 offen offset:0 sc1
  buffer_store_dwordx4 v[32:35], v14, s[4:7], s51 offen offset:1024 sc1
  buffer_store_dwordx4 v[32:35], v14, s[4:7], s51 offen offset:2048 sc1
  buffer_store_dwordx4 v[32:35], v14, s[4:7], s51 offen offset:3072 sc1
  s_add_u32 s51, s34, 75520000
  buffer_store_dwordx4 v[32:35], v14, s[4:7], s51 offen offset:0 sc1
  buffer_store_dwordx4 v[32:35], v14, s[4:7], s51 offen offset:1024 sc1
  buffer_store_dwordx4 v[32:35], v14, s[4:7], s51 offen offset:2048 sc1
  buffer_store_dwordx4 v[32:35], v14, s[4:7], s51 offen offset:3072 sc1
  s_add_u32 s51, s34, 75524096
  buffer_store_dwordx4 v[32:35], v14, s[4:7], s51 offen offset:0 sc1
  s_add_u32 s51, s34, 76843008
  buffer_store_dwordx4 v[32:35], v14, s[4:7], s51 offen offset:0 sc1
  buffer_store_dwordx4 v[32:35], v14, s[4:7], s51 offen offset:1024 sc1
  buffer_store_dwordx4 v[32:35], v14, s[4:7], s51 offen offset:2048 sc1
  buffer_store_dwordx4 v[32:35], v14, s[4:7], s51 offen offset:3072 sc1
  s_add_u32 s51, s34, 76847104
  buffer_store_dwordx4 v[32:35], v14, s[4:7], s51 offen offset:0 sc1
  buffer_store_dwordx4 v[32:35], v14, s[4:7], s51 offen offset:1024 sc1
  buffer_store_dwordx4 v[32:35], v14, s[4:7], s51 offen offset:2048 sc1
  buffer_store_dwordx4 v[32:35], v14, s[4:7], s51 offen offset:3072 sc1
  s_add_u32 s51, s34, 76851200
  buffer_store_dwordx4 v[32:35], v14, s[4:7], s51 offen offset:0 sc1
  s_cmp_lg_u32 s44, 3
  s_cbranch_scc1 L_f4_62
  s_waitcnt vmcnt(0)
  s_barrier
  s_cmp_lg_u32 s33, 0
  s_cbranch_scc1 L_meet_63
  v_mov_b32 v20, 1
  s_mov_b64 exec, 1
  buffer_atomic_add v20, off, s[8:11], 0 offset:64 sc0
  s_waitcnt vmcnt(0)
  v_readfirstlane_b32 s51, v20
  v_mov_b32 v20, 1
  s_cmp_lg_u32 s51, 35
  s_cbranch_scc1 L_cnt_64
  buffer_store_dword v20, off, s[8:11], 0 offset:156 sc1
L_cnt_64:
  s_mov_b64 exec, -1
L_f4_65:
  buffer_load_dword v20, off, s[8:11], 0 offset:156 sc1
  s_add_u32 s50, s50, 1
  s_cmp_ge_u32 s50, 262144
  s_waitcnt vmcnt(0)
  s_cbranch_scc1 L_f4_65_x
  v_cmp_ge_u32 vcc, 0, v20
  s_nop 0
  s_cbranch_vccnz L_f4_65
L_f4_65_x:
L_f4_66:
  buffer_load_dword v20, off, s[8:11], 0 offset:144 sc1
  s_add_u32 s50, s50, 1
  s_cmp_ge_u32 s50, 262144
  s_waitcnt vmcnt(0)
  s_cbranch_scc1 L_f4_66_x
  v_cmp_ge_u32 vcc, 0, v20
  s_nop 0
  s_cbranch_vccnz L_f4_66
L_f4_66_x:
L_meet_63:
  s_barrier
  s_mov_b32 s40, 57
  s_branch L_f4_62_x
L_f4_62:
  s_waitcnt vmcnt(0)
  s_barrier
  s_cmp_lg_u32 s33, 0
  s_cbranch_scc1 L_meet_67
  v_mov_b32 v20, 1
  s_mov_b64 exec, 1
  buffer_atomic_add v20, off, s[8:11], 0 offset:28 sc0
  s_waitcnt vmcnt(0)
  v_readfirstlane_b32 s51, v20
  v_mov_b32 v20, 1
  s_cmp_lg_u32 s51, 107
  s_cbranch_scc1 L_cnt_68
  buffer_store_dword v20, off, s[8:11], 0 offset:148 sc1
L_cnt_68:
  s_mov_b64 exec, -1
L_fi_69:
  buffer_load_dword v20, off, s[8:11], 0 offset:148 sc1
  s_add_u32 s50, s50, 1
  s_cmp_ge_u32 s50, 262144
  s_waitcnt vmcnt(0)
  s_cbranch_scc1 L_fi_69_x
  v_cmp_ge_u32 vcc, 0, v20
  s_nop 0
  s_cbranch_vccnz L_fi_69
L_fi_69_x:
L_fi_70:
  buffer_load_dword v20, off, s[8:11], 0 offset:144 sc1
  s_add_u32 s50, s50, 1
  s_cmp_ge_u32 s50, 262144
  s_waitcnt vmcnt(0)
  s_cbranch_scc1 L_fi_70_x
  v_cmp_ge_u32 vcc, 0, v20
  s_nop 0
  s_cbranch_vccnz L_fi_70
L_fi_70_x:
L_meet_67:
  s_barrier
  s_mov_b32 s40, s44
L_f4_62_x:
  s_mov_b32 s95, 0
  s_mov_b32 s48, 0
  v_min_u32 v19, 7, v0
  v_mul_u32_u24 v19, 1152, v19
  v_bfe_u32 v20, v0, 4, 1
  v_lshlrev_b32 v20, 10, v20
  v_lshrrev_b32 v21, 5, v0
  v_lshl_add_u32 v20, v21, 8, v20
  v_and_b32 v21, 15, v0
  v_lshl_add_u32 v24, v21, 4, v20
.p2align 5
L_ffn_l2:
  s_mul_i32 s45, s40, 36864
  s_add_u32 s35, s45, 7340032
  s_add_u32 s34, s45, 4212736
  s_bfe_u32 s60, s95, 0x10001
  s_and_b32 s41, s95, 1
  s_lshl1_add_u32 s41, s44, s41
  s_mul_i32 s41, s41, 1327104
  s_add_u32 s41, s41, 75497472
  s_cmp_ge_u32 s40, 54
  s_addc_u32 s49, s40, 3
  s_cmp_eq_u32 s48, 0
  s_cbranch_scc1 L_ffn_l2_reg
  s_waitcnt vmcnt(1)
  ds_read_b128 v[32:35], v18 offset:0
  ds_read_b128 v[36:39], v18 offset:1024
  ds_read_b128 v[40:43], v18 offset:2048
  ds_read_b128 v[44:47], v18 offset:3072
  ds_read_b128 v[48:51], v18 offset:4096
  ds_read_b128 v[52:55], v18 offset:5120
  ds_read_b128 v[56:59], v18 offset:6144
  ds_read_b128 v[60:63], v18 offset:7168
  ds_read_b128 v[64:67], v18 offset:8192
  s_waitcnt lgkmcnt(8)
  v_max_u32 v20, v32, v34
  s_waitcnt lgkmcnt(7)
  v_max3_u32 v20, v20, v36, v38
  s_waitcnt lgkmcnt(6)
  v_max3_u32 v20, v20, v40, v42
  s_waitcnt lgkmcnt(5)
  v_max3_u32 v20, v20, v44, v46
  s_waitcnt lgkmcnt(4)
  v_max3_u32 v20, v20, v48, v50
  s_waitcnt lgkmcnt(3)
  v_max3_u32 v20, v20, v52, v54
  s_waitcnt lgkmcnt(2)
  v_max3_u32 v20, v20, v56, v58
  s_waitcnt lgkmcnt(1)
  v_max3_u32 v20, v20, v60, v62
  s_waitcnt lgkmcnt(0)
  v_max3_u32 v20, v20, v64, v66
  v_cmp_eq_u32 vcc, -1, v20
  s_nop 0
  s_cbranch_vccz L_ffn_l2_xok
L_ffn_l2_reg:
  s_cmp_ge_u32 s40, 63
  s_cbranch_scc1 L_ffn_l2_p_x
L_ffn_l2_p:
  buffer_load_dword v20, v19, s[4:7], s34 offen sc1
  s_add_u32 s50, s50, 1
  s_cmp_ge_u32 s50, 262144
  s_waitcnt vmcnt(0)
  s_cbranch_scc1 L_ffn_l2_p_x
  v_cmp_eq_u32 vcc, -1, v20
  s_nop 0
  s_cbranch_vccnz L_ffn_l2_p
L_ffn_l2_p_x:
  buffer_load_dwordx4 v[32:35], v1, s[4:7], s35 offen sc1
  buffer_load_dwordx4 v[36:39], v2, s[4:7], s35 offen sc1
  buffer_load_dwordx4 v[40:43], v3, s[4:7], s35 offen sc1
  buffer_load_dwordx4 v[44:47], v4, s[4:7], s35 offen sc1
  buffer_load_dwordx4 v[48:51], v5, s[4:7], s35 offen sc1
  buffer_load_dwordx4 v[52:55], v6, s[4:7], s35 offen sc1
  buffer_load_dwordx4 v[56:59], v7, s[4:7], s35 offen sc1
  buffer_load_dwordx4 v[60:63], v8, s[4:7], s35 offen sc1
  buffer_load_dwordx4 v[64:67], v9, s[4:7], s35 offen sc1
L_ffn_x2_0:
  s_waitcnt vmcnt(8)
  ds_write_b128 v18, v[32:35] offset:0
  v_max_u32 v20, v32, v34
  s_waitcnt vmcnt(7)
  ds_write_b128 v18, v[36:39] offset:1024
  v_max3_u32 v20, v20, v36, v38
  s_waitcnt vmcnt(6)
  ds_write_b128 v18, v[40:43] offset:2048
  v_max3_u32 v20, v20, v40, v42
  v_cmp_eq_u32 vcc, -1, v20
  s_nop 0
  s_cbranch_vccz L_ffn_x2_0_x
  s_add_u32 s50, s50, 1
  s_cmp_ge_u32 s50, 262144
  s_cbranch_scc1 L_ffn_x2_0_x
  s_waitcnt lgkmcnt(0)
  buffer_load_dwordx4 v[32:35], v1, s[4:7], s35 offen sc1
  buffer_load_dwordx4 v[36:39], v2, s[4:7], s35 offen sc1
  buffer_load_dwordx4 v[40:43], v3, s[4:7], s35 offen sc1
  buffer_load_dwordx4 v[44:47], v4, s[4:7], s35 offen sc1
  buffer_load_dwordx4 v[48:51], v5, s[4:7], s35 offen sc1
  buffer_load_dwordx4 v[52:55], v6, s[4:7], s35 offen sc1
  buffer_load_dwordx4 v[56:59], v7, s[4:7], s35 offen sc1
  buffer_load_dwordx4 v[60:63], v8, s[4:7], s35 offen sc1
  buffer_load_dwordx4 v[64:67], v9, s[4:7], s35 offen sc1
  s_branch L_ffn_x2_0
L_ffn_x2_0_x:
L_ffn_x2_1:
  s_waitcnt vmcnt(5)
  ds_write_b128 v18, v[44:47] offset:3072
  v_max_u32 v20, v44, v46
  s_waitcnt vmcnt(4)
  ds_write_b128 v18, v[48:51] offset:4096
  v_max3_u32 v20, v20, v48, v50
  s_waitcnt vmcnt(3)
  ds_write_b128 v18, v[52:55] offset:5120
  v_max3_u32 v20, v20, v52, v54
  v_cmp_eq_u32 vcc, -1, v20
  s_nop 0
  s_cbranch_vccz L_ffn_x2_1_x
  s_add_u32 s50, s50, 1
  s_cmp_ge_u32 s50, 262144
  s_cbranch_scc1 L_ffn_x2_1_x
  s_waitcnt lgkmcnt(0)
  buffer_load_dwordx4 v[44:47], v4, s[4:7], s35 offen sc1
  buffer_load_dwordx4 v[48:51], v5, s[4:7], s35 offen sc1
  buffer_load_dwordx4 v[52:55], v6, s[4:7], s35 offen sc1
  buffer_load_dwordx4 v[56:59], v7, s[4:7], s35 offen sc1
  buffer_load_dwordx4 v[60:63], v8, s[4:7], s35 offen sc1
  buffer_load_dwordx4 v[64:67], v9, s[4:7], s35 offen sc1
  s_branch L_ffn_x2_1
L_ffn_x2_1_x:
L_ffn_x2_2:
  s_waitcnt vmcnt(2)
  ds_write_b128 v18, v[56:59] offset:6144
  v_max_u32 v20, v56, v58
  s_waitcnt vmcnt(1)
  ds_write_b128 v18, v[60:63] offset:7168
  v_max3_u32 v20, v20, v60, v62
  s_waitcnt vmcnt(0)
  ds_write_b128 v18, v[64:67] offset:8192
  v_max3_u32 v20, v20, v64, v66
  v_cmp_eq_u32 vcc, -1, v20
  s_nop 0
  s_cbranch_vccz L_ffn_x2_2_x
  s_add_u32 s50, s50, 1
  s_cmp_ge_u32 s50, 262144
  s_cbranch_scc1 L_ffn_x2_2_x
  s_waitcnt lgkmcnt(0)
  buffer_load_dwordx4 v[56:59], v7, s[4:7], s35 offen sc1
  buffer_load_dwordx4 v[60:63], v8, s[4:7], s35 offen sc1
  buffer_load_dwordx4 v[64:67], v9, s[4:7], s35 offen sc1
  s_branch L_ffn_x2_2
L_ffn_x2_2_x:
  s_waitcnt lgkmcnt(0)
L_ffn_l2_xok:
  s_barrier
  ds_read_b128 v[64:67], v10 offset:0
  ds_read_b128 v[68:71], v11 offset:0
  ds_read_b128 v[72:75], v12 offset:0
  s_add_u32 s34, s45, 4194304
  s_waitcnt lgkmcnt(2)
  v_mfma_f32_32x32x16_bf16 v[32:47], v[80:83], v[64:67], 0
  ds_read_b128 v[76:79], v13 offset:0
  v_mfma_f32_32x32x16_bf16 v[48:63], v[84:87], v[64:67], 0
  s_waitcnt lgkmcnt(2)
  v_mfma_f32_32x32x16_bf16 v[32:47], v[88:91], v[68:71], v[32:47]
  ds_read_b128 v[64:67], v10 offset:128
  v_mfma_f32_32x32x16_bf16 v[48:63], v[92:95], v[68:71], v[48:63]
  s_waitcnt lgkmcnt(2)
  v_mfma_f32_32x32x16_bf16 v[32:47], v[96:99], v[72:75], v[32:47]
  ds_read_b128 v[68:71], v11 offset:128
  v_mfma_f32_32x32x16_bf16 v[48:63], v[100:103], v[72:75], v[48:63]
  s_waitcnt lgkmcnt(2)
  v_mfma_f32_32x32x16_bf16 v[32:47], v[104:107], v[76:79], v[32:47]
  ds_read_b128 v[72:75], v12 offset:128
  v_mfma_f32_32x32x16_bf16 v[48:63], v[108:111], v[76:79], v[48:63]
  s_waitcnt lgkmcnt(2)
  v_mfma_f32_32x32x16_bf16 v[32:47], v[112:115], v[64:67], v[32:47]
  ds_read_b128 v[76:79], v13 offset:128
  v_mfma_f32_32x32x16_bf16 v[48:63], v[116:119], v[64:67], v[48:63]
  s_waitcnt lgkmcnt(2)
  v_mfma_f32_32x32x16_bf16 v[32:47], v[120:123], v[68:71], v[32:47]
  ds_read_b128 v[64:67], v10 offset:256
  v_mfma_f32_32x32x16_bf16 v[48:63], v[124:127], v[68:71], v[48:63]
  s_waitcnt lgkmcnt(2)
  v_mfma_f32_32x32x16_bf16 v[32:47], v[128:131], v[72:75], v[32:47]
  ds_read_b128 v[68:71], v11 offset:256
  v_mfma_f32_32x32x16_bf16 v[48:63], v[132:135], v[72:75], v[48:63]
  s_waitcnt lgkmcnt(2)
  v_mfma_f32_32x32x16_bf16 v[32:47], v[136:139], v[76:79], v[32:47]
  ds_read_b128 v[72:75], v12 offset:256
  v_mfma_f32_32x32x16_bf16 v[48:63], v[140:143], v[76:79], v[48:63]
  s_waitcnt lgkmcnt(2)
  v_mfma_f32_32x32x16_bf16 v[32:47], v[144:147], v[64:67], v[32:47]
  ds_read_b128 v[76:79], v13 offset:256
  v_mfma_f32_32x32x16_bf16 v[48:63], v[148:151], v[64:67], v[48:63]
  buffer_load_dwordx2 v[26:27], v17, s[4:7], s34 offen sc1
  s_waitcnt lgkmcnt(2)
  v_mfma_f32_32x32x16_bf16 v[32:47], v[152:155], v[68:71], v[32:47]
  ds_read_b128 v[64:67], v10 offset:384
  v_mfma_f32_32x32x16_bf16 v[48:63], v[156:159], v[68:71], v[48:63]
  s_waitcnt lgkmcnt(2)
  v_mfma_f32_32x32x16_bf16 v[32:47], v[160:163], v[72:75], v[32:47]
  ds_read_b128 v[68:71], v11 offset:384
  v_mfma_f32_32x32x16_bf16 v[48:63], v[164:167], v[72:75], v[48:63]
  s_waitcnt lgkmcnt(2)
  v_mfma_f32_32x32x16_bf16 v[32:47], v[168:171], v[76:79], v[32:47]
  ds_read_b128 v[72:75], v12 offset:384
  v_mfma_f32_32x32x16_bf16 v[48:63], v[172:175], v[76:79], v[48:63]
  s_waitcnt lgkmcnt(2)
  v_mfma_f32_32x32x16_bf16 v[32:47], v[176:179], v[64:67], v[32:47]
  ds_read_b128 v[76:79], v13 offset:384
  v_mfma_f32_32x32x16_bf16 v[48:63], v[180:183], v[64:67], v[48:63]
  s_waitcnt lgkmcnt(2)
  v_mfma_f32_32x32x16_bf16 v[32:47], v[184:187], v[68:71], v[32:47]
  ds_read_b128 v[64:67], v10 offset:512
  v_mfma_f32_32x32x16_bf16 v[48:63], v[188:191], v[68:71], v[48:63]
  s_waitcnt lgkmcnt(2)
  v_mfma_f32_32x32x16_bf16 v[32:47], v[192:195], v[72:75], v[32:47]
  ds_read_b128 v[68:71], v11 offset:512
  v_mfma_f32_32x32x16_bf16 v[48:63], v[196:199], v[72:75], v[48:63]
  s_waitcnt lgkmcnt(2)
  v_mfma_f32_32x32x16_bf16 v[32:47], v[200:203], v[76:79], v[32:47]
  ds_read_b128 v[72:75], v12 offset:512
  v_mfma_f32_32x32x16_bf16 v[48:63], v[204:207], v[76:79], v[48:63]
  s_waitcnt lgkmcnt(2)
  v_mfma_f32_32x32x16_bf16 v[32:47], v[208:211], v[64:67], v[32:47]
  ds_read_b128 v[76:79], v13 offset:512
  v_mfma_f32_32x32x16_bf16 v[48:63], v[212:215], v[64:67], v[48:63]
  s_waitcnt lgkmcnt(2)
  v_mfma_f32_32x32x16_bf16 v[32:47], v[216:219], v[68:71], v[32:47]
  ds_read_b128 v[64:67], v10 offset:640
  v_mfma_f32_32x32x16_bf16 v[48:63], v[220:223], v[68:71], v[48:63]
  s_waitcnt lgkmcnt(2)
  v_mfma_f32_32x32x16_bf16 v[32:47], v[224:227], v[72:75], v[32:47]
  ds_read_b128 v[68:71], v11 offset:640
  v_mfma_f32_32x32x16_bf16 v[48:63], v[228:231], v[72:75], v[48:63]
  s_waitcnt lgkmcnt(2)
  v_mfma_f32_32x32x16_bf16 v[32:47], v[232:235], v[76:79], v[32:47]
  ds_read_b128 v[72:75], v12 offset:640
  v_mfma_f32_32x32x16_bf16 v[48:63], v[236:239], v[76:79], v[48:63]
  s_waitcnt lgkmcnt(2)
  v_mfma_f32_32x32x16_bf16 v[32:47], v[240:243], v[64:67], v[32:47]
  ds_read_b128 v[76:79], v13 offset:640
  v_mfma_f32_32x32x16_bf16 v[48:63], v[244:247], v[64:67], v[48:63]
  s_waitcnt lgkmcnt(2)
  v_mfma_f32_32x32x16_bf16 v[32:47], v[248:251], v[68:71], v[32:47]
  ds_read_b128 v[64:67], v10 offset:768
  v_mfma_f32_32x32x16_bf16 v[48:63], v[252:255], v[68:71], v[48:63]
  s_waitcnt lgkmcnt(2)
  v_mfma_f32_32x32x16_bf16 v[32:47], a[0:3], v[72:75], v[32:47]
  ds_read_b128 v[68:71], v11 offset:768
  v_mfma_f32_32x32x16_bf16 v[48:63], a[4:7], v[72:75], v[48:63]
  s_waitcnt lgkmcnt(2)
  v_mfma_f32_32x32x16_bf16 v[32:47], a[8:11], v[76:79], v[32:47]
  ds_read_b128 v[72:75], v12 offset:768
  v_mfma_f32_32x32x16_bf16 v[48:63], a[12:15], v[76:79], v[48:63]
  s_waitcnt lgkmcnt(2)
  v_mfma_f32_32x32x16_bf16 v[32:47], a[16:19], v[64:67], v[32:47]
  ds_read_b128 v[76:79], v13 offset:768
  v_mfma_f32_32x32x16_bf16 v[48:63], a[20:23], v[64:67], v[48:63]
  s_waitcnt lgkmcnt(2)
  v_mfma_f32_32x32x16_bf16 v[32:47], a[24:27], v[68:71], v[32:47]
  ds_read_b128 v[64:67], v10 offset:896
  v_mfma_f32_32x32x16_bf16 v[48:63], a[28:31], v[68:71], v[48:63]
  s_waitcnt lgkmcnt(2)
  v_mfma_f32_32x32x16_bf16 v[32:47], a[32:35], v[72:75], v[32:47]
  ds_read_b128 v[68:71], v11 offset:896
  v_mfma_f32_32x32x16_bf16 v[48:63], a[36:39], v[72:75], v[48:63]
  s_waitcnt lgkmcnt(2)
  v_mfma_f32_32x32x16_bf16 v[32:47], a[40:43], v[76:79], v[32:47]
  ds_read_b128 v[72:75], v12 offset:896
  v_mfma_f32_32x32x16_bf16 v[48:63], a[44:47], v[76:79], v[48:63]
  s_waitcnt lgkmcnt(2)
  v_mfma_f32_32x32x16_bf16 v[32:47], a[48:51], v[64:67], v[32:47]
  ds_read_b128 v[76:79], v13 offset:896
  v_mfma_f32_32x32x16_bf16 v[48:63], a[52:55], v[64:67], v[48:63]
  s_waitcnt lgkmcnt(2)
  v_mfma_f32_32x32x16_bf16 v[32:47], a[56:59], v[68:71], v[32:47]
  ds_read_b128 v[64:67], v10 offset:1024
  v_mfma_f32_32x32x16_bf16 v[48:63], a[60:63], v[68:71], v[48:63]
  s_waitcnt lgkmcnt(2)
  v_mfma_f32_32x32x16_bf16 v[32:47], a[64:67], v[72:75], v[32:47]
  ds_read_b128 v[68:71], v11 offset:1024
  v_mfma_f32_32x32x16_bf16 v[48:63], a[68:71], v[72:75], v[48:63]
  s_waitcnt lgkmcnt(2)
  v_mfma_f32_32x32x16_bf16 v[32:47], a[72:75], v[76:79], v[32:47]
  ds_read_b128 v[72:75], v12 offset:1024
  v_mfma_f32_32x32x16_bf16 v[48:63], a[76:79], v[76:79], v[48:63]
  s_waitcnt lgkmcnt(2)
  v_mfma_f32_32x32x16_bf16 v[32:47], a[80:83], v[64:67], v[32:47]
  ds_read_b128 v[76:79], v13 offset:1024
  v_mfma_f32_32x32x16_bf16 v[48:63], a[84:87], v[64:67], v[48:63]
  s_waitcnt lgkmcnt(2)
  v_mfma_f32_32x32x16_bf16 v[32:47], a[88:91], v[68:71], v[32:47]
  v_mfma_f32_32x32x16_bf16 v[48:63], a[92:95], v[68:71], v[48:63]
  s_waitcnt lgkmcnt(1)
  v_mfma_f32_32x32x16_bf16 v[32:47], a[96:99], v[72:75], v[32:47]
  v_mfma_f32_32x32x16_bf16 v[48:63], a[100:103], v[72:75], v[48:63]
  s_waitcnt lgkmcnt(0)
  v_mfma_f32_32x32x16_bf16 v[32:47], a[104:107], v[76:79], v[32:47]
  v_mfma_f32_32x32x16_bf16 v[48:63], a[108:111], v[76:79], v[48:63]
  s_nop 4
  v_max_f32_e64 v32, 0, v32
  v_max_f32_e64 v33, 0, v33
  v_max_f32 v34, 0, v34
  v_max_f32 v35, 0, v35
  v_max_f32_e64 v36, 0, v36
  v_max_f32_e64 v37, 0, v37
  v_max_f32_e64 v38, 0, v38
  v_max_f32 v39, 0, v39
  v_max_f32 v40, 0, v40
  v_max_f32 v41, 0, v41
  v_max_f32 v42, 0, v42
  v_max_f32_e64 v43, 0, v43
  v_max_f32_e64 v44, 0, v44
  v_max_f32 v45, 0, v45
  v_max_f32 v46, 0, v46
  v_max_f32 v47, 0, v47
  v_pk_mul_f32 v[32:33], v[32:33], v[48:49]
  v_pk_mul_f32 v[34:35], v[34:35], v[50:51]
  v_pk_mul_f32 v[36:37], v[36:37], v[52:53]
  v_pk_mul_f32 v[38:39], v[38:39], v[54:55]
  v_cvt_pk_bf16_f32 v32, v32, v33
  v_cvt_pk_bf16_f32 v33, v34, v35
  v_cvt_pk_bf16_f32 v34, v36, v37
  v_cvt_pk_bf16_f32 v35, v38, v39
  ds_write_b128 v24, v[32:35] offset:45056
  v_pk_mul_f32 v[40:41], v[40:41], v[56:57]
  v_pk_mul_f32 v[42:43], v[42:43], v[58:59]
  v_pk_mul_f32 v[44:45], v[44:45], v[60:61]
  v_pk_mul_f32 v[46:47], v[46:47], v[62:63]
  v_cvt_pk_bf16_f32 v40, v40, v41
  v_cvt_pk_bf16_f32 v41, v42, v43
  v_cvt_pk_bf16_f32 v42, v44, v45
  v_cvt_pk_bf16_f32 v43, v46, v47
  ds_write_b128 v24, v[40:43] offset:45568
  s_waitcnt lgkmcnt(0)
  s_barrier
  ds_read_b128 v[32:35], v14 offset:40960
  ds_read_b128 v[36:39], v14 offset:41984
  ds_read_b128 v[40:43], v14 offset:43008
  ds_read_b128 v[44:47], v14 offset:44032
  ds_read_b128 v[48:51], v14 offset:45056
  ds_read_b128 v[52:55], v14 offset:46080
  ds_read_b128 v[56:59], v14 offset:47104
  ds_read_b128 v[60:63], v14 offset:48128
  s_waitcnt lgkmcnt(7)
  v_mfma_f32_16x16x32_bf16 v[64:67], a[112:115], v[32:35], 0
  v_mfma_f32_16x16x32_bf16 v[68:71], a[128:131], v[32:35], 0
  s_waitcnt lgkmcnt(5)
  v_mfma_f32_16x16x32_bf16 v[64:67], a[116:119], v[40:43], v[64:67]
  v_mfma_f32_16x16x32_bf16 v[68:71], a[132:135], v[40:43], v[68:71]
  s_waitcnt lgkmcnt(3)
  v_mfma_f32_16x16x32_bf16 v[64:67], a[120:123], v[48:51], v[64:67]
  v_mfma_f32_16x16x32_bf16 v[68:71], a[136:139], v[48:51], v[68:71]
  s_waitcnt lgkmcnt(1)
  v_mfma_f32_16x16x32_bf16 v[64:67], a[124:127], v[56:59], v[64:67]
  v_mfma_f32_16x16x32_bf16 v[68:71], a[140:143], v[56:59], v[68:71]
  v_mfma_f32_16x16x32_bf16 v[72:75], a[112:115], v[36:39], 0
  v_mfma_f32_16x16x32_bf16 v[76:79], a[128:131], v[36:39], 0
  v_mfma_f32_16x16x32_bf16 v[72:75], a[116:119], v[44:47], v[72:75]
  v_mfma_f32_16x16x32_bf16 v[76:79], a[132:135], v[44:47], v[76:79]
  s_add_u32 s51, s41, 331776
  v_cvt_pk_bf16_f32 v64, v64, v65
  v_cvt_pk_bf16_f32 v65, v66, v67
  v_cvt_pk_bf16_f32 v66, v68, v69
  v_cvt_pk_bf16_f32 v67, v70, v71
  v_bfi_b32 v64, 1, s60, v64
  v_bfi_b32 v66, 1, s60, v66
  buffer_store_dwordx4 v[64:67], v15, s[4:7], s51 offen sc1
  v_mfma_f32_16x16x32_bf16 v[72:75], a[120:123], v[52:55], v[72:75]
  v_mfma_f32_16x16x32_bf16 v[76:79], a[136:139], v[52:55], v[76:79]
  s_waitcnt lgkmcnt(0)
  v_mfma_f32_16x16x32_bf16 v[72:75], a[124:127], v[60:63], v[72:75]
  v_mfma_f32_16x16x32_bf16 v[76:79], a[140:143], v[60:63], v[76:79]
  v_mfma_f32_16x16x32_bf16 v[64:67], a[144:147], v[32:35], 0
  v_mfma_f32_16x16x32_bf16 v[68:71], a[160:163], v[32:35], 0
  v_mfma_f32_16x16x32_bf16 v[64:67], a[148:151], v[40:43], v[64:67]
  v_mfma_f32_16x16x32_bf16 v[68:71], a[164:167], v[40:43], v[68:71]
  s_add_u32 s51, s41, 995328
  v_cvt_pk_bf16_f32 v72, v72, v73
  v_cvt_pk_bf16_f32 v73, v74, v75
  v_cvt_pk_bf16_f32 v74, v76, v77
  v_cvt_pk_bf16_f32 v75, v78, v79
  v_bfi_b32 v72, 1, s60, v72
  v_bfi_b32 v74, 1, s60, v74
  buffer_store_dwordx4 v[72:75], v15, s[4:7], s51 offen sc1
  v_mfma_f32_16x16x32_bf16 v[64:67], a[152:155], v[48:51], v[64:67]
  v_mfma_f32_16x16x32_bf16 v[68:71], a[168:171], v[48:51], v[68:71]
  v_mfma_f32_16x16x32_bf16 v[64:67], a[156:159], v[56:59], v[64:67]
  v_mfma_f32_16x16x32_bf16 v[68:71], a[172:175], v[56:59], v[68:71]
  v_mfma_f32_16x16x32_bf16 v[72:75], a[144:147], v[36:39], 0
  v_mfma_f32_16x16x32_bf16 v[76:79], a[160:163], v[36:39], 0
  v_mfma_f32_16x16x32_bf16 v[72:75], a[148:151], v[44:47], v[72:75]
  v_mfma_f32_16x16x32_bf16 v[76:79], a[164:167], v[44:47], v[76:79]
  s_add_u32 s51, s41, 368640
  v_cvt_pk_bf16_f32 v64, v64, v65
  v_cvt_pk_bf16_f32 v65, v66, v67
  v_cvt_pk_bf16_f32 v66, v68, v69
  v_cvt_pk_bf16_f32 v67, v70, v71
  v_bfi_b32 v64, 1, s60, v64
  v_bfi_b32 v66, 1, s60, v66
  buffer_store_dwordx4 v[64:67], v15, s[4:7], s51 offen sc1
  v_mfma_f32_16x16x32_bf16 v[72:75], a[152:155], v[52:55], v[72:75]
  v_mfma_f32_16x16x32_bf16 v[76:79], a[168:171], v[52:55], v[76:79]
  v_mfma_f32_16x16x32_bf16 v[72:75], a[156:159], v[60:63], v[72:75]
  v_mfma_f32_16x16x32_bf16 v[76:79], a[172:175], v[60:63], v[76:79]
  v_mfma_f32_16x16x32_bf16 v[64:67], a[176:179], v[32:35], 0
  v_mfma_f32_16x16x32_bf16 v[68:71], a[192:195], v[32:35], 0
  v_mfma_f32_16x16x32_bf16 v[64:67], a[180:183], v[40:43], v[64:67]
  v_mfma_f32_16x16x32_bf16 v[68:71], a[196:199], v[40:43], v[68:71]
  s_add_u32 s51, s41, 1032192
  v_cvt_pk_bf16_f32 v72, v72, v73
  v_cvt_pk_bf16_f32 v73, v74, v75
  v_cvt_pk_bf16_f32 v74, v76, v77
  v_cvt_pk_bf16_f32 v75, v78, v79
  v_bfi_b32 v72, 1, s60, v72
  v_bfi_b32 v74, 1, s60, v74
  buffer_store_dwordx4 v[72:75], v15, s[4:7], s51 offen sc1
  v_mfma_f32_16x16x32_bf16 v[64:67], a[184:187], v[48:51], v[64:67]
  v_mfma_f32_16x16x32_bf16 v[68:71], a[200:203], v[48:51], v[68:71]
  v_mfma_f32_16x16x32_bf16 v[64:67], a[188:191], v[56:59], v[64:67]
  v_mfma_f32_16x16x32_bf16 v[68:71], a[204:207], v[56:59], v[68:71]
  v_mfma_f32_16x16x32_bf16 v[72:75], a[176:179], v[36:39], 0
  v_mfma_f32_16x16x32_bf16 v[76:79], a[192:195], v[36:39], 0
  v_mfma_f32_16x16x32_bf16 v[72:75], a[180:183], v[44:47], v[72:75]
  v_mfma_f32_16x16x32_bf16 v[76:79], a[196:199], v[44:47], v[76:79]
  s_add_u32 s51, s41, 405504
  v_cvt_pk_bf16_f32 v64, v64, v65
  v_cvt_pk_bf16_f32 v65, v66, v67
  v_cvt_pk_bf16_f32 v66, v68, v69
  v_cvt_pk_bf16_f32 v67, v70, v71
  v_bfi_b32 v64, 1, s60, v64
  v_bfi_b32 v66, 1, s60, v66
  buffer_store_dwordx4 v[64:67], v15, s[4:7], s51 offen sc1
  v_mfma_f32_16x16x32_bf16 v[72:75], a[184:187], v[52:55], v[72:75]
  v_mfma_f32_16x16x32_bf16 v[76:79], a[200:203], v[52:55], v[76:79]
  v_mfma_f32_16x16x32_bf16 v[72:75], a[188:191], v[60:63], v[72:75]
  v_mfma_f32_16x16x32_bf16 v[76:79], a[204:207], v[60:63], v[76:79]
  v_mfma_f32_16x16x32_bf16 v[64:67], a[208:211], v[32:35], 0
  v_mfma_f32_16x16x32_bf16 v[68:71], a[224:227], v[32:35], 0
  v_mfma_f32_16x16x32_bf16 v[64:67], a[212:215], v[40:43], v[64:67]
  v_mfma_f32_16x16x32_bf16 v[68:71], a[228:231], v[40:43], v[68:71]
  s_add_u32 s51, s41, 1069056
  v_cvt_pk_bf16_f32 v72, v72, v73
  v_cvt_pk_bf16_f32 v73, v74, v75
  v_cvt_pk_bf16_f32 v74, v76, v77
  v_cvt_pk_bf16_f32 v75, v78, v79
  v_bfi_b32 v72, 1, s60, v72
  v_bfi_b32 v74, 1, s60, v74
  buffer_store_dwordx4 v[72:75], v15, s[4:7], s51 offen sc1
  v_mfma_f32_16x16x32_bf16 v[64:67], a[216:219], v[48:51], v[64:67]
  v_mfma_f32_16x16x32_bf16 v[68:71], a[232:235], v[48:51], v[68:71]
  v_mfma_f32_16x16x32_bf16 v[64:67], a[220:223], v[56:59], v[64:67]
  v_mfma_f32_16x16x32_bf16 v[68:71], a[236:239], v[56:59], v[68:71]
  v_mfma_f32_16x16x32_bf16 v[72:75], a[208:211], v[36:39], 0
  v_mfma_f32_16x16x32_bf16 v[76:79], a[224:227], v[36:39], 0
  v_mfma_f32_16x16x32_bf16 v[72:75], a[212:215], v[44:47], v[72:75]
  v_mfma_f32_16x16x32_bf16 v[76:79], a[228:231], v[44:47], v[76:79]
  s_add_u32 s51, s41, 442368
  v_cvt_pk_bf16_f32 v64, v64, v65
  v_cvt_pk_bf16_f32 v65, v66, v67
  v_cvt_pk_bf16_f32 v66, v68, v69
  v_cvt_pk_bf16_f32 v67, v70, v71
  v_bfi_b32 v64, 1, s60, v64
  v_bfi_b32 v66, 1, s60, v66
  buffer_store_dwordx4 v[64:67], v15, s[4:7], s51 offen sc1
  v_mfma_f32_16x16x32_bf16 v[72:75], a[216:219], v[52:55], v[72:75]
  v_mfma_f32_16x16x32_bf16 v[76:79], a[232:235], v[52:55], v[76:79]
  v_mfma_f32_16x16x32_bf16 v[72:75], a[220:223], v[60:63], v[72:75]
  v_mfma_f32_16x16x32_bf16 v[76:79], a[236:239], v[60:63], v[76:79]
  s_mul_i32 s35, s49, 36864
  s_add_u32 s35, s35, 7340032
  s_load_dword s52, s[4:5], s35 offset:18432 glc
  s_load_dword s53, s[4:5], s35 offset:19584 glc
  s_load_dword s54, s[4:5], s35 offset:20736 glc
  s_load_dword s55, s[4:5], s35 offset:21888 glc
  s_load_dword s56, s[4:5], s35 offset:23040 glc
  s_load_dword s57, s[4:5], s35 offset:24192 glc
  s_load_dword s58, s[4:5], s35 offset:25344 glc
  s_load_dword s59, s[4:5], s35 offset:26496 glc
  v_mfma_f32_16x16x32_bf16 v[64:67], a[240:243], v[32:35], 0
  v_mfma_f32_16x16x32_bf16 v[64:67], a[244:247], v[40:43], v[64:67]
  s_add_u32 s51, s41, 1105920
  v_cvt_pk_bf16_f32 v72, v72, v73
  v_cvt_pk_bf16_f32 v73, v74, v75
  v_cvt_pk_bf16_f32 v74, v76, v77
  v_cvt_pk_bf16_f32 v75, v78, v79
  v_bfi_b32 v72, 1, s60, v72
  v_bfi_b32 v74, 1, s60, v74
  buffer_store_dwordx4 v[72:75], v15, s[4:7], s51 offen sc1
  v_mfma_f32_16x16x32_bf16 v[64:67], a[248:251], v[48:51], v[64:67]
  v_mfma_f32_16x16x32_bf16 v[64:67], a[252:255], v[56:59], v[64:67]
  v_mfma_f32_16x16x32_bf16 v[72:75], a[240:243], v[36:39], 0
  v_mfma_f32_16x16x32_bf16 v[72:75], a[244:247], v[44:47], v[72:75]
  s_add_u32 s51, s41, 479232
  v_cvt_pk_bf16_f32 v64, v64, v65
  v_cvt_pk_bf16_f32 v65, v66, v67
  v_bfi_b32 v64, 1, s60, v64
  buffer_store_dwordx2 v[64:65], v15, s[4:7], s51 offen offset:0 sc1
  v_mfma_f32_16x16x32_bf16 v[72:75], a[248:251], v[52:55], v[72:75]
  v_mfma_f32_16x16x32_bf16 v[72:75], a[252:255], v[60:63], v[72:75]
  s_add_u32 s51, s41, 1142784
  s_nop 6
  v_cvt_pk_bf16_f32 v72, v72, v73
  v_cvt_pk_bf16_f32 v73, v74, v75
  v_bfi_b32 v72, 1, s60, v72
  buffer_store_dwordx2 v[72:73], v15, s[4:7], s51 offen offset:0 sc1
  s_waitcnt vmcnt(2)
  s_add_u32 s51, s41, 0
  buffer_load_dwordx4 v[32:35], v16, s[4:7], s51 offen sc1
  s_add_u32 s51, s41, 4096
  buffer_load_dwordx4 v[36:39], v16, s[4:7], s51 offen sc1
  s_add_u32 s51, s41, 8192
  buffer_load_dwordx4 v[40:43], v16, s[4:7], s51 offen sc1
  s_add_u32 s51, s41, 12288
  buffer_load_dwordx4 v[44:47], v16, s[4:7], s51 offen sc1
  s_add_u32 s51, s41, 16384
  buffer_load_dwordx4 v[48:51], v16, s[4:7], s51 offen sc1
  s_add_u32 s51, s41, 20480
  buffer_load_dwordx4 v[52:55], v16, s[4:7], s51 offen sc1
  s_add_u32 s51, s41, 24576
  buffer_load_dwordx4 v[56:59], v16, s[4:7], s51 offen sc1
  s_add_u32 s51, s41, 28672
  buffer_load_dwordx4 v[60:63], v16, s[4:7], s51 offen sc1
  s_add_u32 s51, s41, 32768
  buffer_load_dwordx4 v[64:67], v16, s[4:7], s51 offen sc1
  s_waitcnt lgkmcnt(0)
  s_max_u32 s52, s52, s53
  s_max_u32 s52, s52, s54
  s_max_u32 s52, s52, s55
  s_max_u32 s52, s52, s56
  s_max_u32 s52, s52, s57
  s_max_u32 s52, s52, s58
  s_max_u32 s52, s52, s59
  s_cmp_lt_u32 s49, 64
  s_cselect_b32 s52, s52, -1
  s_cmp_lg_u32 s52, -1
  s_cselect_b32 s48, 1, 0
  s_cbranch_scc0 L_ffn_f2_0
  s_mov_b32 m0, s42
  s_nop 0
  buffer_load_dwordx4 v1, s[4:7], s35 offen sc1 lds
  s_add_u32 m0, s42, 1024
  s_nop 0
  buffer_load_dwordx4 v2, s[4:7], s35 offen sc1 lds
  s_add_u32 m0, s42, 2048
  s_nop 0
  buffer_load_dwordx4 v3, s[4:7], s35 offen sc1 lds
  s_add_u32 m0, s42, 3072
  s_nop 0
  buffer_load_dwordx4 v4, s[4:7], s35 offen sc1 lds
  s_add_u32 m0, s42, 4096
  s_nop 0
  buffer_load_dwordx4 v5, s[4:7], s35 offen sc1 lds
  s_add_u32 m0, s42, 5120
  s_nop 0
  buffer_load_dwordx4 v6, s[4:7], s35 offen sc1 lds
  s_add_u32 m0, s42, 6144
  s_nop 0
  buffer_load_dwordx4 v7, s[4:7], s35 offen sc1 lds
  s_add_u32 m0, s42, 7168
  s_nop 0
  buffer_load_dwordx4 v8, s[4:7], s35 offen sc1 lds
  s_add_u32 m0, s42, 8192
  s_nop 0
  buffer_load_dwordx4 v9, s[4:7], s35 offen sc1 lds
  s_waitcnt vmcnt(15)
  v_bitop3_b32 v20, v32, v34, s60 bitop3:0x7e
  v_bitop3_b32 v21, v36, v38, s60 bitop3:0x7e
  v_bitop3_b32 v22, v40, v42, s60 bitop3:0x7e
  v_or3_b32 v20, v20, v21, v22
  v_and_b32 v20, 1, v20
  v_cmp_eq_u32 vcc, -1, v26
  s_nop 1
  v_cndmask_b32 v20, v20, 1, vcc
  v_cmp_eq_u32 vcc, 1, v20
  s_nop 0
  s_cbranch_vccnz L_ffn_f2_0_r
  v_lshlrev_b32 v68, 16, v26
  v_and_b32 v69, 0xffff0000, v26
  v_lshlrev_b32 v70, 16, v27
  v_and_b32 v71, 0xffff0000, v27
  s_nop 1
  v_mfma_f32_16x16x32_bf16 v[68:71], v[28:31], v[32:35], v[68:71]
  v_mfma_f32_16x16x32_bf16 v[68:71], v[28:31], v[36:39], v[68:71]
  v_mfma_f32_16x16x32_bf16 v[68:71], v[28:31], v[40:43], v[68:71]
  s_waitcnt vmcnt(12)
  v_bitop3_b32 v20, v44, v46, s60 bitop3:0x7e
  v_bitop3_b32 v21, v48, v50, s60 bitop3:0x7e
  v_bitop3_b32 v22, v52, v54, s60 bitop3:0x7e
  v_or3_b32 v20, v20, v21, v22
  v_and_b32 v20, 1, v20
  v_cmp_eq_u32 vcc, 1, v20
  s_nop 0
  s_cbranch_vccnz L_ffn_f2_1_r
  v_mfma_f32_16x16x32_bf16 v[68:71], v[28:31], v[44:47], v[68:71]
  v_mfma_f32_16x16x32_bf16 v[68:71], v[28:31], v[48:51], v[68:71]
  v_mfma_f32_16x16x32_bf16 v[68:71], v[28:31], v[52:55], v[68:71]
  s_waitcnt vmcnt(9)
  v_bitop3_b32 v20, v56, v58, s60 bitop3:0x7e
  v_bitop3_b32 v21, v60, v62, s60 bitop3:0x7e
  v_bitop3_b32 v22, v64, v66, s60 bitop3:0x7e
  v_or3_b32 v20, v20, v21, v22
  v_and_b32 v20, 1, v20
  v_cmp_eq_u32 vcc, 1, v20
  s_nop 0
  s_cbranch_vccnz L_ffn_f2_2_r
  v_mfma_f32_16x16x32_bf16 v[68:71], v[28:31], v[56:59], v[68:71]
  v_mfma_f32_16x16x32_bf16 v[68:71], v[28:31], v[60:63], v[68:71]
  v_mfma_f32_16x16x32_bf16 v[68:71], v[28:31], v[64:67], v[68:71]
  s_branch L_ffn_l2_out
L_ffn_f2_0:
  s_waitcnt vmcnt(6)
  v_bitop3_b32 v20, v32, v34, s60 bitop3:0x7e
  v_bitop3_b32 v21, v36, v38, s60 bitop3:0x7e
  v_bitop3_b32 v22, v40, v42, s60 bitop3:0x7e
  v_or3_b32 v20, v20, v21, v22
  v_and_b32 v20, 1, v20
  v_cmp_eq_u32 vcc, -1, v26
  s_nop 1
  v_cndmask_b32 v20, v20, 1, vcc
  v_cmp_eq_u32 vcc, 1, v20
  s_nop 0
  s_cbranch_vccz L_ffn_f2_0_x
L_ffn_f2_0_r:
  s_add_u32 s50, s50, 1
  s_cmp_ge_u32 s50, 262144
  s_cbranch_scc1 L_ffn_f2_0_x
  buffer_load_dwordx2 v[26:27], v17, s[4:7], s34 offen sc1
  s_add_u32 s51, s41, 0
  buffer_load_dwordx4 v[32:35], v16, s[4:7], s51 offen sc1
  s_add_u32 s51, s41, 4096
  buffer_load_dwordx4 v[36:39], v16, s[4:7], s51 offen sc1
  s_add_u32 s51, s41, 8192
  buffer_load_dwordx4 v[40:43], v16, s[4:7], s51 offen sc1
  s_add_u32 s51, s41, 12288
  buffer_load_dwordx4 v[44:47], v16, s[4:7], s51 offen sc1
  s_add_u32 s51, s41, 16384
  buffer_load_dwordx4 v[48:51], v16, s[4:7], s51 offen sc1
  s_add_u32 s51, s41, 20480
  buffer_load_dwordx4 v[52:55], v16, s[4:7], s51 offen sc1
  s_add_u32 s51, s41, 24576
  buffer_load_dwordx4 v[56:59], v16, s[4:7], s51 offen sc1
  s_add_u32 s51, s41, 28672
  buffer_load_dwordx4 v[60:63], v16, s[4:7], s51 offen sc1
  s_add_u32 s51, s41, 32768
  buffer_load_dwordx4 v[64:67], v16, s[4:7], s51 offen sc1
  s_branch L_ffn_f2_0
L_ffn_f2_0_x:
  v_lshlrev_b32 v68, 16, v26
  v_and_b32 v69, 0xffff0000, v26
  v_lshlrev_b32 v70, 16, v27
  v_and_b32 v71, 0xffff0000, v27
  s_nop 1
  v_mfma_f32_16x16x32_bf16 v[68:71], v[28:31], v[32:35], v[68:71]
  v_mfma_f32_16x16x32_bf16 v[68:71], v[28:31], v[36:39], v[68:71]
  v_mfma_f32_16x16x32_bf16 v[68:71], v[28:31], v[40:43], v[68:71]
L_ffn_f2_1:
  s_waitcnt vmcnt(3)
  v_bitop3_b32 v20, v44, v46, s60 bitop3:0x7e
  v_bitop3_b32 v21, v48, v50, s60 bitop3:0x7e
  v_bitop3_b32 v22, v52, v54, s60 bitop3:0x7e
  v_or3_b32 v20, v20, v21, v22
  v_and_b32 v20, 1, v20
  v_cmp_eq_u32 vcc, 1, v20
  s_nop 0
  s_cbranch_vccz L_ffn_f2_1_x
L_ffn_f2_1_r:
  s_add_u32 s50, s50, 1
  s_cmp_ge_u32 s50, 262144
  s_cbranch_scc1 L_ffn_f2_1_x
  s_add_u32 s51, s41, 12288
  buffer_load_dwordx4 v[44:47], v16, s[4:7], s51 offen sc1
  s_add_u32 s51, s41, 16384
  buffer_load_dwordx4 v[48:51], v16, s[4:7], s51 offen sc1
  s_add_u32 s51, s41, 20480
  buffer_load_dwordx4 v[52:55], v16, s[4:7], s51 offen sc1
  s_add_u32 s51, s41, 24576
  buffer_load_dwordx4 v[56:59], v16, s[4:7], s51 offen sc1
  s_add_u32 s51, s41, 28672
  buffer_load_dwordx4 v[60:63], v16, s[4:7], s51 offen sc1
  s_add_u32 s51, s41, 32768
  buffer_load_dwordx4 v[64:67], v16, s[4:7], s51 offen sc1
  s_branch L_ffn_f2_1
L_ffn_f2_1_x:
  v_mfma_f32_16x16x32_bf16 v[68:71], v[28:31], v[44:47], v[68:71]
  v_mfma_f32_16x16x32_bf16 v[68:71], v[28:31], v[48:51], v[68:71]
  v_mfma_f32_16x16x32_bf16 v[68:71], v[28:31], v[52:55], v[68:71]
L_ffn_f2_2:
  s_waitcnt vmcnt(0)
  v_bitop3_b32 v20, v56, v58, s60 bitop3:0x7e
  v_bitop3_b32 v21, v60, v62, s60 bitop3:0x7e
  v_bitop3_b32 v22, v64, v66, s60 bitop3:0x7e
  v_or3_b32 v20, v20, v21, v22
  v_and_b32 v20, 1, v20
  v_cmp_eq_u32_e64 vcc, 1, v20
  s_nop 0
  s_cbranch_vccz L_ffn_f2_2_x
L_ffn_f2_2_r:
  s_add_u32 s50, s50, 1
  s_cmp_ge_u32 s50, 262144
  s_cbranch_scc1 L_ffn_f2_2_x
  s_add_u32 s51, s41, 24576
  buffer_load_dwordx4 v[56:59], v16, s[4:7], s51 offen sc1
  s_add_u32 s51, s41, 28672
  buffer_load_dwordx4 v[60:63], v16, s[4:7], s51 offen sc1
  s_add_u32 s51, s41, 32768
  buffer_load_dwordx4 v[64:67], v16, s[4:7], s51 offen sc1
  s_branch L_ffn_f2_2
L_ffn_f2_2_x:
  v_mfma_f32_16x16x32_bf16 v[68:71], v[28:31], v[56:59], v[68:71]
  v_mfma_f32_16x16x32_bf16 v[68:71], v[28:31], v[60:63], v[68:71]
  v_mfma_f32_16x16x32_bf16 v[68:71], v[28:31], v[64:67], v[68:71]
L_ffn_l2_out:
  s_nop 7
  v_cvt_pk_bf16_f32 v68, v68, v69
  v_cvt_pk_bf16_f32 v69, v70, v71
  buffer_store_dwordx2 v[68:69], v17, s[24:27], s45 offen
  s_mov_b32 s40, s49
  s_add_u32 s95, s95, 1
  s_cmp_lt_u32 s40, 64
  s_cbranch_scc1 L_ffn_l2
  s_endpgm
L_ffn_w3:
  s_waitcnt vmcnt(27)
  s_barrier
  ds_read_b64_tr_b16 a[112:113], v25 offset:896
  ds_read_b64_tr_b16 a[114:115], v25 offset:10112
  ds_read_b64_tr_b16 a[128:129], v25 offset:904
  ds_read_b64_tr_b16 a[130:131], v25 offset:10120
  ds_read_b64_tr_b16 a[144:145], v25 offset:960
  ds_read_b64_tr_b16 a[146:147], v25 offset:10176
  ds_read_b64_tr_b16 a[160:161], v25 offset:968
  ds_read_b64_tr_b16 a[162:163], v25 offset:10184
  ds_read_b64_tr_b16 a[176:177], v25 offset:1024
  ds_read_b64_tr_b16 a[178:179], v25 offset:10240
  ds_read_b64_tr_b16 a[192:193], v25 offset:1032
  ds_read_b64_tr_b16 a[194:195], v25 offset:10248
  ds_read_b64_tr_b16 a[208:209], v25 offset:1088
  ds_read_b64_tr_b16 a[210:211], v25 offset:10304
  ds_read_b64_tr_b16 a[224:225], v25 offset:1096
  ds_read_b64_tr_b16 a[226:227], v25 offset:10312
  ds_read_b64_tr_b16 a[240:241], v25 offset:840
  ds_read_b64_tr_b16 a[242:243], v25 offset:10056
  s_waitcnt vmcnt(18)
  s_barrier
  ds_read_b64_tr_b16 a[116:117], v25 offset:37760
  ds_read_b64_tr_b16 a[118:119], v25 offset:46976
  ds_read_b64_tr_b16 a[132:133], v25 offset:37768
  ds_read_b64_tr_b16 a[134:135], v25 offset:46984
  ds_read_b64_tr_b16 a[148:149], v25 offset:37824
  ds_read_b64_tr_b16 a[150:151], v25 offset:47040
  ds_read_b64_tr_b16 a[164:165], v25 offset:37832
  ds_read_b64_tr_b16 a[166:167], v25 offset:47048
  ds_read_b64_tr_b16 a[180:181], v25 offset:37888
  ds_read_b64_tr_b16 a[182:183], v25 offset:47104
  ds_read_b64_tr_b16 a[196:197], v25 offset:37896
  ds_read_b64_tr_b16 a[198:199], v25 offset:47112
  ds_read_b64_tr_b16 a[212:213], v25 offset:37952
  ds_read_b64_tr_b16 a[214:215], v25 offset:47168
  ds_read_b64_tr_b16 a[228:229], v25 offset:37960
  ds_read_b64_tr_b16 a[230:231], v25 offset:47176
  ds_read_b64_tr_b16 a[244:245], v25 offset:37704
  ds_read_b64_tr_b16 a[246:247], v25 offset:46920
  s_waitcnt vmcnt(9)
  s_barrier
  ds_read_b64_tr_b16 a[120:121], v26 offset:896
  ds_read_b64_tr_b16 a[122:123], v26 offset:10112
  ds_read_b64_tr_b16 a[136:137], v26 offset:904
  ds_read_b64_tr_b16 a[138:139], v26 offset:10120
  ds_read_b64_tr_b16 a[152:153], v26 offset:960
  ds_read_b64_tr_b16 a[154:155], v26 offset:10176
  ds_read_b64_tr_b16 a[168:169], v26 offset:968
  ds_read_b64_tr_b16 a[170:171], v26 offset:10184
  ds_read_b64_tr_b16 a[184:185], v26 offset:1024
  ds_read_b64_tr_b16 a[186:187], v26 offset:10240
  ds_read_b64_tr_b16 a[200:201], v26 offset:1032
  ds_read_b64_tr_b16 a[202:203], v26 offset:10248
  ds_read_b64_tr_b16 a[216:217], v26 offset:1088
  ds_read_b64_tr_b16 a[218:219], v26 offset:10304
  ds_read_b64_tr_b16 a[232:233], v26 offset:1096
  ds_read_b64_tr_b16 a[234:235], v26 offset:10312
  ds_read_b64_tr_b16 a[248:249], v26 offset:840
  ds_read_b64_tr_b16 a[250:251], v26 offset:10056
  s_waitcnt vmcnt(0)
  s_barrier
  ds_read_b64_tr_b16 a[124:125], v26 offset:37760
  ds_read_b64_tr_b16 a[126:127], v26 offset:46976
  ds_read_b64_tr_b16 a[140:141], v26 offset:37768
  ds_read_b64_tr_b16 a[142:143], v26 offset:46984
  ds_read_b64_tr_b16 a[156:157], v26 offset:37824
  ds_read_b64_tr_b16 a[158:159], v26 offset:47040
  ds_read_b64_tr_b16 a[172:173], v26 offset:37832
  ds_read_b64_tr_b16 a[174:175], v26 offset:47048
  ds_read_b64_tr_b16 a[188:189], v26 offset:37888
  ds_read_b64_tr_b16 a[190:191], v26 offset:47104
  ds_read_b64_tr_b16 a[204:205], v26 offset:37896
  ds_read_b64_tr_b16 a[206:207], v26 offset:47112
  ds_read_b64_tr_b16 a[220:221], v26 offset:37952
  ds_read_b64_tr_b16 a[222:223], v26 offset:47168
  ds_read_b64_tr_b16 a[236:237], v26 offset:37960
  ds_read_b64_tr_b16 a[238:239], v26 offset:47176
  ds_read_b64_tr_b16 a[252:253], v26 offset:37704
  ds_read_b64_tr_b16 a[254:255], v26 offset:46920
  s_waitcnt lgkmcnt(0)
  s_mul_i32 s34, s44, 2654208
  s_mul_i32 s35, s43, 36864
  s_add_u32 s34, s34, s35
  v_mov_b64 v[32:33], -1
  v_mov_b64 v[34:35], -1
  s_add_u32 s51, s34, 75525120
  buffer_store_dwordx4 v[32:35], v14, s[4:7], s51 offen offset:0 sc1
  buffer_store_dwordx4 v[32:35], v14, s[4:7], s51 offen offset:1024 sc1
  buffer_store_dwordx4 v[32:35], v14, s[4:7], s51 offen offset:2048 sc1
  buffer_store_dwordx4 v[32:35], v14, s[4:7], s51 offen offset:3072 sc1
  s_add_u32 s51, s34, 75529216
  buffer_store_dwordx4 v[32:35], v14, s[4:7], s51 offen offset:0 sc1
  buffer_store_dwordx4 v[32:35], v14, s[4:7], s51 offen offset:1024 sc1
  buffer_store_dwordx4 v[32:35], v14, s[4:7], s51 offen offset:2048 sc1
  buffer_store_dwordx4 v[32:35], v14, s[4:7], s51 offen offset:3072 sc1
  s_add_u32 s51, s34, 75533312
  buffer_store_dwordx4 v[32:35], v14, s[4:7], s51 offen offset:0 sc1
  s_add_u32 s51, s34, 76852224
  buffer_store_dwordx4 v[32:35], v14, s[4:7], s51 offen offset:0 sc1
  buffer_store_dwordx4 v[32:35], v14, s[4:7], s51 offen offset:1024 sc1
  buffer_store_dwordx4 v[32:35], v14, s[4:7], s51 offen offset:2048 sc1
  buffer_store_dwordx4 v[32:35], v14, s[4:7], s51 offen offset:3072 sc1
  s_add_u32 s51, s34, 76856320
  buffer_store_dwordx4 v[32:35], v14, s[4:7], s51 offen offset:0 sc1
  buffer_store_dwordx4 v[32:35], v14, s[4:7], s51 offen offset:1024 sc1
  buffer_store_dwordx4 v[32:35], v14, s[4:7], s51 offen offset:2048 sc1
  buffer_store_dwordx4 v[32:35], v14, s[4:7], s51 offen offset:3072 sc1
  s_add_u32 s51, s34, 76860416
  buffer_store_dwordx4 v[32:35], v14, s[4:7], s51 offen offset:0 sc1
  s_cmp_lg_u32 s44, 3
  s_cbranch_scc1 L_f4_71
  s_waitcnt vmcnt(0)
  s_barrier
  s_cmp_lg_u32 s33, 0
  s_cbranch_scc1 L_meet_72
  v_mov_b32 v20, 1
  s_mov_b64 exec, 1
  buffer_atomic_add v20, off, s[8:11], 0 offset:64 sc0
  s_waitcnt vmcnt(0)
  v_readfirstlane_b32 s51, v20
  v_mov_b32 v20, 1
  s_cmp_lg_u32 s51, 35
  s_cbranch_scc1 L_cnt_73
  buffer_store_dword v20, off, s[8:11], 0 offset:156 sc1
L_cnt_73:
  s_mov_b64 exec, -1
L_f4_74:
  buffer_load_dword v20, off, s[8:11], 0 offset:156 sc1
  s_add_u32 s50, s50, 1
  s_cmp_ge_u32 s50, 262144
  s_waitcnt vmcnt(0)
  s_cbranch_scc1 L_f4_74_x
  v_cmp_ge_u32 vcc, 0, v20
  s_nop 0
  s_cbranch_vccnz L_f4_74
L_f4_74_x:
L_f4_75:
  buffer_load_dword v20, off, s[8:11], 0 offset:144 sc1
  s_add_u32 s50, s50, 1
  s_cmp_ge_u32 s50, 262144
  s_waitcnt vmcnt(0)
  s_cbranch_scc1 L_f4_75_x
  v_cmp_ge_u32 vcc, 0, v20
  s_nop 0
  s_cbranch_vccnz L_f4_75
L_f4_75_x:
L_meet_72:
  s_barrier
  s_mov_b32 s40, 57
  s_branch L_f4_71_x
L_f4_71:
  s_waitcnt vmcnt(0)
  s_barrier
  s_cmp_lg_u32 s33, 0
  s_cbranch_scc1 L_meet_76
  v_mov_b32 v20, 1
  s_mov_b64 exec, 1
  buffer_atomic_add v20, off, s[8:11], 0 offset:28 sc0
  s_waitcnt vmcnt(0)
  v_readfirstlane_b32 s51, v20
  v_mov_b32 v20, 1
  s_cmp_lg_u32 s51, 107
  s_cbranch_scc1 L_cnt_77
  buffer_store_dword v20, off, s[8:11], 0 offset:148 sc1
L_cnt_77:
  s_mov_b64 exec, -1
L_fi_78:
  buffer_load_dword v20, off, s[8:11], 0 offset:148 sc1
  s_add_u32 s50, s50, 1
  s_cmp_ge_u32 s50, 262144
  s_waitcnt vmcnt(0)
  s_cbranch_scc1 L_fi_78_x
  v_cmp_ge_u32 vcc, 0, v20
  s_nop 0
  s_cbranch_vccnz L_fi_78
L_fi_78_x:
L_fi_79:
  buffer_load_dword v20, off, s[8:11], 0 offset:144 sc1
  s_add_u32 s50, s50, 1
  s_cmp_ge_u32 s50, 262144
  s_waitcnt vmcnt(0)
  s_cbranch_scc1 L_fi_79_x
  v_cmp_ge_u32 vcc, 0, v20
  s_nop 0
  s_cbranch_vccnz L_fi_79
L_fi_79_x:
L_meet_76:
  s_barrier
  s_mov_b32 s40, s44
L_f4_71_x:
  s_mov_b32 s95, 0
  s_mov_b32 s48, 0
  v_min_u32 v19, 7, v0
  v_mul_u32_u24 v19, 1152, v19
  v_bfe_u32 v20, v0, 4, 1
  v_lshlrev_b32 v20, 10, v20
  v_lshrrev_b32 v21, 5, v0
  v_lshl_add_u32 v20, v21, 8, v20
  v_and_b32 v21, 15, v0
  v_lshl_add_u32 v24, v21, 4, v20
.p2align 5
L_ffn_l3:
  s_mul_i32 s45, s40, 36864
  s_add_u32 s35, s45, 7340032
  s_add_u32 s34, s45, 4221952
  s_bfe_u32 s60, s95, 0x10001
  s_and_b32 s41, s95, 1
  s_lshl1_add_u32 s41, s44, s41
  s_mul_i32 s41, s41, 1327104
  s_add_u32 s41, s41, 75497472
  s_cmp_ge_u32 s40, 54
  s_addc_u32 s49, s40, 3
  s_cmp_eq_u32 s48, 0
  s_cbranch_scc1 L_ffn_l3_reg
  s_waitcnt vmcnt(1)
  ds_read_b128 v[32:35], v18 offset:0
  ds_read_b128 v[36:39], v18 offset:1024
  ds_read_b128 v[40:43], v18 offset:2048
  ds_read_b128 v[44:47], v18 offset:3072
  ds_read_b128 v[48:51], v18 offset:4096
  ds_read_b128 v[52:55], v18 offset:5120
  ds_read_b128 v[56:59], v18 offset:6144
  ds_read_b128 v[60:63], v18 offset:7168
  ds_read_b128 v[64:67], v18 offset:8192
  s_waitcnt lgkmcnt(8)
  v_max_u32 v20, v32, v34
  s_waitcnt lgkmcnt(7)
  v_max3_u32 v20, v20, v36, v38
  s_waitcnt lgkmcnt(6)
  v_max3_u32 v20, v20, v40, v42
  s_waitcnt lgkmcnt(5)
  v_max3_u32 v20, v20, v44, v46
  s_waitcnt lgkmcnt(4)
  v_max3_u32 v20, v20, v48, v50
  s_waitcnt lgkmcnt(3)
  v_max3_u32 v20, v20, v52, v54
  s_waitcnt lgkmcnt(2)
  v_max3_u32 v20, v20, v56, v58
  s_waitcnt lgkmcnt(1)
  v_max3_u32 v20, v20, v60, v62
  s_waitcnt lgkmcnt(0)
  v_max3_u32 v20, v20, v64, v66
  v_cmp_eq_u32 vcc, -1, v20
  s_nop 0
  s_cbranch_vccz L_ffn_l3_xok
L_ffn_l3_reg:
  s_cmp_ge_u32 s40, 63
  s_cbranch_scc1 L_ffn_l3_p_x
L_ffn_l3_p:
  buffer_load_dword v20, v19, s[4:7], s34 offen sc1
  s_add_u32 s50, s50, 1
  s_cmp_ge_u32 s50, 262144
  s_waitcnt vmcnt(0)
  s_cbranch_scc1 L_ffn_l3_p_x
  v_cmp_eq_u32 vcc, -1, v20
  s_nop 0
  s_cbranch_vccnz L_ffn_l3_p
L_ffn_l3_p_x:
  buffer_load_dwordx4 v[32:35], v1, s[4:7], s35 offen sc1
  buffer_load_dwordx4 v[36:39], v2, s[4:7], s35 offen sc1
  buffer_load_dwordx4 v[40:43], v3, s[4:7], s35 offen sc1
  buffer_load_dwordx4 v[44:47], v4, s[4:7], s35 offen sc1
  buffer_load_dwordx4 v[48:51], v5, s[4:7], s35 offen sc1
  buffer_load_dwordx4 v[52:55], v6, s[4:7], s35 offen sc1
  buffer_load_dwordx4 v[56:59], v7, s[4:7], s35 offen sc1
  buffer_load_dwordx4 v[60:63], v8, s[4:7], s35 offen sc1
  buffer_load_dwordx4 v[64:67], v9, s[4:7], s35 offen sc1
L_ffn_x3_0:
  s_waitcnt vmcnt(8)
  ds_write_b128 v18, v[32:35] offset:0
  v_max_u32 v20, v32, v34
  s_waitcnt vmcnt(7)
  ds_write_b128 v18, v[36:39] offset:1024
  v_max3_u32 v20, v20, v36, v38
  s_waitcnt vmcnt(6)
  ds_write_b128 v18, v[40:43] offset:2048
  v_max3_u32 v20, v20, v40, v42
  v_cmp_eq_u32 vcc, -1, v20
  s_nop 0
  s_cbranch_vccz L_ffn_x3_0_x
  s_add_u32 s50, s50, 1
  s_cmp_ge_u32 s50, 262144
  s_cbranch_scc1 L_ffn_x3_0_x
  s_waitcnt lgkmcnt(0)
  buffer_load_dwordx4 v[32:35], v1, s[4:7], s35 offen sc1
  buffer_load_dwordx4 v[36:39], v2, s[4:7], s35 offen sc1
  buffer_load_dwordx4 v[40:43], v3, s[4:7], s35 offen sc1
  buffer_load_dwordx4 v[44:47], v4, s[4:7], s35 offen sc1
  buffer_load_dwordx4 v[48:51], v5, s[4:7], s35 offen sc1
  buffer_load_dwordx4 v[52:55], v6, s[4:7], s35 offen sc1
  buffer_load_dwordx4 v[56:59], v7, s[4:7], s35 offen sc1
  buffer_load_dwordx4 v[60:63], v8, s[4:7], s35 offen sc1
  buffer_load_dwordx4 v[64:67], v9, s[4:7], s35 offen sc1
  s_branch L_ffn_x3_0
L_ffn_x3_0_x:
L_ffn_x3_1:
  s_waitcnt vmcnt(5)
  ds_write_b128 v18, v[44:47] offset:3072
  v_max_u32 v20, v44, v46
  s_waitcnt vmcnt(4)
  ds_write_b128 v18, v[48:51] offset:4096
  v_max3_u32 v20, v20, v48, v50
  s_waitcnt vmcnt(3)
  ds_write_b128 v18, v[52:55] offset:5120
  v_max3_u32 v20, v20, v52, v54
  v_cmp_eq_u32 vcc, -1, v20
  s_nop 0
  s_cbranch_vccz L_ffn_x3_1_x
  s_add_u32 s50, s50, 1
  s_cmp_ge_u32 s50, 262144
  s_cbranch_scc1 L_ffn_x3_1_x
  s_waitcnt lgkmcnt(0)
  buffer_load_dwordx4 v[44:47], v4, s[4:7], s35 offen sc1
  buffer_load_dwordx4 v[48:51], v5, s[4:7], s35 offen sc1
  buffer_load_dwordx4 v[52:55], v6, s[4:7], s35 offen sc1
  buffer_load_dwordx4 v[56:59], v7, s[4:7], s35 offen sc1
  buffer_load_dwordx4 v[60:63], v8, s[4:7], s35 offen sc1
  buffer_load_dwordx4 v[64:67], v9, s[4:7], s35 offen sc1
  s_branch L_ffn_x3_1
L_ffn_x3_1_x:
L_ffn_x3_2:
  s_waitcnt vmcnt(2)
  ds_write_b128 v18, v[56:59] offset:6144
  v_max_u32 v20, v56, v58
  s_waitcnt vmcnt(1)
  ds_write_b128 v18, v[60:63] offset:7168
  v_max3_u32 v20, v20, v60, v62
  s_waitcnt vmcnt(0)
  ds_write_b128 v18, v[64:67] offset:8192
  v_max3_u32 v20, v20, v64, v66
  v_cmp_eq_u32 vcc, -1, v20
  s_nop 0
  s_cbranch_vccz L_ffn_x3_2_x
  s_add_u32 s50, s50, 1
  s_cmp_ge_u32 s50, 262144
  s_cbranch_scc1 L_ffn_x3_2_x
  s_waitcnt lgkmcnt(0)
  buffer_load_dwordx4 v[56:59], v7, s[4:7], s35 offen sc1
  buffer_load_dwordx4 v[60:63], v8, s[4:7], s35 offen sc1
  buffer_load_dwordx4 v[64:67], v9, s[4:7], s35 offen sc1
  s_branch L_ffn_x3_2
L_ffn_x3_2_x:
  s_waitcnt lgkmcnt(0)
L_ffn_l3_xok:
  s_barrier
  ds_read_b128 v[64:67], v10 offset:0
  ds_read_b128 v[68:71], v11 offset:0
  ds_read_b128 v[72:75], v12 offset:0
  s_add_u32 s34, s45, 4194304
  s_waitcnt lgkmcnt(2)
  v_mfma_f32_32x32x16_bf16 v[32:47], v[80:83], v[64:67], 0
  ds_read_b128 v[76:79], v13 offset:0
  v_mfma_f32_32x32x16_bf16 v[48:63], v[84:87], v[64:67], 0
  s_waitcnt lgkmcnt(2)
  v_mfma_f32_32x32x16_bf16 v[32:47], v[88:91], v[68:71], v[32:47]
  ds_read_b128 v[64:67], v10 offset:128
  v_mfma_f32_32x32x16_bf16 v[48:63], v[92:95], v[68:71], v[48:63]
  s_waitcnt lgkmcnt(2)
  v_mfma_f32_32x32x16_bf16 v[32:47], v[96:99], v[72:75], v[32:47]
  ds_read_b128 v[68:71], v11 offset:128
  v_mfma_f32_32x32x16_bf16 v[48:63], v[100:103], v[72:75], v[48:63]
  s_waitcnt lgkmcnt(2)
  v_mfma_f32_32x32x16_bf16 v[32:47], v[104:107], v[76:79], v[32:47]
  ds_read_b128 v[72:75], v12 offset:128
  v_mfma_f32_32x32x16_bf16 v[48:63], v[108:111], v[76:79], v[48:63]
  s_waitcnt lgkmcnt(2)
  v_mfma_f32_32x32x16_bf16 v[32:47], v[112:115], v[64:67], v[32:47]
  ds_read_b128 v[76:79], v13 offset:128
  v_mfma_f32_32x32x16_bf16 v[48:63], v[116:119], v[64:67], v[48:63]
  s_waitcnt lgkmcnt(2)
  v_mfma_f32_32x32x16_bf16 v[32:47], v[120:123], v[68:71], v[32:47]
  ds_read_b128 v[64:67], v10 offset:256
  v_mfma_f32_32x32x16_bf16 v[48:63], v[124:127], v[68:71], v[48:63]
  s_waitcnt lgkmcnt(2)
  v_mfma_f32_32x32x16_bf16 v[32:47], v[128:131], v[72:75], v[32:47]
  ds_read_b128 v[68:71], v11 offset:256
  v_mfma_f32_32x32x16_bf16 v[48:63], v[132:135], v[72:75], v[48:63]
  s_waitcnt lgkmcnt(2)
  v_mfma_f32_32x32x16_bf16 v[32:47], v[136:139], v[76:79], v[32:47]
  ds_read_b128 v[72:75], v12 offset:256
  v_mfma_f32_32x32x16_bf16 v[48:63], v[140:143], v[76:79], v[48:63]
  s_waitcnt lgkmcnt(2)
  v_mfma_f32_32x32x16_bf16 v[32:47], v[144:147], v[64:67], v[32:47]
  ds_read_b128 v[76:79], v13 offset:256
  v_mfma_f32_32x32x16_bf16 v[48:63], v[148:151], v[64:67], v[48:63]
  buffer_load_dwordx2 v[26:27], v17, s[4:7], s34 offen sc1
  s_waitcnt lgkmcnt(2)
  v_mfma_f32_32x32x16_bf16 v[32:47], v[152:155], v[68:71], v[32:47]
  ds_read_b128 v[64:67], v10 offset:384
  v_mfma_f32_32x32x16_bf16 v[48:63], v[156:159], v[68:71], v[48:63]
  s_waitcnt lgkmcnt(2)
  v_mfma_f32_32x32x16_bf16 v[32:47], v[160:163], v[72:75], v[32:47]
  ds_read_b128 v[68:71], v11 offset:384
  v_mfma_f32_32x32x16_bf16 v[48:63], v[164:167], v[72:75], v[48:63]
  s_waitcnt lgkmcnt(2)
  v_mfma_f32_32x32x16_bf16 v[32:47], v[168:171], v[76:79], v[32:47]
  ds_read_b128 v[72:75], v12 offset:384
  v_mfma_f32_32x32x16_bf16 v[48:63], v[172:175], v[76:79], v[48:63]
  s_waitcnt lgkmcnt(2)
  v_mfma_f32_32x32x16_bf16 v[32:47], v[176:179], v[64:67], v[32:47]
  ds_read_b128 v[76:79], v13 offset:384
  v_mfma_f32_32x32x16_bf16 v[48:63], v[180:183], v[64:67], v[48:63]
  s_waitcnt lgkmcnt(2)
  v_mfma_f32_32x32x16_bf16 v[32:47], v[184:187], v[68:71], v[32:47]
  ds_read_b128 v[64:67], v10 offset:512
  v_mfma_f32_32x32x16_bf16 v[48:63], v[188:191], v[68:71], v[48:63]
  s_waitcnt lgkmcnt(2)
  v_mfma_f32_32x32x16_bf16 v[32:47], v[192:195], v[72:75], v[32:47]
  ds_read_b128 v[68:71], v11 offset:512
  v_mfma_f32_32x32x16_bf16 v[48:63], v[196:199], v[72:75], v[48:63]
  s_waitcnt lgkmcnt(2)
  v_mfma_f32_32x32x16_bf16 v[32:47], v[200:203], v[76:79], v[32:47]
  ds_read_b128 v[72:75], v12 offset:512
  v_mfma_f32_32x32x16_bf16 v[48:63], v[204:207], v[76:79], v[48:63]
  s_waitcnt lgkmcnt(2)
  v_mfma_f32_32x32x16_bf16 v[32:47], v[208:211], v[64:67], v[32:47]
  ds_read_b128 v[76:79], v13 offset:512
  v_mfma_f32_32x32x16_bf16 v[48:63], v[212:215], v[64:67], v[48:63]
  s_waitcnt lgkmcnt(2)
  v_mfma_f32_32x32x16_bf16 v[32:47], v[216:219], v[68:71], v[32:47]
  ds_read_b128 v[64:67], v10 offset:640
  v_mfma_f32_32x32x16_bf16 v[48:63], v[220:223], v[68:71], v[48:63]
  s_waitcnt lgkmcnt(2)
  v_mfma_f32_32x32x16_bf16 v[32:47], v[224:227], v[72:75], v[32:47]
  ds_read_b128 v[68:71], v11 offset:640
  v_mfma_f32_32x32x16_bf16 v[48:63], v[228:231], v[72:75], v[48:63]
  s_waitcnt lgkmcnt(2)
  v_mfma_f32_32x32x16_bf16 v[32:47], v[232:235], v[76:79], v[32:47]
  ds_read_b128 v[72:75], v12 offset:640
  v_mfma_f32_32x32x16_bf16 v[48:63], v[236:239], v[76:79], v[48:63]
  s_waitcnt lgkmcnt(2)
  v_mfma_f32_32x32x16_bf16 v[32:47], v[240:243], v[64:67], v[32:47]
  ds_read_b128 v[76:79], v13 offset:640
  v_mfma_f32_32x32x16_bf16 v[48:63], v[244:247], v[64:67], v[48:63]
  s_waitcnt lgkmcnt(2)
  v_mfma_f32_32x32x16_bf16 v[32:47], v[248:251], v[68:71], v[32:47]
  ds_read_b128 v[64:67], v10 offset:768
  v_mfma_f32_32x32x16_bf16 v[48:63], v[252:255], v[68:71], v[48:63]
  s_waitcnt lgkmcnt(2)
  v_mfma_f32_32x32x16_bf16 v[32:47], a[0:3], v[72:75], v[32:47]
  ds_read_b128 v[68:71], v11 offset:768
  v_mfma_f32_32x32x16_bf16 v[48:63], a[4:7], v[72:75], v[48:63]
  s_waitcnt lgkmcnt(2)
  v_mfma_f32_32x32x16_bf16 v[32:47], a[8:11], v[76:79], v[32:47]
  ds_read_b128 v[72:75], v12 offset:768
  v_mfma_f32_32x32x16_bf16 v[48:63], a[12:15], v[76:79], v[48:63]
  s_waitcnt lgkmcnt(2)
  v_mfma_f32_32x32x16_bf16 v[32:47], a[16:19], v[64:67], v[32:47]
  ds_read_b128 v[76:79], v13 offset:768
  v_mfma_f32_32x32x16_bf16 v[48:63], a[20:23], v[64:67], v[48:63]
  s_waitcnt lgkmcnt(2)
  v_mfma_f32_32x32x16_bf16 v[32:47], a[24:27], v[68:71], v[32:47]
  ds_read_b128 v[64:67], v10 offset:896
  v_mfma_f32_32x32x16_bf16 v[48:63], a[28:31], v[68:71], v[48:63]
  s_waitcnt lgkmcnt(2)
  v_mfma_f32_32x32x16_bf16 v[32:47], a[32:35], v[72:75], v[32:47]
  ds_read_b128 v[68:71], v11 offset:896
  v_mfma_f32_32x32x16_bf16 v[48:63], a[36:39], v[72:75], v[48:63]
  s_waitcnt lgkmcnt(2)
  v_mfma_f32_32x32x16_bf16 v[32:47], a[40:43], v[76:79], v[32:47]
  ds_read_b128 v[72:75], v12 offset:896
  v_mfma_f32_32x32x16_bf16 v[48:63], a[44:47], v[76:79], v[48:63]
  s_waitcnt lgkmcnt(2)
  v_mfma_f32_32x32x16_bf16 v[32:47], a[48:51], v[64:67], v[32:47]
  ds_read_b128 v[76:79], v13 offset:896
  v_mfma_f32_32x32x16_bf16 v[48:63], a[52:55], v[64:67], v[48:63]
  s_waitcnt lgkmcnt(2)
  v_mfma_f32_32x32x16_bf16 v[32:47], a[56:59], v[68:71], v[32:47]
  ds_read_b128 v[64:67], v10 offset:1024
  v_mfma_f32_32x32x16_bf16 v[48:63], a[60:63], v[68:71], v[48:63]
  s_waitcnt lgkmcnt(2)
  v_mfma_f32_32x32x16_bf16 v[32:47], a[64:67], v[72:75], v[32:47]
  ds_read_b128 v[68:71], v11 offset:1024
  v_mfma_f32_32x32x16_bf16 v[48:63], a[68:71], v[72:75], v[48:63]
  s_waitcnt lgkmcnt(2)
  v_mfma_f32_32x32x16_bf16 v[32:47], a[72:75], v[76:79], v[32:47]
  ds_read_b128 v[72:75], v12 offset:1024
  v_mfma_f32_32x32x16_bf16 v[48:63], a[76:79], v[76:79], v[48:63]
  s_waitcnt lgkmcnt(2)
  v_mfma_f32_32x32x16_bf16 v[32:47], a[80:83], v[64:67], v[32:47]
  ds_read_b128 v[76:79], v13 offset:1024
  v_mfma_f32_32x32x16_bf16 v[48:63], a[84:87], v[64:67], v[48:63]
  s_waitcnt lgkmcnt(2)
  v_mfma_f32_32x32x16_bf16 v[32:47], a[88:91], v[68:71], v[32:47]
  v_mfma_f32_32x32x16_bf16 v[48:63], a[92:95], v[68:71], v[48:63]
  s_waitcnt lgkmcnt(1)
  v_mfma_f32_32x32x16_bf16 v[32:47], a[96:99], v[72:75], v[32:47]
  v_mfma_f32_32x32x16_bf16 v[48:63], a[100:103], v[72:75], v[48:63]
  s_waitcnt lgkmcnt(0)
  v_mfma_f32_32x32x16_bf16 v[32:47], a[104:107], v[76:79], v[32:47]
  v_mfma_f32_32x32x16_bf16 v[48:63], a[108:111], v[76:79], v[48:63]
  s_nop 4
  v_max_f32_e64 v32, 0, v32
  v_max_f32_e64 v33, 0, v33
  v_max_f32 v34, 0, v34
  v_max_f32 v35, 0, v35
  v_max_f32_e64 v36, 0, v36
  v_max_f32_e64 v37, 0, v37
  v_max_f32_e64 v38, 0, v38
  v_max_f32 v39, 0, v39
  v_max_f32 v40, 0, v40
  v_max_f32 v41, 0, v41
  v_max_f32 v42, 0, v42
  v_max_f32_e64 v43, 0, v43
  v_max_f32_e64 v44, 0, v44
  v_max_f32 v45, 0, v45
  v_max_f32 v46, 0, v46
  v_max_f32 v47, 0, v47
  v_pk_mul_f32 v[32:33], v[32:33], v[48:49]
  v_pk_mul_f32 v[34:35], v[34:35], v[50:51]
  v_pk_mul_f32 v[36:37], v[36:37], v[52:53]
  v_pk_mul_f32 v[38:39], v[38:39], v[54:55]
  v_cvt_pk_bf16_f32 v32, v32, v33
  v_cvt_pk_bf16_f32 v33, v34, v35
  v_cvt_pk_bf16_f32 v34, v36, v37
  v_cvt_pk_bf16_f32 v35, v38, v39
  ds_write_b128 v24, v[32:35] offset:47104
  v_pk_mul_f32 v[40:41], v[40:41], v[56:57]
  v_pk_mul_f32 v[42:43], v[42:43], v[58:59]
  v_pk_mul_f32 v[44:45], v[44:45], v[60:61]
  v_pk_mul_f32 v[46:47], v[46:47], v[62:63]
  v_cvt_pk_bf16_f32 v40, v40, v41
  v_cvt_pk_bf16_f32 v41, v42, v43
  v_cvt_pk_bf16_f32 v42, v44, v45
  v_cvt_pk_bf16_f32 v43, v46, v47
  ds_write_b128 v24, v[40:43] offset:47616
  s_waitcnt lgkmcnt(0)
  s_barrier
  ds_read_b128 v[32:35], v14 offset:40960
  ds_read_b128 v[36:39], v14 offset:41984
  ds_read_b128 v[40:43], v14 offset:43008
  ds_read_b128 v[44:47], v14 offset:44032
  ds_read_b128 v[48:51], v14 offset:45056
  ds_read_b128 v[52:55], v14 offset:46080
  ds_read_b128 v[56:59], v14 offset:47104
  ds_read_b128 v[60:63], v14 offset:48128
  s_waitcnt lgkmcnt(7)
  v_mfma_f32_16x16x32_bf16 v[64:67], a[112:115], v[32:35], 0
  v_mfma_f32_16x16x32_bf16 v[68:71], a[128:131], v[32:35], 0
  s_waitcnt lgkmcnt(5)
  v_mfma_f32_16x16x32_bf16 v[64:67], a[116:119], v[40:43], v[64:67]
  v_mfma_f32_16x16x32_bf16 v[68:71], a[132:135], v[40:43], v[68:71]
  s_waitcnt lgkmcnt(3)
  v_mfma_f32_16x16x32_bf16 v[64:67], a[120:123], v[48:51], v[64:67]
  v_mfma_f32_16x16x32_bf16 v[68:71], a[136:139], v[48:51], v[68:71]
  s_waitcnt lgkmcnt(1)
  v_mfma_f32_16x16x32_bf16 v[64:67], a[124:127], v[56:59], v[64:67]
  v_mfma_f32_16x16x32_bf16 v[68:71], a[140:143], v[56:59], v[68:71]
  v_mfma_f32_16x16x32_bf16 v[72:75], a[112:115], v[36:39], 0
  v_mfma_f32_16x16x32_bf16 v[76:79], a[128:131], v[36:39], 0
  v_mfma_f32_16x16x32_bf16 v[72:75], a[116:119], v[44:47], v[72:75]
  v_mfma_f32_16x16x32_bf16 v[76:79], a[132:135], v[44:47], v[76:79]
  s_add_u32 s51, s41, 516096
  v_cvt_pk_bf16_f32 v64, v64, v65
  v_cvt_pk_bf16_f32 v65, v66, v67
  v_cvt_pk_bf16_f32 v66, v68, v69
  v_cvt_pk_bf16_f32 v67, v70, v71
  v_bfi_b32 v64, 1, s60, v64
  v_bfi_b32 v66, 1, s60, v66
  buffer_store_dwordx4 v[64:67], v15, s[4:7], s51 offen sc1
  v_mfma_f32_16x16x32_bf16 v[72:75], a[120:123], v[52:55], v[72:75]
  v_mfma_f32_16x16x32_bf16 v[76:79], a[136:139], v[52:55], v[76:79]
  s_waitcnt lgkmcnt(0)
  v_mfma_f32_16x16x32_bf16 v[72:75], a[124:127], v[60:63], v[72:75]
  v_mfma_f32_16x16x32_bf16 v[76:79], a[140:143], v[60:63], v[76:79]
  v_mfma_f32_16x16x32_bf16 v[64:67], a[144:147], v[32:35], 0
  v_mfma_f32_16x16x32_bf16 v[68:71], a[160:163], v[32:35], 0
  v_mfma_f32_16x16x32_bf16 v[64:67], a[148:151], v[40:43], v[64:67]
  v_mfma_f32_16x16x32_bf16 v[68:71], a[164:167], v[40:43], v[68:71]
  s_add_u32 s51, s41, 1179648
  v_cvt_pk_bf16_f32 v72, v72, v73
  v_cvt_pk_bf16_f32 v73, v74, v75
  v_cvt_pk_bf16_f32 v74, v76, v77
  v_cvt_pk_bf16_f32 v75, v78, v79
  v_bfi_b32 v72, 1, s60, v72
  v_bfi_b32 v74, 1, s60, v74
  buffer_store_dwordx4 v[72:75], v15, s[4:7], s51 offen sc1
  v_mfma_f32_16x16x32_bf16 v[64:67], a[152:155], v[48:51], v[64:67]
  v_mfma_f32_16x16x32_bf16 v[68:71], a[168:171], v[48:51], v[68:71]
  v_mfma_f32_16x16x32_bf16 v[64:67], a[156:159], v[56:59], v[64:67]
  v_mfma_f32_16x16x32_bf16 v[68:71], a[172:175], v[56:59], v[68:71]
  v_mfma_f32_16x16x32_bf16 v[72:75], a[144:147], v[36:39], 0
  v_mfma_f32_16x16x32_bf16 v[76:79], a[160:163], v[36:39], 0
  v_mfma_f32_16x16x32_bf16 v[72:75], a[148:151], v[44:47], v[72:75]
  v_mfma_f32_16x16x32_bf16 v[76:79], a[164:167], v[44:47], v[76:79]
  s_add_u32 s51, s41, 552960
  v_cvt_pk_bf16_f32 v64, v64, v65
  v_cvt_pk_bf16_f32 v65, v66, v67
  v_cvt_pk_bf16_f32 v66, v68, v69
  v_cvt_pk_bf16_f32 v67, v70, v71
  v_bfi_b32 v64, 1, s60, v64
  v_bfi_b32 v66, 1, s60, v66
  buffer_store_dwordx4 v[64:67], v15, s[4:7], s51 offen sc1
  v_mfma_f32_16x16x32_bf16 v[72:75], a[152:155], v[52:55], v[72:75]
  v_mfma_f32_16x16x32_bf16 v[76:79], a[168:171], v[52:55], v[76:79]
  v_mfma_f32_16x16x32_bf16 v[72:75], a[156:159], v[60:63], v[72:75]
  v_mfma_f32_16x16x32_bf16 v[76:79], a[172:175], v[60:63], v[76:79]
  v_mfma_f32_16x16x32_bf16 v[64:67], a[176:179], v[32:35], 0
  v_mfma_f32_16x16x32_bf16 v[68:71], a[192:195], v[32:35], 0
  v_mfma_f32_16x16x32_bf16 v[64:67], a[180:183], v[40:43], v[64:67]
  v_mfma_f32_16x16x32_bf16 v[68:71], a[196:199], v[40:43], v[68:71]
  s_add_u32 s51, s41, 1216512
  v_cvt_pk_bf16_f32 v72, v72, v73
  v_cvt_pk_bf16_f32 v73, v74, v75
  v_cvt_pk_bf16_f32 v74, v76, v77
  v_cvt_pk_bf16_f32 v75, v78, v79
  v_bfi_b32 v72, 1, s60, v72
  v_bfi_b32 v74, 1, s60, v74
  buffer_store_dwordx4 v[72:75], v15, s[4:7], s51 offen sc1
  v_mfma_f32_16x16x32_bf16 v[64:67], a[184:187], v[48:51], v[64:67]
  v_mfma_f32_16x16x32_bf16 v[68:71], a[200:203], v[48:51], v[68:71]
  v_mfma_f32_16x16x32_bf16 v[64:67], a[188:191], v[56:59], v[64:67]
  v_mfma_f32_16x16x32_bf16 v[68:71], a[204:207], v[56:59], v[68:71]
  v_mfma_f32_16x16x32_bf16 v[72:75], a[176:179], v[36:39], 0
  v_mfma_f32_16x16x32_bf16 v[76:79], a[192:195], v[36:39], 0
  v_mfma_f32_16x16x32_bf16 v[72:75], a[180:183], v[44:47], v[72:75]
  v_mfma_f32_16x16x32_bf16 v[76:79], a[196:199], v[44:47], v[76:79]
  s_add_u32 s51, s41, 589824
  v_cvt_pk_bf16_f32 v64, v64, v65
  v_cvt_pk_bf16_f32 v65, v66, v67
  v_cvt_pk_bf16_f32 v66, v68, v69
  v_cvt_pk_bf16_f32 v67, v70, v71
  v_bfi_b32 v64, 1, s60, v64
  v_bfi_b32 v66, 1, s60, v66
  buffer_store_dwordx4 v[64:67], v15, s[4:7], s51 offen sc1
  v_mfma_f32_16x16x32_bf16 v[72:75], a[184:187], v[52:55], v[72:75]
  v_mfma_f32_16x16x32_bf16 v[76:79], a[200:203], v[52:55], v[76:79]
  v_mfma_f32_16x16x32_bf16 v[72:75], a[188:191], v[60:63], v[72:75]
  v_mfma_f32_16x16x32_bf16 v[76:79], a[204:207], v[60:63], v[76:79]
  v_mfma_f32_16x16x32_bf16 v[64:67], a[208:211], v[32:35], 0
  v_mfma_f32_16x16x32_bf16 v[68:71], a[224:227], v[32:35], 0
  v_mfma_f32_16x16x32_bf16 v[64:67], a[212:215], v[40:43], v[64:67]
  v_mfma_f32_16x16x32_bf16 v[68:71], a[228:231], v[40:43], v[68:71]
  s_add_u32 s51, s41, 1253376
  v_cvt_pk_bf16_f32 v72, v72, v73
  v_cvt_pk_bf16_f32 v73, v74, v75
  v_cvt_pk_bf16_f32 v74, v76, v77
  v_cvt_pk_bf16_f32 v75, v78, v79
  v_bfi_b32 v72, 1, s60, v72
  v_bfi_b32 v74, 1, s60, v74
  buffer_store_dwordx4 v[72:75], v15, s[4:7], s51 offen sc1
  v_mfma_f32_16x16x32_bf16 v[64:67], a[216:219], v[48:51], v[64:67]
  v_mfma_f32_16x16x32_bf16 v[68:71], a[232:235], v[48:51], v[68:71]
  v_mfma_f32_16x16x32_bf16 v[64:67], a[220:223], v[56:59], v[64:67]
  v_mfma_f32_16x16x32_bf16 v[68:71], a[236:239], v[56:59], v[68:71]
  v_mfma_f32_16x16x32_bf16 v[72:75], a[208:211], v[36:39], 0
  v_mfma_f32_16x16x32_bf16 v[76:79], a[224:227], v[36:39], 0
  v_mfma_f32_16x16x32_bf16 v[72:75], a[212:215], v[44:47], v[72:75]
  v_mfma_f32_16x16x32_bf16 v[76:79], a[228:231], v[44:47], v[76:79]
  s_add_u32 s51, s41, 626688
  v_cvt_pk_bf16_f32 v64, v64, v65
  v_cvt_pk_bf16_f32 v65, v66, v67
  v_cvt_pk_bf16_f32 v66, v68, v69
  v_cvt_pk_bf16_f32 v67, v70, v71
  v_bfi_b32 v64, 1, s60, v64
  v_bfi_b32 v66, 1, s60, v66
  buffer_store_dwordx4 v[64:67], v15, s[4:7], s51 offen sc1
  v_mfma_f32_16x16x32_bf16 v[72:75], a[216:219], v[52:55], v[72:75]
  v_mfma_f32_16x16x32_bf16 v[76:79], a[232:235], v[52:55], v[76:79]
  v_mfma_f32_16x16x32_bf16 v[72:75], a[220:223], v[60:63], v[72:75]
  v_mfma_f32_16x16x32_bf16 v[76:79], a[236:239], v[60:63], v[76:79]
  s_mul_i32 s35, s49, 36864
  s_add_u32 s35, s35, 7340032
  s_load_dword s52, s[4:5], s35 offset:27648 glc
  s_load_dword s53, s[4:5], s35 offset:28800 glc
  s_load_dword s54, s[4:5], s35 offset:29952 glc
  s_load_dword s55, s[4:5], s35 offset:31104 glc
  s_load_dword s56, s[4:5], s35 offset:32256 glc
  s_load_dword s57, s[4:5], s35 offset:33408 glc
  s_load_dword s58, s[4:5], s35 offset:34560 glc
  s_load_dword s59, s[4:5], s35 offset:35712 glc
  v_mfma_f32_16x16x32_bf16 v[64:67], a[240:243], v[32:35], 0
  v_mfma_f32_16x16x32_bf16 v[64:67], a[244:247], v[40:43], v[64:67]
  s_add_u32 s51, s41, 1290240
  v_cvt_pk_bf16_f32 v72, v72, v73
  v_cvt_pk_bf16_f32 v73, v74, v75
  v_cvt_pk_bf16_f32 v74, v76, v77
  v_cvt_pk_bf16_f32 v75, v78, v79
  v_bfi_b32 v72, 1, s60, v72
  v_bfi_b32 v74, 1, s60, v74
  buffer_store_dwordx4 v[72:75], v15, s[4:7], s51 offen sc1
  v_mfma_f32_16x16x32_bf16 v[64:67], a[248:251], v[48:51], v[64:67]
  v_mfma_f32_16x16x32_bf16 v[64:67], a[252:255], v[56:59], v[64:67]
  v_mfma_f32_16x16x32_bf16 v[72:75], a[240:243], v[36:39], 0
  v_mfma_f32_16x16x32_bf16 v[72:75], a[244:247], v[44:47], v[72:75]
  s_add_u32 s51, s41, 479232
  v_cvt_pk_bf16_f32 v64, v64, v65
  v_cvt_pk_bf16_f32 v65, v66, v67
  v_bfi_b32 v64, 1, s60, v64
  buffer_store_dwordx2 v[64:65], v15, s[4:7], s51 offen offset:8 sc1
  v_mfma_f32_16x16x32_bf16 v[72:75], a[248:251], v[52:55], v[72:75]
  v_mfma_f32_16x16x32_bf16 v[72:75], a[252:255], v[60:63], v[72:75]
  s_add_u32 s51, s41, 1142784
  s_nop 6
  v_cvt_pk_bf16_f32 v72, v72, v73
  v_cvt_pk_bf16_f32 v73, v74, v75
  v_bfi_b32 v72, 1, s60, v72
  buffer_store_dwordx2 v[72:73], v15, s[4:7], s51 offen offset:8 sc1
  s_waitcnt vmcnt(2)
  s_add_u32 s51, s41, 0
  buffer_load_dwordx4 v[32:35], v16, s[4:7], s51 offen sc1
  s_add_u32 s51, s41, 4096
  buffer_load_dwordx4 v[36:39], v16, s[4:7], s51 offen sc1
  s_add_u32 s51, s41, 8192
  buffer_load_dwordx4 v[40:43], v16, s[4:7], s51 offen sc1
  s_add_u32 s51, s41, 12288
  buffer_load_dwordx4 v[44:47], v16, s[4:7], s51 offen sc1
  s_add_u32 s51, s41, 16384
  buffer_load_dwordx4 v[48:51], v16, s[4:7], s51 offen sc1
  s_add_u32 s51, s41, 20480
  buffer_load_dwordx4 v[52:55], v16, s[4:7], s51 offen sc1
  s_add_u32 s51, s41, 24576
  buffer_load_dwordx4 v[56:59], v16, s[4:7], s51 offen sc1
  s_add_u32 s51, s41, 28672
  buffer_load_dwordx4 v[60:63], v16, s[4:7], s51 offen sc1
  s_add_u32 s51, s41, 32768
  buffer_load_dwordx4 v[64:67], v16, s[4:7], s51 offen sc1
  s_waitcnt lgkmcnt(0)
  s_max_u32 s52, s52, s53
  s_max_u32 s52, s52, s54
  s_max_u32 s52, s52, s55
  s_max_u32 s52, s52, s56
  s_max_u32 s52, s52, s57
  s_max_u32 s52, s52, s58
  s_max_u32 s52, s52, s59
  s_cmp_lt_u32 s49, 64
  s_cselect_b32 s52, s52, -1
  s_cmp_lg_u32 s52, -1
  s_cselect_b32 s48, 1, 0
  s_cbranch_scc0 L_ffn_f3_0
  s_mov_b32 m0, s42
  s_nop 0
  buffer_load_dwordx4 v1, s[4:7], s35 offen sc1 lds
  s_add_u32 m0, s42, 1024
  s_nop 0
  buffer_load_dwordx4 v2, s[4:7], s35 offen sc1 lds
  s_add_u32 m0, s42, 2048
  s_nop 0
  buffer_load_dwordx4 v3, s[4:7], s35 offen sc1 lds
  s_add_u32 m0, s42, 3072
  s_nop 0
  buffer_load_dwordx4 v4, s[4:7], s35 offen sc1 lds
  s_add_u32 m0, s42, 4096
  s_nop 0
  buffer_load_dwordx4 v5, s[4:7], s35 offen sc1 lds
  s_add_u32 m0, s42, 5120
  s_nop 0
  buffer_load_dwordx4 v6, s[4:7], s35 offen sc1 lds
  s_add_u32 m0, s42, 6144
  s_nop 0
  buffer_load_dwordx4 v7, s[4:7], s35 offen sc1 lds
  s_add_u32 m0, s42, 7168
  s_nop 0
  buffer_load_dwordx4 v8, s[4:7], s35 offen sc1 lds
  s_add_u32 m0, s42, 8192
  s_nop 0
  buffer_load_dwordx4 v9, s[4:7], s35 offen sc1 lds
  s_waitcnt vmcnt(15)
  v_bitop3_b32 v20, v32, v34, s60 bitop3:0x7e
  v_bitop3_b32 v21, v36, v38, s60 bitop3:0x7e
  v_bitop3_b32 v22, v40, v42, s60 bitop3:0x7e
  v_or3_b32 v20, v20, v21, v22
  v_and_b32 v20, 1, v20
  v_cmp_eq_u32 vcc, -1, v26
  s_nop 1
  v_cndmask_b32 v20, v20, 1, vcc
  v_cmp_eq_u32 vcc, 1, v20
  s_nop 0
  s_cbranch_vccnz L_ffn_f3_0_r
  v_lshlrev_b32 v68, 16, v26
  v_and_b32 v69, 0xffff0000, v26
  v_lshlrev_b32 v70, 16, v27
  v_and_b32 v71, 0xffff0000, v27
  s_nop 1
  v_mfma_f32_16x16x32_bf16 v[68:71], v[28:31], v[32:35], v[68:71]
  v_mfma_f32_16x16x32_bf16 v[68:71], v[28:31], v[36:39], v[68:71]
  v_mfma_f32_16x16x32_bf16 v[68:71], v[28:31], v[40:43], v[68:71]
  s_waitcnt vmcnt(12)
  v_bitop3_b32 v20, v44, v46, s60 bitop3:0x7e
  v_bitop3_b32 v21, v48, v50, s60 bitop3:0x7e
  v_bitop3_b32 v22, v52, v54, s60 bitop3:0x7e
  v_or3_b32 v20, v20, v21, v22
  v_and_b32 v20, 1, v20
  v_cmp_eq_u32 vcc, 1, v20
  s_nop 0
  s_cbranch_vccnz L_ffn_f3_1_r
  v_mfma_f32_16x16x32_bf16 v[68:71], v[28:31], v[44:47], v[68:71]
  v_mfma_f32_16x16x32_bf16 v[68:71], v[28:31], v[48:51], v[68:71]
  v_mfma_f32_16x16x32_bf16 v[68:71], v[28:31], v[52:55], v[68:71]
  s_waitcnt vmcnt(9)
  v_bitop3_b32 v20, v56, v58, s60 bitop3:0x7e
  v_bitop3_b32 v21, v60, v62, s60 bitop3:0x7e
  v_bitop3_b32 v22, v64, v66, s60 bitop3:0x7e
  v_or3_b32 v20, v20, v21, v22
  v_and_b32 v20, 1, v20
  v_cmp_eq_u32 vcc, 1, v20
  s_nop 0
  s_cbranch_vccnz L_ffn_f3_2_r
  v_mfma_f32_16x16x32_bf16 v[68:71], v[28:31], v[56:59], v[68:71]
  v_mfma_f32_16x16x32_bf16 v[68:71], v[28:31], v[60:63], v[68:71]
  v_mfma_f32_16x16x32_bf16 v[68:71], v[28:31], v[64:67], v[68:71]
  s_branch L_ffn_l3_out
L_ffn_f3_0:
  s_waitcnt vmcnt(6)
  v_bitop3_b32 v20, v32, v34, s60 bitop3:0x7e
  v_bitop3_b32 v21, v36, v38, s60 bitop3:0x7e
  v_bitop3_b32 v22, v40, v42, s60 bitop3:0x7e
  v_or3_b32 v20, v20, v21, v22
  v_and_b32 v20, 1, v20
  v_cmp_eq_u32 vcc, -1, v26
  s_nop 1
  v_cndmask_b32 v20, v20, 1, vcc
  v_cmp_eq_u32 vcc, 1, v20
  s_nop 0
  s_cbranch_vccz L_ffn_f3_0_x
L_ffn_f3_0_r:
  s_add_u32 s50, s50, 1
  s_cmp_ge_u32 s50, 262144
  s_cbranch_scc1 L_ffn_f3_0_x
  buffer_load_dwordx2 v[26:27], v17, s[4:7], s34 offen sc1
  s_add_u32 s51, s41, 0
  buffer_load_dwordx4 v[32:35], v16, s[4:7], s51 offen sc1
  s_add_u32 s51, s41, 4096
  buffer_load_dwordx4 v[36:39], v16, s[4:7], s51 offen sc1
  s_add_u32 s51, s41, 8192
  buffer_load_dwordx4 v[40:43], v16, s[4:7], s51 offen sc1
  s_add_u32 s51, s41, 12288
  buffer_load_dwordx4 v[44:47], v16, s[4:7], s51 offen sc1
  s_add_u32 s51, s41, 16384
  buffer_load_dwordx4 v[48:51], v16, s[4:7], s51 offen sc1
  s_add_u32 s51, s41, 20480
  buffer_load_dwordx4 v[52:55], v16, s[4:7], s51 offen sc1
  s_add_u32 s51, s41, 24576
  buffer_load_dwordx4 v[56:59], v16, s[4:7], s51 offen sc1
  s_add_u32 s51, s41, 28672
  buffer_load_dwordx4 v[60:63], v16, s[4:7], s51 offen sc1
  s_add_u32 s51, s41, 32768
  buffer_load_dwordx4 v[64:67], v16, s[4:7], s51 offen sc1
  s_branch L_ffn_f3_0
L_ffn_f3_0_x:
  v_lshlrev_b32 v68, 16, v26
  v_and_b32 v69, 0xffff0000, v26
  v_lshlrev_b32 v70, 16, v27
  v_and_b32 v71, 0xffff0000, v27
  s_nop 1
  v_mfma_f32_16x16x32_bf16 v[68:71], v[28:31], v[32:35], v[68:71]
  v_mfma_f32_16x16x32_bf16 v[68:71], v[28:31], v[36:39], v[68:71]
  v_mfma_f32_16x16x32_bf16 v[68:71], v[28:31], v[40:43], v[68:71]
L_ffn_f3_1:
  s_waitcnt vmcnt(3)
  v_bitop3_b32 v20, v44, v46, s60 bitop3:0x7e
  v_bitop3_b32 v21, v48, v50, s60 bitop3:0x7e
  v_bitop3_b32 v22, v52, v54, s60 bitop3:0x7e
  v_or3_b32 v20, v20, v21, v22
  v_and_b32 v20, 1, v20
  v_cmp_eq_u32 vcc, 1, v20
  s_nop 0
  s_cbranch_vccz L_ffn_f3_1_x
L_ffn_f3_1_r:
  s_add_u32 s50, s50, 1
  s_cmp_ge_u32 s50, 262144
  s_cbranch_scc1 L_ffn_f3_1_x
  s_add_u32 s51, s41, 12288
  buffer_load_dwordx4 v[44:47], v16, s[4:7], s51 offen sc1
  s_add_u32 s51, s41, 16384
  buffer_load_dwordx4 v[48:51], v16, s[4:7], s51 offen sc1
  s_add_u32 s51, s41, 20480
  buffer_load_dwordx4 v[52:55], v16, s[4:7], s51 offen sc1
  s_add_u32 s51, s41, 24576
  buffer_load_dwordx4 v[56:59], v16, s[4:7], s51 offen sc1
  s_add_u32 s51, s41, 28672
  buffer_load_dwordx4 v[60:63], v16, s[4:7], s51 offen sc1
  s_add_u32 s51, s41, 32768
  buffer_load_dwordx4 v[64:67], v16, s[4:7], s51 offen sc1
  s_branch L_ffn_f3_1
L_ffn_f3_1_x:
  v_mfma_f32_16x16x32_bf16 v[68:71], v[28:31], v[44:47], v[68:71]
  v_mfma_f32_16x16x32_bf16 v[68:71], v[28:31], v[48:51], v[68:71]
  v_mfma_f32_16x16x32_bf16 v[68:71], v[28:31], v[52:55], v[68:71]
L_ffn_f3_2:
  s_waitcnt vmcnt(0)
  v_bitop3_b32 v20, v56, v58, s60 bitop3:0x7e
  v_bitop3_b32 v21, v60, v62, s60 bitop3:0x7e
  v_bitop3_b32 v22, v64, v66, s60 bitop3:0x7e
  v_or3_b32 v20, v20, v21, v22
  v_and_b32 v20, 1, v20
  v_cmp_eq_u32_e64 vcc, 1, v20
  s_nop 0
  s_cbranch_vccz L_ffn_f3_2_x
L_ffn_f3_2_r:
  s_add_u32 s50, s50, 1
  s_cmp_ge_u32 s50, 262144
  s_cbranch_scc1 L_ffn_f3_2_x
  s_add_u32 s51, s41, 24576
  buffer_load_dwordx4 v[56:59], v16, s[4:7], s51 offen sc1
  s_add_u32 s51, s41, 28672
  buffer_load_dwordx4 v[60:63], v16, s[4:7], s51 offen sc1
  s_add_u32 s51, s41, 32768
  buffer_load_dwordx4 v[64:67], v16, s[4:7], s51 offen sc1
  s_branch L_ffn_f3_2
L_ffn_f3_2_x:
  v_mfma_f32_16x16x32_bf16 v[68:71], v[28:31], v[56:59], v[68:71]
  v_mfma_f32_16x16x32_bf16 v[68:71], v[28:31], v[60:63], v[68:71]
  v_mfma_f32_16x16x32_bf16 v[68:71], v[28:31], v[64:67], v[68:71]
L_ffn_l3_out:
  s_nop 7
  v_cvt_pk_bf16_f32 v68, v68, v69
  v_cvt_pk_bf16_f32 v69, v70, v71
  buffer_store_dwordx2 v[68:69], v17, s[24:27], s45 offen
  s_mov_b32 s40, s49
  s_add_u32 s95, s95, 1
  s_cmp_lt_u32 s40, 64
  s_cbranch_scc1 L_ffn_l3
  s_endpgm
L_chain:
  s_load_dwordx4 s[12:15], s[0:1], 16
  s_load_dwordx4 s[20:23], s[0:1], 32
  s_load_dwordx2 s[28:29], s[0:1], 8
  s_waitcnt lgkmcnt(0)
  s_mov_b32 s16, s14
  s_and_b32 s17, s15, 0xffff
  s_mov_b32 s24, s22
  s_and_b32 s25, s23, 0xffff
  s_and_b32 s13, s13, 0xffff
  s_and_b32 s21, s21, 0xffff
  s_and_b32 s29, s29, 0xffff
  s_mov_b32 s14, 4718592
  s_mov_b32 s15, 0x20000
  s_mov_b32 s18, 4718592
  s_mov_b32 s19, 0x20000
  s_mov_b32 s22, 4718592
  s_mov_b32 s23, 0x20000
  s_mov_b32 s26, 4718592
  s_mov_b32 s27, 0x20000
  s_mov_b32 s30, 9216
  s_mov_b32 s31, 0x20000
  s_mov_b32 s50, 0
  s_cmp_eq_u32 s33, 1
  s_cbranch_scc1 L_chain_w1
  s_cmp_eq_u32 s33, 2
  s_cbranch_scc1 L_chain_w2
  s_cmp_eq_u32 s33, 3
  s_cbranch_scc1 L_chain_w3
L_chain_w0:
  v_mov_b32 v12, v0
  v_lshlrev_b32 v0, 4, v12
  v_and_b32 v13, 15, v12
  v_lshrrev_b32 v14, 4, v12
  v_mov_b32 v1, 0x4444
  v_and_b32 v15, 2, v12
  v_cmp_ne_u32 vcc, 0, v15
  v_mov_b32 v16, 0xeeee
  s_nop 0
  v_cndmask_b32 v1, v1, v16, vcc
  v_add_u32 v2, 32768, v0
  v_add_u32 v3, 98304, v0
  v_and_b32 v16, 13, v13
  v_and_b32 v17, 1, v14
  v_lshl_add_u32 v16, v17, 1, v16
  v_lshrrev_b32 v18, 1, v14
  v_lshl_add_u32 v16, v18, 4, v16
  v_lshlrev_b32 v4, 4, v16
  v_lshrrev_b32 v16, 2, v13
  v_xor_b32 v19, v16, v14
  v_lshlrev_b32 v19, 3, v19
  v_lshl_add_u32 v19, v13, 5, v19
  v_add_u32 v5, 25600, v19
  v_lshl_add_u32 v19, v17, 2, v16
  v_lshl_add_u32 v19, v18, 4, v19
  v_lshlrev_b32 v19, 5, v19
  v_and_b32 v20, 3, v13
  v_xor_b32 v20, v20, v17
  v_lshl_add_u32 v6, v20, 3, v19
  v_add_u32 v6, 25600, v6
  v_and_b32 v19, 13, v13
  v_lshl_add_u32 v19, v18, 1, v19
  v_lshlrev_b32 v19, 4, v19
  v_lshl_add_u32 v19, v17, 3, v19
  v_add_u32 v7, 29696, v19
  s_lshl_b32 s34, s32, 7
  v_and_b32 v19, 7, v13
  v_lshlrev_b32 v19, 4, v19
  v_lshrrev_b32 v20, 3, v13
  v_lshl_add_u32 v19, v20, 3, v19
  v_lshl_add_u32 v19, v14, 12, v19
  v_add_u32 v8, s34, v19
  v_and_b32 v19, 0x3c0, v0
  v_lshrrev_b32 v19, 1, v19
  v_and_b32 v20, 0x10, v0
  v_or_b32 v19, v19, v20
  v_and_b32 v20, 0x20, v0
  v_lshl_or_b32 v9, v20, 26, v19
  s_add_u32 s34, s32, 0
  s_mov_b32 s36, 8
  s_lshl_b32 s41, s34, 12
  s_add_u32 s41, s41, 65536
  s_lshl_b32 s35, s34, 7
  v_bfe_u32 v19, v13, 1, 1
  v_lshlrev_b32 v19, 6, v19
  v_and_b32 v20, 1, v13
  v_lshl_add_u32 v19, v20, 5, v19
  v_lshl_add_u32 v19, v16, 4, v19
  v_lshl_add_u32 v19, v17, 3, v19
  v_lshl_add_u32 v19, v18, 2, v19
  v_add_u32 v19, s35, v19
  v_mov_b32 v20, 0x80000000
  v_cmp_gt_u32 vcc, s36, v13
  s_nop 1
  v_cndmask_b32 v10, v20, v19, vcc
  v_lshlrev_b32 v19, 9, v18
  v_lshl_add_u32 v19, v16, 7, v19
  v_lshl_add_u32 v19, v17, 6, v19
  v_and_b32 v20, 1, v13
  v_lshl_add_u32 v19, v20, 5, v19
  v_and_b32 v20, 2, v13
  v_lshl_add_u32 v19, v20, 3, v19
  v_add_u32 v11, 0, v19
  s_mov_b32 s42, 664576
  s_mov_b32 s43, 655360
  s_mov_b32 s44, 673792
  v_mov_b64 v[44:45], -1
  v_mov_b64 v[46:47], -1
  buffer_store_dwordx4 v[44:47], v0, s[4:7], s41 offen offset:0 sc1
  buffer_store_dwordx4 v[44:47], v0, s[4:7], s41 offen offset:1024 sc1
  buffer_store_dwordx4 v[44:47], v0, s[4:7], s41 offen offset:2048 sc1
  buffer_store_dwordx4 v[44:47], v0, s[4:7], s41 offen offset:3072 sc1
  buffer_store_dword v44, v10, s[4:7], s42 offen sc1
  buffer_store_dword v44, v10, s[4:7], s43 offen sc1
  buffer_store_dword v44, v10, s[4:7], s44 offen sc1
L_noinit_80:
  s_mov_b32 s40, 0
  s_mov_b32 s54, 0
  s_mov_b32 s46, 0x3e0293ee
  s_mov_b32 s47, 0xbe0293ee
  s_mov_b32 s52, 0xcccccccc
  s_mov_b32 s53, 0xcccccccc
  s_lshl_b32 s48, s32, 13
  s_add_u32 s48, s48, 35651584
  s_add_u32 s93, s48, 262144
  s_lshl_b32 s49, s32, 11
  s_add_u32 s49, s49, 10485760
  s_mov_b32 s60, 0
  s_mov_b32 s88, 131072
  s_mov_b32 s89, 65536
  s_mov_b32 s90, 81920
  s_mov_b32 s91, 98304
  s_mov_b32 s92, 114688
  s_mov_b32 s80, 0
  s_mov_b32 s81, 0
  s_mov_b32 s82, 0
  s_mov_b32 s83, 0
  s_mov_b32 s84, 0
  s_mov_b32 s85, 0
  s_mov_b32 s86, 0
  s_mov_b32 s87, 0
  v_lshrrev_b32 v12, 4, v0
  v_lshrrev_b32 v13, 4, v12
  v_and_b32 v14, 15, v12
  v_and_b32 v15, 1, v13
  v_lshlrev_b32 v15, 1, v15
  v_xor_b32 v14, v14, v15
  s_lshl_b32 s34, s32, 8
  s_add_u32 s34, s34, 0
  v_lshlrev_b32 v15, 13, v13
  v_lshl_add_u32 v15, v14, 4, v15
  v_add_u32 v56, s34, v15
  v_xor_b32 v57, 64, v56
  v_xor_b32 v58, 128, v56
  v_xor_b32 v59, 192, v56
  v_and_b32 v14, 3, v12
  v_lshrrev_b32 v15, 5, v12
  v_bfe_u32 v16, v12, 4, 1
  v_bfe_u32 v17, v12, 2, 1
  v_bfe_u32 v18, v12, 3, 1
  v_lshl_add_u32 v19, v16, 2, v17
  v_lshl_add_u32 v20, v15, 4, v19
  v_lshl_add_u32 v20, v18, 3, v20
  v_lshl_add_u32 v21, v16, 1, v17
  v_lshl_add_u32 v21, v18, 2, v21
  v_lshlrev_b32 v21, 1, v21
  v_lshrrev_b32 v22, 1, v14
  v_add_u32 v22, 0, v22
  v_xor_b32 v22, v22, v21
  v_lshlrev_b32 v22, 4, v22
  v_lshl_add_u32 v22, v20, 8, v22
  v_and_b32 v23, 1, v12
  v_lshl_add_u32 v52, v23, 3, v22
  v_xor_b32 v53, 32, v52
  v_mul_u32_u24 v20, 1152, v20
  v_lshl_add_u32 v20, v14, 3, v20
  v_add_u32 v61, 256, v20
  v_lshl_add_u32 v20, v15, 3, v19
  v_mul_u32_u24 v20, 1152, v20
  v_lshl_add_u32 v20, v18, 5, v20
  v_lshl_add_u32 v60, v14, 3, v20
  s_mul_i32 s61, s32, 147456
  s_add_u32 s61, s61, 0
  s_mov_b32 m0, 0
  s_add_u32 s51, s61, 0
  buffer_load_dwordx4 v0, s[24:27], s51 offen offset:0 lds
  buffer_load_dwordx4 v0, s[24:27], s51 offen offset:1024 lds
  buffer_load_dwordx4 v0, s[24:27], s51 offen offset:2048 lds
  buffer_load_dwordx4 v0, s[24:27], s51 offen offset:3072 lds
  s_mov_b32 m0, 4096
  s_add_u32 s51, s61, 4096
  buffer_load_dwordx4 v0, s[24:27], s51 offen offset:0 lds
  buffer_load_dwordx4 v0, s[24:27], s51 offen offset:1024 lds
  buffer_load_dwordx4 v0, s[24:27], s51 offen offset:2048 lds
  buffer_load_dwordx4 v0, s[24:27], s51 offen offset:3072 lds
  s_mov_b32 m0, 8192
  s_add_u32 s51, s61, 8192
  buffer_load_dwordx4 v0, s[24:27], s51 offen offset:0 lds
  s_mov_b32 m0, 36864
  s_add_u32 s51, s61, 36864
  buffer_load_dwordx4 v0, s[24:27], s51 offen offset:0 lds
  buffer_load_dwordx4 v0, s[24:27], s51 offen offset:1024 lds
  buffer_load_dwordx4 v0, s[24:27], s51 offen offset:2048 lds
  buffer_load_dwordx4 v0, s[24:27], s51 offen offset:3072 lds
  s_mov_b32 m0, 40960
  s_add_u32 s51, s61, 40960
  buffer_load_dwordx4 v0, s[24:27], s51 offen offset:0 lds
  buffer_load_dwordx4 v0, s[24:27], s51 offen offset:1024 lds
  buffer_load_dwordx4 v0, s[24:27], s51 offen offset:2048 lds
  buffer_load_dwordx4 v0, s[24:27], s51 offen offset:3072 lds
  s_mov_b32 m0, 45056
  s_add_u32 s51, s61, 45056
  buffer_load_dwordx4 v0, s[24:27], s51 offen offset:0 lds
  s_mov_b32 m0, 73728
  s_add_u32 s51, s61, 73728
  buffer_load_dwordx4 v0, s[24:27], s51 offen offset:0 lds
  buffer_load_dwordx4 v0, s[24:27], s51 offen offset:1024 lds
  buffer_load_dwordx4 v0, s[24:27], s51 offen offset:2048 lds
  buffer_load_dwordx4 v0, s[24:27], s51 offen offset:3072 lds
  s_mov_b32 m0, 77824
  s_add_u32 s51, s61, 77824
  buffer_load_dwordx4 v0, s[24:27], s51 offen offset:0 lds
  buffer_load_dwordx4 v0, s[24:27], s51 offen offset:1024 lds
  buffer_load_dwordx4 v0, s[24:27], s51 offen offset:2048 lds
  buffer_load_dwordx4 v0, s[24:27], s51 offen offset:3072 lds
  s_mov_b32 m0, 81920
  s_add_u32 s51, s61, 81920
  buffer_load_dwordx4 v0, s[24:27], s51 offen offset:0 lds
  s_mov_b32 m0, 110592
  s_add_u32 s51, s61, 110592
  buffer_load_dwordx4 v0, s[24:27], s51 offen offset:0 lds
  buffer_load_dwordx4 v0, s[24:27], s51 offen offset:1024 lds
  buffer_load_dwordx4 v0, s[24:27], s51 offen offset:2048 lds
  buffer_load_dwordx4 v0, s[24:27], s51 offen offset:3072 lds
  s_mov_b32 m0, 114688
  s_add_u32 s51, s61, 114688
  buffer_load_dwordx4 v0, s[24:27], s51 offen offset:0 lds
  buffer_load_dwordx4 v0, s[24:27], s51 offen offset:1024 lds
  buffer_load_dwordx4 v0, s[24:27], s51 offen offset:2048 lds
  buffer_load_dwordx4 v0, s[24:27], s51 offen offset:3072 lds
  s_mov_b32 m0, 118784
  s_add_u32 s51, s61, 118784
  buffer_load_dwordx4 v0, s[24:27], s51 offen offset:0 lds
  s_mov_b32 m0, 147456
  s_mov_b32 s51, 0
  buffer_load_dwordx4 v56, s[20:23], s51 offen lds
  s_mov_b32 m0, 148480
  s_mov_b32 s51, 32768
  buffer_load_dwordx4 v57, s[20:23], s51 offen lds
  s_mov_b32 m0, 149504
  s_mov_b32 s51, 65536
  buffer_load_dwordx4 v58, s[20:23], s51 offen lds
  s_mov_b32 m0, 150528
  s_mov_b32 s51, 98304
  buffer_load_dwordx4 v59, s[20:23], s51 offen lds
  s_waitcnt vmcnt(31)
  s_barrier
  v_mov_b32 v48, 1
  s_mov_b64 exec, 1
  buffer_atomic_add v48, off, s[8:11], 0 offset:8
  s_mov_b64 exec, -1
  v_add_u32 v54, 0, v60
  v_add_u32 v55, 0, v61
  ds_read_b64_tr_b16 a[160:161], v54 offset:0
  ds_read_b64_tr_b16 a[162:163], v54 offset:2304
  ds_read_b64_tr_b16 a[164:165], v54 offset:18432
  ds_read_b64_tr_b16 a[166:167], v54 offset:20736
  ds_read_b64_tr_b16 v[20:21], v54 offset:64
  ds_read_b64_tr_b16 v[22:23], v54 offset:2368
  ds_read_b64_tr_b16 v[24:25], v54 offset:18496
  ds_read_b64_tr_b16 v[26:27], v54 offset:20800
  ds_read_b64_tr_b16 v[28:29], v54 offset:128
  ds_read_b64_tr_b16 v[30:31], v54 offset:2432
  ds_read_b64_tr_b16 v[32:33], v54 offset:18560
  ds_read_b64_tr_b16 v[34:35], v54 offset:20864
  ds_read_b64_tr_b16 v[36:37], v54 offset:192
  ds_read_b64_tr_b16 v[38:39], v54 offset:2496
  ds_read_b64_tr_b16 v[40:41], v54 offset:18624
  ds_read_b64_tr_b16 v[42:43], v54 offset:20928
  ds_read_b64_tr_b16 a[144:145], v55 offset:0
  ds_read_b64_tr_b16 a[146:147], v55 offset:2304
  s_waitcnt lgkmcnt(0)
  s_waitcnt vmcnt(23)
  s_barrier
  s_mov_b32 m0, 0
  s_mov_b32 s51, 0
  buffer_load_dwordx4 v56, s[12:15], s51 offen lds
  s_mov_b32 m0, 1024
  s_mov_b32 s51, 32768
  buffer_load_dwordx4 v57, s[12:15], s51 offen lds
  s_mov_b32 m0, 2048
  s_mov_b32 s51, 65536
  buffer_load_dwordx4 v58, s[12:15], s51 offen lds
  s_mov_b32 m0, 3072
  s_mov_b32 s51, 98304
  buffer_load_dwordx4 v59, s[12:15], s51 offen lds
  s_mov_b32 m0, 16384
  s_mov_b32 s51, 524288
  buffer_load_dwordx4 v56, s[20:23], s51 offen lds
  s_mov_b32 m0, 17408
  s_mov_b32 s51, 557056
  buffer_load_dwordx4 v57, s[20:23], s51 offen lds
  s_mov_b32 m0, 18432
  s_mov_b32 s51, 589824
  buffer_load_dwordx4 v58, s[20:23], s51 offen lds
  s_mov_b32 m0, 19456
  s_mov_b32 s51, 622592
  buffer_load_dwordx4 v59, s[20:23], s51 offen lds
  v_add_u32 v54, 36864, v60
  v_add_u32 v55, 36864, v61
  ds_read_b64_tr_b16 v[12:13], v54 offset:0
  ds_read_b64_tr_b16 v[14:15], v54 offset:2304
  ds_read_b64_tr_b16 v[16:17], v54 offset:18432
  ds_read_b64_tr_b16 v[18:19], v54 offset:20736
  ds_read_b64_tr_b16 a[184:185], v54 offset:64
  ds_read_b64_tr_b16 a[186:187], v54 offset:2368
  ds_read_b64_tr_b16 a[188:189], v54 offset:18496
  ds_read_b64_tr_b16 a[190:191], v54 offset:20800
  ds_read_b64_tr_b16 a[208:209], v54 offset:128
  ds_read_b64_tr_b16 a[210:211], v54 offset:2432
  ds_read_b64_tr_b16 a[212:213], v54 offset:18560
  ds_read_b64_tr_b16 a[214:215], v54 offset:20864
  ds_read_b64_tr_b16 a[232:233], v54 offset:192
  ds_read_b64_tr_b16 a[234:235], v54 offset:2496
  ds_read_b64_tr_b16 a[236:237], v54 offset:18624
  ds_read_b64_tr_b16 a[238:239], v54 offset:20928
  ds_read_b64_tr_b16 a[148:149], v55 offset:0
  ds_read_b64_tr_b16 a[150:151], v55 offset:2304
  s_waitcnt lgkmcnt(0)
  s_waitcnt vmcnt(22)
  s_barrier
  s_mov_b32 m0, 32768
  s_mov_b32 s51, 0
  buffer_load_dwordx4 v56, s[16:19], s51 offen lds
  s_mov_b32 m0, 33792
  s_mov_b32 s51, 32768
  buffer_load_dwordx4 v57, s[16:19], s51 offen lds
  s_mov_b32 m0, 34816
  s_mov_b32 s51, 65536
  buffer_load_dwordx4 v58, s[16:19], s51 offen lds
  s_mov_b32 m0, 35840
  s_mov_b32 s51, 98304
  buffer_load_dwordx4 v59, s[16:19], s51 offen lds
  s_mov_b32 m0, 49152
  s_mov_b32 s51, 1048576
  buffer_load_dwordx4 v56, s[16:19], s51 offen lds
  s_mov_b32 m0, 50176
  s_mov_b32 s51, 1081344
  buffer_load_dwordx4 v57, s[16:19], s51 offen lds
  s_mov_b32 m0, 51200
  s_mov_b32 s51, 1114112
  buffer_load_dwordx4 v58, s[16:19], s51 offen lds
  s_mov_b32 m0, 52224
  s_mov_b32 s51, 1146880
  buffer_load_dwordx4 v59, s[16:19], s51 offen lds
  v_add_u32 v54, 73728, v60
  v_add_u32 v55, 73728, v61
  ds_read_b64_tr_b16 a[168:169], v54 offset:0
  ds_read_b64_tr_b16 a[170:171], v54 offset:2304
  ds_read_b64_tr_b16 a[172:173], v54 offset:18432
  ds_read_b64_tr_b16 a[174:175], v54 offset:20736
  ds_read_b64_tr_b16 a[192:193], v54 offset:64
  ds_read_b64_tr_b16 a[194:195], v54 offset:2368
  ds_read_b64_tr_b16 a[196:197], v54 offset:18496
  ds_read_b64_tr_b16 a[198:199], v54 offset:20800
  ds_read_b64_tr_b16 a[216:217], v54 offset:128
  ds_read_b64_tr_b16 a[218:219], v54 offset:2432
  ds_read_b64_tr_b16 a[220:221], v54 offset:18560
  ds_read_b64_tr_b16 a[222:223], v54 offset:20864
  ds_read_b64_tr_b16 a[240:241], v54 offset:192
  ds_read_b64_tr_b16 a[242:243], v54 offset:2496
  ds_read_b64_tr_b16 a[244:245], v54 offset:18624
  ds_read_b64_tr_b16 a[246:247], v54 offset:20928
  ds_read_b64_tr_b16 a[152:153], v55 offset:0
  ds_read_b64_tr_b16 a[154:155], v55 offset:2304
  s_waitcnt lgkmcnt(0)
  s_waitcnt vmcnt(21)
  s_barrier
  s_mov_b32 m0, 65536
  s_mov_b32 s51, 524288
  buffer_load_dwordx4 v56, s[12:15], s51 offen lds
  s_mov_b32 m0, 66560
  s_mov_b32 s51, 557056
  buffer_load_dwordx4 v57, s[12:15], s51 offen lds
  s_mov_b32 m0, 67584
  s_mov_b32 s51, 589824
  buffer_load_dwordx4 v58, s[12:15], s51 offen lds
  s_mov_b32 m0, 68608
  s_mov_b32 s51, 622592
  buffer_load_dwordx4 v59, s[12:15], s51 offen lds
  s_mov_b32 m0, 81920
  s_mov_b32 s51, 524288
  buffer_load_dwordx4 v56, s[16:19], s51 offen lds
  s_mov_b32 m0, 82944
  s_mov_b32 s51, 557056
  buffer_load_dwordx4 v57, s[16:19], s51 offen lds
  s_mov_b32 m0, 83968
  s_mov_b32 s51, 589824
  buffer_load_dwordx4 v58, s[16:19], s51 offen lds
  s_mov_b32 m0, 84992
  s_mov_b32 s51, 622592
  buffer_load_dwordx4 v59, s[16:19], s51 offen lds
  v_add_u32 v54, 110592, v60
  v_add_u32 v55, 110592, v61
  ds_read_b64_tr_b16 a[176:177], v54 offset:0
  ds_read_b64_tr_b16 a[178:179], v54 offset:2304
  ds_read_b64_tr_b16 a[180:181], v54 offset:18432
  ds_read_b64_tr_b16 a[182:183], v54 offset:20736
  ds_read_b64_tr_b16 a[200:201], v54 offset:64
  ds_read_b64_tr_b16 a[202:203], v54 offset:2368
  ds_read_b64_tr_b16 a[204:205], v54 offset:18496
  ds_read_b64_tr_b16 a[206:207], v54 offset:20800
  ds_read_b64_tr_b16 a[224:225], v54 offset:128
  ds_read_b64_tr_b16 a[226:227], v54 offset:2432
  ds_read_b64_tr_b16 a[228:229], v54 offset:18560
  ds_read_b64_tr_b16 a[230:231], v54 offset:20864
  ds_read_b64_tr_b16 a[248:249], v54 offset:192
  ds_read_b64_tr_b16 a[250:251], v54 offset:2496
  ds_read_b64_tr_b16 a[252:253], v54 offset:18624
  ds_read_b64_tr_b16 a[254:255], v54 offset:20928
  ds_read_b64_tr_b16 a[156:157], v55 offset:0
  ds_read_b64_tr_b16 a[158:159], v55 offset:2304
  s_waitcnt lgkmcnt(0)
  s_waitcnt vmcnt(25)
  s_barrier
  s_mov_b32 m0, 98304
  s_mov_b32 s51, 1048576
  buffer_load_dwordx4 v56, s[20:23], s51 offen lds
  s_mov_b32 m0, 99328
  s_mov_b32 s51, 1081344
  buffer_load_dwordx4 v57, s[20:23], s51 offen lds
  s_mov_b32 m0, 100352
  s_mov_b32 s51, 1114112
  buffer_load_dwordx4 v58, s[20:23], s51 offen lds
  s_mov_b32 m0, 101376
  s_mov_b32 s51, 1146880
  buffer_load_dwordx4 v59, s[20:23], s51 offen lds
  s_mov_b32 m0, 114688
  s_mov_b32 s51, 1048576
  buffer_load_dwordx4 v56, s[12:15], s51 offen lds
  s_mov_b32 m0, 115712
  s_mov_b32 s51, 1081344
  buffer_load_dwordx4 v57, s[12:15], s51 offen lds
  s_mov_b32 m0, 116736
  s_mov_b32 s51, 1114112
  buffer_load_dwordx4 v58, s[12:15], s51 offen lds
  s_mov_b32 m0, 117760
  s_mov_b32 s51, 1146880
  buffer_load_dwordx4 v59, s[12:15], s51 offen lds
  s_mov_b32 m0, 131072
  s_mov_b32 s51, 1572864
  buffer_load_dwordx4 v56, s[20:23], s51 offen lds
  s_mov_b32 m0, 132096
  s_mov_b32 s51, 1605632
  buffer_load_dwordx4 v57, s[20:23], s51 offen lds
  s_mov_b32 m0, 133120
  s_mov_b32 s51, 1638400
  buffer_load_dwordx4 v58, s[20:23], s51 offen lds
  s_mov_b32 m0, 134144
  s_mov_b32 s51, 1671168
  buffer_load_dwordx4 v59, s[20:23], s51 offen lds
  v_add_u32 v54, 147456, v52
  v_add_u32 v55, 147456, v53
  ds_read_b64_tr_b16 v[64:65], v54 offset:0
  ds_read_b64_tr_b16 v[66:67], v54 offset:512
  ds_read_b64_tr_b16 v[68:69], v54 offset:8192
  ds_read_b64_tr_b16 v[70:71], v54 offset:8704
  ds_read_b64_tr_b16 v[72:73], v55 offset:0
  ds_read_b64_tr_b16 v[74:75], v55 offset:512
  ds_read_b64_tr_b16 v[76:77], v55 offset:8192
  ds_read_b64_tr_b16 v[78:79], v55 offset:8704
  s_waitcnt lgkmcnt(0)
  s_waitcnt vmcnt(32)
  s_barrier
  s_mov_b32 m0, 147456
  s_mov_b32 s51, 1572864
  buffer_load_dwordx4 v56, s[12:15], s51 offen lds
  s_mov_b32 m0, 148480
  s_mov_b32 s51, 1605632
  buffer_load_dwordx4 v57, s[12:15], s51 offen lds
  s_mov_b32 m0, 149504
  s_mov_b32 s51, 1638400
  buffer_load_dwordx4 v58, s[12:15], s51 offen lds
  s_mov_b32 m0, 150528
  s_mov_b32 s51, 1671168
  buffer_load_dwordx4 v59, s[12:15], s51 offen lds
  v_add_u32 v54, 0, v52
  v_add_u32 v55, 0, v53
  ds_read_b64_tr_b16 v[208:209], v54 offset:0
  ds_read_b64_tr_b16 v[210:211], v54 offset:512
  ds_read_b64_tr_b16 v[212:213], v54 offset:8192
  ds_read_b64_tr_b16 v[214:215], v54 offset:8704
  ds_read_b64_tr_b16 v[216:217], v55 offset:0
  ds_read_b64_tr_b16 v[218:219], v55 offset:512
  ds_read_b64_tr_b16 v[220:221], v55 offset:8192
  ds_read_b64_tr_b16 v[222:223], v55 offset:8704
  s_waitcnt lgkmcnt(0)
  s_waitcnt vmcnt(32)
  s_barrier
  s_mov_b32 m0, 0
  s_mov_b32 s51, 2097152
  buffer_load_dwordx4 v56, s[20:23], s51 offen lds
  s_mov_b32 m0, 1024
  s_mov_b32 s51, 2129920
  buffer_load_dwordx4 v57, s[20:23], s51 offen lds
  s_mov_b32 m0, 2048
  s_mov_b32 s51, 2162688
  buffer_load_dwordx4 v58, s[20:23], s51 offen lds
  s_mov_b32 m0, 3072
  s_mov_b32 s51, 2195456
  buffer_load_dwordx4 v59, s[20:23], s51 offen lds
  v_add_u32 v54, 16384, v52
  v_add_u32 v55, 16384, v53
  ds_read_b64_tr_b16 v[80:81], v54 offset:0
  ds_read_b64_tr_b16 v[82:83], v54 offset:512
  ds_read_b64_tr_b16 v[84:85], v54 offset:8192
  ds_read_b64_tr_b16 v[86:87], v54 offset:8704
  ds_read_b64_tr_b16 v[88:89], v55 offset:0
  ds_read_b64_tr_b16 v[90:91], v55 offset:512
  ds_read_b64_tr_b16 v[92:93], v55 offset:8192
  ds_read_b64_tr_b16 v[94:95], v55 offset:8704
  s_waitcnt lgkmcnt(0)
  s_waitcnt vmcnt(32)
  s_barrier
  s_mov_b32 m0, 16384
  s_mov_b32 s51, 2097152
  buffer_load_dwordx4 v56, s[12:15], s51 offen lds
  s_mov_b32 m0, 17408
  s_mov_b32 s51, 2129920
  buffer_load_dwordx4 v57, s[12:15], s51 offen lds
  s_mov_b32 m0, 18432
  s_mov_b32 s51, 2162688
  buffer_load_dwordx4 v58, s[12:15], s51 offen lds
  s_mov_b32 m0, 19456
  s_mov_b32 s51, 2195456
  buffer_load_dwordx4 v59, s[12:15], s51 offen lds
  v_add_u32 v54, 32768, v52
  v_add_u32 v55, 32768, v53
  ds_read_b64_tr_b16 v[192:193], v54 offset:0
  ds_read_b64_tr_b16 v[194:195], v54 offset:512
  ds_read_b64_tr_b16 v[196:197], v54 offset:8192
  ds_read_b64_tr_b16 v[198:199], v54 offset:8704
  ds_read_b64_tr_b16 v[200:201], v55 offset:0
  ds_read_b64_tr_b16 v[202:203], v55 offset:512
  ds_read_b64_tr_b16 v[204:205], v55 offset:8192
  ds_read_b64_tr_b16 v[206:207], v55 offset:8704
  s_waitcnt lgkmcnt(0)
  s_barrier
  ds_write_b128 v2, v[192:195] offset:0
  ds_write_b128 v2, v[196:199] offset:1024
  ds_write_b128 v2, v[200:203] offset:2048
  ds_write_b128 v2, v[204:207] offset:3072
  s_waitcnt vmcnt(32)
  s_barrier
  v_add_u32 v54, 49152, v52
  v_add_u32 v55, 49152, v53
  ds_read_b64_tr_b16 v[192:193], v54 offset:0
  ds_read_b64_tr_b16 v[194:195], v54 offset:512
  ds_read_b64_tr_b16 v[196:197], v54 offset:8192
  ds_read_b64_tr_b16 v[198:199], v54 offset:8704
  ds_read_b64_tr_b16 v[200:201], v55 offset:0
  ds_read_b64_tr_b16 v[202:203], v55 offset:512
  ds_read_b64_tr_b16 v[204:205], v55 offset:8192
  ds_read_b64_tr_b16 v[206:207], v55 offset:8704
  s_waitcnt lgkmcnt(0)
  s_barrier
  ds_write_b128 v2, v[192:195] offset:16384
  ds_write_b128 v2, v[196:199] offset:17408
  ds_write_b128 v2, v[200:203] offset:18432
  ds_write_b128 v2, v[204:207] offset:19456
  s_waitcnt vmcnt(28)
  s_barrier
  v_add_u32 v54, 65536, v52
  v_add_u32 v55, 65536, v53
  ds_read_b64_tr_b16 v[224:225], v54 offset:0
  ds_read_b64_tr_b16 v[226:227], v54 offset:512
  ds_read_b64_tr_b16 v[228:229], v54 offset:8192
  ds_read_b64_tr_b16 v[230:231], v54 offset:8704
  ds_read_b64_tr_b16 v[232:233], v55 offset:0
  ds_read_b64_tr_b16 v[234:235], v55 offset:512
  ds_read_b64_tr_b16 v[236:237], v55 offset:8192
  ds_read_b64_tr_b16 v[238:239], v55 offset:8704
  s_waitcnt lgkmcnt(0)
  s_waitcnt vmcnt(24)
  s_barrier
  s_mov_b32 m0, 65536
  s_mov_b32 s51, 1572864
  buffer_load_dwordx4 v56, s[16:19], s51 offen lds
  s_mov_b32 m0, 66560
  s_mov_b32 s51, 1605632
  buffer_load_dwordx4 v57, s[16:19], s51 offen lds
  s_mov_b32 m0, 67584
  s_mov_b32 s51, 1638400
  buffer_load_dwordx4 v58, s[16:19], s51 offen lds
  s_mov_b32 m0, 68608
  s_mov_b32 s51, 1671168
  buffer_load_dwordx4 v59, s[16:19], s51 offen lds
  buffer_load_dwordx2 v[44:45], off, s[8:11], 0 offset:4 sc1
  v_add_u32 v54, 81920, v52
  v_add_u32 v55, 81920, v53
  ds_read_b64_tr_b16 a[96:97], v54 offset:0
  ds_read_b64_tr_b16 a[98:99], v54 offset:512
  ds_read_b64_tr_b16 a[100:101], v54 offset:8192
  ds_read_b64_tr_b16 a[102:103], v54 offset:8704
  ds_read_b64_tr_b16 a[104:105], v55 offset:0
  ds_read_b64_tr_b16 a[106:107], v55 offset:512
  ds_read_b64_tr_b16 a[108:109], v55 offset:8192
  ds_read_b64_tr_b16 a[110:111], v55 offset:8704
  s_waitcnt lgkmcnt(0)
  s_waitcnt vmcnt(25)
  s_barrier
  s_mov_b32 m0, 81920
  s_mov_b32 s51, 2621440
  buffer_load_dwordx4 v56, s[16:19], s51 offen lds
  s_mov_b32 m0, 82944
  s_mov_b32 s51, 2654208
  buffer_load_dwordx4 v57, s[16:19], s51 offen lds
  s_mov_b32 m0, 83968
  s_mov_b32 s51, 2686976
  buffer_load_dwordx4 v58, s[16:19], s51 offen lds
  s_mov_b32 m0, 84992
  s_mov_b32 s51, 2719744
  buffer_load_dwordx4 v59, s[16:19], s51 offen lds
  v_add_u32 v54, 98304, v52
  v_add_u32 v55, 98304, v53
  ds_read_b64_tr_b16 v[96:97], v54 offset:0
  ds_read_b64_tr_b16 v[98:99], v54 offset:512
  ds_read_b64_tr_b16 v[100:101], v54 offset:8192
  ds_read_b64_tr_b16 v[102:103], v54 offset:8704
  ds_read_b64_tr_b16 v[104:105], v55 offset:0
  ds_read_b64_tr_b16 v[106:107], v55 offset:512
  ds_read_b64_tr_b16 v[108:109], v55 offset:8192
  ds_read_b64_tr_b16 v[110:111], v55 offset:8704
  s_waitcnt lgkmcnt(0)
  s_waitcnt vmcnt(25)
  s_barrier
  s_mov_b32 m0, 98304
  s_mov_b32 s51, 3145728
  buffer_load_dwordx4 v56, s[16:19], s51 offen lds
  s_mov_b32 m0, 99328
  s_mov_b32 s51, 3178496
  buffer_load_dwordx4 v57, s[16:19], s51 offen lds
  s_mov_b32 m0, 100352
  s_mov_b32 s51, 3211264
  buffer_load_dwordx4 v58, s[16:19], s51 offen lds
  s_mov_b32 m0, 101376
  s_mov_b32 s51, 3244032
  buffer_load_dwordx4 v59, s[16:19], s51 offen lds
  v_add_u32 v54, 114688, v52
  v_add_u32 v55, 114688, v53
  ds_read_b64_tr_b16 v[240:241], v54 offset:0
  ds_read_b64_tr_b16 v[242:243], v54 offset:512
  ds_read_b64_tr_b16 v[244:245], v54 offset:8192
  ds_read_b64_tr_b16 v[246:247], v54 offset:8704
  ds_read_b64_tr_b16 v[248:249], v55 offset:0
  ds_read_b64_tr_b16 v[250:251], v55 offset:512
  ds_read_b64_tr_b16 v[252:253], v55 offset:8192
  ds_read_b64_tr_b16 v[254:255], v55 offset:8704
  s_waitcnt lgkmcnt(0)
  s_waitcnt vmcnt(25)
  s_barrier
  s_mov_b32 m0, 114688
  s_mov_b32 s51, 4194304
  buffer_load_dwordx4 v56, s[16:19], s51 offen lds
  s_mov_b32 m0, 115712
  s_mov_b32 s51, 4227072
  buffer_load_dwordx4 v57, s[16:19], s51 offen lds
  s_mov_b32 m0, 116736
  s_mov_b32 s51, 4259840
  buffer_load_dwordx4 v58, s[16:19], s51 offen lds
  s_mov_b32 m0, 117760
  s_mov_b32 s51, 4292608
  buffer_load_dwordx4 v59, s[16:19], s51 offen lds
  v_add_u32 v54, 131072, v52
  v_add_u32 v55, 131072, v53
  ds_read_b64_tr_b16 v[112:113], v54 offset:0
  ds_read_b64_tr_b16 v[114:115], v54 offset:512
  ds_read_b64_tr_b16 v[116:117], v54 offset:8192
  ds_read_b64_tr_b16 v[118:119], v54 offset:8704
  ds_read_b64_tr_b16 v[120:121], v55 offset:0
  ds_read_b64_tr_b16 v[122:123], v55 offset:512
  ds_read_b64_tr_b16 v[124:125], v55 offset:8192
  ds_read_b64_tr_b16 v[126:127], v55 offset:8704
  s_waitcnt lgkmcnt(0)
  s_waitcnt vmcnt(25)
  s_barrier
  s_mov_b32 m0, 131072
  s_mov_b32 s51, 2097152
  buffer_load_dwordx4 v56, s[16:19], s51 offen lds
  s_mov_b32 m0, 132096
  s_mov_b32 s51, 2129920
  buffer_load_dwordx4 v57, s[16:19], s51 offen lds
  s_mov_b32 m0, 133120
  s_mov_b32 s51, 2162688
  buffer_load_dwordx4 v58, s[16:19], s51 offen lds
  s_mov_b32 m0, 134144
  s_mov_b32 s51, 2195456
  buffer_load_dwordx4 v59, s[16:19], s51 offen lds
  v_add_u32 v54, 147456, v52
  v_add_u32 v55, 147456, v53
  ds_read_b64_tr_b16 a[0:1], v54 offset:0
  ds_read_b64_tr_b16 a[2:3], v54 offset:512
  ds_read_b64_tr_b16 a[4:5], v54 offset:8192
  ds_read_b64_tr_b16 a[6:7], v54 offset:8704
  ds_read_b64_tr_b16 a[8:9], v55 offset:0
  ds_read_b64_tr_b16 a[10:11], v55 offset:512
  ds_read_b64_tr_b16 a[12:13], v55 offset:8192
  ds_read_b64_tr_b16 a[14:15], v55 offset:8704
  s_waitcnt lgkmcnt(0)
  s_waitcnt vmcnt(25)
  s_barrier
  s_mov_b32 m0, 147456
  s_mov_b32 s51, 2621440
  buffer_load_dwordx4 v56, s[20:23], s51 offen lds
  s_mov_b32 m0, 148480
  s_mov_b32 s51, 2654208
  buffer_load_dwordx4 v57, s[20:23], s51 offen lds
  s_mov_b32 m0, 149504
  s_mov_b32 s51, 2686976
  buffer_load_dwordx4 v58, s[20:23], s51 offen lds
  s_mov_b32 m0, 150528
  s_mov_b32 s51, 2719744
  buffer_load_dwordx4 v59, s[20:23], s51 offen lds
  v_add_u32 v54, 0, v52
  v_add_u32 v55, 0, v53
  ds_read_b64_tr_b16 v[128:129], v54 offset:0
  ds_read_b64_tr_b16 v[130:131], v54 offset:512
  ds_read_b64_tr_b16 v[132:133], v54 offset:8192
  ds_read_b64_tr_b16 v[134:135], v54 offset:8704
  ds_read_b64_tr_b16 v[136:137], v55 offset:0
  ds_read_b64_tr_b16 v[138:139], v55 offset:512
  ds_read_b64_tr_b16 v[140:141], v55 offset:8192
  ds_read_b64_tr_b16 v[142:143], v55 offset:8704
  s_waitcnt lgkmcnt(0)
  s_waitcnt vmcnt(25)
  s_barrier
  s_mov_b32 m0, 0
  s_mov_b32 s51, 2621440
  buffer_load_dwordx4 v56, s[12:15], s51 offen lds
  s_mov_b32 m0, 1024
  s_mov_b32 s51, 2654208
  buffer_load_dwordx4 v57, s[12:15], s51 offen lds
  s_mov_b32 m0, 2048
  s_mov_b32 s51, 2686976
  buffer_load_dwordx4 v58, s[12:15], s51 offen lds
  s_mov_b32 m0, 3072
  s_mov_b32 s51, 2719744
  buffer_load_dwordx4 v59, s[12:15], s51 offen lds
  v_add_u32 v54, 16384, v52
  v_add_u32 v55, 16384, v53
  ds_read_b64_tr_b16 a[16:17], v54 offset:0
  ds_read_b64_tr_b16 a[18:19], v54 offset:512
  ds_read_b64_tr_b16 a[20:21], v54 offset:8192
  ds_read_b64_tr_b16 a[22:23], v54 offset:8704
  ds_read_b64_tr_b16 a[24:25], v55 offset:0
  ds_read_b64_tr_b16 a[26:27], v55 offset:512
  ds_read_b64_tr_b16 a[28:29], v55 offset:8192
  ds_read_b64_tr_b16 a[30:31], v55 offset:8704
  s_waitcnt lgkmcnt(0)
  s_waitcnt vmcnt(25)
  s_barrier
  s_mov_b32 m0, 16384
  s_mov_b32 s51, 3145728
  buffer_load_dwordx4 v56, s[20:23], s51 offen lds
  s_mov_b32 m0, 17408
  s_mov_b32 s51, 3178496
  buffer_load_dwordx4 v57, s[20:23], s51 offen lds
  s_mov_b32 m0, 18432
  s_mov_b32 s51, 3211264
  buffer_load_dwordx4 v58, s[20:23], s51 offen lds
  s_mov_b32 m0, 19456
  s_mov_b32 s51, 3244032
  buffer_load_dwordx4 v59, s[20:23], s51 offen lds
  v_add_u32 v54, 65536, v52
  v_add_u32 v55, 65536, v53
  ds_read_b64_tr_b16 v[192:193], v54 offset:0
  ds_read_b64_tr_b16 v[194:195], v54 offset:512
  ds_read_b64_tr_b16 v[196:197], v54 offset:8192
  ds_read_b64_tr_b16 v[198:199], v54 offset:8704
  ds_read_b64_tr_b16 v[200:201], v55 offset:0
  ds_read_b64_tr_b16 v[202:203], v55 offset:512
  ds_read_b64_tr_b16 v[204:205], v55 offset:8192
  ds_read_b64_tr_b16 v[206:207], v55 offset:8704
  s_waitcnt lgkmcnt(0)
  s_barrier
  ds_write_b128 v2, v[192:195] offset:32768
  ds_write_b128 v2, v[196:199] offset:33792
  ds_write_b128 v2, v[200:203] offset:34816
  ds_write_b128 v2, v[204:207] offset:35840
  s_waitcnt vmcnt(24)
  s_barrier
  v_add_u32 v54, 81920, v52
  v_add_u32 v55, 81920, v53
  ds_read_b64_tr_b16 v[192:193], v54 offset:0
  ds_read_b64_tr_b16 v[194:195], v54 offset:512
  ds_read_b64_tr_b16 v[196:197], v54 offset:8192
  ds_read_b64_tr_b16 v[198:199], v54 offset:8704
  ds_read_b64_tr_b16 v[200:201], v55 offset:0
  ds_read_b64_tr_b16 v[202:203], v55 offset:512
  ds_read_b64_tr_b16 v[204:205], v55 offset:8192
  ds_read_b64_tr_b16 v[206:207], v55 offset:8704
  s_waitcnt lgkmcnt(0)
  s_barrier
  ds_write_b128 v2, v[192:195] offset:49152
  ds_write_b128 v2, v[196:199] offset:50176
  ds_write_b128 v2, v[200:203] offset:51200
  ds_write_b128 v2, v[204:207] offset:52224
  s_waitcnt vmcnt(20)
  s_barrier
  v_add_u32 v54, 98304, v52
  v_add_u32 v55, 98304, v53
  ds_read_b64_tr_b16 v[192:193], v54 offset:0
  ds_read_b64_tr_b16 v[194:195], v54 offset:512
  ds_read_b64_tr_b16 v[196:197], v54 offset:8192
  ds_read_b64_tr_b16 v[198:199], v54 offset:8704
  ds_read_b64_tr_b16 v[200:201], v55 offset:0
  ds_read_b64_tr_b16 v[202:203], v55 offset:512
  ds_read_b64_tr_b16 v[204:205], v55 offset:8192
  ds_read_b64_tr_b16 v[206:207], v55 offset:8704
  s_waitcnt lgkmcnt(0)
  s_barrier
  ds_write_b128 v3, v[192:195] offset:0
  ds_write_b128 v3, v[196:199] offset:1024
  ds_write_b128 v3, v[200:203] offset:2048
  ds_write_b128 v3, v[204:207] offset:3072
  s_waitcnt vmcnt(16)
  s_barrier
  v_add_u32 v54, 114688, v52
  v_add_u32 v55, 114688, v53
  ds_read_b64_tr_b16 v[192:193], v54 offset:0
  ds_read_b64_tr_b16 v[194:195], v54 offset:512
  ds_read_b64_tr_b16 v[196:197], v54 offset:8192
  ds_read_b64_tr_b16 v[198:199], v54 offset:8704
  ds_read_b64_tr_b16 v[200:201], v55 offset:0
  ds_read_b64_tr_b16 v[202:203], v55 offset:512
  ds_read_b64_tr_b16 v[204:205], v55 offset:8192
  ds_read_b64_tr_b16 v[206:207], v55 offset:8704
  s_waitcnt lgkmcnt(0)
  s_barrier
  ds_write_b128 v3, v[192:195] offset:16384
  ds_write_b128 v3, v[196:199] offset:17408
  ds_write_b128 v3, v[200:203] offset:18432
  ds_write_b128 v3, v[204:207] offset:19456
  s_waitcnt vmcnt(12)
L_cwait_81:
  v_readfirstlane_b32 s96, v44
  v_readfirstlane_b32 s97, v45
  s_add_u32 s50, s50, 1
  s_cmp_ge_u32 s50, 262144
  s_cbranch_scc1 L_cwait_81_x
  s_lshl_b32 s96, s96, 8
  s_add_u32 s96, s96, s97
  s_cmp_eq_u32 s96, 2592
  s_cbranch_scc1 L_cwait_81_x
  buffer_load_dwordx2 v[44:45], off, s[8:11], 0 offset:4 sc1
  s_waitcnt vmcnt(0)
  s_branch L_cwait_81
L_cwait_81_x:
  s_lshl_b32 s61, s32, 7
  s_add_u32 s94, s61, 6144
  s_add_u32 s61, s61, 0
  s_barrier
  buffer_load_dword v48, off, s[8:11], 0 offset:128 sc1
  v_add_u32 v54, 131072, v52
  v_add_u32 v55, 131072, v53
  ds_read_b64_tr_b16 a[112:113], v54 offset:0
  ds_read_b64_tr_b16 a[114:115], v54 offset:512
  ds_read_b64_tr_b16 a[116:117], v54 offset:8192
  ds_read_b64_tr_b16 a[118:119], v54 offset:8704
  ds_read_b64_tr_b16 a[120:121], v55 offset:0
  ds_read_b64_tr_b16 a[122:123], v55 offset:512
  ds_read_b64_tr_b16 a[124:125], v55 offset:8192
  ds_read_b64_tr_b16 a[126:127], v55 offset:8704
  s_waitcnt lgkmcnt(0)
  s_waitcnt vmcnt(9)
  s_barrier
  s_mov_b32 m0, 131072
  s_mov_b32 s51, 3145728
  buffer_load_dwordx4 v56, s[12:15], s51 offen lds
  s_mov_b32 m0, 132096
  s_mov_b32 s51, 3178496
  buffer_load_dwordx4 v57, s[12:15], s51 offen lds
  s_mov_b32 m0, 133120
  s_mov_b32 s51, 3211264
  buffer_load_dwordx4 v58, s[12:15], s51 offen lds
  s_mov_b32 m0, 134144
  s_mov_b32 s51, 3244032
  buffer_load_dwordx4 v59, s[12:15], s51 offen lds
  v_add_u32 v54, 147456, v52
  v_add_u32 v55, 147456, v53
  ds_read_b64_tr_b16 v[144:145], v54 offset:0
  ds_read_b64_tr_b16 v[146:147], v54 offset:512
  ds_read_b64_tr_b16 v[148:149], v54 offset:8192
  ds_read_b64_tr_b16 v[150:151], v54 offset:8704
  ds_read_b64_tr_b16 v[152:153], v55 offset:0
  ds_read_b64_tr_b16 v[154:155], v55 offset:512
  ds_read_b64_tr_b16 v[156:157], v55 offset:8192
  ds_read_b64_tr_b16 v[158:159], v55 offset:8704
  s_waitcnt lgkmcnt(0)
  s_waitcnt vmcnt(9)
  s_barrier
  s_mov_b32 m0, 147456
  s_mov_b32 s51, 3670016
  buffer_load_dwordx4 v56, s[20:23], s51 offen lds
  s_mov_b32 m0, 148480
  s_mov_b32 s51, 3702784
  buffer_load_dwordx4 v57, s[20:23], s51 offen lds
  s_mov_b32 m0, 149504
  s_mov_b32 s51, 3735552
  buffer_load_dwordx4 v58, s[20:23], s51 offen lds
  s_mov_b32 m0, 150528
  s_mov_b32 s51, 3768320
  buffer_load_dwordx4 v59, s[20:23], s51 offen lds
  s_getpc_b64 s[34:35]
L_scp_82:
  s_add_u32 s34, s34, L_loop_c0f-L_scp_82
  s_addc_u32 s35, s35, 0
  v_lshlrev_b32 v200, 2, v0
  v_min_u32 v200, L_code_end-L_loop_c0f-4, v200
  v_mov_b32 v201, s35
  v_add_co_u32 v200, vcc, s34, v200
  s_nop 1
  v_addc_co_u32 v201, vcc, 0, v201, vcc
  global_load_dword v202, v[200:201], off
  v_add_u32 v54, 0, v52
  v_add_u32 v55, 0, v53
  ds_read_b64_tr_b16 a[32:33], v54 offset:0
  ds_read_b64_tr_b16 a[34:35], v54 offset:512
  ds_read_b64_tr_b16 a[36:37], v54 offset:8192
  ds_read_b64_tr_b16 a[38:39], v54 offset:8704
  ds_read_b64_tr_b16 a[40:41], v55 offset:0
  ds_read_b64_tr_b16 a[42:43], v55 offset:512
  ds_read_b64_tr_b16 a[44:45], v55 offset:8192
  ds_read_b64_tr_b16 a[46:47], v55 offset:8704
  s_waitcnt lgkmcnt(0)
  s_waitcnt vmcnt(10)
  s_barrier
  s_mov_b32 m0, 0
  s_mov_b32 s51, 3670016
  buffer_load_dwordx4 v56, s[12:15], s51 offen lds
  s_mov_b32 m0, 1024
  s_mov_b32 s51, 3702784
  buffer_load_dwordx4 v57, s[12:15], s51 offen lds
  s_mov_b32 m0, 2048
  s_mov_b32 s51, 3735552
  buffer_load_dwordx4 v58, s[12:15], s51 offen lds
  s_mov_b32 m0, 3072
  s_mov_b32 s51, 3768320
  buffer_load_dwordx4 v59, s[12:15], s51 offen lds
  v_add_u32 v54, 16384, v52
  v_add_u32 v55, 16384, v53
  ds_read_b64_tr_b16 v[160:161], v54 offset:0
  ds_read_b64_tr_b16 v[162:163], v54 offset:512
  ds_read_b64_tr_b16 v[164:165], v54 offset:8192
  ds_read_b64_tr_b16 v[166:167], v54 offset:8704
  ds_read_b64_tr_b16 v[168:169], v55 offset:0
  ds_read_b64_tr_b16 v[170:171], v55 offset:512
  ds_read_b64_tr_b16 v[172:173], v55 offset:8192
  ds_read_b64_tr_b16 v[174:175], v55 offset:8704
  s_waitcnt lgkmcnt(0)
  s_waitcnt vmcnt(9)
  s_barrier
  s_mov_b32 m0, 16384
  s_mov_b32 s51, 3670016
  buffer_load_dwordx4 v56, s[16:19], s51 offen lds
  s_mov_b32 m0, 17408
  s_mov_b32 s51, 3702784
  buffer_load_dwordx4 v57, s[16:19], s51 offen lds
  s_mov_b32 m0, 18432
  s_mov_b32 s51, 3735552
  buffer_load_dwordx4 v58, s[16:19], s51 offen lds
  s_mov_b32 m0, 19456
  s_mov_b32 s51, 3768320
  buffer_load_dwordx4 v59, s[16:19], s51 offen lds
  v_add_u32 v54, 131072, v52
  v_add_u32 v55, 131072, v53
  ds_read_b64_tr_b16 a[48:49], v54 offset:0
  ds_read_b64_tr_b16 a[50:51], v54 offset:512
  ds_read_b64_tr_b16 a[52:53], v54 offset:8192
  ds_read_b64_tr_b16 a[54:55], v54 offset:8704
  ds_read_b64_tr_b16 a[56:57], v55 offset:0
  ds_read_b64_tr_b16 a[58:59], v55 offset:512
  ds_read_b64_tr_b16 a[60:61], v55 offset:8192
  ds_read_b64_tr_b16 a[62:63], v55 offset:8704
  s_waitcnt lgkmcnt(0)
  s_waitcnt vmcnt(9)
  s_barrier
  s_mov_b32 m0, 131072
  s_mov_b32 s51, 4194304
  buffer_load_dwordx4 v56, s[20:23], s51 offen lds
  s_mov_b32 m0, 132096
  s_mov_b32 s51, 4227072
  buffer_load_dwordx4 v57, s[20:23], s51 offen lds
  s_mov_b32 m0, 133120
  s_mov_b32 s51, 4259840
  buffer_load_dwordx4 v58, s[20:23], s51 offen lds
  s_mov_b32 m0, 134144
  s_mov_b32 s51, 4292608
  buffer_load_dwordx4 v59, s[20:23], s51 offen lds
  v_add_u32 v54, 147456, v52
  v_add_u32 v55, 147456, v53
  ds_read_b64_tr_b16 v[176:177], v54 offset:0
  ds_read_b64_tr_b16 v[178:179], v54 offset:512
  ds_read_b64_tr_b16 v[180:181], v54 offset:8192
  ds_read_b64_tr_b16 v[182:183], v54 offset:8704
  ds_read_b64_tr_b16 v[184:185], v55 offset:0
  ds_read_b64_tr_b16 v[186:187], v55 offset:512
  ds_read_b64_tr_b16 v[188:189], v55 offset:8192
  ds_read_b64_tr_b16 v[190:191], v55 offset:8704
  s_waitcnt lgkmcnt(0)
  s_waitcnt vmcnt(8)
  s_barrier
  ds_write_b128 v3, v[28:31] offset:49152
  ds_write_b128 v3, v[32:35] offset:50176
  ds_write_b128 v3, v[36:39] offset:51200
  ds_write_b128 v3, v[40:43] offset:52224
  v_bfe_u32 v44, v0, 6, 2
  v_bfe_u32 v45, v0, 4, 1
  v_lshl_add_u32 v44, v44, 1, v45
  v_mul_u32_u24 v44, 1152, v44
  v_bfe_u32 v45, v0, 8, 2
  v_lshl_add_u32 v44, v45, 5, v44
  v_bfe_u32 v45, v0, 5, 1
  v_lshl_add_u32 v44, v45, 4, v44
  buffer_load_dwordx4 v[28:31], v44, s[28:31], 0 offen offset:0
  buffer_load_dwordx4 v[32:35], v44, s[28:31], 0 offen offset:128
  v_add_u32 v54, 0, v52
  v_add_u32 v55, 0, v53
  ds_read_b64_tr_b16 a[64:65], v54 offset:0
  ds_read_b64_tr_b16 a[66:67], v54 offset:512
  ds_read_b64_tr_b16 a[68:69], v54 offset:8192
  ds_read_b64_tr_b16 a[70:71], v54 offset:8704
  ds_read_b64_tr_b16 a[72:73], v55 offset:0
  ds_read_b64_tr_b16 a[74:75], v55 offset:512
  ds_read_b64_tr_b16 a[76:77], v55 offset:8192
  ds_read_b64_tr_b16 a[78:79], v55 offset:8704
  s_waitcnt lgkmcnt(0)
  s_waitcnt vmcnt(6)
  s_barrier
  s_mov_b32 m0, 0
  s_mov_b32 s51, 4194304
  buffer_load_dwordx4 v56, s[12:15], s51 offen lds
  s_mov_b32 m0, 1024
  s_mov_b32 s51, 4227072
  buffer_load_dwordx4 v57, s[12:15], s51 offen lds
  s_mov_b32 m0, 2048
  s_mov_b32 s51, 4259840
  buffer_load_dwordx4 v58, s[12:15], s51 offen lds
  s_mov_b32 m0, 3072
  s_mov_b32 s51, 4292608
  buffer_load_dwordx4 v59, s[12:15], s51 offen lds
  v_add_u32 v54, 16384, v52
  v_add_u32 v55, 16384, v53
  ds_read_b64_tr_b16 a[128:129], v54 offset:0
  ds_read_b64_tr_b16 a[130:131], v54 offset:512
  ds_read_b64_tr_b16 a[132:133], v54 offset:8192
  ds_read_b64_tr_b16 a[134:135], v54 offset:8704
  ds_read_b64_tr_b16 a[136:137], v55 offset:0
  ds_read_b64_tr_b16 a[138:139], v55 offset:512
  ds_read_b64_tr_b16 a[140:141], v55 offset:8192
  ds_read_b64_tr_b16 a[142:143], v55 offset:8704
  s_waitcnt lgkmcnt(0)
  s_waitcnt vmcnt(6)
  s_barrier
  v_add_u32 v54, 131072, v52
  v_add_u32 v55, 131072, v53
  ds_read_b64_tr_b16 v[192:193], v54 offset:0
  ds_read_b64_tr_b16 v[194:195], v54 offset:512
  ds_read_b64_tr_b16 v[196:197], v54 offset:8192
  ds_read_b64_tr_b16 v[198:199], v54 offset:8704
  ds_read_b64_tr_b16 v[200:201], v55 offset:0
  ds_read_b64_tr_b16 v[202:203], v55 offset:512
  ds_read_b64_tr_b16 v[204:205], v55 offset:8192
  ds_read_b64_tr_b16 v[206:207], v55 offset:8704
  s_waitcnt lgkmcnt(0)
  s_waitcnt vmcnt(0)
  s_barrier
  ds_write_b128 v3, v[12:15] offset:32768
  ds_write_b128 v3, v[16:19] offset:33792
  ds_write_b128 v3, v[20:23] offset:34816
  ds_write_b128 v3, v[24:27] offset:35840
  v_add_u32 v54, 0, v52
  v_add_u32 v55, 0, v53
  ds_read_b64_tr_b16 a[80:81], v54 offset:0
  ds_read_b64_tr_b16 a[82:83], v54 offset:512
  ds_read_b64_tr_b16 a[84:85], v54 offset:8192
  ds_read_b64_tr_b16 a[86:87], v54 offset:8704
  ds_read_b64_tr_b16 a[88:89], v55 offset:0
  ds_read_b64_tr_b16 a[90:91], v55 offset:512
  ds_read_b64_tr_b16 a[92:93], v55 offset:8192
  ds_read_b64_tr_b16 a[94:95], v55 offset:8704
  s_waitcnt lgkmcnt(0)
  v_readfirstlane_b32 s37, v48
  ds_read_b128 v[40:43], v2 offset:0
  ds_read_b128 v[44:47], v2 offset:1024
  ds_read_b128 v[48:51], v2 offset:2048
  ds_read_b128 v[52:55], v2 offset:3072
  ds_read_b128 v[56:59], v2 offset:16384
  ds_read_b128 v[60:63], v2 offset:17408
  v_mov_b64 v[12:13], 0
  v_mov_b64 v[14:15], 0
  v_mov_b64 v[16:17], 0
  v_mov_b64 v[18:19], 0
  v_mov_b64 v[20:21], 0
  v_mov_b64 v[22:23], 0
  s_waitcnt vmcnt(0) lgkmcnt(0)
  v_mov_b64 v[24:25], 0
  v_mov_b64 v[26:27], 0
  s_mov_b32 s28, s4
  s_or_b32 s29, s5, 0x40000
  s_mov_b32 s30, 67108864
  ds_write_b128 v0, v[28:31] offset:16384
  ds_write_b128 v0, v[32:35] offset:17408
  s_cmp_lt_u32 s37, 32
  s_cbranch_scc1 L_enter_c0s
  s_branch L_enter_c0f
.p2align 6
.fill 7, 4, 0xbf800000
L_loop_c0f:
  s_barrier
  s_mov_b32 s45, s42
  v_mov_b64 v[12:13], 0
  v_mov_b64_e64 v[14:15], 0
  v_mov_b64_e64 v[16:17], 0
  v_mov_b64_e64 v[18:19], 0
  buffer_load_dwordx4 v[28:31], v11, s[4:7], s45 offen offset:0 sc1
  buffer_load_dwordx4 v[32:35], v11, s[4:7], s45 offen offset:1024 sc1
  ds_read_b128 v[40:43], v2 offset:0
  ds_read_b128 v[44:47], v2 offset:1024
  ds_read_b128 v[48:51], v2 offset:2048
  ds_read_b128 v[52:55], v2 offset:3072
  ds_read_b128 v[56:59], v2 offset:16384
  ds_read_b128 v[60:63], v2 offset:17408
  s_waitcnt lgkmcnt(0)
  s_waitcnt vmcnt(3)
  v_mov_b64_e64 v[20:21], 0
  v_mov_b64_e64 v[22:23], 0
  v_mov_b64_e64 v[24:25], 0
  v_mov_b64 v[26:27], 0
  s_add_u32 s40, s40, 1
  s_xor_b32 s54, s54, 1
  s_mov_b32 s42, s44
  s_mov_b32 s44, s43
  s_mov_b32 s43, s45
  s_add_u32 s48, s48, 262144
  s_add_u32 s93, s93, 262144
  s_add_u32 s49, s49, 65536
  s_nop 3
  buffer_load_dwordx4 v[28:31], v11, s[4:7], s45 offen offset:0 sc1
  buffer_load_dwordx4 v[32:35], v11, s[4:7], s45 offen offset:1024 sc1
  s_cmp_eq_u32 s40, 63
  s_waitcnt vmcnt(3) lgkmcnt(0)
  v_max3_u32 v36, v28, v29, v30
  v_max_u32_e64 v36, v36, v31
  ds_write_b128 v0, v[28:31] offset:16384
  s_waitcnt vmcnt(2)
  v_max3_u32 v36, v36, v32, v33
  v_max3_u32 v36, v36, v34, v35
  ds_write_b128 v0, v[32:35] offset:17408
  v_cmp_eq_u32_e64 vcc, -1, v36
  s_nop 0
  s_cbranch_vccz L_okB_c0f
L_retB_c0f:
  s_add_u32 s50, s50, 1
  s_mov_b64 exec, vcc
  buffer_load_dwordx4 v[28:31], v11, s[4:7], s45 offen offset:0 sc1
  buffer_load_dwordx4 v[32:35], v11, s[4:7], s45 offen offset:1024 sc1
  s_mov_b64 exec, -1
  s_cmp_ge_u32 s50, 262144
  s_cbranch_scc1 L_chain_end
  s_cmp_eq_u32 s40, 63
  s_waitcnt vmcnt(3)
  v_max3_u32 v36, v28, v29, v30
  v_max_u32_e64 v36, v36, v31
  ds_write_b128 v0, v[28:31] offset:16384
  s_waitcnt vmcnt(2)
  v_max3_u32 v36, v36, v32, v33
  v_max3_u32 v36, v36, v34, v35
  ds_write_b128 v0, v[32:35] offset:17408
  v_cmp_eq_u32_e64 vcc, -1, v36
  s_nop 0
  s_cbranch_vccnz L_retB_c0f
L_okB_c0f:
  s_cbranch_scc1 L_last_0
L_enter_c0f:
  v_smfmac_f32_16x16x64_bf16 v[12:15], v[28:31], v[208:215], v1
  v_smfmac_f32_16x16x64_bf16 v[20:23], v[28:31], v[40:47], v1
  ds_read_b128 v[40:43], v2 offset:18432
  ds_read_b128 v[44:47], v2 offset:19456
  v_smfmac_f32_16x16x64_bf16 v[16:19], v[28:31], v[216:223], v1
  s_waitcnt lgkmcnt(2)
  s_barrier
  ds_read_b128 v[36:39], v0 offset:18432
  v_smfmac_f32_16x16x64_bf16 v[24:27], v[28:31], v[48:55], v1
  ds_read_b128 v[48:51], v2 offset:32768
  ds_read_b128 v[52:55], v2 offset:33792
  s_waitcnt vmcnt(0)
  ds_read_b128 v[28:31], v0 offset:19456
  v_smfmac_f32_16x16x64_bf16 v[12:15], v[32:35], v[224:231], v1
  v_smfmac_f32_16x16x64_bf16 v[20:23], v[32:35], a[96:103], v1
  v_smfmac_f32_16x16x64_bf16 v[16:19], v[32:35], v[232:239], v1
  s_mov_b32 m0, 1024
  s_add_u32 s51, s48, 1024
  buffer_load_dwordx4 v0, s[4:7], s51 offen offset:0 sc1 lds
  v_smfmac_f32_16x16x64_bf16 v[24:27], v[32:35], a[104:111], v1
  s_waitcnt lgkmcnt(3)
  v_smfmac_f32_16x16x64_bf16 v[12:15], v[36:39], v[240:247], v1
  ds_read_b128 v[32:35], v0 offset:20480
  v_smfmac_f32_16x16x64_bf16 v[20:23], v[36:39], v[56:63], v1
  ds_read_b128 v[56:59], v2 offset:34816
  ds_read_b128 v[60:63], v2 offset:35840
  v_smfmac_f32_16x16x64_bf16 v[16:19], v[36:39], v[248:255], v1
  s_mov_b32 m0, 5120
  s_add_u32 s51, s48, 5120
  buffer_load_dwordx4 v0, s[4:7], s51 offen offset:0 sc1 lds
  v_smfmac_f32_16x16x64_bf16 v[24:27], v[36:39], v[40:47], v1
  ds_read_b128 v[40:43], v2 offset:49152
  ds_read_b128 v[44:47], v2 offset:50176
  s_waitcnt lgkmcnt(5)
  v_smfmac_f32_16x16x64_bf16 v[12:15], v[28:31], a[0:7], v1
  ds_read_b128 v[36:39], v0 offset:21504
  v_smfmac_f32_16x16x64_bf16 v[20:23], v[28:31], v[48:55], v1
  ds_read_b128 v[48:51], v2 offset:51200
  ds_read_b128 v[52:55], v2 offset:52224
  v_smfmac_f32_16x16x64_bf16 v[16:19], v[28:31], a[8:15], v1
  s_mov_b32 m0, 8192
  s_add_u32 s51, s48, 16777216
  buffer_load_dwordx4 v0, s[4:7], s51 offen offset:0 sc1 lds
  s_waitcnt lgkmcnt(5)
  v_smfmac_f32_16x16x64_bf16 v[24:27], v[28:31], v[56:63], v1
  ds_read_b128 v[56:59], v3 offset:0
  ds_read_b128 v[60:63], v3 offset:1024
  v_smfmac_f32_16x16x64_bf16 v[12:15], v[32:35], a[16:23], v1
  ds_read_b128 v[28:31], v0 offset:22528
  v_smfmac_f32_16x16x64_bf16 v[20:23], v[32:35], a[112:119], v1
  v_smfmac_f32_16x16x64_bf16 v[16:19], v[32:35], a[24:31], v1
  buffer_load_dwordx4 v0, s[4:7], s51 offen offset:1024 sc1 lds
  v_smfmac_f32_16x16x64_bf16 v[24:27], v[32:35], a[120:127], v1
  s_waitcnt lgkmcnt(5)
  v_smfmac_f32_16x16x64_bf16 v[12:15], v[36:39], a[32:39], v1
  ds_read_b128 v[32:35], v0 offset:24576
  v_smfmac_f32_16x16x64_bf16 v[20:23], v[36:39], v[40:47], v1
  ds_read_b128 v[40:43], v3 offset:2048
  ds_read_b128 v[44:47], v3 offset:3072
  v_smfmac_f32_16x16x64_bf16 v[16:19], v[36:39], a[40:47], v1
  s_mov_b32 m0, 31744
  s_nop 0
  buffer_load_dword v0, s[28:31], s93 idxen sc1 lds
  s_waitcnt lgkmcnt(6)
  v_smfmac_f32_16x16x64_bf16 v[24:27], v[36:39], v[48:55], v1
  ds_read_b128 v[48:51], v3 offset:16384
  ds_read_b128 v[52:55], v3 offset:17408
  s_waitcnt lgkmcnt(5)
  v_smfmac_f32_16x16x64_bf16 v[12:15], v[28:31], a[48:55], v1
  ds_read_b128 v[36:39], v0 offset:23552
  v_smfmac_f32_16x16x64_bf16 v[20:23], v[28:31], v[56:63], v1
  ds_read_b128 v[56:59], v3 offset:18432
  ds_read_b128 v[60:63], v3 offset:19456
  v_smfmac_f32_16x16x64_bf16 v[16:19], v[28:31], a[56:63], v1
  s_waitcnt lgkmcnt(5)
  v_smfmac_f32_16x16x64_bf16 v[24:27], v[28:31], v[40:47], v1
  v_smfmac_f32_16x16x64_bf16 v[12:15], v[32:35], a[80:87], v1
  v_mov_b64 v[40:41], 0
  s_waitcnt lgkmcnt(3)
  v_smfmac_f32_16x16x64_bf16 v[20:23], v[32:35], v[48:55], v1
  v_smfmac_f32_16x16x64_bf16 v[16:19], v[32:35], a[88:95], v1
  v_mov_b64 v[42:43], 0
  s_waitcnt lgkmcnt(0)
  v_smfmac_f32_16x16x64_bf16 v[24:27], v[32:35], v[56:63], v1
  v_smfmac_f32_16x16x64_bf16 v[12:15], v[36:39], a[64:71], v1
  v_mov_b64 v[44:45], 0
  v_smfmac_f32_16x16x64_bf16 v[20:23], v[36:39], a[128:135], v1
  v_mov_b64_e64 v[46:47], 0
  v_smfmac_f32_16x16x64_bf16 v[16:19], v[36:39], a[72:79], v1
  v_smfmac_f32_16x16x64_bf16 v[24:27], v[36:39], a[136:143], v1
  v_pk_add_f32 v[12:13], v[12:13], v[14:15]
  v_pk_add_f32 v[20:21], v[20:21], v[22:23]
  v_cvt_pk_bf16_f32 v23, v12, v13
  v_cvt_pk_bf16_f32 v22, v20, v21
  ds_write_b64 v5, v[22:23] offset:0
  v_pk_add_f32 v[16:17], v[16:17], v[18:19]
  s_nop 1
  v_pk_add_f32 v[24:25], v[24:25], v[26:27]
  v_cvt_pk_bf16_f32 v27, v16, v17
  v_cvt_pk_bf16_f32 v26, v24, v25
  ds_write_b64 v5, v[26:27] offset:512
  v_smfmac_f32_16x16x64_bf16 v[40:43], v[28:31], v[160:167], v1
  v_xor_b32 v52, 16, v6
  s_waitcnt vmcnt(3)
  ds_read_b128 v[60:63], v0 offset:1024
  v_smfmac_f32_16x16x64_bf16 v[44:47], v[28:31], v[168:175], v1
  ds_read_b128 v[28:31], v0 offset:16384
  ds_read_b128 v[48:51], v0 offset:5120
  v_smfmac_f32_16x16x64_bf16 v[40:43], v[32:35], v[192:199], v1
  v_smfmac_f32_16x16x64_bf16 v[44:47], v[32:35], v[200:207], v1
  ds_read_b128 v[32:35], v0 offset:17408
  v_smfmac_f32_16x16x64_bf16 v[40:43], v[36:39], v[176:183], v1
  s_waitcnt lgkmcnt(4)
  s_barrier
  ds_read_b64_tr_b16 v[12:13], v6 offset:1024
  ds_read_b64_tr_b16 v[14:15], v52 offset:1280
  ds_read_b64_tr_b16 v[16:17], v6 offset:2048
  ds_read_b64_tr_b16 v[18:19], v52 offset:2304
  v_smfmac_f32_16x16x64_bf16 v[44:47], v[36:39], v[184:191], v1
  ds_read_b64_tr_b16 v[20:21], v6 offset:3072
  ds_read_b64_tr_b16 v[22:23], v52 offset:3328
  s_waitcnt lgkmcnt(8)
  v_smfmac_f32_16x16x64_bf16 v[40:43], v[28:31], v[64:71], v1
  ds_read_b64_tr_b16 v[24:25], v6 offset:0
  ds_read_b64_tr_b16 v[26:27], v52 offset:256
  v_smfmac_f32_16x16x64_bf16 v[44:47], v[28:31], v[72:79], v1
  ds_read_b128 v[28:31], v0 offset:18432
  s_waitcnt lgkmcnt(9)
  v_smfmac_f32_16x16x64_bf16 v[40:43], v[32:35], v[80:87], v1
  v_smfmac_f32_16x16x64_bf16 v[44:47], v[32:35], v[88:95], v1
  ds_read_b128 v[32:35], v0 offset:19456
  s_waitcnt lgkmcnt(8)
  v_mfma_f32_16x16x32_bf16 v[56:59], v[60:63], v[12:15], 0
  ds_read_b128 v[36:39], v0 offset:2048
  v_mfma_f32_16x16x32_bf16 v[60:63], v[48:51], v[12:15], 0
  ds_read_b128 v[48:51], v0 offset:6144
  v_mfma_f32_16x16x32_bf16 v[52:55], v[12:15], v[12:15], 0
  ds_read_b128 v[12:15], v0 offset:3072
  s_waitcnt lgkmcnt(9)
  v_mfma_f32_16x16x32_bf16 v[52:55], v[16:19], v[16:19], v[52:55]
  s_waitcnt lgkmcnt(2)
  v_mfma_f32_16x16x32_bf16 v[56:59], v[36:39], v[16:19], v[56:59]
  ds_read_b128 v[36:39], v0 offset:7168
  s_waitcnt lgkmcnt(2)
  v_mfma_f32_16x16x32_bf16 v[60:63], v[48:51], v[16:19], v[60:63]
  ds_read_b128 v[48:51], v0 offset:0
  ds_read_b128 v[16:19], v0 offset:4096
  v_mfma_f32_16x16x32_bf16 v[52:55], v[20:23], v[20:23], v[52:55]
  s_waitcnt lgkmcnt(3)
  v_mfma_f32_16x16x32_bf16 v[56:59], v[12:15], v[20:23], v[56:59]
  s_waitcnt lgkmcnt(2)
  v_mfma_f32_16x16x32_bf16 v[60:63], v[36:39], v[20:23], v[60:63]
  s_waitcnt vmcnt(1)
  ds_read_b128 v[20:23], v0 offset:8192
  ds_read_b128 v[12:15], v0 offset:9216
  v_mfma_f32_16x16x32_bf16 v[52:55], v[24:27], v[24:27], v[52:55]
  s_waitcnt lgkmcnt(3)
  v_mfma_f32_16x16x32_bf16 v[56:59], v[48:51], v[24:27], v[56:59]
  s_waitcnt lgkmcnt(2)
  v_mfma_f32_16x16x32_bf16 v[60:63], v[16:19], v[24:27], v[60:63]
  v_smfmac_f32_16x16x64_bf16 v[40:43], v[28:31], v[96:103], v1
  buffer_store_dwordx4 v[24:27], v9, s[4:7], s49 offen offset:0 sc1
  v_mov_b32 v36, 0x3f803f80
  v_mov_b32 v37, 0x3f803f80
  v_max3_f32 v48, v52, v53, v56
  v_max3_f32 v48, v48, v57, v58
  v_max3_f32 v48, v48, v59, v60
  v_max3_f32 v48, v48, v61, v62
  v_max_f32 v49, v48, v63
  v_max_f32 v48, v48, v63
  v_smfmac_f32_16x16x64_bf16 v[44:47], v[28:31], v[104:111], v1
  ds_read_b128 v[28:31], v0 offset:20480
  v_mov_b64 v[38:39], v[36:37]
  v_permlane32_swap_b32 v48, v49
  v_max_f32 v48, v48, v49
  v_mov_b32 v49, v48
  v_smfmac_f32_16x16x64_bf16 v[40:43], v[32:35], v[112:119], v1
  v_mov_b64 v[16:17], 0
  v_permlane16_swap_b32 v48, v49
  v_max_f32 v48, v48, v49
  v_mul_f32 v48, s47, v48
  v_pk_fma_f32 v[56:57], v[56:57], s[46:47], v[48:49] op_sel_hi:[1,0,0]
  v_pk_fma_f32 v[58:59], v[58:59], s[46:47], v[48:49] op_sel_hi:[1,0,0]
  v_pk_fma_f32 v[60:61], v[60:61], s[46:47], v[48:49] op_sel_hi:[1,0,0]
  v_pk_fma_f32 v[62:63], v[62:63], s[46:47], v[48:49] op_sel_hi:[1,0,0]
  v_pk_fma_f32 v[52:53], v[52:53], s[46:47], v[48:49] op_sel_hi:[1,0,0]
  v_smfmac_f32_16x16x64_bf16 v[44:47], v[32:35], v[120:127], v1
  ds_read_b128 v[32:35], v0 offset:21504
  v_exp_f32 v56, v56
  v_exp_f32 v57, v57
  s_waitcnt lgkmcnt(1)
  v_smfmac_f32_16x16x64_bf16 v[40:43], v[28:31], v[128:135], v1
  v_exp_f32 v58, v58
  v_exp_f32 v59, v59
  v_smfmac_f32_16x16x64_bf16 v[44:47], v[28:31], v[136:143], v1
  v_exp_f32 v60, v60
  v_exp_f32 v61, v61
  s_waitcnt lgkmcnt(0)
  v_smfmac_f32_16x16x64_bf16 v[40:43], v[32:35], v[144:151], v1
  v_exp_f32 v62, v62
  v_exp_f32 v63, v63
  v_smfmac_f32_16x16x64_bf16 v[44:47], v[32:35], v[152:159], v1
  v_exp_f32 v52, v52
  v_exp_f32 v53, v53
  ds_read_b128 v[28:31], v3 offset:32768
  ds_read_b128 v[32:35], v3 offset:33792
  v_mov_b64 v[18:19], 0
  v_cvt_pk_bf16_f32 v24, v56, v57
  v_cvt_pk_bf16_f32 v25, v58, v59
  v_cvt_pk_bf16_f32 v26, v60, v61
  v_cvt_pk_bf16_f32 v27, v62, v63
  v_cvt_pk_bf16_f32 v16, v52, v53
  v_cvt_pk_bf16_f32 v19, v52, v53
  v_mfma_f32_16x16x32_bf16 v[52:55], v[36:39], v[24:27], 0
  v_add_f32 v40, v40, v42
  v_add_f32 v41, v41, v43
  v_mfma_f32_16x16x32_bf16 v[56:59], v[20:23], v[24:27], 0
  v_add_f32 v44, v44, v46
  v_add_f32 v45, v45, v47
  v_mfma_f32_16x16x32_bf16 v[60:63], v[12:15], v[24:27], 0
  v_cvt_pk_bf16_f32 v40, v40, v41
  v_cvt_pk_bf16_f32 v41, v44, v45
  s_add_u32 s51, s49, 4194304
  v_lshrrev_b32 v50, 1, v0
  v_mfma_f32_16x16x16_bf16 v[52:55], v[36:37], v[16:17], v[52:55]
  v_mov_b64 v[44:45], 0
  v_mov_b64 v[46:47], 0
  v_mfma_f32_16x16x16_bf16 v[56:59], v[40:41], v[16:17], v[56:59]
  buffer_store_dwordx2 v[40:41], v50, s[4:7], s51 offen offset:0 sc1
  v_mov_b64 v[12:13], 0
  v_mov_b64 v[14:15], 0
  v_mfma_f32_16x16x16_bf16 v[60:63], v[40:41], v[18:19], v[60:63]
  s_nop 0
  v_rcp_f32 v48, v52
  v_mov_b64 v[36:37], 0
  v_mov_b64_e64 v[38:39], 0
  s_mov_b64 exec, s[52:53]
  v_pk_mul_f32 v[56:57], v[56:57], v[48:49] op_sel_hi:[1,0]
  v_pk_mul_f32 v[58:59], v[58:59], v[48:49] op_sel_hi:[1,0]
  v_cvt_pk_bf16_f32 v56, v56, v57
  v_cvt_pk_bf16_f32 v57, v58, v59
  ds_write_b64 v7, v[56:57] offset:0
  v_pk_mul_f32 v[60:61], v[60:61], v[48:49] op_sel_hi:[1,0]
  v_pk_mul_f32 v[62:63], v[62:63], v[48:49] op_sel_hi:[1,0]
  v_cvt_pk_bf16_f32 v60, v60, v61
  v_cvt_pk_bf16_f32 v61, v62, v63
  ds_write_b64 v7, v[60:61] offset:256
  s_mov_b64 exec, -1
  v_mov_b32 v58, 0
  v_mov_b32 v59, 0
  v_mov_b32 v56, 0
  v_mov_b32 v57, 0
  s_waitcnt lgkmcnt(0)
  s_barrier
  v_mov_b32 v60, 0
  ds_read_b128 v[16:19], v4 offset:29696
  ds_read_b128 v[40:43], v4 offset:30208
  ds_read_b128 v[48:51], v4 offset:30720
  v_mov_b32 v61, 0
  ds_read_b128 v[52:55], v4 offset:31232
  ds_read_b128 v[20:23], v3 offset:34816
  ds_read_b128 v[24:27], v3 offset:35840
  s_nop 1
  v_mov_b32 v62, 0
  s_nop 2
  v_mov_b32_e64 v63, 0
  s_waitcnt lgkmcnt(5)
  v_smfmac_f32_16x16x64_bf16 v[44:47], v[16:19], a[160:167], v1
  s_waitcnt lgkmcnt(4)
  v_smfmac_f32_16x16x64_bf16 v[44:47], v[40:43], v[28:35], v1
  ds_read_b128 v[28:31], v3 offset:49152
  ds_read_b128 v[32:35], v3 offset:50176
  s_waitcnt lgkmcnt(5)
  v_smfmac_f32_16x16x64_bf16 v[44:47], v[48:51], a[168:175], v1
  s_waitcnt lgkmcnt(4)
  v_smfmac_f32_16x16x64_bf16 v[44:47], v[52:55], a[176:183], v1
  s_waitcnt lgkmcnt(2)
  v_smfmac_f32_16x16x64_bf16 v[12:15], v[16:19], v[20:27], v1
  ds_read_b128 v[20:23], v3 offset:51200
  ds_read_b128 v[24:27], v3 offset:52224
  v_smfmac_f32_16x16x64_bf16 v[12:15], v[40:43], a[184:191], v1
  s_nop 0
  v_cvt_pk_bf16_f32 v44, v44, v45
  v_cvt_pk_bf16_f32 v45, v46, v47
  v_smfmac_f32_16x16x64_bf16 v[12:15], v[48:51], a[192:199], v1
  v_bfi_b32 v44, 1, s54, v44
  v_bfi_b32 v45, 1, s54, v45
  buffer_store_dwordx2 v[44:45], v8, s[4:7], s89 offen
  v_smfmac_f32_16x16x64_bf16 v[12:15], v[52:55], a[200:207], v1
  s_waitcnt lgkmcnt(2)
  v_smfmac_f32_16x16x64_bf16 v[36:39], v[16:19], v[28:35], v1
  ds_read_b128 v[28:31], v0 offset:29696
  ds_read_b128 v[32:35], v0 offset:30720
  v_smfmac_f32_16x16x64_bf16 v[36:39], v[40:43], a[208:215], v1
  s_nop 0
  v_cvt_pk_bf16_f32 v12, v12, v13
  v_cvt_pk_bf16_f32 v13, v14, v15
  v_smfmac_f32_16x16x64_bf16 v[36:39], v[48:51], a[216:223], v1
  v_bfi_b32 v12, 1, s54, v12
  v_bfi_b32 v13, 1, s54, v13
  buffer_store_dwordx2 v[12:13], v8, s[4:7], s90 offen
  v_smfmac_f32_16x16x64_bf16 v[36:39], v[52:55], a[224:231], v1
  s_waitcnt lgkmcnt(2)
  v_smfmac_f32_16x16x64_bf16 v[56:59], v[16:19], v[20:27], v1
  v_smfmac_f32_16x16x64_bf16 v[56:59], v[40:43], a[232:239], v1
  s_nop 0
  v_cvt_pk_bf16_f32 v36, v36, v37
  v_cvt_pk_bf16_f32 v37, v38, v39
  v_smfmac_f32_16x16x64_bf16 v[56:59], v[48:51], a[240:247], v1
  v_bfi_b32 v36, 1, s54, v36
  v_bfi_b32 v37, 1, s54, v37
  buffer_store_dwordx2 v[36:37], v8, s[4:7], s91 offen
  v_smfmac_f32_16x16x64_bf16 v[56:59], v[52:55], a[248:255], v1
  s_waitcnt lgkmcnt(1)
  v_smfmac_f32_16x16x64_bf16 v[60:63], v[28:31], a[144:151], v1
  s_waitcnt lgkmcnt(0)
  v_smfmac_f32_16x16x64_bf16 v[60:63], v[32:35], a[152:159], v1
  s_nop 0
  v_cvt_pk_bf16_f32 v56, v56, v57
  v_cvt_pk_bf16_f32 v57, v58, v59
  v_bfi_b32 v56, 1, s54, v56
  v_bfi_b32 v57, 1, s54, v57
  buffer_store_dwordx2 v[56:57], v8, s[4:7], s92 offen
  s_nop 1
  v_pk_add_f32 v[60:61], v[60:61], v[62:63]
  v_cvt_pk_bf16_f32 v60, v60, v61
  v_bfi_b32 v60, 1, s54, v60
  buffer_store_dword v60, v8, s[4:7], s88 offen offset:0
  v_mov_b32 v51, -1
  buffer_store_dword v51, v10, s[4:7], s44 offen
  s_waitcnt vmcnt(3)
  s_nop 3
  buffer_load_dwordx4 v[20:23], v0, s[4:7], s41 offen offset:0 sc1
  buffer_load_dwordx4 v[24:27], v0, s[4:7], s41 offen offset:1024 sc1
  buffer_load_dwordx4 v[28:31], v0, s[4:7], s41 offen offset:2048 sc1
  buffer_load_dwordx4 v[32:35], v0, s[4:7], s41 offen offset:3072 sc1
  s_nop 7
  s_nop 3
  v_bfe_u32 v48, v0, 4, 1
  v_lshlrev_b32 v48, 4, v48
  v_mov_b32 v49, 0x3f80
  v_lshlrev_b32 v49, v48, v49
  v_bfe_u32 v48, v0, 5, 3
  v_cmp_eq_u32_e64 vcc, 0, v48
  s_nop 1
  v_cndmask_b32_e64 v36, 0, v49, vcc
  v_cmp_eq_u32 vcc, 1, v48
  s_nop 1
  v_cndmask_b32 v37, 0, v49, vcc
  v_cmp_eq_u32_e64 vcc, 2, v48
  s_nop 1
  v_cndmask_b32_e64 v38, 0, v49, vcc
  v_cmp_eq_u32 vcc, 3, v48
  s_nop 1
  v_cndmask_b32 v39, 0, v49, vcc
  buffer_load_dwordx4 v[20:23], v0, s[4:7], s41 offen offset:0 sc1
  buffer_load_dwordx4 v[24:27], v0, s[4:7], s41 offen offset:1024 sc1
  buffer_load_dwordx4 v[28:31], v0, s[4:7], s41 offen offset:2048 sc1
  buffer_load_dwordx4 v[32:35], v0, s[4:7], s41 offen offset:3072 sc1
  s_waitcnt vmcnt(7)
  v_bitop3_b32 v48, v20, v21, s54 bitop3:0x7e
  v_bitop3_b32 v49, v22, v23, s54 bitop3:0x7e
  v_mfma_f32_16x16x32_bf16 v[40:43], v[20:23], v[36:39], 0
  v_or_b32 v50, v48, v49
  s_waitcnt vmcnt(6)
  v_bitop3_b32 v48, v24, v25, s54 bitop3:0x7e
  v_bitop3_b32 v49, v26, v27, s54 bitop3:0x7e
  v_mfma_f32_16x16x32_bf16 v[40:43], v[24:27], v[36:39], v[40:43]
  v_or3_b32 v50, v50, v48, v49
  s_waitcnt vmcnt(5)
  v_bitop3_b32 v48, v28, v29, s54 bitop3:0x7e
  v_bitop3_b32 v49, v30, v31, s54 bitop3:0x7e
  v_mfma_f32_16x16x32_bf16 v[40:43], v[28:31], v[36:39], v[40:43]
  v_or3_b32 v50, v50, v48, v49
  s_waitcnt vmcnt(4)
  v_bitop3_b32 v48, v32, v33, s54 bitop3:0x7e
  v_bitop3_b32 v49, v34, v35, s54 bitop3:0x7e
  v_mfma_f32_16x16x32_bf16 v[40:43], v[32:35], v[36:39], v[40:43]
  v_or3_b32 v50, v50, v48, v49
  v_and_b32_e64 v50, 1, v50
  v_cmp_eq_u32 vcc, 1, v50
  s_nop 0
  s_cbranch_vccz L_okA_c0f
L_retA_c0f:
  s_add_u32 s50, s50, 1
  s_mov_b64 exec, vcc
  buffer_load_dwordx4 v[20:23], v0, s[4:7], s41 offen offset:0 sc1
  buffer_load_dwordx4 v[24:27], v0, s[4:7], s41 offen offset:1024 sc1
  buffer_load_dwordx4 v[28:31], v0, s[4:7], s41 offen offset:2048 sc1
  buffer_load_dwordx4 v[32:35], v0, s[4:7], s41 offen offset:3072 sc1
  s_mov_b64 exec, -1
  s_cmp_ge_u32 s50, 262144
  s_cbranch_scc1 L_chain_end
  s_waitcnt vmcnt(7)
  v_bitop3_b32 v48, v20, v21, s54 bitop3:0x7e
  v_bitop3_b32 v49, v22, v23, s54 bitop3:0x7e
  v_mfma_f32_16x16x32_bf16 v[40:43], v[20:23], v[36:39], 0
  v_or_b32 v50, v48, v49
  s_waitcnt vmcnt(6)
  v_bitop3_b32 v48, v24, v25, s54 bitop3:0x7e
  v_bitop3_b32 v49, v26, v27, s54 bitop3:0x7e
  v_mfma_f32_16x16x32_bf16 v[40:43], v[24:27], v[36:39], v[40:43]
  v_or3_b32 v50, v50, v48, v49
  s_waitcnt vmcnt(5)
  v_bitop3_b32 v48, v28, v29, s54 bitop3:0x7e
  v_bitop3_b32 v49, v30, v31, s54 bitop3:0x7e
  v_mfma_f32_16x16x32_bf16 v[40:43], v[28:31], v[36:39], v[40:43]
  v_or3_b32 v50, v50, v48, v49
  s_waitcnt vmcnt(4)
  v_bitop3_b32 v48, v32, v33, s54 bitop3:0x7e
  v_bitop3_b32 v49, v34, v35, s54 bitop3:0x7e
  v_mfma_f32_16x16x32_bf16 v[40:43], v[32:35], v[36:39], v[40:43]
  v_or3_b32 v50, v50, v48, v49
  v_and_b32 v50, 1, v50
  v_cmp_eq_u32_e64 vcc, 1, v50
  s_nop 0
  s_cbranch_vccnz L_retA_c0f
L_okA_c0f:
  s_nop 2
  v_permlane32_swap_b32 v40, v42
  v_permlane32_swap_b32 v41, v43
  v_add_f32 v40, v40, v42
  v_add_f32 v41, v41, v43
  v_cvt_pk_bf16_f32 v40, v40, v41
  buffer_store_dword v40, v10, s[4:7], s42 offen
  s_branch L_loop_c0f
L_loop_c0s:
  s_barrier
  s_mov_b32 s45, s42
  v_mov_b64 v[12:13], 0
  v_mov_b64 v[14:15], 0
  v_mov_b64 v[16:17], 0
  v_mov_b64 v[18:19], 0
  buffer_load_dwordx4 v[28:31], v11, s[4:7], s45 offen offset:0 sc1
  buffer_load_dwordx4 v[32:35], v11, s[4:7], s45 offen offset:1024 sc1
  ds_read_b128 v[40:43], v2 offset:0
  ds_read_b128 v[44:47], v2 offset:1024
  ds_read_b128 v[48:51], v2 offset:2048
  ds_read_b128 v[52:55], v2 offset:3072
  ds_read_b128 v[56:59], v2 offset:16384
  ds_read_b128 v[60:63], v2 offset:17408
  s_waitcnt lgkmcnt(0)
  s_waitcnt vmcnt(3)
  v_mov_b64 v[20:21], 0
  v_mov_b64 v[22:23], 0
  v_mov_b64 v[24:25], 0
  v_mov_b64 v[26:27], 0
  s_add_u32 s40, s40, 1
  s_xor_b32 s54, s54, 1
  s_mov_b32 s42, s44
  s_mov_b32 s44, s43
  s_mov_b32 s43, s45
  s_add_u32 s48, s48, 262144
  s_add_u32 s93, s93, 262144
  s_add_u32 s49, s49, 65536
  s_nop 3
  buffer_load_dwordx4 v[28:31], v11, s[4:7], s45 offen offset:0 sc1
  buffer_load_dwordx4 v[32:35], v11, s[4:7], s45 offen offset:1024 sc1
  s_cmp_eq_u32 s40, 63
  s_waitcnt vmcnt(3) lgkmcnt(0)
  v_max3_u32 v36, v28, v29, v30
  v_max_u32 v36, v36, v31
  ds_write_b128 v0, v[28:31] offset:16384
  s_waitcnt vmcnt(2)
  v_max3_u32 v36, v36, v32, v33
  v_max3_u32 v36, v36, v34, v35
  ds_write_b128 v0, v[32:35] offset:17408
  v_cmp_eq_u32 vcc, -1, v36
  s_nop 0
  s_cbranch_vccz L_okB_c0s
L_retB_c0s:
  s_add_u32 s50, s50, 1
  s_mov_b64 exec, vcc
  buffer_load_dwordx4 v[28:31], v11, s[4:7], s45 offen offset:0 sc1
  buffer_load_dwordx4 v[32:35], v11, s[4:7], s45 offen offset:1024 sc1
  s_mov_b64 exec, -1
  s_cmp_ge_u32 s50, 262144
  s_cbranch_scc1 L_chain_end
  s_cmp_eq_u32 s40, 63
  s_waitcnt vmcnt(3)
  v_max3_u32 v36, v28, v29, v30
  v_max_u32 v36, v36, v31
  ds_write_b128 v0, v[28:31] offset:16384
  s_waitcnt vmcnt(2)
  v_max3_u32 v36, v36, v32, v33
  v_max3_u32 v36, v36, v34, v35
  ds_write_b128 v0, v[32:35] offset:17408
  v_cmp_eq_u32 vcc, -1, v36
  s_nop 0
  s_cbranch_vccnz L_retB_c0s
L_okB_c0s:
  s_cbranch_scc1 L_last_0
L_enter_c0s:
  v_smfmac_f32_16x16x64_bf16 v[12:15], v[28:31], v[208:215], v1
  v_smfmac_f32_16x16x64_bf16 v[20:23], v[28:31], v[40:47], v1
  ds_read_b128 v[40:43], v2 offset:18432
  ds_read_b128 v[44:47], v2 offset:19456
  v_smfmac_f32_16x16x64_bf16 v[16:19], v[28:31], v[216:223], v1
  s_waitcnt lgkmcnt(2)
  s_barrier
  ds_read_b128 v[36:39], v0 offset:18432
  v_smfmac_f32_16x16x64_bf16 v[24:27], v[28:31], v[48:55], v1
  ds_read_b128 v[48:51], v2 offset:32768
  ds_read_b128 v[52:55], v2 offset:33792
  s_waitcnt vmcnt(0)
  ds_read_b128 v[28:31], v0 offset:19456
  v_smfmac_f32_16x16x64_bf16 v[12:15], v[32:35], v[224:231], v1
  v_smfmac_f32_16x16x64_bf16 v[20:23], v[32:35], a[96:103], v1
  v_smfmac_f32_16x16x64_bf16 v[16:19], v[32:35], v[232:239], v1
  s_mov_b32 m0, 1024
  s_add_u32 s51, s48, 1024
  buffer_load_dwordx4 v0, s[4:7], s51 offen offset:0 sc1 lds
  v_smfmac_f32_16x16x64_bf16 v[24:27], v[32:35], a[104:111], v1
  s_waitcnt lgkmcnt(3)
  v_smfmac_f32_16x16x64_bf16 v[12:15], v[36:39], v[240:247], v1
  ds_read_b128 v[32:35], v0 offset:20480
  v_smfmac_f32_16x16x64_bf16 v[20:23], v[36:39], v[56:63], v1
  ds_read_b128 v[56:59], v2 offset:34816
  ds_read_b128 v[60:63], v2 offset:35840
  v_smfmac_f32_16x16x64_bf16 v[16:19], v[36:39], v[248:255], v1
  s_mov_b32 m0, 5120
  s_add_u32 s51, s48, 5120
  buffer_load_dwordx4 v0, s[4:7], s51 offen offset:0 sc1 lds
  v_smfmac_f32_16x16x64_bf16 v[24:27], v[36:39], v[40:47], v1
  ds_read_b128 v[40:43], v2 offset:49152
  ds_read_b128 v[44:47], v2 offset:50176
  s_waitcnt lgkmcnt(5)
  v_smfmac_f32_16x16x64_bf16 v[12:15], v[28:31], a[0:7], v1
  ds_read_b128 v[36:39], v0 offset:21504
  v_smfmac_f32_16x16x64_bf16 v[20:23], v[28:31], v[48:55], v1
  ds_read_b128 v[48:51], v2 offset:51200
  ds_read_b128 v[52:55], v2 offset:52224
  v_smfmac_f32_16x16x64_bf16 v[16:19], v[28:31], a[8:15], v1
  s_mov_b32 m0, 8192
  s_add_u32 s51, s48, 16777216
  buffer_load_dwordx4 v0, s[4:7], s51 offen offset:0 sc1 lds
  s_waitcnt lgkmcnt(5)
  v_smfmac_f32_16x16x64_bf16 v[24:27], v[28:31], v[56:63], v1
  ds_read_b128 v[56:59], v3 offset:0
  ds_read_b128 v[60:63], v3 offset:1024
  v_smfmac_f32_16x16x64_bf16 v[12:15], v[32:35], a[16:23], v1
  ds_read_b128 v[28:31], v0 offset:22528
  v_smfmac_f32_16x16x64_bf16 v[20:23], v[32:35], a[112:119], v1
  v_smfmac_f32_16x16x64_bf16 v[16:19], v[32:35], a[24:31], v1
  buffer_load_dwordx4 v0, s[4:7], s51 offen offset:1024 sc1 lds
  v_smfmac_f32_16x16x64_bf16 v[24:27], v[32:35], a[120:127], v1
  s_waitcnt lgkmcnt(5)
  v_smfmac_f32_16x16x64_bf16 v[12:15], v[36:39], a[32:39], v1
  ds_read_b128 v[32:35], v0 offset:24576
  v_smfmac_f32_16x16x64_bf16 v[20:23], v[36:39], v[40:47], v1
  ds_read_b128 v[40:43], v3 offset:2048
  ds_read_b128 v[44:47], v3 offset:3072
  v_smfmac_f32_16x16x64_bf16 v[16:19], v[36:39], a[40:47], v1
  s_mov_b32 m0, 31744
  s_nop 0
  buffer_load_dword v0, s[28:31], s93 idxen sc1 lds
  s_waitcnt lgkmcnt(6)
  v_smfmac_f32_16x16x64_bf16 v[24:27], v[36:39], v[48:55], v1
  ds_read_b128 v[48:51], v3 offset:16384
  ds_read_b128 v[52:55], v3 offset:17408
  s_waitcnt lgkmcnt(5)
  v_smfmac_f32_16x16x64_bf16 v[12:15], v[28:31], a[48:55], v1
  ds_read_b128 v[36:39], v0 offset:23552
  v_smfmac_f32_16x16x64_bf16 v[20:23], v[28:31], v[56:63], v1
  ds_read_b128 v[56:59], v3 offset:18432
  ds_read_b128 v[60:63], v3 offset:19456
  v_smfmac_f32_16x16x64_bf16 v[16:19], v[28:31], a[56:63], v1
  s_waitcnt lgkmcnt(5)
  v_smfmac_f32_16x16x64_bf16 v[24:27], v[28:31], v[40:47], v1
  v_smfmac_f32_16x16x64_bf16 v[12:15], v[32:35], a[80:87], v1
  v_mov_b64 v[40:41], 0
  s_waitcnt lgkmcnt(3)
  v_smfmac_f32_16x16x64_bf16 v[20:23], v[32:35], v[48:55], v1
  v_smfmac_f32_16x16x64_bf16 v[16:19], v[32:35], a[88:95], v1
  v_mov_b64 v[42:43], 0
  s_waitcnt lgkmcnt(0)
  v_smfmac_f32_16x16x64_bf16 v[24:27], v[32:35], v[56:63], v1
  v_smfmac_f32_16x16x64_bf16 v[12:15], v[36:39], a[64:71], v1
  v_mov_b64 v[44:45], 0
  v_smfmac_f32_16x16x64_bf16 v[20:23], v[36:39], a[128:135], v1
  v_mov_b64 v[46:47], 0
  v_smfmac_f32_16x16x64_bf16 v[16:19], v[36:39], a[72:79], v1
  v_smfmac_f32_16x16x64_bf16 v[24:27], v[36:39], a[136:143], v1
  v_pk_add_f32 v[12:13], v[12:13], v[14:15]
  v_pk_add_f32 v[20:21], v[20:21], v[22:23]
  v_cvt_pk_bf16_f32 v23, v12, v13
  v_cvt_pk_bf16_f32 v22, v20, v21
  ds_write_b64 v5, v[22:23] offset:0
  v_pk_add_f32 v[16:17], v[16:17], v[18:19]
  s_nop 1
  v_pk_add_f32 v[24:25], v[24:25], v[26:27]
  v_cvt_pk_bf16_f32 v27, v16, v17
  v_cvt_pk_bf16_f32 v26, v24, v25
  ds_write_b64 v5, v[26:27] offset:512
  v_smfmac_f32_16x16x64_bf16 v[40:43], v[28:31], v[160:167], v1
  v_xor_b32 v52, 16, v6
  s_waitcnt vmcnt(3)
  ds_read_b128 v[60:63], v0 offset:1024
  v_smfmac_f32_16x16x64_bf16 v[44:47], v[28:31], v[168:175], v1
  ds_read_b128 v[28:31], v0 offset:16384
  ds_read_b128 v[48:51], v0 offset:5120
  v_smfmac_f32_16x16x64_bf16 v[40:43], v[32:35], v[192:199], v1
  v_smfmac_f32_16x16x64_bf16 v[44:47], v[32:35], v[200:207], v1
  ds_read_b128 v[32:35], v0 offset:17408
  v_smfmac_f32_16x16x64_bf16 v[40:43], v[36:39], v[176:183], v1
  s_waitcnt lgkmcnt(4)
  s_barrier
  ds_read_b64_tr_b16 v[12:13], v6 offset:1024
  ds_read_b64_tr_b16 v[14:15], v52 offset:1280
  ds_read_b64_tr_b16 v[16:17], v6 offset:2048
  ds_read_b64_tr_b16 v[18:19], v52 offset:2304
  v_smfmac_f32_16x16x64_bf16 v[44:47], v[36:39], v[184:191], v1
  ds_read_b64_tr_b16 v[20:21], v6 offset:3072
  ds_read_b64_tr_b16 v[22:23], v52 offset:3328
  s_waitcnt lgkmcnt(8)
  v_smfmac_f32_16x16x64_bf16 v[40:43], v[28:31], v[64:71], v1
  ds_read_b64_tr_b16 v[24:25], v6 offset:0
  ds_read_b64_tr_b16 v[26:27], v52 offset:256
  v_smfmac_f32_16x16x64_bf16 v[44:47], v[28:31], v[72:79], v1
  ds_read_b128 v[28:31], v0 offset:18432
  s_waitcnt lgkmcnt(9)
  v_smfmac_f32_16x16x64_bf16 v[40:43], v[32:35], v[80:87], v1
  v_smfmac_f32_16x16x64_bf16 v[44:47], v[32:35], v[88:95], v1
  ds_read_b128 v[32:35], v0 offset:19456
  s_waitcnt lgkmcnt(8)
  v_mfma_f32_16x16x32_bf16 v[56:59], v[60:63], v[12:15], 0
  ds_read_b128 v[36:39], v0 offset:2048
  v_mfma_f32_16x16x32_bf16 v[60:63], v[48:51], v[12:15], 0
  ds_read_b128 v[48:51], v0 offset:6144
  v_mfma_f32_16x16x32_bf16 v[52:55], v[12:15], v[12:15], 0
  ds_read_b128 v[12:15], v0 offset:3072
  s_waitcnt lgkmcnt(9)
  v_mfma_f32_16x16x32_bf16 v[52:55], v[16:19], v[16:19], v[52:55]
  s_waitcnt lgkmcnt(2)
  v_mfma_f32_16x16x32_bf16 v[56:59], v[36:39], v[16:19], v[56:59]
  ds_read_b128 v[36:39], v0 offset:7168
  s_waitcnt lgkmcnt(2)
  v_mfma_f32_16x16x32_bf16 v[60:63], v[48:51], v[16:19], v[60:63]
  ds_read_b128 v[48:51], v0 offset:0
  ds_read_b128 v[16:19], v0 offset:4096
  v_mfma_f32_16x16x32_bf16 v[52:55], v[20:23], v[20:23], v[52:55]
  s_waitcnt lgkmcnt(3)
  v_mfma_f32_16x16x32_bf16 v[56:59], v[12:15], v[20:23], v[56:59]
  s_waitcnt lgkmcnt(2)
  v_mfma_f32_16x16x32_bf16 v[60:63], v[36:39], v[20:23], v[60:63]
  s_waitcnt vmcnt(1)
  ds_read_b128 v[20:23], v0 offset:8192
  ds_read_b128 v[12:15], v0 offset:9216
  v_mfma_f32_16x16x32_bf16 v[52:55], v[24:27], v[24:27], v[52:55]
  s_waitcnt lgkmcnt(3)
  v_mfma_f32_16x16x32_bf16 v[56:59], v[48:51], v[24:27], v[56:59]
  s_waitcnt lgkmcnt(2)
  v_mfma_f32_16x16x32_bf16 v[60:63], v[16:19], v[24:27], v[60:63]
  v_smfmac_f32_16x16x64_bf16 v[40:43], v[28:31], v[96:103], v1
  buffer_store_dwordx4 v[24:27], v9, s[4:7], s49 offen offset:0 sc1
  v_mov_b32 v36, 0x3f803f80
  v_mov_b32 v37, 0x3f803f80
  v_max3_f32 v48, v52, v53, v56
  v_max3_f32 v48, v48, v57, v58
  v_max3_f32 v48, v48, v59, v60
  v_max3_f32 v48, v48, v61, v62
  v_max_f32 v49, v48, v63
  v_max_f32 v48, v48, v63
  v_smfmac_f32_16x16x64_bf16 v[44:47], v[28:31], v[104:111], v1
  ds_read_b128 v[28:31], v0 offset:20480
  v_mov_b64 v[38:39], v[36:37]
  v_permlane32_swap_b32 v48, v49
  v_max_f32 v48, v48, v49
  v_mov_b32 v49, v48
  v_smfmac_f32_16x16x64_bf16 v[40:43], v[32:35], v[112:119], v1
  v_mov_b64 v[16:17], 0
  v_permlane16_swap_b32 v48, v49
  v_max_f32 v48, v48, v49
  v_mul_f32 v48, s47, v48
  v_pk_fma_f32 v[56:57], v[56:57], s[46:47], v[48:49] op_sel_hi:[1,0,0]
  v_pk_fma_f32 v[58:59], v[58:59], s[46:47], v[48:49] op_sel_hi:[1,0,0]
  v_pk_fma_f32 v[60:61], v[60:61], s[46:47], v[48:49] op_sel_hi:[1,0,0]
  v_pk_fma_f32 v[62:63], v[62:63], s[46:47], v[48:49] op_sel_hi:[1,0,0]
  v_pk_fma_f32 v[52:53], v[52:53], s[46:47], v[48:49] op_sel_hi:[1,0,0]
  v_smfmac_f32_16x16x64_bf16 v[44:47], v[32:35], v[120:127], v1
  ds_read_b128 v[32:35], v0 offset:21504
  v_exp_f32 v56, v56
  v_exp_f32 v57, v57
  s_waitcnt lgkmcnt(1)
  v_smfmac_f32_16x16x64_bf16 v[40:43], v[28:31], v[128:135], v1
  v_exp_f32 v58, v58
  v_exp_f32 v59, v59
  v_smfmac_f32_16x16x64_bf16 v[44:47], v[28:31], v[136:143], v1
  v_exp_f32 v60, v60
  v_exp_f32 v61, v61
  s_waitcnt lgkmcnt(0)
  v_smfmac_f32_16x16x64_bf16 v[40:43], v[32:35], v[144:151], v1
  v_exp_f32 v62, v62
  v_exp_f32 v63, v63
  v_smfmac_f32_16x16x64_bf16 v[44:47], v[32:35], v[152:159], v1
  v_exp_f32 v52, v52
  v_exp_f32 v53, v53
  ds_read_b128 v[28:31], v3 offset:32768
  ds_read_b128 v[32:35], v3 offset:33792
  v_mov_b64 v[18:19], 0
  v_cvt_pk_bf16_f32 v24, v56, v57
  v_cvt_pk_bf16_f32 v25, v58, v59
  v_cvt_pk_bf16_f32 v26, v60, v61
  v_cvt_pk_bf16_f32 v27, v62, v63
  v_cvt_pk_bf16_f32 v16, v52, v53
  v_cvt_pk_bf16_f32 v19, v52, v53
  v_mfma_f32_16x16x32_bf16 v[52:55], v[36:39], v[24:27], 0
  v_add_f32 v40, v40, v42
  v_add_f32 v41, v41, v43
  v_mfma_f32_16x16x32_bf16 v[56:59], v[20:23], v[24:27], 0
  v_add_f32 v44, v44, v46
  v_add_f32 v45, v45, v47
  v_mfma_f32_16x16x32_bf16 v[60:63], v[12:15], v[24:27], 0
  v_cvt_pk_bf16_f32 v40, v40, v41
  v_cvt_pk_bf16_f32 v41, v44, v45
  s_add_u32 s51, s49, 4194304
  v_lshrrev_b32 v50, 1, v0
  v_mfma_f32_16x16x16_bf16 v[52:55], v[36:37], v[16:17], v[52:55]
  v_mov_b64 v[44:45], 0
  v_mov_b64 v[46:47], 0
  v_mfma_f32_16x16x16_bf16 v[56:59], v[40:41], v[16:17], v[56:59]
  buffer_store_dwordx2 v[40:41], v50, s[4:7], s51 offen offset:0 sc1
  v_mov_b64 v[12:13], 0
  v_mov_b64 v[14:15], 0
  v_mfma_f32_16x16x16_bf16 v[60:63], v[40:41], v[18:19], v[60:63]
  s_nop 0
  v_rcp_f32 v48, v52
  v_mov_b64 v[36:37], 0
  v_mov_b64 v[38:39], 0
  s_mov_b64 exec, s[52:53]
  v_pk_mul_f32 v[56:57], v[56:57], v[48:49] op_sel_hi:[1,0]
  v_pk_mul_f32 v[58:59], v[58:59], v[48:49] op_sel_hi:[1,0]
  v_cvt_pk_bf16_f32 v56, v56, v57
  v_cvt_pk_bf16_f32 v57, v58, v59
  ds_write_b64 v7, v[56:57] offset:0
  v_pk_mul_f32 v[60:61], v[60:61], v[48:49] op_sel_hi:[1,0]
  v_pk_mul_f32 v[62:63], v[62:63], v[48:49] op_sel_hi:[1,0]
  v_cvt_pk_bf16_f32 v60, v60, v61
  v_cvt_pk_bf16_f32 v61, v62, v63
  ds_write_b64 v7, v[60:61] offset:256
  s_mov_b64 exec, -1
  v_mov_b32 v58, 0
  v_mov_b32 v59, 0
  v_mov_b32 v56, 0
  v_mov_b32 v57, 0
  s_waitcnt lgkmcnt(0)
  s_barrier
  v_mov_b32 v60, 0
  ds_read_b128 v[16:19], v4 offset:29696
  ds_read_b128 v[40:43], v4 offset:30208
  ds_read_b128 v[48:51], v4 offset:30720
  v_mov_b32 v61, 0
  ds_read_b128 v[52:55], v4 offset:31232
  ds_read_b128 v[20:23], v3 offset:34816
  ds_read_b128 v[24:27], v3 offset:35840
  s_nop 1
  v_mov_b32 v62, 0
  s_nop 2
  v_mov_b32 v63, 0
  s_waitcnt lgkmcnt(5)
  v_smfmac_f32_16x16x64_bf16 v[44:47], v[16:19], a[160:167], v1
  s_waitcnt lgkmcnt(4)
  v_smfmac_f32_16x16x64_bf16 v[44:47], v[40:43], v[28:35], v1
  ds_read_b128 v[28:31], v3 offset:49152
  ds_read_b128 v[32:35], v3 offset:50176
  s_waitcnt lgkmcnt(5)
  v_smfmac_f32_16x16x64_bf16 v[44:47], v[48:51], a[168:175], v1
  s_waitcnt lgkmcnt(4)
  v_smfmac_f32_16x16x64_bf16 v[44:47], v[52:55], a[176:183], v1
  s_waitcnt lgkmcnt(2)
  v_smfmac_f32_16x16x64_bf16 v[12:15], v[16:19], v[20:27], v1
  ds_read_b128 v[20:23], v3 offset:51200
  ds_read_b128 v[24:27], v3 offset:52224
  v_smfmac_f32_16x16x64_bf16 v[12:15], v[40:43], a[184:191], v1
  s_nop 0
  v_cvt_pk_bf16_f32 v44, v44, v45
  v_cvt_pk_bf16_f32 v45, v46, v47
  v_smfmac_f32_16x16x64_bf16 v[12:15], v[48:51], a[192:199], v1
  v_bfi_b32 v44, 1, s54, v44
  v_bfi_b32 v45, 1, s54, v45
  buffer_store_dwordx2 v[44:45], v8, s[4:7], s89 offen sc1
  v_smfmac_f32_16x16x64_bf16 v[12:15], v[52:55], a[200:207], v1
  s_waitcnt lgkmcnt(2)
  v_smfmac_f32_16x16x64_bf16 v[36:39], v[16:19], v[28:35], v1
  ds_read_b128 v[28:31], v0 offset:29696
  ds_read_b128 v[32:35], v0 offset:30720
  v_smfmac_f32_16x16x64_bf16 v[36:39], v[40:43], a[208:215], v1
  s_nop 0
  v_cvt_pk_bf16_f32 v12, v12, v13
  v_cvt_pk_bf16_f32 v13, v14, v15
  v_smfmac_f32_16x16x64_bf16 v[36:39], v[48:51], a[216:223], v1
  v_bfi_b32 v12, 1, s54, v12
  v_bfi_b32 v13, 1, s54, v13
  buffer_store_dwordx2 v[12:13], v8, s[4:7], s90 offen sc1
  v_smfmac_f32_16x16x64_bf16 v[36:39], v[52:55], a[224:231], v1
  s_waitcnt lgkmcnt(2)
  v_smfmac_f32_16x16x64_bf16 v[56:59], v[16:19], v[20:27], v1
  v_smfmac_f32_16x16x64_bf16 v[56:59], v[40:43], a[232:239], v1
  s_nop 0
  v_cvt_pk_bf16_f32 v36, v36, v37
  v_cvt_pk_bf16_f32 v37, v38, v39
  v_smfmac_f32_16x16x64_bf16 v[56:59], v[48:51], a[240:247], v1
  v_bfi_b32 v36, 1, s54, v36
  v_bfi_b32 v37, 1, s54, v37
  buffer_store_dwordx2 v[36:37], v8, s[4:7], s91 offen sc1
  v_smfmac_f32_16x16x64_bf16 v[56:59], v[52:55], a[248:255], v1
  s_waitcnt lgkmcnt(1)
  v_smfmac_f32_16x16x64_bf16 v[60:63], v[28:31], a[144:151], v1
  s_waitcnt lgkmcnt(0)
  v_smfmac_f32_16x16x64_bf16 v[60:63], v[32:35], a[152:159], v1
  s_nop 0
  v_cvt_pk_bf16_f32 v56, v56, v57
  v_cvt_pk_bf16_f32 v57, v58, v59
  v_bfi_b32 v56, 1, s54, v56
  v_bfi_b32 v57, 1, s54, v57
  buffer_store_dwordx2 v[56:57], v8, s[4:7], s92 offen sc1
  s_nop 1
  v_pk_add_f32 v[60:61], v[60:61], v[62:63]
  v_cvt_pk_bf16_f32 v60, v60, v61
  v_bfi_b32 v60, 1, s54, v60
  buffer_store_dword v60, v8, s[4:7], s88 offen offset:0 sc1
  v_mov_b32 v51, -1
  buffer_store_dword v51, v10, s[4:7], s44 offen sc1
  s_waitcnt vmcnt(3)
  s_nop 3
  buffer_load_dwordx4 v[20:23], v0, s[4:7], s41 offen offset:0 sc1
  buffer_load_dwordx4 v[24:27], v0, s[4:7], s41 offen offset:1024 sc1
  buffer_load_dwordx4 v[28:31], v0, s[4:7], s41 offen offset:2048 sc1
  buffer_load_dwordx4 v[32:35], v0, s[4:7], s41 offen offset:3072 sc1
  s_nop 7
  s_nop 3
  v_bfe_u32 v48, v0, 4, 1
  v_lshlrev_b32 v48, 4, v48
  v_mov_b32 v49, 0x3f80
  v_lshlrev_b32 v49, v48, v49
  v_bfe_u32 v48, v0, 5, 3
  v_cmp_eq_u32 vcc, 0, v48
  s_nop 1
  v_cndmask_b32 v36, 0, v49, vcc
  v_cmp_eq_u32 vcc, 1, v48
  s_nop 1
  v_cndmask_b32 v37, 0, v49, vcc
  v_cmp_eq_u32 vcc, 2, v48
  s_nop 1
  v_cndmask_b32 v38, 0, v49, vcc
  v_cmp_eq_u32 vcc, 3, v48
  s_nop 1
  v_cndmask_b32 v39, 0, v49, vcc
  buffer_load_dwordx4 v[20:23], v0, s[4:7], s41 offen offset:0 sc1
  buffer_load_dwordx4 v[24:27], v0, s[4:7], s41 offen offset:1024 sc1
  buffer_load_dwordx4 v[28:31], v0, s[4:7], s41 offen offset:2048 sc1
  buffer_load_dwordx4 v[32:35], v0, s[4:7], s41 offen offset:3072 sc1
  s_waitcnt vmcnt(7)
  v_bitop3_b32 v48, v20, v21, s54 bitop3:0x7e
  v_bitop3_b32 v49, v22, v23, s54 bitop3:0x7e
  v_mfma_f32_16x16x32_bf16 v[40:43], v[20:23], v[36:39], 0
  v_or_b32 v50, v48, v49
  s_waitcnt vmcnt(6)
  v_bitop3_b32 v48, v24, v25, s54 bitop3:0x7e
  v_bitop3_b32 v49, v26, v27, s54 bitop3:0x7e
  v_mfma_f32_16x16x32_bf16 v[40:43], v[24:27], v[36:39], v[40:43]
  v_or3_b32 v50, v50, v48, v49
  s_waitcnt vmcnt(5)
  v_bitop3_b32 v48, v28, v29, s54 bitop3:0x7e
  v_bitop3_b32 v49, v30, v31, s54 bitop3:0x7e
  v_mfma_f32_16x16x32_bf16 v[40:43], v[28:31], v[36:39], v[40:43]
  v_or3_b32 v50, v50, v48, v49
  s_waitcnt vmcnt(4)
  v_bitop3_b32 v48, v32, v33, s54 bitop3:0x7e
  v_bitop3_b32 v49, v34, v35, s54 bitop3:0x7e
  v_mfma_f32_16x16x32_bf16 v[40:43], v[32:35], v[36:39], v[40:43]
  v_or3_b32 v50, v50, v48, v49
  v_and_b32 v50, 1, v50
  v_cmp_eq_u32 vcc, 1, v50
  s_nop 0
  s_cbranch_vccz L_okA_c0s
L_retA_c0s:
  s_add_u32 s50, s50, 1
  s_mov_b64 exec, vcc
  buffer_load_dwordx4 v[20:23], v0, s[4:7], s41 offen offset:0 sc1
  buffer_load_dwordx4 v[24:27], v0, s[4:7], s41 offen offset:1024 sc1
  buffer_load_dwordx4 v[28:31], v0, s[4:7], s41 offen offset:2048 sc1
  buffer_load_dwordx4 v[32:35], v0, s[4:7], s41 offen offset:3072 sc1
  s_mov_b64 exec, -1
  s_cmp_ge_u32 s50, 262144
  s_cbranch_scc1 L_chain_end
  s_waitcnt vmcnt(7)
  v_bitop3_b32 v48, v20, v21, s54 bitop3:0x7e
  v_bitop3_b32 v49, v22, v23, s54 bitop3:0x7e
  v_mfma_f32_16x16x32_bf16 v[40:43], v[20:23], v[36:39], 0
  v_or_b32 v50, v48, v49
  s_waitcnt vmcnt(6)
  v_bitop3_b32 v48, v24, v25, s54 bitop3:0x7e
  v_bitop3_b32 v49, v26, v27, s54 bitop3:0x7e
  v_mfma_f32_16x16x32_bf16 v[40:43], v[24:27], v[36:39], v[40:43]
  v_or3_b32 v50, v50, v48, v49
  s_waitcnt vmcnt(5)
  v_bitop3_b32 v48, v28, v29, s54 bitop3:0x7e
  v_bitop3_b32 v49, v30, v31, s54 bitop3:0x7e
  v_mfma_f32_16x16x32_bf16 v[40:43], v[28:31], v[36:39], v[40:43]
  v_or3_b32 v50, v50, v48, v49
  s_waitcnt vmcnt(4)
  v_bitop3_b32 v48, v32, v33, s54 bitop3:0x7e
  v_bitop3_b32 v49, v34, v35, s54 bitop3:0x7e
  v_mfma_f32_16x16x32_bf16 v[40:43], v[32:35], v[36:39], v[40:43]
  v_or3_b32 v50, v50, v48, v49
  v_and_b32 v50, 1, v50
  v_cmp_eq_u32 vcc, 1, v50
  s_nop 0
  s_cbranch_vccnz L_retA_c0s
L_okA_c0s:
  s_nop 2
  v_permlane32_swap_b32 v40, v42
  v_permlane32_swap_b32 v41, v43
  v_add_f32 v40, v40, v42
  v_add_f32 v41, v41, v43
  v_cvt_pk_bf16_f32 v40, v40, v41
  buffer_store_dword v40, v10, s[4:7], s42 offen sc1
  s_branch L_loop_c0s
L_chain_w1:
  v_mov_b32 v12, v0
  v_lshlrev_b32 v0, 4, v12
  v_and_b32 v13, 15, v12
  v_lshrrev_b32 v14, 4, v12
  v_mov_b32 v1, 0x4444
  v_and_b32 v15, 2, v12
  v_cmp_ne_u32 vcc, 0, v15
  v_mov_b32 v16, 0xeeee
  s_nop 0
  v_cndmask_b32 v1, v1, v16, vcc
  v_add_u32 v2, 36864, v0
  v_add_u32 v3, 102400, v0
  v_and_b32 v16, 13, v13
  v_and_b32 v17, 1, v14
  v_lshl_add_u32 v16, v17, 1, v16
  v_lshrrev_b32 v18, 1, v14
  v_lshl_add_u32 v16, v18, 4, v16
  v_lshlrev_b32 v4, 4, v16
  v_lshrrev_b32 v16, 2, v13
  v_xor_b32 v19, v16, v14
  v_lshlrev_b32 v19, 3, v19
  v_lshl_add_u32 v19, v13, 5, v19
  v_add_u32 v5, 26624, v19
  v_lshl_add_u32 v19, v17, 2, v16
  v_lshl_add_u32 v19, v18, 4, v19
  v_lshlrev_b32 v19, 5, v19
  v_and_b32 v20, 3, v13
  v_xor_b32 v20, v20, v17
  v_lshl_add_u32 v6, v20, 3, v19
  v_add_u32 v6, 25600, v6
  v_and_b32 v19, 13, v13
  v_lshl_add_u32 v19, v18, 1, v19
  v_lshlrev_b32 v19, 4, v19
  v_lshl_add_u32 v19, v17, 3, v19
  v_add_u32 v7, 30208, v19
  s_lshl_b32 s34, s32, 7
  v_and_b32 v19, 7, v13
  v_lshlrev_b32 v19, 4, v19
  v_lshrrev_b32 v20, 3, v13
  v_lshl_add_u32 v19, v20, 3, v19
  v_lshl_add_u32 v19, v14, 12, v19
  v_add_u32 v8, s34, v19
  v_and_b32 v19, 0x3c0, v0
  v_lshrrev_b32 v19, 1, v19
  v_and_b32 v20, 0x10, v0
  v_or_b32 v19, v19, v20
  v_and_b32 v20, 0x20, v0
  v_lshl_or_b32 v9, v20, 26, v19
  s_add_u32 s34, s32, 32
  s_mov_b32 s36, 8
  s_lshl_b32 s41, s34, 12
  s_add_u32 s41, s41, 65536
  s_lshl_b32 s35, s34, 7
  v_bfe_u32 v19, v13, 1, 1
  v_lshlrev_b32 v19, 6, v19
  v_and_b32 v20, 1, v13
  v_lshl_add_u32 v19, v20, 5, v19
  v_lshl_add_u32 v19, v16, 4, v19
  v_lshl_add_u32 v19, v17, 3, v19
  v_lshl_add_u32 v19, v18, 2, v19
  v_add_u32 v19, s35, v19
  v_mov_b32 v20, 0x80000000
  v_cmp_gt_u32 vcc, s36, v13
  s_nop 1
  v_cndmask_b32 v10, v20, v19, vcc
  v_lshlrev_b32 v19, 9, v18
  v_lshl_add_u32 v19, v16, 7, v19
  v_lshl_add_u32 v19, v17, 6, v19
  v_and_b32 v20, 1, v13
  v_lshl_add_u32 v19, v20, 5, v19
  v_and_b32 v20, 2, v13
  v_lshl_add_u32 v19, v20, 3, v19
  v_add_u32 v11, 2048, v19
  s_mov_b32 s42, 664576
  s_mov_b32 s43, 655360
  s_mov_b32 s44, 673792
  v_mov_b64 v[44:45], -1
  v_mov_b64 v[46:47], -1
  buffer_store_dwordx4 v[44:47], v0, s[4:7], s41 offen offset:0 sc1
  buffer_store_dwordx4 v[44:47], v0, s[4:7], s41 offen offset:1024 sc1
  buffer_store_dwordx4 v[44:47], v0, s[4:7], s41 offen offset:2048 sc1
  buffer_store_dwordx4 v[44:47], v0, s[4:7], s41 offen offset:3072 sc1
  buffer_store_dword v44, v10, s[4:7], s42 offen sc1
  buffer_store_dword v44, v10, s[4:7], s43 offen sc1
  buffer_store_dword v44, v10, s[4:7], s44 offen sc1
L_noinit_83:
  s_mov_b32 s40, 0
  s_mov_b32 s54, 0
  s_mov_b32 s46, 0x3e0293ee
  s_mov_b32 s47, 0xbe0293ee
  s_mov_b32 s52, 0xcccccccc
  s_mov_b32 s53, 0xcccccccc
  s_lshl_b32 s48, s32, 13
  s_add_u32 s48, s48, 35651584
  s_add_u32 s93, s48, 266240
  s_lshl_b32 s49, s32, 11
  s_add_u32 s49, s49, 10485760
  s_mov_b32 s60, 0
  s_mov_b32 s88, 131072
  s_mov_b32 s89, 147456
  s_mov_b32 s90, 163840
  s_mov_b32 s91, 180224
  s_mov_b32 s92, 196608
  s_mov_b32 s80, 0
  s_mov_b32 s81, 0
  s_mov_b32 s82, 0
  s_mov_b32 s83, 0
  s_mov_b32 s84, 0
  s_mov_b32 s85, 0
  s_mov_b32 s86, 0
  s_mov_b32 s87, 0
  v_lshrrev_b32 v12, 4, v0
  v_lshrrev_b32 v13, 4, v12
  v_and_b32 v14, 15, v12
  v_and_b32 v15, 1, v13
  v_lshlrev_b32 v15, 1, v15
  v_xor_b32 v14, v14, v15
  s_lshl_b32 s34, s32, 8
  s_add_u32 s34, s34, 131072
  v_lshlrev_b32 v15, 13, v13
  v_lshl_add_u32 v15, v14, 4, v15
  v_add_u32 v56, s34, v15
  v_xor_b32 v57, 64, v56
  v_xor_b32 v58, 128, v56
  v_xor_b32 v59, 192, v56
  v_and_b32 v14, 3, v12
  v_lshrrev_b32 v15, 5, v12
  v_bfe_u32 v16, v12, 4, 1
  v_bfe_u32 v17, v12, 2, 1
  v_bfe_u32 v18, v12, 3, 1
  v_lshl_add_u32 v19, v16, 2, v17
  v_lshl_add_u32 v20, v15, 4, v19
  v_lshl_add_u32 v20, v18, 3, v20
  v_lshl_add_u32 v21, v16, 1, v17
  v_lshl_add_u32 v21, v18, 2, v21
  v_lshlrev_b32 v21, 1, v21
  v_lshrrev_b32 v22, 1, v14
  v_add_u32 v22, 4, v22
  v_xor_b32 v22, v22, v21
  v_lshlrev_b32 v22, 4, v22
  v_lshl_add_u32 v22, v20, 8, v22
  v_and_b32 v23, 1, v12
  v_lshl_add_u32 v52, v23, 3, v22
  v_xor_b32 v53, 32, v52
  v_mul_u32_u24 v20, 1152, v20
  v_lshl_add_u32 v20, v14, 3, v20
  v_add_u32 v61, 288, v20
  v_lshl_add_u32 v20, v15, 3, v19
  v_mul_u32_u24 v20, 1152, v20
  v_lshl_add_u32 v20, v18, 5, v20
  v_lshl_add_u32 v60, v14, 3, v20
  s_mul_i32 s61, s32, 147456
  s_add_u32 s61, s61, 9216
  s_mov_b32 m0, 9216
  s_add_u32 s51, s61, 0
  buffer_load_dwordx4 v0, s[24:27], s51 offen offset:0 lds
  buffer_load_dwordx4 v0, s[24:27], s51 offen offset:1024 lds
  buffer_load_dwordx4 v0, s[24:27], s51 offen offset:2048 lds
  buffer_load_dwordx4 v0, s[24:27], s51 offen offset:3072 lds
  s_mov_b32 m0, 13312
  s_add_u32 s51, s61, 4096
  buffer_load_dwordx4 v0, s[24:27], s51 offen offset:0 lds
  buffer_load_dwordx4 v0, s[24:27], s51 offen offset:1024 lds
  buffer_load_dwordx4 v0, s[24:27], s51 offen offset:2048 lds
  buffer_load_dwordx4 v0, s[24:27], s51 offen offset:3072 lds
  s_mov_b32 m0, 17408
  s_add_u32 s51, s61, 8192
  buffer_load_dwordx4 v0, s[24:27], s51 offen offset:0 lds
  s_mov_b32 m0, 46080
  s_add_u32 s51, s61, 36864
  buffer_load_dwordx4 v0, s[24:27], s51 offen offset:0 lds
  buffer_load_dwordx4 v0, s[24:27], s51 offen offset:1024 lds
  buffer_load_dwordx4 v0, s[24:27], s51 offen offset:2048 lds
  buffer_load_dwordx4 v0, s[24:27], s51 offen offset:3072 lds
  s_mov_b32 m0, 50176
  s_add_u32 s51, s61, 40960
  buffer_load_dwordx4 v0, s[24:27], s51 offen offset:0 lds
  buffer_load_dwordx4 v0, s[24:27], s51 offen offset:1024 lds
  buffer_load_dwordx4 v0, s[24:27], s51 offen offset:2048 lds
  buffer_load_dwordx4 v0, s[24:27], s51 offen offset:3072 lds
  s_mov_b32 m0, 54272
  s_add_u32 s51, s61, 45056
  buffer_load_dwordx4 v0, s[24:27], s51 offen offset:0 lds
  s_mov_b32 m0, 82944
  s_add_u32 s51, s61, 73728
  buffer_load_dwordx4 v0, s[24:27], s51 offen offset:0 lds
  buffer_load_dwordx4 v0, s[24:27], s51 offen offset:1024 lds
  buffer_load_dwordx4 v0, s[24:27], s51 offen offset:2048 lds
  buffer_load_dwordx4 v0, s[24:27], s51 offen offset:3072 lds
  s_mov_b32 m0, 87040
  s_add_u32 s51, s61, 77824
  buffer_load_dwordx4 v0, s[24:27], s51 offen offset:0 lds
  buffer_load_dwordx4 v0, s[24:27], s51 offen offset:1024 lds
  buffer_load_dwordx4 v0, s[24:27], s51 offen offset:2048 lds
  buffer_load_dwordx4 v0, s[24:27], s51 offen offset:3072 lds
  s_mov_b32 m0, 91136
  s_add_u32 s51, s61, 81920
  buffer_load_dwordx4 v0, s[24:27], s51 offen offset:0 lds
  s_mov_b32 m0, 119808
  s_add_u32 s51, s61, 110592
  buffer_load_dwordx4 v0, s[24:27], s51 offen offset:0 lds
  buffer_load_dwordx4 v0, s[24:27], s51 offen offset:1024 lds
  buffer_load_dwordx4 v0, s[24:27], s51 offen offset:2048 lds
  buffer_load_dwordx4 v0, s[24:27], s51 offen offset:3072 lds
  s_mov_b32 m0, 123904
  s_add_u32 s51, s61, 114688
  buffer_load_dwordx4 v0, s[24:27], s51 offen offset:0 lds
  buffer_load_dwordx4 v0, s[24:27], s51 offen offset:1024 lds
  buffer_load_dwordx4 v0, s[24:27], s51 offen offset:2048 lds
  buffer_load_dwordx4 v0, s[24:27], s51 offen offset:3072 lds
  s_mov_b32 m0, 128000
  s_add_u32 s51, s61, 118784
  buffer_load_dwordx4 v0, s[24:27], s51 offen offset:0 lds
  s_mov_b32 m0, 151552
  s_mov_b32 s51, 0
  buffer_load_dwordx4 v56, s[20:23], s51 offen lds
  s_mov_b32 m0, 152576
  s_mov_b32 s51, 32768
  buffer_load_dwordx4 v57, s[20:23], s51 offen lds
  s_mov_b32 m0, 153600
  s_mov_b32 s51, 65536
  buffer_load_dwordx4 v58, s[20:23], s51 offen lds
  s_mov_b32 m0, 154624
  s_mov_b32 s51, 98304
  buffer_load_dwordx4 v59, s[20:23], s51 offen lds
  s_waitcnt vmcnt(31)
  s_barrier
  v_add_u32 v54, 0, v60
  v_add_u32 v55, 0, v61
  ds_read_b64_tr_b16 a[160:161], v54 offset:320
  ds_read_b64_tr_b16 a[162:163], v54 offset:2624
  ds_read_b64_tr_b16 a[164:165], v54 offset:18752
  ds_read_b64_tr_b16 a[166:167], v54 offset:21056
  ds_read_b64_tr_b16 v[20:21], v54 offset:384
  ds_read_b64_tr_b16 v[22:23], v54 offset:2688
  ds_read_b64_tr_b16 v[24:25], v54 offset:18816
  ds_read_b64_tr_b16 v[26:27], v54 offset:21120
  ds_read_b64_tr_b16 v[28:29], v54 offset:448
  ds_read_b64_tr_b16 v[30:31], v54 offset:2752
  ds_read_b64_tr_b16 v[32:33], v54 offset:18880
  ds_read_b64_tr_b16 v[34:35], v54 offset:21184
  ds_read_b64_tr_b16 v[36:37], v54 offset:512
  ds_read_b64_tr_b16 v[38:39], v54 offset:2816
  ds_read_b64_tr_b16 v[40:41], v54 offset:18944
  ds_read_b64_tr_b16 v[42:43], v54 offset:21248
  ds_read_b64_tr_b16 a[144:145], v55 offset:0
  ds_read_b64_tr_b16 a[146:147], v55 offset:2304
  s_waitcnt lgkmcnt(0)
  s_waitcnt vmcnt(22)
  s_barrier
  s_mov_b32 m0, 4096
  s_mov_b32 s51, 0
  buffer_load_dwordx4 v56, s[12:15], s51 offen lds
  s_mov_b32 m0, 5120
  s_mov_b32 s51, 32768
  buffer_load_dwordx4 v57, s[12:15], s51 offen lds
  s_mov_b32 m0, 6144
  s_mov_b32 s51, 65536
  buffer_load_dwordx4 v58, s[12:15], s51 offen lds
  s_mov_b32 m0, 7168
  s_mov_b32 s51, 98304
  buffer_load_dwordx4 v59, s[12:15], s51 offen lds
  s_mov_b32 m0, 20480
  s_mov_b32 s51, 524288
  buffer_load_dwordx4 v56, s[20:23], s51 offen lds
  s_mov_b32 m0, 21504
  s_mov_b32 s51, 557056
  buffer_load_dwordx4 v57, s[20:23], s51 offen lds
  s_mov_b32 m0, 22528
  s_mov_b32 s51, 589824
  buffer_load_dwordx4 v58, s[20:23], s51 offen lds
  s_mov_b32 m0, 23552
  s_mov_b32 s51, 622592
  buffer_load_dwordx4 v59, s[20:23], s51 offen lds
  v_add_u32 v54, 36864, v60
  v_add_u32 v55, 36864, v61
  ds_read_b64_tr_b16 v[12:13], v54 offset:320
  ds_read_b64_tr_b16 v[14:15], v54 offset:2624
  ds_read_b64_tr_b16 v[16:17], v54 offset:18752
  ds_read_b64_tr_b16 v[18:19], v54 offset:21056
  ds_read_b64_tr_b16 a[184:185], v54 offset:384
  ds_read_b64_tr_b16 a[186:187], v54 offset:2688
  ds_read_b64_tr_b16 a[188:189], v54 offset:18816
  ds_read_b64_tr_b16 a[190:191], v54 offset:21120
  ds_read_b64_tr_b16 a[208:209], v54 offset:448
  ds_read_b64_tr_b16 a[210:211], v54 offset:2752
  ds_read_b64_tr_b16 a[212:213], v54 offset:18880
  ds_read_b64_tr_b16 a[214:215], v54 offset:21184
  ds_read_b64_tr_b16 a[232:233], v54 offset:512
  ds_read_b64_tr_b16 a[234:235], v54 offset:2816
  ds_read_b64_tr_b16 a[236:237], v54 offset:18944
  ds_read_b64_tr_b16 a[238:239], v54 offset:21248
  ds_read_b64_tr_b16 a[148:149], v55 offset:0
  ds_read_b64_tr_b16 a[150:151], v55 offset:2304
  s_waitcnt lgkmcnt(0)
  s_waitcnt vmcnt(21)
  s_barrier
  s_mov_b32 m0, 36864
  s_mov_b32 s51, 0
  buffer_load_dwordx4 v56, s[16:19], s51 offen lds
  s_mov_b32 m0, 37888
  s_mov_b32 s51, 32768
  buffer_load_dwordx4 v57, s[16:19], s51 offen lds
  s_mov_b32 m0, 38912
  s_mov_b32 s51, 65536
  buffer_load_dwordx4 v58, s[16:19], s51 offen lds
  s_mov_b32 m0, 39936
  s_mov_b32 s51, 98304
  buffer_load_dwordx4 v59, s[16:19], s51 offen lds
  s_mov_b32 m0, 53248
  s_mov_b32 s51, 1048576
  buffer_load_dwordx4 v56, s[16:19], s51 offen lds
  s_mov_b32 m0, 54272
  s_mov_b32 s51, 1081344
  buffer_load_dwordx4 v57, s[16:19], s51 offen lds
  s_mov_b32 m0, 55296
  s_mov_b32 s51, 1114112
  buffer_load_dwordx4 v58, s[16:19], s51 offen lds
  s_mov_b32 m0, 56320
  s_mov_b32 s51, 1146880
  buffer_load_dwordx4 v59, s[16:19], s51 offen lds
  v_add_u32 v54, 73728, v60
  v_add_u32 v55, 73728, v61
  ds_read_b64_tr_b16 a[168:169], v54 offset:320
  ds_read_b64_tr_b16 a[170:171], v54 offset:2624
  ds_read_b64_tr_b16 a[172:173], v54 offset:18752
  ds_read_b64_tr_b16 a[174:175], v54 offset:21056
  ds_read_b64_tr_b16 a[192:193], v54 offset:384
  ds_read_b64_tr_b16 a[194:195], v54 offset:2688
  ds_read_b64_tr_b16 a[196:197], v54 offset:18816
  ds_read_b64_tr_b16 a[198:199], v54 offset:21120
  ds_read_b64_tr_b16 a[216:217], v54 offset:448
  ds_read_b64_tr_b16 a[218:219], v54 offset:2752
  ds_read_b64_tr_b16 a[220:221], v54 offset:18880
  ds_read_b64_tr_b16 a[222:223], v54 offset:21184
  ds_read_b64_tr_b16 a[240:241], v54 offset:512
  ds_read_b64_tr_b16 a[242:243], v54 offset:2816
  ds_read_b64_tr_b16 a[244:245], v54 offset:18944
  ds_read_b64_tr_b16 a[246:247], v54 offset:21248
  ds_read_b64_tr_b16 a[152:153], v55 offset:0
  ds_read_b64_tr_b16 a[154:155], v55 offset:2304
  s_waitcnt lgkmcnt(0)
  s_waitcnt vmcnt(20)
  s_barrier
  s_mov_b32 m0, 69632
  s_mov_b32 s51, 524288
  buffer_load_dwordx4 v56, s[12:15], s51 offen lds
  s_mov_b32 m0, 70656
  s_mov_b32 s51, 557056
  buffer_load_dwordx4 v57, s[12:15], s51 offen lds
  s_mov_b32 m0, 71680
  s_mov_b32 s51, 589824
  buffer_load_dwordx4 v58, s[12:15], s51 offen lds
  s_mov_b32 m0, 72704
  s_mov_b32 s51, 622592
  buffer_load_dwordx4 v59, s[12:15], s51 offen lds
  s_mov_b32 m0, 86016
  s_mov_b32 s51, 524288
  buffer_load_dwordx4 v56, s[16:19], s51 offen lds
  s_mov_b32 m0, 87040
  s_mov_b32 s51, 557056
  buffer_load_dwordx4 v57, s[16:19], s51 offen lds
  s_mov_b32 m0, 88064
  s_mov_b32 s51, 589824
  buffer_load_dwordx4 v58, s[16:19], s51 offen lds
  s_mov_b32 m0, 89088
  s_mov_b32 s51, 622592
  buffer_load_dwordx4 v59, s[16:19], s51 offen lds
  v_add_u32 v54, 110592, v60
  v_add_u32 v55, 110592, v61
  ds_read_b64_tr_b16 a[176:177], v54 offset:320
  ds_read_b64_tr_b16 a[178:179], v54 offset:2624
  ds_read_b64_tr_b16 a[180:181], v54 offset:18752
  ds_read_b64_tr_b16 a[182:183], v54 offset:21056
  ds_read_b64_tr_b16 a[200:201], v54 offset:384
  ds_read_b64_tr_b16 a[202:203], v54 offset:2688
  ds_read_b64_tr_b16 a[204:205], v54 offset:18816
  ds_read_b64_tr_b16 a[206:207], v54 offset:21120
  ds_read_b64_tr_b16 a[224:225], v54 offset:448
  ds_read_b64_tr_b16 a[226:227], v54 offset:2752
  ds_read_b64_tr_b16 a[228:229], v54 offset:18880
  ds_read_b64_tr_b16 a[230:231], v54 offset:21184
  ds_read_b64_tr_b16 a[248:249], v54 offset:512
  ds_read_b64_tr_b16 a[250:251], v54 offset:2816
  ds_read_b64_tr_b16 a[252:253], v54 offset:18944
  ds_read_b64_tr_b16 a[254:255], v54 offset:21248
  ds_read_b64_tr_b16 a[156:157], v55 offset:0
  ds_read_b64_tr_b16 a[158:159], v55 offset:2304
  s_waitcnt lgkmcnt(0)
  s_waitcnt vmcnt(24)
  s_barrier
  s_mov_b32 m0, 102400
  s_mov_b32 s51, 1048576
  buffer_load_dwordx4 v56, s[20:23], s51 offen lds
  s_mov_b32 m0, 103424
  s_mov_b32 s51, 1081344
  buffer_load_dwordx4 v57, s[20:23], s51 offen lds
  s_mov_b32 m0, 104448
  s_mov_b32 s51, 1114112
  buffer_load_dwordx4 v58, s[20:23], s51 offen lds
  s_mov_b32 m0, 105472
  s_mov_b32 s51, 1146880
  buffer_load_dwordx4 v59, s[20:23], s51 offen lds
  s_mov_b32 m0, 118784
  s_mov_b32 s51, 1048576
  buffer_load_dwordx4 v56, s[12:15], s51 offen lds
  s_mov_b32 m0, 119808
  s_mov_b32 s51, 1081344
  buffer_load_dwordx4 v57, s[12:15], s51 offen lds
  s_mov_b32 m0, 120832
  s_mov_b32 s51, 1114112
  buffer_load_dwordx4 v58, s[12:15], s51 offen lds
  s_mov_b32 m0, 121856
  s_mov_b32 s51, 1146880
  buffer_load_dwordx4 v59, s[12:15], s51 offen lds
  s_mov_b32 m0, 135168
  s_mov_b32 s51, 1572864
  buffer_load_dwordx4 v56, s[20:23], s51 offen lds
  s_mov_b32 m0, 136192
  s_mov_b32 s51, 1605632
  buffer_load_dwordx4 v57, s[20:23], s51 offen lds
  s_mov_b32 m0, 137216
  s_mov_b32 s51, 1638400
  buffer_load_dwordx4 v58, s[20:23], s51 offen lds
  s_mov_b32 m0, 138240
  s_mov_b32 s51, 1671168
  buffer_load_dwordx4 v59, s[20:23], s51 offen lds
  v_add_u32 v54, 147456, v52
  v_add_u32 v55, 147456, v53
  ds_read_b64_tr_b16 v[64:65], v54 offset:0
  ds_read_b64_tr_b16 v[66:67], v54 offset:512
  ds_read_b64_tr_b16 v[68:69], v54 offset:8192
  ds_read_b64_tr_b16 v[70:71], v54 offset:8704
  ds_read_b64_tr_b16 v[72:73], v55 offset:0
  ds_read_b64_tr_b16 v[74:75], v55 offset:512
  ds_read_b64_tr_b16 v[76:77], v55 offset:8192
  ds_read_b64_tr_b16 v[78:79], v55 offset:8704
  s_waitcnt lgkmcnt(0)
  s_waitcnt vmcnt(32)
  s_barrier
  s_mov_b32 m0, 151552
  s_mov_b32 s51, 1572864
  buffer_load_dwordx4 v56, s[12:15], s51 offen lds
  s_mov_b32 m0, 152576
  s_mov_b32 s51, 1605632
  buffer_load_dwordx4 v57, s[12:15], s51 offen lds
  s_mov_b32 m0, 153600
  s_mov_b32 s51, 1638400
  buffer_load_dwordx4 v58, s[12:15], s51 offen lds
  s_mov_b32 m0, 154624
  s_mov_b32 s51, 1671168
  buffer_load_dwordx4 v59, s[12:15], s51 offen lds
  v_add_u32 v54, 0, v52
  v_add_u32 v55, 0, v53
  ds_read_b64_tr_b16 v[208:209], v54 offset:0
  ds_read_b64_tr_b16 v[210:211], v54 offset:512
  ds_read_b64_tr_b16 v[212:213], v54 offset:8192
  ds_read_b64_tr_b16 v[214:215], v54 offset:8704
  ds_read_b64_tr_b16 v[216:217], v55 offset:0
  ds_read_b64_tr_b16 v[218:219], v55 offset:512
  ds_read_b64_tr_b16 v[220:221], v55 offset:8192
  ds_read_b64_tr_b16 v[222:223], v55 offset:8704
  s_waitcnt lgkmcnt(0)
  s_waitcnt vmcnt(32)
  s_barrier
  s_mov_b32 m0, 4096
  s_mov_b32 s51, 2097152
  buffer_load_dwordx4 v56, s[20:23], s51 offen lds
  s_mov_b32 m0, 5120
  s_mov_b32 s51, 2129920
  buffer_load_dwordx4 v57, s[20:23], s51 offen lds
  s_mov_b32 m0, 6144
  s_mov_b32 s51, 2162688
  buffer_load_dwordx4 v58, s[20:23], s51 offen lds
  s_mov_b32 m0, 7168
  s_mov_b32 s51, 2195456
  buffer_load_dwordx4 v59, s[20:23], s51 offen lds
  v_add_u32 v54, 16384, v52
  v_add_u32 v55, 16384, v53
  ds_read_b64_tr_b16 v[80:81], v54 offset:0
  ds_read_b64_tr_b16 v[82:83], v54 offset:512
  ds_read_b64_tr_b16 v[84:85], v54 offset:8192
  ds_read_b64_tr_b16 v[86:87], v54 offset:8704
  ds_read_b64_tr_b16 v[88:89], v55 offset:0
  ds_read_b64_tr_b16 v[90:91], v55 offset:512
  ds_read_b64_tr_b16 v[92:93], v55 offset:8192
  ds_read_b64_tr_b16 v[94:95], v55 offset:8704
  s_waitcnt lgkmcnt(0)
  s_waitcnt vmcnt(32)
  s_barrier
  s_mov_b32 m0, 20480
  s_mov_b32 s51, 2097152
  buffer_load_dwordx4 v56, s[12:15], s51 offen lds
  s_mov_b32 m0, 21504
  s_mov_b32 s51, 2129920
  buffer_load_dwordx4 v57, s[12:15], s51 offen lds
  s_mov_b32 m0, 22528
  s_mov_b32 s51, 2162688
  buffer_load_dwordx4 v58, s[12:15], s51 offen lds
  s_mov_b32 m0, 23552
  s_mov_b32 s51, 2195456
  buffer_load_dwordx4 v59, s[12:15], s51 offen lds
  v_add_u32 v54, 32768, v52
  v_add_u32 v55, 32768, v53
  ds_read_b64_tr_b16 v[192:193], v54 offset:0
  ds_read_b64_tr_b16 v[194:195], v54 offset:512
  ds_read_b64_tr_b16 v[196:197], v54 offset:8192
  ds_read_b64_tr_b16 v[198:199], v54 offset:8704
  ds_read_b64_tr_b16 v[200:201], v55 offset:0
  ds_read_b64_tr_b16 v[202:203], v55 offset:512
  ds_read_b64_tr_b16 v[204:205], v55 offset:8192
  ds_read_b64_tr_b16 v[206:207], v55 offset:8704
  s_waitcnt lgkmcnt(0)
  s_barrier
  ds_write_b128 v2, v[192:195] offset:0
  ds_write_b128 v2, v[196:199] offset:1024
  ds_write_b128 v2, v[200:203] offset:2048
  ds_write_b128 v2, v[204:207] offset:3072
  s_waitcnt vmcnt(32)
  s_barrier
  v_add_u32 v54, 49152, v52
  v_add_u32 v55, 49152, v53
  ds_read_b64_tr_b16 v[192:193], v54 offset:0
  ds_read_b64_tr_b16 v[194:195], v54 offset:512
  ds_read_b64_tr_b16 v[196:197], v54 offset:8192
  ds_read_b64_tr_b16 v[198:199], v54 offset:8704
  ds_read_b64_tr_b16 v[200:201], v55 offset:0
  ds_read_b64_tr_b16 v[202:203], v55 offset:512
  ds_read_b64_tr_b16 v[204:205], v55 offset:8192
  ds_read_b64_tr_b16 v[206:207], v55 offset:8704
  s_waitcnt lgkmcnt(0)
  s_barrier
  ds_write_b128 v2, v[192:195] offset:16384
  ds_write_b128 v2, v[196:199] offset:17408
  ds_write_b128 v2, v[200:203] offset:18432
  ds_write_b128 v2, v[204:207] offset:19456
  s_waitcnt vmcnt(28)
  s_barrier
  v_add_u32 v54, 65536, v52
  v_add_u32 v55, 65536, v53
  ds_read_b64_tr_b16 v[224:225], v54 offset:0
  ds_read_b64_tr_b16 v[226:227], v54 offset:512
  ds_read_b64_tr_b16 v[228:229], v54 offset:8192
  ds_read_b64_tr_b16 v[230:231], v54 offset:8704
  ds_read_b64_tr_b16 v[232:233], v55 offset:0
  ds_read_b64_tr_b16 v[234:235], v55 offset:512
  ds_read_b64_tr_b16 v[236:237], v55 offset:8192
  ds_read_b64_tr_b16 v[238:239], v55 offset:8704
  s_waitcnt lgkmcnt(0)
  s_waitcnt vmcnt(24)
  s_barrier
  s_mov_b32 m0, 69632
  s_mov_b32 s51, 1572864
  buffer_load_dwordx4 v56, s[16:19], s51 offen lds
  s_mov_b32 m0, 70656
  s_mov_b32 s51, 1605632
  buffer_load_dwordx4 v57, s[16:19], s51 offen lds
  s_mov_b32 m0, 71680
  s_mov_b32 s51, 1638400
  buffer_load_dwordx4 v58, s[16:19], s51 offen lds
  s_mov_b32 m0, 72704
  s_mov_b32 s51, 1671168
  buffer_load_dwordx4 v59, s[16:19], s51 offen lds
  buffer_load_dwordx2 v[44:45], off, s[8:11], 0 offset:4 sc1
  v_add_u32 v54, 81920, v52
  v_add_u32 v55, 81920, v53
  ds_read_b64_tr_b16 a[96:97], v54 offset:0
  ds_read_b64_tr_b16 a[98:99], v54 offset:512
  ds_read_b64_tr_b16 a[100:101], v54 offset:8192
  ds_read_b64_tr_b16 a[102:103], v54 offset:8704
  ds_read_b64_tr_b16 a[104:105], v55 offset:0
  ds_read_b64_tr_b16 a[106:107], v55 offset:512
  ds_read_b64_tr_b16 a[108:109], v55 offset:8192
  ds_read_b64_tr_b16 a[110:111], v55 offset:8704
  s_waitcnt lgkmcnt(0)
  s_waitcnt vmcnt(25)
  s_barrier
  s_mov_b32 m0, 86016
  s_mov_b32 s51, 2621440
  buffer_load_dwordx4 v56, s[16:19], s51 offen lds
  s_mov_b32 m0, 87040
  s_mov_b32 s51, 2654208
  buffer_load_dwordx4 v57, s[16:19], s51 offen lds
  s_mov_b32 m0, 88064
  s_mov_b32 s51, 2686976
  buffer_load_dwordx4 v58, s[16:19], s51 offen lds
  s_mov_b32 m0, 89088
  s_mov_b32 s51, 2719744
  buffer_load_dwordx4 v59, s[16:19], s51 offen lds
  v_add_u32 v54, 98304, v52
  v_add_u32 v55, 98304, v53
  ds_read_b64_tr_b16 v[96:97], v54 offset:0
  ds_read_b64_tr_b16 v[98:99], v54 offset:512
  ds_read_b64_tr_b16 v[100:101], v54 offset:8192
  ds_read_b64_tr_b16 v[102:103], v54 offset:8704
  ds_read_b64_tr_b16 v[104:105], v55 offset:0
  ds_read_b64_tr_b16 v[106:107], v55 offset:512
  ds_read_b64_tr_b16 v[108:109], v55 offset:8192
  ds_read_b64_tr_b16 v[110:111], v55 offset:8704
  s_waitcnt lgkmcnt(0)
  s_waitcnt vmcnt(25)
  s_barrier
  s_mov_b32 m0, 102400
  s_mov_b32 s51, 3145728
  buffer_load_dwordx4 v56, s[16:19], s51 offen lds
  s_mov_b32 m0, 103424
  s_mov_b32 s51, 3178496
  buffer_load_dwordx4 v57, s[16:19], s51 offen lds
  s_mov_b32 m0, 104448
  s_mov_b32 s51, 3211264
  buffer_load_dwordx4 v58, s[16:19], s51 offen lds
  s_mov_b32 m0, 105472
  s_mov_b32 s51, 3244032
  buffer_load_dwordx4 v59, s[16:19], s51 offen lds
  v_add_u32 v54, 114688, v52
  v_add_u32 v55, 114688, v53
  ds_read_b64_tr_b16 v[240:241], v54 offset:0
  ds_read_b64_tr_b16 v[242:243], v54 offset:512
  ds_read_b64_tr_b16 v[244:245], v54 offset:8192
  ds_read_b64_tr_b16 v[246:247], v54 offset:8704
  ds_read_b64_tr_b16 v[248:249], v55 offset:0
  ds_read_b64_tr_b16 v[250:251], v55 offset:512
  ds_read_b64_tr_b16 v[252:253], v55 offset:8192
  ds_read_b64_tr_b16 v[254:255], v55 offset:8704
  s_waitcnt lgkmcnt(0)
  s_waitcnt vmcnt(25)
  s_barrier
  s_mov_b32 m0, 118784
  s_mov_b32 s51, 4194304
  buffer_load_dwordx4 v56, s[16:19], s51 offen lds
  s_mov_b32 m0, 119808
  s_mov_b32 s51, 4227072
  buffer_load_dwordx4 v57, s[16:19], s51 offen lds
  s_mov_b32 m0, 120832
  s_mov_b32 s51, 4259840
  buffer_load_dwordx4 v58, s[16:19], s51 offen lds
  s_mov_b32 m0, 121856
  s_mov_b32 s51, 4292608
  buffer_load_dwordx4 v59, s[16:19], s51 offen lds
  v_add_u32 v54, 131072, v52
  v_add_u32 v55, 131072, v53
  ds_read_b64_tr_b16 v[112:113], v54 offset:0
  ds_read_b64_tr_b16 v[114:115], v54 offset:512
  ds_read_b64_tr_b16 v[116:117], v54 offset:8192
  ds_read_b64_tr_b16 v[118:119], v54 offset:8704
  ds_read_b64_tr_b16 v[120:121], v55 offset:0
  ds_read_b64_tr_b16 v[122:123], v55 offset:512
  ds_read_b64_tr_b16 v[124:125], v55 offset:8192
  ds_read_b64_tr_b16 v[126:127], v55 offset:8704
  s_waitcnt lgkmcnt(0)
  s_waitcnt vmcnt(25)
  s_barrier
  s_mov_b32 m0, 135168
  s_mov_b32 s51, 2097152
  buffer_load_dwordx4 v56, s[16:19], s51 offen lds
  s_mov_b32 m0, 136192
  s_mov_b32 s51, 2129920
  buffer_load_dwordx4 v57, s[16:19], s51 offen lds
  s_mov_b32 m0, 137216
  s_mov_b32 s51, 2162688
  buffer_load_dwordx4 v58, s[16:19], s51 offen lds
  s_mov_b32 m0, 138240
  s_mov_b32 s51, 2195456
  buffer_load_dwordx4 v59, s[16:19], s51 offen lds
  v_add_u32 v54, 147456, v52
  v_add_u32 v55, 147456, v53
  ds_read_b64_tr_b16 a[0:1], v54 offset:0
  ds_read_b64_tr_b16 a[2:3], v54 offset:512
  ds_read_b64_tr_b16 a[4:5], v54 offset:8192
  ds_read_b64_tr_b16 a[6:7], v54 offset:8704
  ds_read_b64_tr_b16 a[8:9], v55 offset:0
  ds_read_b64_tr_b16 a[10:11], v55 offset:512
  ds_read_b64_tr_b16 a[12:13], v55 offset:8192
  ds_read_b64_tr_b16 a[14:15], v55 offset:8704
  s_waitcnt lgkmcnt(0)
  s_waitcnt vmcnt(25)
  s_barrier
  s_mov_b32 m0, 151552
  s_mov_b32 s51, 2621440
  buffer_load_dwordx4 v56, s[20:23], s51 offen lds
  s_mov_b32 m0, 152576
  s_mov_b32 s51, 2654208
  buffer_load_dwordx4 v57, s[20:23], s51 offen lds
  s_mov_b32 m0, 153600
  s_mov_b32 s51, 2686976
  buffer_load_dwordx4 v58, s[20:23], s51 offen lds
  s_mov_b32 m0, 154624
  s_mov_b32 s51, 2719744
  buffer_load_dwordx4 v59, s[20:23], s51 offen lds
  v_add_u32 v54, 0, v52
  v_add_u32 v55, 0, v53
  ds_read_b64_tr_b16 v[128:129], v54 offset:0
  ds_read_b64_tr_b16 v[130:131], v54 offset:512
  ds_read_b64_tr_b16 v[132:133], v54 offset:8192
  ds_read_b64_tr_b16 v[134:135], v54 offset:8704
  ds_read_b64_tr_b16 v[136:137], v55 offset:0
  ds_read_b64_tr_b16 v[138:139], v55 offset:512
  ds_read_b64_tr_b16 v[140:141], v55 offset:8192
  ds_read_b64_tr_b16 v[142:143], v55 offset:8704
  s_waitcnt lgkmcnt(0)
  s_waitcnt vmcnt(25)
  s_barrier
  s_mov_b32 m0, 4096
  s_mov_b32 s51, 2621440
  buffer_load_dwordx4 v56, s[12:15], s51 offen lds
  s_mov_b32 m0, 5120
  s_mov_b32 s51, 2654208
  buffer_load_dwordx4 v57, s[12:15], s51 offen lds
  s_mov_b32 m0, 6144
  s_mov_b32 s51, 2686976
  buffer_load_dwordx4 v58, s[12:15], s51 offen lds
  s_mov_b32 m0, 7168
  s_mov_b32 s51, 2719744
  buffer_load_dwordx4 v59, s[12:15], s51 offen lds
  v_add_u32 v54, 16384, v52
  v_add_u32 v55, 16384, v53
  ds_read_b64_tr_b16 a[16:17], v54 offset:0
  ds_read_b64_tr_b16 a[18:19], v54 offset:512
  ds_read_b64_tr_b16 a[20:21], v54 offset:8192
  ds_read_b64_tr_b16 a[22:23], v54 offset:8704
  ds_read_b64_tr_b16 a[24:25], v55 offset:0
  ds_read_b64_tr_b16 a[26:27], v55 offset:512
  ds_read_b64_tr_b16 a[28:29], v55 offset:8192
  ds_read_b64_tr_b16 a[30:31], v55 offset:8704
  s_waitcnt lgkmcnt(0)
  s_waitcnt vmcnt(25)
  s_barrier
  s_mov_b32 m0, 20480
  s_mov_b32 s51, 3145728
  buffer_load_dwordx4 v56, s[20:23], s51 offen lds
  s_mov_b32 m0, 21504
  s_mov_b32 s51, 3178496
  buffer_load_dwordx4 v57, s[20:23], s51 offen lds
  s_mov_b32 m0, 22528
  s_mov_b32 s51, 3211264
  buffer_load_dwordx4 v58, s[20:23], s51 offen lds
  s_mov_b32 m0, 23552
  s_mov_b32 s51, 3244032
  buffer_load_dwordx4 v59, s[20:23], s51 offen lds
  v_add_u32 v54, 65536, v52
  v_add_u32 v55, 65536, v53
  ds_read_b64_tr_b16 v[192:193], v54 offset:0
  ds_read_b64_tr_b16 v[194:195], v54 offset:512
  ds_read_b64_tr_b16 v[196:197], v54 offset:8192
  ds_read_b64_tr_b16 v[198:199], v54 offset:8704
  ds_read_b64_tr_b16 v[200:201], v55 offset:0
  ds_read_b64_tr_b16 v[202:203], v55 offset:512
  ds_read_b64_tr_b16 v[204:205], v55 offset:8192
  ds_read_b64_tr_b16 v[206:207], v55 offset:8704
  s_waitcnt lgkmcnt(0)
  s_barrier
  ds_write_b128 v2, v[192:195] offset:32768
  ds_write_b128 v2, v[196:199] offset:33792
  ds_write_b128 v2, v[200:203] offset:34816
  ds_write_b128 v2, v[204:207] offset:35840
  s_waitcnt vmcnt(24)
  s_barrier
  v_add_u32 v54, 81920, v52
  v_add_u32 v55, 81920, v53
  ds_read_b64_tr_b16 v[192:193], v54 offset:0
  ds_read_b64_tr_b16 v[194:195], v54 offset:512
  ds_read_b64_tr_b16 v[196:197], v54 offset:8192
  ds_read_b64_tr_b16 v[198:199], v54 offset:8704
  ds_read_b64_tr_b16 v[200:201], v55 offset:0
  ds_read_b64_tr_b16 v[202:203], v55 offset:512
  ds_read_b64_tr_b16 v[204:205], v55 offset:8192
  ds_read_b64_tr_b16 v[206:207], v55 offset:8704
  s_waitcnt lgkmcnt(0)
  s_barrier
  ds_write_b128 v2, v[192:195] offset:49152
  ds_write_b128 v2, v[196:199] offset:50176
  ds_write_b128 v2, v[200:203] offset:51200
  ds_write_b128 v2, v[204:207] offset:52224
  s_waitcnt vmcnt(20)
  s_barrier
  v_add_u32 v54, 98304, v52
  v_add_u32 v55, 98304, v53
  ds_read_b64_tr_b16 v[192:193], v54 offset:0
  ds_read_b64_tr_b16 v[194:195], v54 offset:512
  ds_read_b64_tr_b16 v[196:197], v54 offset:8192
  ds_read_b64_tr_b16 v[198:199], v54 offset:8704
  ds_read_b64_tr_b16 v[200:201], v55 offset:0
  ds_read_b64_tr_b16 v[202:203], v55 offset:512
  ds_read_b64_tr_b16 v[204:205], v55 offset:8192
  ds_read_b64_tr_b16 v[206:207], v55 offset:8704
  s_waitcnt lgkmcnt(0)
  s_barrier
  ds_write_b128 v3, v[192:195] offset:0
  ds_write_b128 v3, v[196:199] offset:1024
  ds_write_b128 v3, v[200:203] offset:2048
  ds_write_b128 v3, v[204:207] offset:3072
  s_waitcnt vmcnt(16)
  s_barrier
  v_add_u32 v54, 114688, v52
  v_add_u32 v55, 114688, v53
  ds_read_b64_tr_b16 v[192:193], v54 offset:0
  ds_read_b64_tr_b16 v[194:195], v54 offset:512
  ds_read_b64_tr_b16 v[196:197], v54 offset:8192
  ds_read_b64_tr_b16 v[198:199], v54 offset:8704
  ds_read_b64_tr_b16 v[200:201], v55 offset:0
  ds_read_b64_tr_b16 v[202:203], v55 offset:512
  ds_read_b64_tr_b16 v[204:205], v55 offset:8192
  ds_read_b64_tr_b16 v[206:207], v55 offset:8704
  s_waitcnt lgkmcnt(0)
  s_barrier
  ds_write_b128 v3, v[192:195] offset:16384
  ds_write_b128 v3, v[196:199] offset:17408
  ds_write_b128 v3, v[200:203] offset:18432
  ds_write_b128 v3, v[204:207] offset:19456
  s_waitcnt vmcnt(12)
L_cwait_84:
  v_readfirstlane_b32 s96, v44
  v_readfirstlane_b32 s97, v45
  s_add_u32 s50, s50, 1
  s_cmp_ge_u32 s50, 262144
  s_cbranch_scc1 L_cwait_84_x
  s_lshl_b32 s96, s96, 8
  s_add_u32 s96, s96, s97
  s_cmp_eq_u32 s96, 2592
  s_cbranch_scc1 L_cwait_84_x
  buffer_load_dwordx2 v[44:45], off, s[8:11], 0 offset:4 sc1
  s_waitcnt vmcnt(0)
  s_branch L_cwait_84
L_cwait_84_x:
  s_lshl_b32 s61, s32, 7
  s_add_u32 s94, s61, 6144
  s_add_u32 s61, s61, 0
  s_barrier
  buffer_load_dword v48, off, s[8:11], 0 offset:128 sc1
  v_add_u32 v54, 131072, v52
  v_add_u32 v55, 131072, v53
  ds_read_b64_tr_b16 a[112:113], v54 offset:0
  ds_read_b64_tr_b16 a[114:115], v54 offset:512
  ds_read_b64_tr_b16 a[116:117], v54 offset:8192
  ds_read_b64_tr_b16 a[118:119], v54 offset:8704
  ds_read_b64_tr_b16 a[120:121], v55 offset:0
  ds_read_b64_tr_b16 a[122:123], v55 offset:512
  ds_read_b64_tr_b16 a[124:125], v55 offset:8192
  ds_read_b64_tr_b16 a[126:127], v55 offset:8704
  s_waitcnt lgkmcnt(0)
  s_waitcnt vmcnt(9)
  s_barrier
  s_mov_b32 m0, 135168
  s_mov_b32 s51, 3145728
  buffer_load_dwordx4 v56, s[12:15], s51 offen lds
  s_mov_b32 m0, 136192
  s_mov_b32 s51, 3178496
  buffer_load_dwordx4 v57, s[12:15], s51 offen lds
  s_mov_b32 m0, 137216
  s_mov_b32 s51, 3211264
  buffer_load_dwordx4 v58, s[12:15], s51 offen lds
  s_mov_b32 m0, 138240
  s_mov_b32 s51, 3244032
  buffer_load_dwordx4 v59, s[12:15], s51 offen lds
  v_add_u32 v54, 147456, v52
  v_add_u32 v55, 147456, v53
  ds_read_b64_tr_b16 v[144:145], v54 offset:0
  ds_read_b64_tr_b16 v[146:147], v54 offset:512
  ds_read_b64_tr_b16 v[148:149], v54 offset:8192
  ds_read_b64_tr_b16 v[150:151], v54 offset:8704
  ds_read_b64_tr_b16 v[152:153], v55 offset:0
  ds_read_b64_tr_b16 v[154:155], v55 offset:512
  ds_read_b64_tr_b16 v[156:157], v55 offset:8192
  ds_read_b64_tr_b16 v[158:159], v55 offset:8704
  s_waitcnt lgkmcnt(0)
  s_waitcnt vmcnt(9)
  s_barrier
  s_mov_b32 m0, 151552
  s_mov_b32 s51, 3670016
  buffer_load_dwordx4 v56, s[20:23], s51 offen lds
  s_mov_b32 m0, 152576
  s_mov_b32 s51, 3702784
  buffer_load_dwordx4 v57, s[20:23], s51 offen lds
  s_mov_b32 m0, 153600
  s_mov_b32 s51, 3735552
  buffer_load_dwordx4 v58, s[20:23], s51 offen lds
  s_mov_b32 m0, 154624
  s_mov_b32 s51, 3768320
  buffer_load_dwordx4 v59, s[20:23], s51 offen lds
  s_getpc_b64 s[34:35]
L_scp_85:
  s_add_u32 s34, s34, L_loop_c1f-L_scp_85
  s_addc_u32 s35, s35, 0
  v_lshlrev_b32 v200, 2, v0
  v_min_u32 v200, L_code_end-L_loop_c1f-4, v200
  v_mov_b32 v201, s35
  v_add_co_u32 v200, vcc, s34, v200
  s_nop 1
  v_addc_co_u32 v201, vcc, 0, v201, vcc
  global_load_dword v202, v[200:201], off
  v_add_u32 v54, 0, v52
  v_add_u32 v55, 0, v53
  ds_read_b64_tr_b16 a[32:33], v54 offset:0
  ds_read_b64_tr_b16 a[34:35], v54 offset:512
  ds_read_b64_tr_b16 a[36:37], v54 offset:8192
  ds_read_b64_tr_b16 a[38:39], v54 offset:8704
  ds_read_b64_tr_b16 a[40:41], v55 offset:0
  ds_read_b64_tr_b16 a[42:43], v55 offset:512
  ds_read_b64_tr_b16 a[44:45], v55 offset:8192
  ds_read_b64_tr_b16 a[46:47], v55 offset:8704
  s_waitcnt lgkmcnt(0)
  s_waitcnt vmcnt(10)
  s_barrier
  s_mov_b32 m0, 4096
  s_mov_b32 s51, 3670016
  buffer_load_dwordx4 v56, s[12:15], s51 offen lds
  s_mov_b32 m0, 5120
  s_mov_b32 s51, 3702784
  buffer_load_dwordx4 v57, s[12:15], s51 offen lds
  s_mov_b32 m0, 6144
  s_mov_b32 s51, 3735552
  buffer_load_dwordx4 v58, s[12:15], s51 offen lds
  s_mov_b32 m0, 7168
  s_mov_b32 s51, 3768320
  buffer_load_dwordx4 v59, s[12:15], s51 offen lds
  v_add_u32 v54, 16384, v52
  v_add_u32 v55, 16384, v53
  ds_read_b64_tr_b16 v[160:161], v54 offset:0
  ds_read_b64_tr_b16 v[162:163], v54 offset:512
  ds_read_b64_tr_b16 v[164:165], v54 offset:8192
  ds_read_b64_tr_b16 v[166:167], v54 offset:8704
  ds_read_b64_tr_b16 v[168:169], v55 offset:0
  ds_read_b64_tr_b16 v[170:171], v55 offset:512
  ds_read_b64_tr_b16 v[172:173], v55 offset:8192
  ds_read_b64_tr_b16 v[174:175], v55 offset:8704
  s_waitcnt lgkmcnt(0)
  s_waitcnt vmcnt(9)
  s_barrier
  s_mov_b32 m0, 20480
  s_mov_b32 s51, 3670016
  buffer_load_dwordx4 v56, s[16:19], s51 offen lds
  s_mov_b32 m0, 21504
  s_mov_b32 s51, 3702784
  buffer_load_dwordx4 v57, s[16:19], s51 offen lds
  s_mov_b32 m0, 22528
  s_mov_b32 s51, 3735552
  buffer_load_dwordx4 v58, s[16:19], s51 offen lds
  s_mov_b32 m0, 23552
  s_mov_b32 s51, 3768320
  buffer_load_dwordx4 v59, s[16:19], s51 offen lds
  v_add_u32 v54, 131072, v52
  v_add_u32 v55, 131072, v53
  ds_read_b64_tr_b16 a[48:49], v54 offset:0
  ds_read_b64_tr_b16 a[50:51], v54 offset:512
  ds_read_b64_tr_b16 a[52:53], v54 offset:8192
  ds_read_b64_tr_b16 a[54:55], v54 offset:8704
  ds_read_b64_tr_b16 a[56:57], v55 offset:0
  ds_read_b64_tr_b16 a[58:59], v55 offset:512
  ds_read_b64_tr_b16 a[60:61], v55 offset:8192
  ds_read_b64_tr_b16 a[62:63], v55 offset:8704
  s_waitcnt lgkmcnt(0)
  s_waitcnt vmcnt(9)
  s_barrier
  s_mov_b32 m0, 135168
  s_mov_b32 s51, 4194304
  buffer_load_dwordx4 v56, s[20:23], s51 offen lds
  s_mov_b32 m0, 136192
  s_mov_b32 s51, 4227072
  buffer_load_dwordx4 v57, s[20:23], s51 offen lds
  s_mov_b32 m0, 137216
  s_mov_b32 s51, 4259840
  buffer_load_dwordx4 v58, s[20:23], s51 offen lds
  s_mov_b32 m0, 138240
  s_mov_b32 s51, 4292608
  buffer_load_dwordx4 v59, s[20:23], s51 offen lds
  v_add_u32 v54, 147456, v52
  v_add_u32 v55, 147456, v53
  ds_read_b64_tr_b16 v[176:177], v54 offset:0
  ds_read_b64_tr_b16 v[178:179], v54 offset:512
  ds_read_b64_tr_b16 v[180:181], v54 offset:8192
  ds_read_b64_tr_b16 v[182:183], v54 offset:8704
  ds_read_b64_tr_b16 v[184:185], v55 offset:0
  ds_read_b64_tr_b16 v[186:187], v55 offset:512
  ds_read_b64_tr_b16 v[188:189], v55 offset:8192
  ds_read_b64_tr_b16 v[190:191], v55 offset:8704
  s_waitcnt lgkmcnt(0)
  s_waitcnt vmcnt(8)
  s_barrier
  ds_write_b128 v3, v[28:31] offset:49152
  ds_write_b128 v3, v[32:35] offset:50176
  ds_write_b128 v3, v[36:39] offset:51200
  ds_write_b128 v3, v[40:43] offset:52224
  v_bfe_u32 v44, v0, 6, 2
  v_bfe_u32 v45, v0, 4, 1
  v_lshl_add_u32 v44, v44, 1, v45
  v_mul_u32_u24 v44, 1152, v44
  v_bfe_u32 v45, v0, 8, 2
  v_lshl_add_u32 v44, v45, 5, v44
  v_bfe_u32 v45, v0, 5, 1
  v_lshl_add_u32 v44, v45, 4, v44
  buffer_load_dwordx4 v[28:31], v44, s[28:31], 0 offen offset:256
  buffer_load_dwordx4 v[32:35], v44, s[28:31], 0 offen offset:384
  v_add_u32 v54, 0, v52
  v_add_u32 v55, 0, v53
  ds_read_b64_tr_b16 a[64:65], v54 offset:0
  ds_read_b64_tr_b16 a[66:67], v54 offset:512
  ds_read_b64_tr_b16 a[68:69], v54 offset:8192
  ds_read_b64_tr_b16 a[70:71], v54 offset:8704
  ds_read_b64_tr_b16 a[72:73], v55 offset:0
  ds_read_b64_tr_b16 a[74:75], v55 offset:512
  ds_read_b64_tr_b16 a[76:77], v55 offset:8192
  ds_read_b64_tr_b16 a[78:79], v55 offset:8704
  s_waitcnt lgkmcnt(0)
  s_waitcnt vmcnt(6)
  s_barrier
  s_mov_b32 m0, 4096
  s_mov_b32 s51, 4194304
  buffer_load_dwordx4 v56, s[12:15], s51 offen lds
  s_mov_b32 m0, 5120
  s_mov_b32 s51, 4227072
  buffer_load_dwordx4 v57, s[12:15], s51 offen lds
  s_mov_b32 m0, 6144
  s_mov_b32 s51, 4259840
  buffer_load_dwordx4 v58, s[12:15], s51 offen lds
  s_mov_b32 m0, 7168
  s_mov_b32 s51, 4292608
  buffer_load_dwordx4 v59, s[12:15], s51 offen lds
  v_add_u32 v54, 16384, v52
  v_add_u32 v55, 16384, v53
  ds_read_b64_tr_b16 a[128:129], v54 offset:0
  ds_read_b64_tr_b16 a[130:131], v54 offset:512
  ds_read_b64_tr_b16 a[132:133], v54 offset:8192
  ds_read_b64_tr_b16 a[134:135], v54 offset:8704
  ds_read_b64_tr_b16 a[136:137], v55 offset:0
  ds_read_b64_tr_b16 a[138:139], v55 offset:512
  ds_read_b64_tr_b16 a[140:141], v55 offset:8192
  ds_read_b64_tr_b16 a[142:143], v55 offset:8704
  s_waitcnt lgkmcnt(0)
  s_waitcnt vmcnt(6)
  s_barrier
  v_add_u32 v54, 131072, v52
  v_add_u32 v55, 131072, v53
  ds_read_b64_tr_b16 v[192:193], v54 offset:0
  ds_read_b64_tr_b16 v[194:195], v54 offset:512
  ds_read_b64_tr_b16 v[196:197], v54 offset:8192
  ds_read_b64_tr_b16 v[198:199], v54 offset:8704
  ds_read_b64_tr_b16 v[200:201], v55 offset:0
  ds_read_b64_tr_b16 v[202:203], v55 offset:512
  ds_read_b64_tr_b16 v[204:205], v55 offset:8192
  ds_read_b64_tr_b16 v[206:207], v55 offset:8704
  s_waitcnt lgkmcnt(0)
  s_waitcnt vmcnt(0)
  s_barrier
  ds_write_b128 v3, v[12:15] offset:32768
  ds_write_b128 v3, v[16:19] offset:33792
  ds_write_b128 v3, v[20:23] offset:34816
  ds_write_b128 v3, v[24:27] offset:35840
  v_add_u32 v54, 0, v52
  v_add_u32 v55, 0, v53
  ds_read_b64_tr_b16 a[80:81], v54 offset:0
  ds_read_b64_tr_b16 a[82:83], v54 offset:512
  ds_read_b64_tr_b16 a[84:85], v54 offset:8192
  ds_read_b64_tr_b16 a[86:87], v54 offset:8704
  ds_read_b64_tr_b16 a[88:89], v55 offset:0
  ds_read_b64_tr_b16 a[90:91], v55 offset:512
  ds_read_b64_tr_b16 a[92:93], v55 offset:8192
  ds_read_b64_tr_b16 a[94:95], v55 offset:8704
  s_waitcnt lgkmcnt(0)
  v_readfirstlane_b32 s37, v48
  ds_read_b128 v[40:43], v2 offset:16384
  ds_read_b128 v[44:47], v2 offset:17408
  ds_read_b128 v[48:51], v2 offset:18432
  ds_read_b128 v[52:55], v2 offset:19456
  ds_read_b128 v[56:59], v2 offset:32768
  ds_read_b128 v[60:63], v2 offset:33792
  v_mov_b64 v[12:13], 0
  v_mov_b64 v[14:15], 0
  v_mov_b64 v[16:17], 0
  v_mov_b64 v[18:19], 0
  v_mov_b64 v[20:21], 0
  v_mov_b64 v[22:23], 0
  s_waitcnt vmcnt(0) lgkmcnt(0)
  v_mov_b64 v[24:25], 0
  v_mov_b64 v[26:27], 0
  s_mov_b32 s28, s4
  s_or_b32 s29, s5, 0x40000
  s_mov_b32 s30, 67108864
  ds_write_b128 v0, v[28:31] offset:18432
  ds_write_b128 v0, v[32:35] offset:19456
  s_cmp_lt_u32 s37, 32
  s_cbranch_scc1 L_enter_c1s
  s_branch L_enter_c1f
.p2align 6
.fill 7, 4, 0xbf800000
L_loop_c1f:
  s_barrier
  s_mov_b32 s45, s42
  v_mov_b64 v[12:13], 0
  v_mov_b64_e64 v[14:15], 0
  v_mov_b64_e64 v[16:17], 0
  v_mov_b64_e64 v[18:19], 0
  buffer_load_dwordx4 v[28:31], v11, s[4:7], s45 offen offset:0 sc1
  buffer_load_dwordx4 v[32:35], v11, s[4:7], s45 offen offset:1024 sc1
  ds_read_b128 v[40:43], v2 offset:16384
  ds_read_b128 v[44:47], v2 offset:17408
  ds_read_b128 v[48:51], v2 offset:18432
  ds_read_b128 v[52:55], v2 offset:19456
  ds_read_b128 v[56:59], v2 offset:32768
  ds_read_b128 v[60:63], v2 offset:33792
  s_waitcnt lgkmcnt(0)
  s_waitcnt vmcnt(3)
  v_mov_b64 v[20:21], 0
  v_mov_b64 v[22:23], 0
  v_mov_b64_e64 v[24:25], 0
  v_mov_b64_e64 v[26:27], 0
  s_add_u32 s40, s40, 1
  s_xor_b32 s54, s54, 1
  s_mov_b32 s42, s44
  s_mov_b32 s44, s43
  s_mov_b32 s43, s45
  s_add_u32 s48, s48, 262144
  s_add_u32 s93, s93, 262144
  s_add_u32 s49, s49, 65536
  s_nop 3
  buffer_load_dwordx4 v[28:31], v11, s[4:7], s45 offen offset:0 sc1
  buffer_load_dwordx4 v[32:35], v11, s[4:7], s45 offen offset:1024 sc1
  s_cmp_eq_u32 s40, 63
  s_waitcnt vmcnt(3) lgkmcnt(0)
  v_max3_u32 v36, v28, v29, v30
  v_max_u32 v36, v36, v31
  ds_write_b128 v0, v[28:31] offset:18432
  s_waitcnt vmcnt(2)
  v_max3_u32 v36, v36, v32, v33
  v_max3_u32 v36, v36, v34, v35
  ds_write_b128 v0, v[32:35] offset:19456
  v_cmp_eq_u32 vcc, -1, v36
  s_nop 0
  s_cbranch_vccz L_okB_c1f
L_retB_c1f:
  s_add_u32 s50, s50, 1
  s_mov_b64 exec, vcc
  buffer_load_dwordx4 v[28:31], v11, s[4:7], s45 offen offset:0 sc1
  buffer_load_dwordx4 v[32:35], v11, s[4:7], s45 offen offset:1024 sc1
  s_mov_b64 exec, -1
  s_cmp_ge_u32 s50, 262144
  s_cbranch_scc1 L_chain_end
  s_cmp_eq_u32 s40, 63
  s_waitcnt vmcnt(3)
  v_max3_u32 v36, v28, v29, v30
  v_max_u32 v36, v36, v31
  ds_write_b128 v0, v[28:31] offset:18432
  s_waitcnt vmcnt(2)
  v_max3_u32 v36, v36, v32, v33
  v_max3_u32 v36, v36, v34, v35
  ds_write_b128 v0, v[32:35] offset:19456
  v_cmp_eq_u32_e64 vcc, -1, v36
  s_nop 0
  s_cbranch_vccnz L_retB_c1f
L_okB_c1f:
  s_cbranch_scc1 L_last_1
L_enter_c1f:
  v_smfmac_f32_16x16x64_bf16 v[12:15], v[28:31], v[240:247], v1
  v_smfmac_f32_16x16x64_bf16 v[20:23], v[28:31], v[40:47], v1
  ds_read_b128 v[40:43], v2 offset:34816
  ds_read_b128 v[44:47], v2 offset:35840
  v_smfmac_f32_16x16x64_bf16 v[16:19], v[28:31], v[248:255], v1
  s_waitcnt lgkmcnt(2)
  s_barrier
  ds_read_b128 v[36:39], v0 offset:17408
  v_smfmac_f32_16x16x64_bf16 v[24:27], v[28:31], v[48:55], v1
  ds_read_b128 v[48:51], v2 offset:0
  ds_read_b128 v[52:55], v2 offset:1024
  s_waitcnt vmcnt(0)
  ds_read_b128 v[28:31], v0 offset:16384
  v_smfmac_f32_16x16x64_bf16 v[12:15], v[32:35], a[0:7], v1
  v_smfmac_f32_16x16x64_bf16 v[20:23], v[32:35], v[56:63], v1
  ds_read_b128 v[56:59], v2 offset:2048
  ds_read_b128 v[60:63], v2 offset:3072
  v_smfmac_f32_16x16x64_bf16 v[16:19], v[32:35], a[8:15], v1
  s_mov_b32 m0, 2048
  s_add_u32 s51, s48, 2048
  buffer_load_dwordx4 v0, s[4:7], s51 offen offset:0 sc1 lds
  s_waitcnt lgkmcnt(6)
  v_smfmac_f32_16x16x64_bf16 v[24:27], v[32:35], v[40:47], v1
  ds_read_b128 v[40:43], v2 offset:49152
  ds_read_b128 v[44:47], v2 offset:50176
  s_waitcnt lgkmcnt(7)
  v_smfmac_f32_16x16x64_bf16 v[12:15], v[36:39], v[224:231], v1
  ds_read_b128 v[32:35], v0 offset:21504
  v_smfmac_f32_16x16x64_bf16 v[20:23], v[36:39], a[96:103], v1
  v_smfmac_f32_16x16x64_bf16 v[16:19], v[36:39], v[232:239], v1
  s_mov_b32 m0, 6144
  s_add_u32 s51, s48, 6144
  buffer_load_dwordx4 v0, s[4:7], s51 offen offset:0 sc1 lds
  v_smfmac_f32_16x16x64_bf16 v[24:27], v[36:39], a[104:111], v1
  s_waitcnt lgkmcnt(5)
  v_smfmac_f32_16x16x64_bf16 v[12:15], v[28:31], v[208:215], v1
  ds_read_b128 v[36:39], v0 offset:20480
  v_smfmac_f32_16x16x64_bf16 v[20:23], v[28:31], v[48:55], v1
  ds_read_b128 v[48:51], v2 offset:51200
  ds_read_b128 v[52:55], v2 offset:52224
  v_smfmac_f32_16x16x64_bf16 v[16:19], v[28:31], v[216:223], v1
  s_mov_b32 m0, 10240
  s_add_u32 s51, s48, 16779264
  buffer_load_dwordx4 v0, s[4:7], s51 offen offset:0 sc1 lds
  s_waitcnt lgkmcnt(6)
  v_smfmac_f32_16x16x64_bf16 v[24:27], v[28:31], v[56:63], v1
  ds_read_b128 v[56:59], v3 offset:0
  ds_read_b128 v[60:63], v3 offset:1024
  s_waitcnt lgkmcnt(5)
  v_smfmac_f32_16x16x64_bf16 v[12:15], v[32:35], a[32:39], v1
  ds_read_b128 v[28:31], v0 offset:22528
  v_smfmac_f32_16x16x64_bf16 v[20:23], v[32:35], v[40:47], v1
  ds_read_b128 v[40:43], v3 offset:2048
  ds_read_b128 v[44:47], v3 offset:3072
  v_smfmac_f32_16x16x64_bf16 v[16:19], v[32:35], a[40:47], v1
  buffer_load_dwordx4 v0, s[4:7], s51 offen offset:1024 sc1 lds
  s_waitcnt lgkmcnt(5)
  v_smfmac_f32_16x16x64_bf16 v[24:27], v[32:35], v[48:55], v1
  ds_read_b128 v[48:51], v3 offset:16384
  ds_read_b128 v[52:55], v3 offset:17408
  v_smfmac_f32_16x16x64_bf16 v[12:15], v[36:39], a[16:23], v1
  ds_read_b128 v[32:35], v0 offset:24576
  v_smfmac_f32_16x16x64_bf16 v[20:23], v[36:39], a[112:119], v1
  v_smfmac_f32_16x16x64_bf16 v[16:19], v[36:39], a[24:31], v1
  s_mov_b32 m0, 32000
  s_nop 0
  buffer_load_dword v0, s[28:31], s93 idxen sc1 lds
  v_smfmac_f32_16x16x64_bf16 v[24:27], v[36:39], a[120:127], v1
  s_waitcnt lgkmcnt(5)
  v_smfmac_f32_16x16x64_bf16 v[12:15], v[28:31], a[48:55], v1
  ds_read_b128 v[36:39], v0 offset:23552
  v_smfmac_f32_16x16x64_bf16 v[20:23], v[28:31], v[56:63], v1
  ds_read_b128 v[56:59], v3 offset:18432
  ds_read_b128 v[60:63], v3 offset:19456
  v_smfmac_f32_16x16x64_bf16 v[16:19], v[28:31], a[56:63], v1
  s_waitcnt lgkmcnt(6)
  v_smfmac_f32_16x16x64_bf16 v[24:27], v[28:31], v[40:47], v1
  s_waitcnt lgkmcnt(3)
  v_smfmac_f32_16x16x64_bf16 v[12:15], v[32:35], a[80:87], v1
  v_mov_b64_e64 v[40:41], 0
  v_smfmac_f32_16x16x64_bf16 v[20:23], v[32:35], v[48:55], v1
  v_smfmac_f32_16x16x64_bf16 v[16:19], v[32:35], a[88:95], v1
  v_mov_b64_e64 v[42:43], 0
  s_waitcnt lgkmcnt(0)
  v_smfmac_f32_16x16x64_bf16 v[24:27], v[32:35], v[56:63], v1
  v_smfmac_f32_16x16x64_bf16 v[12:15], v[36:39], a[64:71], v1
  v_mov_b64_e64 v[44:45], 0
  v_smfmac_f32_16x16x64_bf16 v[20:23], v[36:39], a[128:135], v1
  v_mov_b64_e64 v[46:47], 0
  v_smfmac_f32_16x16x64_bf16 v[16:19], v[36:39], a[72:79], v1
  v_smfmac_f32_16x16x64_bf16 v[24:27], v[36:39], a[136:143], v1
  v_pk_add_f32 v[12:13], v[12:13], v[14:15]
  v_pk_add_f32 v[20:21], v[20:21], v[22:23]
  v_cvt_pk_bf16_f32 v23, v12, v13
  v_cvt_pk_bf16_f32 v22, v20, v21
  ds_write_b64 v5, v[22:23] offset:0
  v_pk_add_f32 v[16:17], v[16:17], v[18:19]
  s_nop 1
  v_pk_add_f32 v[24:25], v[24:25], v[26:27]
  v_cvt_pk_bf16_f32 v27, v16, v17
  v_cvt_pk_bf16_f32 v26, v24, v25
  ds_write_b64 v5, v[26:27] offset:512
  v_smfmac_f32_16x16x64_bf16 v[40:43], v[28:31], v[160:167], v1
  v_xor_b32 v52, 16, v6
  s_waitcnt vmcnt(3)
  ds_read_b128 v[60:63], v0 offset:2048
  v_smfmac_f32_16x16x64_bf16 v[44:47], v[28:31], v[168:175], v1
  ds_read_b128 v[28:31], v0 offset:18432
  ds_read_b128 v[48:51], v0 offset:6144
  v_smfmac_f32_16x16x64_bf16 v[40:43], v[32:35], v[192:199], v1
  v_smfmac_f32_16x16x64_bf16 v[44:47], v[32:35], v[200:207], v1
  ds_read_b128 v[32:35], v0 offset:19456
  v_smfmac_f32_16x16x64_bf16 v[40:43], v[36:39], v[176:183], v1
  s_waitcnt lgkmcnt(4)
  s_barrier
  ds_read_b64_tr_b16 v[12:13], v6 offset:2048
  ds_read_b64_tr_b16 v[14:15], v52 offset:2304
  ds_read_b64_tr_b16 v[16:17], v6 offset:3072
  ds_read_b64_tr_b16 v[18:19], v52 offset:3328
  v_smfmac_f32_16x16x64_bf16 v[44:47], v[36:39], v[184:191], v1
  ds_read_b64_tr_b16 v[20:21], v6 offset:0
  ds_read_b64_tr_b16 v[22:23], v52 offset:256
  s_waitcnt lgkmcnt(8)
  v_smfmac_f32_16x16x64_bf16 v[40:43], v[28:31], v[96:103], v1
  ds_read_b64_tr_b16 v[24:25], v6 offset:1024
  ds_read_b64_tr_b16 v[26:27], v52 offset:1280
  v_smfmac_f32_16x16x64_bf16 v[44:47], v[28:31], v[104:111], v1
  ds_read_b128 v[28:31], v0 offset:17408
  s_waitcnt lgkmcnt(9)
  v_smfmac_f32_16x16x64_bf16 v[40:43], v[32:35], v[112:119], v1
  v_smfmac_f32_16x16x64_bf16 v[44:47], v[32:35], v[120:127], v1
  ds_read_b128 v[32:35], v0 offset:16384
  s_waitcnt lgkmcnt(8)
  v_mfma_f32_16x16x32_bf16 v[56:59], v[60:63], v[12:15], 0
  ds_read_b128 v[36:39], v0 offset:3072
  v_mfma_f32_16x16x32_bf16 v[60:63], v[48:51], v[12:15], 0
  ds_read_b128 v[48:51], v0 offset:7168
  v_mfma_f32_16x16x32_bf16 v[52:55], v[12:15], v[12:15], 0
  ds_read_b128 v[12:15], v0 offset:0
  s_waitcnt lgkmcnt(9)
  v_mfma_f32_16x16x32_bf16 v[52:55], v[16:19], v[16:19], v[52:55]
  s_waitcnt lgkmcnt(2)
  v_mfma_f32_16x16x32_bf16 v[56:59], v[36:39], v[16:19], v[56:59]
  ds_read_b128 v[36:39], v0 offset:4096
  s_waitcnt lgkmcnt(2)
  v_mfma_f32_16x16x32_bf16 v[60:63], v[48:51], v[16:19], v[60:63]
  ds_read_b128 v[48:51], v0 offset:1024
  ds_read_b128 v[16:19], v0 offset:5120
  v_mfma_f32_16x16x32_bf16 v[52:55], v[20:23], v[20:23], v[52:55]
  s_waitcnt lgkmcnt(3)
  v_mfma_f32_16x16x32_bf16 v[56:59], v[12:15], v[20:23], v[56:59]
  s_waitcnt lgkmcnt(2)
  v_mfma_f32_16x16x32_bf16 v[60:63], v[36:39], v[20:23], v[60:63]
  s_waitcnt vmcnt(1)
  ds_read_b128 v[20:23], v0 offset:10240
  ds_read_b128 v[12:15], v0 offset:11264
  v_mfma_f32_16x16x32_bf16 v[52:55], v[24:27], v[24:27], v[52:55]
  s_waitcnt lgkmcnt(3)
  v_mfma_f32_16x16x32_bf16 v[56:59], v[48:51], v[24:27], v[56:59]
  s_waitcnt lgkmcnt(2)
  v_mfma_f32_16x16x32_bf16 v[60:63], v[16:19], v[24:27], v[60:63]
  v_smfmac_f32_16x16x64_bf16 v[40:43], v[28:31], v[80:87], v1
  buffer_store_dwordx4 v[24:27], v9, s[4:7], s49 offen offset:512 sc1
  v_mov_b32 v36, 0x3f803f80
  v_mov_b32 v37, 0x3f803f80
  v_max3_f32 v48, v52, v53, v56
  v_max3_f32 v48, v48, v57, v58
  v_max3_f32 v48, v48, v59, v60
  v_max3_f32 v48, v48, v61, v62
  v_max_f32 v49, v48, v63
  v_max_f32 v48, v48, v63
  v_smfmac_f32_16x16x64_bf16 v[44:47], v[28:31], v[88:95], v1
  ds_read_b128 v[28:31], v0 offset:21504
  v_mov_b64 v[38:39], v[36:37]
  v_permlane32_swap_b32 v48, v49
  v_max_f32 v48, v48, v49
  v_mov_b32 v49, v48
  v_smfmac_f32_16x16x64_bf16 v[40:43], v[32:35], v[64:71], v1
  v_mov_b64 v[16:17], 0
  v_permlane16_swap_b32 v48, v49
  v_max_f32 v48, v48, v49
  v_mul_f32 v48, s47, v48
  v_pk_fma_f32 v[56:57], v[56:57], s[46:47], v[48:49] op_sel_hi:[1,0,0]
  v_pk_fma_f32 v[58:59], v[58:59], s[46:47], v[48:49] op_sel_hi:[1,0,0]
  v_pk_fma_f32 v[60:61], v[60:61], s[46:47], v[48:49] op_sel_hi:[1,0,0]
  v_pk_fma_f32 v[62:63], v[62:63], s[46:47], v[48:49] op_sel_hi:[1,0,0]
  v_pk_fma_f32 v[52:53], v[52:53], s[46:47], v[48:49] op_sel_hi:[1,0,0]
  v_smfmac_f32_16x16x64_bf16 v[44:47], v[32:35], v[72:79], v1
  ds_read_b128 v[32:35], v0 offset:20480
  v_exp_f32 v56, v56
  v_exp_f32 v57, v57
  s_waitcnt lgkmcnt(1)
  v_smfmac_f32_16x16x64_bf16 v[40:43], v[28:31], v[144:151], v1
  v_exp_f32 v58, v58
  v_exp_f32 v59, v59
  v_smfmac_f32_16x16x64_bf16 v[44:47], v[28:31], v[152:159], v1
  v_exp_f32 v60, v60
  v_exp_f32 v61, v61
  s_waitcnt lgkmcnt(0)
  v_smfmac_f32_16x16x64_bf16 v[40:43], v[32:35], v[128:135], v1
  v_exp_f32 v62, v62
  v_exp_f32 v63, v63
  v_smfmac_f32_16x16x64_bf16 v[44:47], v[32:35], v[136:143], v1
  v_exp_f32 v52, v52
  v_exp_f32 v53, v53
  ds_read_b128 v[28:31], v3 offset:32768
  ds_read_b128 v[32:35], v3 offset:33792
  v_mov_b64 v[18:19], 0
  v_cvt_pk_bf16_f32 v24, v56, v57
  v_cvt_pk_bf16_f32 v25, v58, v59
  v_cvt_pk_bf16_f32 v26, v60, v61
  v_cvt_pk_bf16_f32 v27, v62, v63
  v_cvt_pk_bf16_f32 v16, v52, v53
  v_cvt_pk_bf16_f32 v19, v52, v53
  v_mfma_f32_16x16x32_bf16 v[52:55], v[36:39], v[24:27], 0
  v_add_f32 v40, v40, v42
  v_add_f32 v41, v41, v43
  v_mfma_f32_16x16x32_bf16 v[56:59], v[20:23], v[24:27], 0
  v_add_f32 v44, v44, v46
  v_add_f32 v45, v45, v47
  v_mfma_f32_16x16x32_bf16 v[60:63], v[12:15], v[24:27], 0
  v_cvt_pk_bf16_f32 v40, v40, v41
  v_cvt_pk_bf16_f32 v41, v44, v45
  s_add_u32 s51, s49, 4194304
  v_lshrrev_b32 v50, 1, v0
  v_mfma_f32_16x16x16_bf16 v[52:55], v[36:37], v[16:17], v[52:55]
  v_mov_b64 v[44:45], 0
  v_mov_b64 v[46:47], 0
  v_mfma_f32_16x16x16_bf16 v[56:59], v[40:41], v[16:17], v[56:59]
  buffer_store_dwordx2 v[40:41], v50, s[4:7], s51 offen offset:512 sc1
  v_mov_b64 v[12:13], 0
  v_mov_b64 v[14:15], 0
  v_mfma_f32_16x16x16_bf16 v[60:63], v[40:41], v[18:19], v[60:63]
  s_nop 0
  v_rcp_f32 v48, v52
  v_mov_b64 v[36:37], 0
  v_mov_b64_e64 v[38:39], 0
  s_mov_b64 exec, s[52:53]
  v_pk_mul_f32 v[56:57], v[56:57], v[48:49] op_sel_hi:[1,0]
  v_pk_mul_f32 v[58:59], v[58:59], v[48:49] op_sel_hi:[1,0]
  v_cvt_pk_bf16_f32 v56, v56, v57
  v_cvt_pk_bf16_f32 v57, v58, v59
  ds_write_b64 v7, v[56:57] offset:0
  v_pk_mul_f32 v[60:61], v[60:61], v[48:49] op_sel_hi:[1,0]
  v_pk_mul_f32 v[62:63], v[62:63], v[48:49] op_sel_hi:[1,0]
  v_cvt_pk_bf16_f32 v60, v60, v61
  v_cvt_pk_bf16_f32 v61, v62, v63
  ds_write_b64 v7, v[60:61] offset:256
  s_mov_b64 exec, -1
  v_mov_b32 v58, 0
  v_mov_b32_e64 v59, 0
  v_mov_b32 v56, 0
  v_mov_b32 v57, 0
  s_waitcnt lgkmcnt(0)
  s_barrier
  ds_read_b128 v[16:19], v4 offset:29696
  v_mov_b32_e64 v60, 0
  ds_read_b128 v[40:43], v4 offset:30208
  v_mov_b32 v61, 0
  ds_read_b128 v[48:51], v4 offset:30720
  v_mov_b32 v62, 0
  ds_read_b128 v[52:55], v4 offset:31232
  v_mov_b32_e64 v63, 0
  ds_read_b128 v[20:23], v3 offset:34816
  ds_read_b128 v[24:27], v3 offset:35840
  s_waitcnt lgkmcnt(5)
  v_smfmac_f32_16x16x64_bf16 v[44:47], v[16:19], a[160:167], v1
  s_waitcnt lgkmcnt(4)
  v_smfmac_f32_16x16x64_bf16 v[44:47], v[40:43], v[28:35], v1
  ds_read_b128 v[28:31], v3 offset:49152
  ds_read_b128 v[32:35], v3 offset:50176
  s_waitcnt lgkmcnt(5)
  v_smfmac_f32_16x16x64_bf16 v[44:47], v[48:51], a[168:175], v1
  s_waitcnt lgkmcnt(4)
  v_smfmac_f32_16x16x64_bf16 v[44:47], v[52:55], a[176:183], v1
  s_waitcnt lgkmcnt(2)
  v_smfmac_f32_16x16x64_bf16 v[12:15], v[16:19], v[20:27], v1
  ds_read_b128 v[20:23], v3 offset:51200
  ds_read_b128 v[24:27], v3 offset:52224
  v_smfmac_f32_16x16x64_bf16 v[12:15], v[40:43], a[184:191], v1
  s_nop 0
  v_cvt_pk_bf16_f32 v44, v44, v45
  v_cvt_pk_bf16_f32 v45, v46, v47
  v_smfmac_f32_16x16x64_bf16 v[12:15], v[48:51], a[192:199], v1
  v_bfi_b32 v44, 1, s54, v44
  v_bfi_b32 v45, 1, s54, v45
  buffer_store_dwordx2 v[44:45], v8, s[4:7], s89 offen
  v_smfmac_f32_16x16x64_bf16 v[12:15], v[52:55], a[200:207], v1
  s_waitcnt lgkmcnt(2)
  v_smfmac_f32_16x16x64_bf16 v[36:39], v[16:19], v[28:35], v1
  ds_read_b128 v[28:31], v0 offset:29696
  ds_read_b128 v[32:35], v0 offset:30720
  v_smfmac_f32_16x16x64_bf16 v[36:39], v[40:43], a[208:215], v1
  s_nop 0
  v_cvt_pk_bf16_f32 v12, v12, v13
  v_cvt_pk_bf16_f32 v13, v14, v15
  v_smfmac_f32_16x16x64_bf16 v[36:39], v[48:51], a[216:223], v1
  v_bfi_b32 v12, 1, s54, v12
  v_bfi_b32 v13, 1, s54, v13
  buffer_store_dwordx2 v[12:13], v8, s[4:7], s90 offen
  v_smfmac_f32_16x16x64_bf16 v[36:39], v[52:55], a[224:231], v1
  s_waitcnt lgkmcnt(2)
  v_smfmac_f32_16x16x64_bf16 v[56:59], v[16:19], v[20:27], v1
  v_smfmac_f32_16x16x64_bf16 v[56:59], v[40:43], a[232:239], v1
  s_nop 0
  v_cvt_pk_bf16_f32 v36, v36, v37
  v_cvt_pk_bf16_f32 v37, v38, v39
  v_smfmac_f32_16x16x64_bf16 v[56:59], v[48:51], a[240:247], v1
  v_bfi_b32 v36, 1, s54, v36
  v_bfi_b32 v37, 1, s54, v37
  buffer_store_dwordx2 v[36:37], v8, s[4:7], s91 offen
  v_smfmac_f32_16x16x64_bf16 v[56:59], v[52:55], a[248:255], v1
  s_waitcnt lgkmcnt(1)
  v_smfmac_f32_16x16x64_bf16 v[60:63], v[28:31], a[144:151], v1
  s_waitcnt lgkmcnt(0)
  v_smfmac_f32_16x16x64_bf16 v[60:63], v[32:35], a[152:159], v1
  s_nop 0
  v_cvt_pk_bf16_f32 v56, v56, v57
  v_cvt_pk_bf16_f32 v57, v58, v59
  v_bfi_b32 v56, 1, s54, v56
  v_bfi_b32 v57, 1, s54, v57
  buffer_store_dwordx2 v[56:57], v8, s[4:7], s92 offen
  s_nop 1
  v_pk_add_f32 v[60:61], v[60:61], v[62:63]
  v_cvt_pk_bf16_f32 v60, v60, v61
  v_bfi_b32 v60, 1, s54, v60
  buffer_store_dword v60, v8, s[4:7], s88 offen offset:4
  v_mov_b32 v51, -1
  buffer_store_dword v51, v10, s[4:7], s44 offen
  s_waitcnt vmcnt(3)
  s_nop 3
  buffer_load_dwordx4 v[20:23], v0, s[4:7], s41 offen offset:0 sc1
  buffer_load_dwordx4 v[24:27], v0, s[4:7], s41 offen offset:1024 sc1
  buffer_load_dwordx4 v[28:31], v0, s[4:7], s41 offen offset:2048 sc1
  buffer_load_dwordx4 v[32:35], v0, s[4:7], s41 offen offset:3072 sc1
  s_nop 7
  s_nop 3
  v_bfe_u32 v48, v0, 4, 1
  v_lshlrev_b32 v48, 4, v48
  v_mov_b32 v49, 0x3f80
  v_lshlrev_b32 v49, v48, v49
  v_bfe_u32 v48, v0, 5, 3
  v_cmp_eq_u32_e64 vcc, 0, v48
  s_nop 1
  v_cndmask_b32_e64 v36, 0, v49, vcc
  v_cmp_eq_u32 vcc, 1, v48
  s_nop 1
  v_cndmask_b32 v37, 0, v49, vcc
  v_cmp_eq_u32_e64 vcc, 2, v48
  s_nop 1
  v_cndmask_b32_e64 v38, 0, v49, vcc
  v_cmp_eq_u32 vcc, 3, v48
  s_nop 1
  v_cndmask_b32 v39, 0, v49, vcc
  buffer_load_dwordx4 v[20:23], v0, s[4:7], s41 offen offset:0 sc1
  buffer_load_dwordx4 v[24:27], v0, s[4:7], s41 offen offset:1024 sc1
  buffer_load_dwordx4 v[28:31], v0, s[4:7], s41 offen offset:2048 sc1
  buffer_load_dwordx4 v[32:35], v0, s[4:7], s41 offen offset:3072 sc1
  s_waitcnt vmcnt(7)
  v_bitop3_b32 v48, v20, v21, s54 bitop3:0x7e
  v_bitop3_b32 v49, v22, v23, s54 bitop3:0x7e
  v_mfma_f32_16x16x32_bf16 v[40:43], v[20:23], v[36:39], 0
  v_or_b32 v50, v48, v49
  s_waitcnt vmcnt(6)
  v_bitop3_b32 v48, v24, v25, s54 bitop3:0x7e
  v_bitop3_b32 v49, v26, v27, s54 bitop3:0x7e
  v_mfma_f32_16x16x32_bf16 v[40:43], v[24:27], v[36:39], v[40:43]
  v_or3_b32 v50, v50, v48, v49
  s_waitcnt vmcnt(5)
  v_bitop3_b32 v48, v28, v29, s54 bitop3:0x7e
  v_bitop3_b32 v49, v30, v31, s54 bitop3:0x7e
  v_mfma_f32_16x16x32_bf16 v[40:43], v[28:31], v[36:39], v[40:43]
  v_or3_b32 v50, v50, v48, v49
  s_waitcnt vmcnt(4)
  v_bitop3_b32 v48, v32, v33, s54 bitop3:0x7e
  v_bitop3_b32 v49, v34, v35, s54 bitop3:0x7e
  v_mfma_f32_16x16x32_bf16 v[40:43], v[32:35], v[36:39], v[40:43]
  v_or3_b32 v50, v50, v48, v49
  v_and_b32_e64 v50, 1, v50
  v_cmp_eq_u32 vcc, 1, v50
  s_nop 0
  s_cbranch_vccz L_okA_c1f
L_retA_c1f:
  s_add_u32 s50, s50, 1
  s_mov_b64 exec, vcc
  buffer_load_dwordx4 v[20:23], v0, s[4:7], s41 offen offset:0 sc1
  buffer_load_dwordx4 v[24:27], v0, s[4:7], s41 offen offset:1024 sc1
  buffer_load_dwordx4 v[28:31], v0, s[4:7], s41 offen offset:2048 sc1
  buffer_load_dwordx4 v[32:35], v0, s[4:7], s41 offen offset:3072 sc1
  s_mov_b64 exec, -1
  s_cmp_ge_u32 s50, 262144
  s_cbranch_scc1 L_chain_end
  s_waitcnt vmcnt(7)
  v_bitop3_b32 v48, v20, v21, s54 bitop3:0x7e
  v_bitop3_b32 v49, v22, v23, s54 bitop3:0x7e
  v_mfma_f32_16x16x32_bf16 v[40:43], v[20:23], v[36:39], 0
  v_or_b32 v50, v48, v49
  s_waitcnt vmcnt(6)
  v_bitop3_b32 v48, v24, v25, s54 bitop3:0x7e
  v_bitop3_b32 v49, v26, v27, s54 bitop3:0x7e
  v_mfma_f32_16x16x32_bf16 v[40:43], v[24:27], v[36:39], v[40:43]
  v_or3_b32 v50, v50, v48, v49
  s_waitcnt vmcnt(5)
  v_bitop3_b32 v48, v28, v29, s54 bitop3:0x7e
  v_bitop3_b32 v49, v30, v31, s54 bitop3:0x7e
  v_mfma_f32_16x16x32_bf16 v[40:43], v[28:31], v[36:39], v[40:43]
  v_or3_b32 v50, v50, v48, v49
  s_waitcnt vmcnt(4)
  v_bitop3_b32 v48, v32, v33, s54 bitop3:0x7e
  v_bitop3_b32 v49, v34, v35, s54 bitop3:0x7e
  v_mfma_f32_16x16x32_bf16 v[40:43], v[32:35], v[36:39], v[40:43]
  v_or3_b32 v50, v50, v48, v49
  v_and_b32 v50, 1, v50
  v_cmp_eq_u32_e64 vcc, 1, v50
  s_nop 0
  s_cbranch_vccnz L_retA_c1f
L_okA_c1f:
  s_nop 2
  v_permlane32_swap_b32 v40, v42
  v_permlane32_swap_b32 v41, v43
  v_add_f32 v40, v40, v42
  v_add_f32 v41, v41, v43
  v_cvt_pk_bf16_f32 v40, v40, v41
  buffer_store_dword v40, v10, s[4:7], s42 offen
  s_branch L_loop_c1f
L_loop_c1s:
  s_barrier
  s_mov_b32 s45, s42
  v_mov_b64 v[12:13], 0
  v_mov_b64 v[14:15], 0
  v_mov_b64 v[16:17], 0
  v_mov_b64 v[18:19], 0
  buffer_load_dwordx4 v[28:31], v11, s[4:7], s45 offen offset:0 sc1
  buffer_load_dwordx4 v[32:35], v11, s[4:7], s45 offen offset:1024 sc1
  ds_read_b128 v[40:43], v2 offset:16384
  ds_read_b128 v[44:47], v2 offset:17408
  ds_read_b128 v[48:51], v2 offset:18432
  ds_read_b128 v[52:55], v2 offset:19456
  ds_read_b128 v[56:59], v2 offset:32768
  ds_read_b128 v[60:63], v2 offset:33792
  s_waitcnt lgkmcnt(0)
  s_waitcnt vmcnt(3)
  v_mov_b64 v[20:21], 0
  v_mov_b64 v[22:23], 0
  v_mov_b64 v[24:25], 0
  v_mov_b64 v[26:27], 0
  s_add_u32 s40, s40, 1
  s_xor_b32 s54, s54, 1
  s_mov_b32 s42, s44
  s_mov_b32 s44, s43
  s_mov_b32 s43, s45
  s_add_u32 s48, s48, 262144
  s_add_u32 s93, s93, 262144
  s_add_u32 s49, s49, 65536
  s_nop 3
  buffer_load_dwordx4 v[28:31], v11, s[4:7], s45 offen offset:0 sc1
  buffer_load_dwordx4 v[32:35], v11, s[4:7], s45 offen offset:1024 sc1
  s_cmp_eq_u32 s40, 63
  s_waitcnt vmcnt(3) lgkmcnt(0)
  v_max3_u32 v36, v28, v29, v30
  v_max_u32 v36, v36, v31
  ds_write_b128 v0, v[28:31] offset:18432
  s_waitcnt vmcnt(2)
  v_max3_u32 v36, v36, v32, v33
  v_max3_u32 v36, v36, v34, v35
  ds_write_b128 v0, v[32:35] offset:19456
  v_cmp_eq_u32 vcc, -1, v36
  s_nop 0
  s_cbranch_vccz L_okB_c1s
L_retB_c1s:
  s_add_u32 s50, s50, 1
  s_mov_b64 exec, vcc
  buffer_load_dwordx4 v[28:31], v11, s[4:7], s45 offen offset:0 sc1
  buffer_load_dwordx4 v[32:35], v11, s[4:7], s45 offen offset:1024 sc1
  s_mov_b64 exec, -1
  s_cmp_ge_u32 s50, 262144
  s_cbranch_scc1 L_chain_end
  s_cmp_eq_u32 s40, 63
  s_waitcnt vmcnt(3)
  v_max3_u32 v36, v28, v29, v30
  v_max_u32 v36, v36, v31
  ds_write_b128 v0, v[28:31] offset:18432
  s_waitcnt vmcnt(2)
  v_max3_u32 v36, v36, v32, v33
  v_max3_u32 v36, v36, v34, v35
  ds_write_b128 v0, v[32:35] offset:19456
  v_cmp_eq_u32 vcc, -1, v36
  s_nop 0
  s_cbranch_vccnz L_retB_c1s
L_okB_c1s:
  s_cbranch_scc1 L_last_1
L_enter_c1s:
  v_smfmac_f32_16x16x64_bf16 v[12:15], v[28:31], v[240:247], v1
  v_smfmac_f32_16x16x64_bf16 v[20:23], v[28:31], v[40:47], v1
  ds_read_b128 v[40:43], v2 offset:34816
  ds_read_b128 v[44:47], v2 offset:35840
  v_smfmac_f32_16x16x64_bf16 v[16:19], v[28:31], v[248:255], v1
  s_waitcnt lgkmcnt(2)
  s_barrier
  ds_read_b128 v[36:39], v0 offset:17408
  v_smfmac_f32_16x16x64_bf16 v[24:27], v[28:31], v[48:55], v1
  ds_read_b128 v[48:51], v2 offset:0
  ds_read_b128 v[52:55], v2 offset:1024
  s_waitcnt vmcnt(0)
  ds_read_b128 v[28:31], v0 offset:16384
  v_smfmac_f32_16x16x64_bf16 v[12:15], v[32:35], a[0:7], v1
  v_smfmac_f32_16x16x64_bf16 v[20:23], v[32:35], v[56:63], v1
  ds_read_b128 v[56:59], v2 offset:2048
  ds_read_b128 v[60:63], v2 offset:3072
  v_smfmac_f32_16x16x64_bf16 v[16:19], v[32:35], a[8:15], v1
  s_mov_b32 m0, 2048
  s_add_u32 s51, s48, 2048
  buffer_load_dwordx4 v0, s[4:7], s51 offen offset:0 sc1 lds
  s_waitcnt lgkmcnt(6)
  v_smfmac_f32_16x16x64_bf16 v[24:27], v[32:35], v[40:47], v1
  ds_read_b128 v[40:43], v2 offset:49152
  ds_read_b128 v[44:47], v2 offset:50176
  s_waitcnt lgkmcnt(7)
  v_smfmac_f32_16x16x64_bf16 v[12:15], v[36:39], v[224:231], v1
  ds_read_b128 v[32:35], v0 offset:21504
  v_smfmac_f32_16x16x64_bf16 v[20:23], v[36:39], a[96:103], v1
  v_smfmac_f32_16x16x64_bf16 v[16:19], v[36:39], v[232:239], v1
  s_mov_b32 m0, 6144
  s_add_u32 s51, s48, 6144
  buffer_load_dwordx4 v0, s[4:7], s51 offen offset:0 sc1 lds
  v_smfmac_f32_16x16x64_bf16 v[24:27], v[36:39], a[104:111], v1
  s_waitcnt lgkmcnt(5)
  v_smfmac_f32_16x16x64_bf16 v[12:15], v[28:31], v[208:215], v1
  ds_read_b128 v[36:39], v0 offset:20480
  v_smfmac_f32_16x16x64_bf16 v[20:23], v[28:31], v[48:55], v1
  ds_read_b128 v[48:51], v2 offset:51200
  ds_read_b128 v[52:55], v2 offset:52224
  v_smfmac_f32_16x16x64_bf16 v[16:19], v[28:31], v[216:223], v1
  s_mov_b32 m0, 10240
  s_add_u32 s51, s48, 16779264
  buffer_load_dwordx4 v0, s[4:7], s51 offen offset:0 sc1 lds
  s_waitcnt lgkmcnt(6)
  v_smfmac_f32_16x16x64_bf16 v[24:27], v[28:31], v[56:63], v1
  ds_read_b128 v[56:59], v3 offset:0
  ds_read_b128 v[60:63], v3 offset:1024
  s_waitcnt lgkmcnt(5)
  v_smfmac_f32_16x16x64_bf16 v[12:15], v[32:35], a[32:39], v1
  ds_read_b128 v[28:31], v0 offset:22528
  v_smfmac_f32_16x16x64_bf16 v[20:23], v[32:35], v[40:47], v1
  ds_read_b128 v[40:43], v3 offset:2048
  ds_read_b128 v[44:47], v3 offset:3072
  v_smfmac_f32_16x16x64_bf16 v[16:19], v[32:35], a[40:47], v1
  buffer_load_dwordx4 v0, s[4:7], s51 offen offset:1024 sc1 lds
  s_waitcnt lgkmcnt(5)
  v_smfmac_f32_16x16x64_bf16 v[24:27], v[32:35], v[48:55], v1
  ds_read_b128 v[48:51], v3 offset:16384
  ds_read_b128 v[52:55], v3 offset:17408
  v_smfmac_f32_16x16x64_bf16 v[12:15], v[36:39], a[16:23], v1
  ds_read_b128 v[32:35], v0 offset:24576
  v_smfmac_f32_16x16x64_bf16 v[20:23], v[36:39], a[112:119], v1
  v_smfmac_f32_16x16x64_bf16 v[16:19], v[36:39], a[24:31], v1
  s_mov_b32 m0, 32000
  s_nop 0
  buffer_load_dword v0, s[28:31], s93 idxen sc1 lds
  v_smfmac_f32_16x16x64_bf16 v[24:27], v[36:39], a[120:127], v1
  s_waitcnt lgkmcnt(5)
  v_smfmac_f32_16x16x64_bf16 v[12:15], v[28:31], a[48:55], v1
  ds_read_b128 v[36:39], v0 offset:23552
  v_smfmac_f32_16x16x64_bf16 v[20:23], v[28:31], v[56:63], v1
  ds_read_b128 v[56:59], v3 offset:18432
  ds_read_b128 v[60:63], v3 offset:19456
  v_smfmac_f32_16x16x64_bf16 v[16:19], v[28:31], a[56:63], v1
  s_waitcnt lgkmcnt(6)
  v_smfmac_f32_16x16x64_bf16 v[24:27], v[28:31], v[40:47], v1
  s_waitcnt lgkmcnt(3)
  v_smfmac_f32_16x16x64_bf16 v[12:15], v[32:35], a[80:87], v1
  v_mov_b64 v[40:41], 0
  v_smfmac_f32_16x16x64_bf16 v[20:23], v[32:35], v[48:55], v1
  v_smfmac_f32_16x16x64_bf16 v[16:19], v[32:35], a[88:95], v1
  v_mov_b64 v[42:43], 0
  s_waitcnt lgkmcnt(0)
  v_smfmac_f32_16x16x64_bf16 v[24:27], v[32:35], v[56:63], v1
  v_smfmac_f32_16x16x64_bf16 v[12:15], v[36:39], a[64:71], v1
  v_mov_b64 v[44:45], 0
  v_smfmac_f32_16x16x64_bf16 v[20:23], v[36:39], a[128:135], v1
  v_mov_b64 v[46:47], 0
  v_smfmac_f32_16x16x64_bf16 v[16:19], v[36:39], a[72:79], v1
  v_smfmac_f32_16x16x64_bf16 v[24:27], v[36:39], a[136:143], v1
  v_pk_add_f32 v[12:13], v[12:13], v[14:15]
  v_pk_add_f32 v[20:21], v[20:21], v[22:23]
  v_cvt_pk_bf16_f32 v23, v12, v13
  v_cvt_pk_bf16_f32 v22, v20, v21
  ds_write_b64 v5, v[22:23] offset:0
  v_pk_add_f32 v[16:17], v[16:17], v[18:19]
  s_nop 1
  v_pk_add_f32 v[24:25], v[24:25], v[26:27]
  v_cvt_pk_bf16_f32 v27, v16, v17
  v_cvt_pk_bf16_f32 v26, v24, v25
  ds_write_b64 v5, v[26:27] offset:512
  v_smfmac_f32_16x16x64_bf16 v[40:43], v[28:31], v[160:167], v1
  v_xor_b32 v52, 16, v6
  s_waitcnt vmcnt(3)
  ds_read_b128 v[60:63], v0 offset:2048
  v_smfmac_f32_16x16x64_bf16 v[44:47], v[28:31], v[168:175], v1
  ds_read_b128 v[28:31], v0 offset:18432
  ds_read_b128 v[48:51], v0 offset:6144
  v_smfmac_f32_16x16x64_bf16 v[40:43], v[32:35], v[192:199], v1
  v_smfmac_f32_16x16x64_bf16 v[44:47], v[32:35], v[200:207], v1
  ds_read_b128 v[32:35], v0 offset:19456
  v_smfmac_f32_16x16x64_bf16 v[40:43], v[36:39], v[176:183], v1
  s_waitcnt lgkmcnt(4)
  s_barrier
  ds_read_b64_tr_b16 v[12:13], v6 offset:2048
  ds_read_b64_tr_b16 v[14:15], v52 offset:2304
  ds_read_b64_tr_b16 v[16:17], v6 offset:3072
  ds_read_b64_tr_b16 v[18:19], v52 offset:3328
  v_smfmac_f32_16x16x64_bf16 v[44:47], v[36:39], v[184:191], v1
  ds_read_b64_tr_b16 v[20:21], v6 offset:0
  ds_read_b64_tr_b16 v[22:23], v52 offset:256
  s_waitcnt lgkmcnt(8)
  v_smfmac_f32_16x16x64_bf16 v[40:43], v[28:31], v[96:103], v1
  ds_read_b64_tr_b16 v[24:25], v6 offset:1024
  ds_read_b64_tr_b16 v[26:27], v52 offset:1280
  v_smfmac_f32_16x16x64_bf16 v[44:47], v[28:31], v[104:111], v1
  ds_read_b128 v[28:31], v0 offset:17408
  s_waitcnt lgkmcnt(9)
  v_smfmac_f32_16x16x64_bf16 v[40:43], v[32:35], v[112:119], v1
  v_smfmac_f32_16x16x64_bf16 v[44:47], v[32:35], v[120:127], v1
  ds_read_b128 v[32:35], v0 offset:16384
  s_waitcnt lgkmcnt(8)
  v_mfma_f32_16x16x32_bf16 v[56:59], v[60:63], v[12:15], 0
  ds_read_b128 v[36:39], v0 offset:3072
  v_mfma_f32_16x16x32_bf16 v[60:63], v[48:51], v[12:15], 0
  ds_read_b128 v[48:51], v0 offset:7168
  v_mfma_f32_16x16x32_bf16 v[52:55], v[12:15], v[12:15], 0
  ds_read_b128 v[12:15], v0 offset:0
  s_waitcnt lgkmcnt(9)
  v_mfma_f32_16x16x32_bf16 v[52:55], v[16:19], v[16:19], v[52:55]
  s_waitcnt lgkmcnt(2)
  v_mfma_f32_16x16x32_bf16 v[56:59], v[36:39], v[16:19], v[56:59]
  ds_read_b128 v[36:39], v0 offset:4096
  s_waitcnt lgkmcnt(2)
  v_mfma_f32_16x16x32_bf16 v[60:63], v[48:51], v[16:19], v[60:63]
  ds_read_b128 v[48:51], v0 offset:1024
  ds_read_b128 v[16:19], v0 offset:5120
  v_mfma_f32_16x16x32_bf16 v[52:55], v[20:23], v[20:23], v[52:55]
  s_waitcnt lgkmcnt(3)
  v_mfma_f32_16x16x32_bf16 v[56:59], v[12:15], v[20:23], v[56:59]
  s_waitcnt lgkmcnt(2)
  v_mfma_f32_16x16x32_bf16 v[60:63], v[36:39], v[20:23], v[60:63]
  s_waitcnt vmcnt(1)
  ds_read_b128 v[20:23], v0 offset:10240
  ds_read_b128 v[12:15], v0 offset:11264
  v_mfma_f32_16x16x32_bf16 v[52:55], v[24:27], v[24:27], v[52:55]
  s_waitcnt lgkmcnt(3)
  v_mfma_f32_16x16x32_bf16 v[56:59], v[48:51], v[24:27], v[56:59]
  s_waitcnt lgkmcnt(2)
  v_mfma_f32_16x16x32_bf16 v[60:63], v[16:19], v[24:27], v[60:63]
  v_smfmac_f32_16x16x64_bf16 v[40:43], v[28:31], v[80:87], v1
  buffer_store_dwordx4 v[24:27], v9, s[4:7], s49 offen offset:512 sc1
  v_mov_b32 v36, 0x3f803f80
  v_mov_b32 v37, 0x3f803f80
  v_max3_f32 v48, v52, v53, v56
  v_max3_f32 v48, v48, v57, v58
  v_max3_f32 v48, v48, v59, v60
  v_max3_f32 v48, v48, v61, v62
  v_max_f32 v49, v48, v63
  v_max_f32 v48, v48, v63
  v_smfmac_f32_16x16x64_bf16 v[44:47], v[28:31], v[88:95], v1
  ds_read_b128 v[28:31], v0 offset:21504
  v_mov_b64 v[38:39], v[36:37]
  v_permlane32_swap_b32 v48, v49
  v_max_f32 v48, v48, v49
  v_mov_b32 v49, v48
  v_smfmac_f32_16x16x64_bf16 v[40:43], v[32:35], v[64:71], v1
  v_mov_b64 v[16:17], 0
  v_permlane16_swap_b32 v48, v49
  v_max_f32 v48, v48, v49
  v_mul_f32 v48, s47, v48
  v_pk_fma_f32 v[56:57], v[56:57], s[46:47], v[48:49] op_sel_hi:[1,0,0]
  v_pk_fma_f32 v[58:59], v[58:59], s[46:47], v[48:49] op_sel_hi:[1,0,0]
  v_pk_fma_f32 v[60:61], v[60:61], s[46:47], v[48:49] op_sel_hi:[1,0,0]
  v_pk_fma_f32 v[62:63], v[62:63], s[46:47], v[48:49] op_sel_hi:[1,0,0]
  v_pk_fma_f32 v[52:53], v[52:53], s[46:47], v[48:49] op_sel_hi:[1,0,0]
  v_smfmac_f32_16x16x64_bf16 v[44:47], v[32:35], v[72:79], v1
  ds_read_b128 v[32:35], v0 offset:20480
  v_exp_f32 v56, v56
  v_exp_f32 v57, v57
  s_waitcnt lgkmcnt(1)
  v_smfmac_f32_16x16x64_bf16 v[40:43], v[28:31], v[144:151], v1
  v_exp_f32 v58, v58
  v_exp_f32 v59, v59
  v_smfmac_f32_16x16x64_bf16 v[44:47], v[28:31], v[152:159], v1
  v_exp_f32 v60, v60
  v_exp_f32 v61, v61
  s_waitcnt lgkmcnt(0)
  v_smfmac_f32_16x16x64_bf16 v[40:43], v[32:35], v[128:135], v1
  v_exp_f32 v62, v62
  v_exp_f32 v63, v63
  v_smfmac_f32_16x16x64_bf16 v[44:47], v[32:35], v[136:143], v1
  v_exp_f32 v52, v52
  v_exp_f32 v53, v53
  ds_read_b128 v[28:31], v3 offset:32768
  ds_read_b128 v[32:35], v3 offset:33792
  v_mov_b64 v[18:19], 0
  v_cvt_pk_bf16_f32 v24, v56, v57
  v_cvt_pk_bf16_f32 v25, v58, v59
  v_cvt_pk_bf16_f32 v26, v60, v61
  v_cvt_pk_bf16_f32 v27, v62, v63
  v_cvt_pk_bf16_f32 v16, v52, v53
  v_cvt_pk_bf16_f32 v19, v52, v53
  v_mfma_f32_16x16x32_bf16 v[52:55], v[36:39], v[24:27], 0
  v_add_f32 v40, v40, v42
  v_add_f32 v41, v41, v43
  v_mfma_f32_16x16x32_bf16 v[56:59], v[20:23], v[24:27], 0
  v_add_f32 v44, v44, v46
  v_add_f32 v45, v45, v47
  v_mfma_f32_16x16x32_bf16 v[60:63], v[12:15], v[24:27], 0
  v_cvt_pk_bf16_f32 v40, v40, v41
  v_cvt_pk_bf16_f32 v41, v44, v45
  s_add_u32 s51, s49, 4194304
  v_lshrrev_b32 v50, 1, v0
  v_mfma_f32_16x16x16_bf16 v[52:55], v[36:37], v[16:17], v[52:55]
  v_mov_b64 v[44:45], 0
  v_mov_b64 v[46:47], 0
  v_mfma_f32_16x16x16_bf16 v[56:59], v[40:41], v[16:17], v[56:59]
  buffer_store_dwordx2 v[40:41], v50, s[4:7], s51 offen offset:512 sc1
  v_mov_b64 v[12:13], 0
  v_mov_b64 v[14:15], 0
  v_mfma_f32_16x16x16_bf16 v[60:63], v[40:41], v[18:19], v[60:63]
  s_nop 0
  v_rcp_f32 v48, v52
  v_mov_b64 v[36:37], 0
  v_mov_b64 v[38:39], 0
  s_mov_b64 exec, s[52:53]
  v_pk_mul_f32 v[56:57], v[56:57], v[48:49] op_sel_hi:[1,0]
  v_pk_mul_f32 v[58:59], v[58:59], v[48:49] op_sel_hi:[1,0]
  v_cvt_pk_bf16_f32 v56, v56, v57
  v_cvt_pk_bf16_f32 v57, v58, v59
  ds_write_b64 v7, v[56:57] offset:0
  v_pk_mul_f32 v[60:61], v[60:61], v[48:49] op_sel_hi:[1,0]
  v_pk_mul_f32 v[62:63], v[62:63], v[48:49] op_sel_hi:[1,0]
  v_cvt_pk_bf16_f32 v60, v60, v61
  v_cvt_pk_bf16_f32 v61, v62, v63
  ds_write_b64 v7, v[60:61] offset:256
  s_mov_b64 exec, -1
  v_mov_b32 v58, 0
  v_mov_b32 v59, 0
  v_mov_b32 v56, 0
  v_mov_b32 v57, 0
  s_waitcnt lgkmcnt(0)
  s_barrier
  ds_read_b128 v[16:19], v4 offset:29696
  v_mov_b32 v60, 0
  ds_read_b128 v[40:43], v4 offset:30208
  v_mov_b32 v61, 0
  ds_read_b128 v[48:51], v4 offset:30720
  v_mov_b32 v62, 0
  ds_read_b128 v[52:55], v4 offset:31232
  v_mov_b32 v63, 0
  ds_read_b128 v[20:23], v3 offset:34816
  ds_read_b128 v[24:27], v3 offset:35840
  s_waitcnt lgkmcnt(5)
  v_smfmac_f32_16x16x64_bf16 v[44:47], v[16:19], a[160:167], v1
  s_waitcnt lgkmcnt(4)
  v_smfmac_f32_16x16x64_bf16 v[44:47], v[40:43], v[28:35], v1
  ds_read_b128 v[28:31], v3 offset:49152
  ds_read_b128 v[32:35], v3 offset:50176
  s_waitcnt lgkmcnt(5)
  v_smfmac_f32_16x16x64_bf16 v[44:47], v[48:51], a[168:175], v1
  s_waitcnt lgkmcnt(4)
  v_smfmac_f32_16x16x64_bf16 v[44:47], v[52:55], a[176:183], v1
  s_waitcnt lgkmcnt(2)
  v_smfmac_f32_16x16x64_bf16 v[12:15], v[16:19], v[20:27], v1
  ds_read_b128 v[20:23], v3 offset:51200
  ds_read_b128 v[24:27], v3 offset:52224
  v_smfmac_f32_16x16x64_bf16 v[12:15], v[40:43], a[184:191], v1
  s_nop 0
  v_cvt_pk_bf16_f32 v44, v44, v45
  v_cvt_pk_bf16_f32 v45, v46, v47
  v_smfmac_f32_16x16x64_bf16 v[12:15], v[48:51], a[192:199], v1
  v_bfi_b32 v44, 1, s54, v44
  v_bfi_b32 v45, 1, s54, v45
  buffer_store_dwordx2 v[44:45], v8, s[4:7], s89 offen sc1
  v_smfmac_f32_16x16x64_bf16 v[12:15], v[52:55], a[200:207], v1
  s_waitcnt lgkmcnt(2)
  v_smfmac_f32_16x16x64_bf16 v[36:39], v[16:19], v[28:35], v1
  ds_read_b128 v[28:31], v0 offset:29696
  ds_read_b128 v[32:35], v0 offset:30720
  v_smfmac_f32_16x16x64_bf16 v[36:39], v[40:43], a[208:215], v1
  s_nop 0
  v_cvt_pk_bf16_f32 v12, v12, v13
  v_cvt_pk_bf16_f32 v13, v14, v15
  v_smfmac_f32_16x16x64_bf16 v[36:39], v[48:51], a[216:223], v1
  v_bfi_b32 v12, 1, s54, v12
  v_bfi_b32 v13, 1, s54, v13
  buffer_store_dwordx2 v[12:13], v8, s[4:7], s90 offen sc1
  v_smfmac_f32_16x16x64_bf16 v[36:39], v[52:55], a[224:231], v1
  s_waitcnt lgkmcnt(2)
  v_smfmac_f32_16x16x64_bf16 v[56:59], v[16:19], v[20:27], v1
  v_smfmac_f32_16x16x64_bf16 v[56:59], v[40:43], a[232:239], v1
  s_nop 0
  v_cvt_pk_bf16_f32 v36, v36, v37
  v_cvt_pk_bf16_f32 v37, v38, v39
  v_smfmac_f32_16x16x64_bf16 v[56:59], v[48:51], a[240:247], v1
  v_bfi_b32 v36, 1, s54, v36
  v_bfi_b32 v37, 1, s54, v37
  buffer_store_dwordx2 v[36:37], v8, s[4:7], s91 offen sc1
  v_smfmac_f32_16x16x64_bf16 v[56:59], v[52:55], a[248:255], v1
  s_waitcnt lgkmcnt(1)
  v_smfmac_f32_16x16x64_bf16 v[60:63], v[28:31], a[144:151], v1
  s_waitcnt lgkmcnt(0)
  v_smfmac_f32_16x16x64_bf16 v[60:63], v[32:35], a[152:159], v1
  s_nop 0
  v_cvt_pk_bf16_f32 v56, v56, v57
  v_cvt_pk_bf16_f32 v57, v58, v59
  v_bfi_b32 v56, 1, s54, v56
  v_bfi_b32 v57, 1, s54, v57
  buffer_store_dwordx2 v[56:57], v8, s[4:7], s92 offen sc1
  s_nop 1
  v_pk_add_f32 v[60:61], v[60:61], v[62:63]
  v_cvt_pk_bf16_f32 v60, v60, v61
  v_bfi_b32 v60, 1, s54, v60
  buffer_store_dword v60, v8, s[4:7], s88 offen offset:4 sc1
  v_mov_b32 v51, -1
  buffer_store_dword v51, v10, s[4:7], s44 offen sc1
  s_waitcnt vmcnt(3)
  s_nop 3
  buffer_load_dwordx4 v[20:23], v0, s[4:7], s41 offen offset:0 sc1
  buffer_load_dwordx4 v[24:27], v0, s[4:7], s41 offen offset:1024 sc1
  buffer_load_dwordx4 v[28:31], v0, s[4:7], s41 offen offset:2048 sc1
  buffer_load_dwordx4 v[32:35], v0, s[4:7], s41 offen offset:3072 sc1
  s_nop 7
  s_nop 3
  v_bfe_u32 v48, v0, 4, 1
  v_lshlrev_b32 v48, 4, v48
  v_mov_b32 v49, 0x3f80
  v_lshlrev_b32 v49, v48, v49
  v_bfe_u32 v48, v0, 5, 3
  v_cmp_eq_u32 vcc, 0, v48
  s_nop 1
  v_cndmask_b32 v36, 0, v49, vcc
  v_cmp_eq_u32 vcc, 1, v48
  s_nop 1
  v_cndmask_b32 v37, 0, v49, vcc
  v_cmp_eq_u32 vcc, 2, v48
  s_nop 1
  v_cndmask_b32 v38, 0, v49, vcc
  v_cmp_eq_u32 vcc, 3, v48
  s_nop 1
  v_cndmask_b32 v39, 0, v49, vcc
  buffer_load_dwordx4 v[20:23], v0, s[4:7], s41 offen offset:0 sc1
  buffer_load_dwordx4 v[24:27], v0, s[4:7], s41 offen offset:1024 sc1
  buffer_load_dwordx4 v[28:31], v0, s[4:7], s41 offen offset:2048 sc1
  buffer_load_dwordx4 v[32:35], v0, s[4:7], s41 offen offset:3072 sc1
  s_waitcnt vmcnt(7)
  v_bitop3_b32 v48, v20, v21, s54 bitop3:0x7e
  v_bitop3_b32 v49, v22, v23, s54 bitop3:0x7e
  v_mfma_f32_16x16x32_bf16 v[40:43], v[20:23], v[36:39], 0
  v_or_b32 v50, v48, v49
  s_waitcnt vmcnt(6)
  v_bitop3_b32 v48, v24, v25, s54 bitop3:0x7e
  v_bitop3_b32 v49, v26, v27, s54 bitop3:0x7e
  v_mfma_f32_16x16x32_bf16 v[40:43], v[24:27], v[36:39], v[40:43]
  v_or3_b32 v50, v50, v48, v49
  s_waitcnt vmcnt(5)
  v_bitop3_b32 v48, v28, v29, s54 bitop3:0x7e
  v_bitop3_b32 v49, v30, v31, s54 bitop3:0x7e
  v_mfma_f32_16x16x32_bf16 v[40:43], v[28:31], v[36:39], v[40:43]
  v_or3_b32 v50, v50, v48, v49
  s_waitcnt vmcnt(4)
  v_bitop3_b32 v48, v32, v33, s54 bitop3:0x7e
  v_bitop3_b32 v49, v34, v35, s54 bitop3:0x7e
  v_mfma_f32_16x16x32_bf16 v[40:43], v[32:35], v[36:39], v[40:43]
  v_or3_b32 v50, v50, v48, v49
  v_and_b32 v50, 1, v50
  v_cmp_eq_u32 vcc, 1, v50
  s_nop 0
  s_cbranch_vccz L_okA_c1s
L_retA_c1s:
  s_add_u32 s50, s50, 1
  s_mov_b64 exec, vcc
  buffer_load_dwordx4 v[20:23], v0, s[4:7], s41 offen offset:0 sc1
  buffer_load_dwordx4 v[24:27], v0, s[4:7], s41 offen offset:1024 sc1
  buffer_load_dwordx4 v[28:31], v0, s[4:7], s41 offen offset:2048 sc1
  buffer_load_dwordx4 v[32:35], v0, s[4:7], s41 offen offset:3072 sc1
  s_mov_b64 exec, -1
  s_cmp_ge_u32 s50, 262144
  s_cbranch_scc1 L_chain_end
  s_waitcnt vmcnt(7)
  v_bitop3_b32 v48, v20, v21, s54 bitop3:0x7e
  v_bitop3_b32 v49, v22, v23, s54 bitop3:0x7e
  v_mfma_f32_16x16x32_bf16 v[40:43], v[20:23], v[36:39], 0
  v_or_b32 v50, v48, v49
  s_waitcnt vmcnt(6)
  v_bitop3_b32 v48, v24, v25, s54 bitop3:0x7e
  v_bitop3_b32 v49, v26, v27, s54 bitop3:0x7e
  v_mfma_f32_16x16x32_bf16 v[40:43], v[24:27], v[36:39], v[40:43]
  v_or3_b32 v50, v50, v48, v49
  s_waitcnt vmcnt(5)
  v_bitop3_b32 v48, v28, v29, s54 bitop3:0x7e
  v_bitop3_b32 v49, v30, v31, s54 bitop3:0x7e
  v_mfma_f32_16x16x32_bf16 v[40:43], v[28:31], v[36:39], v[40:43]
  v_or3_b32 v50, v50, v48, v49
  s_waitcnt vmcnt(4)
  v_bitop3_b32 v48, v32, v33, s54 bitop3:0x7e
  v_bitop3_b32 v49, v34, v35, s54 bitop3:0x7e
  v_mfma_f32_16x16x32_bf16 v[40:43], v[32:35], v[36:39], v[40:43]
  v_or3_b32 v50, v50, v48, v49
  v_and_b32 v50, 1, v50
  v_cmp_eq_u32 vcc, 1, v50
  s_nop 0
  s_cbranch_vccnz L_retA_c1s
L_okA_c1s:
  s_nop 2
  v_permlane32_swap_b32 v40, v42
  v_permlane32_swap_b32 v41, v43
  v_add_f32 v40, v40, v42
  v_add_f32 v41, v41, v43
  v_cvt_pk_bf16_f32 v40, v40, v41
  buffer_store_dword v40, v10, s[4:7], s42 offen sc1
  s_branch L_loop_c1s
L_chain_w2:
  v_mov_b32 v12, v0
  v_lshlrev_b32 v0, 4, v12
  v_and_b32 v13, 15, v12
  v_lshrrev_b32 v14, 4, v12
  v_mov_b32 v1, 0x4444
  v_and_b32 v15, 2, v12
  v_cmp_ne_u32 vcc, 0, v15
  v_mov_b32 v16, 0xeeee
  s_nop 0
  v_cndmask_b32 v1, v1, v16, vcc
  v_add_u32 v2, 40960, v0
  v_add_u32 v3, 106496, v0
  v_and_b32 v16, 13, v13
  v_and_b32 v17, 1, v14
  v_lshl_add_u32 v16, v17, 1, v16
  v_lshrrev_b32 v18, 1, v14
  v_lshl_add_u32 v16, v18, 4, v16
  v_lshlrev_b32 v4, 4, v16
  v_lshrrev_b32 v16, 2, v13
  v_xor_b32 v19, v16, v14
  v_lshlrev_b32 v19, 3, v19
  v_lshl_add_u32 v19, v13, 5, v19
  v_add_u32 v5, 27648, v19
  v_lshl_add_u32 v19, v17, 2, v16
  v_lshl_add_u32 v19, v18, 4, v19
  v_lshlrev_b32 v19, 5, v19
  v_and_b32 v20, 3, v13
  v_xor_b32 v20, v20, v17
  v_lshl_add_u32 v6, v20, 3, v19
  v_add_u32 v6, 25600, v6
  v_and_b32 v19, 13, v13
  v_lshl_add_u32 v19, v18, 1, v19
  v_lshlrev_b32 v19, 4, v19
  v_lshl_add_u32 v19, v17, 3, v19
  v_add_u32 v7, 30720, v19
  s_lshl_b32 s34, s32, 7
  v_and_b32 v19, 7, v13
  v_lshlrev_b32 v19, 4, v19
  v_lshrrev_b32 v20, 3, v13
  v_lshl_add_u32 v19, v20, 3, v19
  v_lshl_add_u32 v19, v14, 12, v19
  v_add_u32 v8, s34, v19
  v_and_b32 v19, 0x3c0, v0
  v_lshrrev_b32 v19, 1, v19
  v_and_b32 v20, 0x10, v0
  v_or_b32 v19, v19, v20
  v_and_b32 v20, 0x20, v0
  v_lshl_or_b32 v9, v20, 26, v19
  s_add_u32 s34, s32, 64
  s_mov_b32 s36, 8
  s_lshl_b32 s41, s34, 12
  s_add_u32 s41, s41, 65536
  s_lshl_b32 s35, s34, 7
  v_bfe_u32 v19, v13, 1, 1
  v_lshlrev_b32 v19, 6, v19
  v_and_b32 v20, 1, v13
  v_lshl_add_u32 v19, v20, 5, v19
  v_lshl_add_u32 v19, v16, 4, v19
  v_lshl_add_u32 v19, v17, 3, v19
  v_lshl_add_u32 v19, v18, 2, v19
  v_add_u32 v19, s35, v19
  v_mov_b32 v20, 0x80000000
  v_cmp_gt_u32 vcc, s36, v13
  s_nop 1
  v_cndmask_b32 v10, v20, v19, vcc
  v_lshlrev_b32 v19, 9, v18
  v_lshl_add_u32 v19, v16, 7, v19
  v_lshl_add_u32 v19, v17, 6, v19
  v_and_b32 v20, 1, v13
  v_lshl_add_u32 v19, v20, 5, v19
  v_and_b32 v20, 2, v13
  v_lshl_add_u32 v19, v20, 3, v19
  v_add_u32 v11, 4096, v19
  s_mov_b32 s42, 664576
  s_mov_b32 s43, 655360
  s_mov_b32 s44, 673792
  v_mov_b64 v[44:45], -1
  v_mov_b64 v[46:47], -1
  s_cmp_ge_u32 s32, 8
  s_cbranch_scc1 L_noinit_86
  buffer_store_dwordx4 v[44:47], v0, s[4:7], s41 offen offset:0 sc1
  buffer_store_dwordx4 v[44:47], v0, s[4:7], s41 offen offset:1024 sc1
  buffer_store_dwordx4 v[44:47], v0, s[4:7], s41 offen offset:2048 sc1
  buffer_store_dwordx4 v[44:47], v0, s[4:7], s41 offen offset:3072 sc1
  buffer_store_dword v44, v10, s[4:7], s42 offen sc1
  buffer_store_dword v44, v10, s[4:7], s43 offen sc1
  buffer_store_dword v44, v10, s[4:7], s44 offen sc1
L_noinit_86:
  s_mov_b32 s40, 0
  s_mov_b32 s54, 0
  s_mov_b32 s46, 0x3e0293ee
  s_mov_b32 s47, 0xbe0293ee
  s_mov_b32 s52, 0xcccccccc
  s_mov_b32 s53, 0xcccccccc
  s_lshl_b32 s48, s32, 13
  s_add_u32 s48, s48, 35651584
  s_add_u32 s93, s48, 17039360
  s_lshl_b32 s49, s32, 11
  s_add_u32 s49, s49, 10485760
  s_mov_b32 s60, 0
  s_mov_b32 s88, 278528
  s_mov_b32 s89, 212992
  s_mov_b32 s90, 229376
  s_mov_b32 s91, 245760
  s_mov_b32 s92, 262144
  s_mov_b32 s80, 0
  s_mov_b32 s81, 0
  s_mov_b32 s82, 0
  s_mov_b32 s83, 0
  s_mov_b32 s84, 0
  s_mov_b32 s85, 0
  s_mov_b32 s86, 0
  s_mov_b32 s87, 0
  v_lshrrev_b32 v12, 4, v0
  v_lshrrev_b32 v13, 4, v12
  v_and_b32 v14, 15, v12
  v_and_b32 v15, 1, v13
  v_lshlrev_b32 v15, 1, v15
  v_xor_b32 v14, v14, v15
  s_lshl_b32 s34, s32, 8
  s_add_u32 s34, s34, 262144
  v_lshlrev_b32 v15, 13, v13
  v_lshl_add_u32 v15, v14, 4, v15
  v_add_u32 v56, s34, v15
  v_xor_b32 v57, 64, v56
  v_xor_b32 v58, 128, v56
  v_xor_b32 v59, 192, v56
  v_and_b32 v14, 3, v12
  v_lshrrev_b32 v15, 5, v12
  v_bfe_u32 v16, v12, 4, 1
  v_bfe_u32 v17, v12, 2, 1
  v_bfe_u32 v18, v12, 3, 1
  v_lshl_add_u32 v19, v16, 2, v17
  v_lshl_add_u32 v20, v15, 4, v19
  v_lshl_add_u32 v20, v18, 3, v20
  v_lshl_add_u32 v21, v16, 1, v17
  v_lshl_add_u32 v21, v18, 2, v21
  v_lshlrev_b32 v21, 1, v21
  v_lshrrev_b32 v22, 1, v14
  v_add_u32 v22, 8, v22
  v_xor_b32 v22, v22, v21
  v_lshlrev_b32 v22, 4, v22
  v_lshl_add_u32 v22, v20, 8, v22
  v_and_b32 v23, 1, v12
  v_lshl_add_u32 v52, v23, 3, v22
  v_xor_b32 v53, 32, v52
  v_mul_u32_u24 v20, 1152, v20
  v_lshl_add_u32 v20, v14, 3, v20
  v_add_u32 v61, 832, v20
  v_lshl_add_u32 v20, v15, 3, v19
  v_mul_u32_u24 v20, 1152, v20
  v_lshl_add_u32 v20, v18, 5, v20
  v_lshl_add_u32 v60, v14, 3, v20
  s_mul_i32 s61, s32, 147456
  s_add_u32 s61, s61, 18432
  s_mov_b32 m0, 18432
  s_add_u32 s51, s61, 0
  buffer_load_dwordx4 v0, s[24:27], s51 offen offset:0 lds
  buffer_load_dwordx4 v0, s[24:27], s51 offen offset:1024 lds
  buffer_load_dwordx4 v0, s[24:27], s51 offen offset:2048 lds
  buffer_load_dwordx4 v0, s[24:27], s51 offen offset:3072 lds
  s_mov_b32 m0, 22528
  s_add_u32 s51, s61, 4096
  buffer_load_dwordx4 v0, s[24:27], s51 offen offset:0 lds
  buffer_load_dwordx4 v0, s[24:27], s51 offen offset:1024 lds
  buffer_load_dwordx4 v0, s[24:27], s51 offen offset:2048 lds
  buffer_load_dwordx4 v0, s[24:27], s51 offen offset:3072 lds
  s_mov_b32 m0, 26624
  s_add_u32 s51, s61, 8192
  buffer_load_dwordx4 v0, s[24:27], s51 offen offset:0 lds
  s_mov_b32 m0, 55296
  s_add_u32 s51, s61, 36864
  buffer_load_dwordx4 v0, s[24:27], s51 offen offset:0 lds
  buffer_load_dwordx4 v0, s[24:27], s51 offen offset:1024 lds
  buffer_load_dwordx4 v0, s[24:27], s51 offen offset:2048 lds
  buffer_load_dwordx4 v0, s[24:27], s51 offen offset:3072 lds
  s_mov_b32 m0, 59392
  s_add_u32 s51, s61, 40960
  buffer_load_dwordx4 v0, s[24:27], s51 offen offset:0 lds
  buffer_load_dwordx4 v0, s[24:27], s51 offen offset:1024 lds
  buffer_load_dwordx4 v0, s[24:27], s51 offen offset:2048 lds
  buffer_load_dwordx4 v0, s[24:27], s51 offen offset:3072 lds
  s_mov_b32 m0, 63488
  s_add_u32 s51, s61, 45056
  buffer_load_dwordx4 v0, s[24:27], s51 offen offset:0 lds
  s_mov_b32 m0, 92160
  s_add_u32 s51, s61, 73728
  buffer_load_dwordx4 v0, s[24:27], s51 offen offset:0 lds
  buffer_load_dwordx4 v0, s[24:27], s51 offen offset:1024 lds
  buffer_load_dwordx4 v0, s[24:27], s51 offen offset:2048 lds
  buffer_load_dwordx4 v0, s[24:27], s51 offen offset:3072 lds
  s_mov_b32 m0, 96256
  s_add_u32 s51, s61, 77824
  buffer_load_dwordx4 v0, s[24:27], s51 offen offset:0 lds
  buffer_load_dwordx4 v0, s[24:27], s51 offen offset:1024 lds
  buffer_load_dwordx4 v0, s[24:27], s51 offen offset:2048 lds
  buffer_load_dwordx4 v0, s[24:27], s51 offen offset:3072 lds
  s_mov_b32 m0, 100352
  s_add_u32 s51, s61, 81920
  buffer_load_dwordx4 v0, s[24:27], s51 offen offset:0 lds
  s_mov_b32 m0, 129024
  s_add_u32 s51, s61, 110592
  buffer_load_dwordx4 v0, s[24:27], s51 offen offset:0 lds
  buffer_load_dwordx4 v0, s[24:27], s51 offen offset:1024 lds
  buffer_load_dwordx4 v0, s[24:27], s51 offen offset:2048 lds
  buffer_load_dwordx4 v0, s[24:27], s51 offen offset:3072 lds
  s_mov_b32 m0, 133120
  s_add_u32 s51, s61, 114688
  buffer_load_dwordx4 v0, s[24:27], s51 offen offset:0 lds
  buffer_load_dwordx4 v0, s[24:27], s51 offen offset:1024 lds
  buffer_load_dwordx4 v0, s[24:27], s51 offen offset:2048 lds
  buffer_load_dwordx4 v0, s[24:27], s51 offen offset:3072 lds
  s_mov_b32 m0, 137216
  s_add_u32 s51, s61, 118784
  buffer_load_dwordx4 v0, s[24:27], s51 offen offset:0 lds
  s_mov_b32 m0, 155648
  s_mov_b32 s51, 0
  buffer_load_dwordx4 v56, s[20:23], s51 offen lds
  s_mov_b32 m0, 156672
  s_mov_b32 s51, 32768
  buffer_load_dwordx4 v57, s[20:23], s51 offen lds
  s_mov_b32 m0, 157696
  s_mov_b32 s51, 65536
  buffer_load_dwordx4 v58, s[20:23], s51 offen lds
  s_mov_b32 m0, 158720
  s_mov_b32 s51, 98304
  buffer_load_dwordx4 v59, s[20:23], s51 offen lds
  s_waitcnt vmcnt(31)
  s_barrier
  v_add_u32 v54, 0, v60
  v_add_u32 v55, 0, v61
  ds_read_b64_tr_b16 a[160:161], v54 offset:576
  ds_read_b64_tr_b16 a[162:163], v54 offset:2880
  ds_read_b64_tr_b16 a[164:165], v54 offset:19008
  ds_read_b64_tr_b16 a[166:167], v54 offset:21312
  ds_read_b64_tr_b16 v[20:21], v54 offset:640
  ds_read_b64_tr_b16 v[22:23], v54 offset:2944
  ds_read_b64_tr_b16 v[24:25], v54 offset:19072
  ds_read_b64_tr_b16 v[26:27], v54 offset:21376
  ds_read_b64_tr_b16 v[28:29], v54 offset:704
  ds_read_b64_tr_b16 v[30:31], v54 offset:3008
  ds_read_b64_tr_b16 v[32:33], v54 offset:19136
  ds_read_b64_tr_b16 v[34:35], v54 offset:21440
  ds_read_b64_tr_b16 v[36:37], v54 offset:768
  ds_read_b64_tr_b16 v[38:39], v54 offset:3072
  ds_read_b64_tr_b16 v[40:41], v54 offset:19200
  ds_read_b64_tr_b16 v[42:43], v54 offset:21504
  ds_read_b64_tr_b16 a[144:145], v55 offset:0
  ds_read_b64_tr_b16 a[146:147], v55 offset:2304
  s_waitcnt lgkmcnt(0)
  s_waitcnt vmcnt(22)
  s_barrier
  s_mov_b32 m0, 8192
  s_mov_b32 s51, 0
  buffer_load_dwordx4 v56, s[12:15], s51 offen lds
  s_mov_b32 m0, 9216
  s_mov_b32 s51, 32768
  buffer_load_dwordx4 v57, s[12:15], s51 offen lds
  s_mov_b32 m0, 10240
  s_mov_b32 s51, 65536
  buffer_load_dwordx4 v58, s[12:15], s51 offen lds
  s_mov_b32 m0, 11264
  s_mov_b32 s51, 98304
  buffer_load_dwordx4 v59, s[12:15], s51 offen lds
  s_mov_b32 m0, 24576
  s_mov_b32 s51, 524288
  buffer_load_dwordx4 v56, s[20:23], s51 offen lds
  s_mov_b32 m0, 25600
  s_mov_b32 s51, 557056
  buffer_load_dwordx4 v57, s[20:23], s51 offen lds
  s_mov_b32 m0, 26624
  s_mov_b32 s51, 589824
  buffer_load_dwordx4 v58, s[20:23], s51 offen lds
  s_mov_b32 m0, 27648
  s_mov_b32 s51, 622592
  buffer_load_dwordx4 v59, s[20:23], s51 offen lds
  v_add_u32 v54, 36864, v60
  v_add_u32 v55, 36864, v61
  ds_read_b64_tr_b16 v[12:13], v54 offset:576
  ds_read_b64_tr_b16 v[14:15], v54 offset:2880
  ds_read_b64_tr_b16 v[16:17], v54 offset:19008
  ds_read_b64_tr_b16 v[18:19], v54 offset:21312
  ds_read_b64_tr_b16 a[184:185], v54 offset:640
  ds_read_b64_tr_b16 a[186:187], v54 offset:2944
  ds_read_b64_tr_b16 a[188:189], v54 offset:19072
  ds_read_b64_tr_b16 a[190:191], v54 offset:21376
  ds_read_b64_tr_b16 a[208:209], v54 offset:704
  ds_read_b64_tr_b16 a[210:211], v54 offset:3008
  ds_read_b64_tr_b16 a[212:213], v54 offset:19136
  ds_read_b64_tr_b16 a[214:215], v54 offset:21440
  ds_read_b64_tr_b16 a[232:233], v54 offset:768
  ds_read_b64_tr_b16 a[234:235], v54 offset:3072
  ds_read_b64_tr_b16 a[236:237], v54 offset:19200
  ds_read_b64_tr_b16 a[238:239], v54 offset:21504
  ds_read_b64_tr_b16 a[148:149], v55 offset:0
  ds_read_b64_tr_b16 a[150:151], v55 offset:2304
  s_waitcnt lgkmcnt(0)
  s_waitcnt vmcnt(21)
  s_barrier
  s_mov_b32 m0, 40960
  s_mov_b32 s51, 0
  buffer_load_dwordx4 v56, s[16:19], s51 offen lds
  s_mov_b32 m0, 41984
  s_mov_b32 s51, 32768
  buffer_load_dwordx4 v57, s[16:19], s51 offen lds
  s_mov_b32 m0, 43008
  s_mov_b32 s51, 65536
  buffer_load_dwordx4 v58, s[16:19], s51 offen lds
  s_mov_b32 m0, 44032
  s_mov_b32 s51, 98304
  buffer_load_dwordx4 v59, s[16:19], s51 offen lds
  s_mov_b32 m0, 57344
  s_mov_b32 s51, 1048576
  buffer_load_dwordx4 v56, s[16:19], s51 offen lds
  s_mov_b32 m0, 58368
  s_mov_b32 s51, 1081344
  buffer_load_dwordx4 v57, s[16:19], s51 offen lds
  s_mov_b32 m0, 59392
  s_mov_b32 s51, 1114112
  buffer_load_dwordx4 v58, s[16:19], s51 offen lds
  s_mov_b32 m0, 60416
  s_mov_b32 s51, 1146880
  buffer_load_dwordx4 v59, s[16:19], s51 offen lds
  v_add_u32 v54, 73728, v60
  v_add_u32 v55, 73728, v61
  ds_read_b64_tr_b16 a[168:169], v54 offset:576
  ds_read_b64_tr_b16 a[170:171], v54 offset:2880
  ds_read_b64_tr_b16 a[172:173], v54 offset:19008
  ds_read_b64_tr_b16 a[174:175], v54 offset:21312
  ds_read_b64_tr_b16 a[192:193], v54 offset:640
  ds_read_b64_tr_b16 a[194:195], v54 offset:2944
  ds_read_b64_tr_b16 a[196:197], v54 offset:19072
  ds_read_b64_tr_b16 a[198:199], v54 offset:21376
  ds_read_b64_tr_b16 a[216:217], v54 offset:704
  ds_read_b64_tr_b16 a[218:219], v54 offset:3008
  ds_read_b64_tr_b16 a[220:221], v54 offset:19136
  ds_read_b64_tr_b16 a[222:223], v54 offset:21440
  ds_read_b64_tr_b16 a[240:241], v54 offset:768
  ds_read_b64_tr_b16 a[242:243], v54 offset:3072
  ds_read_b64_tr_b16 a[244:245], v54 offset:19200
  ds_read_b64_tr_b16 a[246:247], v54 offset:21504
  ds_read_b64_tr_b16 a[152:153], v55 offset:0
  ds_read_b64_tr_b16 a[154:155], v55 offset:2304
  s_waitcnt lgkmcnt(0)
  s_waitcnt vmcnt(20)
  s_barrier
  s_mov_b32 m0, 73728
  s_mov_b32 s51, 524288
  buffer_load_dwordx4 v56, s[12:15], s51 offen lds
  s_mov_b32 m0, 74752
  s_mov_b32 s51, 557056
  buffer_load_dwordx4 v57, s[12:15], s51 offen lds
  s_mov_b32 m0, 75776
  s_mov_b32 s51, 589824
  buffer_load_dwordx4 v58, s[12:15], s51 offen lds
  s_mov_b32 m0, 76800
  s_mov_b32 s51, 622592
  buffer_load_dwordx4 v59, s[12:15], s51 offen lds
  s_mov_b32 m0, 90112
  s_mov_b32 s51, 524288
  buffer_load_dwordx4 v56, s[16:19], s51 offen lds
  s_mov_b32 m0, 91136
  s_mov_b32 s51, 557056
  buffer_load_dwordx4 v57, s[16:19], s51 offen lds
  s_mov_b32 m0, 92160
  s_mov_b32 s51, 589824
  buffer_load_dwordx4 v58, s[16:19], s51 offen lds
  s_mov_b32 m0, 93184
  s_mov_b32 s51, 622592
  buffer_load_dwordx4 v59, s[16:19], s51 offen lds
  v_add_u32 v54, 110592, v60
  v_add_u32 v55, 110592, v61
  ds_read_b64_tr_b16 a[176:177], v54 offset:576
  ds_read_b64_tr_b16 a[178:179], v54 offset:2880
  ds_read_b64_tr_b16 a[180:181], v54 offset:19008
  ds_read_b64_tr_b16 a[182:183], v54 offset:21312
  ds_read_b64_tr_b16 a[200:201], v54 offset:640
  ds_read_b64_tr_b16 a[202:203], v54 offset:2944
  ds_read_b64_tr_b16 a[204:205], v54 offset:19072
  ds_read_b64_tr_b16 a[206:207], v54 offset:21376
  ds_read_b64_tr_b16 a[224:225], v54 offset:704
  ds_read_b64_tr_b16 a[226:227], v54 offset:3008
  ds_read_b64_tr_b16 a[228:229], v54 offset:19136
  ds_read_b64_tr_b16 a[230:231], v54 offset:21440
  ds_read_b64_tr_b16 a[248:249], v54 offset:768
  ds_read_b64_tr_b16 a[250:251], v54 offset:3072
  ds_read_b64_tr_b16 a[252:253], v54 offset:19200
  ds_read_b64_tr_b16 a[254:255], v54 offset:21504
  ds_read_b64_tr_b16 a[156:157], v55 offset:0
  ds_read_b64_tr_b16 a[158:159], v55 offset:2304
  s_waitcnt lgkmcnt(0)
  s_waitcnt vmcnt(24)
  s_barrier
  s_mov_b32 m0, 106496
  s_mov_b32 s51, 1048576
  buffer_load_dwordx4 v56, s[20:23], s51 offen lds
  s_mov_b32 m0, 107520
  s_mov_b32 s51, 1081344
  buffer_load_dwordx4 v57, s[20:23], s51 offen lds
  s_mov_b32 m0, 108544
  s_mov_b32 s51, 1114112
  buffer_load_dwordx4 v58, s[20:23], s51 offen lds
  s_mov_b32 m0, 109568
  s_mov_b32 s51, 1146880
  buffer_load_dwordx4 v59, s[20:23], s51 offen lds
  s_mov_b32 m0, 122880
  s_mov_b32 s51, 1048576
  buffer_load_dwordx4 v56, s[12:15], s51 offen lds
  s_mov_b32 m0, 123904
  s_mov_b32 s51, 1081344
  buffer_load_dwordx4 v57, s[12:15], s51 offen lds
  s_mov_b32 m0, 124928
  s_mov_b32 s51, 1114112
  buffer_load_dwordx4 v58, s[12:15], s51 offen lds
  s_mov_b32 m0, 125952
  s_mov_b32 s51, 1146880
  buffer_load_dwordx4 v59, s[12:15], s51 offen lds
  s_mov_b32 m0, 139264
  s_mov_b32 s51, 1572864
  buffer_load_dwordx4 v56, s[20:23], s51 offen lds
  s_mov_b32 m0, 140288
  s_mov_b32 s51, 1605632
  buffer_load_dwordx4 v57, s[20:23], s51 offen lds
  s_mov_b32 m0, 141312
  s_mov_b32 s51, 1638400
  buffer_load_dwordx4 v58, s[20:23], s51 offen lds
  s_mov_b32 m0, 142336
  s_mov_b32 s51, 1671168
  buffer_load_dwordx4 v59, s[20:23], s51 offen lds
  v_add_u32 v54, 147456, v52
  v_add_u32 v55, 147456, v53
  ds_read_b64_tr_b16 v[64:65], v54 offset:0
  ds_read_b64_tr_b16 v[66:67], v54 offset:512
  ds_read_b64_tr_b16 v[68:69], v54 offset:8192
  ds_read_b64_tr_b16 v[70:71], v54 offset:8704
  ds_read_b64_tr_b16 v[72:73], v55 offset:0
  ds_read_b64_tr_b16 v[74:75], v55 offset:512
  ds_read_b64_tr_b16 v[76:77], v55 offset:8192
  ds_read_b64_tr_b16 v[78:79], v55 offset:8704
  s_waitcnt lgkmcnt(0)
  s_waitcnt vmcnt(32)
  s_barrier
  s_mov_b32 m0, 155648
  s_mov_b32 s51, 1572864
  buffer_load_dwordx4 v56, s[12:15], s51 offen lds
  s_mov_b32 m0, 156672
  s_mov_b32 s51, 1605632
  buffer_load_dwordx4 v57, s[12:15], s51 offen lds
  s_mov_b32 m0, 157696
  s_mov_b32 s51, 1638400
  buffer_load_dwordx4 v58, s[12:15], s51 offen lds
  s_mov_b32 m0, 158720
  s_mov_b32 s51, 1671168
  buffer_load_dwordx4 v59, s[12:15], s51 offen lds
  v_add_u32 v54, 0, v52
  v_add_u32 v55, 0, v53
  ds_read_b64_tr_b16 v[208:209], v54 offset:0
  ds_read_b64_tr_b16 v[210:211], v54 offset:512
  ds_read_b64_tr_b16 v[212:213], v54 offset:8192
  ds_read_b64_tr_b16 v[214:215], v54 offset:8704
  ds_read_b64_tr_b16 v[216:217], v55 offset:0
  ds_read_b64_tr_b16 v[218:219], v55 offset:512
  ds_read_b64_tr_b16 v[220:221], v55 offset:8192
  ds_read_b64_tr_b16 v[222:223], v55 offset:8704
  s_waitcnt lgkmcnt(0)
  s_waitcnt vmcnt(32)
  s_barrier
  s_mov_b32 m0, 8192
  s_mov_b32 s51, 2097152
  buffer_load_dwordx4 v56, s[20:23], s51 offen lds
  s_mov_b32 m0, 9216
  s_mov_b32 s51, 2129920
  buffer_load_dwordx4 v57, s[20:23], s51 offen lds
  s_mov_b32 m0, 10240
  s_mov_b32 s51, 2162688
  buffer_load_dwordx4 v58, s[20:23], s51 offen lds
  s_mov_b32 m0, 11264
  s_mov_b32 s51, 2195456
  buffer_load_dwordx4 v59, s[20:23], s51 offen lds
  v_add_u32 v54, 16384, v52
  v_add_u32 v55, 16384, v53
  ds_read_b64_tr_b16 v[80:81], v54 offset:0
  ds_read_b64_tr_b16 v[82:83], v54 offset:512
  ds_read_b64_tr_b16 v[84:85], v54 offset:8192
  ds_read_b64_tr_b16 v[86:87], v54 offset:8704
  ds_read_b64_tr_b16 v[88:89], v55 offset:0
  ds_read_b64_tr_b16 v[90:91], v55 offset:512
  ds_read_b64_tr_b16 v[92:93], v55 offset:8192
  ds_read_b64_tr_b16 v[94:95], v55 offset:8704
  s_waitcnt lgkmcnt(0)
  s_waitcnt vmcnt(32)
  s_barrier
  s_mov_b32 m0, 24576
  s_mov_b32 s51, 2097152
  buffer_load_dwordx4 v56, s[12:15], s51 offen lds
  s_mov_b32 m0, 25600
  s_mov_b32 s51, 2129920
  buffer_load_dwordx4 v57, s[12:15], s51 offen lds
  s_mov_b32 m0, 26624
  s_mov_b32 s51, 2162688
  buffer_load_dwordx4 v58, s[12:15], s51 offen lds
  s_mov_b32 m0, 27648
  s_mov_b32 s51, 2195456
  buffer_load_dwordx4 v59, s[12:15], s51 offen lds
  v_add_u32 v54, 32768, v52
  v_add_u32 v55, 32768, v53
  ds_read_b64_tr_b16 v[192:193], v54 offset:0
  ds_read_b64_tr_b16 v[194:195], v54 offset:512
  ds_read_b64_tr_b16 v[196:197], v54 offset:8192
  ds_read_b64_tr_b16 v[198:199], v54 offset:8704
  ds_read_b64_tr_b16 v[200:201], v55 offset:0
  ds_read_b64_tr_b16 v[202:203], v55 offset:512
  ds_read_b64_tr_b16 v[204:205], v55 offset:8192
  ds_read_b64_tr_b16 v[206:207], v55 offset:8704
  s_waitcnt lgkmcnt(0)
  s_barrier
  ds_write_b128 v2, v[192:195] offset:0
  ds_write_b128 v2, v[196:199] offset:1024
  ds_write_b128 v2, v[200:203] offset:2048
  ds_write_b128 v2, v[204:207] offset:3072
  s_waitcnt vmcnt(32)
  s_barrier
  v_add_u32 v54, 49152, v52
  v_add_u32 v55, 49152, v53
  ds_read_b64_tr_b16 v[192:193], v54 offset:0
  ds_read_b64_tr_b16 v[194:195], v54 offset:512
  ds_read_b64_tr_b16 v[196:197], v54 offset:8192
  ds_read_b64_tr_b16 v[198:199], v54 offset:8704
  ds_read_b64_tr_b16 v[200:201], v55 offset:0
  ds_read_b64_tr_b16 v[202:203], v55 offset:512
  ds_read_b64_tr_b16 v[204:205], v55 offset:8192
  ds_read_b64_tr_b16 v[206:207], v55 offset:8704
  s_waitcnt lgkmcnt(0)
  s_barrier
  ds_write_b128 v2, v[192:195] offset:16384
  ds_write_b128 v2, v[196:199] offset:17408
  ds_write_b128 v2, v[200:203] offset:18432
  ds_write_b128 v2, v[204:207] offset:19456
  s_waitcnt vmcnt(28)
  s_barrier
  v_add_u32 v54, 65536, v52
  v_add_u32 v55, 65536, v53
  ds_read_b64_tr_b16 v[224:225], v54 offset:0
  ds_read_b64_tr_b16 v[226:227], v54 offset:512
  ds_read_b64_tr_b16 v[228:229], v54 offset:8192
  ds_read_b64_tr_b16 v[230:231], v54 offset:8704
  ds_read_b64_tr_b16 v[232:233], v55 offset:0
  ds_read_b64_tr_b16 v[234:235], v55 offset:512
  ds_read_b64_tr_b16 v[236:237], v55 offset:8192
  ds_read_b64_tr_b16 v[238:239], v55 offset:8704
  s_waitcnt lgkmcnt(0)
  s_waitcnt vmcnt(24)
  s_barrier
  s_mov_b32 m0, 73728
  s_mov_b32 s51, 1572864
  buffer_load_dwordx4 v56, s[16:19], s51 offen lds
  s_mov_b32 m0, 74752
  s_mov_b32 s51, 1605632
  buffer_load_dwordx4 v57, s[16:19], s51 offen lds
  s_mov_b32 m0, 75776
  s_mov_b32 s51, 1638400
  buffer_load_dwordx4 v58, s[16:19], s51 offen lds
  s_mov_b32 m0, 76800
  s_mov_b32 s51, 1671168
  buffer_load_dwordx4 v59, s[16:19], s51 offen lds
  buffer_load_dwordx2 v[44:45], off, s[8:11], 0 offset:4 sc1
  v_add_u32 v54, 81920, v52
  v_add_u32 v55, 81920, v53
  ds_read_b64_tr_b16 a[96:97], v54 offset:0
  ds_read_b64_tr_b16 a[98:99], v54 offset:512
  ds_read_b64_tr_b16 a[100:101], v54 offset:8192
  ds_read_b64_tr_b16 a[102:103], v54 offset:8704
  ds_read_b64_tr_b16 a[104:105], v55 offset:0
  ds_read_b64_tr_b16 a[106:107], v55 offset:512
  ds_read_b64_tr_b16 a[108:109], v55 offset:8192
  ds_read_b64_tr_b16 a[110:111], v55 offset:8704
  s_waitcnt lgkmcnt(0)
  s_waitcnt vmcnt(25)
  s_barrier
  s_mov_b32 m0, 90112
  s_mov_b32 s51, 2621440
  buffer_load_dwordx4 v56, s[16:19], s51 offen lds
  s_mov_b32 m0, 91136
  s_mov_b32 s51, 2654208
  buffer_load_dwordx4 v57, s[16:19], s51 offen lds
  s_mov_b32 m0, 92160
  s_mov_b32 s51, 2686976
  buffer_load_dwordx4 v58, s[16:19], s51 offen lds
  s_mov_b32 m0, 93184
  s_mov_b32 s51, 2719744
  buffer_load_dwordx4 v59, s[16:19], s51 offen lds
  v_add_u32 v54, 98304, v52
  v_add_u32 v55, 98304, v53
  ds_read_b64_tr_b16 v[96:97], v54 offset:0
  ds_read_b64_tr_b16 v[98:99], v54 offset:512
  ds_read_b64_tr_b16 v[100:101], v54 offset:8192
  ds_read_b64_tr_b16 v[102:103], v54 offset:8704
  ds_read_b64_tr_b16 v[104:105], v55 offset:0
  ds_read_b64_tr_b16 v[106:107], v55 offset:512
  ds_read_b64_tr_b16 v[108:109], v55 offset:8192
  ds_read_b64_tr_b16 v[110:111], v55 offset:8704
  s_waitcnt lgkmcnt(0)
  s_waitcnt vmcnt(25)
  s_barrier
  s_mov_b32 m0, 106496
  s_mov_b32 s51, 3145728
  buffer_load_dwordx4 v56, s[16:19], s51 offen lds
  s_mov_b32 m0, 107520
  s_mov_b32 s51, 3178496
  buffer_load_dwordx4 v57, s[16:19], s51 offen lds
  s_mov_b32 m0, 108544
  s_mov_b32 s51, 3211264
  buffer_load_dwordx4 v58, s[16:19], s51 offen lds
  s_mov_b32 m0, 109568
  s_mov_b32 s51, 3244032
  buffer_load_dwordx4 v59, s[16:19], s51 offen lds
  v_add_u32 v54, 114688, v52
  v_add_u32 v55, 114688, v53
  ds_read_b64_tr_b16 v[240:241], v54 offset:0
  ds_read_b64_tr_b16 v[242:243], v54 offset:512
  ds_read_b64_tr_b16 v[244:245], v54 offset:8192
  ds_read_b64_tr_b16 v[246:247], v54 offset:8704
  ds_read_b64_tr_b16 v[248:249], v55 offset:0
  ds_read_b64_tr_b16 v[250:251], v55 offset:512
  ds_read_b64_tr_b16 v[252:253], v55 offset:8192
  ds_read_b64_tr_b16 v[254:255], v55 offset:8704
  s_waitcnt lgkmcnt(0)
  s_waitcnt vmcnt(25)
  s_barrier
  s_mov_b32 m0, 122880
  s_mov_b32 s51, 4194304
  buffer_load_dwordx4 v56, s[16:19], s51 offen lds
  s_mov_b32 m0, 123904
  s_mov_b32 s51, 4227072
  buffer_load_dwordx4 v57, s[16:19], s51 offen lds
  s_mov_b32 m0, 124928
  s_mov_b32 s51, 4259840
  buffer_load_dwordx4 v58, s[16:19], s51 offen lds
  s_mov_b32 m0, 125952
  s_mov_b32 s51, 4292608
  buffer_load_dwordx4 v59, s[16:19], s51 offen lds
  v_add_u32 v54, 131072, v52
  v_add_u32 v55, 131072, v53
  ds_read_b64_tr_b16 v[112:113], v54 offset:0
  ds_read_b64_tr_b16 v[114:115], v54 offset:512
  ds_read_b64_tr_b16 v[116:117], v54 offset:8192
  ds_read_b64_tr_b16 v[118:119], v54 offset:8704
  ds_read_b64_tr_b16 v[120:121], v55 offset:0
  ds_read_b64_tr_b16 v[122:123], v55 offset:512
  ds_read_b64_tr_b16 v[124:125], v55 offset:8192
  ds_read_b64_tr_b16 v[126:127], v55 offset:8704
  s_waitcnt lgkmcnt(0)
  s_waitcnt vmcnt(25)
  s_barrier
  s_mov_b32 m0, 139264
  s_mov_b32 s51, 2097152
  buffer_load_dwordx4 v56, s[16:19], s51 offen lds
  s_mov_b32 m0, 140288
  s_mov_b32 s51, 2129920
  buffer_load_dwordx4 v57, s[16:19], s51 offen lds
  s_mov_b32 m0, 141312
  s_mov_b32 s51, 2162688
  buffer_load_dwordx4 v58, s[16:19], s51 offen lds
  s_mov_b32 m0, 142336
  s_mov_b32 s51, 2195456
  buffer_load_dwordx4 v59, s[16:19], s51 offen lds
  v_add_u32 v54, 147456, v52
  v_add_u32 v55, 147456, v53
  ds_read_b64_tr_b16 a[0:1], v54 offset:0
  ds_read_b64_tr_b16 a[2:3], v54 offset:512
  ds_read_b64_tr_b16 a[4:5], v54 offset:8192
  ds_read_b64_tr_b16 a[6:7], v54 offset:8704
  ds_read_b64_tr_b16 a[8:9], v55 offset:0
  ds_read_b64_tr_b16 a[10:11], v55 offset:512
  ds_read_b64_tr_b16 a[12:13], v55 offset:8192
  ds_read_b64_tr_b16 a[14:15], v55 offset:8704
  s_waitcnt lgkmcnt(0)
  s_waitcnt vmcnt(25)
  s_barrier
  s_mov_b32 m0, 155648
  s_mov_b32 s51, 2621440
  buffer_load_dwordx4 v56, s[20:23], s51 offen lds
  s_mov_b32 m0, 156672
  s_mov_b32 s51, 2654208
  buffer_load_dwordx4 v57, s[20:23], s51 offen lds
  s_mov_b32 m0, 157696
  s_mov_b32 s51, 2686976
  buffer_load_dwordx4 v58, s[20:23], s51 offen lds
  s_mov_b32 m0, 158720
  s_mov_b32 s51, 2719744
  buffer_load_dwordx4 v59, s[20:23], s51 offen lds
  v_add_u32 v54, 0, v52
  v_add_u32 v55, 0, v53
  ds_read_b64_tr_b16 v[128:129], v54 offset:0
  ds_read_b64_tr_b16 v[130:131], v54 offset:512
  ds_read_b64_tr_b16 v[132:133], v54 offset:8192
  ds_read_b64_tr_b16 v[134:135], v54 offset:8704
  ds_read_b64_tr_b16 v[136:137], v55 offset:0
  ds_read_b64_tr_b16 v[138:139], v55 offset:512
  ds_read_b64_tr_b16 v[140:141], v55 offset:8192
  ds_read_b64_tr_b16 v[142:143], v55 offset:8704
  s_waitcnt lgkmcnt(0)
  s_waitcnt vmcnt(25)
  s_barrier
  s_mov_b32 m0, 8192
  s_mov_b32 s51, 2621440
  buffer_load_dwordx4 v56, s[12:15], s51 offen lds
  s_mov_b32 m0, 9216
  s_mov_b32 s51, 2654208
  buffer_load_dwordx4 v57, s[12:15], s51 offen lds
  s_mov_b32 m0, 10240
  s_mov_b32 s51, 2686976
  buffer_load_dwordx4 v58, s[12:15], s51 offen lds
  s_mov_b32 m0, 11264
  s_mov_b32 s51, 2719744
  buffer_load_dwordx4 v59, s[12:15], s51 offen lds
  v_add_u32 v54, 16384, v52
  v_add_u32 v55, 16384, v53
  ds_read_b64_tr_b16 a[16:17], v54 offset:0
  ds_read_b64_tr_b16 a[18:19], v54 offset:512
  ds_read_b64_tr_b16 a[20:21], v54 offset:8192
  ds_read_b64_tr_b16 a[22:23], v54 offset:8704
  ds_read_b64_tr_b16 a[24:25], v55 offset:0
  ds_read_b64_tr_b16 a[26:27], v55 offset:512
  ds_read_b64_tr_b16 a[28:29], v55 offset:8192
  ds_read_b64_tr_b16 a[30:31], v55 offset:8704
  s_waitcnt lgkmcnt(0)
  s_waitcnt vmcnt(25)
  s_barrier
  s_mov_b32 m0, 24576
  s_mov_b32 s51, 3145728
  buffer_load_dwordx4 v56, s[20:23], s51 offen lds
  s_mov_b32 m0, 25600
  s_mov_b32 s51, 3178496
  buffer_load_dwordx4 v57, s[20:23], s51 offen lds
  s_mov_b32 m0, 26624
  s_mov_b32 s51, 3211264
  buffer_load_dwordx4 v58, s[20:23], s51 offen lds
  s_mov_b32 m0, 27648
  s_mov_b32 s51, 3244032
  buffer_load_dwordx4 v59, s[20:23], s51 offen lds
  v_add_u32 v54, 65536, v52
  v_add_u32 v55, 65536, v53
  ds_read_b64_tr_b16 v[192:193], v54 offset:0
  ds_read_b64_tr_b16 v[194:195], v54 offset:512
  ds_read_b64_tr_b16 v[196:197], v54 offset:8192
  ds_read_b64_tr_b16 v[198:199], v54 offset:8704
  ds_read_b64_tr_b16 v[200:201], v55 offset:0
  ds_read_b64_tr_b16 v[202:203], v55 offset:512
  ds_read_b64_tr_b16 v[204:205], v55 offset:8192
  ds_read_b64_tr_b16 v[206:207], v55 offset:8704
  s_waitcnt lgkmcnt(0)
  s_barrier
  ds_write_b128 v2, v[192:195] offset:32768
  ds_write_b128 v2, v[196:199] offset:33792
  ds_write_b128 v2, v[200:203] offset:34816
  ds_write_b128 v2, v[204:207] offset:35840
  s_waitcnt vmcnt(24)
  s_barrier
  v_add_u32 v54, 81920, v52
  v_add_u32 v55, 81920, v53
  ds_read_b64_tr_b16 v[192:193], v54 offset:0
  ds_read_b64_tr_b16 v[194:195], v54 offset:512
  ds_read_b64_tr_b16 v[196:197], v54 offset:8192
  ds_read_b64_tr_b16 v[198:199], v54 offset:8704
  ds_read_b64_tr_b16 v[200:201], v55 offset:0
  ds_read_b64_tr_b16 v[202:203], v55 offset:512
  ds_read_b64_tr_b16 v[204:205], v55 offset:8192
  ds_read_b64_tr_b16 v[206:207], v55 offset:8704
  s_waitcnt lgkmcnt(0)
  s_barrier
  ds_write_b128 v2, v[192:195] offset:49152
  ds_write_b128 v2, v[196:199] offset:50176
  ds_write_b128 v2, v[200:203] offset:51200
  ds_write_b128 v2, v[204:207] offset:52224
  s_waitcnt vmcnt(20)
  s_barrier
  v_add_u32 v54, 98304, v52
  v_add_u32 v55, 98304, v53
  ds_read_b64_tr_b16 v[192:193], v54 offset:0
  ds_read_b64_tr_b16 v[194:195], v54 offset:512
  ds_read_b64_tr_b16 v[196:197], v54 offset:8192
  ds_read_b64_tr_b16 v[198:199], v54 offset:8704
  ds_read_b64_tr_b16 v[200:201], v55 offset:0
  ds_read_b64_tr_b16 v[202:203], v55 offset:512
  ds_read_b64_tr_b16 v[204:205], v55 offset:8192
  ds_read_b64_tr_b16 v[206:207], v55 offset:8704
  s_waitcnt lgkmcnt(0)
  s_barrier
  ds_write_b128 v3, v[192:195] offset:0
  ds_write_b128 v3, v[196:199] offset:1024
  ds_write_b128 v3, v[200:203] offset:2048
  ds_write_b128 v3, v[204:207] offset:3072
  s_waitcnt vmcnt(16)
  s_barrier
  v_add_u32 v54, 114688, v52
  v_add_u32 v55, 114688, v53
  ds_read_b64_tr_b16 v[192:193], v54 offset:0
  ds_read_b64_tr_b16 v[194:195], v54 offset:512
  ds_read_b64_tr_b16 v[196:197], v54 offset:8192
  ds_read_b64_tr_b16 v[198:199], v54 offset:8704
  ds_read_b64_tr_b16 v[200:201], v55 offset:0
  ds_read_b64_tr_b16 v[202:203], v55 offset:512
  ds_read_b64_tr_b16 v[204:205], v55 offset:8192
  ds_read_b64_tr_b16 v[206:207], v55 offset:8704
  s_waitcnt lgkmcnt(0)
  s_barrier
  ds_write_b128 v3, v[192:195] offset:16384
  ds_write_b128 v3, v[196:199] offset:17408
  ds_write_b128 v3, v[200:203] offset:18432
  ds_write_b128 v3, v[204:207] offset:19456
  s_waitcnt vmcnt(12)
L_cwait_87:
  v_readfirstlane_b32 s96, v44
  v_readfirstlane_b32 s97, v45
  s_add_u32 s50, s50, 1
  s_cmp_ge_u32 s50, 262144
  s_cbranch_scc1 L_cwait_87_x
  s_lshl_b32 s96, s96, 8
  s_add_u32 s96, s96, s97
  s_cmp_eq_u32 s96, 2592
  s_cbranch_scc1 L_cwait_87_x
  buffer_load_dwordx2 v[44:45], off, s[8:11], 0 offset:4 sc1
  s_waitcnt vmcnt(0)
  s_branch L_cwait_87
L_cwait_87_x:
  s_lshl_b32 s61, s32, 7
  s_add_u32 s94, s61, 6144
  s_add_u32 s61, s61, 0
  s_barrier
  buffer_load_dword v48, off, s[8:11], 0 offset:128 sc1
  v_add_u32 v54, 131072, v52
  v_add_u32 v55, 131072, v53
  ds_read_b64_tr_b16 a[112:113], v54 offset:0
  ds_read_b64_tr_b16 a[114:115], v54 offset:512
  ds_read_b64_tr_b16 a[116:117], v54 offset:8192
  ds_read_b64_tr_b16 a[118:119], v54 offset:8704
  ds_read_b64_tr_b16 a[120:121], v55 offset:0
  ds_read_b64_tr_b16 a[122:123], v55 offset:512
  ds_read_b64_tr_b16 a[124:125], v55 offset:8192
  ds_read_b64_tr_b16 a[126:127], v55 offset:8704
  s_waitcnt lgkmcnt(0)
  s_waitcnt vmcnt(9)
  s_barrier
  s_mov_b32 m0, 139264
  s_mov_b32 s51, 3145728
  buffer_load_dwordx4 v56, s[12:15], s51 offen lds
  s_mov_b32 m0, 140288
  s_mov_b32 s51, 3178496
  buffer_load_dwordx4 v57, s[12:15], s51 offen lds
  s_mov_b32 m0, 141312
  s_mov_b32 s51, 3211264
  buffer_load_dwordx4 v58, s[12:15], s51 offen lds
  s_mov_b32 m0, 142336
  s_mov_b32 s51, 3244032
  buffer_load_dwordx4 v59, s[12:15], s51 offen lds
  v_add_u32 v54, 147456, v52
  v_add_u32 v55, 147456, v53
  ds_read_b64_tr_b16 v[144:145], v54 offset:0
  ds_read_b64_tr_b16 v[146:147], v54 offset:512
  ds_read_b64_tr_b16 v[148:149], v54 offset:8192
  ds_read_b64_tr_b16 v[150:151], v54 offset:8704
  ds_read_b64_tr_b16 v[152:153], v55 offset:0
  ds_read_b64_tr_b16 v[154:155], v55 offset:512
  ds_read_b64_tr_b16 v[156:157], v55 offset:8192
  ds_read_b64_tr_b16 v[158:159], v55 offset:8704
  s_waitcnt lgkmcnt(0)
  s_waitcnt vmcnt(9)
  s_barrier
  s_mov_b32 m0, 155648
  s_mov_b32 s51, 3670016
  buffer_load_dwordx4 v56, s[20:23], s51 offen lds
  s_mov_b32 m0, 156672
  s_mov_b32 s51, 3702784
  buffer_load_dwordx4 v57, s[20:23], s51 offen lds
  s_mov_b32 m0, 157696
  s_mov_b32 s51, 3735552
  buffer_load_dwordx4 v58, s[20:23], s51 offen lds
  s_mov_b32 m0, 158720
  s_mov_b32 s51, 3768320
  buffer_load_dwordx4 v59, s[20:23], s51 offen lds
  s_getpc_b64 s[34:35]
L_scp_88:
  s_add_u32 s34, s34, L_loop_c2f-L_scp_88
  s_addc_u32 s35, s35, 0
  v_lshlrev_b32 v200, 2, v0
  v_min_u32 v200, L_code_end-L_loop_c2f-4, v200
  v_mov_b32 v201, s35
  v_add_co_u32 v200, vcc, s34, v200
  s_nop 1
  v_addc_co_u32 v201, vcc, 0, v201, vcc
  global_load_dword v202, v[200:201], off
  v_add_u32 v54, 0, v52
  v_add_u32 v55, 0, v53
  ds_read_b64_tr_b16 a[32:33], v54 offset:0
  ds_read_b64_tr_b16 a[34:35], v54 offset:512
  ds_read_b64_tr_b16 a[36:37], v54 offset:8192
  ds_read_b64_tr_b16 a[38:39], v54 offset:8704
  ds_read_b64_tr_b16 a[40:41], v55 offset:0
  ds_read_b64_tr_b16 a[42:43], v55 offset:512
  ds_read_b64_tr_b16 a[44:45], v55 offset:8192
  ds_read_b64_tr_b16 a[46:47], v55 offset:8704
  s_waitcnt lgkmcnt(0)
  s_waitcnt vmcnt(10)
  s_barrier
  s_mov_b32 m0, 8192
  s_mov_b32 s51, 3670016
  buffer_load_dwordx4 v56, s[12:15], s51 offen lds
  s_mov_b32 m0, 9216
  s_mov_b32 s51, 3702784
  buffer_load_dwordx4 v57, s[12:15], s51 offen lds
  s_mov_b32 m0, 10240
  s_mov_b32 s51, 3735552
  buffer_load_dwordx4 v58, s[12:15], s51 offen lds
  s_mov_b32 m0, 11264
  s_mov_b32 s51, 3768320
  buffer_load_dwordx4 v59, s[12:15], s51 offen lds
  v_add_u32 v54, 16384, v52
  v_add_u32 v55, 16384, v53
  ds_read_b64_tr_b16 v[160:161], v54 offset:0
  ds_read_b64_tr_b16 v[162:163], v54 offset:512
  ds_read_b64_tr_b16 v[164:165], v54 offset:8192
  ds_read_b64_tr_b16 v[166:167], v54 offset:8704
  ds_read_b64_tr_b16 v[168:169], v55 offset:0
  ds_read_b64_tr_b16 v[170:171], v55 offset:512
  ds_read_b64_tr_b16 v[172:173], v55 offset:8192
  ds_read_b64_tr_b16 v[174:175], v55 offset:8704
  s_waitcnt lgkmcnt(0)
  s_waitcnt vmcnt(9)
  s_barrier
  s_mov_b32 m0, 24576
  s_mov_b32 s51, 3670016
  buffer_load_dwordx4 v56, s[16:19], s51 offen lds
  s_mov_b32 m0, 25600
  s_mov_b32 s51, 3702784
  buffer_load_dwordx4 v57, s[16:19], s51 offen lds
  s_mov_b32 m0, 26624
  s_mov_b32 s51, 3735552
  buffer_load_dwordx4 v58, s[16:19], s51 offen lds
  s_mov_b32 m0, 27648
  s_mov_b32 s51, 3768320
  buffer_load_dwordx4 v59, s[16:19], s51 offen lds
  v_add_u32 v54, 131072, v52
  v_add_u32 v55, 131072, v53
  ds_read_b64_tr_b16 a[48:49], v54 offset:0
  ds_read_b64_tr_b16 a[50:51], v54 offset:512
  ds_read_b64_tr_b16 a[52:53], v54 offset:8192
  ds_read_b64_tr_b16 a[54:55], v54 offset:8704
  ds_read_b64_tr_b16 a[56:57], v55 offset:0
  ds_read_b64_tr_b16 a[58:59], v55 offset:512
  ds_read_b64_tr_b16 a[60:61], v55 offset:8192
  ds_read_b64_tr_b16 a[62:63], v55 offset:8704
  s_waitcnt lgkmcnt(0)
  s_waitcnt vmcnt(9)
  s_barrier
  s_mov_b32 m0, 139264
  s_mov_b32 s51, 4194304
  buffer_load_dwordx4 v56, s[20:23], s51 offen lds
  s_mov_b32 m0, 140288
  s_mov_b32 s51, 4227072
  buffer_load_dwordx4 v57, s[20:23], s51 offen lds
  s_mov_b32 m0, 141312
  s_mov_b32 s51, 4259840
  buffer_load_dwordx4 v58, s[20:23], s51 offen lds
  s_mov_b32 m0, 142336
  s_mov_b32 s51, 4292608
  buffer_load_dwordx4 v59, s[20:23], s51 offen lds
  v_add_u32 v54, 147456, v52
  v_add_u32 v55, 147456, v53
  ds_read_b64_tr_b16 v[176:177], v54 offset:0
  ds_read_b64_tr_b16 v[178:179], v54 offset:512
  ds_read_b64_tr_b16 v[180:181], v54 offset:8192
  ds_read_b64_tr_b16 v[182:183], v54 offset:8704
  ds_read_b64_tr_b16 v[184:185], v55 offset:0
  ds_read_b64_tr_b16 v[186:187], v55 offset:512
  ds_read_b64_tr_b16 v[188:189], v55 offset:8192
  ds_read_b64_tr_b16 v[190:191], v55 offset:8704
  s_waitcnt lgkmcnt(0)
  s_waitcnt vmcnt(8)
  s_barrier
  ds_write_b128 v3, v[28:31] offset:49152
  ds_write_b128 v3, v[32:35] offset:50176
  ds_write_b128 v3, v[36:39] offset:51200
  ds_write_b128 v3, v[40:43] offset:52224
  v_bfe_u32 v44, v0, 6, 2
  v_bfe_u32 v45, v0, 4, 1
  v_lshl_add_u32 v44, v44, 1, v45
  v_mul_u32_u24 v44, 1152, v44
  v_bfe_u32 v45, v0, 8, 2
  v_lshl_add_u32 v44, v45, 5, v44
  v_bfe_u32 v45, v0, 5, 1
  v_lshl_add_u32 v44, v45, 4, v44
  buffer_load_dwordx4 v[28:31], v44, s[28:31], 0 offen offset:512
  buffer_load_dwordx4 v[32:35], v44, s[28:31], 0 offen offset:640
  v_add_u32 v54, 0, v52
  v_add_u32 v55, 0, v53
  ds_read_b64_tr_b16 a[64:65], v54 offset:0
  ds_read_b64_tr_b16 a[66:67], v54 offset:512
  ds_read_b64_tr_b16 a[68:69], v54 offset:8192
  ds_read_b64_tr_b16 a[70:71], v54 offset:8704
  ds_read_b64_tr_b16 a[72:73], v55 offset:0
  ds_read_b64_tr_b16 a[74:75], v55 offset:512
  ds_read_b64_tr_b16 a[76:77], v55 offset:8192
  ds_read_b64_tr_b16 a[78:79], v55 offset:8704
  s_waitcnt lgkmcnt(0)
  s_waitcnt vmcnt(6)
  s_barrier
  s_mov_b32 m0, 8192
  s_mov_b32 s51, 4194304
  buffer_load_dwordx4 v56, s[12:15], s51 offen lds
  s_mov_b32 m0, 9216
  s_mov_b32 s51, 4227072
  buffer_load_dwordx4 v57, s[12:15], s51 offen lds
  s_mov_b32 m0, 10240
  s_mov_b32 s51, 4259840
  buffer_load_dwordx4 v58, s[12:15], s51 offen lds
  s_mov_b32 m0, 11264
  s_mov_b32 s51, 4292608
  buffer_load_dwordx4 v59, s[12:15], s51 offen lds
  v_add_u32 v54, 16384, v52
  v_add_u32 v55, 16384, v53
  ds_read_b64_tr_b16 a[128:129], v54 offset:0
  ds_read_b64_tr_b16 a[130:131], v54 offset:512
  ds_read_b64_tr_b16 a[132:133], v54 offset:8192
  ds_read_b64_tr_b16 a[134:135], v54 offset:8704
  ds_read_b64_tr_b16 a[136:137], v55 offset:0
  ds_read_b64_tr_b16 a[138:139], v55 offset:512
  ds_read_b64_tr_b16 a[140:141], v55 offset:8192
  ds_read_b64_tr_b16 a[142:143], v55 offset:8704
  s_waitcnt lgkmcnt(0)
  s_waitcnt vmcnt(6)
  s_barrier
  v_add_u32 v54, 131072, v52
  v_add_u32 v55, 131072, v53
  ds_read_b64_tr_b16 v[192:193], v54 offset:0
  ds_read_b64_tr_b16 v[194:195], v54 offset:512
  ds_read_b64_tr_b16 v[196:197], v54 offset:8192
  ds_read_b64_tr_b16 v[198:199], v54 offset:8704
  ds_read_b64_tr_b16 v[200:201], v55 offset:0
  ds_read_b64_tr_b16 v[202:203], v55 offset:512
  ds_read_b64_tr_b16 v[204:205], v55 offset:8192
  ds_read_b64_tr_b16 v[206:207], v55 offset:8704
  s_waitcnt lgkmcnt(0)
  s_waitcnt vmcnt(0)
  s_barrier
  ds_write_b128 v3, v[12:15] offset:32768
  ds_write_b128 v3, v[16:19] offset:33792
  ds_write_b128 v3, v[20:23] offset:34816
  ds_write_b128 v3, v[24:27] offset:35840
  v_add_u32 v54, 0, v52
  v_add_u32 v55, 0, v53
  ds_read_b64_tr_b16 a[80:81], v54 offset:0
  ds_read_b64_tr_b16 a[82:83], v54 offset:512
  ds_read_b64_tr_b16 a[84:85], v54 offset:8192
  ds_read_b64_tr_b16 a[86:87], v54 offset:8704
  ds_read_b64_tr_b16 a[88:89], v55 offset:0
  ds_read_b64_tr_b16 a[90:91], v55 offset:512
  ds_read_b64_tr_b16 a[92:93], v55 offset:8192
  ds_read_b64_tr_b16 a[94:95], v55 offset:8704
  s_waitcnt lgkmcnt(0)
  v_readfirstlane_b32 s37, v48
  ds_read_b128 v[40:43], v2 offset:49152
  ds_read_b128 v[44:47], v2 offset:50176
  ds_read_b128 v[48:51], v2 offset:51200
  ds_read_b128 v[52:55], v2 offset:52224
  ds_read_b128 v[56:59], v2 offset:0
  ds_read_b128 v[60:63], v2 offset:1024
  v_mov_b64 v[12:13], 0
  v_mov_b64 v[14:15], 0
  v_mov_b64 v[16:17], 0
  v_mov_b64 v[18:19], 0
  v_mov_b64 v[20:21], 0
  v_mov_b64 v[22:23], 0
  s_waitcnt vmcnt(0) lgkmcnt(0)
  v_mov_b64 v[24:25], 0
  v_mov_b64 v[26:27], 0
  s_mov_b32 s28, s4
  s_or_b32 s29, s5, 0x40000
  s_mov_b32 s30, 67108864
  ds_write_b128 v0, v[28:31] offset:20480
  ds_write_b128 v0, v[32:35] offset:21504
  s_cmp_lt_u32 s37, 32
  s_cbranch_scc1 L_enter_c2s
  s_branch L_enter_c2f
.p2align 6
.fill 7, 4, 0xbf800000
L_loop_c2f:
  s_barrier
  s_mov_b32 s45, s42
  v_mov_b64 v[12:13], 0
  v_mov_b64_e64 v[14:15], 0
  v_mov_b64_e64 v[16:17], 0
  v_mov_b64_e64 v[18:19], 0
  buffer_load_dwordx4 v[28:31], v11, s[4:7], s45 offen offset:0 sc1
  buffer_load_dwordx4 v[32:35], v11, s[4:7], s45 offen offset:1024 sc1
  ds_read_b128 v[40:43], v2 offset:49152
  ds_read_b128 v[44:47], v2 offset:50176
  ds_read_b128 v[48:51], v2 offset:51200
  ds_read_b128 v[52:55], v2 offset:52224
  ds_read_b128 v[56:59], v2 offset:0
  ds_read_b128 v[60:63], v2 offset:1024
  s_waitcnt lgkmcnt(0)
  s_waitcnt vmcnt(3)
  v_mov_b64 v[20:21], 0
  v_mov_b64 v[22:23], 0
  v_mov_b64_e64 v[24:25], 0
  v_mov_b64_e64 v[26:27], 0
  s_add_u32 s40, s40, 1
  s_xor_b32 s54, s54, 1
  s_mov_b32 s42, s44
  s_mov_b32 s44, s43
  s_mov_b32 s43, s45
  s_add_u32 s48, s48, 262144
  s_add_u32 s93, s93, 262144
  s_add_u32 s49, s49, 65536
  s_nop 3
  buffer_load_dwordx4 v[28:31], v11, s[4:7], s45 offen offset:0 sc1
  buffer_load_dwordx4 v[32:35], v11, s[4:7], s45 offen offset:1024 sc1
  s_cmp_eq_u32 s40, 63
  s_waitcnt vmcnt(3) lgkmcnt(0)
  v_max3_u32 v36, v28, v29, v30
  v_max_u32 v36, v36, v31
  ds_write_b128 v0, v[28:31] offset:20480
  s_waitcnt vmcnt(2)
  v_max3_u32 v36, v36, v32, v33
  v_max3_u32 v36, v36, v34, v35
  ds_write_b128 v0, v[32:35] offset:21504
  v_cmp_eq_u32 vcc, -1, v36
  s_nop 0
  s_cbranch_vccz L_okB_c2f
L_retB_c2f:
  s_add_u32 s50, s50, 1
  s_mov_b64 exec, vcc
  buffer_load_dwordx4 v[28:31], v11, s[4:7], s45 offen offset:0 sc1
  buffer_load_dwordx4 v[32:35], v11, s[4:7], s45 offen offset:1024 sc1
  s_mov_b64 exec, -1
  s_cmp_ge_u32 s50, 262144
  s_cbranch_scc1 L_chain_end
  s_cmp_eq_u32 s40, 63
  s_waitcnt vmcnt(3)
  v_max3_u32 v36, v28, v29, v30
  v_max_u32 v36, v36, v31
  ds_write_b128 v0, v[28:31] offset:20480
  s_waitcnt vmcnt(2)
  v_max3_u32 v36, v36, v32, v33
  v_max3_u32 v36, v36, v34, v35
  ds_write_b128 v0, v[32:35] offset:21504
  v_cmp_eq_u32 vcc, -1, v36
  s_nop 0
  s_cbranch_vccnz L_retB_c2f
L_okB_c2f:
  s_cbranch_scc1 L_last_2
L_enter_c2f:
  v_smfmac_f32_16x16x64_bf16 v[12:15], v[28:31], a[16:23], v1
  v_smfmac_f32_16x16x64_bf16 v[20:23], v[28:31], a[112:119], v1
  v_smfmac_f32_16x16x64_bf16 v[16:19], v[28:31], a[24:31], v1
  s_waitcnt lgkmcnt(0)
  s_barrier
  ds_read_b128 v[36:39], v0 offset:16384
  v_smfmac_f32_16x16x64_bf16 v[24:27], v[28:31], a[120:127], v1
  s_waitcnt vmcnt(0)
  ds_read_b128 v[28:31], v0 offset:18432
  v_smfmac_f32_16x16x64_bf16 v[12:15], v[32:35], a[32:39], v1
  v_smfmac_f32_16x16x64_bf16 v[20:23], v[32:35], v[40:47], v1
  ds_read_b128 v[40:43], v2 offset:2048
  ds_read_b128 v[44:47], v2 offset:3072
  v_smfmac_f32_16x16x64_bf16 v[16:19], v[32:35], a[40:47], v1
  s_mov_b32 m0, 3072
  s_add_u32 s51, s48, 3072
  buffer_load_dwordx4 v0, s[4:7], s51 offen offset:0 sc1 lds
  v_smfmac_f32_16x16x64_bf16 v[24:27], v[32:35], v[48:55], v1
  ds_read_b128 v[48:51], v2 offset:16384
  ds_read_b128 v[52:55], v2 offset:17408
  s_waitcnt lgkmcnt(5)
  v_smfmac_f32_16x16x64_bf16 v[12:15], v[36:39], v[208:215], v1
  ds_read_b128 v[32:35], v0 offset:17408
  v_smfmac_f32_16x16x64_bf16 v[20:23], v[36:39], v[56:63], v1
  ds_read_b128 v[56:59], v2 offset:18432
  ds_read_b128 v[60:63], v2 offset:19456
  v_smfmac_f32_16x16x64_bf16 v[16:19], v[36:39], v[216:223], v1
  s_mov_b32 m0, 7168
  s_add_u32 s51, s48, 7168
  buffer_load_dwordx4 v0, s[4:7], s51 offen offset:0 sc1 lds
  s_waitcnt lgkmcnt(5)
  v_smfmac_f32_16x16x64_bf16 v[24:27], v[36:39], v[40:47], v1
  ds_read_b128 v[40:43], v2 offset:32768
  ds_read_b128 v[44:47], v2 offset:33792
  v_smfmac_f32_16x16x64_bf16 v[12:15], v[28:31], v[240:247], v1
  ds_read_b128 v[36:39], v0 offset:19456
  s_waitcnt lgkmcnt(6)
  v_smfmac_f32_16x16x64_bf16 v[20:23], v[28:31], v[48:55], v1
  ds_read_b128 v[48:51], v2 offset:34816
  ds_read_b128 v[52:55], v2 offset:35840
  v_smfmac_f32_16x16x64_bf16 v[16:19], v[28:31], v[248:255], v1
  s_mov_b32 m0, 12288
  s_add_u32 s51, s48, 16781312
  buffer_load_dwordx4 v0, s[4:7], s51 offen offset:0 sc1 lds
  s_waitcnt lgkmcnt(5)
  v_smfmac_f32_16x16x64_bf16 v[24:27], v[28:31], v[56:63], v1
  ds_read_b128 v[56:59], v3 offset:0
  ds_read_b128 v[60:63], v3 offset:1024
  v_smfmac_f32_16x16x64_bf16 v[12:15], v[32:35], v[224:231], v1
  ds_read_b128 v[28:31], v0 offset:22528
  v_smfmac_f32_16x16x64_bf16 v[20:23], v[32:35], a[96:103], v1
  v_smfmac_f32_16x16x64_bf16 v[16:19], v[32:35], v[232:239], v1
  buffer_load_dwordx4 v0, s[4:7], s51 offen offset:1024 sc1 lds
  v_smfmac_f32_16x16x64_bf16 v[24:27], v[32:35], a[104:111], v1
  s_waitcnt lgkmcnt(5)
  v_smfmac_f32_16x16x64_bf16 v[12:15], v[36:39], a[0:7], v1
  ds_read_b128 v[32:35], v0 offset:24576
  v_smfmac_f32_16x16x64_bf16 v[20:23], v[36:39], v[40:47], v1
  ds_read_b128 v[40:43], v3 offset:2048
  ds_read_b128 v[44:47], v3 offset:3072
  v_smfmac_f32_16x16x64_bf16 v[16:19], v[36:39], a[8:15], v1
  s_mov_b32 m0, 32256
  s_nop 0
  buffer_load_dword v0, s[28:31], s93 idxen sc1 lds
  s_waitcnt lgkmcnt(6)
  v_smfmac_f32_16x16x64_bf16 v[24:27], v[36:39], v[48:55], v1
  ds_read_b128 v[48:51], v3 offset:16384
  ds_read_b128 v[52:55], v3 offset:17408
  s_waitcnt lgkmcnt(5)
  v_smfmac_f32_16x16x64_bf16 v[12:15], v[28:31], a[48:55], v1
  ds_read_b128 v[36:39], v0 offset:23552
  v_smfmac_f32_16x16x64_bf16 v[20:23], v[28:31], v[56:63], v1
  ds_read_b128 v[56:59], v3 offset:18432
  ds_read_b128 v[60:63], v3 offset:19456
  v_smfmac_f32_16x16x64_bf16 v[16:19], v[28:31], a[56:63], v1
  s_waitcnt lgkmcnt(5)
  v_smfmac_f32_16x16x64_bf16 v[24:27], v[28:31], v[40:47], v1
  v_smfmac_f32_16x16x64_bf16 v[12:15], v[32:35], a[80:87], v1
  v_mov_b64 v[40:41], 0
  s_waitcnt lgkmcnt(3)
  v_smfmac_f32_16x16x64_bf16 v[20:23], v[32:35], v[48:55], v1
  v_smfmac_f32_16x16x64_bf16 v[16:19], v[32:35], a[88:95], v1
  v_mov_b64_e64 v[42:43], 0
  s_waitcnt lgkmcnt(0)
  v_smfmac_f32_16x16x64_bf16 v[24:27], v[32:35], v[56:63], v1
  v_smfmac_f32_16x16x64_bf16 v[12:15], v[36:39], a[64:71], v1
  v_mov_b64 v[44:45], 0
  v_smfmac_f32_16x16x64_bf16 v[20:23], v[36:39], a[128:135], v1
  v_mov_b64_e64 v[46:47], 0
  v_smfmac_f32_16x16x64_bf16 v[16:19], v[36:39], a[72:79], v1
  v_smfmac_f32_16x16x64_bf16 v[24:27], v[36:39], a[136:143], v1
  v_pk_add_f32 v[12:13], v[12:13], v[14:15]
  v_pk_add_f32 v[20:21], v[20:21], v[22:23]
  v_cvt_pk_bf16_f32 v23, v12, v13
  v_cvt_pk_bf16_f32 v22, v20, v21
  ds_write_b64 v5, v[22:23] offset:0
  v_pk_add_f32 v[16:17], v[16:17], v[18:19]
  s_nop 1
  v_pk_add_f32 v[24:25], v[24:25], v[26:27]
  v_cvt_pk_bf16_f32 v27, v16, v17
  v_cvt_pk_bf16_f32 v26, v24, v25
  ds_write_b64 v5, v[26:27] offset:512
  v_smfmac_f32_16x16x64_bf16 v[40:43], v[28:31], v[160:167], v1
  v_xor_b32 v52, 16, v6
  s_waitcnt vmcnt(3)
  ds_read_b128 v[60:63], v0 offset:3072
  v_smfmac_f32_16x16x64_bf16 v[44:47], v[28:31], v[168:175], v1
  ds_read_b128 v[28:31], v0 offset:20480
  ds_read_b128 v[48:51], v0 offset:7168
  v_smfmac_f32_16x16x64_bf16 v[40:43], v[32:35], v[192:199], v1
  v_smfmac_f32_16x16x64_bf16 v[44:47], v[32:35], v[200:207], v1
  ds_read_b128 v[32:35], v0 offset:21504
  v_smfmac_f32_16x16x64_bf16 v[40:43], v[36:39], v[176:183], v1
  s_waitcnt lgkmcnt(4)
  s_barrier
  ds_read_b64_tr_b16 v[12:13], v6 offset:3072
  ds_read_b64_tr_b16 v[14:15], v52 offset:3328
  ds_read_b64_tr_b16 v[16:17], v6 offset:0
  ds_read_b64_tr_b16 v[18:19], v52 offset:256
  v_smfmac_f32_16x16x64_bf16 v[44:47], v[36:39], v[184:191], v1
  ds_read_b64_tr_b16 v[20:21], v6 offset:1024
  ds_read_b64_tr_b16 v[22:23], v52 offset:1280
  s_waitcnt lgkmcnt(8)
  v_smfmac_f32_16x16x64_bf16 v[40:43], v[28:31], v[128:135], v1
  ds_read_b64_tr_b16 v[24:25], v6 offset:2048
  ds_read_b64_tr_b16 v[26:27], v52 offset:2304
  v_smfmac_f32_16x16x64_bf16 v[44:47], v[28:31], v[136:143], v1
  ds_read_b128 v[28:31], v0 offset:16384
  s_waitcnt lgkmcnt(9)
  v_smfmac_f32_16x16x64_bf16 v[40:43], v[32:35], v[144:151], v1
  v_smfmac_f32_16x16x64_bf16 v[44:47], v[32:35], v[152:159], v1
  ds_read_b128 v[32:35], v0 offset:18432
  s_waitcnt lgkmcnt(8)
  v_mfma_f32_16x16x32_bf16 v[56:59], v[60:63], v[12:15], 0
  ds_read_b128 v[36:39], v0 offset:0
  v_mfma_f32_16x16x32_bf16 v[60:63], v[48:51], v[12:15], 0
  ds_read_b128 v[48:51], v0 offset:4096
  v_mfma_f32_16x16x32_bf16 v[52:55], v[12:15], v[12:15], 0
  ds_read_b128 v[12:15], v0 offset:1024
  s_waitcnt lgkmcnt(9)
  v_mfma_f32_16x16x32_bf16 v[52:55], v[16:19], v[16:19], v[52:55]
  s_waitcnt lgkmcnt(2)
  v_mfma_f32_16x16x32_bf16 v[56:59], v[36:39], v[16:19], v[56:59]
  ds_read_b128 v[36:39], v0 offset:5120
  s_waitcnt lgkmcnt(2)
  v_mfma_f32_16x16x32_bf16 v[60:63], v[48:51], v[16:19], v[60:63]
  ds_read_b128 v[48:51], v0 offset:2048
  ds_read_b128 v[16:19], v0 offset:6144
  v_mfma_f32_16x16x32_bf16 v[52:55], v[20:23], v[20:23], v[52:55]
  s_waitcnt lgkmcnt(3)
  v_mfma_f32_16x16x32_bf16 v[56:59], v[12:15], v[20:23], v[56:59]
  s_waitcnt lgkmcnt(2)
  v_mfma_f32_16x16x32_bf16 v[60:63], v[36:39], v[20:23], v[60:63]
  s_waitcnt vmcnt(1)
  ds_read_b128 v[20:23], v0 offset:12288
  ds_read_b128 v[12:15], v0 offset:13312
  v_mfma_f32_16x16x32_bf16 v[52:55], v[24:27], v[24:27], v[52:55]
  s_waitcnt lgkmcnt(3)
  v_mfma_f32_16x16x32_bf16 v[56:59], v[48:51], v[24:27], v[56:59]
  s_waitcnt lgkmcnt(2)
  v_mfma_f32_16x16x32_bf16 v[60:63], v[16:19], v[24:27], v[60:63]
  v_smfmac_f32_16x16x64_bf16 v[40:43], v[28:31], v[64:71], v1
  buffer_store_dwordx4 v[24:27], v9, s[4:7], s49 offen offset:1024 sc1
  v_mov_b32 v36, 0x3f803f80
  v_mov_b32 v37, 0x3f803f80
  v_max3_f32 v48, v52, v53, v56
  v_max3_f32 v48, v48, v57, v58
  v_max3_f32 v48, v48, v59, v60
  v_max3_f32 v48, v48, v61, v62
  v_max_f32 v49, v48, v63
  v_max_f32 v48, v48, v63
  v_smfmac_f32_16x16x64_bf16 v[44:47], v[28:31], v[72:79], v1
  ds_read_b128 v[28:31], v0 offset:17408
  v_mov_b64 v[38:39], v[36:37]
  v_permlane32_swap_b32 v48, v49
  v_max_f32 v48, v48, v49
  v_mov_b32 v49, v48
  v_smfmac_f32_16x16x64_bf16 v[40:43], v[32:35], v[96:103], v1
  v_mov_b64 v[16:17], 0
  v_permlane16_swap_b32 v48, v49
  v_max_f32 v48, v48, v49
  v_mul_f32_e64 v48, s47, v48
  v_pk_fma_f32 v[56:57], v[56:57], s[46:47], v[48:49] op_sel_hi:[1,0,0]
  v_pk_fma_f32 v[58:59], v[58:59], s[46:47], v[48:49] op_sel_hi:[1,0,0]
  v_pk_fma_f32 v[60:61], v[60:61], s[46:47], v[48:49] op_sel_hi:[1,0,0]
  v_pk_fma_f32 v[62:63], v[62:63], s[46:47], v[48:49] op_sel_hi:[1,0,0]
  v_pk_fma_f32 v[52:53], v[52:53], s[46:47], v[48:49] op_sel_hi:[1,0,0]
  v_smfmac_f32_16x16x64_bf16 v[44:47], v[32:35], v[104:111], v1
  ds_read_b128 v[32:35], v0 offset:19456
  v_exp_f32 v56, v56
  v_exp_f32 v57, v57
  s_waitcnt lgkmcnt(1)
  v_smfmac_f32_16x16x64_bf16 v[40:43], v[28:31], v[80:87], v1
  v_exp_f32 v58, v58
  v_exp_f32 v59, v59
  v_smfmac_f32_16x16x64_bf16 v[44:47], v[28:31], v[88:95], v1
  v_exp_f32 v60, v60
  v_exp_f32 v61, v61
  s_waitcnt lgkmcnt(0)
  v_smfmac_f32_16x16x64_bf16 v[40:43], v[32:35], v[112:119], v1
  v_exp_f32 v62, v62
  v_exp_f32 v63, v63
  v_smfmac_f32_16x16x64_bf16 v[44:47], v[32:35], v[120:127], v1
  v_exp_f32 v52, v52
  v_exp_f32 v53, v53
  ds_read_b128 v[28:31], v3 offset:32768
  ds_read_b128 v[32:35], v3 offset:33792
  v_mov_b64_e64 v[18:19], 0
  v_cvt_pk_bf16_f32 v24, v56, v57
  v_cvt_pk_bf16_f32 v25, v58, v59
  v_cvt_pk_bf16_f32 v26, v60, v61
  v_cvt_pk_bf16_f32 v27, v62, v63
  v_cvt_pk_bf16_f32 v16, v52, v53
  v_cvt_pk_bf16_f32 v19, v52, v53
  v_mfma_f32_16x16x32_bf16 v[52:55], v[36:39], v[24:27], 0
  v_add_f32 v40, v40, v42
  v_add_f32 v41, v41, v43
  v_mfma_f32_16x16x32_bf16 v[56:59], v[20:23], v[24:27], 0
  v_add_f32 v44, v44, v46
  v_add_f32 v45, v45, v47
  v_mfma_f32_16x16x32_bf16 v[60:63], v[12:15], v[24:27], 0
  v_cvt_pk_bf16_f32 v40, v40, v41
  v_cvt_pk_bf16_f32 v41, v44, v45
  s_add_u32 s51, s49, 4194304
  v_lshrrev_b32 v50, 1, v0
  v_mfma_f32_16x16x16_bf16 v[52:55], v[36:37], v[16:17], v[52:55]
  v_mov_b64 v[44:45], 0
  v_mov_b64 v[46:47], 0
  v_mfma_f32_16x16x16_bf16 v[56:59], v[40:41], v[16:17], v[56:59]
  buffer_store_dwordx2 v[40:41], v50, s[4:7], s51 offen offset:1024 sc1
  v_mov_b64 v[12:13], 0
  v_mov_b64 v[14:15], 0
  v_mfma_f32_16x16x16_bf16 v[60:63], v[40:41], v[18:19], v[60:63]
  s_nop 0
  v_rcp_f32 v48, v52
  v_mov_b64 v[36:37], 0
  v_mov_b64 v[38:39], 0
  s_mov_b64 exec, s[52:53]
  v_pk_mul_f32 v[56:57], v[56:57], v[48:49] op_sel_hi:[1,0]
  v_pk_mul_f32 v[58:59], v[58:59], v[48:49] op_sel_hi:[1,0]
  v_cvt_pk_bf16_f32 v56, v56, v57
  v_cvt_pk_bf16_f32 v57, v58, v59
  ds_write_b64 v7, v[56:57] offset:0
  v_pk_mul_f32 v[60:61], v[60:61], v[48:49] op_sel_hi:[1,0]
  v_pk_mul_f32 v[62:63], v[62:63], v[48:49] op_sel_hi:[1,0]
  v_cvt_pk_bf16_f32 v60, v60, v61
  v_cvt_pk_bf16_f32 v61, v62, v63
  ds_write_b64 v7, v[60:61] offset:256
  s_mov_b64 exec, -1
  v_mov_b32 v58, 0
  v_mov_b32 v59, 0
  v_mov_b32 v56, 0
  v_mov_b32 v57, 0
  s_waitcnt lgkmcnt(0)
  s_barrier
  ds_read_b128 v[16:19], v4 offset:29696
  v_mov_b32 v60, 0
  ds_read_b128 v[40:43], v4 offset:30208
  v_mov_b32_e64 v61, 0
  ds_read_b128 v[48:51], v4 offset:30720
  v_mov_b32 v62, 0
  ds_read_b128 v[52:55], v4 offset:31232
  v_mov_b32 v63, 0
  ds_read_b128 v[20:23], v3 offset:34816
  ds_read_b128 v[24:27], v3 offset:35840
  s_waitcnt lgkmcnt(5)
  v_smfmac_f32_16x16x64_bf16 v[44:47], v[16:19], a[160:167], v1
  s_waitcnt lgkmcnt(4)
  v_smfmac_f32_16x16x64_bf16 v[44:47], v[40:43], v[28:35], v1
  ds_read_b128 v[28:31], v3 offset:49152
  ds_read_b128 v[32:35], v3 offset:50176
  s_waitcnt lgkmcnt(5)
  v_smfmac_f32_16x16x64_bf16 v[44:47], v[48:51], a[168:175], v1
  s_waitcnt lgkmcnt(4)
  v_smfmac_f32_16x16x64_bf16 v[44:47], v[52:55], a[176:183], v1
  s_waitcnt lgkmcnt(2)
  v_smfmac_f32_16x16x64_bf16 v[12:15], v[16:19], v[20:27], v1
  ds_read_b128 v[20:23], v3 offset:51200
  ds_read_b128 v[24:27], v3 offset:52224
  v_smfmac_f32_16x16x64_bf16 v[12:15], v[40:43], a[184:191], v1
  s_nop 0
  v_cvt_pk_bf16_f32 v44, v44, v45
  v_cvt_pk_bf16_f32 v45, v46, v47
  v_smfmac_f32_16x16x64_bf16 v[12:15], v[48:51], a[192:199], v1
  v_bfi_b32 v44, 1, s54, v44
  v_bfi_b32 v45, 1, s54, v45
  buffer_store_dwordx2 v[44:45], v8, s[4:7], s89 offen
  v_smfmac_f32_16x16x64_bf16 v[12:15], v[52:55], a[200:207], v1
  s_waitcnt lgkmcnt(2)
  v_smfmac_f32_16x16x64_bf16 v[36:39], v[16:19], v[28:35], v1
  ds_read_b128 v[28:31], v0 offset:29696
  ds_read_b128 v[32:35], v0 offset:30720
  v_smfmac_f32_16x16x64_bf16 v[36:39], v[40:43], a[208:215], v1
  s_nop 0
  v_cvt_pk_bf16_f32 v12, v12, v13
  v_cvt_pk_bf16_f32 v13, v14, v15
  v_smfmac_f32_16x16x64_bf16 v[36:39], v[48:51], a[216:223], v1
  v_bfi_b32 v12, 1, s54, v12
  v_bfi_b32 v13, 1, s54, v13
  buffer_store_dwordx2 v[12:13], v8, s[4:7], s90 offen
  v_smfmac_f32_16x16x64_bf16 v[36:39], v[52:55], a[224:231], v1
  s_waitcnt lgkmcnt(2)
  v_smfmac_f32_16x16x64_bf16 v[56:59], v[16:19], v[20:27], v1
  v_smfmac_f32_16x16x64_bf16 v[56:59], v[40:43], a[232:239], v1
  s_nop 0
  v_cvt_pk_bf16_f32 v36, v36, v37
  v_cvt_pk_bf16_f32 v37, v38, v39
  v_smfmac_f32_16x16x64_bf16 v[56:59], v[48:51], a[240:247], v1
  v_bfi_b32 v36, 1, s54, v36
  v_bfi_b32 v37, 1, s54, v37
  buffer_store_dwordx2 v[36:37], v8, s[4:7], s91 offen
  v_smfmac_f32_16x16x64_bf16 v[56:59], v[52:55], a[248:255], v1
  s_waitcnt lgkmcnt(1)
  v_smfmac_f32_16x16x64_bf16 v[60:63], v[28:31], a[144:151], v1
  s_waitcnt lgkmcnt(0)
  v_smfmac_f32_16x16x64_bf16 v[60:63], v[32:35], a[152:159], v1
  s_nop 0
  v_cvt_pk_bf16_f32 v56, v56, v57
  v_cvt_pk_bf16_f32 v57, v58, v59
  v_bfi_b32 v56, 1, s54, v56
  v_bfi_b32 v57, 1, s54, v57
  buffer_store_dwordx2 v[56:57], v8, s[4:7], s92 offen
  s_nop 1
  v_pk_add_f32 v[60:61], v[60:61], v[62:63]
  v_cvt_pk_bf16_f32 v60, v60, v61
  v_bfi_b32 v60, 1, s54, v60
  buffer_store_dword v60, v8, s[4:7], s88 offen offset:0
  s_cmp_ge_u32 s32, 8
  s_cbranch_scc1 L_nored_c2f
  v_mov_b32_e64 v51, -1
  buffer_store_dword v51, v10, s[4:7], s44 offen
  s_waitcnt vmcnt(3)
  s_nop 3
  buffer_load_dwordx4 v[20:23], v0, s[4:7], s41 offen offset:0 sc1
  buffer_load_dwordx4 v[24:27], v0, s[4:7], s41 offen offset:1024 sc1
  buffer_load_dwordx4 v[28:31], v0, s[4:7], s41 offen offset:2048 sc1
  buffer_load_dwordx4 v[32:35], v0, s[4:7], s41 offen offset:3072 sc1
  s_nop 7
  s_nop 3
  v_bfe_u32 v48, v0, 4, 1
  v_lshlrev_b32_e64 v48, 4, v48
  v_mov_b32 v49, 0x3f80
  v_lshlrev_b32 v49, v48, v49
  v_bfe_u32 v48, v0, 5, 3
  v_cmp_eq_u32_e64 vcc, 0, v48
  s_nop 1
  v_cndmask_b32_e64 v36, 0, v49, vcc
  v_cmp_eq_u32 vcc, 1, v48
  s_nop 1
  v_cndmask_b32 v37, 0, v49, vcc
  v_cmp_eq_u32_e64 vcc, 2, v48
  s_nop 1
  v_cndmask_b32_e64 v38, 0, v49, vcc
  v_cmp_eq_u32 vcc, 3, v48
  s_nop 1
  v_cndmask_b32 v39, 0, v49, vcc
  buffer_load_dwordx4 v[20:23], v0, s[4:7], s41 offen offset:0 sc1
  buffer_load_dwordx4 v[24:27], v0, s[4:7], s41 offen offset:1024 sc1
  buffer_load_dwordx4 v[28:31], v0, s[4:7], s41 offen offset:2048 sc1
  buffer_load_dwordx4 v[32:35], v0, s[4:7], s41 offen offset:3072 sc1
  s_waitcnt vmcnt(7)
  v_bitop3_b32 v48, v20, v21, s54 bitop3:0x7e
  v_bitop3_b32 v49, v22, v23, s54 bitop3:0x7e
  v_mfma_f32_16x16x32_bf16 v[40:43], v[20:23], v[36:39], 0
  v_or_b32 v50, v48, v49
  s_waitcnt vmcnt(6)
  v_bitop3_b32 v48, v24, v25, s54 bitop3:0x7e
  v_bitop3_b32 v49, v26, v27, s54 bitop3:0x7e
  v_mfma_f32_16x16x32_bf16 v[40:43], v[24:27], v[36:39], v[40:43]
  v_or3_b32 v50, v50, v48, v49
  s_waitcnt vmcnt(5)
  v_bitop3_b32 v48, v28, v29, s54 bitop3:0x7e
  v_bitop3_b32 v49, v30, v31, s54 bitop3:0x7e
  v_mfma_f32_16x16x32_bf16 v[40:43], v[28:31], v[36:39], v[40:43]
  v_or3_b32 v50, v50, v48, v49
  s_waitcnt vmcnt(4)
  v_bitop3_b32 v48, v32, v33, s54 bitop3:0x7e
  v_bitop3_b32 v49, v34, v35, s54 bitop3:0x7e
  v_mfma_f32_16x16x32_bf16 v[40:43], v[32:35], v[36:39], v[40:43]
  v_or3_b32 v50, v50, v48, v49
  v_and_b32_e64 v50, 1, v50
  v_cmp_eq_u32 vcc, 1, v50
  s_nop 0
  s_cbranch_vccz L_okA_c2f
L_retA_c2f:
  s_add_u32 s50, s50, 1
  s_mov_b64 exec, vcc
  buffer_load_dwordx4 v[20:23], v0, s[4:7], s41 offen offset:0 sc1
  buffer_load_dwordx4 v[24:27], v0, s[4:7], s41 offen offset:1024 sc1
  buffer_load_dwordx4 v[28:31], v0, s[4:7], s41 offen offset:2048 sc1
  buffer_load_dwordx4 v[32:35], v0, s[4:7], s41 offen offset:3072 sc1
  s_mov_b64 exec, -1
  s_cmp_ge_u32 s50, 262144
  s_cbranch_scc1 L_chain_end
  s_waitcnt vmcnt(7)
  v_bitop3_b32 v48, v20, v21, s54 bitop3:0x7e
  v_bitop3_b32 v49, v22, v23, s54 bitop3:0x7e
  v_mfma_f32_16x16x32_bf16 v[40:43], v[20:23], v[36:39], 0
  v_or_b32 v50, v48, v49
  s_waitcnt vmcnt(6)
  v_bitop3_b32 v48, v24, v25, s54 bitop3:0x7e
  v_bitop3_b32 v49, v26, v27, s54 bitop3:0x7e
  v_mfma_f32_16x16x32_bf16 v[40:43], v[24:27], v[36:39], v[40:43]
  v_or3_b32 v50, v50, v48, v49
  s_waitcnt vmcnt(5)
  v_bitop3_b32 v48, v28, v29, s54 bitop3:0x7e
  v_bitop3_b32 v49, v30, v31, s54 bitop3:0x7e
  v_mfma_f32_16x16x32_bf16 v[40:43], v[28:31], v[36:39], v[40:43]
  v_or3_b32 v50, v50, v48, v49
  s_waitcnt vmcnt(4)
  v_bitop3_b32 v48, v32, v33, s54 bitop3:0x7e
  v_bitop3_b32 v49, v34, v35, s54 bitop3:0x7e
  v_mfma_f32_16x16x32_bf16 v[40:43], v[32:35], v[36:39], v[40:43]
  v_or3_b32 v50, v50, v48, v49
  v_and_b32 v50, 1, v50
  v_cmp_eq_u32_e64 vcc, 1, v50
  s_nop 0
  s_cbranch_vccnz L_retA_c2f
L_okA_c2f:
  s_nop 2
  v_permlane32_swap_b32 v40, v42
  v_permlane32_swap_b32 v41, v43
  v_add_f32 v40, v40, v42
  v_add_f32 v41, v41, v43
  v_cvt_pk_bf16_f32 v40, v40, v41
  buffer_store_dword v40, v10, s[4:7], s42 offen
  s_branch L_loop_c2f
L_nored_c2f:
  s_waitcnt vmcnt(0)
  s_branch L_loop_c2f
L_loop_c2s:
  s_barrier
  s_mov_b32 s45, s42
  v_mov_b64 v[12:13], 0
  v_mov_b64 v[14:15], 0
  v_mov_b64 v[16:17], 0
  v_mov_b64 v[18:19], 0
  buffer_load_dwordx4 v[28:31], v11, s[4:7], s45 offen offset:0 sc1
  buffer_load_dwordx4 v[32:35], v11, s[4:7], s45 offen offset:1024 sc1
  ds_read_b128 v[40:43], v2 offset:49152
  ds_read_b128 v[44:47], v2 offset:50176
  ds_read_b128 v[48:51], v2 offset:51200
  ds_read_b128 v[52:55], v2 offset:52224
  ds_read_b128 v[56:59], v2 offset:0
  ds_read_b128 v[60:63], v2 offset:1024
  s_waitcnt lgkmcnt(0)
  s_waitcnt vmcnt(3)
  v_mov_b64 v[20:21], 0
  v_mov_b64 v[22:23], 0
  v_mov_b64 v[24:25], 0
  v_mov_b64 v[26:27], 0
  s_add_u32 s40, s40, 1
  s_xor_b32 s54, s54, 1
  s_mov_b32 s42, s44
  s_mov_b32 s44, s43
  s_mov_b32 s43, s45
  s_add_u32 s48, s48, 262144
  s_add_u32 s93, s93, 262144
  s_add_u32 s49, s49, 65536
  s_nop 3
  buffer_load_dwordx4 v[28:31], v11, s[4:7], s45 offen offset:0 sc1
  buffer_load_dwordx4 v[32:35], v11, s[4:7], s45 offen offset:1024 sc1
  s_cmp_eq_u32 s40, 63
  s_waitcnt vmcnt(3) lgkmcnt(0)
  v_max3_u32 v36, v28, v29, v30
  v_max_u32 v36, v36, v31
  ds_write_b128 v0, v[28:31] offset:20480
  s_waitcnt vmcnt(2)
  v_max3_u32 v36, v36, v32, v33
  v_max3_u32 v36, v36, v34, v35
  ds_write_b128 v0, v[32:35] offset:21504
  v_cmp_eq_u32 vcc, -1, v36
  s_nop 0
  s_cbranch_vccz L_okB_c2s
L_retB_c2s:
  s_add_u32 s50, s50, 1
  s_mov_b64 exec, vcc
  buffer_load_dwordx4 v[28:31], v11, s[4:7], s45 offen offset:0 sc1
  buffer_load_dwordx4 v[32:35], v11, s[4:7], s45 offen offset:1024 sc1
  s_mov_b64 exec, -1
  s_cmp_ge_u32 s50, 262144
  s_cbranch_scc1 L_chain_end
  s_cmp_eq_u32 s40, 63
  s_waitcnt vmcnt(3)
  v_max3_u32 v36, v28, v29, v30
  v_max_u32 v36, v36, v31
  ds_write_b128 v0, v[28:31] offset:20480
  s_waitcnt vmcnt(2)
  v_max3_u32 v36, v36, v32, v33
  v_max3_u32 v36, v36, v34, v35
  ds_write_b128 v0, v[32:35] offset:21504
  v_cmp_eq_u32 vcc, -1, v36
  s_nop 0
  s_cbranch_vccnz L_retB_c2s
L_okB_c2s:
  s_cbranch_scc1 L_last_2
L_enter_c2s:
  v_smfmac_f32_16x16x64_bf16 v[12:15], v[28:31], a[16:23], v1
  v_smfmac_f32_16x16x64_bf16 v[20:23], v[28:31], a[112:119], v1
  v_smfmac_f32_16x16x64_bf16 v[16:19], v[28:31], a[24:31], v1
  s_waitcnt lgkmcnt(0)
  s_barrier
  ds_read_b128 v[36:39], v0 offset:16384
  v_smfmac_f32_16x16x64_bf16 v[24:27], v[28:31], a[120:127], v1
  s_waitcnt vmcnt(0)
  ds_read_b128 v[28:31], v0 offset:18432
  v_smfmac_f32_16x16x64_bf16 v[12:15], v[32:35], a[32:39], v1
  v_smfmac_f32_16x16x64_bf16 v[20:23], v[32:35], v[40:47], v1
  ds_read_b128 v[40:43], v2 offset:2048
  ds_read_b128 v[44:47], v2 offset:3072
  v_smfmac_f32_16x16x64_bf16 v[16:19], v[32:35], a[40:47], v1
  s_mov_b32 m0, 3072
  s_add_u32 s51, s48, 3072
  buffer_load_dwordx4 v0, s[4:7], s51 offen offset:0 sc1 lds
  v_smfmac_f32_16x16x64_bf16 v[24:27], v[32:35], v[48:55], v1
  ds_read_b128 v[48:51], v2 offset:16384
  ds_read_b128 v[52:55], v2 offset:17408
  s_waitcnt lgkmcnt(5)
  v_smfmac_f32_16x16x64_bf16 v[12:15], v[36:39], v[208:215], v1
  ds_read_b128 v[32:35], v0 offset:17408
  v_smfmac_f32_16x16x64_bf16 v[20:23], v[36:39], v[56:63], v1
  ds_read_b128 v[56:59], v2 offset:18432
  ds_read_b128 v[60:63], v2 offset:19456
  v_smfmac_f32_16x16x64_bf16 v[16:19], v[36:39], v[216:223], v1
  s_mov_b32 m0, 7168
  s_add_u32 s51, s48, 7168
  buffer_load_dwordx4 v0, s[4:7], s51 offen offset:0 sc1 lds
  s_waitcnt lgkmcnt(5)
  v_smfmac_f32_16x16x64_bf16 v[24:27], v[36:39], v[40:47], v1
  ds_read_b128 v[40:43], v2 offset:32768
  ds_read_b128 v[44:47], v2 offset:33792
  v_smfmac_f32_16x16x64_bf16 v[12:15], v[28:31], v[240:247], v1
  ds_read_b128 v[36:39], v0 offset:19456
  s_waitcnt lgkmcnt(6)
  v_smfmac_f32_16x16x64_bf16 v[20:23], v[28:31], v[48:55], v1
  ds_read_b128 v[48:51], v2 offset:34816
  ds_read_b128 v[52:55], v2 offset:35840
  v_smfmac_f32_16x16x64_bf16 v[16:19], v[28:31], v[248:255], v1
  s_mov_b32 m0, 12288
  s_add_u32 s51, s48, 16781312
  buffer_load_dwordx4 v0, s[4:7], s51 offen offset:0 sc1 lds
  s_waitcnt lgkmcnt(5)
  v_smfmac_f32_16x16x64_bf16 v[24:27], v[28:31], v[56:63], v1
  ds_read_b128 v[56:59], v3 offset:0
  ds_read_b128 v[60:63], v3 offset:1024
  v_smfmac_f32_16x16x64_bf16 v[12:15], v[32:35], v[224:231], v1
  ds_read_b128 v[28:31], v0 offset:22528
  v_smfmac_f32_16x16x64_bf16 v[20:23], v[32:35], a[96:103], v1
  v_smfmac_f32_16x16x64_bf16 v[16:19], v[32:35], v[232:239], v1
  buffer_load_dwordx4 v0, s[4:7], s51 offen offset:1024 sc1 lds
  v_smfmac_f32_16x16x64_bf16 v[24:27], v[32:35], a[104:111], v1
  s_waitcnt lgkmcnt(5)
  v_smfmac_f32_16x16x64_bf16 v[12:15], v[36:39], a[0:7], v1
  ds_read_b128 v[32:35], v0 offset:24576
  v_smfmac_f32_16x16x64_bf16 v[20:23], v[36:39], v[40:47], v1
  ds_read_b128 v[40:43], v3 offset:2048
  ds_read_b128 v[44:47], v3 offset:3072
  v_smfmac_f32_16x16x64_bf16 v[16:19], v[36:39], a[8:15], v1
  s_mov_b32 m0, 32256
  s_nop 0
  buffer_load_dword v0, s[28:31], s93 idxen sc1 lds
  s_waitcnt lgkmcnt(6)
  v_smfmac_f32_16x16x64_bf16 v[24:27], v[36:39], v[48:55], v1
  ds_read_b128 v[48:51], v3 offset:16384
  ds_read_b128 v[52:55], v3 offset:17408
  s_waitcnt lgkmcnt(5)
  v_smfmac_f32_16x16x64_bf16 v[12:15], v[28:31], a[48:55], v1
  ds_read_b128 v[36:39], v0 offset:23552
  v_smfmac_f32_16x16x64_bf16 v[20:23], v[28:31], v[56:63], v1
  ds_read_b128 v[56:59], v3 offset:18432
  ds_read_b128 v[60:63], v3 offset:19456
  v_smfmac_f32_16x16x64_bf16 v[16:19], v[28:31], a[56:63], v1
  s_waitcnt lgkmcnt(5)
  v_smfmac_f32_16x16x64_bf16 v[24:27], v[28:31], v[40:47], v1
  v_smfmac_f32_16x16x64_bf16 v[12:15], v[32:35], a[80:87], v1
  v_mov_b64 v[40:41], 0
  s_waitcnt lgkmcnt(3)
  v_smfmac_f32_16x16x64_bf16 v[20:23], v[32:35], v[48:55], v1
  v_smfmac_f32_16x16x64_bf16 v[16:19], v[32:35], a[88:95], v1
  v_mov_b64 v[42:43], 0
  s_waitcnt lgkmcnt(0)
  v_smfmac_f32_16x16x64_bf16 v[24:27], v[32:35], v[56:63], v1
  v_smfmac_f32_16x16x64_bf16 v[12:15], v[36:39], a[64:71], v1
  v_mov_b64 v[44:45], 0
  v_smfmac_f32_16x16x64_bf16 v[20:23], v[36:39], a[128:135], v1
  v_mov_b64 v[46:47], 0
  v_smfmac_f32_16x16x64_bf16 v[16:19], v[36:39], a[72:79], v1
  v_smfmac_f32_16x16x64_bf16 v[24:27], v[36:39], a[136:143], v1
  v_pk_add_f32 v[12:13], v[12:13], v[14:15]
  v_pk_add_f32 v[20:21], v[20:21], v[22:23]
  v_cvt_pk_bf16_f32 v23, v12, v13
  v_cvt_pk_bf16_f32 v22, v20, v21
  ds_write_b64 v5, v[22:23] offset:0
  v_pk_add_f32 v[16:17], v[16:17], v[18:19]
  s_nop 1
  v_pk_add_f32 v[24:25], v[24:25], v[26:27]
  v_cvt_pk_bf16_f32 v27, v16, v17
  v_cvt_pk_bf16_f32 v26, v24, v25
  ds_write_b64 v5, v[26:27] offset:512
  v_smfmac_f32_16x16x64_bf16 v[40:43], v[28:31], v[160:167], v1
  v_xor_b32 v52, 16, v6
  s_waitcnt vmcnt(3)
  ds_read_b128 v[60:63], v0 offset:3072
  v_smfmac_f32_16x16x64_bf16 v[44:47], v[28:31], v[168:175], v1
  ds_read_b128 v[28:31], v0 offset:20480
  ds_read_b128 v[48:51], v0 offset:7168
  v_smfmac_f32_16x16x64_bf16 v[40:43], v[32:35], v[192:199], v1
  v_smfmac_f32_16x16x64_bf16 v[44:47], v[32:35], v[200:207], v1
  ds_read_b128 v[32:35], v0 offset:21504
  v_smfmac_f32_16x16x64_bf16 v[40:43], v[36:39], v[176:183], v1
  s_waitcnt lgkmcnt(4)
  s_barrier
  ds_read_b64_tr_b16 v[12:13], v6 offset:3072
  ds_read_b64_tr_b16 v[14:15], v52 offset:3328
  ds_read_b64_tr_b16 v[16:17], v6 offset:0
  ds_read_b64_tr_b16 v[18:19], v52 offset:256
  v_smfmac_f32_16x16x64_bf16 v[44:47], v[36:39], v[184:191], v1
  ds_read_b64_tr_b16 v[20:21], v6 offset:1024
  ds_read_b64_tr_b16 v[22:23], v52 offset:1280
  s_waitcnt lgkmcnt(8)
  v_smfmac_f32_16x16x64_bf16 v[40:43], v[28:31], v[128:135], v1
  ds_read_b64_tr_b16 v[24:25], v6 offset:2048
  ds_read_b64_tr_b16 v[26:27], v52 offset:2304
  v_smfmac_f32_16x16x64_bf16 v[44:47], v[28:31], v[136:143], v1
  ds_read_b128 v[28:31], v0 offset:16384
  s_waitcnt lgkmcnt(9)
  v_smfmac_f32_16x16x64_bf16 v[40:43], v[32:35], v[144:151], v1
  v_smfmac_f32_16x16x64_bf16 v[44:47], v[32:35], v[152:159], v1
  ds_read_b128 v[32:35], v0 offset:18432
  s_waitcnt lgkmcnt(8)
  v_mfma_f32_16x16x32_bf16 v[56:59], v[60:63], v[12:15], 0
  ds_read_b128 v[36:39], v0 offset:0
  v_mfma_f32_16x16x32_bf16 v[60:63], v[48:51], v[12:15], 0
  ds_read_b128 v[48:51], v0 offset:4096
  v_mfma_f32_16x16x32_bf16 v[52:55], v[12:15], v[12:15], 0
  ds_read_b128 v[12:15], v0 offset:1024
  s_waitcnt lgkmcnt(9)
  v_mfma_f32_16x16x32_bf16 v[52:55], v[16:19], v[16:19], v[52:55]
  s_waitcnt lgkmcnt(2)
  v_mfma_f32_16x16x32_bf16 v[56:59], v[36:39], v[16:19], v[56:59]
  ds_read_b128 v[36:39], v0 offset:5120
  s_waitcnt lgkmcnt(2)
  v_mfma_f32_16x16x32_bf16 v[60:63], v[48:51], v[16:19], v[60:63]
  ds_read_b128 v[48:51], v0 offset:2048
  ds_read_b128 v[16:19], v0 offset:6144
  v_mfma_f32_16x16x32_bf16 v[52:55], v[20:23], v[20:23], v[52:55]
  s_waitcnt lgkmcnt(3)
  v_mfma_f32_16x16x32_bf16 v[56:59], v[12:15], v[20:23], v[56:59]
  s_waitcnt lgkmcnt(2)
  v_mfma_f32_16x16x32_bf16 v[60:63], v[36:39], v[20:23], v[60:63]
  s_waitcnt vmcnt(1)
  ds_read_b128 v[20:23], v0 offset:12288
  ds_read_b128 v[12:15], v0 offset:13312
  v_mfma_f32_16x16x32_bf16 v[52:55], v[24:27], v[24:27], v[52:55]
  s_waitcnt lgkmcnt(3)
  v_mfma_f32_16x16x32_bf16 v[56:59], v[48:51], v[24:27], v[56:59]
  s_waitcnt lgkmcnt(2)
  v_mfma_f32_16x16x32_bf16 v[60:63], v[16:19], v[24:27], v[60:63]
  v_smfmac_f32_16x16x64_bf16 v[40:43], v[28:31], v[64:71], v1
  buffer_store_dwordx4 v[24:27], v9, s[4:7], s49 offen offset:1024 sc1
  v_mov_b32 v36, 0x3f803f80
  v_mov_b32 v37, 0x3f803f80
  v_max3_f32 v48, v52, v53, v56
  v_max3_f32 v48, v48, v57, v58
  v_max3_f32 v48, v48, v59, v60
  v_max3_f32 v48, v48, v61, v62
  v_max_f32 v49, v48, v63
  v_max_f32 v48, v48, v63
  v_smfmac_f32_16x16x64_bf16 v[44:47], v[28:31], v[72:79], v1
  ds_read_b128 v[28:31], v0 offset:17408
  v_mov_b64 v[38:39], v[36:37]
  v_permlane32_swap_b32 v48, v49
  v_max_f32 v48, v48, v49
  v_mov_b32 v49, v48
  v_smfmac_f32_16x16x64_bf16 v[40:43], v[32:35], v[96:103], v1
  v_mov_b64 v[16:17], 0
  v_permlane16_swap_b32 v48, v49
  v_max_f32 v48, v48, v49
  v_mul_f32 v48, s47, v48
  v_pk_fma_f32 v[56:57], v[56:57], s[46:47], v[48:49] op_sel_hi:[1,0,0]
  v_pk_fma_f32 v[58:59], v[58:59], s[46:47], v[48:49] op_sel_hi:[1,0,0]
  v_pk_fma_f32 v[60:61], v[60:61], s[46:47], v[48:49] op_sel_hi:[1,0,0]
  v_pk_fma_f32 v[62:63], v[62:63], s[46:47], v[48:49] op_sel_hi:[1,0,0]
  v_pk_fma_f32 v[52:53], v[52:53], s[46:47], v[48:49] op_sel_hi:[1,0,0]
  v_smfmac_f32_16x16x64_bf16 v[44:47], v[32:35], v[104:111], v1
  ds_read_b128 v[32:35], v0 offset:19456
  v_exp_f32 v56, v56
  v_exp_f32 v57, v57
  s_waitcnt lgkmcnt(1)
  v_smfmac_f32_16x16x64_bf16 v[40:43], v[28:31], v[80:87], v1
  v_exp_f32 v58, v58
  v_exp_f32 v59, v59
  v_smfmac_f32_16x16x64_bf16 v[44:47], v[28:31], v[88:95], v1
  v_exp_f32 v60, v60
  v_exp_f32 v61, v61
  s_waitcnt lgkmcnt(0)
  v_smfmac_f32_16x16x64_bf16 v[40:43], v[32:35], v[112:119], v1
  v_exp_f32 v62, v62
  v_exp_f32 v63, v63
  v_smfmac_f32_16x16x64_bf16 v[44:47], v[32:35], v[120:127], v1
  v_exp_f32 v52, v52
  v_exp_f32 v53, v53
  ds_read_b128 v[28:31], v3 offset:32768
  ds_read_b128 v[32:35], v3 offset:33792
  v_mov_b64 v[18:19], 0
  v_cvt_pk_bf16_f32 v24, v56, v57
  v_cvt_pk_bf16_f32 v25, v58, v59
  v_cvt_pk_bf16_f32 v26, v60, v61
  v_cvt_pk_bf16_f32 v27, v62, v63
  v_cvt_pk_bf16_f32 v16, v52, v53
  v_cvt_pk_bf16_f32 v19, v52, v53
  v_mfma_f32_16x16x32_bf16 v[52:55], v[36:39], v[24:27], 0
  v_add_f32 v40, v40, v42
  v_add_f32 v41, v41, v43
  v_mfma_f32_16x16x32_bf16 v[56:59], v[20:23], v[24:27], 0
  v_add_f32 v44, v44, v46
  v_add_f32 v45, v45, v47
  v_mfma_f32_16x16x32_bf16 v[60:63], v[12:15], v[24:27], 0
  v_cvt_pk_bf16_f32 v40, v40, v41
  v_cvt_pk_bf16_f32 v41, v44, v45
  s_add_u32 s51, s49, 4194304
  v_lshrrev_b32 v50, 1, v0
  v_mfma_f32_16x16x16_bf16 v[52:55], v[36:37], v[16:17], v[52:55]
  v_mov_b64 v[44:45], 0
  v_mov_b64 v[46:47], 0
  v_mfma_f32_16x16x16_bf16 v[56:59], v[40:41], v[16:17], v[56:59]
  buffer_store_dwordx2 v[40:41], v50, s[4:7], s51 offen offset:1024 sc1
  v_mov_b64 v[12:13], 0
  v_mov_b64 v[14:15], 0
  v_mfma_f32_16x16x16_bf16 v[60:63], v[40:41], v[18:19], v[60:63]
  s_nop 0
  v_rcp_f32 v48, v52
  v_mov_b64 v[36:37], 0
  v_mov_b64 v[38:39], 0
  s_mov_b64 exec, s[52:53]
  v_pk_mul_f32 v[56:57], v[56:57], v[48:49] op_sel_hi:[1,0]
  v_pk_mul_f32 v[58:59], v[58:59], v[48:49] op_sel_hi:[1,0]
  v_cvt_pk_bf16_f32 v56, v56, v57
  v_cvt_pk_bf16_f32 v57, v58, v59
  ds_write_b64 v7, v[56:57] offset:0
  v_pk_mul_f32 v[60:61], v[60:61], v[48:49] op_sel_hi:[1,0]
  v_pk_mul_f32 v[62:63], v[62:63], v[48:49] op_sel_hi:[1,0]
  v_cvt_pk_bf16_f32 v60, v60, v61
  v_cvt_pk_bf16_f32 v61, v62, v63
  ds_write_b64 v7, v[60:61] offset:256
  s_mov_b64 exec, -1
  v_mov_b32 v58, 0
  v_mov_b32 v59, 0
  v_mov_b32 v56, 0
  v_mov_b32 v57, 0
  s_waitcnt lgkmcnt(0)
  s_barrier
  ds_read_b128 v[16:19], v4 offset:29696
  v_mov_b32 v60, 0
  ds_read_b128 v[40:43], v4 offset:30208
  v_mov_b32 v61, 0
  ds_read_b128 v[48:51], v4 offset:30720
  v_mov_b32 v62, 0
  ds_read_b128 v[52:55], v4 offset:31232
  v_mov_b32 v63, 0
  ds_read_b128 v[20:23], v3 offset:34816
  ds_read_b128 v[24:27], v3 offset:35840
  s_waitcnt lgkmcnt(5)
  v_smfmac_f32_16x16x64_bf16 v[44:47], v[16:19], a[160:167], v1
  s_waitcnt lgkmcnt(4)
  v_smfmac_f32_16x16x64_bf16 v[44:47], v[40:43], v[28:35], v1
  ds_read_b128 v[28:31], v3 offset:49152
  ds_read_b128 v[32:35], v3 offset:50176
  s_waitcnt lgkmcnt(5)
  v_smfmac_f32_16x16x64_bf16 v[44:47], v[48:51], a[168:175], v1
  s_waitcnt lgkmcnt(4)
  v_smfmac_f32_16x16x64_bf16 v[44:47], v[52:55], a[176:183], v1
  s_waitcnt lgkmcnt(2)
  v_smfmac_f32_16x16x64_bf16 v[12:15], v[16:19], v[20:27], v1
  ds_read_b128 v[20:23], v3 offset:51200
  ds_read_b128 v[24:27], v3 offset:52224
  v_smfmac_f32_16x16x64_bf16 v[12:15], v[40:43], a[184:191], v1
  s_nop 0
  v_cvt_pk_bf16_f32 v44, v44, v45
  v_cvt_pk_bf16_f32 v45, v46, v47
  v_smfmac_f32_16x16x64_bf16 v[12:15], v[48:51], a[192:199], v1
  v_bfi_b32 v44, 1, s54, v44
  v_bfi_b32 v45, 1, s54, v45
  buffer_store_dwordx2 v[44:45], v8, s[4:7], s89 offen sc1
  v_smfmac_f32_16x16x64_bf16 v[12:15], v[52:55], a[200:207], v1
  s_waitcnt lgkmcnt(2)
  v_smfmac_f32_16x16x64_bf16 v[36:39], v[16:19], v[28:35], v1
  ds_read_b128 v[28:31], v0 offset:29696
  ds_read_b128 v[32:35], v0 offset:30720
  v_smfmac_f32_16x16x64_bf16 v[36:39], v[40:43], a[208:215], v1
  s_nop 0
  v_cvt_pk_bf16_f32 v12, v12, v13
  v_cvt_pk_bf16_f32 v13, v14, v15
  v_smfmac_f32_16x16x64_bf16 v[36:39], v[48:51], a[216:223], v1
  v_bfi_b32 v12, 1, s54, v12
  v_bfi_b32 v13, 1, s54, v13
  buffer_store_dwordx2 v[12:13], v8, s[4:7], s90 offen sc1
  v_smfmac_f32_16x16x64_bf16 v[36:39], v[52:55], a[224:231], v1
  s_waitcnt lgkmcnt(2)
  v_smfmac_f32_16x16x64_bf16 v[56:59], v[16:19], v[20:27], v1
  v_smfmac_f32_16x16x64_bf16 v[56:59], v[40:43], a[232:239], v1
  s_nop 0
  v_cvt_pk_bf16_f32 v36, v36, v37
  v_cvt_pk_bf16_f32 v37, v38, v39
  v_smfmac_f32_16x16x64_bf16 v[56:59], v[48:51], a[240:247], v1
  v_bfi_b32 v36, 1, s54, v36
  v_bfi_b32 v37, 1, s54, v37
  buffer_store_dwordx2 v[36:37], v8, s[4:7], s91 offen sc1
  v_smfmac_f32_16x16x64_bf16 v[56:59], v[52:55], a[248:255], v1
  s_waitcnt lgkmcnt(1)
  v_smfmac_f32_16x16x64_bf16 v[60:63], v[28:31], a[144:151], v1
  s_waitcnt lgkmcnt(0)
  v_smfmac_f32_16x16x64_bf16 v[60:63], v[32:35], a[152:159], v1
  s_nop 0
  v_cvt_pk_bf16_f32 v56, v56, v57
  v_cvt_pk_bf16_f32 v57, v58, v59
  v_bfi_b32 v56, 1, s54, v56
  v_bfi_b32 v57, 1, s54, v57
  buffer_store_dwordx2 v[56:57], v8, s[4:7], s92 offen sc1
  s_nop 1
  v_pk_add_f32 v[60:61], v[60:61], v[62:63]
  v_cvt_pk_bf16_f32 v60, v60, v61
  v_bfi_b32 v60, 1, s54, v60
  buffer_store_dword v60, v8, s[4:7], s88 offen offset:0 sc1
  s_cmp_ge_u32 s32, 8
  s_cbranch_scc1 L_nored_c2s
  v_mov_b32 v51, -1
  buffer_store_dword v51, v10, s[4:7], s44 offen sc1
  s_waitcnt vmcnt(3)
  s_nop 3
  buffer_load_dwordx4 v[20:23], v0, s[4:7], s41 offen offset:0 sc1
  buffer_load_dwordx4 v[24:27], v0, s[4:7], s41 offen offset:1024 sc1
  buffer_load_dwordx4 v[28:31], v0, s[4:7], s41 offen offset:2048 sc1
  buffer_load_dwordx4 v[32:35], v0, s[4:7], s41 offen offset:3072 sc1
  s_nop 7
  s_nop 3
  v_bfe_u32 v48, v0, 4, 1
  v_lshlrev_b32 v48, 4, v48
  v_mov_b32 v49, 0x3f80
  v_lshlrev_b32 v49, v48, v49
  v_bfe_u32 v48, v0, 5, 3
  v_cmp_eq_u32 vcc, 0, v48
  s_nop 1
  v_cndmask_b32 v36, 0, v49, vcc
  v_cmp_eq_u32 vcc, 1, v48
  s_nop 1
  v_cndmask_b32 v37, 0, v49, vcc
  v_cmp_eq_u32 vcc, 2, v48
  s_nop 1
  v_cndmask_b32 v38, 0, v49, vcc
  v_cmp_eq_u32 vcc, 3, v48
  s_nop 1
  v_cndmask_b32 v39, 0, v49, vcc
  buffer_load_dwordx4 v[20:23], v0, s[4:7], s41 offen offset:0 sc1
  buffer_load_dwordx4 v[24:27], v0, s[4:7], s41 offen offset:1024 sc1
  buffer_load_dwordx4 v[28:31], v0, s[4:7], s41 offen offset:2048 sc1
  buffer_load_dwordx4 v[32:35], v0, s[4:7], s41 offen offset:3072 sc1
  s_waitcnt vmcnt(7)
  v_bitop3_b32 v48, v20, v21, s54 bitop3:0x7e
  v_bitop3_b32 v49, v22, v23, s54 bitop3:0x7e
  v_mfma_f32_16x16x32_bf16 v[40:43], v[20:23], v[36:39], 0
  v_or_b32 v50, v48, v49
  s_waitcnt vmcnt(6)
  v_bitop3_b32 v48, v24, v25, s54 bitop3:0x7e
  v_bitop3_b32 v49, v26, v27, s54 bitop3:0x7e
  v_mfma_f32_16x16x32_bf16 v[40:43], v[24:27], v[36:39], v[40:43]
  v_or3_b32 v50, v50, v48, v49
  s_waitcnt vmcnt(5)
  v_bitop3_b32 v48, v28, v29, s54 bitop3:0x7e
  v_bitop3_b32 v49, v30, v31, s54 bitop3:0x7e
  v_mfma_f32_16x16x32_bf16 v[40:43], v[28:31], v[36:39], v[40:43]
  v_or3_b32 v50, v50, v48, v49
  s_waitcnt vmcnt(4)
  v_bitop3_b32 v48, v32, v33, s54 bitop3:0x7e
  v_bitop3_b32 v49, v34, v35, s54 bitop3:0x7e
  v_mfma_f32_16x16x32_bf16 v[40:43], v[32:35], v[36:39], v[40:43]
  v_or3_b32 v50, v50, v48, v49
  v_and_b32 v50, 1, v50
  v_cmp_eq_u32 vcc, 1, v50
  s_nop 0
  s_cbranch_vccz L_okA_c2s
L_retA_c2s:
  s_add_u32 s50, s50, 1
  s_mov_b64 exec, vcc
  buffer_load_dwordx4 v[20:23], v0, s[4:7], s41 offen offset:0 sc1
  buffer_load_dwordx4 v[24:27], v0, s[4:7], s41 offen offset:1024 sc1
  buffer_load_dwordx4 v[28:31], v0, s[4:7], s41 offen offset:2048 sc1
  buffer_load_dwordx4 v[32:35], v0, s[4:7], s41 offen offset:3072 sc1
  s_mov_b64 exec, -1
  s_cmp_ge_u32 s50, 262144
  s_cbranch_scc1 L_chain_end
  s_waitcnt vmcnt(7)
  v_bitop3_b32 v48, v20, v21, s54 bitop3:0x7e
  v_bitop3_b32 v49, v22, v23, s54 bitop3:0x7e
  v_mfma_f32_16x16x32_bf16 v[40:43], v[20:23], v[36:39], 0
  v_or_b32 v50, v48, v49
  s_waitcnt vmcnt(6)
  v_bitop3_b32 v48, v24, v25, s54 bitop3:0x7e
  v_bitop3_b32 v49, v26, v27, s54 bitop3:0x7e
  v_mfma_f32_16x16x32_bf16 v[40:43], v[24:27], v[36:39], v[40:43]
  v_or3_b32 v50, v50, v48, v49
  s_waitcnt vmcnt(5)
  v_bitop3_b32 v48, v28, v29, s54 bitop3:0x7e
  v_bitop3_b32 v49, v30, v31, s54 bitop3:0x7e
  v_mfma_f32_16x16x32_bf16 v[40:43], v[28:31], v[36:39], v[40:43]
  v_or3_b32 v50, v50, v48, v49
  s_waitcnt vmcnt(4)
  v_bitop3_b32 v48, v32, v33, s54 bitop3:0x7e
  v_bitop3_b32 v49, v34, v35, s54 bitop3:0x7e
  v_mfma_f32_16x16x32_bf16 v[40:43], v[32:35], v[36:39], v[40:43]
  v_or3_b32 v50, v50, v48, v49
  v_and_b32 v50, 1, v50
  v_cmp_eq_u32 vcc, 1, v50
  s_nop 0
  s_cbranch_vccnz L_retA_c2s
L_okA_c2s:
  s_nop 2
  v_permlane32_swap_b32 v40, v42
  v_permlane32_swap_b32 v41, v43
  v_add_f32 v40, v40, v42
  v_add_f32 v41, v41, v43
  v_cvt_pk_bf16_f32 v40, v40, v41
  buffer_store_dword v40, v10, s[4:7], s42 offen sc1
  s_branch L_loop_c2s
L_nored_c2s:
  s_waitcnt vmcnt(0)
  s_branch L_loop_c2s
L_chain_w3:
  v_mov_b32 v12, v0
  v_lshlrev_b32 v0, 4, v12
  v_and_b32 v13, 15, v12
  v_lshrrev_b32 v14, 4, v12
  v_mov_b32 v1, 0x4444
  v_and_b32 v15, 2, v12
  v_cmp_ne_u32 vcc, 0, v15
  v_mov_b32 v16, 0xeeee
  s_nop 0
  v_cndmask_b32 v1, v1, v16, vcc
  v_add_u32 v2, 45056, v0
  v_add_u32 v3, 110592, v0
  v_and_b32 v16, 13, v13
  v_and_b32 v17, 1, v14
  v_lshl_add_u32 v16, v17, 1, v16
  v_lshrrev_b32 v18, 1, v14
  v_lshl_add_u32 v16, v18, 4, v16
  v_lshlrev_b32 v4, 4, v16
  v_lshrrev_b32 v16, 2, v13
  v_xor_b32 v19, v16, v14
  v_lshlrev_b32 v19, 3, v19
  v_lshl_add_u32 v19, v13, 5, v19
  v_add_u32 v5, 28672, v19
  v_lshl_add_u32 v19, v17, 2, v16
  v_lshl_add_u32 v19, v18, 4, v19
  v_lshlrev_b32 v19, 5, v19
  v_and_b32 v20, 3, v13
  v_xor_b32 v20, v20, v17
  v_lshl_add_u32 v6, v20, 3, v19
  v_add_u32 v6, 25600, v6
  v_and_b32 v19, 13, v13
  v_lshl_add_u32 v19, v18, 1, v19
  v_lshlrev_b32 v19, 4, v19
  v_lshl_add_u32 v19, v17, 3, v19
  v_add_u32 v7, 31232, v19
  s_lshl_b32 s34, s32, 7
  v_and_b32 v19, 7, v13
  v_lshlrev_b32 v19, 4, v19
  v_lshrrev_b32 v20, 3, v13
  v_lshl_add_u32 v19, v20, 3, v19
  v_lshl_add_u32 v19, v14, 12, v19
  v_add_u32 v8, s34, v19
  v_and_b32 v19, 0x3c0, v0
  v_lshrrev_b32 v19, 1, v19
  v_and_b32 v20, 0x10, v0
  v_or_b32 v19, v19, v20
  v_and_b32 v20, 0x20, v0
  v_lshl_or_b32 v9, v20, 26, v19
  s_add_u32 s34, s32, 96
  s_mov_b32 s36, 8
  s_lshl_b32 s41, s34, 12
  s_add_u32 s41, s41, 65536
  s_lshl_b32 s35, s34, 7
  v_bfe_u32 v19, v13, 1, 1
  v_lshlrev_b32 v19, 6, v19
  v_and_b32 v20, 1, v13
  v_lshl_add_u32 v19, v20, 5, v19
  v_lshl_add_u32 v19, v16, 4, v19
  v_lshl_add_u32 v19, v17, 3, v19
  v_lshl_add_u32 v19, v18, 2, v19
  v_add_u32 v19, s35, v19
  v_mov_b32 v20, 0x80000000
  v_cmp_gt_u32 vcc, s36, v13
  s_nop 1
  v_cndmask_b32 v10, v20, v19, vcc
  v_lshlrev_b32 v19, 9, v18
  v_lshl_add_u32 v19, v16, 7, v19
  v_lshl_add_u32 v19, v17, 6, v19
  v_and_b32 v20, 1, v13
  v_lshl_add_u32 v19, v20, 5, v19
  v_and_b32 v20, 2, v13
  v_lshl_add_u32 v19, v20, 3, v19
  v_add_u32 v11, 6144, v19
  s_mov_b32 s42, 664576
  s_mov_b32 s43, 655360
  s_mov_b32 s44, 673792
  v_mov_b64 v[44:45], -1
  v_mov_b64 v[46:47], -1
  s_mov_b32 s40, 0
  s_mov_b32 s54, 0
  s_mov_b32 s46, 0x3e0293ee
  s_mov_b32 s47, 0xbe0293ee
  s_mov_b32 s52, 0xcccccccc
  s_mov_b32 s53, 0xcccccccc
  s_lshl_b32 s48, s32, 13
  s_add_u32 s48, s48, 35651584
  s_add_u32 s93, s48, 17043456
  s_lshl_b32 s49, s32, 11
  s_add_u32 s49, s49, 10485760
  s_mov_b32 s60, 0
  s_mov_b32 s88, 278528
  s_mov_b32 s89, 294912
  s_mov_b32 s90, 311296
  s_mov_b32 s91, 327680
  s_mov_b32 s92, 344064
  s_mov_b32 s80, 0
  s_mov_b32 s81, 0
  s_mov_b32 s82, 0
  s_mov_b32 s83, 0
  s_mov_b32 s84, 0
  s_mov_b32 s85, 0
  s_mov_b32 s86, 0
  s_mov_b32 s87, 0
  v_lshrrev_b32 v12, 4, v0
  v_lshrrev_b32 v13, 4, v12
  v_and_b32 v14, 15, v12
  v_and_b32 v15, 1, v13
  v_lshlrev_b32 v15, 1, v15
  v_xor_b32 v14, v14, v15
  s_lshl_b32 s34, s32, 8
  s_add_u32 s34, s34, 393216
  v_lshlrev_b32 v15, 13, v13
  v_lshl_add_u32 v15, v14, 4, v15
  v_add_u32 v56, s34, v15
  v_xor_b32 v57, 64, v56
  v_xor_b32 v58, 128, v56
  v_xor_b32 v59, 192, v56
  v_and_b32 v14, 3, v12
  v_lshrrev_b32 v15, 5, v12
  v_bfe_u32 v16, v12, 4, 1
  v_bfe_u32 v17, v12, 2, 1
  v_bfe_u32 v18, v12, 3, 1
  v_lshl_add_u32 v19, v16, 2, v17
  v_lshl_add_u32 v20, v15, 4, v19
  v_lshl_add_u32 v20, v18, 3, v20
  v_lshl_add_u32 v21, v16, 1, v17
  v_lshl_add_u32 v21, v18, 2, v21
  v_lshlrev_b32 v21, 1, v21
  v_lshrrev_b32 v22, 1, v14
  v_add_u32 v22, 12, v22
  v_xor_b32 v22, v22, v21
  v_lshlrev_b32 v22, 4, v22
  v_lshl_add_u32 v22, v20, 8, v22
  v_and_b32 v23, 1, v12
  v_lshl_add_u32 v52, v23, 3, v22
  v_xor_b32 v53, 32, v52
  v_mul_u32_u24 v20, 1152, v20
  v_lshl_add_u32 v20, v14, 3, v20
  v_add_u32 v61, 864, v20
  v_lshl_add_u32 v20, v15, 3, v19
  v_mul_u32_u24 v20, 1152, v20
  v_lshl_add_u32 v20, v18, 5, v20
  v_lshl_add_u32 v60, v14, 3, v20
  s_mul_i32 s61, s32, 147456
  s_add_u32 s61, s61, 27648
  s_mov_b32 m0, 27648
  s_add_u32 s51, s61, 0
  buffer_load_dwordx4 v0, s[24:27], s51 offen offset:0 lds
  buffer_load_dwordx4 v0, s[24:27], s51 offen offset:1024 lds
  buffer_load_dwordx4 v0, s[24:27], s51 offen offset:2048 lds
  buffer_load_dwordx4 v0, s[24:27], s51 offen offset:3072 lds
  s_mov_b32 m0, 31744
  s_add_u32 s51, s61, 4096
  buffer_load_dwordx4 v0, s[24:27], s51 offen offset:0 lds
  buffer_load_dwordx4 v0, s[24:27], s51 offen offset:1024 lds
  buffer_load_dwordx4 v0, s[24:27], s51 offen offset:2048 lds
  buffer_load_dwordx4 v0, s[24:27], s51 offen offset:3072 lds
  s_mov_b32 m0, 35840
  s_add_u32 s51, s61, 8192
  buffer_load_dwordx4 v0, s[24:27], s51 offen offset:0 lds
  s_mov_b32 m0, 64512
  s_add_u32 s51, s61, 36864
  buffer_load_dwordx4 v0, s[24:27], s51 offen offset:0 lds
  buffer_load_dwordx4 v0, s[24:27], s51 offen offset:1024 lds
  buffer_load_dwordx4 v0, s[24:27], s51 offen offset:2048 lds
  buffer_load_dwordx4 v0, s[24:27], s51 offen offset:3072 lds
  s_mov_b32 m0, 68608
  s_add_u32 s51, s61, 40960
  buffer_load_dwordx4 v0, s[24:27], s51 offen offset:0 lds
  buffer_load_dwordx4 v0, s[24:27], s51 offen offset:1024 lds
  buffer_load_dwordx4 v0, s[24:27], s51 offen offset:2048 lds
  buffer_load_dwordx4 v0, s[24:27], s51 offen offset:3072 lds
  s_mov_b32 m0, 72704
  s_add_u32 s51, s61, 45056
  buffer_load_dwordx4 v0, s[24:27], s51 offen offset:0 lds
  s_mov_b32 m0, 101376
  s_add_u32 s51, s61, 73728
  buffer_load_dwordx4 v0, s[24:27], s51 offen offset:0 lds
  buffer_load_dwordx4 v0, s[24:27], s51 offen offset:1024 lds
  buffer_load_dwordx4 v0, s[24:27], s51 offen offset:2048 lds
  buffer_load_dwordx4 v0, s[24:27], s51 offen offset:3072 lds
  s_mov_b32 m0, 105472
  s_add_u32 s51, s61, 77824
  buffer_load_dwordx4 v0, s[24:27], s51 offen offset:0 lds
  buffer_load_dwordx4 v0, s[24:27], s51 offen offset:1024 lds
  buffer_load_dwordx4 v0, s[24:27], s51 offen offset:2048 lds
  buffer_load_dwordx4 v0, s[24:27], s51 offen offset:3072 lds
  s_mov_b32 m0, 109568
  s_add_u32 s51, s61, 81920
  buffer_load_dwordx4 v0, s[24:27], s51 offen offset:0 lds
  s_mov_b32 m0, 138240
  s_add_u32 s51, s61, 110592
  buffer_load_dwordx4 v0, s[24:27], s51 offen offset:0 lds
  buffer_load_dwordx4 v0, s[24:27], s51 offen offset:1024 lds
  buffer_load_dwordx4 v0, s[24:27], s51 offen offset:2048 lds
  buffer_load_dwordx4 v0, s[24:27], s51 offen offset:3072 lds
  s_mov_b32 m0, 142336
  s_add_u32 s51, s61, 114688
  buffer_load_dwordx4 v0, s[24:27], s51 offen offset:0 lds
  buffer_load_dwordx4 v0, s[24:27], s51 offen offset:1024 lds
  buffer_load_dwordx4 v0, s[24:27], s51 offen offset:2048 lds
  buffer_load_dwordx4 v0, s[24:27], s51 offen offset:3072 lds
  s_mov_b32 m0, 146432
  s_add_u32 s51, s61, 118784
  buffer_load_dwordx4 v0, s[24:27], s51 offen offset:0 lds
  s_mov_b32 m0, 159744
  s_mov_b32 s51, 0
  buffer_load_dwordx4 v56, s[20:23], s51 offen lds
  s_mov_b32 m0, 160768
  s_mov_b32 s51, 32768
  buffer_load_dwordx4 v57, s[20:23], s51 offen lds
  s_mov_b32 m0, 161792
  s_mov_b32 s51, 65536
  buffer_load_dwordx4 v58, s[20:23], s51 offen lds
  s_mov_b32 m0, 162816
  s_mov_b32 s51, 98304
  buffer_load_dwordx4 v59, s[20:23], s51 offen lds
  s_waitcnt vmcnt(31)
  s_barrier
  v_add_u32 v54, 0, v60
  v_add_u32 v55, 0, v61
  ds_read_b64_tr_b16 a[160:161], v54 offset:896
  ds_read_b64_tr_b16 a[162:163], v54 offset:3200
  ds_read_b64_tr_b16 a[164:165], v54 offset:19328
  ds_read_b64_tr_b16 a[166:167], v54 offset:21632
  ds_read_b64_tr_b16 v[20:21], v54 offset:960
  ds_read_b64_tr_b16 v[22:23], v54 offset:3264
  ds_read_b64_tr_b16 v[24:25], v54 offset:19392
  ds_read_b64_tr_b16 v[26:27], v54 offset:21696
  ds_read_b64_tr_b16 v[28:29], v54 offset:1024
  ds_read_b64_tr_b16 v[30:31], v54 offset:3328
  ds_read_b64_tr_b16 v[32:33], v54 offset:19456
  ds_read_b64_tr_b16 v[34:35], v54 offset:21760
  ds_read_b64_tr_b16 v[36:37], v54 offset:1088
  ds_read_b64_tr_b16 v[38:39], v54 offset:3392
  ds_read_b64_tr_b16 v[40:41], v54 offset:19520
  ds_read_b64_tr_b16 v[42:43], v54 offset:21824
  ds_read_b64_tr_b16 a[144:145], v55 offset:0
  ds_read_b64_tr_b16 a[146:147], v55 offset:2304
  s_waitcnt lgkmcnt(0)
  s_waitcnt vmcnt(22)
  s_barrier
  s_mov_b32 m0, 12288
  s_mov_b32 s51, 0
  buffer_load_dwordx4 v56, s[12:15], s51 offen lds
  s_mov_b32 m0, 13312
  s_mov_b32 s51, 32768
  buffer_load_dwordx4 v57, s[12:15], s51 offen lds
  s_mov_b32 m0, 14336
  s_mov_b32 s51, 65536
  buffer_load_dwordx4 v58, s[12:15], s51 offen lds
  s_mov_b32 m0, 15360
  s_mov_b32 s51, 98304
  buffer_load_dwordx4 v59, s[12:15], s51 offen lds
  s_mov_b32 m0, 28672
  s_mov_b32 s51, 524288
  buffer_load_dwordx4 v56, s[20:23], s51 offen lds
  s_mov_b32 m0, 29696
  s_mov_b32 s51, 557056
  buffer_load_dwordx4 v57, s[20:23], s51 offen lds
  s_mov_b32 m0, 30720
  s_mov_b32 s51, 589824
  buffer_load_dwordx4 v58, s[20:23], s51 offen lds
  s_mov_b32 m0, 31744
  s_mov_b32 s51, 622592
  buffer_load_dwordx4 v59, s[20:23], s51 offen lds
  v_add_u32 v54, 36864, v60
  v_add_u32 v55, 36864, v61
  ds_read_b64_tr_b16 v[12:13], v54 offset:896
  ds_read_b64_tr_b16 v[14:15], v54 offset:3200
  ds_read_b64_tr_b16 v[16:17], v54 offset:19328
  ds_read_b64_tr_b16 v[18:19], v54 offset:21632
  ds_read_b64_tr_b16 a[184:185], v54 offset:960
  ds_read_b64_tr_b16 a[186:187], v54 offset:3264
  ds_read_b64_tr_b16 a[188:189], v54 offset:19392
  ds_read_b64_tr_b16 a[190:191], v54 offset:21696
  ds_read_b64_tr_b16 a[208:209], v54 offset:1024
  ds_read_b64_tr_b16 a[210:211], v54 offset:3328
  ds_read_b64_tr_b16 a[212:213], v54 offset:19456
  ds_read_b64_tr_b16 a[214:215], v54 offset:21760
  ds_read_b64_tr_b16 a[232:233], v54 offset:1088
  ds_read_b64_tr_b16 a[234:235], v54 offset:3392
  ds_read_b64_tr_b16 a[236:237], v54 offset:19520
  ds_read_b64_tr_b16 a[238:239], v54 offset:21824
  ds_read_b64_tr_b16 a[148:149], v55 offset:0
  ds_read_b64_tr_b16 a[150:151], v55 offset:2304
  s_waitcnt lgkmcnt(0)
  s_waitcnt vmcnt(21)
  s_barrier
  s_mov_b32 m0, 45056
  s_mov_b32 s51, 0
  buffer_load_dwordx4 v56, s[16:19], s51 offen lds
  s_mov_b32 m0, 46080
  s_mov_b32 s51, 32768
  buffer_load_dwordx4 v57, s[16:19], s51 offen lds
  s_mov_b32 m0, 47104
  s_mov_b32 s51, 65536
  buffer_load_dwordx4 v58, s[16:19], s51 offen lds
  s_mov_b32 m0, 48128
  s_mov_b32 s51, 98304
  buffer_load_dwordx4 v59, s[16:19], s51 offen lds
  s_mov_b32 m0, 61440
  s_mov_b32 s51, 1048576
  buffer_load_dwordx4 v56, s[16:19], s51 offen lds
  s_mov_b32 m0, 62464
  s_mov_b32 s51, 1081344
  buffer_load_dwordx4 v57, s[16:19], s51 offen lds
  s_mov_b32 m0, 63488
  s_mov_b32 s51, 1114112
  buffer_load_dwordx4 v58, s[16:19], s51 offen lds
  s_mov_b32 m0, 64512
  s_mov_b32 s51, 1146880
  buffer_load_dwordx4 v59, s[16:19], s51 offen lds
  v_add_u32 v54, 73728, v60
  v_add_u32 v55, 73728, v61
  ds_read_b64_tr_b16 a[168:169], v54 offset:896
  ds_read_b64_tr_b16 a[170:171], v54 offset:3200
  ds_read_b64_tr_b16 a[172:173], v54 offset:19328
  ds_read_b64_tr_b16 a[174:175], v54 offset:21632
  ds_read_b64_tr_b16 a[192:193], v54 offset:960
  ds_read_b64_tr_b16 a[194:195], v54 offset:3264
  ds_read_b64_tr_b16 a[196:197], v54 offset:19392
  ds_read_b64_tr_b16 a[198:199], v54 offset:21696
  ds_read_b64_tr_b16 a[216:217], v54 offset:1024
  ds_read_b64_tr_b16 a[218:219], v54 offset:3328
  ds_read_b64_tr_b16 a[220:221], v54 offset:19456
  ds_read_b64_tr_b16 a[222:223], v54 offset:21760
  ds_read_b64_tr_b16 a[240:241], v54 offset:1088
  ds_read_b64_tr_b16 a[242:243], v54 offset:3392
  ds_read_b64_tr_b16 a[244:245], v54 offset:19520
  ds_read_b64_tr_b16 a[246:247], v54 offset:21824
  ds_read_b64_tr_b16 a[152:153], v55 offset:0
  ds_read_b64_tr_b16 a[154:155], v55 offset:2304
  s_waitcnt lgkmcnt(0)
  s_waitcnt vmcnt(20)
  s_barrier
  s_mov_b32 m0, 77824
  s_mov_b32 s51, 524288
  buffer_load_dwordx4 v56, s[12:15], s51 offen lds
  s_mov_b32 m0, 78848
  s_mov_b32 s51, 557056
  buffer_load_dwordx4 v57, s[12:15], s51 offen lds
  s_mov_b32 m0, 79872
  s_mov_b32 s51, 589824
  buffer_load_dwordx4 v58, s[12:15], s51 offen lds
  s_mov_b32 m0, 80896
  s_mov_b32 s51, 622592
  buffer_load_dwordx4 v59, s[12:15], s51 offen lds
  s_mov_b32 m0, 94208
  s_mov_b32 s51, 524288
  buffer_load_dwordx4 v56, s[16:19], s51 offen lds
  s_mov_b32 m0, 95232
  s_mov_b32 s51, 557056
  buffer_load_dwordx4 v57, s[16:19], s51 offen lds
  s_mov_b32 m0, 96256
  s_mov_b32 s51, 589824
  buffer_load_dwordx4 v58, s[16:19], s51 offen lds
  s_mov_b32 m0, 97280
  s_mov_b32 s51, 622592
  buffer_load_dwordx4 v59, s[16:19], s51 offen lds
  v_add_u32 v54, 110592, v60
  v_add_u32 v55, 110592, v61
  ds_read_b64_tr_b16 a[176:177], v54 offset:896
  ds_read_b64_tr_b16 a[178:179], v54 offset:3200
  ds_read_b64_tr_b16 a[180:181], v54 offset:19328
  ds_read_b64_tr_b16 a[182:183], v54 offset:21632
  ds_read_b64_tr_b16 a[200:201], v54 offset:960
  ds_read_b64_tr_b16 a[202:203], v54 offset:3264
  ds_read_b64_tr_b16 a[204:205], v54 offset:19392
  ds_read_b64_tr_b16 a[206:207], v54 offset:21696
  ds_read_b64_tr_b16 a[224:225], v54 offset:1024
  ds_read_b64_tr_b16 a[226:227], v54 offset:3328
  ds_read_b64_tr_b16 a[228:229], v54 offset:19456
  ds_read_b64_tr_b16 a[230:231], v54 offset:21760
  ds_read_b64_tr_b16 a[248:249], v54 offset:1088
  ds_read_b64_tr_b16 a[250:251], v54 offset:3392
  ds_read_b64_tr_b16 a[252:253], v54 offset:19520
  ds_read_b64_tr_b16 a[254:255], v54 offset:21824
  ds_read_b64_tr_b16 a[156:157], v55 offset:0
  ds_read_b64_tr_b16 a[158:159], v55 offset:2304
  s_waitcnt lgkmcnt(0)
  s_waitcnt vmcnt(24)
  s_barrier
  s_mov_b32 m0, 110592
  s_mov_b32 s51, 1048576
  buffer_load_dwordx4 v56, s[20:23], s51 offen lds
  s_mov_b32 m0, 111616
  s_mov_b32 s51, 1081344
  buffer_load_dwordx4 v57, s[20:23], s51 offen lds
  s_mov_b32 m0, 112640
  s_mov_b32 s51, 1114112
  buffer_load_dwordx4 v58, s[20:23], s51 offen lds
  s_mov_b32 m0, 113664
  s_mov_b32 s51, 1146880
  buffer_load_dwordx4 v59, s[20:23], s51 offen lds
  s_mov_b32 m0, 126976
  s_mov_b32 s51, 1048576
  buffer_load_dwordx4 v56, s[12:15], s51 offen lds
  s_mov_b32 m0, 128000
  s_mov_b32 s51, 1081344
  buffer_load_dwordx4 v57, s[12:15], s51 offen lds
  s_mov_b32 m0, 129024
  s_mov_b32 s51, 1114112
  buffer_load_dwordx4 v58, s[12:15], s51 offen lds
  s_mov_b32 m0, 130048
  s_mov_b32 s51, 1146880
  buffer_load_dwordx4 v59, s[12:15], s51 offen lds
  s_mov_b32 m0, 143360
  s_mov_b32 s51, 1572864
  buffer_load_dwordx4 v56, s[20:23], s51 offen lds
  s_mov_b32 m0, 144384
  s_mov_b32 s51, 1605632
  buffer_load_dwordx4 v57, s[20:23], s51 offen lds
  s_mov_b32 m0, 145408
  s_mov_b32 s51, 1638400
  buffer_load_dwordx4 v58, s[20:23], s51 offen lds
  s_mov_b32 m0, 146432
  s_mov_b32 s51, 1671168
  buffer_load_dwordx4 v59, s[20:23], s51 offen lds
  v_add_u32 v54, 147456, v52
  v_add_u32 v55, 147456, v53
  ds_read_b64_tr_b16 v[64:65], v54 offset:0
  ds_read_b64_tr_b16 v[66:67], v54 offset:512
  ds_read_b64_tr_b16 v[68:69], v54 offset:8192
  ds_read_b64_tr_b16 v[70:71], v54 offset:8704
  ds_read_b64_tr_b16 v[72:73], v55 offset:0
  ds_read_b64_tr_b16 v[74:75], v55 offset:512
  ds_read_b64_tr_b16 v[76:77], v55 offset:8192
  ds_read_b64_tr_b16 v[78:79], v55 offset:8704
  s_waitcnt lgkmcnt(0)
  s_waitcnt vmcnt(32)
  s_barrier
  s_mov_b32 m0, 159744
  s_mov_b32 s51, 1572864
  buffer_load_dwordx4 v56, s[12:15], s51 offen lds
  s_mov_b32 m0, 160768
  s_mov_b32 s51, 1605632
  buffer_load_dwordx4 v57, s[12:15], s51 offen lds
  s_mov_b32 m0, 161792
  s_mov_b32 s51, 1638400
  buffer_load_dwordx4 v58, s[12:15], s51 offen lds
  s_mov_b32 m0, 162816
  s_mov_b32 s51, 1671168
  buffer_load_dwordx4 v59, s[12:15], s51 offen lds
  v_add_u32 v54, 0, v52
  v_add_u32 v55, 0, v53
  ds_read_b64_tr_b16 v[208:209], v54 offset:0
  ds_read_b64_tr_b16 v[210:211], v54 offset:512
  ds_read_b64_tr_b16 v[212:213], v54 offset:8192
  ds_read_b64_tr_b16 v[214:215], v54 offset:8704
  ds_read_b64_tr_b16 v[216:217], v55 offset:0
  ds_read_b64_tr_b16 v[218:219], v55 offset:512
  ds_read_b64_tr_b16 v[220:221], v55 offset:8192
  ds_read_b64_tr_b16 v[222:223], v55 offset:8704
  s_waitcnt lgkmcnt(0)
  s_waitcnt vmcnt(32)
  s_barrier
  s_mov_b32 m0, 12288
  s_mov_b32 s51, 2097152
  buffer_load_dwordx4 v56, s[20:23], s51 offen lds
  s_mov_b32 m0, 13312
  s_mov_b32 s51, 2129920
  buffer_load_dwordx4 v57, s[20:23], s51 offen lds
  s_mov_b32 m0, 14336
  s_mov_b32 s51, 2162688
  buffer_load_dwordx4 v58, s[20:23], s51 offen lds
  s_mov_b32 m0, 15360
  s_mov_b32 s51, 2195456
  buffer_load_dwordx4 v59, s[20:23], s51 offen lds
  v_add_u32 v54, 16384, v52
  v_add_u32 v55, 16384, v53
  ds_read_b64_tr_b16 v[80:81], v54 offset:0
  ds_read_b64_tr_b16 v[82:83], v54 offset:512
  ds_read_b64_tr_b16 v[84:85], v54 offset:8192
  ds_read_b64_tr_b16 v[86:87], v54 offset:8704
  ds_read_b64_tr_b16 v[88:89], v55 offset:0
  ds_read_b64_tr_b16 v[90:91], v55 offset:512
  ds_read_b64_tr_b16 v[92:93], v55 offset:8192
  ds_read_b64_tr_b16 v[94:95], v55 offset:8704
  s_waitcnt lgkmcnt(0)
  s_waitcnt vmcnt(32)
  s_barrier
  s_mov_b32 m0, 28672
  s_mov_b32 s51, 2097152
  buffer_load_dwordx4 v56, s[12:15], s51 offen lds
  s_mov_b32 m0, 29696
  s_mov_b32 s51, 2129920
  buffer_load_dwordx4 v57, s[12:15], s51 offen lds
  s_mov_b32 m0, 30720
  s_mov_b32 s51, 2162688
  buffer_load_dwordx4 v58, s[12:15], s51 offen lds
  s_mov_b32 m0, 31744
  s_mov_b32 s51, 2195456
  buffer_load_dwordx4 v59, s[12:15], s51 offen lds
  v_add_u32 v54, 32768, v52
  v_add_u32 v55, 32768, v53
  ds_read_b64_tr_b16 v[192:193], v54 offset:0
  ds_read_b64_tr_b16 v[194:195], v54 offset:512
  ds_read_b64_tr_b16 v[196:197], v54 offset:8192
  ds_read_b64_tr_b16 v[198:199], v54 offset:8704
  ds_read_b64_tr_b16 v[200:201], v55 offset:0
  ds_read_b64_tr_b16 v[202:203], v55 offset:512
  ds_read_b64_tr_b16 v[204:205], v55 offset:8192
  ds_read_b64_tr_b16 v[206:207], v55 offset:8704
  s_waitcnt lgkmcnt(0)
  s_barrier
  ds_write_b128 v2, v[192:195] offset:0
  ds_write_b128 v2, v[196:199] offset:1024
  ds_write_b128 v2, v[200:203] offset:2048
  ds_write_b128 v2, v[204:207] offset:3072
  s_waitcnt vmcnt(32)
  s_barrier
  v_add_u32 v54, 49152, v52
  v_add_u32 v55, 49152, v53
  ds_read_b64_tr_b16 v[192:193], v54 offset:0
  ds_read_b64_tr_b16 v[194:195], v54 offset:512
  ds_read_b64_tr_b16 v[196:197], v54 offset:8192
  ds_read_b64_tr_b16 v[198:199], v54 offset:8704
  ds_read_b64_tr_b16 v[200:201], v55 offset:0
  ds_read_b64_tr_b16 v[202:203], v55 offset:512
  ds_read_b64_tr_b16 v[204:205], v55 offset:8192
  ds_read_b64_tr_b16 v[206:207], v55 offset:8704
  s_waitcnt lgkmcnt(0)
  s_barrier
  ds_write_b128 v2, v[192:195] offset:16384
  ds_write_b128 v2, v[196:199] offset:17408
  ds_write_b128 v2, v[200:203] offset:18432
  ds_write_b128 v2, v[204:207] offset:19456
  s_waitcnt vmcnt(28)
  s_barrier
  v_add_u32 v54, 65536, v52
  v_add_u32 v55, 65536, v53
  ds_read_b64_tr_b16 v[224:225], v54 offset:0
  ds_read_b64_tr_b16 v[226:227], v54 offset:512
  ds_read_b64_tr_b16 v[228:229], v54 offset:8192
  ds_read_b64_tr_b16 v[230:231], v54 offset:8704
  ds_read_b64_tr_b16 v[232:233], v55 offset:0
  ds_read_b64_tr_b16 v[234:235], v55 offset:512
  ds_read_b64_tr_b16 v[236:237], v55 offset:8192
  ds_read_b64_tr_b16 v[238:239], v55 offset:8704
  s_waitcnt lgkmcnt(0)
  s_waitcnt vmcnt(24)
  s_barrier
  s_mov_b32 m0, 77824
  s_mov_b32 s51, 1572864
  buffer_load_dwordx4 v56, s[16:19], s51 offen lds
  s_mov_b32 m0, 78848
  s_mov_b32 s51, 1605632
  buffer_load_dwordx4 v57, s[16:19], s51 offen lds
  s_mov_b32 m0, 79872
  s_mov_b32 s51, 1638400
  buffer_load_dwordx4 v58, s[16:19], s51 offen lds
  s_mov_b32 m0, 80896
  s_mov_b32 s51, 1671168
  buffer_load_dwordx4 v59, s[16:19], s51 offen lds
  buffer_load_dwordx2 v[44:45], off, s[8:11], 0 offset:4 sc1
  v_add_u32 v54, 81920, v52
  v_add_u32 v55, 81920, v53
  ds_read_b64_tr_b16 a[96:97], v54 offset:0
  ds_read_b64_tr_b16 a[98:99], v54 offset:512
  ds_read_b64_tr_b16 a[100:101], v54 offset:8192
  ds_read_b64_tr_b16 a[102:103], v54 offset:8704
  ds_read_b64_tr_b16 a[104:105], v55 offset:0
  ds_read_b64_tr_b16 a[106:107], v55 offset:512
  ds_read_b64_tr_b16 a[108:109], v55 offset:8192
  ds_read_b64_tr_b16 a[110:111], v55 offset:8704
  s_waitcnt lgkmcnt(0)
  s_waitcnt vmcnt(25)
  s_barrier
  s_mov_b32 m0, 94208
  s_mov_b32 s51, 2621440
  buffer_load_dwordx4 v56, s[16:19], s51 offen lds
  s_mov_b32 m0, 95232
  s_mov_b32 s51, 2654208
  buffer_load_dwordx4 v57, s[16:19], s51 offen lds
  s_mov_b32 m0, 96256
  s_mov_b32 s51, 2686976
  buffer_load_dwordx4 v58, s[16:19], s51 offen lds
  s_mov_b32 m0, 97280
  s_mov_b32 s51, 2719744
  buffer_load_dwordx4 v59, s[16:19], s51 offen lds
  v_add_u32 v54, 98304, v52
  v_add_u32 v55, 98304, v53
  ds_read_b64_tr_b16 v[96:97], v54 offset:0
  ds_read_b64_tr_b16 v[98:99], v54 offset:512
  ds_read_b64_tr_b16 v[100:101], v54 offset:8192
  ds_read_b64_tr_b16 v[102:103], v54 offset:8704
  ds_read_b64_tr_b16 v[104:105], v55 offset:0
  ds_read_b64_tr_b16 v[106:107], v55 offset:512
  ds_read_b64_tr_b16 v[108:109], v55 offset:8192
  ds_read_b64_tr_b16 v[110:111], v55 offset:8704
  s_waitcnt lgkmcnt(0)
  s_waitcnt vmcnt(25)
  s_barrier
  s_mov_b32 m0, 110592
  s_mov_b32 s51, 3145728
  buffer_load_dwordx4 v56, s[16:19], s51 offen lds
  s_mov_b32 m0, 111616
  s_mov_b32 s51, 3178496
  buffer_load_dwordx4 v57, s[16:19], s51 offen lds
  s_mov_b32 m0, 112640
  s_mov_b32 s51, 3211264
  buffer_load_dwordx4 v58, s[16:19], s51 offen lds
  s_mov_b32 m0, 113664
  s_mov_b32 s51, 3244032
  buffer_load_dwordx4 v59, s[16:19], s51 offen lds
  v_add_u32 v54, 114688, v52
  v_add_u32 v55, 114688, v53
  ds_read_b64_tr_b16 v[240:241], v54 offset:0
  ds_read_b64_tr_b16 v[242:243], v54 offset:512
  ds_read_b64_tr_b16 v[244:245], v54 offset:8192
  ds_read_b64_tr_b16 v[246:247], v54 offset:8704
  ds_read_b64_tr_b16 v[248:249], v55 offset:0
  ds_read_b64_tr_b16 v[250:251], v55 offset:512
  ds_read_b64_tr_b16 v[252:253], v55 offset:8192
  ds_read_b64_tr_b16 v[254:255], v55 offset:8704
  s_waitcnt lgkmcnt(0)
  s_waitcnt vmcnt(25)
  s_barrier
  s_mov_b32 m0, 126976
  s_mov_b32 s51, 4194304
  buffer_load_dwordx4 v56, s[16:19], s51 offen lds
  s_mov_b32 m0, 128000
  s_mov_b32 s51, 4227072
  buffer_load_dwordx4 v57, s[16:19], s51 offen lds
  s_mov_b32 m0, 129024
  s_mov_b32 s51, 4259840
  buffer_load_dwordx4 v58, s[16:19], s51 offen lds
  s_mov_b32 m0, 130048
  s_mov_b32 s51, 4292608
  buffer_load_dwordx4 v59, s[16:19], s51 offen lds
  v_add_u32 v54, 131072, v52
  v_add_u32 v55, 131072, v53
  ds_read_b64_tr_b16 v[112:113], v54 offset:0
  ds_read_b64_tr_b16 v[114:115], v54 offset:512
  ds_read_b64_tr_b16 v[116:117], v54 offset:8192
  ds_read_b64_tr_b16 v[118:119], v54 offset:8704
  ds_read_b64_tr_b16 v[120:121], v55 offset:0
  ds_read_b64_tr_b16 v[122:123], v55 offset:512
  ds_read_b64_tr_b16 v[124:125], v55 offset:8192
  ds_read_b64_tr_b16 v[126:127], v55 offset:8704
  s_waitcnt lgkmcnt(0)
  s_waitcnt vmcnt(25)
  s_barrier
  s_mov_b32 m0, 143360
  s_mov_b32 s51, 2097152
  buffer_load_dwordx4 v56, s[16:19], s51 offen lds
  s_mov_b32 m0, 144384
  s_mov_b32 s51, 2129920
  buffer_load_dwordx4 v57, s[16:19], s51 offen lds
  s_mov_b32 m0, 145408
  s_mov_b32 s51, 2162688
  buffer_load_dwordx4 v58, s[16:19], s51 offen lds
  s_mov_b32 m0, 146432
  s_mov_b32 s51, 2195456
  buffer_load_dwordx4 v59, s[16:19], s51 offen lds
  v_add_u32 v54, 147456, v52
  v_add_u32 v55, 147456, v53
  ds_read_b64_tr_b16 a[0:1], v54 offset:0
  ds_read_b64_tr_b16 a[2:3], v54 offset:512
  ds_read_b64_tr_b16 a[4:5], v54 offset:8192
  ds_read_b64_tr_b16 a[6:7], v54 offset:8704
  ds_read_b64_tr_b16 a[8:9], v55 offset:0
  ds_read_b64_tr_b16 a[10:11], v55 offset:512
  ds_read_b64_tr_b16 a[12:13], v55 offset:8192
  ds_read_b64_tr_b16 a[14:15], v55 offset:8704
  s_waitcnt lgkmcnt(0)
  s_waitcnt vmcnt(25)
  s_barrier
  s_mov_b32 m0, 159744
  s_mov_b32 s51, 2621440
  buffer_load_dwordx4 v56, s[20:23], s51 offen lds
  s_mov_b32 m0, 160768
  s_mov_b32 s51, 2654208
  buffer_load_dwordx4 v57, s[20:23], s51 offen lds
  s_mov_b32 m0, 161792
  s_mov_b32 s51, 2686976
  buffer_load_dwordx4 v58, s[20:23], s51 offen lds
  s_mov_b32 m0, 162816
  s_mov_b32 s51, 2719744
  buffer_load_dwordx4 v59, s[20:23], s51 offen lds
  v_add_u32 v54, 0, v52
  v_add_u32 v55, 0, v53
  ds_read_b64_tr_b16 v[128:129], v54 offset:0
  ds_read_b64_tr_b16 v[130:131], v54 offset:512
  ds_read_b64_tr_b16 v[132:133], v54 offset:8192
  ds_read_b64_tr_b16 v[134:135], v54 offset:8704
  ds_read_b64_tr_b16 v[136:137], v55 offset:0
  ds_read_b64_tr_b16 v[138:139], v55 offset:512
  ds_read_b64_tr_b16 v[140:141], v55 offset:8192
  ds_read_b64_tr_b16 v[142:143], v55 offset:8704
  s_waitcnt lgkmcnt(0)
  s_waitcnt vmcnt(25)
  s_barrier
  s_mov_b32 m0, 12288
  s_mov_b32 s51, 2621440
  buffer_load_dwordx4 v56, s[12:15], s51 offen lds
  s_mov_b32 m0, 13312
  s_mov_b32 s51, 2654208
  buffer_load_dwordx4 v57, s[12:15], s51 offen lds
  s_mov_b32 m0, 14336
  s_mov_b32 s51, 2686976
  buffer_load_dwordx4 v58, s[12:15], s51 offen lds
  s_mov_b32 m0, 15360
  s_mov_b32 s51, 2719744
  buffer_load_dwordx4 v59, s[12:15], s51 offen lds
  v_add_u32 v54, 16384, v52
  v_add_u32 v55, 16384, v53
  ds_read_b64_tr_b16 a[16:17], v54 offset:0
  ds_read_b64_tr_b16 a[18:19], v54 offset:512
  ds_read_b64_tr_b16 a[20:21], v54 offset:8192
  ds_read_b64_tr_b16 a[22:23], v54 offset:8704
  ds_read_b64_tr_b16 a[24:25], v55 offset:0
  ds_read_b64_tr_b16 a[26:27], v55 offset:512
  ds_read_b64_tr_b16 a[28:29], v55 offset:8192
  ds_read_b64_tr_b16 a[30:31], v55 offset:8704
  s_waitcnt lgkmcnt(0)
  s_waitcnt vmcnt(25)
  s_barrier
  s_mov_b32 m0, 28672
  s_mov_b32 s51, 3145728
  buffer_load_dwordx4 v56, s[20:23], s51 offen lds
  s_mov_b32 m0, 29696
  s_mov_b32 s51, 3178496
  buffer_load_dwordx4 v57, s[20:23], s51 offen lds
  s_mov_b32 m0, 30720
  s_mov_b32 s51, 3211264
  buffer_load_dwordx4 v58, s[20:23], s51 offen lds
  s_mov_b32 m0, 31744
  s_mov_b32 s51, 3244032
  buffer_load_dwordx4 v59, s[20:23], s51 offen lds
  v_add_u32 v54, 65536, v52
  v_add_u32 v55, 65536, v53
  ds_read_b64_tr_b16 v[192:193], v54 offset:0
  ds_read_b64_tr_b16 v[194:195], v54 offset:512
  ds_read_b64_tr_b16 v[196:197], v54 offset:8192
  ds_read_b64_tr_b16 v[198:199], v54 offset:8704
  ds_read_b64_tr_b16 v[200:201], v55 offset:0
  ds_read_b64_tr_b16 v[202:203], v55 offset:512
  ds_read_b64_tr_b16 v[204:205], v55 offset:8192
  ds_read_b64_tr_b16 v[206:207], v55 offset:8704
  s_waitcnt lgkmcnt(0)
  s_barrier
  ds_write_b128 v2, v[192:195] offset:32768
  ds_write_b128 v2, v[196:199] offset:33792
  ds_write_b128 v2, v[200:203] offset:34816
  ds_write_b128 v2, v[204:207] offset:35840
  s_waitcnt vmcnt(24)
  s_barrier
  v_add_u32 v54, 81920, v52
  v_add_u32 v55, 81920, v53
  ds_read_b64_tr_b16 v[192:193], v54 offset:0
  ds_read_b64_tr_b16 v[194:195], v54 offset:512
  ds_read_b64_tr_b16 v[196:197], v54 offset:8192
  ds_read_b64_tr_b16 v[198:199], v54 offset:8704
  ds_read_b64_tr_b16 v[200:201], v55 offset:0
  ds_read_b64_tr_b16 v[202:203], v55 offset:512
  ds_read_b64_tr_b16 v[204:205], v55 offset:8192
  ds_read_b64_tr_b16 v[206:207], v55 offset:8704
  s_waitcnt lgkmcnt(0)
  s_barrier
  ds_write_b128 v2, v[192:195] offset:49152
  ds_write_b128 v2, v[196:199] offset:50176
  ds_write_b128 v2, v[200:203] offset:51200
  ds_write_b128 v2, v[204:207] offset:52224
  s_waitcnt vmcnt(20)
  s_barrier
  v_add_u32 v54, 98304, v52
  v_add_u32 v55, 98304, v53
  ds_read_b64_tr_b16 v[192:193], v54 offset:0
  ds_read_b64_tr_b16 v[194:195], v54 offset:512
  ds_read_b64_tr_b16 v[196:197], v54 offset:8192
  ds_read_b64_tr_b16 v[198:199], v54 offset:8704
  ds_read_b64_tr_b16 v[200:201], v55 offset:0
  ds_read_b64_tr_b16 v[202:203], v55 offset:512
  ds_read_b64_tr_b16 v[204:205], v55 offset:8192
  ds_read_b64_tr_b16 v[206:207], v55 offset:8704
  s_waitcnt lgkmcnt(0)
  s_barrier
  ds_write_b128 v3, v[192:195] offset:0
  ds_write_b128 v3, v[196:199] offset:1024
  ds_write_b128 v3, v[200:203] offset:2048
  ds_write_b128 v3, v[204:207] offset:3072
  s_waitcnt vmcnt(16)
  s_barrier
  v_add_u32 v54, 114688, v52
  v_add_u32 v55, 114688, v53
  ds_read_b64_tr_b16 v[192:193], v54 offset:0
  ds_read_b64_tr_b16 v[194:195], v54 offset:512
  ds_read_b64_tr_b16 v[196:197], v54 offset:8192
  ds_read_b64_tr_b16 v[198:199], v54 offset:8704
  ds_read_b64_tr_b16 v[200:201], v55 offset:0
  ds_read_b64_tr_b16 v[202:203], v55 offset:512
  ds_read_b64_tr_b16 v[204:205], v55 offset:8192
  ds_read_b64_tr_b16 v[206:207], v55 offset:8704
  s_waitcnt lgkmcnt(0)
  s_barrier
  ds_write_b128 v3, v[192:195] offset:16384
  ds_write_b128 v3, v[196:199] offset:17408
  ds_write_b128 v3, v[200:203] offset:18432
  ds_write_b128 v3, v[204:207] offset:19456
  s_waitcnt vmcnt(12)
L_cwait_89:
  v_readfirstlane_b32 s96, v44
  v_readfirstlane_b32 s97, v45
  s_add_u32 s50, s50, 1
  s_cmp_ge_u32 s50, 262144
  s_cbranch_scc1 L_cwait_89_x
  s_lshl_b32 s96, s96, 8
  s_add_u32 s96, s96, s97
  s_cmp_eq_u32 s96, 2592
  s_cbranch_scc1 L_cwait_89_x
  buffer_load_dwordx2 v[44:45], off, s[8:11], 0 offset:4 sc1
  s_waitcnt vmcnt(0)
  s_branch L_cwait_89
L_cwait_89_x:
  s_lshl_b32 s61, s32, 7
  s_add_u32 s94, s61, 6144
  s_add_u32 s61, s61, 0
  s_barrier
  buffer_load_dword v48, off, s[8:11], 0 offset:128 sc1
  buffer_load_dwordx4 v[192:195], off, s[4:7], s61 sc1
  v_add_u32 v54, 131072, v52
  v_add_u32 v55, 131072, v53
  ds_read_b64_tr_b16 a[112:113], v54 offset:0
  ds_read_b64_tr_b16 a[114:115], v54 offset:512
  ds_read_b64_tr_b16 a[116:117], v54 offset:8192
  ds_read_b64_tr_b16 a[118:119], v54 offset:8704
  ds_read_b64_tr_b16 a[120:121], v55 offset:0
  ds_read_b64_tr_b16 a[122:123], v55 offset:512
  ds_read_b64_tr_b16 a[124:125], v55 offset:8192
  ds_read_b64_tr_b16 a[126:127], v55 offset:8704
  s_waitcnt lgkmcnt(0)
  s_waitcnt vmcnt(10)
  s_barrier
  s_mov_b32 m0, 143360
  s_mov_b32 s51, 3145728
  buffer_load_dwordx4 v56, s[12:15], s51 offen lds
  s_mov_b32 m0, 144384
  s_mov_b32 s51, 3178496
  buffer_load_dwordx4 v57, s[12:15], s51 offen lds
  s_mov_b32 m0, 145408
  s_mov_b32 s51, 3211264
  buffer_load_dwordx4 v58, s[12:15], s51 offen lds
  s_mov_b32 m0, 146432
  s_mov_b32 s51, 3244032
  buffer_load_dwordx4 v59, s[12:15], s51 offen lds
  v_add_u32 v54, 147456, v52
  v_add_u32 v55, 147456, v53
  ds_read_b64_tr_b16 v[144:145], v54 offset:0
  ds_read_b64_tr_b16 v[146:147], v54 offset:512
  ds_read_b64_tr_b16 v[148:149], v54 offset:8192
  ds_read_b64_tr_b16 v[150:151], v54 offset:8704
  ds_read_b64_tr_b16 v[152:153], v55 offset:0
  ds_read_b64_tr_b16 v[154:155], v55 offset:512
  ds_read_b64_tr_b16 v[156:157], v55 offset:8192
  ds_read_b64_tr_b16 v[158:159], v55 offset:8704
  s_waitcnt lgkmcnt(0)
  s_waitcnt vmcnt(10)
  s_barrier
  s_mov_b32 m0, 159744
  s_mov_b32 s51, 3670016
  buffer_load_dwordx4 v56, s[20:23], s51 offen lds
  s_mov_b32 m0, 160768
  s_mov_b32 s51, 3702784
  buffer_load_dwordx4 v57, s[20:23], s51 offen lds
  s_mov_b32 m0, 161792
  s_mov_b32 s51, 3735552
  buffer_load_dwordx4 v58, s[20:23], s51 offen lds
  s_mov_b32 m0, 162816
  s_mov_b32 s51, 3768320
  buffer_load_dwordx4 v59, s[20:23], s51 offen lds
  s_getpc_b64 s[34:35]
L_scp_90:
  s_add_u32 s34, s34, L_loop_c3f-L_scp_90
  s_addc_u32 s35, s35, 0
  v_lshlrev_b32 v200, 2, v0
  v_min_u32 v200, L_code_end-L_loop_c3f-4, v200
  v_mov_b32 v201, s35
  v_add_co_u32 v200, vcc, s34, v200
  s_nop 1
  v_addc_co_u32 v201, vcc, 0, v201, vcc
  global_load_dword v202, v[200:201], off
  v_add_u32 v54, 0, v52
  v_add_u32 v55, 0, v53
  ds_read_b64_tr_b16 a[32:33], v54 offset:0
  ds_read_b64_tr_b16 a[34:35], v54 offset:512
  ds_read_b64_tr_b16 a[36:37], v54 offset:8192
  ds_read_b64_tr_b16 a[38:39], v54 offset:8704
  ds_read_b64_tr_b16 a[40:41], v55 offset:0
  ds_read_b64_tr_b16 a[42:43], v55 offset:512
  ds_read_b64_tr_b16 a[44:45], v55 offset:8192
  ds_read_b64_tr_b16 a[46:47], v55 offset:8704
  s_waitcnt lgkmcnt(0)
  s_waitcnt vmcnt(11)
  s_barrier
  s_mov_b32 m0, 12288
  s_mov_b32 s51, 3670016
  buffer_load_dwordx4 v56, s[12:15], s51 offen lds
  s_mov_b32 m0, 13312
  s_mov_b32 s51, 3702784
  buffer_load_dwordx4 v57, s[12:15], s51 offen lds
  s_mov_b32 m0, 14336
  s_mov_b32 s51, 3735552
  buffer_load_dwordx4 v58, s[12:15], s51 offen lds
  s_mov_b32 m0, 15360
  s_mov_b32 s51, 3768320
  buffer_load_dwordx4 v59, s[12:15], s51 offen lds
  v_add_u32 v54, 16384, v52
  v_add_u32 v55, 16384, v53
  ds_read_b64_tr_b16 v[160:161], v54 offset:0
  ds_read_b64_tr_b16 v[162:163], v54 offset:512
  ds_read_b64_tr_b16 v[164:165], v54 offset:8192
  ds_read_b64_tr_b16 v[166:167], v54 offset:8704
  ds_read_b64_tr_b16 v[168:169], v55 offset:0
  ds_read_b64_tr_b16 v[170:171], v55 offset:512
  ds_read_b64_tr_b16 v[172:173], v55 offset:8192
  ds_read_b64_tr_b16 v[174:175], v55 offset:8704
  s_waitcnt lgkmcnt(0)
  s_waitcnt vmcnt(9)
  s_barrier
  s_mov_b32 m0, 28672
  s_mov_b32 s51, 3670016
  buffer_load_dwordx4 v56, s[16:19], s51 offen lds
  s_mov_b32 m0, 29696
  s_mov_b32 s51, 3702784
  buffer_load_dwordx4 v57, s[16:19], s51 offen lds
  s_mov_b32 m0, 30720
  s_mov_b32 s51, 3735552
  buffer_load_dwordx4 v58, s[16:19], s51 offen lds
  s_mov_b32 m0, 31744
  s_mov_b32 s51, 3768320
  buffer_load_dwordx4 v59, s[16:19], s51 offen lds
  v_add_u32 v54, 131072, v52
  v_add_u32 v55, 131072, v53
  ds_read_b64_tr_b16 a[48:49], v54 offset:0
  ds_read_b64_tr_b16 a[50:51], v54 offset:512
  ds_read_b64_tr_b16 a[52:53], v54 offset:8192
  ds_read_b64_tr_b16 a[54:55], v54 offset:8704
  ds_read_b64_tr_b16 a[56:57], v55 offset:0
  ds_read_b64_tr_b16 a[58:59], v55 offset:512
  ds_read_b64_tr_b16 a[60:61], v55 offset:8192
  ds_read_b64_tr_b16 a[62:63], v55 offset:8704
  s_waitcnt lgkmcnt(0)
  s_waitcnt vmcnt(9)
  s_barrier
  s_mov_b32 m0, 143360
  s_mov_b32 s51, 4194304
  buffer_load_dwordx4 v56, s[20:23], s51 offen lds
  s_mov_b32 m0, 144384
  s_mov_b32 s51, 4227072
  buffer_load_dwordx4 v57, s[20:23], s51 offen lds
  s_mov_b32 m0, 145408
  s_mov_b32 s51, 4259840
  buffer_load_dwordx4 v58, s[20:23], s51 offen lds
  s_mov_b32 m0, 146432
  s_mov_b32 s51, 4292608
  buffer_load_dwordx4 v59, s[20:23], s51 offen lds
  v_add_u32 v54, 147456, v52
  v_add_u32 v55, 147456, v53
  ds_read_b64_tr_b16 v[176:177], v54 offset:0
  ds_read_b64_tr_b16 v[178:179], v54 offset:512
  ds_read_b64_tr_b16 v[180:181], v54 offset:8192
  ds_read_b64_tr_b16 v[182:183], v54 offset:8704
  ds_read_b64_tr_b16 v[184:185], v55 offset:0
  ds_read_b64_tr_b16 v[186:187], v55 offset:512
  ds_read_b64_tr_b16 v[188:189], v55 offset:8192
  ds_read_b64_tr_b16 v[190:191], v55 offset:8704
  s_waitcnt lgkmcnt(0)
  s_waitcnt vmcnt(8)
  v_min_u32 v192, v192, v193
  v_min3_u32 v192, v192, v194, v195
  s_mov_b32 s95, 1
  v_readfirstlane_b32 s60, v192
  s_nop 0
  s_cmp_ge_u32 s60, s95
  s_cbranch_scc1 L_fwi_91_x
L_fwi_91:
  s_load_dwordx4 s[96:99], s[4:5], s61 glc
  s_add_u32 s50, s50, 1
  s_waitcnt lgkmcnt(0)
  s_min_u32 s96, s96, s97
  s_min_u32 s98, s98, s99
  s_min_u32 s60, s96, s98
  s_cmp_ge_u32 s50, 262144
  s_cbranch_scc1 L_fwi_91_x
  s_cmp_lt_u32 s60, s95
  s_cbranch_scc1 L_fwi_91
L_fwi_91_x:
  s_add_u32 s95, s95, 1
  s_barrier
  ds_write_b128 v3, v[28:31] offset:49152
  ds_write_b128 v3, v[32:35] offset:50176
  ds_write_b128 v3, v[36:39] offset:51200
  ds_write_b128 v3, v[40:43] offset:52224
  v_bfe_u32 v44, v0, 6, 2
  v_bfe_u32 v45, v0, 4, 1
  v_lshl_add_u32 v44, v44, 1, v45
  v_mul_u32_u24 v44, 1152, v44
  v_bfe_u32 v45, v0, 8, 2
  v_lshl_add_u32 v44, v45, 5, v44
  v_bfe_u32 v45, v0, 5, 1
  v_lshl_add_u32 v44, v45, 4, v44
  buffer_load_dwordx4 v[28:31], v44, s[28:31], 0 offen offset:768
  buffer_load_dwordx4 v[32:35], v44, s[28:31], 0 offen offset:896
  buffer_load_dwordx4 v[36:39], v44, s[28:31], 0 offen offset:1024
  v_add_u32 v54, 0, v52
  v_add_u32 v55, 0, v53
  ds_read_b64_tr_b16 a[64:65], v54 offset:0
  ds_read_b64_tr_b16 a[66:67], v54 offset:512
  ds_read_b64_tr_b16 a[68:69], v54 offset:8192
  ds_read_b64_tr_b16 a[70:71], v54 offset:8704
  ds_read_b64_tr_b16 a[72:73], v55 offset:0
  ds_read_b64_tr_b16 a[74:75], v55 offset:512
  ds_read_b64_tr_b16 a[76:77], v55 offset:8192
  ds_read_b64_tr_b16 a[78:79], v55 offset:8704
  s_waitcnt lgkmcnt(0)
  s_waitcnt vmcnt(7)
  s_barrier
  s_mov_b32 m0, 12288
  s_mov_b32 s51, 4194304
  buffer_load_dwordx4 v56, s[12:15], s51 offen lds
  s_mov_b32 m0, 13312
  s_mov_b32 s51, 4227072
  buffer_load_dwordx4 v57, s[12:15], s51 offen lds
  s_mov_b32 m0, 14336
  s_mov_b32 s51, 4259840
  buffer_load_dwordx4 v58, s[12:15], s51 offen lds
  s_mov_b32 m0, 15360
  s_mov_b32 s51, 4292608
  buffer_load_dwordx4 v59, s[12:15], s51 offen lds
  v_add_u32 v54, 16384, v52
  v_add_u32 v55, 16384, v53
  ds_read_b64_tr_b16 a[128:129], v54 offset:0
  ds_read_b64_tr_b16 a[130:131], v54 offset:512
  ds_read_b64_tr_b16 a[132:133], v54 offset:8192
  ds_read_b64_tr_b16 a[134:135], v54 offset:8704
  ds_read_b64_tr_b16 a[136:137], v55 offset:0
  ds_read_b64_tr_b16 a[138:139], v55 offset:512
  ds_read_b64_tr_b16 a[140:141], v55 offset:8192
  ds_read_b64_tr_b16 a[142:143], v55 offset:8704
  s_waitcnt lgkmcnt(0)
  s_waitcnt vmcnt(7)
  s_barrier
  v_add_u32 v54, 131072, v52
  v_add_u32 v55, 131072, v53
  ds_read_b64_tr_b16 v[192:193], v54 offset:0
  ds_read_b64_tr_b16 v[194:195], v54 offset:512
  ds_read_b64_tr_b16 v[196:197], v54 offset:8192
  ds_read_b64_tr_b16 v[198:199], v54 offset:8704
  ds_read_b64_tr_b16 v[200:201], v55 offset:0
  ds_read_b64_tr_b16 v[202:203], v55 offset:512
  ds_read_b64_tr_b16 v[204:205], v55 offset:8192
  ds_read_b64_tr_b16 v[206:207], v55 offset:8704
  s_waitcnt lgkmcnt(0)
  s_waitcnt vmcnt(0)
  s_barrier
  ds_write_b128 v3, v[12:15] offset:32768
  ds_write_b128 v3, v[16:19] offset:33792
  ds_write_b128 v3, v[20:23] offset:34816
  ds_write_b128 v3, v[24:27] offset:35840
  v_add_u32 v54, 0, v52
  v_add_u32 v55, 0, v53
  ds_read_b64_tr_b16 a[80:81], v54 offset:0
  ds_read_b64_tr_b16 a[82:83], v54 offset:512
  ds_read_b64_tr_b16 a[84:85], v54 offset:8192
  ds_read_b64_tr_b16 a[86:87], v54 offset:8704
  ds_read_b64_tr_b16 a[88:89], v55 offset:0
  ds_read_b64_tr_b16 a[90:91], v55 offset:512
  ds_read_b64_tr_b16 a[92:93], v55 offset:8192
  ds_read_b64_tr_b16 a[94:95], v55 offset:8704
  s_waitcnt lgkmcnt(0)
  s_getpc_b64 s[12:13]
L_lcp_pc:
  s_add_u32 s12, s12, L_last_0-L_lcp_pc
  s_addc_u32 s13, s13, 0
  v_readfirstlane_b32 s37, v48
  ds_read_b128 v[40:43], v3 offset:0
  ds_read_b128 v[44:47], v3 offset:1024
  ds_read_b128 v[48:51], v3 offset:2048
  ds_read_b128 v[52:55], v3 offset:3072
  ds_read_b128 v[56:59], v3 offset:16384
  ds_read_b128 v[60:63], v3 offset:17408
  v_mov_b64 v[12:13], 0
  v_mov_b64 v[14:15], 0
  v_mov_b64 v[16:17], 0
  v_mov_b64 v[18:19], 0
  v_mov_b64 v[20:21], 0
  v_mov_b64 v[22:23], 0
  s_waitcnt vmcnt(0) lgkmcnt(0)
  v_mov_b64 v[24:25], 0
  v_mov_b64 v[26:27], 0
  s_mov_b32 s28, s4
  s_or_b32 s29, s5, 0x40000
  s_mov_b32 s30, 67108864
  ds_write_b128 v0, v[28:31] offset:22528
  ds_write_b128 v0, v[32:35] offset:23552
  ds_write_b128 v0, v[36:39] offset:24576
  s_cmp_lt_u32 s37, 32
  s_cbranch_scc1 L_enter_c3s
  s_branch L_enter_c3f
.p2align 6
.fill 7, 4, 0xbf800000
L_loop_c3f:
  s_barrier
  s_mov_b32 s45, s42
  v_mov_b64 v[12:13], 0
  v_mov_b64_e64 v[14:15], 0
  v_mov_b64_e64 v[16:17], 0
  v_mov_b64_e64 v[18:19], 0
  buffer_load_dwordx4 v[28:31], v11, s[4:7], s45 offen offset:0 sc1
  buffer_load_dwordx4 v[32:35], v11, s[4:7], s45 offen offset:1024 sc1
  buffer_load_dwordx4 v[36:39], v11, s[4:7], s45 offen offset:2048 sc1
  ds_read_b128 v[40:43], v3 offset:0
  ds_read_b128 v[44:47], v3 offset:1024
  ds_read_b128 v[48:51], v3 offset:2048
  ds_read_b128 v[52:55], v3 offset:3072
  ds_read_b128 v[56:59], v3 offset:16384
  ds_read_b128 v[60:63], v3 offset:17408
  s_waitcnt lgkmcnt(0)
  v_mov_b64 v[20:21], 0
  v_mov_b64_e64 v[22:23], 0
  v_mov_b64_e64 v[24:25], 0
  v_mov_b64_e64 v[26:27], 0
  s_add_u32 s40, s40, 1
  s_xor_b32 s54, s54, 1
  s_mov_b32 s42, s44
  s_mov_b32 s44, s43
  s_mov_b32 s43, s45
  s_add_u32 s48, s48, 262144
  s_add_u32 s93, s93, 262144
  s_add_u32 s49, s49, 65536
  s_nop 3
  buffer_load_dwordx4 v[28:31], v11, s[4:7], s45 offen offset:0 sc1
  buffer_load_dwordx4 v[32:35], v11, s[4:7], s45 offen offset:1024 sc1
  buffer_load_dwordx4 v[36:39], v11, s[4:7], s45 offen offset:2048 sc1
  s_cmp_eq_u32 s40, 63
  s_waitcnt vmcnt(5) lgkmcnt(0)
  v_max3_u32 v10, v28, v29, v30
  v_max_u32_e64 v10, v10, v31
  ds_write_b128 v0, v[28:31] offset:22528
  s_waitcnt vmcnt(4)
  v_max3_u32 v10, v10, v32, v33
  v_max3_u32 v10, v10, v34, v35
  ds_write_b128 v0, v[32:35] offset:23552
  s_waitcnt vmcnt(3)
  v_max3_u32 v10, v10, v36, v37
  v_max3_u32 v10, v10, v38, v39
  ds_write_b128 v0, v[36:39] offset:24576
  v_cmp_eq_u32 vcc, -1, v10
  s_nop 0
  s_cbranch_vccz L_okB_c3f
L_retB_c3f:
  s_add_u32 s50, s50, 1
  s_mov_b64 exec, vcc
  buffer_load_dwordx4 v[28:31], v11, s[4:7], s45 offen offset:0 sc1
  buffer_load_dwordx4 v[32:35], v11, s[4:7], s45 offen offset:1024 sc1
  buffer_load_dwordx4 v[36:39], v11, s[4:7], s45 offen offset:2048 sc1
  s_mov_b64 exec, -1
  s_cmp_ge_u32 s50, 262144
  s_cbranch_scc1 L_chain_end
  s_cmp_eq_u32 s40, 63
  s_waitcnt vmcnt(5)
  v_max3_u32 v10, v28, v29, v30
  v_max_u32 v10, v10, v31
  ds_write_b128 v0, v[28:31] offset:22528
  s_waitcnt vmcnt(4)
  v_max3_u32 v10, v10, v32, v33
  v_max3_u32 v10, v10, v34, v35
  ds_write_b128 v0, v[32:35] offset:23552
  s_waitcnt vmcnt(3)
  v_max3_u32 v10, v10, v36, v37
  v_max3_u32 v10, v10, v38, v39
  ds_write_b128 v0, v[36:39] offset:24576
  v_cmp_eq_u32 vcc, -1, v10
  s_nop 0
  s_cbranch_vccnz L_retB_c3f
L_okB_c3f:
  s_cbranch_scc1 L_last_3
L_enter_c3f:
  v_smfmac_f32_16x16x64_bf16 v[12:15], v[28:31], a[48:55], v1
  v_smfmac_f32_16x16x64_bf16 v[20:23], v[28:31], v[40:47], v1
  ds_read_b128 v[40:43], v3 offset:18432
  ds_read_b128 v[44:47], v3 offset:19456
  v_smfmac_f32_16x16x64_bf16 v[16:19], v[28:31], a[56:63], v1
  s_waitcnt lgkmcnt(2)
  s_barrier
  v_smfmac_f32_16x16x64_bf16 v[24:27], v[28:31], v[48:55], v1
  ds_read_b128 v[48:51], v2 offset:0
  ds_read_b128 v[52:55], v2 offset:1024
  s_waitcnt vmcnt(0)
  ds_read_b128 v[28:31], v0 offset:16384
  v_smfmac_f32_16x16x64_bf16 v[12:15], v[32:35], a[64:71], v1
  v_smfmac_f32_16x16x64_bf16 v[20:23], v[32:35], a[128:135], v1
  v_smfmac_f32_16x16x64_bf16 v[16:19], v[32:35], a[72:79], v1
  s_mov_b32 m0, 0
  s_add_u32 s51, s48, 0
  buffer_load_dwordx4 v0, s[4:7], s51 offen offset:0 sc1 lds
  v_smfmac_f32_16x16x64_bf16 v[24:27], v[32:35], a[136:143], v1
  v_smfmac_f32_16x16x64_bf16 v[12:15], v[36:39], a[80:87], v1
  ds_read_b128 v[32:35], v0 offset:17408
  v_smfmac_f32_16x16x64_bf16 v[20:23], v[36:39], v[56:63], v1
  ds_read_b128 v[56:59], v2 offset:2048
  ds_read_b128 v[60:63], v2 offset:3072
  v_smfmac_f32_16x16x64_bf16 v[16:19], v[36:39], a[88:95], v1
  s_mov_b32 m0, 4096
  s_add_u32 s51, s48, 4096
  buffer_load_dwordx4 v0, s[4:7], s51 offen offset:0 sc1 lds
  s_waitcnt lgkmcnt(6)
  v_smfmac_f32_16x16x64_bf16 v[24:27], v[36:39], v[40:47], v1
  ds_read_b128 v[40:43], v2 offset:16384
  ds_read_b128 v[44:47], v2 offset:17408
  s_waitcnt lgkmcnt(5)
  v_smfmac_f32_16x16x64_bf16 v[12:15], v[28:31], v[208:215], v1
  ds_read_b128 v[36:39], v0 offset:18432
  v_smfmac_f32_16x16x64_bf16 v[20:23], v[28:31], v[48:55], v1
  ds_read_b128 v[48:51], v2 offset:18432
  ds_read_b128 v[52:55], v2 offset:19456
  v_smfmac_f32_16x16x64_bf16 v[16:19], v[28:31], v[216:223], v1
  s_mov_b32 m0, 14336
  s_add_u32 s51, s48, 16783360
  buffer_load_dwordx4 v0, s[4:7], s51 offen offset:0 sc1 lds
  s_waitcnt lgkmcnt(5)
  v_smfmac_f32_16x16x64_bf16 v[24:27], v[28:31], v[56:63], v1
  ds_read_b128 v[56:59], v2 offset:32768
  ds_read_b128 v[60:63], v2 offset:33792
  v_smfmac_f32_16x16x64_bf16 v[12:15], v[32:35], v[224:231], v1
  ds_read_b128 v[28:31], v0 offset:19456
  v_smfmac_f32_16x16x64_bf16 v[20:23], v[32:35], a[96:103], v1
  v_smfmac_f32_16x16x64_bf16 v[16:19], v[32:35], v[232:239], v1
  buffer_load_dwordx4 v0, s[4:7], s51 offen offset:1024 sc1 lds
  v_smfmac_f32_16x16x64_bf16 v[24:27], v[32:35], a[104:111], v1
  s_waitcnt lgkmcnt(5)
  v_smfmac_f32_16x16x64_bf16 v[12:15], v[36:39], v[240:247], v1
  ds_read_b128 v[32:35], v0 offset:21504
  v_smfmac_f32_16x16x64_bf16 v[20:23], v[36:39], v[40:47], v1
  ds_read_b128 v[40:43], v2 offset:34816
  ds_read_b128 v[44:47], v2 offset:35840
  v_smfmac_f32_16x16x64_bf16 v[16:19], v[36:39], v[248:255], v1
  s_mov_b32 m0, 32512
  s_nop 0
  buffer_load_dword v0, s[28:31], s93 idxen sc1 lds
  s_waitcnt lgkmcnt(6)
  v_smfmac_f32_16x16x64_bf16 v[24:27], v[36:39], v[48:55], v1
  ds_read_b128 v[48:51], v2 offset:49152
  ds_read_b128 v[52:55], v2 offset:50176
  s_waitcnt lgkmcnt(5)
  v_smfmac_f32_16x16x64_bf16 v[12:15], v[28:31], a[0:7], v1
  ds_read_b128 v[36:39], v0 offset:20480
  v_smfmac_f32_16x16x64_bf16 v[20:23], v[28:31], v[56:63], v1
  ds_read_b128 v[56:59], v2 offset:51200
  ds_read_b128 v[60:63], v2 offset:52224
  v_smfmac_f32_16x16x64_bf16 v[16:19], v[28:31], a[8:15], v1
  s_waitcnt lgkmcnt(5)
  v_smfmac_f32_16x16x64_bf16 v[24:27], v[28:31], v[40:47], v1
  v_smfmac_f32_16x16x64_bf16 v[12:15], v[32:35], a[32:39], v1
  v_mov_b64 v[40:41], 0
  s_waitcnt lgkmcnt(3)
  v_smfmac_f32_16x16x64_bf16 v[20:23], v[32:35], v[48:55], v1
  v_smfmac_f32_16x16x64_bf16 v[16:19], v[32:35], a[40:47], v1
  v_mov_b64_e64 v[42:43], 0
  s_waitcnt lgkmcnt(0)
  v_smfmac_f32_16x16x64_bf16 v[24:27], v[32:35], v[56:63], v1
  v_smfmac_f32_16x16x64_bf16 v[12:15], v[36:39], a[16:23], v1
  v_mov_b64 v[44:45], 0
  v_smfmac_f32_16x16x64_bf16 v[20:23], v[36:39], a[112:119], v1
  v_mov_b64_e64 v[46:47], 0
  v_smfmac_f32_16x16x64_bf16 v[16:19], v[36:39], a[24:31], v1
  v_smfmac_f32_16x16x64_bf16 v[24:27], v[36:39], a[120:127], v1
  v_pk_add_f32 v[12:13], v[12:13], v[14:15]
  v_pk_add_f32 v[20:21], v[20:21], v[22:23]
  v_cvt_pk_bf16_f32 v23, v12, v13
  v_cvt_pk_bf16_f32 v22, v20, v21
  ds_write_b64 v5, v[22:23] offset:0
  v_pk_add_f32 v[16:17], v[16:17], v[18:19]
  s_nop 1
  v_pk_add_f32 v[24:25], v[24:25], v[26:27]
  v_cvt_pk_bf16_f32 v27, v16, v17
  v_cvt_pk_bf16_f32 v26, v24, v25
  ds_write_b64 v5, v[26:27] offset:512
  v_smfmac_f32_16x16x64_bf16 v[40:43], v[28:31], v[112:119], v1
  v_xor_b32_e64 v52, 16, v6
  s_waitcnt vmcnt(3)
  ds_read_b128 v[60:63], v0 offset:0
  v_smfmac_f32_16x16x64_bf16 v[44:47], v[28:31], v[120:127], v1
  ds_read_b128 v[28:31], v0 offset:22528
  ds_read_b128 v[48:51], v0 offset:4096
  v_smfmac_f32_16x16x64_bf16 v[40:43], v[32:35], v[144:151], v1
  s_cmp_eq_u32 s40, 62
  s_cbranch_scc1 L_lcp_c3f
  buffer_load_dword v0, s[28:31], s93 idxen sc1 lds
L_lcpb_c3f:
  v_smfmac_f32_16x16x64_bf16 v[44:47], v[32:35], v[152:159], v1
  ds_read_b128 v[32:35], v0 offset:23552
  v_smfmac_f32_16x16x64_bf16 v[40:43], v[36:39], v[128:135], v1
  s_waitcnt lgkmcnt(4)
  s_barrier
  ds_read_b64_tr_b16 v[12:13], v6 offset:0
  ds_read_b64_tr_b16 v[14:15], v52 offset:256
  ds_read_b64_tr_b16 v[16:17], v6 offset:1024
  ds_read_b64_tr_b16 v[18:19], v52 offset:1280
  v_smfmac_f32_16x16x64_bf16 v[44:47], v[36:39], v[136:143], v1
  ds_read_b64_tr_b16 v[20:21], v6 offset:2048
  ds_read_b64_tr_b16 v[22:23], v52 offset:2304
  s_waitcnt lgkmcnt(8)
  v_smfmac_f32_16x16x64_bf16 v[40:43], v[28:31], v[160:167], v1
  ds_read_b64_tr_b16 v[24:25], v6 offset:3072
  ds_read_b64_tr_b16 v[26:27], v52 offset:3328
  v_smfmac_f32_16x16x64_bf16 v[44:47], v[28:31], v[168:175], v1
  ds_read_b128 v[28:31], v0 offset:24576
  s_waitcnt lgkmcnt(9)
  v_smfmac_f32_16x16x64_bf16 v[40:43], v[32:35], v[176:183], v1
  v_smfmac_f32_16x16x64_bf16 v[44:47], v[32:35], v[184:191], v1
  ds_read_b128 v[32:35], v0 offset:16384
  s_waitcnt lgkmcnt(8)
  v_mfma_f32_16x16x32_bf16 v[56:59], v[60:63], v[12:15], 0
  ds_read_b128 v[36:39], v0 offset:1024
  v_mfma_f32_16x16x32_bf16 v[60:63], v[48:51], v[12:15], 0
  ds_read_b128 v[48:51], v0 offset:5120
  v_mfma_f32_16x16x32_bf16 v[52:55], v[12:15], v[12:15], 0
  ds_read_b128 v[12:15], v0 offset:2048
  s_waitcnt lgkmcnt(9)
  v_mfma_f32_16x16x32_bf16 v[52:55], v[16:19], v[16:19], v[52:55]
  s_waitcnt lgkmcnt(2)
  v_mfma_f32_16x16x32_bf16 v[56:59], v[36:39], v[16:19], v[56:59]
  ds_read_b128 v[36:39], v0 offset:6144
  s_waitcnt lgkmcnt(2)
  v_mfma_f32_16x16x32_bf16 v[60:63], v[48:51], v[16:19], v[60:63]
  ds_read_b128 v[48:51], v0 offset:3072
  ds_read_b128 v[16:19], v0 offset:7168
  v_mfma_f32_16x16x32_bf16 v[52:55], v[20:23], v[20:23], v[52:55]
  s_waitcnt lgkmcnt(3)
  v_mfma_f32_16x16x32_bf16 v[56:59], v[12:15], v[20:23], v[56:59]
  s_waitcnt lgkmcnt(2)
  v_mfma_f32_16x16x32_bf16 v[60:63], v[36:39], v[20:23], v[60:63]
  s_waitcnt vmcnt(2)
  ds_read_b128 v[20:23], v0 offset:14336
  ds_read_b128 v[12:15], v0 offset:15360
  v_mfma_f32_16x16x32_bf16 v[52:55], v[24:27], v[24:27], v[52:55]
  s_waitcnt lgkmcnt(3)
  v_mfma_f32_16x16x32_bf16 v[56:59], v[48:51], v[24:27], v[56:59]
  s_waitcnt lgkmcnt(2)
  v_mfma_f32_16x16x32_bf16 v[60:63], v[16:19], v[24:27], v[60:63]
  v_smfmac_f32_16x16x64_bf16 v[40:43], v[28:31], v[192:199], v1
  buffer_store_dwordx4 v[24:27], v9, s[4:7], s49 offen offset:1536 sc1
  v_mov_b32 v36, 0x3f803f80
  v_mov_b32 v37, 0x3f803f80
  v_max3_f32 v48, v52, v53, v56
  v_max3_f32 v48, v48, v57, v58
  v_max3_f32 v48, v48, v59, v60
  v_max3_f32 v48, v48, v61, v62
  v_max_f32 v49, v48, v63
  v_max_f32 v48, v48, v63
  v_smfmac_f32_16x16x64_bf16 v[44:47], v[28:31], v[200:207], v1
  ds_read_b128 v[28:31], v0 offset:17408
  v_mov_b64 v[38:39], v[36:37]
  v_permlane32_swap_b32 v48, v49
  v_max_f32 v48, v48, v49
  v_mov_b32 v49, v48
  v_smfmac_f32_16x16x64_bf16 v[40:43], v[32:35], v[64:71], v1
  v_mov_b64 v[16:17], 0
  v_permlane16_swap_b32 v48, v49
  v_max_f32 v48, v48, v49
  v_mul_f32 v48, s47, v48
  v_pk_fma_f32 v[56:57], v[56:57], s[46:47], v[48:49] op_sel_hi:[1,0,0]
  v_pk_fma_f32 v[58:59], v[58:59], s[46:47], v[48:49] op_sel_hi:[1,0,0]
  v_pk_fma_f32 v[60:61], v[60:61], s[46:47], v[48:49] op_sel_hi:[1,0,0]
  v_pk_fma_f32 v[62:63], v[62:63], s[46:47], v[48:49] op_sel_hi:[1,0,0]
  v_pk_fma_f32 v[52:53], v[52:53], s[46:47], v[48:49] op_sel_hi:[1,0,0]
  v_smfmac_f32_16x16x64_bf16 v[44:47], v[32:35], v[72:79], v1
  ds_read_b128 v[32:35], v0 offset:18432
  v_exp_f32 v56, v56
  v_exp_f32 v57, v57
  s_waitcnt lgkmcnt(1)
  v_smfmac_f32_16x16x64_bf16 v[40:43], v[28:31], v[80:87], v1
  v_exp_f32 v58, v58
  v_exp_f32 v59, v59
  v_smfmac_f32_16x16x64_bf16 v[44:47], v[28:31], v[88:95], v1
  v_exp_f32 v60, v60
  v_exp_f32 v61, v61
  s_waitcnt lgkmcnt(0)
  v_smfmac_f32_16x16x64_bf16 v[40:43], v[32:35], v[96:103], v1
  v_exp_f32 v62, v62
  v_exp_f32 v63, v63
  v_smfmac_f32_16x16x64_bf16 v[44:47], v[32:35], v[104:111], v1
  v_exp_f32 v52, v52
  v_exp_f32 v53, v53
  ds_read_b128 v[28:31], v3 offset:32768
  ds_read_b128 v[32:35], v3 offset:33792
  v_mov_b64_e64 v[18:19], 0
  v_cvt_pk_bf16_f32 v24, v56, v57
  v_cvt_pk_bf16_f32 v25, v58, v59
  v_cvt_pk_bf16_f32 v26, v60, v61
  v_cvt_pk_bf16_f32 v27, v62, v63
  v_cvt_pk_bf16_f32 v16, v52, v53
  v_cvt_pk_bf16_f32 v19, v52, v53
  v_mfma_f32_16x16x32_bf16 v[52:55], v[36:39], v[24:27], 0
  v_add_f32 v40, v40, v42
  v_add_f32 v41, v41, v43
  v_mfma_f32_16x16x32_bf16 v[56:59], v[20:23], v[24:27], 0
  v_add_f32 v44, v44, v46
  v_add_f32 v45, v45, v47
  v_mfma_f32_16x16x32_bf16 v[60:63], v[12:15], v[24:27], 0
  v_cvt_pk_bf16_f32 v40, v40, v41
  v_cvt_pk_bf16_f32 v41, v44, v45
  s_add_u32 s51, s49, 4194304
  v_lshrrev_b32 v50, 1, v0
  v_mfma_f32_16x16x16_bf16 v[52:55], v[36:37], v[16:17], v[52:55]
  v_mov_b64 v[44:45], 0
  v_mov_b64_e64 v[46:47], 0
  v_mfma_f32_16x16x16_bf16 v[56:59], v[40:41], v[16:17], v[56:59]
  buffer_store_dwordx2 v[40:41], v50, s[4:7], s51 offen offset:1536 sc1
  v_mov_b64 v[12:13], 0
  v_mov_b64_e64 v[14:15], 0
  v_mfma_f32_16x16x16_bf16 v[60:63], v[40:41], v[18:19], v[60:63]
  s_nop 0
  v_rcp_f32 v48, v52
  v_mov_b64 v[36:37], 0
  v_mov_b64 v[38:39], 0
  s_mov_b64 exec, s[52:53]
  v_pk_mul_f32 v[56:57], v[56:57], v[48:49] op_sel_hi:[1,0]
  v_pk_mul_f32 v[58:59], v[58:59], v[48:49] op_sel_hi:[1,0]
  v_cvt_pk_bf16_f32 v56, v56, v57
  v_cvt_pk_bf16_f32 v57, v58, v59
  ds_write_b64 v7, v[56:57] offset:0
  v_pk_mul_f32 v[60:61], v[60:61], v[48:49] op_sel_hi:[1,0]
  v_pk_mul_f32 v[62:63], v[62:63], v[48:49] op_sel_hi:[1,0]
  v_cvt_pk_bf16_f32 v60, v60, v61
  v_cvt_pk_bf16_f32 v61, v62, v63
  ds_write_b64 v7, v[60:61] offset:256
  s_mov_b64 exec, -1
  v_mov_b32 v58, 0
  v_mov_b32 v59, 0
  v_mov_b32 v56, 0
  v_mov_b32_e64 v57, 0
  v_mov_b32_e64 v51, s40
  buffer_store_dword v51, off, s[4:7], s94 sc1
  s_cmp_lt_u32 s60, s95
  s_cbranch_scc1 L_fwc3f_92_o
L_fwc3f_92_b:
  s_waitcnt lgkmcnt(0)
  s_barrier
  ds_read_b128 v[16:19], v4 offset:29696
  v_mov_b32_e64 v60, 0
  ds_read_b128 v[40:43], v4 offset:30208
  v_mov_b32_e64 v61, 0
  ds_read_b128 v[48:51], v4 offset:30720
  v_mov_b32 v62, 0
  ds_read_b128 v[52:55], v4 offset:31232
  v_mov_b32 v63, 0
  ds_read_b128 v[20:23], v3 offset:34816
  ds_read_b128 v[24:27], v3 offset:35840
  s_waitcnt lgkmcnt(5)
  v_smfmac_f32_16x16x64_bf16 v[44:47], v[16:19], a[160:167], v1
  s_waitcnt lgkmcnt(4)
  v_smfmac_f32_16x16x64_bf16 v[44:47], v[40:43], v[28:35], v1
  ds_read_b128 v[28:31], v3 offset:49152
  ds_read_b128 v[32:35], v3 offset:50176
  s_waitcnt lgkmcnt(5)
  v_smfmac_f32_16x16x64_bf16 v[44:47], v[48:51], a[168:175], v1
  s_waitcnt lgkmcnt(4)
  v_smfmac_f32_16x16x64_bf16 v[44:47], v[52:55], a[176:183], v1
  s_waitcnt lgkmcnt(2)
  v_smfmac_f32_16x16x64_bf16 v[12:15], v[16:19], v[20:27], v1
  ds_read_b128 v[20:23], v3 offset:51200
  ds_read_b128 v[24:27], v3 offset:52224
  v_smfmac_f32_16x16x64_bf16 v[12:15], v[40:43], a[184:191], v1
  s_nop 0
  v_cvt_pk_bf16_f32 v44, v44, v45
  v_cvt_pk_bf16_f32 v45, v46, v47
  v_smfmac_f32_16x16x64_bf16 v[12:15], v[48:51], a[192:199], v1
  v_bfi_b32 v44, 1, s54, v44
  v_bfi_b32 v45, 1, s54, v45
  buffer_store_dwordx2 v[44:45], v8, s[4:7], s89 offen
  v_smfmac_f32_16x16x64_bf16 v[12:15], v[52:55], a[200:207], v1
  s_waitcnt lgkmcnt(2)
  v_smfmac_f32_16x16x64_bf16 v[36:39], v[16:19], v[28:35], v1
  ds_read_b128 v[28:31], v0 offset:29696
  ds_read_b128 v[32:35], v0 offset:30720
  v_smfmac_f32_16x16x64_bf16 v[36:39], v[40:43], a[208:215], v1
  s_nop 0
  v_cvt_pk_bf16_f32 v12, v12, v13
  v_cvt_pk_bf16_f32 v13, v14, v15
  v_smfmac_f32_16x16x64_bf16 v[36:39], v[48:51], a[216:223], v1
  v_bfi_b32 v12, 1, s54, v12
  v_bfi_b32 v13, 1, s54, v13
  buffer_store_dwordx2 v[12:13], v8, s[4:7], s90 offen
  v_smfmac_f32_16x16x64_bf16 v[36:39], v[52:55], a[224:231], v1
  s_waitcnt lgkmcnt(2)
  v_smfmac_f32_16x16x64_bf16 v[56:59], v[16:19], v[20:27], v1
  v_smfmac_f32_16x16x64_bf16 v[56:59], v[40:43], a[232:239], v1
  s_nop 0
  v_cvt_pk_bf16_f32 v36, v36, v37
  v_cvt_pk_bf16_f32 v37, v38, v39
  v_smfmac_f32_16x16x64_bf16 v[56:59], v[48:51], a[240:247], v1
  v_bfi_b32 v36, 1, s54, v36
  v_bfi_b32 v37, 1, s54, v37
  buffer_store_dwordx2 v[36:37], v8, s[4:7], s91 offen
  v_smfmac_f32_16x16x64_bf16 v[56:59], v[52:55], a[248:255], v1
  s_waitcnt lgkmcnt(1)
  v_smfmac_f32_16x16x64_bf16 v[60:63], v[28:31], a[144:151], v1
  s_waitcnt lgkmcnt(0)
  v_smfmac_f32_16x16x64_bf16 v[60:63], v[32:35], a[152:159], v1
  s_nop 0
  v_cvt_pk_bf16_f32 v56, v56, v57
  v_cvt_pk_bf16_f32 v57, v58, v59
  v_bfi_b32 v56, 1, s54, v56
  v_bfi_b32 v57, 1, s54, v57
  buffer_store_dwordx2 v[56:57], v8, s[4:7], s92 offen
  s_nop 1
  v_pk_add_f32 v[60:61], v[60:61], v[62:63]
  v_cvt_pk_bf16_f32 v60, v60, v61
  v_bfi_b32 v60, 1, s54, v60
  buffer_store_dword v60, v8, s[4:7], s88 offen offset:4
  s_add_u32 s96, s40, 4
  s_min_u32 s96, s96, 64
  s_cmp_ge_u32 s60, s96
  s_cbranch_scc1 L_fwc3f_93_x
L_fwc3f_93:
  s_load_dwordx4 s[96:99], s[4:5], s61 glc
  s_waitcnt lgkmcnt(0)
  s_min_u32 s96, s96, s97
  s_min_u32 s98, s98, s99
  s_min_u32 s60, s96, s98
L_fwc3f_93_x:
  s_add_u32 s95, s40, 3
  s_waitcnt vmcnt(0)
  s_branch L_loop_c3f
L_lcp_c3f:
  v_lshlrev_b32 v56, 2, v0
  v_min_u32 v56, L_code_end-L_last_0-4, v56
  v_mov_b32 v57, s13
  v_add_co_u32 v56, vcc, s12, v56
  s_nop 1
  v_addc_co_u32 v57, vcc, 0, v57, vcc
  global_load_lds_dword v[56:57], off
  s_branch L_lcpb_c3f
L_fwc3f_92_o:
  s_cmp_ge_u32 s60, s95
  s_cbranch_scc1 L_fwc3f_94_x
L_fwc3f_94:
  s_load_dwordx4 s[96:99], s[4:5], s61 glc
  s_add_u32 s50, s50, 1
  s_waitcnt lgkmcnt(0)
  s_min_u32 s96, s96, s97
  s_min_u32 s98, s98, s99
  s_min_u32 s60, s96, s98
  s_cmp_ge_u32 s50, 262144
  s_cbranch_scc1 L_fwc3f_94_x
  s_cmp_lt_u32 s60, s95
  s_cbranch_scc1 L_fwc3f_94
L_fwc3f_94_x:
  s_branch L_fwc3f_92_b
L_loop_c3s:
  s_barrier
  s_mov_b32 s45, s42
  v_mov_b64 v[12:13], 0
  v_mov_b64 v[14:15], 0
  v_mov_b64 v[16:17], 0
  v_mov_b64 v[18:19], 0
  buffer_load_dwordx4 v[28:31], v11, s[4:7], s45 offen offset:0 sc1
  buffer_load_dwordx4 v[32:35], v11, s[4:7], s45 offen offset:1024 sc1
  buffer_load_dwordx4 v[36:39], v11, s[4:7], s45 offen offset:2048 sc1
  ds_read_b128 v[40:43], v3 offset:0
  ds_read_b128 v[44:47], v3 offset:1024
  ds_read_b128 v[48:51], v3 offset:2048
  ds_read_b128 v[52:55], v3 offset:3072
  ds_read_b128 v[56:59], v3 offset:16384
  ds_read_b128 v[60:63], v3 offset:17408
  s_waitcnt lgkmcnt(0)
  v_mov_b64 v[20:21], 0
  v_mov_b64 v[22:23], 0
  v_mov_b64 v[24:25], 0
  v_mov_b64 v[26:27], 0
  s_add_u32 s40, s40, 1
  s_xor_b32 s54, s54, 1
  s_mov_b32 s42, s44
  s_mov_b32 s44, s43
  s_mov_b32 s43, s45
  s_add_u32 s48, s48, 262144
  s_add_u32 s93, s93, 262144
  s_add_u32 s49, s49, 65536
  s_nop 3
  buffer_load_dwordx4 v[28:31], v11, s[4:7], s45 offen offset:0 sc1
  buffer_load_dwordx4 v[32:35], v11, s[4:7], s45 offen offset:1024 sc1
  buffer_load_dwordx4 v[36:39], v11, s[4:7], s45 offen offset:2048 sc1
  s_cmp_eq_u32 s40, 63
  s_waitcnt vmcnt(5) lgkmcnt(0)
  v_max3_u32 v10, v28, v29, v30
  v_max_u32 v10, v10, v31
  ds_write_b128 v0, v[28:31] offset:22528
  s_waitcnt vmcnt(4)
  v_max3_u32 v10, v10, v32, v33
  v_max3_u32 v10, v10, v34, v35
  ds_write_b128 v0, v[32:35] offset:23552
  s_waitcnt vmcnt(3)
  v_max3_u32 v10, v10, v36, v37
  v_max3_u32 v10, v10, v38, v39
  ds_write_b128 v0, v[36:39] offset:24576
  v_cmp_eq_u32 vcc, -1, v10
  s_nop 0
  s_cbranch_vccz L_okB_c3s
L_retB_c3s:
  s_add_u32 s50, s50, 1
  s_mov_b64 exec, vcc
  buffer_load_dwordx4 v[28:31], v11, s[4:7], s45 offen offset:0 sc1
  buffer_load_dwordx4 v[32:35], v11, s[4:7], s45 offen offset:1024 sc1
  buffer_load_dwordx4 v[36:39], v11, s[4:7], s45 offen offset:2048 sc1
  s_mov_b64 exec, -1
  s_cmp_ge_u32 s50, 262144
  s_cbranch_scc1 L_chain_end
  s_cmp_eq_u32 s40, 63
  s_waitcnt vmcnt(5)
  v_max3_u32 v10, v28, v29, v30
  v_max_u32 v10, v10, v31
  ds_write_b128 v0, v[28:31] offset:22528
  s_waitcnt vmcnt(4)
  v_max3_u32 v10, v10, v32, v33
  v_max3_u32 v10, v10, v34, v35
  ds_write_b128 v0, v[32:35] offset:23552
  s_waitcnt vmcnt(3)
  v_max3_u32 v10, v10, v36, v37
  v_max3_u32 v10, v10, v38, v39
  ds_write_b128 v0, v[36:39] offset:24576
  v_cmp_eq_u32 vcc, -1, v10
  s_nop 0
  s_cbranch_vccnz L_retB_c3s
L_okB_c3s:
  s_cbranch_scc1 L_last_3
L_enter_c3s:
  v_smfmac_f32_16x16x64_bf16 v[12:15], v[28:31], a[48:55], v1
  v_smfmac_f32_16x16x64_bf16 v[20:23], v[28:31], v[40:47], v1
  ds_read_b128 v[40:43], v3 offset:18432
  ds_read_b128 v[44:47], v3 offset:19456
  v_smfmac_f32_16x16x64_bf16 v[16:19], v[28:31], a[56:63], v1
  s_waitcnt lgkmcnt(2)
  s_barrier
  v_smfmac_f32_16x16x64_bf16 v[24:27], v[28:31], v[48:55], v1
  ds_read_b128 v[48:51], v2 offset:0
  ds_read_b128 v[52:55], v2 offset:1024
  s_waitcnt vmcnt(0)
  ds_read_b128 v[28:31], v0 offset:16384
  v_smfmac_f32_16x16x64_bf16 v[12:15], v[32:35], a[64:71], v1
  v_smfmac_f32_16x16x64_bf16 v[20:23], v[32:35], a[128:135], v1
  v_smfmac_f32_16x16x64_bf16 v[16:19], v[32:35], a[72:79], v1
  s_mov_b32 m0, 0
  s_add_u32 s51, s48, 0
  buffer_load_dwordx4 v0, s[4:7], s51 offen offset:0 sc1 lds
  v_smfmac_f32_16x16x64_bf16 v[24:27], v[32:35], a[136:143], v1
  v_smfmac_f32_16x16x64_bf16 v[12:15], v[36:39], a[80:87], v1
  ds_read_b128 v[32:35], v0 offset:17408
  v_smfmac_f32_16x16x64_bf16 v[20:23], v[36:39], v[56:63], v1
  ds_read_b128 v[56:59], v2 offset:2048
  ds_read_b128 v[60:63], v2 offset:3072
  v_smfmac_f32_16x16x64_bf16 v[16:19], v[36:39], a[88:95], v1
  s_mov_b32 m0, 4096
  s_add_u32 s51, s48, 4096
  buffer_load_dwordx4 v0, s[4:7], s51 offen offset:0 sc1 lds
  s_waitcnt lgkmcnt(6)
  v_smfmac_f32_16x16x64_bf16 v[24:27], v[36:39], v[40:47], v1
  ds_read_b128 v[40:43], v2 offset:16384
  ds_read_b128 v[44:47], v2 offset:17408
  s_waitcnt lgkmcnt(5)
  v_smfmac_f32_16x16x64_bf16 v[12:15], v[28:31], v[208:215], v1
  ds_read_b128 v[36:39], v0 offset:18432
  v_smfmac_f32_16x16x64_bf16 v[20:23], v[28:31], v[48:55], v1
  ds_read_b128 v[48:51], v2 offset:18432
  ds_read_b128 v[52:55], v2 offset:19456
  v_smfmac_f32_16x16x64_bf16 v[16:19], v[28:31], v[216:223], v1
  s_mov_b32 m0, 14336
  s_add_u32 s51, s48, 16783360
  buffer_load_dwordx4 v0, s[4:7], s51 offen offset:0 sc1 lds
  s_waitcnt lgkmcnt(5)
  v_smfmac_f32_16x16x64_bf16 v[24:27], v[28:31], v[56:63], v1
  ds_read_b128 v[56:59], v2 offset:32768
  ds_read_b128 v[60:63], v2 offset:33792
  v_smfmac_f32_16x16x64_bf16 v[12:15], v[32:35], v[224:231], v1
  ds_read_b128 v[28:31], v0 offset:19456
  v_smfmac_f32_16x16x64_bf16 v[20:23], v[32:35], a[96:103], v1
  v_smfmac_f32_16x16x64_bf16 v[16:19], v[32:35], v[232:239], v1
  buffer_load_dwordx4 v0, s[4:7], s51 offen offset:1024 sc1 lds
  v_smfmac_f32_16x16x64_bf16 v[24:27], v[32:35], a[104:111], v1
  s_waitcnt lgkmcnt(5)
  v_smfmac_f32_16x16x64_bf16 v[12:15], v[36:39], v[240:247], v1
  ds_read_b128 v[32:35], v0 offset:21504
  v_smfmac_f32_16x16x64_bf16 v[20:23], v[36:39], v[40:47], v1
  ds_read_b128 v[40:43], v2 offset:34816
  ds_read_b128 v[44:47], v2 offset:35840
  v_smfmac_f32_16x16x64_bf16 v[16:19], v[36:39], v[248:255], v1
  s_mov_b32 m0, 32512
  s_nop 0
  buffer_load_dword v0, s[28:31], s93 idxen sc1 lds
  s_waitcnt lgkmcnt(6)
  v_smfmac_f32_16x16x64_bf16 v[24:27], v[36:39], v[48:55], v1
  ds_read_b128 v[48:51], v2 offset:49152
  ds_read_b128 v[52:55], v2 offset:50176
  s_waitcnt lgkmcnt(5)
  v_smfmac_f32_16x16x64_bf16 v[12:15], v[28:31], a[0:7], v1
  ds_read_b128 v[36:39], v0 offset:20480
  v_smfmac_f32_16x16x64_bf16 v[20:23], v[28:31], v[56:63], v1
  ds_read_b128 v[56:59], v2 offset:51200
  ds_read_b128 v[60:63], v2 offset:52224
  v_smfmac_f32_16x16x64_bf16 v[16:19], v[28:31], a[8:15], v1
  s_waitcnt lgkmcnt(5)
  v_smfmac_f32_16x16x64_bf16 v[24:27], v[28:31], v[40:47], v1
  v_smfmac_f32_16x16x64_bf16 v[12:15], v[32:35], a[32:39], v1
  v_mov_b64 v[40:41], 0
  s_waitcnt lgkmcnt(3)
  v_smfmac_f32_16x16x64_bf16 v[20:23], v[32:35], v[48:55], v1
  v_smfmac_f32_16x16x64_bf16 v[16:19], v[32:35], a[40:47], v1
  v_mov_b64 v[42:43], 0
  s_waitcnt lgkmcnt(0)
  v_smfmac_f32_16x16x64_bf16 v[24:27], v[32:35], v[56:63], v1
  v_smfmac_f32_16x16x64_bf16 v[12:15], v[36:39], a[16:23], v1
  v_mov_b64 v[44:45], 0
  v_smfmac_f32_16x16x64_bf16 v[20:23], v[36:39], a[112:119], v1
  v_mov_b64 v[46:47], 0
  v_smfmac_f32_16x16x64_bf16 v[16:19], v[36:39], a[24:31], v1
  v_smfmac_f32_16x16x64_bf16 v[24:27], v[36:39], a[120:127], v1
  v_pk_add_f32 v[12:13], v[12:13], v[14:15]
  v_pk_add_f32 v[20:21], v[20:21], v[22:23]
  v_cvt_pk_bf16_f32 v23, v12, v13
  v_cvt_pk_bf16_f32 v22, v20, v21
  ds_write_b64 v5, v[22:23] offset:0
  v_pk_add_f32 v[16:17], v[16:17], v[18:19]
  s_nop 1
  v_pk_add_f32 v[24:25], v[24:25], v[26:27]
  v_cvt_pk_bf16_f32 v27, v16, v17
  v_cvt_pk_bf16_f32 v26, v24, v25
  ds_write_b64 v5, v[26:27] offset:512
  v_smfmac_f32_16x16x64_bf16 v[40:43], v[28:31], v[112:119], v1
  v_xor_b32 v52, 16, v6
  s_waitcnt vmcnt(3)
  ds_read_b128 v[60:63], v0 offset:0
  v_smfmac_f32_16x16x64_bf16 v[44:47], v[28:31], v[120:127], v1
  ds_read_b128 v[28:31], v0 offset:22528
  ds_read_b128 v[48:51], v0 offset:4096
  v_smfmac_f32_16x16x64_bf16 v[40:43], v[32:35], v[144:151], v1
  s_cmp_eq_u32 s40, 62
  s_cbranch_scc1 L_lcp_c3s
  buffer_load_dword v0, s[28:31], s93 idxen sc1 lds
L_lcpb_c3s:
  v_smfmac_f32_16x16x64_bf16 v[44:47], v[32:35], v[152:159], v1
  ds_read_b128 v[32:35], v0 offset:23552
  v_smfmac_f32_16x16x64_bf16 v[40:43], v[36:39], v[128:135], v1
  s_waitcnt lgkmcnt(4)
  s_barrier
  ds_read_b64_tr_b16 v[12:13], v6 offset:0
  ds_read_b64_tr_b16 v[14:15], v52 offset:256
  ds_read_b64_tr_b16 v[16:17], v6 offset:1024
  ds_read_b64_tr_b16 v[18:19], v52 offset:1280
  v_smfmac_f32_16x16x64_bf16 v[44:47], v[36:39], v[136:143], v1
  ds_read_b64_tr_b16 v[20:21], v6 offset:2048
  ds_read_b64_tr_b16 v[22:23], v52 offset:2304
  s_waitcnt lgkmcnt(8)
  v_smfmac_f32_16x16x64_bf16 v[40:43], v[28:31], v[160:167], v1
  ds_read_b64_tr_b16 v[24:25], v6 offset:3072
  ds_read_b64_tr_b16 v[26:27], v52 offset:3328
  v_smfmac_f32_16x16x64_bf16 v[44:47], v[28:31], v[168:175], v1
  ds_read_b128 v[28:31], v0 offset:24576
  s_waitcnt lgkmcnt(9)
  v_smfmac_f32_16x16x64_bf16 v[40:43], v[32:35], v[176:183], v1
  v_smfmac_f32_16x16x64_bf16 v[44:47], v[32:35], v[184:191], v1
  ds_read_b128 v[32:35], v0 offset:16384
  s_waitcnt lgkmcnt(8)
  v_mfma_f32_16x16x32_bf16 v[56:59], v[60:63], v[12:15], 0
  ds_read_b128 v[36:39], v0 offset:1024
  v_mfma_f32_16x16x32_bf16 v[60:63], v[48:51], v[12:15], 0
  ds_read_b128 v[48:51], v0 offset:5120
  v_mfma_f32_16x16x32_bf16 v[52:55], v[12:15], v[12:15], 0
  ds_read_b128 v[12:15], v0 offset:2048
  s_waitcnt lgkmcnt(9)
  v_mfma_f32_16x16x32_bf16 v[52:55], v[16:19], v[16:19], v[52:55]
  s_waitcnt lgkmcnt(2)
  v_mfma_f32_16x16x32_bf16 v[56:59], v[36:39], v[16:19], v[56:59]
  ds_read_b128 v[36:39], v0 offset:6144
  s_waitcnt lgkmcnt(2)
  v_mfma_f32_16x16x32_bf16 v[60:63], v[48:51], v[16:19], v[60:63]
  ds_read_b128 v[48:51], v0 offset:3072
  ds_read_b128 v[16:19], v0 offset:7168
  v_mfma_f32_16x16x32_bf16 v[52:55], v[20:23], v[20:23], v[52:55]
  s_waitcnt lgkmcnt(3)
  v_mfma_f32_16x16x32_bf16 v[56:59], v[12:15], v[20:23], v[56:59]
  s_waitcnt lgkmcnt(2)
  v_mfma_f32_16x16x32_bf16 v[60:63], v[36:39], v[20:23], v[60:63]
  s_waitcnt vmcnt(2)
  ds_read_b128 v[20:23], v0 offset:14336
  ds_read_b128 v[12:15], v0 offset:15360
  v_mfma_f32_16x16x32_bf16 v[52:55], v[24:27], v[24:27], v[52:55]
  s_waitcnt lgkmcnt(3)
  v_mfma_f32_16x16x32_bf16 v[56:59], v[48:51], v[24:27], v[56:59]
  s_waitcnt lgkmcnt(2)
  v_mfma_f32_16x16x32_bf16 v[60:63], v[16:19], v[24:27], v[60:63]
  v_smfmac_f32_16x16x64_bf16 v[40:43], v[28:31], v[192:199], v1
  buffer_store_dwordx4 v[24:27], v9, s[4:7], s49 offen offset:1536 sc1
  v_mov_b32 v36, 0x3f803f80
  v_mov_b32 v37, 0x3f803f80
  v_max3_f32 v48, v52, v53, v56
  v_max3_f32 v48, v48, v57, v58
  v_max3_f32 v48, v48, v59, v60
  v_max3_f32 v48, v48, v61, v62
  v_max_f32 v49, v48, v63
  v_max_f32 v48, v48, v63
  v_smfmac_f32_16x16x64_bf16 v[44:47], v[28:31], v[200:207], v1
  ds_read_b128 v[28:31], v0 offset:17408
  v_mov_b64 v[38:39], v[36:37]
  v_permlane32_swap_b32 v48, v49
  v_max_f32 v48, v48, v49
  v_mov_b32 v49, v48
  v_smfmac_f32_16x16x64_bf16 v[40:43], v[32:35], v[64:71], v1
  v_mov_b64 v[16:17], 0
  v_permlane16_swap_b32 v48, v49
  v_max_f32 v48, v48, v49
  v_mul_f32 v48, s47, v48
  v_pk_fma_f32 v[56:57], v[56:57], s[46:47], v[48:49] op_sel_hi:[1,0,0]
  v_pk_fma_f32 v[58:59], v[58:59], s[46:47], v[48:49] op_sel_hi:[1,0,0]
  v_pk_fma_f32 v[60:61], v[60:61], s[46:47], v[48:49] op_sel_hi:[1,0,0]
  v_pk_fma_f32 v[62:63], v[62:63], s[46:47], v[48:49] op_sel_hi:[1,0,0]
  v_pk_fma_f32 v[52:53], v[52:53], s[46:47], v[48:49] op_sel_hi:[1,0,0]
  v_smfmac_f32_16x16x64_bf16 v[44:47], v[32:35], v[72:79], v1
  ds_read_b128 v[32:35], v0 offset:18432
  v_exp_f32 v56, v56
  v_exp_f32 v57, v57
  s_waitcnt lgkmcnt(1)
  v_smfmac_f32_16x16x64_bf16 v[40:43], v[28:31], v[80:87], v1
  v_exp_f32 v58, v58
  v_exp_f32 v59, v59
  v_smfmac_f32_16x16x64_bf16 v[44:47], v[28:31], v[88:95], v1
  v_exp_f32 v60, v60
  v_exp_f32 v61, v61
  s_waitcnt lgkmcnt(0)
  v_smfmac_f32_16x16x64_bf16 v[40:43], v[32:35], v[96:103], v1
  v_exp_f32 v62, v62
  v_exp_f32 v63, v63
  v_smfmac_f32_16x16x64_bf16 v[44:47], v[32:35], v[104:111], v1
  v_exp_f32 v52, v52
  v_exp_f32 v53, v53
  ds_read_b128 v[28:31], v3 offset:32768
  ds_read_b128 v[32:35], v3 offset:33792
  v_mov_b64 v[18:19], 0
  v_cvt_pk_bf16_f32 v24, v56, v57
  v_cvt_pk_bf16_f32 v25, v58, v59
  v_cvt_pk_bf16_f32 v26, v60, v61
  v_cvt_pk_bf16_f32 v27, v62, v63
  v_cvt_pk_bf16_f32 v16, v52, v53
  v_cvt_pk_bf16_f32 v19, v52, v53
  v_mfma_f32_16x16x32_bf16 v[52:55], v[36:39], v[24:27], 0
  v_add_f32 v40, v40, v42
  v_add_f32 v41, v41, v43
  v_mfma_f32_16x16x32_bf16 v[56:59], v[20:23], v[24:27], 0
  v_add_f32 v44, v44, v46
  v_add_f32 v45, v45, v47
  v_mfma_f32_16x16x32_bf16 v[60:63], v[12:15], v[24:27], 0
  v_cvt_pk_bf16_f32 v40, v40, v41
  v_cvt_pk_bf16_f32 v41, v44, v45
  s_add_u32 s51, s49, 4194304
  v_lshrrev_b32 v50, 1, v0
  v_mfma_f32_16x16x16_bf16 v[52:55], v[36:37], v[16:17], v[52:55]
  v_mov_b64 v[44:45], 0
  v_mov_b64 v[46:47], 0
  v_mfma_f32_16x16x16_bf16 v[56:59], v[40:41], v[16:17], v[56:59]
  buffer_store_dwordx2 v[40:41], v50, s[4:7], s51 offen offset:1536 sc1
  v_mov_b64 v[12:13], 0
  v_mov_b64 v[14:15], 0
  v_mfma_f32_16x16x16_bf16 v[60:63], v[40:41], v[18:19], v[60:63]
  s_nop 0
  v_rcp_f32 v48, v52
  v_mov_b64 v[36:37], 0
  v_mov_b64 v[38:39], 0
  s_mov_b64 exec, s[52:53]
  v_pk_mul_f32 v[56:57], v[56:57], v[48:49] op_sel_hi:[1,0]
  v_pk_mul_f32 v[58:59], v[58:59], v[48:49] op_sel_hi:[1,0]
  v_cvt_pk_bf16_f32 v56, v56, v57
  v_cvt_pk_bf16_f32 v57, v58, v59
  ds_write_b64 v7, v[56:57] offset:0
  v_pk_mul_f32 v[60:61], v[60:61], v[48:49] op_sel_hi:[1,0]
  v_pk_mul_f32 v[62:63], v[62:63], v[48:49] op_sel_hi:[1,0]
  v_cvt_pk_bf16_f32 v60, v60, v61
  v_cvt_pk_bf16_f32 v61, v62, v63
  ds_write_b64 v7, v[60:61] offset:256
  s_mov_b64 exec, -1
  v_mov_b32 v58, 0
  v_mov_b32 v59, 0
  v_mov_b32 v56, 0
  v_mov_b32 v57, 0
  v_mov_b32 v51, s40
  buffer_store_dword v51, off, s[4:7], s94 sc1
  s_cmp_lt_u32 s60, s95
  s_cbranch_scc1 L_fwc3s_95_o
L_fwc3s_95_b:
  s_waitcnt lgkmcnt(0)
  s_barrier
  ds_read_b128 v[16:19], v4 offset:29696
  v_mov_b32 v60, 0
  ds_read_b128 v[40:43], v4 offset:30208
  v_mov_b32 v61, 0
  ds_read_b128 v[48:51], v4 offset:30720
  v_mov_b32 v62, 0
  ds_read_b128 v[52:55], v4 offset:31232
  v_mov_b32 v63, 0
  ds_read_b128 v[20:23], v3 offset:34816
  ds_read_b128 v[24:27], v3 offset:35840
  s_waitcnt lgkmcnt(5)
  v_smfmac_f32_16x16x64_bf16 v[44:47], v[16:19], a[160:167], v1
  s_waitcnt lgkmcnt(4)
  v_smfmac_f32_16x16x64_bf16 v[44:47], v[40:43], v[28:35], v1
  ds_read_b128 v[28:31], v3 offset:49152
  ds_read_b128 v[32:35], v3 offset:50176
  s_waitcnt lgkmcnt(5)
  v_smfmac_f32_16x16x64_bf16 v[44:47], v[48:51], a[168:175], v1
  s_waitcnt lgkmcnt(4)
  v_smfmac_f32_16x16x64_bf16 v[44:47], v[52:55], a[176:183], v1
  s_waitcnt lgkmcnt(2)
  v_smfmac_f32_16x16x64_bf16 v[12:15], v[16:19], v[20:27], v1
  ds_read_b128 v[20:23], v3 offset:51200
  ds_read_b128 v[24:27], v3 offset:52224
  v_smfmac_f32_16x16x64_bf16 v[12:15], v[40:43], a[184:191], v1
  s_nop 0
  v_cvt_pk_bf16_f32 v44, v44, v45
  v_cvt_pk_bf16_f32 v45, v46, v47
  v_smfmac_f32_16x16x64_bf16 v[12:15], v[48:51], a[192:199], v1
  v_bfi_b32 v44, 1, s54, v44
  v_bfi_b32 v45, 1, s54, v45
  buffer_store_dwordx2 v[44:45], v8, s[4:7], s89 offen sc1
  v_smfmac_f32_16x16x64_bf16 v[12:15], v[52:55], a[200:207], v1
  s_waitcnt lgkmcnt(2)
  v_smfmac_f32_16x16x64_bf16 v[36:39], v[16:19], v[28:35], v1
  ds_read_b128 v[28:31], v0 offset:29696
  ds_read_b128 v[32:35], v0 offset:30720
  v_smfmac_f32_16x16x64_bf16 v[36:39], v[40:43], a[208:215], v1
  s_nop 0
  v_cvt_pk_bf16_f32 v12, v12, v13
  v_cvt_pk_bf16_f32 v13, v14, v15
  v_smfmac_f32_16x16x64_bf16 v[36:39], v[48:51], a[216:223], v1
  v_bfi_b32 v12, 1, s54, v12
  v_bfi_b32 v13, 1, s54, v13
  buffer_store_dwordx2 v[12:13], v8, s[4:7], s90 offen sc1
  v_smfmac_f32_16x16x64_bf16 v[36:39], v[52:55], a[224:231], v1
  s_waitcnt lgkmcnt(2)
  v_smfmac_f32_16x16x64_bf16 v[56:59], v[16:19], v[20:27], v1
  v_smfmac_f32_16x16x64_bf16 v[56:59], v[40:43], a[232:239], v1
  s_nop 0
  v_cvt_pk_bf16_f32 v36, v36, v37
  v_cvt_pk_bf16_f32 v37, v38, v39
  v_smfmac_f32_16x16x64_bf16 v[56:59], v[48:51], a[240:247], v1
  v_bfi_b32 v36, 1, s54, v36
  v_bfi_b32 v37, 1, s54, v37
  buffer_store_dwordx2 v[36:37], v8, s[4:7], s91 offen sc1
  v_smfmac_f32_16x16x64_bf16 v[56:59], v[52:55], a[248:255], v1
  s_waitcnt lgkmcnt(1)
  v_smfmac_f32_16x16x64_bf16 v[60:63], v[28:31], a[144:151], v1
  s_waitcnt lgkmcnt(0)
  v_smfmac_f32_16x16x64_bf16 v[60:63], v[32:35], a[152:159], v1
  s_nop 0
  v_cvt_pk_bf16_f32 v56, v56, v57
  v_cvt_pk_bf16_f32 v57, v58, v59
  v_bfi_b32 v56, 1, s54, v56
  v_bfi_b32 v57, 1, s54, v57
  buffer_store_dwordx2 v[56:57], v8, s[4:7], s92 offen sc1
  s_nop 1
  v_pk_add_f32 v[60:61], v[60:61], v[62:63]
  v_cvt_pk_bf16_f32 v60, v60, v61
  v_bfi_b32 v60, 1, s54, v60
  buffer_store_dword v60, v8, s[4:7], s88 offen offset:4 sc1
  s_add_u32 s96, s40, 4
  s_min_u32 s96, s96, 64
  s_cmp_ge_u32 s60, s96
  s_cbranch_scc1 L_fwc3s_96_x
L_fwc3s_96:
  s_load_dwordx4 s[96:99], s[4:5], s61 glc
  s_waitcnt lgkmcnt(0)
  s_min_u32 s96, s96, s97
  s_min_u32 s98, s98, s99
  s_min_u32 s60, s96, s98
L_fwc3s_96_x:
  s_add_u32 s95, s40, 3
  s_waitcnt vmcnt(0)
  s_branch L_loop_c3s
L_lcp_c3s:
  v_lshlrev_b32 v56, 2, v0
  v_min_u32 v56, L_code_end-L_last_0-4, v56
  v_mov_b32 v57, s13
  v_add_co_u32 v56, vcc, s12, v56
  s_nop 1
  v_addc_co_u32 v57, vcc, 0, v57, vcc
  global_load_lds_dword v[56:57], off
  s_branch L_lcpb_c3s
L_fwc3s_95_o:
  s_cmp_ge_u32 s60, s95
  s_cbranch_scc1 L_fwc3s_97_x
L_fwc3s_97:
  s_load_dwordx4 s[96:99], s[4:5], s61 glc
  s_add_u32 s50, s50, 1
  s_waitcnt lgkmcnt(0)
  s_min_u32 s96, s96, s97
  s_min_u32 s98, s98, s99
  s_min_u32 s60, s96, s98
  s_cmp_ge_u32 s50, 262144
  s_cbranch_scc1 L_fwc3s_97_x
  s_cmp_lt_u32 s60, s95
  s_cbranch_scc1 L_fwc3s_97
L_fwc3s_97_x:
  s_branch L_fwc3s_95_b
.p2align 5
L_last_0:
  v_smfmac_f32_16x16x64_bf16 v[12:15], v[28:31], v[64:71], v1
  v_smfmac_f32_16x16x64_bf16 v[20:23], v[28:31], v[40:47], v1
  ds_read_b128 v[40:43], v2 offset:18432
  ds_read_b128 v[44:47], v2 offset:19456
  v_smfmac_f32_16x16x64_bf16 v[16:19], v[28:31], v[72:79], v1
  v_smfmac_f32_16x16x64_bf16 v[24:27], v[28:31], v[48:55], v1
  ds_read_b128 v[48:51], v2 offset:32768
  ds_read_b128 v[52:55], v2 offset:33792
  s_waitcnt vmcnt(0)
  v_mov_b32 v10, s40
  buffer_store_dword v10, off, s[4:7], s94 sc1
  s_waitcnt lgkmcnt(4)
  s_barrier
  ds_read_b128 v[36:39], v0 offset:18432
  ds_read_b128 v[28:31], v0 offset:19456
  v_smfmac_f32_16x16x64_bf16 v[12:15], v[32:35], v[80:87], v1
  v_smfmac_f32_16x16x64_bf16 v[20:23], v[32:35], a[96:103], v1
  v_smfmac_f32_16x16x64_bf16 v[16:19], v[32:35], v[88:95], v1
  v_smfmac_f32_16x16x64_bf16 v[24:27], v[32:35], a[104:111], v1
  ds_read_b128 v[32:35], v0 offset:20480
  s_waitcnt lgkmcnt(2)
  v_smfmac_f32_16x16x64_bf16 v[12:15], v[36:39], v[96:103], v1
  v_smfmac_f32_16x16x64_bf16 v[20:23], v[36:39], v[56:63], v1
  ds_read_b128 v[56:59], v2 offset:34816
  ds_read_b128 v[60:63], v2 offset:35840
  v_smfmac_f32_16x16x64_bf16 v[16:19], v[36:39], v[104:111], v1
  v_smfmac_f32_16x16x64_bf16 v[24:27], v[36:39], v[40:47], v1
  ds_read_b128 v[40:43], v2 offset:49152
  ds_read_b128 v[44:47], v2 offset:50176
  ds_read_b128 v[36:39], v0 offset:21504
  s_waitcnt lgkmcnt(6)
  v_smfmac_f32_16x16x64_bf16 v[12:15], v[28:31], v[112:119], v1
  v_smfmac_f32_16x16x64_bf16 v[20:23], v[28:31], v[48:55], v1
  ds_read_b128 v[48:51], v2 offset:51200
  ds_read_b128 v[52:55], v2 offset:52224
  v_smfmac_f32_16x16x64_bf16 v[16:19], v[28:31], v[120:127], v1
  s_waitcnt lgkmcnt(5)
  v_smfmac_f32_16x16x64_bf16 v[24:27], v[28:31], v[56:63], v1
  ds_read_b128 v[56:59], v3 offset:0
  ds_read_b128 v[60:63], v3 offset:1024
  ds_read_b128 v[28:31], v0 offset:22528
  v_smfmac_f32_16x16x64_bf16 v[12:15], v[32:35], v[128:135], v1
  v_smfmac_f32_16x16x64_bf16 v[20:23], v[32:35], a[112:119], v1
  v_smfmac_f32_16x16x64_bf16 v[16:19], v[32:35], v[136:143], v1
  v_smfmac_f32_16x16x64_bf16 v[24:27], v[32:35], a[120:127], v1
  ds_read_b128 v[32:35], v0 offset:24576
  s_waitcnt lgkmcnt(6)
  v_smfmac_f32_16x16x64_bf16 v[12:15], v[36:39], v[144:151], v1
  v_smfmac_f32_16x16x64_bf16 v[20:23], v[36:39], v[40:47], v1
  ds_read_b128 v[40:43], v3 offset:2048
  ds_read_b128 v[44:47], v3 offset:3072
  v_smfmac_f32_16x16x64_bf16 v[16:19], v[36:39], v[152:159], v1
  s_waitcnt lgkmcnt(6)
  v_smfmac_f32_16x16x64_bf16 v[24:27], v[36:39], v[48:55], v1
  ds_read_b128 v[48:51], v3 offset:16384
  ds_read_b128 v[52:55], v3 offset:17408
  ds_read_b128 v[36:39], v0 offset:23552
  s_waitcnt lgkmcnt(6)
  v_smfmac_f32_16x16x64_bf16 v[12:15], v[28:31], v[160:167], v1
  v_smfmac_f32_16x16x64_bf16 v[20:23], v[28:31], v[56:63], v1
  ds_read_b128 v[56:59], v3 offset:18432
  ds_read_b128 v[60:63], v3 offset:19456
  v_smfmac_f32_16x16x64_bf16 v[16:19], v[28:31], v[168:175], v1
  s_waitcnt lgkmcnt(5)
  v_smfmac_f32_16x16x64_bf16 v[24:27], v[28:31], v[40:47], v1
  v_smfmac_f32_16x16x64_bf16 v[12:15], v[32:35], v[192:199], v1
  s_waitcnt lgkmcnt(3)
  v_smfmac_f32_16x16x64_bf16 v[20:23], v[32:35], v[48:55], v1
  v_smfmac_f32_16x16x64_bf16 v[16:19], v[32:35], v[200:207], v1
  s_waitcnt lgkmcnt(0)
  v_smfmac_f32_16x16x64_bf16 v[24:27], v[32:35], v[56:63], v1
  v_smfmac_f32_16x16x64_bf16 v[12:15], v[36:39], v[176:183], v1
  v_smfmac_f32_16x16x64_bf16 v[20:23], v[36:39], a[128:135], v1
  v_smfmac_f32_16x16x64_bf16 v[16:19], v[36:39], v[184:191], v1
  v_smfmac_f32_16x16x64_bf16 v[24:27], v[36:39], a[136:143], v1
  v_lshrrev_b32 v48, 1, v0
  v_xor_b32 v49, 16, v6
  s_add_u32 s51, s49, 4194304
  v_pk_add_f32 v[12:13], v[12:13], v[14:15]
  v_pk_add_f32 v[20:21], v[20:21], v[22:23]
  v_pk_add_f32 v[16:17], v[16:17], v[18:19]
  s_nop 1
  v_pk_add_f32 v[24:25], v[24:25], v[26:27]
  v_cvt_pk_bf16_f32 v20, v20, v21
  ds_write_b64 v5, v[20:21] offset:0
  v_cvt_pk_bf16_f32 v24, v24, v25
  ds_write_b64 v5, v[24:25] offset:512
  v_cvt_pk_bf16_f32 v12, v12, v13
  v_cvt_pk_bf16_f32 v13, v16, v17
  s_waitcnt lgkmcnt(0)
  ds_read_b64_tr_b16 v[28:29], v6 offset:0
  ds_read_b64_tr_b16 v[30:31], v49 offset:256
  buffer_store_dwordx2 v[12:13], v48, s[4:7], s51 offen offset:0 sc1
  s_waitcnt lgkmcnt(0)
  buffer_store_dwordx4 v[28:31], v9, s[4:7], s49 offen offset:0 sc1
  s_branch L_chain_end
.p2align 5
L_last_1:
  v_smfmac_f32_16x16x64_bf16 v[12:15], v[28:31], v[96:103], v1
  v_smfmac_f32_16x16x64_bf16 v[20:23], v[28:31], v[40:47], v1
  ds_read_b128 v[40:43], v2 offset:34816
  ds_read_b128 v[44:47], v2 offset:35840
  v_smfmac_f32_16x16x64_bf16 v[16:19], v[28:31], v[104:111], v1
  v_smfmac_f32_16x16x64_bf16 v[24:27], v[28:31], v[48:55], v1
  ds_read_b128 v[48:51], v2 offset:0
  ds_read_b128 v[52:55], v2 offset:1024
  s_waitcnt vmcnt(0)
  s_waitcnt lgkmcnt(4)
  s_barrier
  ds_read_b128 v[36:39], v0 offset:17408
  ds_read_b128 v[28:31], v0 offset:16384
  v_smfmac_f32_16x16x64_bf16 v[12:15], v[32:35], v[112:119], v1
  v_smfmac_f32_16x16x64_bf16 v[20:23], v[32:35], v[56:63], v1
  ds_read_b128 v[56:59], v2 offset:2048
  ds_read_b128 v[60:63], v2 offset:3072
  v_smfmac_f32_16x16x64_bf16 v[16:19], v[32:35], v[120:127], v1
  s_waitcnt lgkmcnt(6)
  v_smfmac_f32_16x16x64_bf16 v[24:27], v[32:35], v[40:47], v1
  ds_read_b128 v[40:43], v2 offset:49152
  ds_read_b128 v[44:47], v2 offset:50176
  ds_read_b128 v[32:35], v0 offset:21504
  s_waitcnt lgkmcnt(6)
  v_smfmac_f32_16x16x64_bf16 v[12:15], v[36:39], v[80:87], v1
  v_smfmac_f32_16x16x64_bf16 v[20:23], v[36:39], a[96:103], v1
  v_smfmac_f32_16x16x64_bf16 v[16:19], v[36:39], v[88:95], v1
  v_smfmac_f32_16x16x64_bf16 v[24:27], v[36:39], a[104:111], v1
  ds_read_b128 v[36:39], v0 offset:20480
  s_waitcnt lgkmcnt(6)
  v_smfmac_f32_16x16x64_bf16 v[12:15], v[28:31], v[64:71], v1
  v_smfmac_f32_16x16x64_bf16 v[20:23], v[28:31], v[48:55], v1
  ds_read_b128 v[48:51], v2 offset:51200
  ds_read_b128 v[52:55], v2 offset:52224
  v_smfmac_f32_16x16x64_bf16 v[16:19], v[28:31], v[72:79], v1
  s_waitcnt lgkmcnt(6)
  v_smfmac_f32_16x16x64_bf16 v[24:27], v[28:31], v[56:63], v1
  ds_read_b128 v[56:59], v3 offset:0
  ds_read_b128 v[60:63], v3 offset:1024
  ds_read_b128 v[28:31], v0 offset:22528
  s_waitcnt lgkmcnt(6)
  v_smfmac_f32_16x16x64_bf16 v[12:15], v[32:35], v[144:151], v1
  v_smfmac_f32_16x16x64_bf16 v[20:23], v[32:35], v[40:47], v1
  ds_read_b128 v[40:43], v3 offset:2048
  ds_read_b128 v[44:47], v3 offset:3072
  v_smfmac_f32_16x16x64_bf16 v[16:19], v[32:35], v[152:159], v1
  s_waitcnt lgkmcnt(5)
  v_smfmac_f32_16x16x64_bf16 v[24:27], v[32:35], v[48:55], v1
  ds_read_b128 v[48:51], v3 offset:16384
  ds_read_b128 v[52:55], v3 offset:17408
  ds_read_b128 v[32:35], v0 offset:24576
  v_smfmac_f32_16x16x64_bf16 v[12:15], v[36:39], v[128:135], v1
  v_smfmac_f32_16x16x64_bf16 v[20:23], v[36:39], a[112:119], v1
  v_smfmac_f32_16x16x64_bf16 v[16:19], v[36:39], v[136:143], v1
  v_smfmac_f32_16x16x64_bf16 v[24:27], v[36:39], a[120:127], v1
  ds_read_b128 v[36:39], v0 offset:23552
  s_waitcnt lgkmcnt(6)
  v_smfmac_f32_16x16x64_bf16 v[12:15], v[28:31], v[160:167], v1
  v_smfmac_f32_16x16x64_bf16 v[20:23], v[28:31], v[56:63], v1
  ds_read_b128 v[56:59], v3 offset:18432
  ds_read_b128 v[60:63], v3 offset:19456
  v_smfmac_f32_16x16x64_bf16 v[16:19], v[28:31], v[168:175], v1
  s_waitcnt lgkmcnt(6)
  v_smfmac_f32_16x16x64_bf16 v[24:27], v[28:31], v[40:47], v1
  s_waitcnt lgkmcnt(3)
  v_smfmac_f32_16x16x64_bf16 v[12:15], v[32:35], v[192:199], v1
  v_smfmac_f32_16x16x64_bf16 v[20:23], v[32:35], v[48:55], v1
  v_smfmac_f32_16x16x64_bf16 v[16:19], v[32:35], v[200:207], v1
  s_waitcnt lgkmcnt(0)
  v_smfmac_f32_16x16x64_bf16 v[24:27], v[32:35], v[56:63], v1
  v_smfmac_f32_16x16x64_bf16 v[12:15], v[36:39], v[176:183], v1
  v_smfmac_f32_16x16x64_bf16 v[20:23], v[36:39], a[128:135], v1
  v_smfmac_f32_16x16x64_bf16 v[16:19], v[36:39], v[184:191], v1
  v_smfmac_f32_16x16x64_bf16 v[24:27], v[36:39], a[136:143], v1
  v_lshrrev_b32 v48, 1, v0
  v_xor_b32 v49, 16, v6
  s_add_u32 s51, s49, 4194304
  v_pk_add_f32 v[12:13], v[12:13], v[14:15]
  v_pk_add_f32 v[20:21], v[20:21], v[22:23]
  v_pk_add_f32 v[16:17], v[16:17], v[18:19]
  s_nop 1
  v_pk_add_f32 v[24:25], v[24:25], v[26:27]
  v_cvt_pk_bf16_f32 v20, v20, v21
  ds_write_b64 v5, v[20:21] offset:0
  v_cvt_pk_bf16_f32 v24, v24, v25
  ds_write_b64 v5, v[24:25] offset:512
  v_cvt_pk_bf16_f32 v12, v12, v13
  v_cvt_pk_bf16_f32 v13, v16, v17
  s_waitcnt lgkmcnt(0)
  ds_read_b64_tr_b16 v[28:29], v6 offset:1024
  ds_read_b64_tr_b16 v[30:31], v49 offset:1280
  buffer_store_dwordx2 v[12:13], v48, s[4:7], s51 offen offset:512 sc1
  s_waitcnt lgkmcnt(0)
  buffer_store_dwordx4 v[28:31], v9, s[4:7], s49 offen offset:512 sc1
  s_branch L_chain_end
.p2align 5
L_last_2:
  v_smfmac_f32_16x16x64_bf16 v[12:15], v[28:31], v[128:135], v1
  v_smfmac_f32_16x16x64_bf16 v[20:23], v[28:31], a[112:119], v1
  v_smfmac_f32_16x16x64_bf16 v[16:19], v[28:31], v[136:143], v1
  v_smfmac_f32_16x16x64_bf16 v[24:27], v[28:31], a[120:127], v1
  s_waitcnt vmcnt(0)
  s_waitcnt lgkmcnt(0)
  s_barrier
  ds_read_b128 v[36:39], v0 offset:16384
  ds_read_b128 v[28:31], v0 offset:18432
  v_smfmac_f32_16x16x64_bf16 v[12:15], v[32:35], v[144:151], v1
  v_smfmac_f32_16x16x64_bf16 v[20:23], v[32:35], v[40:47], v1
  ds_read_b128 v[40:43], v2 offset:2048
  ds_read_b128 v[44:47], v2 offset:3072
  v_smfmac_f32_16x16x64_bf16 v[16:19], v[32:35], v[152:159], v1
  v_smfmac_f32_16x16x64_bf16 v[24:27], v[32:35], v[48:55], v1
  ds_read_b128 v[48:51], v2 offset:16384
  ds_read_b128 v[52:55], v2 offset:17408
  ds_read_b128 v[32:35], v0 offset:17408
  s_waitcnt lgkmcnt(6)
  v_smfmac_f32_16x16x64_bf16 v[12:15], v[36:39], v[64:71], v1
  v_smfmac_f32_16x16x64_bf16 v[20:23], v[36:39], v[56:63], v1
  ds_read_b128 v[56:59], v2 offset:18432
  ds_read_b128 v[60:63], v2 offset:19456
  v_smfmac_f32_16x16x64_bf16 v[16:19], v[36:39], v[72:79], v1
  s_waitcnt lgkmcnt(5)
  v_smfmac_f32_16x16x64_bf16 v[24:27], v[36:39], v[40:47], v1
  ds_read_b128 v[40:43], v2 offset:32768
  ds_read_b128 v[44:47], v2 offset:33792
  ds_read_b128 v[36:39], v0 offset:19456
  v_smfmac_f32_16x16x64_bf16 v[12:15], v[28:31], v[96:103], v1
  s_waitcnt lgkmcnt(6)
  v_smfmac_f32_16x16x64_bf16 v[20:23], v[28:31], v[48:55], v1
  ds_read_b128 v[48:51], v2 offset:34816
  ds_read_b128 v[52:55], v2 offset:35840
  v_smfmac_f32_16x16x64_bf16 v[16:19], v[28:31], v[104:111], v1
  s_waitcnt lgkmcnt(5)
  v_smfmac_f32_16x16x64_bf16 v[24:27], v[28:31], v[56:63], v1
  ds_read_b128 v[56:59], v3 offset:0
  ds_read_b128 v[60:63], v3 offset:1024
  ds_read_b128 v[28:31], v0 offset:22528
  v_smfmac_f32_16x16x64_bf16 v[12:15], v[32:35], v[80:87], v1
  v_smfmac_f32_16x16x64_bf16 v[20:23], v[32:35], a[96:103], v1
  v_smfmac_f32_16x16x64_bf16 v[16:19], v[32:35], v[88:95], v1
  v_smfmac_f32_16x16x64_bf16 v[24:27], v[32:35], a[104:111], v1
  ds_read_b128 v[32:35], v0 offset:24576
  s_waitcnt lgkmcnt(6)
  v_smfmac_f32_16x16x64_bf16 v[12:15], v[36:39], v[112:119], v1
  v_smfmac_f32_16x16x64_bf16 v[20:23], v[36:39], v[40:47], v1
  ds_read_b128 v[40:43], v3 offset:2048
  ds_read_b128 v[44:47], v3 offset:3072
  v_smfmac_f32_16x16x64_bf16 v[16:19], v[36:39], v[120:127], v1
  s_waitcnt lgkmcnt(6)
  v_smfmac_f32_16x16x64_bf16 v[24:27], v[36:39], v[48:55], v1
  ds_read_b128 v[48:51], v3 offset:16384
  ds_read_b128 v[52:55], v3 offset:17408
  ds_read_b128 v[36:39], v0 offset:23552
  s_waitcnt lgkmcnt(6)
  v_smfmac_f32_16x16x64_bf16 v[12:15], v[28:31], v[160:167], v1
  v_smfmac_f32_16x16x64_bf16 v[20:23], v[28:31], v[56:63], v1
  ds_read_b128 v[56:59], v3 offset:18432
  ds_read_b128 v[60:63], v3 offset:19456
  v_smfmac_f32_16x16x64_bf16 v[16:19], v[28:31], v[168:175], v1
  s_waitcnt lgkmcnt(5)
  v_smfmac_f32_16x16x64_bf16 v[24:27], v[28:31], v[40:47], v1
  v_smfmac_f32_16x16x64_bf16 v[12:15], v[32:35], v[192:199], v1
  s_waitcnt lgkmcnt(3)
  v_smfmac_f32_16x16x64_bf16 v[20:23], v[32:35], v[48:55], v1
  v_smfmac_f32_16x16x64_bf16 v[16:19], v[32:35], v[200:207], v1
  s_waitcnt lgkmcnt(0)
  v_smfmac_f32_16x16x64_bf16 v[24:27], v[32:35], v[56:63], v1
  v_smfmac_f32_16x16x64_bf16 v[12:15], v[36:39], v[176:183], v1
  v_smfmac_f32_16x16x64_bf16 v[20:23], v[36:39], a[128:135], v1
  v_smfmac_f32_16x16x64_bf16 v[16:19], v[36:39], v[184:191], v1
  v_smfmac_f32_16x16x64_bf16 v[24:27], v[36:39], a[136:143], v1
  v_lshrrev_b32 v48, 1, v0
  v_xor_b32 v49, 16, v6
  s_add_u32 s51, s49, 4194304
  v_pk_add_f32 v[12:13], v[12:13], v[14:15]
  v_pk_add_f32 v[20:21], v[20:21], v[22:23]
  v_pk_add_f32 v[16:17], v[16:17], v[18:19]
  s_nop 1
  v_pk_add_f32 v[24:25], v[24:25], v[26:27]
  v_cvt_pk_bf16_f32 v20, v20, v21
  ds_write_b64 v5, v[20:21] offset:0
  v_cvt_pk_bf16_f32 v24, v24, v25
  ds_write_b64 v5, v[24:25] offset:512
  v_cvt_pk_bf16_f32 v12, v12, v13
  v_cvt_pk_bf16_f32 v13, v16, v17
  s_waitcnt lgkmcnt(0)
  ds_read_b64_tr_b16 v[28:29], v6 offset:2048
  ds_read_b64_tr_b16 v[30:31], v49 offset:2304
  buffer_store_dwordx2 v[12:13], v48, s[4:7], s51 offen offset:1024 sc1
  s_waitcnt lgkmcnt(0)
  buffer_store_dwordx4 v[28:31], v9, s[4:7], s49 offen offset:1024 sc1
  s_branch L_chain_end
.p2align 5
L_last_3:
  v_smfmac_f32_16x16x64_bf16 v[12:15], v[28:31], v[160:167], v1
  v_smfmac_f32_16x16x64_bf16 v[20:23], v[28:31], v[40:47], v1
  ds_read_b128 v[40:43], v3 offset:18432
  ds_read_b128 v[44:47], v3 offset:19456
  v_smfmac_f32_16x16x64_bf16 v[16:19], v[28:31], v[168:175], v1
  v_smfmac_f32_16x16x64_bf16 v[24:27], v[28:31], v[48:55], v1
  ds_read_b128 v[48:51], v2 offset:0
  ds_read_b128 v[52:55], v2 offset:1024
  s_waitcnt vmcnt(0)
  s_waitcnt lgkmcnt(4)
  s_barrier
  ds_read_b128 v[28:31], v0 offset:16384
  v_smfmac_f32_16x16x64_bf16 v[12:15], v[32:35], v[176:183], v1
  v_smfmac_f32_16x16x64_bf16 v[20:23], v[32:35], a[128:135], v1
  v_smfmac_f32_16x16x64_bf16 v[16:19], v[32:35], v[184:191], v1
  v_smfmac_f32_16x16x64_bf16 v[24:27], v[32:35], a[136:143], v1
  ds_read_b128 v[32:35], v0 offset:17408
  v_smfmac_f32_16x16x64_bf16 v[12:15], v[36:39], v[192:199], v1
  v_smfmac_f32_16x16x64_bf16 v[20:23], v[36:39], v[56:63], v1
  ds_read_b128 v[56:59], v2 offset:2048
  ds_read_b128 v[60:63], v2 offset:3072
  v_smfmac_f32_16x16x64_bf16 v[16:19], v[36:39], v[200:207], v1
  s_waitcnt lgkmcnt(6)
  v_smfmac_f32_16x16x64_bf16 v[24:27], v[36:39], v[40:47], v1
  ds_read_b128 v[40:43], v2 offset:16384
  ds_read_b128 v[44:47], v2 offset:17408
  ds_read_b128 v[36:39], v0 offset:18432
  s_waitcnt lgkmcnt(6)
  v_smfmac_f32_16x16x64_bf16 v[12:15], v[28:31], v[64:71], v1
  v_smfmac_f32_16x16x64_bf16 v[20:23], v[28:31], v[48:55], v1
  ds_read_b128 v[48:51], v2 offset:18432
  ds_read_b128 v[52:55], v2 offset:19456
  v_smfmac_f32_16x16x64_bf16 v[16:19], v[28:31], v[72:79], v1
  s_waitcnt lgkmcnt(5)
  v_smfmac_f32_16x16x64_bf16 v[24:27], v[28:31], v[56:63], v1
  ds_read_b128 v[56:59], v2 offset:32768
  ds_read_b128 v[60:63], v2 offset:33792
  ds_read_b128 v[28:31], v0 offset:19456
  v_smfmac_f32_16x16x64_bf16 v[12:15], v[32:35], v[80:87], v1
  v_smfmac_f32_16x16x64_bf16 v[20:23], v[32:35], a[96:103], v1
  v_smfmac_f32_16x16x64_bf16 v[16:19], v[32:35], v[88:95], v1
  v_smfmac_f32_16x16x64_bf16 v[24:27], v[32:35], a[104:111], v1
  ds_read_b128 v[32:35], v0 offset:21504
  s_waitcnt lgkmcnt(6)
  v_smfmac_f32_16x16x64_bf16 v[12:15], v[36:39], v[96:103], v1
  v_smfmac_f32_16x16x64_bf16 v[20:23], v[36:39], v[40:47], v1
  ds_read_b128 v[40:43], v2 offset:34816
  ds_read_b128 v[44:47], v2 offset:35840
  v_smfmac_f32_16x16x64_bf16 v[16:19], v[36:39], v[104:111], v1
  s_waitcnt lgkmcnt(6)
  v_smfmac_f32_16x16x64_bf16 v[24:27], v[36:39], v[48:55], v1
  ds_read_b128 v[48:51], v2 offset:49152
  ds_read_b128 v[52:55], v2 offset:50176
  ds_read_b128 v[36:39], v0 offset:20480
  s_waitcnt lgkmcnt(6)
  v_smfmac_f32_16x16x64_bf16 v[12:15], v[28:31], v[112:119], v1
  v_smfmac_f32_16x16x64_bf16 v[20:23], v[28:31], v[56:63], v1
  ds_read_b128 v[56:59], v2 offset:51200
  ds_read_b128 v[60:63], v2 offset:52224
  v_smfmac_f32_16x16x64_bf16 v[16:19], v[28:31], v[120:127], v1
  s_waitcnt lgkmcnt(5)
  v_smfmac_f32_16x16x64_bf16 v[24:27], v[28:31], v[40:47], v1
  v_smfmac_f32_16x16x64_bf16 v[12:15], v[32:35], v[144:151], v1
  s_waitcnt lgkmcnt(3)
  v_smfmac_f32_16x16x64_bf16 v[20:23], v[32:35], v[48:55], v1
  v_smfmac_f32_16x16x64_bf16 v[16:19], v[32:35], v[152:159], v1
  s_waitcnt lgkmcnt(0)
  v_smfmac_f32_16x16x64_bf16 v[24:27], v[32:35], v[56:63], v1
  v_smfmac_f32_16x16x64_bf16 v[12:15], v[36:39], v[128:135], v1
  v_smfmac_f32_16x16x64_bf16 v[20:23], v[36:39], a[112:119], v1
  v_smfmac_f32_16x16x64_bf16 v[16:19], v[36:39], v[136:143], v1
  v_smfmac_f32_16x16x64_bf16 v[24:27], v[36:39], a[120:127], v1
  v_lshrrev_b32 v48, 1, v0
  v_xor_b32_e64 v49, 16, v6
  s_add_u32 s51, s49, 4194304
  v_pk_add_f32 v[12:13], v[12:13], v[14:15]
  v_pk_add_f32 v[20:21], v[20:21], v[22:23]
  v_pk_add_f32 v[16:17], v[16:17], v[18:19]
  s_nop 1
  v_pk_add_f32 v[24:25], v[24:25], v[26:27]
  v_cvt_pk_bf16_f32 v20, v20, v21
  ds_write_b64 v5, v[20:21] offset:0
  v_cvt_pk_bf16_f32 v24, v24, v25
  ds_write_b64 v5, v[24:25] offset:512
  v_cvt_pk_bf16_f32 v12, v12, v13
  v_cvt_pk_bf16_f32 v13, v16, v17
  s_waitcnt lgkmcnt(0)
  ds_read_b64_tr_b16 v[28:29], v6 offset:3072
  ds_read_b64_tr_b16 v[30:31], v49 offset:3328
  buffer_store_dwordx2 v[12:13], v48, s[4:7], s51 offen offset:1536 sc1
  s_waitcnt lgkmcnt(0)
  buffer_store_dwordx4 v[28:31], v9, s[4:7], s49 offen offset:1536 sc1
  s_branch L_chain_end
L_chain_end:
  s_endpgm
L_code_end:
.section .rodata,"a"
.p2align 6
.amdhsa_kernel sequential_preLN__memory_aug_recurrent_mem_tr__glu_gated_reglu__prompt_kernel
  .amdhsa_next_free_vgpr 512
  .amdhsa_next_free_sgpr 102
  .amdhsa_accum_offset 256
  .amdhsa_group_segment_fixed_size 0
  .amdhsa_kernarg_size 112
  .amdhsa_user_sgpr_count 2
  .amdhsa_user_sgpr_kernarg_segment_ptr 1
  .amdhsa_system_sgpr_workgroup_id_x 1
.end_amdhsa_kernel
```
